```python
import torch

def _softmax(x, axis=-1):
    return torch.softmax(x, dim=axis)

def _gelu(x):
    return torch.nn.functional.gelu(x, approximate='tanh')

def _silu(x):
    return torch.nn.functional.silu(x)

def _sigmoid(x):
    return torch.sigmoid(x)

def _layernorm(x, axis=-1, eps=1e-05):
    m = x.mean(dim=axis, keepdim=True)
    v = x.var(dim=axis, keepdim=True, unbiased=False)
    return (x - m) / torch.sqrt(v + eps)

def _scatter_add(tgt, idx, src, axis=0):
    return tgt.clone().index_add_(axis, idx, src)

def _segment_sum(src, seg, n):
    out = torch.zeros((n,) + src.shape[1:], dtype=src.dtype)
    return out.index_add_(0, seg, src)

def _pad(x, pw):
    flat = tuple((v for pair in reversed(pw) for v in pair))
    return torch.nn.functional.pad(x, flat)
kernel_name = 'standalone__window_attn_davit__vision'

def setup_inputs():

    _w = lambda a: (lambda t: t.to(torch.bfloat16) if t.is_floating_point() else t)(torch.as_tensor(a))
    HW = 512
    C0 = 192
    ws = 7
    nh = 4
    H = W = max(HW // ws * ws, ws)
    C = max(C0 // nh * nh, nh)
    k = 3
    return {'x': _w((lambda *s: torch.randn(*s, dtype=torch.bfloat16) * 1.6)(1, H, W, C)), 'dw_pe': _w((lambda *s: torch.randn(*s, dtype=torch.bfloat16) * 1.6)(k, k, C) * 0.1), 'w_qkv': _w((lambda *s: torch.randn(*s, dtype=torch.bfloat16) * 1.6)(C, 3 * C) * C ** (-0.5)), 'w_o': _w((lambda *s: torch.randn(*s, dtype=torch.bfloat16) * 0.4)(C, C) * C ** (-0.5))}

def reference(x, dw_pe, w_qkv, w_o):
    B, H, W, C = x.shape
    ws = 7
    nh = 4
    dh = C // nh
    kk = dw_pe.shape[0]
    pad = kk // 2
    xp = _pad(x, ((0, 0), (pad, pad), (pad, pad), (0, 0)))
    pe = torch.zeros_like(x)
    for i in range(kk):
        for j in range(kk):
            pe = pe + xp[:, i:i + H, j:j + W, :] * dw_pe[i, j][None, None, None, :]
    x0 = x + pe
    h = _layernorm(x0, axis=-1)
    hw = h.reshape(B, H // ws, ws, W // ws, ws, C)
    hw = (lambda x, *d: x.permute(*d))(hw, 0, 1, 3, 2, 4, 5)
    hw = hw.reshape(-1, ws * ws, C)
    qkv = (hw @ w_qkv).reshape(-1, ws * ws, 3, nh, dh)
    q = qkv[:, :, 0].clone()
    k = qkv[:, :, 1].clone()
    v = qkv[:, :, 2].clone()
    scale = dh ** (-0.5)
    attn = torch.einsum('wnhd,wmhd->whnm', q, k) * scale
    attn = _softmax(attn, axis=-1)
    out = torch.einsum('whnm,wmhd->wnhd', attn, v)
    out = out.reshape(-1, ws * ws, C) @ w_o
    out = out.reshape(B, H // ws, W // ws, ws, ws, C)
    out = (lambda x, *d: x.permute(*d))(out, 0, 1, 3, 2, 4, 5)
    out = out.reshape(B, H, W, C)
    return x0 + out
```

```asm
; @launch grid=(256,1,1) block=(256,1,1) lds=163840
.amdgcn_target "amdgcn-amd-amdhsa--gfx950"
.text
.globl standalone__window_attn_davit__vision_kernel
.p2align 8
.type standalone__window_attn_davit__vision_kernel,@function
standalone__window_attn_davit__vision_kernel:
  s_cmp_ge_u32 s2, 256
  s_cbranch_scc1 L_exit
  s_load_dwordx8 s[36:43], s[0:1], 0
  s_load_dwordx2 s[44:45], s[0:1], 32
  s_load_dwordx2 s[46:47], s[0:1], 48
  v_lshrrev_b32 v1, 6, v0
  s_and_b32 s60, s2, 7
  s_lshr_b32 s30, s2, 3
  v_readfirstlane_b32 s28, v1
  s_mul_i32 s29, s60, 667
  s_add_u32 s29, s29, s30
  s_mov_b32 s72, 667
  s_mov_b32 s73, 5329
  s_mov_b32 s71, 0
  s_waitcnt lgkmcnt(0)
  s_sub_u32 s4, s36, 196608
  s_subb_u32 s5, s37, 0
  s_mov_b32 s6, 100467072
  s_mov_b32 s7, 0x20000
  s_mov_b32 s8, s44
  s_mov_b32 s9, s45
  s_mov_b32 s10, 100270464
  s_mov_b32 s11, 0x20000
  s_mov_b32 s12, s46
  s_mov_b32 s13, s47
  s_mov_b32 s14, 8388608
  s_mov_b32 s15, 0x20000
  s_mov_b32 s16, s40
  s_mov_b32 s17, s41
  s_mov_b32 s18, 221184
  s_mov_b32 s19, 0x20000
  s_mov_b32 s20, s42
  s_mov_b32 s21, s43
  s_mov_b32 s22, 73728
  s_mov_b32 s23, 0x20000
  s_mov_b32 s24, s38
  s_mov_b32 s25, s39
  s_mov_b32 s26, 3456
  s_mov_b32 s27, 0x20000
  s_mov_b64 s[48:49], 0x3f
  s_mov_b32 s50, 0
  s_mov_b32 s51, 0x3f0000
  s_mov_b32 s54, 0xffff
  s_mov_b32 s55, 0
  s_mov_b32 s56, -1
  s_mov_b32 s57, 0
  s_mul_i32 s58, s28, 7936
  s_add_u32 s58, s58, 131968
  s_add_u32 s59, s58, 4320
  s_mul_i32 s74, s28, 96
  s_mul_i32 s75, s2, 32768
  s_lshl_b32 s76, s28, 10
  s_add_u32 s75, s75, s76
  s_mov_b32 s77, 196224
  s_mov_b32 s78, 392448
L_restart:
  s_mov_b32 s31, 0
  v_mbcnt_lo_u32_b32 v250, -1, 0
  v_mbcnt_hi_u32_b32 v250, -1, v250
  v_lshrrev_b32 v251, 4, v250
  v_and_b32 v252, 15, v250
  v_mul_u32_u24 v246, 43, v250
  v_lshrrev_b32 v246, 8, v246
  v_mul_u32_u24 v247, 6, v246
  v_sub_u32 v247, v250, v247
  v_mul_u32_u24 v246, 384, v246
  v_lshl_add_u32 v246, v247, 4, v246
  v_add_u32 v246, s74, v246
  v_cmp_gt_u32 vcc, 54, v250
  s_nop 1
  v_cndmask_b32 v21, 2.0, v246, vcc
  v_and_b32 v246, 3, v250
  v_mul_u32_u24 v0, 0x5555, v246
  v_mov_b32 v1, 0
  v_mov_b32 v246, 0xf149f2ca
  v_cndmask_b32 v2, v246, 0, s[54:55]
  v_mov_b32 v109, 0
  v_mov_b32 v113, 0
  v_lshrrev_b32 v248, 1, v251
  v_and_b32 v249, 1, v251
  v_lshlrev_b32 v249, 4, v249
  v_mov_b32 v246, 0x03020100
  v_mov_b32 v247, 0x13121110
  v_cmp_le_u32 vcc, 4, v252
  s_nop 1
  v_cndmask_b32 v246, v246, v247, vcc
  v_mov_b32 v247, 0x26251514
  v_cmp_le_u32 vcc, 8, v252
  s_nop 1
  v_cndmask_b32 v246, v246, v247, vcc
  v_mov_b32 v247, 0x16060504
  v_cmp_le_u32 vcc, 12, v252
  s_nop 1
  v_cndmask_b32 v246, v246, v247, vcc
  v_and_b32 v247, 3, v252
  v_lshlrev_b32 v247, 3, v247
  v_bfe_u32 v246, v246, v247, 8
  v_lshrrev_b32 v247, 4, v246
  v_and_b32 v246, 15, v246
  v_mul_u32_u24 v12, 196224, v247
  v_mul_u32_u24 v9, 384, v246
  v_add_u32 v12, v12, v9
  v_lshl_add_u32 v12, v251, 3, v12
  v_add_u32 v12, s74, v12
  v_mul_u32_u24 v247, 9, v247
  v_add_u32 v246, v246, v247
  v_mul_u32_u24 v246, 96, v246
  v_add_u32 v246, s58, v246
  v_mul_u32_u24 v247, 96, v248
  v_add3_u32 v3, v246, v247, v249
  v_mul_u32_u24 v247, 864, v248
  v_add3_u32 v6, v246, v247, v249
  v_add_u32 v6, 192, v6
  v_lshl_add_u32 v9, v251, 3, v246
  v_add_u32 v9, 1920, v9
  v_mov_b32 v246, 0x23222120
  v_mov_b32 v247, 0x42323130
  v_cmp_le_u32 vcc, 4, v252
  s_nop 1
  v_cndmask_b32 v246, v246, v247, vcc
  v_mov_b32 v247, 0x46454443
  v_cmp_le_u32 vcc, 8, v252
  s_nop 1
  v_cndmask_b32 v246, v246, v247, vcc
  v_mov_b32 v247, 0x36353424
  v_cmp_le_u32 vcc, 12, v252
  s_nop 1
  v_cndmask_b32 v246, v246, v247, vcc
  v_and_b32 v247, 3, v252
  v_lshlrev_b32 v247, 3, v247
  v_bfe_u32 v246, v246, v247, 8
  v_lshrrev_b32 v247, 4, v246
  v_and_b32 v246, 15, v246
  v_mul_u32_u24 v13, 196224, v247
  v_mul_u32_u24 v10, 384, v246
  v_add_u32 v13, v13, v10
  v_lshl_add_u32 v13, v251, 3, v13
  v_add_u32 v13, s74, v13
  v_mul_u32_u24 v247, 9, v247
  v_add_u32 v246, v246, v247
  v_mul_u32_u24 v246, 96, v246
  v_add_u32 v246, s58, v246
  v_mul_u32_u24 v247, 96, v248
  v_add3_u32 v4, v246, v247, v249
  v_mul_u32_u24 v247, 864, v248
  v_add3_u32 v7, v246, v247, v249
  v_add_u32 v7, 192, v7
  v_lshl_add_u32 v10, v251, 3, v246
  v_add_u32 v10, 1920, v10
  v_mov_b32 v246, 0x52514140
  v_mov_b32 v247, 0x62616050
  v_cmp_le_u32 vcc, 4, v252
  s_nop 1
  v_cndmask_b32 v246, v246, v247, vcc
  v_mov_b32 v247, 0x66656463
  v_cmp_le_u32 vcc, 8, v252
  s_nop 1
  v_cndmask_b32 v246, v246, v247, vcc
  v_mov_b32 v247, 0x56555453
  v_cmp_le_u32 vcc, 12, v252
  s_nop 1
  v_cndmask_b32 v246, v246, v247, vcc
  v_and_b32 v247, 3, v252
  v_lshlrev_b32 v247, 3, v247
  v_bfe_u32 v246, v246, v247, 8
  v_lshrrev_b32 v247, 4, v246
  v_and_b32 v246, 15, v246
  v_mul_u32_u24 v14, 196224, v247
  v_mul_u32_u24 v11, 384, v246
  v_add_u32 v14, v14, v11
  v_lshl_add_u32 v14, v251, 3, v14
  v_add_u32 v14, s74, v14
  v_mul_u32_u24 v247, 9, v247
  v_add_u32 v246, v246, v247
  v_mul_u32_u24 v246, 96, v246
  v_add_u32 v246, s58, v246
  v_mul_u32_u24 v247, 96, v248
  v_add3_u32 v5, v246, v247, v249
  v_mul_u32_u24 v247, 864, v248
  v_add3_u32 v8, v246, v247, v249
  v_add_u32 v8, 192, v8
  v_lshl_add_u32 v11, v251, 3, v246
  v_add_u32 v11, 1920, v11
  v_lshlrev_b32 v15, 4, v250
  v_add_u32 v16, s76, v15
  s_lshr_b32 s60, s28, 1
  s_add_u32 s60, s60, 4
  s_lshl_b32 s60, s60, 10
  s_and_b32 s61, s28, 1
  s_lshl_b32 s61, s61, 3
  s_add_u32 s60, s60, s61
  v_add_u32 v17, s60, v15
  s_mul_i32 s60, s28, 17408
  s_add_u32 s60, s60, 62336
  v_add_u32 v18, s60, v15
  s_add_u32 s60, s74, 38144
  v_mul_u32_u24 v246, 24, v251
  v_add_u32 v19, s60, v246
  v_min_u32 v246, 2, v251
  v_lshl_add_u32 v246, v246, 4, v252
  s_add_u32 s60, s60, 384
  v_lshl_add_u32 v20, v246, 1, s60
  v_add_u32 v246, v249, v252
  v_lshlrev_b32 v247, 10, v248
  v_lshl_add_u32 v97, v246, 4, v247
  s_lshl_b32 s60, s28, 2
  v_add_u32 v97, s60, v97
  v_lshl_add_u32 v101, v246, 3, v247
  v_add_u32 v101, 768, v101
  v_lshlrev_b32 v105, 3, v252
  v_mov_b32 v246, 0x3f803f80
  v_accvgpr_write_b32 a246, v246
  v_accvgpr_write_b32 a247, v246
  v_accvgpr_write_b32 a248, v246
  v_accvgpr_write_b32 a249, v246
  s_mov_b32 s79, 0x4310
  s_mov_b32 s80, 0x5276
  v_add_u32 v246, 0, v252
  v_lshlrev_b32 v246, 5, v246
  v_add_u32 v247, s30, v246
  v_cmp_gt_u32 s[60:61], s72, v247
  v_add_u32 v246, s29, v246
  v_cmp_gt_u32 s[62:63], s73, v246
  s_nop 1
  s_and_b64 s[60:61], s[60:61], s[62:63]
  v_mul_u32_u24 v247, 7183, v246
  v_lshrrev_b32 v247, 22, v247
  v_mul_u32_u24 v248, 584, v247
  v_sub_u32 v248, v246, v248
  v_cmp_le_u32 vcc, 5256, v246
  v_and_b32 v245, 7, v248
  v_lshl_add_u32 v247, v247, 3, v245
  v_mov_b32 v245, 72
  v_cndmask_b32 v247, v247, v245, vcc
  v_lshrrev_b32 v245, 3, v248
  v_cndmask_b32 v248, v245, v248, vcc
  v_mul_u32_u24 v247, 1373568, v247
  v_mul_u32_u24 v248, 2688, v248
  v_add_u32 v245, v247, v248
  v_cndmask_b32 v245, 2.0, v245, s[60:61]
  v_add_u32 v245, s74, v245
  v_lshrrev_b32 v248, 1, v251
  v_mul_u32_u24 v246, 384, v248
  v_add3_u32 v226, v245, v246, v249
  v_add_u32 v226, 589824, v226
  v_mul_u32_u24 v246, 196224, v248
  v_add3_u32 v227, v245, v246, v249
  v_add_u32 v227, 590592, v227
  v_lshl_add_u32 v228, v251, 3, v245
  v_add_u32 v228, 983040, v228
  v_add_u32 v246, 16, v252
  v_lshlrev_b32 v246, 5, v246
  v_add_u32 v247, s30, v246
  v_cmp_gt_u32 s[60:61], s72, v247
  v_add_u32 v246, s29, v246
  v_cmp_gt_u32 s[62:63], s73, v246
  s_nop 1
  s_and_b64 s[60:61], s[60:61], s[62:63]
  v_mul_u32_u24 v247, 7183, v246
  v_lshrrev_b32 v247, 22, v247
  v_mul_u32_u24 v248, 584, v247
  v_sub_u32 v248, v246, v248
  v_cmp_le_u32 vcc, 5256, v246
  v_and_b32 v245, 7, v248
  v_lshl_add_u32 v247, v247, 3, v245
  v_mov_b32 v245, 72
  v_cndmask_b32 v247, v247, v245, vcc
  v_lshrrev_b32 v245, 3, v248
  v_cndmask_b32 v248, v245, v248, vcc
  v_mul_u32_u24 v247, 1373568, v247
  v_mul_u32_u24 v248, 2688, v248
  v_add_u32 v245, v247, v248
  v_cndmask_b32 v245, 2.0, v245, s[60:61]
  v_add_u32 v245, s74, v245
  v_lshrrev_b32 v248, 1, v251
  v_mul_u32_u24 v246, 384, v248
  v_add3_u32 v229, v245, v246, v249
  v_add_u32 v229, 589824, v229
  v_mul_u32_u24 v246, 196224, v248
  v_add3_u32 v230, v245, v246, v249
  v_add_u32 v230, 590592, v230
  v_lshl_add_u32 v231, v251, 3, v245
  v_add_u32 v231, 983040, v231
  v_lshl_add_u32 v246, v252, 1, s74
  v_lshlrev_b32 v247, 2, v251
  v_lshrrev_b32 v248, v247, s79
  v_and_b32 v248, 15, v248
  v_mul_u32_u24 v248, 384, v248
  v_add_u32 v232, v246, v248
  v_lshrrev_b32 v248, v247, s80
  v_and_b32 v248, 15, v248
  v_mul_u32_u24 v248, 384, v248
  v_add_u32 v233, v246, v248
  v_add_u32 v234, 3072, v246
  v_add_u32 v246, 0, v250
  v_mul_u32_u24 v247, 171, v246
  v_lshrrev_b32 v247, 10, v247
  v_mul_u32_u24 v248, 6, v247
  v_sub_u32 v248, v246, v248
  v_lshl_add_u32 v248, v248, 4, s74
  v_mul_u32_u24 v246, 1152, v247
  v_add_u32 v235, v246, v248
  v_mul_u32_u24 v246, 384, v247
  v_add_u32 v238, v246, v248
  v_add_u32 v246, 64, v250
  v_mul_u32_u24 v247, 171, v246
  v_lshrrev_b32 v247, 10, v247
  v_mul_u32_u24 v248, 6, v247
  v_sub_u32 v248, v246, v248
  v_lshl_add_u32 v248, v248, 4, s74
  v_mul_u32_u24 v246, 1152, v247
  v_add_u32 v236, v246, v248
  v_mul_u32_u24 v246, 384, v247
  v_add_u32 v239, v246, v248
  v_add_u32 v246, 128, v250
  v_mul_u32_u24 v247, 171, v246
  v_lshrrev_b32 v247, 10, v247
  v_mul_u32_u24 v248, 6, v247
  v_sub_u32 v248, v246, v248
  v_lshl_add_u32 v248, v248, 4, s74
  v_mul_u32_u24 v246, 1152, v247
  v_add_u32 v237, v246, v248
  v_mul_u32_u24 v246, 384, v247
  v_add_u32 v240, v246, v248
  v_lshrrev_b32 v246, 2, v250
  v_mul_u32_u24 v246, 96, v246
  v_and_b32 v247, 3, v250
  v_lshl_add_u32 v246, v247, 3, v246
  s_mul_i32 s81, s28, 9216
  s_add_u32 s81, s81, 20480
  v_add_u32 v241, s81, v246
  v_mul_u32_u24 v246, 1152, v252
  v_add_u32 v242, v19, v246
  v_lshl_add_u32 v246, v251, 3, v246
  s_add_u32 s60, s74, 38528
  v_add_u32 v243, s60, v246
  v_add_u32 v244, s75, v15
  v_lshrrev_b32 v246, 2, v252
  v_cmp_eq_u32 s[82:83], 0, v246
  v_cmp_eq_u32 s[84:85], 1, v246
  v_cmp_eq_u32 s[86:87], 2, v246
  v_cmp_eq_u32 s[88:89], 3, v246
  v_cmp_eq_u32 s[90:91], 3, v251
  v_cmp_eq_u32 s[92:93], v246, v251
  v_cmp_gt_u32 s[94:95], 5, v252
  v_and_b32 v246, 2, v252
  v_cmp_eq_u32 s[96:97], 0, v246
  v_and_b32 v245, 1, v252
  v_lshlrev_b32 v245, 4, v245
  buffer_load_ushort v96, v232, s[24:27], 0 offen
  buffer_load_ushort v100, v232, s[24:27], 0 offen offset:32
  buffer_load_ushort v104, v232, s[24:27], 0 offen offset:64
  buffer_load_ushort v108, v233, s[24:27], 0 offen
  buffer_load_ushort v112, v233, s[24:27], 0 offen offset:32
  buffer_load_ushort v114, v233, s[24:27], 0 offen offset:64
  buffer_load_ushort v115, v234, s[24:27], 0 offen
  buffer_load_ushort v204, v234, s[24:27], 0 offen offset:32
  buffer_load_ushort v205, v234, s[24:27], 0 offen offset:64
  buffer_load_dwordx2 v[232:233], v228, s[4:7], 0 offen
  buffer_load_dwordx4 v[116:119], v226, s[4:7], 0 offen
  buffer_load_dwordx4 v[120:123], v226, s[4:7], s77 offen
  buffer_load_dwordx4 v[124:127], v226, s[4:7], s78 offen
  buffer_load_dwordx4 v[128:131], v227, s[4:7], 0 offen
  buffer_load_dwordx2 v[94:95], v228, s[4:7], 0 offen offset:32
  buffer_load_dwordx4 v[132:135], v226, s[4:7], 0 offen offset:32
  buffer_load_dwordx4 v[136:139], v226, s[4:7], s77 offen offset:32
  buffer_load_dwordx4 v[140:143], v226, s[4:7], s78 offen offset:32
  buffer_load_dwordx4 v[144:147], v227, s[4:7], 0 offen offset:32
  buffer_load_dwordx2 v[98:99], v228, s[4:7], 0 offen offset:64
  buffer_load_dwordx4 v[148:151], v226, s[4:7], 0 offen offset:64
  buffer_load_dwordx4 v[152:155], v226, s[4:7], s77 offen offset:64
  buffer_load_dwordx4 v[156:159], v226, s[4:7], s78 offen offset:64
  buffer_load_dwordx4 v[160:163], v227, s[4:7], 0 offen offset:64
  buffer_load_dwordx2 v[102:103], v231, s[4:7], 0 offen
  buffer_load_dwordx4 v[220:223], v229, s[4:7], 0 offen
  buffer_load_dwordx4 v[224:227], v229, s[4:7], s77 offen
  buffer_load_dwordx4 v[164:167], v229, s[4:7], s78 offen
  buffer_load_dwordx4 v[168:171], v230, s[4:7], 0 offen
  buffer_load_dwordx2 v[106:107], v231, s[4:7], 0 offen offset:32
  buffer_load_dwordx4 v[172:175], v229, s[4:7], 0 offen offset:32
  buffer_load_dwordx4 v[176:179], v229, s[4:7], s77 offen offset:32
  buffer_load_dwordx4 v[180:183], v229, s[4:7], s78 offen offset:32
  buffer_load_dwordx4 v[184:187], v230, s[4:7], 0 offen offset:32
  buffer_load_dwordx2 v[110:111], v231, s[4:7], 0 offen offset:64
  buffer_load_dwordx4 v[188:191], v229, s[4:7], 0 offen offset:64
  buffer_load_dwordx4 v[192:195], v229, s[4:7], s77 offen offset:64
  buffer_load_dwordx4 v[196:199], v229, s[4:7], s78 offen offset:64
  buffer_load_dwordx4 v[200:203], v230, s[4:7], 0 offen offset:64
  s_lshl_b32 s60, s31, 5
  s_add_u32 s61, s60, s30
  s_add_u32 s60, s60, s29
  s_mul_i32 s62, s60, 7183
  s_lshr_b32 s62, s62, 22
  s_mul_i32 s63, s62, 584
  s_sub_u32 s63, s60, s63
  s_lshr_b32 s64, s63, 3
  s_and_b32 s65, s63, 7
  s_lshl_b32 s66, s62, 3
  s_add_u32 s65, s65, s66
  s_cmp_ge_u32 s60, 5256
  s_cselect_b32 s64, s63, s64
  s_cselect_b32 s65, 72, s65
  s_mul_i32 s66, s65, 1373568
  s_mul_i32 s67, s64, 2688
  s_add_u32 s35, s66, s67
  s_cmp_ge_u32 s61, 667
  s_cselect_b32 s35, 268435456, s35
  s_cmp_ge_u32 s60, 5329
  s_cselect_b32 s35, 268435456, s35
  s_cmp_eq_u32 s65, 0
  s_cselect_b32 s36, 268435456, s35
  s_add_u32 s37, s35, 195360
  s_add_u32 s38, s35, 390720
  s_add_u32 s39, s35, 586080
  s_add_u32 s40, s35, 781440
  s_add_u32 s41, s35, 981120
  s_add_u32 s42, s35, 1176480
  s_add_u32 s43, s35, 1371840
  s_add_u32 s44, s35, 1567200
  s_cmp_eq_u32 s64, 0
  s_cselect_b64 s[52:53], s[48:49], 0
  s_cmp_eq_u32 s64, 72
  s_cselect_b64 s[52:53], s[50:51], s[52:53]
  s_add_u32 s31, s31, 1
  v_cndmask_b32 v230, v21, 2.0, s[52:53]
  s_mov_b32 m0, s58
  s_nop 0
  buffer_load_dwordx4 v230, s[4:7], s36 offen lds
  buffer_load_dwordx4 v230, s[4:7], s37 offen offset:864 lds
  buffer_load_dwordx4 v230, s[4:7], s38 offen offset:1728 lds
  buffer_load_dwordx4 v230, s[4:7], s39 offen offset:2592 lds
  buffer_load_dwordx4 v230, s[4:7], s40 offen offset:3456 lds
  s_mov_b32 m0, s59
  s_nop 0
  buffer_load_dwordx4 v230, s[4:7], s41 offen lds
  buffer_load_dwordx4 v230, s[4:7], s42 offen offset:864 lds
  buffer_load_dwordx4 v230, s[4:7], s43 offen offset:1728 lds
  buffer_load_dwordx4 v230, s[4:7], s44 offen offset:2592 lds
  s_mov_b32 s32, s33
  s_mov_b32 s33, s34
  s_mov_b32 s34, s35
  v_add_u32 v230, 36864, v241
  v_add_u32 v214, 73728, v241
  s_mov_b32 s98, 0
  s_add_u32 m0, s81, 0
  s_nop 0
  buffer_load_dwordx4 v235, s[16:19], s98 offen lds
  s_add_u32 m0, s81, 1024
  s_nop 0
  buffer_load_dwordx4 v236, s[16:19], s98 offen lds
  s_add_u32 m0, s81, 2048
  s_nop 0
  buffer_load_dwordx4 v237, s[16:19], s98 offen lds
  s_mov_b32 s98, 36864
  s_add_u32 m0, s81, 3072
  s_nop 0
  buffer_load_dwordx4 v235, s[16:19], s98 offen lds
  s_add_u32 m0, s81, 4096
  s_nop 0
  buffer_load_dwordx4 v236, s[16:19], s98 offen lds
  s_add_u32 m0, s81, 5120
  s_nop 0
  buffer_load_dwordx4 v237, s[16:19], s98 offen lds
  s_mov_b32 s98, 73728
  s_add_u32 m0, s81, 6144
  s_nop 0
  buffer_load_dwordx4 v235, s[16:19], s98 offen lds
  s_add_u32 m0, s81, 7168
  s_nop 0
  buffer_load_dwordx4 v236, s[16:19], s98 offen lds
  s_add_u32 m0, s81, 8192
  s_nop 0
  buffer_load_dwordx4 v237, s[16:19], s98 offen lds
  v_cndmask_b32 v229, 0, 1.0, s[90:91]
  s_waitcnt vmcnt(56)
  v_or_b32 v96, v96, v229
  v_cndmask_b32 v229, 0, v96, s[82:83]
  v_accvgpr_write_b32 a216, v229
  v_cndmask_b32 v229, 0, v96, s[84:85]
  v_accvgpr_write_b32 a217, v229
  v_cndmask_b32 v229, 0, v96, s[86:87]
  v_accvgpr_write_b32 a218, v229
  v_cndmask_b32 v229, 0, v96, s[88:89]
  v_accvgpr_write_b32 a219, v229
  s_waitcnt vmcnt(53)
  v_cndmask_b32 v229, 0, v108, s[82:83]
  v_accvgpr_write_b32 a220, v229
  v_cndmask_b32 v229, 0, v108, s[84:85]
  v_accvgpr_write_b32 a221, v229
  v_cndmask_b32 v229, 0, v108, s[86:87]
  v_accvgpr_write_b32 a222, v229
  v_cndmask_b32 v229, 0, v108, s[88:89]
  v_accvgpr_write_b32 a223, v229
  s_waitcnt vmcnt(50)
  v_lshlrev_b32 v115, v245, v115
  v_cndmask_b32 v115, 0, v115, s[92:93]
  v_cndmask_b32 v229, 0, v115, s[96:97]
  v_accvgpr_write_b32 a224, v229
  v_cndmask_b32 v229, v115, 0, s[96:97]
  v_accvgpr_write_b32 a225, v229
  v_cndmask_b32 v229, 0, 1.0, s[90:91]
  v_or_b32 v100, v100, v229
  v_cndmask_b32 v229, 0, v100, s[82:83]
  v_accvgpr_write_b32 a226, v229
  v_cndmask_b32 v229, 0, v100, s[84:85]
  v_accvgpr_write_b32 a227, v229
  v_cndmask_b32 v229, 0, v100, s[86:87]
  v_accvgpr_write_b32 a228, v229
  v_cndmask_b32 v229, 0, v100, s[88:89]
  v_accvgpr_write_b32 a229, v229
  v_cndmask_b32 v229, 0, v112, s[82:83]
  v_accvgpr_write_b32 a230, v229
  v_cndmask_b32 v229, 0, v112, s[84:85]
  v_accvgpr_write_b32 a231, v229
  v_cndmask_b32 v229, 0, v112, s[86:87]
  v_accvgpr_write_b32 a232, v229
  v_cndmask_b32 v229, 0, v112, s[88:89]
  v_accvgpr_write_b32 a233, v229
  s_waitcnt vmcnt(49)
  v_lshlrev_b32 v204, v245, v204
  v_cndmask_b32 v204, 0, v204, s[92:93]
  v_cndmask_b32 v229, 0, v204, s[96:97]
  v_accvgpr_write_b32 a234, v229
  v_cndmask_b32 v229, v204, 0, s[96:97]
  v_accvgpr_write_b32 a235, v229
  v_cndmask_b32 v229, 0, 1.0, s[90:91]
  v_or_b32 v104, v104, v229
  v_cndmask_b32 v229, 0, v104, s[82:83]
  v_accvgpr_write_b32 a236, v229
  v_cndmask_b32 v229, 0, v104, s[84:85]
  v_accvgpr_write_b32 a237, v229
  v_cndmask_b32 v229, 0, v104, s[86:87]
  v_accvgpr_write_b32 a238, v229
  v_cndmask_b32 v229, 0, v104, s[88:89]
  v_accvgpr_write_b32 a239, v229
  v_cndmask_b32 v229, 0, v114, s[82:83]
  v_accvgpr_write_b32 a240, v229
  v_cndmask_b32 v229, 0, v114, s[84:85]
  v_accvgpr_write_b32 a241, v229
  v_cndmask_b32 v229, 0, v114, s[86:87]
  v_accvgpr_write_b32 a242, v229
  v_cndmask_b32 v229, 0, v114, s[88:89]
  v_accvgpr_write_b32 a243, v229
  s_waitcnt vmcnt(48)
  v_lshlrev_b32 v205, v245, v205
  v_cndmask_b32 v205, 0, v205, s[92:93]
  v_cndmask_b32 v229, 0, v205, s[96:97]
  v_accvgpr_write_b32 a244, v229
  v_cndmask_b32 v229, v205, 0, s[96:97]
  v_accvgpr_write_b32 a245, v229
  s_mov_b32 s98, 110592
  s_add_u32 m0, s81, 36864
  s_nop 0
  buffer_load_dwordx4 v235, s[16:19], s98 offen lds
  s_add_u32 m0, s81, 37888
  s_nop 0
  buffer_load_dwordx4 v236, s[16:19], s98 offen lds
  s_add_u32 m0, s81, 38912
  s_nop 0
  buffer_load_dwordx4 v237, s[16:19], s98 offen lds
  s_mov_b32 s98, 147456
  s_add_u32 m0, s81, 39936
  s_nop 0
  buffer_load_dwordx4 v235, s[16:19], s98 offen lds
  s_add_u32 m0, s81, 40960
  s_nop 0
  buffer_load_dwordx4 v236, s[16:19], s98 offen lds
  s_add_u32 m0, s81, 41984
  s_nop 0
  buffer_load_dwordx4 v237, s[16:19], s98 offen lds
  s_mov_b32 s98, 184320
  s_add_u32 m0, s81, 43008
  s_nop 0
  buffer_load_dwordx4 v235, s[16:19], s98 offen lds
  s_add_u32 m0, s81, 44032
  s_nop 0
  buffer_load_dwordx4 v236, s[16:19], s98 offen lds
  s_add_u32 m0, s81, 45056
  s_nop 0
  buffer_load_dwordx4 v237, s[16:19], s98 offen lds
  s_waitcnt vmcnt(56)
  v_mfma_f32_16x16x16_bf16 v[58:61], a[224:225], v[232:233], 0
  s_waitcnt vmcnt(54)
  s_nop 2
  s_nop 1
  v_smfmac_f32_16x16x64_bf16 v[58:61], a[216:219], v[116:123], v0
  s_waitcnt vmcnt(52)
  v_smfmac_f32_16x16x64_bf16 v[58:61], a[220:223], v[124:131], v0
  s_waitcnt vmcnt(51)
  v_mfma_f32_16x16x16_bf16 v[62:65], a[234:235], v[94:95], 0
  s_waitcnt vmcnt(49)
  s_nop 2
  s_nop 1
  v_smfmac_f32_16x16x64_bf16 v[62:65], a[226:229], v[132:139], v0
  s_waitcnt vmcnt(47)
  v_smfmac_f32_16x16x64_bf16 v[62:65], a[230:233], v[140:147], v0
  s_waitcnt vmcnt(46)
  v_mfma_f32_16x16x16_bf16 v[66:69], a[244:245], v[98:99], 0
  s_waitcnt vmcnt(44)
  s_nop 2
  s_nop 1
  v_smfmac_f32_16x16x64_bf16 v[66:69], a[236:239], v[148:155], v0
  s_waitcnt vmcnt(42)
  v_smfmac_f32_16x16x64_bf16 v[66:69], a[240:243], v[156:163], v0
  s_mov_b32 s98, 384
  s_add_u32 m0, s81, 73728
  s_nop 0
  buffer_load_dwordx4 v235, s[16:19], s98 offen lds
  s_add_u32 m0, s81, 74752
  s_nop 0
  buffer_load_dwordx4 v236, s[16:19], s98 offen lds
  s_add_u32 m0, s81, 75776
  s_nop 0
  buffer_load_dwordx4 v237, s[16:19], s98 offen lds
  s_mov_b32 s98, 37248
  s_add_u32 m0, s81, 76800
  s_nop 0
  buffer_load_dwordx4 v235, s[16:19], s98 offen lds
  s_add_u32 m0, s81, 77824
  s_nop 0
  buffer_load_dwordx4 v236, s[16:19], s98 offen lds
  s_add_u32 m0, s81, 78848
  s_nop 0
  buffer_load_dwordx4 v237, s[16:19], s98 offen lds
  s_mov_b32 s98, 74112
  s_add_u32 m0, s81, 79872
  s_nop 0
  buffer_load_dwordx4 v235, s[16:19], s98 offen lds
  s_add_u32 m0, s81, 80896
  s_nop 0
  buffer_load_dwordx4 v236, s[16:19], s98 offen lds
  s_add_u32 m0, s81, 81920
  s_nop 0
  buffer_load_dwordx4 v237, s[16:19], s98 offen lds
  s_waitcnt vmcnt(50)
  v_mfma_f32_16x16x16_bf16 v[70:73], a[224:225], v[102:103], 0
  s_waitcnt vmcnt(48)
  s_nop 2
  s_nop 1
  v_smfmac_f32_16x16x64_bf16 v[70:73], a[216:219], v[220:227], v0
  s_waitcnt vmcnt(46)
  v_smfmac_f32_16x16x64_bf16 v[70:73], a[220:223], v[164:171], v0
  s_waitcnt vmcnt(45)
  v_mfma_f32_16x16x16_bf16 v[74:77], a[234:235], v[106:107], 0
  s_waitcnt vmcnt(43)
  s_nop 2
  s_nop 1
  v_smfmac_f32_16x16x64_bf16 v[74:77], a[226:229], v[172:179], v0
  s_waitcnt vmcnt(41)
  v_smfmac_f32_16x16x64_bf16 v[74:77], a[230:233], v[180:187], v0
  s_waitcnt vmcnt(40)
  v_mfma_f32_16x16x16_bf16 v[78:81], a[244:245], v[110:111], 0
  s_waitcnt vmcnt(38)
  s_nop 2
  s_nop 1
  v_smfmac_f32_16x16x64_bf16 v[78:81], a[236:239], v[188:195], v0
  s_waitcnt vmcnt(36)
  v_smfmac_f32_16x16x64_bf16 v[78:81], a[240:243], v[196:203], v0
  v_add_f32 v196, v58, v59
  v_mul_f32 v197, v58, v58
  v_fmac_f32 v197, v59, v59
  v_add_f32 v196, v196, v60
  v_fmac_f32 v197, v60, v60
  v_add_f32 v196, v196, v61
  v_fmac_f32 v197, v61, v61
  v_add_f32 v196, v196, v62
  v_fmac_f32 v197, v62, v62
  v_add_f32 v196, v196, v63
  v_fmac_f32 v197, v63, v63
  v_add_f32 v196, v196, v64
  v_fmac_f32 v197, v64, v64
  v_add_f32 v196, v196, v65
  v_fmac_f32 v197, v65, v65
  v_add_f32 v196, v196, v66
  v_fmac_f32 v197, v66, v66
  v_add_f32 v196, v196, v67
  v_fmac_f32 v197, v67, v67
  v_add_f32 v196, v196, v68
  v_fmac_f32 v197, v68, v68
  v_add_f32 v196, v196, v69
  v_fmac_f32 v197, v69, v69
  s_nop 1
  v_permlane32_swap_b32 v196, v197
  v_add_f32 v196, v196, v197
  v_add_f32 v197, v70, v71
  v_mul_f32 v198, v70, v70
  v_fmac_f32 v198, v71, v71
  v_add_f32 v197, v197, v72
  v_fmac_f32 v198, v72, v72
  v_add_f32 v197, v197, v73
  v_fmac_f32 v198, v73, v73
  v_add_f32 v197, v197, v74
  v_fmac_f32 v198, v74, v74
  v_add_f32 v197, v197, v75
  v_fmac_f32 v198, v75, v75
  v_add_f32 v197, v197, v76
  v_fmac_f32 v198, v76, v76
  v_add_f32 v197, v197, v77
  v_fmac_f32 v198, v77, v77
  v_add_f32 v197, v197, v78
  v_fmac_f32 v198, v78, v78
  v_add_f32 v197, v197, v79
  v_fmac_f32 v198, v79, v79
  v_add_f32 v197, v197, v80
  v_fmac_f32 v198, v80, v80
  v_add_f32 v197, v197, v81
  v_fmac_f32 v198, v81, v81
  s_nop 1
  v_permlane32_swap_b32 v197, v198
  v_add_f32 v197, v197, v198
  s_nop 1
  v_permlane16_swap_b32 v196, v197
  v_add_f32 v196, v196, v197
  ds_write_b32 v97, v196
  s_mov_b32 s98, 0
  buffer_store_dwordx4 v[58:61], v244, s[12:15], s98 offen
  s_mov_b32 s98, 4096
  buffer_store_dwordx4 v[62:65], v244, s[12:15], s98 offen
  s_mov_b32 s98, 8192
  buffer_store_dwordx4 v[66:69], v244, s[12:15], s98 offen
  s_mov_b32 s98, 12288
  buffer_store_dwordx4 v[70:73], v244, s[12:15], s98 offen
  s_mov_b32 s98, 16384
  buffer_store_dwordx4 v[74:77], v244, s[12:15], s98 offen
  s_mov_b32 s98, 20480
  buffer_store_dwordx4 v[78:81], v244, s[12:15], s98 offen
  s_waitcnt lgkmcnt(0)
  s_barrier
  ds_read_b128 v[196:199], v15
  ds_read_b128 v[200:203], v15 offset:1024
  s_waitcnt lgkmcnt(1)
  v_add_f32 v196, v196, v197
  v_add_f32 v198, v198, v199
  v_add_f32 v196, v196, v198
  s_waitcnt lgkmcnt(0)
  v_add_f32 v200, v200, v201
  v_add_f32 v202, v202, v203
  v_add_f32 v200, v200, v202
  v_mul_f32 v197, 0x3baaaaab, v196
  v_fma_f32 v200, -v197, v196, v200
  v_max_f32 v200, 0, v200
  v_add_f32 v200, 0x3afba882, v200
  v_rsq_f32 v200, v200
  s_nop 0
  v_mul_f32 v200, 0x40ca568a, v200
  v_mul_f32 v201, -v197, v200
  ds_write_b64 v101, v[200:201]
  ds_read_b64 v[196:197], v105 offset:768
  s_waitcnt lgkmcnt(0)
  v_fma_f32 v200, v58, v196, v197
  v_fma_f32 v198, v59, v196, v197
  v_cvt_pk_bf16_f32 v200, v200, v198
  v_fma_f32 v201, v60, v196, v197
  v_fma_f32 v198, v61, v196, v197
  v_cvt_pk_bf16_f32 v201, v201, v198
  v_fma_f32 v202, v62, v196, v197
  v_fma_f32 v198, v63, v196, v197
  v_cvt_pk_bf16_f32 v202, v202, v198
  v_fma_f32 v203, v64, v196, v197
  v_fma_f32 v198, v65, v196, v197
  v_cvt_pk_bf16_f32 v203, v203, v198
  v_fma_f32 v198, v66, v196, v197
  v_fma_f32 v244, v67, v196, v197
  v_cvt_pk_bf16_f32 v198, v198, v244
  v_fma_f32 v199, v68, v196, v197
  v_fma_f32 v244, v69, v196, v197
  v_cvt_pk_bf16_f32 v199, v199, v244
  ds_write_b128 v16, v[200:203] offset:8192
  ds_write_b64 v17, v[198:199] offset:8192
  ds_read_b64 v[198:199], v105 offset:896
  s_waitcnt lgkmcnt(0)
  v_fma_f32 v200, v70, v198, v199
  v_fma_f32 v196, v71, v198, v199
  v_cvt_pk_bf16_f32 v200, v200, v196
  v_fma_f32 v201, v72, v198, v199
  v_fma_f32 v196, v73, v198, v199
  v_cvt_pk_bf16_f32 v201, v201, v196
  v_fma_f32 v202, v74, v198, v199
  v_fma_f32 v196, v75, v198, v199
  v_cvt_pk_bf16_f32 v202, v202, v196
  v_fma_f32 v203, v76, v198, v199
  v_fma_f32 v196, v77, v198, v199
  v_cvt_pk_bf16_f32 v203, v203, v196
  v_fma_f32 v196, v78, v198, v199
  v_fma_f32 v244, v79, v198, v199
  v_cvt_pk_bf16_f32 v196, v196, v244
  v_fma_f32 v197, v80, v198, v199
  v_fma_f32 v244, v81, v198, v199
  v_cvt_pk_bf16_f32 v197, v197, v244
  ds_write_b128 v16, v[200:203] offset:14336
  ds_write_b64 v17, v[196:197] offset:14336
  s_waitcnt vmcnt(33)
  ds_read_b64 v[244:245], v9
  ds_read_b128 v[196:199], v3
  ds_read_b128 v[200:203], v3 offset:864
  ds_read_b128 v[188:191], v3 offset:1728
  ds_read_b128 v[192:195], v6
  s_waitcnt lgkmcnt(4)
  v_mfma_f32_16x16x16_bf16 v[22:25], a[224:225], v[244:245], 0
  s_waitcnt lgkmcnt(2)
  s_nop 2
  s_nop 1
  v_smfmac_f32_16x16x64_bf16 v[22:25], a[216:219], v[196:203], v0
  s_waitcnt lgkmcnt(0)
  v_smfmac_f32_16x16x64_bf16 v[22:25], a[220:223], v[188:195], v0
  ds_read_b64 v[244:245], v9 offset:32
  ds_read_b128 v[188:191], v3 offset:32
  ds_read_b128 v[192:195], v3 offset:896
  ds_read_b128 v[196:199], v3 offset:1760
  ds_read_b128 v[200:203], v6 offset:32
  s_waitcnt lgkmcnt(4)
  v_mfma_f32_16x16x16_bf16 v[26:29], a[234:235], v[244:245], 0
  s_waitcnt lgkmcnt(2)
  s_nop 2
  s_nop 1
  v_smfmac_f32_16x16x64_bf16 v[26:29], a[226:229], v[188:195], v0
  s_waitcnt lgkmcnt(0)
  v_smfmac_f32_16x16x64_bf16 v[26:29], a[230:233], v[196:203], v0
  ds_read_b64 v[244:245], v9 offset:64
  ds_read_b128 v[196:199], v3 offset:64
  ds_read_b128 v[200:203], v3 offset:928
  ds_read_b128 v[188:191], v3 offset:1792
  ds_read_b128 v[192:195], v6 offset:64
  s_waitcnt lgkmcnt(4)
  v_mfma_f32_16x16x16_bf16 v[30:33], a[244:245], v[244:245], 0
  s_waitcnt lgkmcnt(2)
  s_nop 2
  s_nop 1
  v_smfmac_f32_16x16x64_bf16 v[30:33], a[236:239], v[196:203], v0
  s_waitcnt lgkmcnt(0)
  v_smfmac_f32_16x16x64_bf16 v[30:33], a[240:243], v[188:195], v0
  ds_read_b64 v[244:245], v10
  ds_read_b128 v[188:191], v4
  ds_read_b128 v[192:195], v4 offset:864
  ds_read_b128 v[196:199], v4 offset:1728
  ds_read_b128 v[200:203], v7
  s_waitcnt lgkmcnt(4)
  v_mfma_f32_16x16x16_bf16 v[34:37], a[224:225], v[244:245], 0
  s_waitcnt lgkmcnt(2)
  s_nop 2
  s_nop 1
  v_smfmac_f32_16x16x64_bf16 v[34:37], a[216:219], v[188:195], v0
  s_waitcnt lgkmcnt(0)
  v_smfmac_f32_16x16x64_bf16 v[34:37], a[220:223], v[196:203], v0
  ds_read_b64 v[244:245], v10 offset:32
  ds_read_b128 v[196:199], v4 offset:32
  ds_read_b128 v[200:203], v4 offset:896
  ds_read_b128 v[188:191], v4 offset:1760
  ds_read_b128 v[192:195], v7 offset:32
  s_waitcnt lgkmcnt(4)
  v_mfma_f32_16x16x16_bf16 v[38:41], a[234:235], v[244:245], 0
  s_waitcnt lgkmcnt(2)
  s_nop 2
  s_nop 1
  v_smfmac_f32_16x16x64_bf16 v[38:41], a[226:229], v[196:203], v0
  s_waitcnt lgkmcnt(0)
  v_smfmac_f32_16x16x64_bf16 v[38:41], a[230:233], v[188:195], v0
  ds_read_b64 v[244:245], v10 offset:64
  ds_read_b128 v[188:191], v4 offset:64
  ds_read_b128 v[192:195], v4 offset:928
  ds_read_b128 v[196:199], v4 offset:1792
  ds_read_b128 v[200:203], v7 offset:64
  s_waitcnt lgkmcnt(4)
  v_mfma_f32_16x16x16_bf16 v[42:45], a[244:245], v[244:245], 0
  s_waitcnt lgkmcnt(2)
  s_nop 2
  s_nop 1
  v_smfmac_f32_16x16x64_bf16 v[42:45], a[236:239], v[188:195], v0
  s_waitcnt lgkmcnt(0)
  v_smfmac_f32_16x16x64_bf16 v[42:45], a[240:243], v[196:203], v0
  ds_read_b64 v[244:245], v11
  ds_read_b128 v[196:199], v5
  ds_read_b128 v[200:203], v5 offset:864
  ds_read_b128 v[188:191], v5 offset:1728
  ds_read_b128 v[192:195], v8
  s_waitcnt lgkmcnt(4)
  v_mfma_f32_16x16x16_bf16 v[46:49], a[224:225], v[244:245], 0
  s_waitcnt lgkmcnt(2)
  s_nop 2
  s_nop 1
  v_smfmac_f32_16x16x64_bf16 v[46:49], a[216:219], v[196:203], v0
  s_waitcnt lgkmcnt(0)
  v_smfmac_f32_16x16x64_bf16 v[46:49], a[220:223], v[188:195], v0
  ds_read_b64 v[244:245], v11 offset:32
  ds_read_b128 v[188:191], v5 offset:32
  ds_read_b128 v[192:195], v5 offset:896
  ds_read_b128 v[196:199], v5 offset:1760
  ds_read_b128 v[200:203], v8 offset:32
  s_waitcnt lgkmcnt(4)
  v_mfma_f32_16x16x16_bf16 v[50:53], a[234:235], v[244:245], 0
  s_waitcnt lgkmcnt(2)
  s_nop 2
  s_nop 1
  v_smfmac_f32_16x16x64_bf16 v[50:53], a[226:229], v[188:195], v0
  s_waitcnt lgkmcnt(0)
  v_smfmac_f32_16x16x64_bf16 v[50:53], a[230:233], v[196:203], v0
  ds_read_b64 v[244:245], v11 offset:64
  ds_read_b128 v[196:199], v5 offset:64
  ds_read_b128 v[200:203], v5 offset:928
  ds_read_b128 v[188:191], v5 offset:1792
  ds_read_b128 v[192:195], v8 offset:64
  s_waitcnt lgkmcnt(4)
  v_mfma_f32_16x16x16_bf16 v[54:57], a[244:245], v[244:245], 0
  s_waitcnt lgkmcnt(2)
  s_nop 2
  s_nop 1
  v_smfmac_f32_16x16x64_bf16 v[54:57], a[236:239], v[196:203], v0
  s_waitcnt lgkmcnt(0)
  v_smfmac_f32_16x16x64_bf16 v[54:57], a[240:243], v[188:195], v0
  s_lshl_b32 s60, s31, 5
  s_add_u32 s61, s60, s30
  s_add_u32 s60, s60, s29
  s_mul_i32 s62, s60, 7183
  s_lshr_b32 s62, s62, 22
  s_mul_i32 s63, s62, 584
  s_sub_u32 s63, s60, s63
  s_lshr_b32 s64, s63, 3
  s_and_b32 s65, s63, 7
  s_lshl_b32 s66, s62, 3
  s_add_u32 s65, s65, s66
  s_cmp_ge_u32 s60, 5256
  s_cselect_b32 s64, s63, s64
  s_cselect_b32 s65, 72, s65
  s_mul_i32 s66, s65, 1373568
  s_mul_i32 s67, s64, 2688
  s_add_u32 s35, s66, s67
  s_cmp_ge_u32 s61, 667
  s_cselect_b32 s35, 268435456, s35
  s_cmp_ge_u32 s60, 5329
  s_cselect_b32 s35, 268435456, s35
  s_cmp_eq_u32 s65, 0
  s_cselect_b32 s36, 268435456, s35
  s_add_u32 s37, s35, 195360
  s_add_u32 s38, s35, 390720
  s_add_u32 s39, s35, 586080
  s_add_u32 s40, s35, 781440
  s_add_u32 s41, s35, 981120
  s_add_u32 s42, s35, 1176480
  s_add_u32 s43, s35, 1371840
  s_add_u32 s44, s35, 1567200
  s_cmp_eq_u32 s64, 0
  s_cselect_b64 s[52:53], s[48:49], 0
  s_cmp_eq_u32 s64, 72
  s_cselect_b64 s[52:53], s[50:51], s[52:53]
  s_add_u32 s31, s31, 1
  v_cndmask_b32 v188, v21, 2.0, s[52:53]
  s_mov_b32 m0, s58
  s_nop 0
  buffer_load_dwordx4 v188, s[4:7], s36 offen lds
  buffer_load_dwordx4 v188, s[4:7], s37 offen offset:864 lds
  buffer_load_dwordx4 v188, s[4:7], s38 offen offset:1728 lds
  buffer_load_dwordx4 v188, s[4:7], s39 offen offset:2592 lds
  buffer_load_dwordx4 v188, s[4:7], s40 offen offset:3456 lds
  s_mov_b32 m0, s59
  s_nop 0
  buffer_load_dwordx4 v188, s[4:7], s41 offen lds
  buffer_load_dwordx4 v188, s[4:7], s42 offen offset:864 lds
  buffer_load_dwordx4 v188, s[4:7], s43 offen offset:1728 lds
  buffer_load_dwordx4 v188, s[4:7], s44 offen offset:2592 lds
  s_mov_b32 s32, s33
  s_mov_b32 s33, s34
  s_mov_b32 s34, s35
  s_waitcnt vmcnt(33)
  ds_read_b64_tr_b16 a[0:1], v241
  ds_read_b64_tr_b16 a[24:25], v241 offset:32
  ds_read_b64_tr_b16 a[48:49], v241 offset:64
  ds_read_b64_tr_b16 a[2:3], v241 offset:1536
  ds_read_b64_tr_b16 a[26:27], v241 offset:1568
  ds_read_b64_tr_b16 a[50:51], v241 offset:1600
  ds_read_b64_tr_b16 a[16:17], v241 offset:3072
  ds_read_b64_tr_b16 a[40:41], v241 offset:3104
  ds_read_b64_tr_b16 a[64:65], v241 offset:3136
  ds_read_b64_tr_b16 a[4:5], v241 offset:4608
  ds_read_b64_tr_b16 a[28:29], v241 offset:4640
  ds_read_b64_tr_b16 a[52:53], v241 offset:4672
  ds_read_b64_tr_b16 a[6:7], v241 offset:6144
  ds_read_b64_tr_b16 a[30:31], v241 offset:6176
  ds_read_b64_tr_b16 a[54:55], v241 offset:6208
  ds_read_b64_tr_b16 a[18:19], v241 offset:7680
  ds_read_b64_tr_b16 a[42:43], v241 offset:7712
  ds_read_b64_tr_b16 a[66:67], v241 offset:7744
  s_mov_b32 s98, 110976
  s_add_u32 m0, s81, 0
  s_waitcnt lgkmcnt(0)
  buffer_load_dwordx4 v235, s[16:19], s98 offen lds
  s_add_u32 m0, s81, 1024
  s_nop 0
  buffer_load_dwordx4 v236, s[16:19], s98 offen lds
  s_add_u32 m0, s81, 2048
  s_nop 0
  buffer_load_dwordx4 v237, s[16:19], s98 offen lds
  s_mov_b32 s98, 147840
  s_add_u32 m0, s81, 3072
  s_nop 0
  buffer_load_dwordx4 v235, s[16:19], s98 offen lds
  s_add_u32 m0, s81, 4096
  s_nop 0
  buffer_load_dwordx4 v236, s[16:19], s98 offen lds
  s_add_u32 m0, s81, 5120
  s_nop 0
  buffer_load_dwordx4 v237, s[16:19], s98 offen lds
  s_mov_b32 s98, 184704
  s_add_u32 m0, s81, 6144
  s_nop 0
  buffer_load_dwordx4 v235, s[16:19], s98 offen lds
  s_add_u32 m0, s81, 7168
  s_nop 0
  buffer_load_dwordx4 v236, s[16:19], s98 offen lds
  s_add_u32 m0, s81, 8192
  s_nop 0
  buffer_load_dwordx4 v237, s[16:19], s98 offen lds
  s_barrier
  v_add_f32 v188, v22, v23
  v_mul_f32 v189, v22, v22
  v_fmac_f32 v189, v23, v23
  v_add_f32 v188, v188, v24
  v_fmac_f32 v189, v24, v24
  v_add_f32 v188, v188, v25
  v_fmac_f32 v189, v25, v25
  v_add_f32 v188, v188, v26
  v_fmac_f32 v189, v26, v26
  v_add_f32 v188, v188, v27
  v_fmac_f32 v189, v27, v27
  v_add_f32 v188, v188, v28
  v_fmac_f32 v189, v28, v28
  v_add_f32 v188, v188, v29
  v_fmac_f32 v189, v29, v29
  v_add_f32 v188, v188, v30
  v_fmac_f32 v189, v30, v30
  v_add_f32 v188, v188, v31
  v_fmac_f32 v189, v31, v31
  v_add_f32 v188, v188, v32
  v_fmac_f32 v189, v32, v32
  v_add_f32 v188, v188, v33
  v_fmac_f32 v189, v33, v33
  s_nop 1
  v_permlane32_swap_b32 v188, v189
  v_add_f32 v188, v188, v189
  v_add_f32 v189, v34, v35
  v_mul_f32 v116, v34, v34
  v_fmac_f32 v116, v35, v35
  v_add_f32 v189, v189, v36
  v_fmac_f32 v116, v36, v36
  v_add_f32 v189, v189, v37
  v_fmac_f32 v116, v37, v37
  v_add_f32 v189, v189, v38
  v_fmac_f32 v116, v38, v38
  v_add_f32 v189, v189, v39
  v_fmac_f32 v116, v39, v39
  v_add_f32 v189, v189, v40
  v_fmac_f32 v116, v40, v40
  v_add_f32 v189, v189, v41
  v_fmac_f32 v116, v41, v41
  v_add_f32 v189, v189, v42
  v_fmac_f32 v116, v42, v42
  v_add_f32 v189, v189, v43
  v_fmac_f32 v116, v43, v43
  v_add_f32 v189, v189, v44
  v_fmac_f32 v116, v44, v44
  v_add_f32 v189, v189, v45
  v_fmac_f32 v116, v45, v45
  s_nop 1
  v_permlane32_swap_b32 v189, v116
  v_add_f32 v189, v189, v116
  v_add_f32 v116, v46, v47
  v_mul_f32 v117, v46, v46
  v_fmac_f32 v117, v47, v47
  v_add_f32 v116, v116, v48
  v_fmac_f32 v117, v48, v48
  v_add_f32 v116, v116, v49
  v_fmac_f32 v117, v49, v49
  v_add_f32 v116, v116, v50
  v_fmac_f32 v117, v50, v50
  v_add_f32 v116, v116, v51
  v_fmac_f32 v117, v51, v51
  v_add_f32 v116, v116, v52
  v_fmac_f32 v117, v52, v52
  v_add_f32 v116, v116, v53
  v_fmac_f32 v117, v53, v53
  v_add_f32 v116, v116, v54
  v_fmac_f32 v117, v54, v54
  v_add_f32 v116, v116, v55
  v_fmac_f32 v117, v55, v55
  v_add_f32 v116, v116, v56
  v_fmac_f32 v117, v56, v56
  v_add_f32 v116, v116, v57
  v_fmac_f32 v117, v57, v57
  s_nop 1
  v_permlane32_swap_b32 v116, v117
  v_add_f32 v116, v116, v117
  v_permlane16_swap_b32 v188, v189
  v_add_f32 v188, v188, v189
  ds_write_b32 v97, v188
  v_mov_b32 v117, v116
  s_nop 1
  v_permlane16_swap_b32 v116, v117
  v_add_f32 v116, v116, v117
  ds_write_b32 v97, v116 offset:512
  s_waitcnt vmcnt(33)
  ds_read_b64_tr_b16 a[8:9], v230
  ds_read_b64_tr_b16 a[32:33], v230 offset:32
  ds_read_b64_tr_b16 a[56:57], v230 offset:64
  ds_read_b64_tr_b16 a[10:11], v230 offset:1536
  ds_read_b64_tr_b16 a[34:35], v230 offset:1568
  ds_read_b64_tr_b16 a[58:59], v230 offset:1600
  ds_read_b64_tr_b16 a[20:21], v230 offset:3072
  ds_read_b64_tr_b16 a[44:45], v230 offset:3104
  ds_read_b64_tr_b16 a[68:69], v230 offset:3136
  ds_read_b64_tr_b16 a[12:13], v230 offset:4608
  ds_read_b64_tr_b16 a[36:37], v230 offset:4640
  ds_read_b64_tr_b16 a[60:61], v230 offset:4672
  ds_read_b64_tr_b16 a[14:15], v230 offset:6144
  ds_read_b64_tr_b16 a[38:39], v230 offset:6176
  ds_read_b64_tr_b16 a[62:63], v230 offset:6208
  ds_read_b64_tr_b16 a[22:23], v230 offset:7680
  ds_read_b64_tr_b16 a[46:47], v230 offset:7712
  ds_read_b64_tr_b16 a[70:71], v230 offset:7744
  s_mov_b32 s98, 768
  s_add_u32 m0, s81, 36864
  s_waitcnt lgkmcnt(0)
  buffer_load_dwordx4 v235, s[16:19], s98 offen lds
  s_add_u32 m0, s81, 37888
  s_nop 0
  buffer_load_dwordx4 v236, s[16:19], s98 offen lds
  s_add_u32 m0, s81, 38912
  s_nop 0
  buffer_load_dwordx4 v237, s[16:19], s98 offen lds
  s_mov_b32 s98, 37632
  s_add_u32 m0, s81, 39936
  s_nop 0
  buffer_load_dwordx4 v235, s[16:19], s98 offen lds
  s_add_u32 m0, s81, 40960
  s_nop 0
  buffer_load_dwordx4 v236, s[16:19], s98 offen lds
  s_add_u32 m0, s81, 41984
  s_nop 0
  buffer_load_dwordx4 v237, s[16:19], s98 offen lds
  s_mov_b32 s98, 74496
  s_add_u32 m0, s81, 43008
  s_nop 0
  buffer_load_dwordx4 v235, s[16:19], s98 offen lds
  s_add_u32 m0, s81, 44032
  s_nop 0
  buffer_load_dwordx4 v236, s[16:19], s98 offen lds
  s_add_u32 m0, s81, 45056
  s_nop 0
  buffer_load_dwordx4 v237, s[16:19], s98 offen lds
  s_barrier
  ds_read_b128 v[116:119], v15
  ds_read_b128 v[120:123], v15 offset:1024
  s_waitcnt lgkmcnt(1)
  v_add_f32 v116, v116, v117
  v_add_f32 v118, v118, v119
  v_add_f32 v116, v116, v118
  s_waitcnt lgkmcnt(0)
  v_add_f32 v120, v120, v121
  v_add_f32 v122, v122, v123
  v_add_f32 v120, v120, v122
  v_mul_f32 v117, 0x3baaaaab, v116
  v_fma_f32 v120, -v117, v116, v120
  v_max_f32 v120, 0, v120
  v_add_f32 v120, 0x3afba882, v120
  v_rsq_f32 v120, v120
  s_nop 0
  v_mul_f32 v120, 0x40ca568a, v120
  v_mul_f32 v121, -v117, v120
  ds_write_b64 v101, v[120:121]
  ds_read_b64 v[116:117], v105 offset:768
  s_waitcnt lgkmcnt(0)
  v_fma_f32 v120, v22, v116, v117
  v_fma_f32 v118, v23, v116, v117
  v_cvt_pk_bf16_f32 v120, v120, v118
  v_fma_f32 v121, v24, v116, v117
  v_fma_f32 v118, v25, v116, v117
  v_cvt_pk_bf16_f32 v121, v121, v118
  v_fma_f32 v122, v26, v116, v117
  v_fma_f32 v118, v27, v116, v117
  v_cvt_pk_bf16_f32 v122, v122, v118
  v_fma_f32 v123, v28, v116, v117
  v_fma_f32 v118, v29, v116, v117
  v_cvt_pk_bf16_f32 v123, v123, v118
  v_fma_f32 v118, v30, v116, v117
  v_fma_f32 v234, v31, v116, v117
  v_cvt_pk_bf16_f32 v118, v118, v234
  v_fma_f32 v119, v32, v116, v117
  v_fma_f32 v234, v33, v116, v117
  v_cvt_pk_bf16_f32 v119, v119, v234
  ds_write_b128 v16, v[120:123] offset:2048
  ds_write_b64 v17, v[118:119] offset:2048
  s_waitcnt vmcnt(33)
  ds_read_b64_tr_b16 a[72:73], v214
  ds_read_b64_tr_b16 a[96:97], v214 offset:32
  ds_read_b64_tr_b16 a[120:121], v214 offset:64
  ds_read_b64_tr_b16 a[74:75], v214 offset:1536
  ds_read_b64_tr_b16 a[98:99], v214 offset:1568
  ds_read_b64_tr_b16 a[122:123], v214 offset:1600
  ds_read_b64_tr_b16 a[88:89], v214 offset:3072
  ds_read_b64_tr_b16 a[112:113], v214 offset:3104
  ds_read_b64_tr_b16 a[136:137], v214 offset:3136
  ds_read_b64_tr_b16 a[76:77], v214 offset:4608
  ds_read_b64_tr_b16 a[100:101], v214 offset:4640
  ds_read_b64_tr_b16 a[124:125], v214 offset:4672
  ds_read_b64_tr_b16 a[78:79], v214 offset:6144
  ds_read_b64_tr_b16 a[102:103], v214 offset:6176
  ds_read_b64_tr_b16 a[126:127], v214 offset:6208
  ds_read_b64_tr_b16 a[90:91], v214 offset:7680
  ds_read_b64_tr_b16 a[114:115], v214 offset:7712
  ds_read_b64_tr_b16 a[138:139], v214 offset:7744
  s_mov_b32 s98, 111360
  s_add_u32 m0, s81, 73728
  s_waitcnt lgkmcnt(0)
  buffer_load_dwordx4 v235, s[16:19], s98 offen lds
  s_add_u32 m0, s81, 74752
  s_nop 0
  buffer_load_dwordx4 v236, s[16:19], s98 offen lds
  s_add_u32 m0, s81, 75776
  s_nop 0
  buffer_load_dwordx4 v237, s[16:19], s98 offen lds
  s_mov_b32 s98, 148224
  s_add_u32 m0, s81, 76800
  s_nop 0
  buffer_load_dwordx4 v235, s[16:19], s98 offen lds
  s_add_u32 m0, s81, 77824
  s_nop 0
  buffer_load_dwordx4 v236, s[16:19], s98 offen lds
  s_add_u32 m0, s81, 78848
  s_nop 0
  buffer_load_dwordx4 v237, s[16:19], s98 offen lds
  s_mov_b32 s98, 185088
  s_add_u32 m0, s81, 79872
  s_nop 0
  buffer_load_dwordx4 v235, s[16:19], s98 offen lds
  s_add_u32 m0, s81, 80896
  s_nop 0
  buffer_load_dwordx4 v236, s[16:19], s98 offen lds
  s_add_u32 m0, s81, 81920
  s_nop 0
  buffer_load_dwordx4 v237, s[16:19], s98 offen lds
  ds_read_b128 v[120:123], v15 offset:8192
  ds_read_b128 v[116:119], v15 offset:9216
  ds_read_b128 v[234:237], v15 offset:10240
  ds_read_b128 v[124:127], v15 offset:11264
  ds_read_b128 v[128:131], v15 offset:12288
  ds_read_b128 v[132:135], v15 offset:13312
  ds_read_b128 v[136:139], v15 offset:14336
  ds_read_b128 v[140:143], v15 offset:15360
  ds_read_b128 v[144:147], v15 offset:16384
  ds_read_b128 v[148:151], v15 offset:17408
  ds_read_b128 v[152:155], v15 offset:18432
  ds_read_b128 v[156:159], v15 offset:19456
  s_waitcnt lgkmcnt(11)
  v_mfma_f32_16x16x32_bf16 v[160:163], a[0:3], v[120:123], 0
  s_waitcnt lgkmcnt(10)
  v_mfma_f32_16x16x32_bf16 v[160:163], a[4:7], v[116:119], v[160:163]
  s_waitcnt lgkmcnt(9)
  v_mfma_f32_16x16x32_bf16 v[160:163], a[8:11], v[234:237], v[160:163]
  s_waitcnt lgkmcnt(8)
  v_mfma_f32_16x16x32_bf16 v[160:163], a[12:15], v[124:127], v[160:163]
  s_waitcnt lgkmcnt(7)
  v_mfma_f32_16x16x32_bf16 v[160:163], a[16:19], v[128:131], v[160:163]
  s_waitcnt lgkmcnt(6)
  v_mfma_f32_16x16x32_bf16 v[160:163], a[20:23], v[132:135], v[160:163]
  s_nop 7
  v_cvt_pk_bf16_f32 v94, v160, v161
  v_cvt_pk_bf16_f32 v95, v162, v163
  v_mfma_f32_16x16x32_bf16 v[160:163], a[24:27], v[120:123], 0
  v_mfma_f32_16x16x32_bf16 v[160:163], a[28:31], v[116:119], v[160:163]
  v_mfma_f32_16x16x32_bf16 v[160:163], a[32:35], v[234:237], v[160:163]
  v_mfma_f32_16x16x32_bf16 v[160:163], a[36:39], v[124:127], v[160:163]
  v_mfma_f32_16x16x32_bf16 v[160:163], a[40:43], v[128:131], v[160:163]
  v_mfma_f32_16x16x32_bf16 v[160:163], a[44:47], v[132:135], v[160:163]
  s_nop 7
  v_cvt_pk_bf16_f32 v98, v160, v161
  v_cvt_pk_bf16_f32 v99, v162, v163
  v_mfma_f32_16x16x32_bf16 v[160:163], a[48:51], v[120:123], 0
  v_mfma_f32_16x16x32_bf16 v[160:163], a[52:55], v[116:119], v[160:163]
  v_mfma_f32_16x16x32_bf16 v[160:163], a[56:59], v[234:237], v[160:163]
  v_mfma_f32_16x16x32_bf16 v[160:163], a[60:63], v[124:127], v[160:163]
  v_mfma_f32_16x16x32_bf16 v[160:163], a[64:67], v[128:131], v[160:163]
  v_mfma_f32_16x16x32_bf16 v[160:163], a[68:71], v[132:135], v[160:163]
  s_nop 7
  v_cvt_pk_bf16_f32 v102, v160, v161
  v_cvt_pk_bf16_f32 v103, v162, v163
  s_waitcnt lgkmcnt(5)
  v_mfma_f32_16x16x32_bf16 v[160:163], a[0:3], v[136:139], 0
  s_waitcnt lgkmcnt(4)
  v_mfma_f32_16x16x32_bf16 v[160:163], a[4:7], v[140:143], v[160:163]
  s_waitcnt lgkmcnt(3)
  v_mfma_f32_16x16x32_bf16 v[160:163], a[8:11], v[144:147], v[160:163]
  s_waitcnt lgkmcnt(2)
  v_mfma_f32_16x16x32_bf16 v[160:163], a[12:15], v[148:151], v[160:163]
  s_waitcnt lgkmcnt(1)
  v_mfma_f32_16x16x32_bf16 v[160:163], a[16:19], v[152:155], v[160:163]
  s_waitcnt lgkmcnt(0)
  v_mfma_f32_16x16x32_bf16 v[160:163], a[20:23], v[156:159], v[160:163]
  s_nop 7
  v_cvt_pk_bf16_f32 v106, v160, v161
  v_cvt_pk_bf16_f32 v107, v162, v163
  v_mfma_f32_16x16x32_bf16 v[160:163], a[24:27], v[136:139], 0
  v_mfma_f32_16x16x32_bf16 v[160:163], a[28:31], v[140:143], v[160:163]
  v_mfma_f32_16x16x32_bf16 v[160:163], a[32:35], v[144:147], v[160:163]
  v_mfma_f32_16x16x32_bf16 v[160:163], a[36:39], v[148:151], v[160:163]
  v_mfma_f32_16x16x32_bf16 v[160:163], a[40:43], v[152:155], v[160:163]
  v_mfma_f32_16x16x32_bf16 v[160:163], a[44:47], v[156:159], v[160:163]
  s_nop 7
  v_cvt_pk_bf16_f32 v110, v160, v161
  v_cvt_pk_bf16_f32 v111, v162, v163
  v_mfma_f32_16x16x32_bf16 v[160:163], a[48:51], v[136:139], 0
  v_mfma_f32_16x16x32_bf16 v[160:163], a[52:55], v[140:143], v[160:163]
  v_mfma_f32_16x16x32_bf16 v[160:163], a[56:59], v[144:147], v[160:163]
  v_mfma_f32_16x16x32_bf16 v[160:163], a[60:63], v[148:151], v[160:163]
  v_mfma_f32_16x16x32_bf16 v[160:163], a[64:67], v[152:155], v[160:163]
  v_mfma_f32_16x16x32_bf16 v[160:163], a[68:71], v[156:159], v[160:163]
  s_nop 7
  v_cvt_pk_bf16_f32 v200, v160, v161
  v_cvt_pk_bf16_f32 v201, v162, v163
  s_waitcnt vmcnt(18)
  ds_read_b64_tr_b16 a[80:81], v241
  ds_read_b64_tr_b16 a[104:105], v241 offset:32
  ds_read_b64_tr_b16 a[128:129], v241 offset:64
  ds_read_b64_tr_b16 a[82:83], v241 offset:1536
  ds_read_b64_tr_b16 a[106:107], v241 offset:1568
  ds_read_b64_tr_b16 a[130:131], v241 offset:1600
  ds_read_b64_tr_b16 a[92:93], v241 offset:3072
  ds_read_b64_tr_b16 a[116:117], v241 offset:3104
  ds_read_b64_tr_b16 a[140:141], v241 offset:3136
  ds_read_b64_tr_b16 a[84:85], v241 offset:4608
  ds_read_b64_tr_b16 a[108:109], v241 offset:4640
  ds_read_b64_tr_b16 a[132:133], v241 offset:4672
  ds_read_b64_tr_b16 a[86:87], v241 offset:6144
  ds_read_b64_tr_b16 a[110:111], v241 offset:6176
  ds_read_b64_tr_b16 a[134:135], v241 offset:6208
  ds_read_b64_tr_b16 a[94:95], v241 offset:7680
  ds_read_b64_tr_b16 a[118:119], v241 offset:7712
  ds_read_b64_tr_b16 a[142:143], v241 offset:7744
  s_mov_b32 s98, 0
  s_add_u32 m0, s81, 0
  s_waitcnt lgkmcnt(0)
  buffer_load_dwordx4 v238, s[20:23], s98 offen lds
  s_add_u32 m0, s81, 1024
  s_nop 0
  buffer_load_dwordx4 v239, s[20:23], s98 offen lds
  s_add_u32 m0, s81, 2048
  s_nop 0
  buffer_load_dwordx4 v240, s[20:23], s98 offen lds
  s_mov_b32 s98, 12288
  s_add_u32 m0, s81, 3072
  s_nop 0
  buffer_load_dwordx4 v238, s[20:23], s98 offen lds
  s_add_u32 m0, s81, 4096
  s_nop 0
  buffer_load_dwordx4 v239, s[20:23], s98 offen lds
  s_add_u32 m0, s81, 5120
  s_nop 0
  buffer_load_dwordx4 v240, s[20:23], s98 offen lds
  s_mov_b32 s98, 24576
  s_add_u32 m0, s81, 6144
  s_nop 0
  buffer_load_dwordx4 v238, s[20:23], s98 offen lds
  s_add_u32 m0, s81, 7168
  s_nop 0
  buffer_load_dwordx4 v239, s[20:23], s98 offen lds
  s_add_u32 m0, s81, 8192
  s_nop 0
  buffer_load_dwordx4 v240, s[20:23], s98 offen lds
  v_mfma_f32_16x16x32_bf16 v[160:163], a[72:75], v[120:123], 0
  v_mfma_f32_16x16x32_bf16 v[160:163], a[76:79], v[116:119], v[160:163]
  v_mfma_f32_16x16x32_bf16 v[160:163], a[80:83], v[234:237], v[160:163]
  v_mfma_f32_16x16x32_bf16 v[160:163], a[84:87], v[124:127], v[160:163]
  v_mfma_f32_16x16x32_bf16 v[160:163], a[88:91], v[128:131], v[160:163]
  v_mfma_f32_16x16x32_bf16 v[160:163], a[92:95], v[132:135], v[160:163]
  s_nop 7
  v_cvt_pk_bf16_f32 v202, v160, v161
  v_cvt_pk_bf16_f32 v203, v162, v163
  v_mfma_f32_16x16x32_bf16 v[160:163], a[96:99], v[120:123], 0
  v_mfma_f32_16x16x32_bf16 v[160:163], a[100:103], v[116:119], v[160:163]
  v_mfma_f32_16x16x32_bf16 v[160:163], a[104:107], v[234:237], v[160:163]
  v_mfma_f32_16x16x32_bf16 v[160:163], a[108:111], v[124:127], v[160:163]
  v_mfma_f32_16x16x32_bf16 v[160:163], a[112:115], v[128:131], v[160:163]
  v_mfma_f32_16x16x32_bf16 v[160:163], a[116:119], v[132:135], v[160:163]
  s_nop 7
  v_cvt_pk_bf16_f32 v204, v160, v161
  v_cvt_pk_bf16_f32 v205, v162, v163
  v_mfma_f32_16x16x32_bf16 v[160:163], a[120:123], v[120:123], 0
  v_mfma_f32_16x16x32_bf16 v[160:163], a[124:127], v[116:119], v[160:163]
  v_mfma_f32_16x16x32_bf16 v[160:163], a[128:131], v[234:237], v[160:163]
  v_mfma_f32_16x16x32_bf16 v[160:163], a[132:135], v[124:127], v[160:163]
  v_mfma_f32_16x16x32_bf16 v[160:163], a[136:139], v[128:131], v[160:163]
  v_mfma_f32_16x16x32_bf16 v[160:163], a[140:143], v[132:135], v[160:163]
  s_nop 7
  v_cvt_pk_bf16_f32 v206, v160, v161
  v_cvt_pk_bf16_f32 v207, v162, v163
  v_mfma_f32_16x16x32_bf16 v[160:163], a[72:75], v[136:139], 0
  v_mfma_f32_16x16x32_bf16 v[160:163], a[76:79], v[140:143], v[160:163]
  v_mfma_f32_16x16x32_bf16 v[160:163], a[80:83], v[144:147], v[160:163]
  v_mfma_f32_16x16x32_bf16 v[160:163], a[84:87], v[148:151], v[160:163]
  v_mfma_f32_16x16x32_bf16 v[160:163], a[88:91], v[152:155], v[160:163]
  v_mfma_f32_16x16x32_bf16 v[160:163], a[92:95], v[156:159], v[160:163]
  s_nop 7
  v_cvt_pk_bf16_f32 v208, v160, v161
  v_cvt_pk_bf16_f32 v209, v162, v163
  v_mfma_f32_16x16x32_bf16 v[160:163], a[96:99], v[136:139], 0
  v_mfma_f32_16x16x32_bf16 v[160:163], a[100:103], v[140:143], v[160:163]
  v_mfma_f32_16x16x32_bf16 v[160:163], a[104:107], v[144:147], v[160:163]
  v_mfma_f32_16x16x32_bf16 v[160:163], a[108:111], v[148:151], v[160:163]
  v_mfma_f32_16x16x32_bf16 v[160:163], a[112:115], v[152:155], v[160:163]
  v_mfma_f32_16x16x32_bf16 v[160:163], a[116:119], v[156:159], v[160:163]
  s_nop 7
  v_cvt_pk_bf16_f32 v210, v160, v161
  v_cvt_pk_bf16_f32 v211, v162, v163
  v_mfma_f32_16x16x32_bf16 v[160:163], a[120:123], v[136:139], 0
  v_mfma_f32_16x16x32_bf16 v[160:163], a[124:127], v[140:143], v[160:163]
  v_mfma_f32_16x16x32_bf16 v[160:163], a[128:131], v[144:147], v[160:163]
  v_mfma_f32_16x16x32_bf16 v[160:163], a[132:135], v[148:151], v[160:163]
  v_mfma_f32_16x16x32_bf16 v[160:163], a[136:139], v[152:155], v[160:163]
  v_mfma_f32_16x16x32_bf16 v[160:163], a[140:143], v[156:159], v[160:163]
  s_nop 7
  v_cvt_pk_bf16_f32 v212, v160, v161
  v_cvt_pk_bf16_f32 v213, v162, v163
  s_waitcnt vmcnt(18)
  ds_read_b64_tr_b16 a[144:145], v230
  ds_read_b64_tr_b16 a[168:169], v230 offset:32
  ds_read_b64_tr_b16 a[192:193], v230 offset:64
  ds_read_b64_tr_b16 a[146:147], v230 offset:1536
  ds_read_b64_tr_b16 a[170:171], v230 offset:1568
  ds_read_b64_tr_b16 a[194:195], v230 offset:1600
  ds_read_b64_tr_b16 a[160:161], v230 offset:3072
  ds_read_b64_tr_b16 a[184:185], v230 offset:3104
  ds_read_b64_tr_b16 a[208:209], v230 offset:3136
  ds_read_b64_tr_b16 a[148:149], v230 offset:4608
  ds_read_b64_tr_b16 a[172:173], v230 offset:4640
  ds_read_b64_tr_b16 a[196:197], v230 offset:4672
  ds_read_b64_tr_b16 a[150:151], v230 offset:6144
  ds_read_b64_tr_b16 a[174:175], v230 offset:6176
  ds_read_b64_tr_b16 a[198:199], v230 offset:6208
  ds_read_b64_tr_b16 a[162:163], v230 offset:7680
  ds_read_b64_tr_b16 a[186:187], v230 offset:7712
  ds_read_b64_tr_b16 a[210:211], v230 offset:7744
  s_mov_b32 s98, 36864
  s_add_u32 m0, s81, 36864
  s_waitcnt lgkmcnt(0)
  buffer_load_dwordx4 v238, s[20:23], s98 offen lds
  s_add_u32 m0, s81, 37888
  s_nop 0
  buffer_load_dwordx4 v239, s[20:23], s98 offen lds
  s_add_u32 m0, s81, 38912
  s_nop 0
  buffer_load_dwordx4 v240, s[20:23], s98 offen lds
  s_mov_b32 s98, 49152
  s_add_u32 m0, s81, 39936
  s_nop 0
  buffer_load_dwordx4 v238, s[20:23], s98 offen lds
  s_add_u32 m0, s81, 40960
  s_nop 0
  buffer_load_dwordx4 v239, s[20:23], s98 offen lds
  s_add_u32 m0, s81, 41984
  s_nop 0
  buffer_load_dwordx4 v240, s[20:23], s98 offen lds
  s_mov_b32 s98, 61440
  s_add_u32 m0, s81, 43008
  s_nop 0
  buffer_load_dwordx4 v238, s[20:23], s98 offen lds
  s_add_u32 m0, s81, 44032
  s_nop 0
  buffer_load_dwordx4 v239, s[20:23], s98 offen lds
  s_add_u32 m0, s81, 45056
  s_nop 0
  buffer_load_dwordx4 v240, s[20:23], s98 offen lds
  s_waitcnt vmcnt(18)
  ds_read_b64_tr_b16 a[152:153], v214
  ds_read_b64_tr_b16 a[176:177], v214 offset:32
  ds_read_b64_tr_b16 a[200:201], v214 offset:64
  ds_read_b64_tr_b16 a[154:155], v214 offset:1536
  ds_read_b64_tr_b16 a[178:179], v214 offset:1568
  ds_read_b64_tr_b16 a[202:203], v214 offset:1600
  ds_read_b64_tr_b16 a[164:165], v214 offset:3072
  ds_read_b64_tr_b16 a[188:189], v214 offset:3104
  ds_read_b64_tr_b16 a[212:213], v214 offset:3136
  ds_read_b64_tr_b16 a[156:157], v214 offset:4608
  ds_read_b64_tr_b16 a[180:181], v214 offset:4640
  ds_read_b64_tr_b16 a[204:205], v214 offset:4672
  ds_read_b64_tr_b16 a[158:159], v214 offset:6144
  ds_read_b64_tr_b16 a[182:183], v214 offset:6176
  ds_read_b64_tr_b16 a[206:207], v214 offset:6208
  ds_read_b64_tr_b16 a[166:167], v214 offset:7680
  ds_read_b64_tr_b16 a[190:191], v214 offset:7712
  ds_read_b64_tr_b16 a[214:215], v214 offset:7744
  v_mfma_f32_16x16x32_bf16 v[160:163], a[144:147], v[120:123], 0
  v_mfma_f32_16x16x32_bf16 v[160:163], a[148:151], v[116:119], v[160:163]
  s_waitcnt lgkmcnt(14)
  v_mfma_f32_16x16x32_bf16 v[160:163], a[152:155], v[234:237], v[160:163]
  s_waitcnt lgkmcnt(5)
  v_mfma_f32_16x16x32_bf16 v[160:163], a[156:159], v[124:127], v[160:163]
  v_mfma_f32_16x16x32_bf16 v[160:163], a[160:163], v[128:131], v[160:163]
  s_waitcnt lgkmcnt(2)
  v_mfma_f32_16x16x32_bf16 v[160:163], a[164:167], v[132:135], v[160:163]
  s_nop 7
  v_cvt_pk_bf16_f32 v214, v160, v161
  v_cvt_pk_bf16_f32 v215, v162, v163
  v_mfma_f32_16x16x32_bf16 v[160:163], a[168:171], v[120:123], 0
  v_mfma_f32_16x16x32_bf16 v[160:163], a[172:175], v[116:119], v[160:163]
  v_mfma_f32_16x16x32_bf16 v[160:163], a[176:179], v[234:237], v[160:163]
  v_mfma_f32_16x16x32_bf16 v[160:163], a[180:183], v[124:127], v[160:163]
  v_mfma_f32_16x16x32_bf16 v[160:163], a[184:187], v[128:131], v[160:163]
  s_waitcnt lgkmcnt(1)
  v_mfma_f32_16x16x32_bf16 v[160:163], a[188:191], v[132:135], v[160:163]
  s_nop 7
  v_cvt_pk_bf16_f32 v216, v160, v161
  v_cvt_pk_bf16_f32 v217, v162, v163
  v_mfma_f32_16x16x32_bf16 v[160:163], a[192:195], v[120:123], 0
  v_mfma_f32_16x16x32_bf16 v[160:163], a[196:199], v[116:119], v[160:163]
  v_mfma_f32_16x16x32_bf16 v[160:163], a[200:203], v[234:237], v[160:163]
  v_mfma_f32_16x16x32_bf16 v[160:163], a[204:207], v[124:127], v[160:163]
  v_mfma_f32_16x16x32_bf16 v[160:163], a[208:211], v[128:131], v[160:163]
  s_waitcnt lgkmcnt(0)
  v_mfma_f32_16x16x32_bf16 v[160:163], a[212:215], v[132:135], v[160:163]
  s_nop 7
  v_cvt_pk_bf16_f32 v218, v160, v161
  v_cvt_pk_bf16_f32 v219, v162, v163
  v_mfma_f32_16x16x32_bf16 v[132:135], a[144:147], v[136:139], 0
  v_mfma_f32_16x16x32_bf16 v[132:135], a[148:151], v[140:143], v[132:135]
  v_mfma_f32_16x16x32_bf16 v[132:135], a[152:155], v[144:147], v[132:135]
  v_mfma_f32_16x16x32_bf16 v[132:135], a[156:159], v[148:151], v[132:135]
  v_mfma_f32_16x16x32_bf16 v[132:135], a[160:163], v[152:155], v[132:135]
  v_mfma_f32_16x16x32_bf16 v[132:135], a[164:167], v[156:159], v[132:135]
  s_nop 7
  v_cvt_pk_bf16_f32 v220, v132, v133
  v_cvt_pk_bf16_f32 v221, v134, v135
  v_mfma_f32_16x16x32_bf16 v[132:135], a[168:171], v[136:139], 0
  v_mfma_f32_16x16x32_bf16 v[132:135], a[172:175], v[140:143], v[132:135]
  v_mfma_f32_16x16x32_bf16 v[132:135], a[176:179], v[144:147], v[132:135]
  v_mfma_f32_16x16x32_bf16 v[132:135], a[180:183], v[148:151], v[132:135]
  v_mfma_f32_16x16x32_bf16 v[132:135], a[184:187], v[152:155], v[132:135]
  v_mfma_f32_16x16x32_bf16 v[132:135], a[188:191], v[156:159], v[132:135]
  s_nop 7
  v_cvt_pk_bf16_f32 v222, v132, v133
  v_cvt_pk_bf16_f32 v223, v134, v135
  v_mfma_f32_16x16x32_bf16 v[132:135], a[192:195], v[136:139], 0
  v_mfma_f32_16x16x32_bf16 v[132:135], a[196:199], v[140:143], v[132:135]
  v_mfma_f32_16x16x32_bf16 v[132:135], a[200:203], v[144:147], v[132:135]
  v_mfma_f32_16x16x32_bf16 v[132:135], a[204:207], v[148:151], v[132:135]
  v_mfma_f32_16x16x32_bf16 v[132:135], a[208:211], v[152:155], v[132:135]
  v_mfma_f32_16x16x32_bf16 v[132:135], a[212:215], v[156:159], v[132:135]
  s_nop 7
  v_cvt_pk_bf16_f32 v138, v132, v133
  v_cvt_pk_bf16_f32 v139, v134, v135
  s_waitcnt vmcnt(9)
  ds_read_b64_tr_b16 a[250:251], v241
  ds_read_b64_tr_b16 v[140:141], v241 offset:32
  ds_read_b64_tr_b16 v[144:145], v241 offset:64
  ds_read_b64_tr_b16 a[252:253], v241 offset:1536
  ds_read_b64_tr_b16 v[142:143], v241 offset:1568
  ds_read_b64_tr_b16 v[146:147], v241 offset:1600
  ds_read_b64_tr_b16 v[148:149], v241 offset:3072
  ds_read_b64_tr_b16 v[152:153], v241 offset:3104
  ds_read_b64_tr_b16 v[156:157], v241 offset:3136
  ds_read_b64_tr_b16 v[160:161], v241 offset:4608
  ds_read_b64_tr_b16 v[234:235], v241 offset:4640
  ds_read_b64_tr_b16 v[164:165], v241 offset:4672
  ds_read_b64_tr_b16 v[162:163], v241 offset:6144
  ds_read_b64_tr_b16 v[236:237], v241 offset:6176
  ds_read_b64_tr_b16 v[166:167], v241 offset:6208
  ds_read_b64_tr_b16 v[150:151], v241 offset:7680
  ds_read_b64_tr_b16 v[154:155], v241 offset:7712
  ds_read_b64_tr_b16 v[158:159], v241 offset:7744
  s_waitcnt vmcnt(0)
  ds_read_b64_tr_b16 v[238:239], v230
  ds_read_b64_tr_b16 v[168:169], v230 offset:32
  ds_read_b64_tr_b16 v[172:173], v230 offset:64
  ds_read_b64_tr_b16 v[240:241], v230 offset:1536
  ds_read_b64_tr_b16 v[170:171], v230 offset:1568
  ds_read_b64_tr_b16 v[174:175], v230 offset:1600
  ds_read_b64_tr_b16 v[176:177], v230 offset:3072
  ds_read_b64_tr_b16 v[180:181], v230 offset:3104
  ds_read_b64_tr_b16 v[184:185], v230 offset:3136
  ds_read_b64_tr_b16 v[188:189], v230 offset:4608
  ds_read_b64_tr_b16 v[192:193], v230 offset:4640
  ds_read_b64_tr_b16 v[196:197], v230 offset:4672
  ds_read_b64_tr_b16 v[190:191], v230 offset:6144
  ds_read_b64_tr_b16 v[194:195], v230 offset:6176
  ds_read_b64_tr_b16 v[198:199], v230 offset:6208
  ds_read_b64_tr_b16 v[178:179], v230 offset:7680
  ds_read_b64_tr_b16 v[182:183], v230 offset:7712
  ds_read_b64_tr_b16 v[186:187], v230 offset:7744
  s_waitcnt lgkmcnt(0)
  s_barrier
  ds_read_b128 v[114:117], v15 offset:2048
  ds_read_b128 v[118:121], v15 offset:3072
  ds_read_b128 v[122:125], v15 offset:4096
  ds_read_b128 v[126:129], v15 offset:5120
  ds_read_b128 v[130:133], v15 offset:6144
  ds_read_b128 v[134:137], v15 offset:7168
  ds_write_b64 v242, v[202:203]
  ds_write_b64 v242, v[94:95] offset:768
  ds_write_b64 v243, v[214:215]
  ds_write_b64 v242, v[204:205] offset:8
  ds_write_b64 v242, v[98:99] offset:776
  ds_write_b64 v243, v[216:217] offset:32
  ds_write_b64 v242, v[206:207] offset:16
  ds_write_b64 v242, v[102:103] offset:784
  ds_write_b64 v243, v[218:219] offset:64
  s_mov_b64 exec, s[94:95]
  ds_write_b64 v242, v[208:209] offset:18432
  ds_write_b64 v242, v[106:107] offset:19200
  ds_write_b64 v243, v[220:221] offset:18432
  ds_write_b64 v242, v[210:211] offset:18440
  ds_write_b64 v242, v[110:111] offset:19208
  ds_write_b64 v243, v[222:223] offset:18464
  ds_write_b64 v242, v[212:213] offset:18448
  ds_write_b64 v242, v[200:201] offset:19216
  ds_write_b64 v243, v[138:139] offset:18496
  s_mov_b64 exec, -1
  ds_write_b128 v18, v[140:143]
  ds_write_b128 v18, v[144:147] offset:1024
  ds_write_b128 v18, v[160:163] offset:2048
  ds_write_b128 v18, v[234:237] offset:3072
  ds_write_b128 v18, v[164:167] offset:4096
  ds_write_b128 v18, v[238:241] offset:5120
  ds_write_b128 v18, v[168:171] offset:6144
  ds_write_b128 v18, v[172:175] offset:7168
  ds_write_b128 v18, v[188:191] offset:8192
  ds_write_b128 v18, v[192:195] offset:9216
  ds_write_b128 v18, v[196:199] offset:10240
  ds_write_b128 v18, v[148:151] offset:11264
  ds_write_b128 v18, v[152:155] offset:12288
  ds_write_b128 v18, v[156:159] offset:13312
  ds_write_b128 v18, v[176:179] offset:14336
  ds_write_b128 v18, v[180:183] offset:15360
  ds_write_b128 v18, v[184:187] offset:16384
  s_waitcnt lgkmcnt(15)
  v_mfma_f32_16x16x32_bf16 v[148:151], a[0:3], v[114:117], 0
  v_mfma_f32_16x16x32_bf16 v[148:151], a[4:7], v[118:121], v[148:151]
  v_mfma_f32_16x16x32_bf16 v[148:151], a[8:11], v[122:125], v[148:151]
  v_mfma_f32_16x16x32_bf16 v[148:151], a[12:15], v[126:129], v[148:151]
  v_mfma_f32_16x16x32_bf16 v[148:151], a[16:19], v[130:133], v[148:151]
  v_mfma_f32_16x16x32_bf16 v[148:151], a[20:23], v[134:137], v[148:151]
  s_nop 7
  v_cvt_pk_bf16_f32 v138, v148, v149
  v_cvt_pk_bf16_f32 v139, v150, v151
  v_mfma_f32_16x16x32_bf16 v[148:151], a[24:27], v[114:117], 0
  v_mfma_f32_16x16x32_bf16 v[148:151], a[28:31], v[118:121], v[148:151]
  v_mfma_f32_16x16x32_bf16 v[148:151], a[32:35], v[122:125], v[148:151]
  v_mfma_f32_16x16x32_bf16 v[148:151], a[36:39], v[126:129], v[148:151]
  v_mfma_f32_16x16x32_bf16 v[148:151], a[40:43], v[130:133], v[148:151]
  v_mfma_f32_16x16x32_bf16 v[148:151], a[44:47], v[134:137], v[148:151]
  s_nop 7
  v_cvt_pk_bf16_f32 v140, v148, v149
  v_cvt_pk_bf16_f32 v141, v150, v151
  v_mfma_f32_16x16x32_bf16 v[148:151], a[48:51], v[114:117], 0
  v_mfma_f32_16x16x32_bf16 v[148:151], a[52:55], v[118:121], v[148:151]
  v_mfma_f32_16x16x32_bf16 v[148:151], a[56:59], v[122:125], v[148:151]
  v_mfma_f32_16x16x32_bf16 v[148:151], a[60:63], v[126:129], v[148:151]
  v_mfma_f32_16x16x32_bf16 v[148:151], a[64:67], v[130:133], v[148:151]
  v_mfma_f32_16x16x32_bf16 v[148:151], a[68:71], v[134:137], v[148:151]
  s_nop 7
  v_cvt_pk_bf16_f32 v142, v148, v149
  v_cvt_pk_bf16_f32 v143, v150, v151
  v_mfma_f32_16x16x32_bf16 v[150:153], a[72:75], v[114:117], 0
  v_mfma_f32_16x16x32_bf16 v[150:153], a[76:79], v[118:121], v[150:153]
  v_mfma_f32_16x16x32_bf16 v[150:153], a[80:83], v[122:125], v[150:153]
  v_mfma_f32_16x16x32_bf16 v[150:153], a[84:87], v[126:129], v[150:153]
  v_mfma_f32_16x16x32_bf16 v[150:153], a[88:91], v[130:133], v[150:153]
  v_mfma_f32_16x16x32_bf16 v[150:153], a[92:95], v[134:137], v[150:153]
  s_nop 7
  v_cvt_pk_bf16_f32 v144, v150, v151
  v_cvt_pk_bf16_f32 v145, v152, v153
  v_mfma_f32_16x16x32_bf16 v[150:153], a[96:99], v[114:117], 0
  v_mfma_f32_16x16x32_bf16 v[150:153], a[100:103], v[118:121], v[150:153]
  v_mfma_f32_16x16x32_bf16 v[150:153], a[104:107], v[122:125], v[150:153]
  v_mfma_f32_16x16x32_bf16 v[150:153], a[108:111], v[126:129], v[150:153]
  v_mfma_f32_16x16x32_bf16 v[150:153], a[112:115], v[130:133], v[150:153]
  v_mfma_f32_16x16x32_bf16 v[150:153], a[116:119], v[134:137], v[150:153]
  s_nop 7
  v_cvt_pk_bf16_f32 v146, v150, v151
  v_cvt_pk_bf16_f32 v147, v152, v153
  v_mfma_f32_16x16x32_bf16 v[150:153], a[120:123], v[114:117], 0
  v_mfma_f32_16x16x32_bf16 v[150:153], a[124:127], v[118:121], v[150:153]
  v_mfma_f32_16x16x32_bf16 v[150:153], a[128:131], v[122:125], v[150:153]
  v_mfma_f32_16x16x32_bf16 v[150:153], a[132:135], v[126:129], v[150:153]
  v_mfma_f32_16x16x32_bf16 v[150:153], a[136:139], v[130:133], v[150:153]
  v_mfma_f32_16x16x32_bf16 v[150:153], a[140:143], v[134:137], v[150:153]
  s_waitcnt lgkmcnt(0)
  s_barrier
  v_mfma_f32_16x16x32_bf16 v[192:195], v[114:117], a[144:147], 0
  ds_read_b64 v[200:201], v105 offset:896
  ds_read_b64 v[202:203], v105 offset:1792
  v_mfma_f32_16x16x32_bf16 v[192:195], v[118:121], a[148:151], v[192:195]
  ds_read_b64 v[188:189], v19 offset:784
  ds_read2_b64 v[184:187], v19 offset0:96 offset1:97
  v_mfma_f32_16x16x32_bf16 v[192:195], v[122:125], a[152:155], v[192:195]
  v_cvt_pk_bf16_f32 v148, v150, v151
  v_cvt_pk_bf16_f32 v149, v152, v153
  v_mfma_f32_16x16x32_bf16 v[192:195], v[126:129], a[156:159], v[192:195]
  v_mfma_f32_16x16x32_bf16 v[192:195], v[130:133], a[160:163], v[192:195]
  v_mfma_f32_16x16x32_bf16 v[192:195], v[134:137], a[164:167], v[192:195]
  s_waitcnt lgkmcnt(3)
  v_fma_f32 v150, v34, v200, v201
  v_fma_f32 v196, v35, v200, v201
  v_mfma_f32_16x16x32_bf16 v[154:157], v[114:117], a[168:171], 0
  s_waitcnt lgkmcnt(2)
  v_fma_f32 v151, v36, v200, v201
  v_fma_f32 v197, v37, v200, v201
  v_mfma_f32_16x16x32_bf16 v[154:157], v[118:121], a[172:175], v[154:157]
  v_fma_f32 v152, v38, v200, v201
  v_fma_f32 v204, v39, v200, v201
  v_mfma_f32_16x16x32_bf16 v[154:157], v[122:125], a[176:179], v[154:157]
  v_fma_f32 v153, v40, v200, v201
  v_fma_f32 v205, v41, v200, v201
  v_mfma_f32_16x16x32_bf16 v[154:157], v[126:129], a[180:183], v[154:157]
  v_fma_f32 v160, v46, v202, v203
  v_fma_f32 v206, v47, v202, v203
  v_mfma_f32_16x16x32_bf16 v[154:157], v[130:133], a[184:187], v[154:157]
  v_fma_f32 v161, v48, v202, v203
  v_fma_f32 v207, v49, v202, v203
  v_mfma_f32_16x16x32_bf16 v[154:157], v[134:137], a[188:191], v[154:157]
  s_waitcnt lgkmcnt(1)
  v_fma_f32 v162, v50, v202, v203
  v_fma_f32 v208, v51, v202, v203
  v_fma_f32 v163, v52, v202, v203
  v_mfma_f32_16x16x16_bf16 v[164:167], v[148:149], v[142:143], 0
  v_fma_f32 v209, v53, v202, v203
  v_cvt_pk_bf16_f32 v150, v150, v196
  v_cvt_pk_bf16_f32 v151, v151, v197
  v_mfma_f32_16x16x16_bf16 v[196:199], v[148:149], v[188:189], 0
  v_cvt_pk_bf16_f32 v152, v152, v204
  v_cvt_pk_bf16_f32 v153, v153, v205
  v_cvt_pk_bf16_f32 v160, v160, v206
  v_cvt_pk_bf16_f32 v161, v161, v207
  v_mfma_f32_16x16x32_bf16 v[164:167], v[144:147], v[138:141], v[164:167]
  s_waitcnt lgkmcnt(0)
  ds_write_b128 v16, v[150:153] offset:8192
  v_mfma_f32_16x16x32_bf16 v[196:199], v[144:147], v[184:187], v[196:199]
  v_cvt_pk_bf16_f32 v162, v162, v208
  v_cvt_pk_bf16_f32 v163, v163, v209
  v_mfma_f32_16x16x32_bf16 v[150:153], v[114:117], a[192:195], 0
  ds_write_b128 v16, v[160:163] offset:14336
  v_mfma_f32_16x16x32_bf16 v[150:153], v[118:121], a[196:199], v[150:153]
  v_fma_f32 v118, v42, v200, v201
  v_fma_f32 v209, v43, v200, v201
  v_mfma_f32_16x16x32_bf16 v[150:153], v[122:125], a[200:203], v[150:153]
  v_fma_f32 v119, v44, v200, v201
  v_fma_f32 v208, v45, v200, v201
  v_mfma_f32_16x16x32_bf16 v[150:153], v[126:129], a[204:207], v[150:153]
  s_waitcnt vmcnt(0)
  v_fma_f32 v200, v54, v202, v203
  v_fma_f32 v207, v55, v202, v203
  v_mfma_f32_16x16x32_bf16 v[150:153], v[130:133], a[208:211], v[150:153]
  s_lshl_b32 s60, s31, 5
  v_fma_f32 v201, v56, v202, v203
  v_fma_f32 v206, v57, v202, v203
  v_mfma_f32_16x16x32_bf16 v[150:153], v[134:137], a[212:215], v[150:153]
  s_waitcnt lgkmcnt(1)
  v_cvt_pk_bf16_f32 v118, v118, v209
  v_cvt_pk_bf16_f32 v119, v119, v208
  v_cvt_pk_bf16_f32 v200, v200, v207
  v_cvt_pk_bf16_f32 v201, v201, v206
  s_add_u32 s61, s60, s30
  s_add_u32 s60, s60, s29
  ds_write_b64 v17, v[118:119] offset:8192
  ds_write_b64 v17, v[200:201] offset:14336
  v_exp_f32 v164, v164
  v_exp_f32 v165, v165
  v_exp_f32 v166, v166
  v_exp_f32 v167, v167
  v_cvt_pk_bf16_f32 v200, v164, v165
  v_cvt_pk_bf16_f32 v201, v166, v167
  v_cvt_pk_bf16_f32 v204, v192, v193
  v_cvt_pk_bf16_f32 v205, v194, v195
  v_cvt_pk_bf16_f32 v208, v154, v155
  v_cvt_pk_bf16_f32 v209, v156, v157
  v_cvt_pk_bf16_f32 v212, v150, v151
  v_cvt_pk_bf16_f32 v213, v152, v153
  v_exp_f32 v196, v196
  v_exp_f32 v197, v197
  v_exp_f32 v198, v198
  v_exp_f32 v199, v199
  v_cvt_pk_bf16_f32 v216, v196, v197
  v_cvt_pk_bf16_f32 v217, v198, v199
  s_waitcnt lgkmcnt(0)
  s_barrier
  ds_read_b128 v[220:223], v15 offset:8192
  ds_read_b128 v[224:227], v15 offset:9216
  s_mul_i32 s62, s60, 7183
  ds_read_b128 v[228:231], v15 offset:10240
  s_lshr_b32 s62, s62, 22
  s_mul_i32 s63, s62, 584
  s_sub_u32 s63, s60, s63
  ds_read_b128 v[232:235], v15 offset:11264
  s_lshr_b32 s64, s63, 3
  s_and_b32 s65, s63, 7
  s_lshl_b32 s66, s62, 3
  ds_read_b128 v[236:239], v15 offset:12288
  s_add_u32 s65, s65, s66
  s_cmp_ge_u32 s60, 5256
  s_cselect_b32 s64, s63, s64
  ds_read_b128 v[240:243], v15 offset:13312
  s_cselect_b32 s65, 72, s65
  s_mul_i32 s66, s65, 1373568
  s_mul_i32 s67, s64, 2688
  ds_read_b64 v[196:197], v9
  s_add_u32 s35, s66, s67
  s_cmp_ge_u32 s61, 667
  s_waitcnt lgkmcnt(6)
  v_mfma_f32_16x16x32_bf16 v[116:119], a[72:75], v[220:223], 0
  s_cselect_b32 s35, 268435456, s35
  ds_read_b64 v[192:193], v9 offset:32
  s_waitcnt lgkmcnt(6)
  v_mfma_f32_16x16x32_bf16 v[116:119], a[76:79], v[224:227], v[116:119]
  s_cmp_ge_u32 s60, 5329
  ds_read_b64 v[164:165], v9 offset:64
  s_waitcnt lgkmcnt(6)
  v_mfma_f32_16x16x32_bf16 v[116:119], a[80:83], v[228:231], v[116:119]
  s_cselect_b32 s35, 268435456, s35
  ds_read_b128 v[128:131], v3
  s_waitcnt lgkmcnt(6)
  v_mfma_f32_16x16x32_bf16 v[116:119], a[84:87], v[232:235], v[116:119]
  s_cmp_eq_u32 s65, 0
  ds_read_b128 v[132:135], v3 offset:864
  s_waitcnt lgkmcnt(6)
  v_mfma_f32_16x16x32_bf16 v[116:119], a[88:91], v[236:239], v[116:119]
  s_cselect_b32 s36, 268435456, s35
  ds_read_b128 v[120:123], v3 offset:1728
  s_waitcnt lgkmcnt(6)
  v_mfma_f32_16x16x32_bf16 v[116:119], a[92:95], v[240:243], v[116:119]
  s_add_u32 s37, s35, 195360
  ds_read_b128 v[124:127], v6
  s_add_u32 s38, s35, 390720
  s_waitcnt lgkmcnt(6)
  v_mfma_f32_16x16x16_bf16 v[58:61], a[224:225], v[196:197], 0
  ds_read_b128 v[150:153], v3 offset:32
  s_add_u32 s39, s35, 586080
  s_waitcnt lgkmcnt(6)
  v_mfma_f32_16x16x16_bf16 v[62:65], a[234:235], v[192:193], 0
  ds_read_b128 v[154:157], v3 offset:896
  v_cvt_pk_bf16_f32 v192, v116, v117
  s_waitcnt lgkmcnt(6)
  v_mfma_f32_16x16x16_bf16 v[66:69], a[244:245], v[164:165], 0
  ds_read_b128 v[160:163], v3 offset:1760
  v_cvt_pk_bf16_f32 v193, v118, v119
  s_add_u32 s40, s35, 781440
  s_add_u32 s41, s35, 981120
  ds_read_b128 v[164:167], v6 offset:32
  s_waitcnt lgkmcnt(6)
  v_smfmac_f32_16x16x64_bf16 v[58:61], a[216:219], v[128:135], v0
  s_add_u32 s42, s35, 1176480
  ds_read_b128 v[128:131], v3 offset:64
  s_add_u32 s43, s35, 1371840
  ds_read_b128 v[132:135], v3 offset:928
  s_add_u32 s44, s35, 1567200
  s_cmp_eq_u32 s64, 0
  s_waitcnt lgkmcnt(6)
  v_smfmac_f32_16x16x64_bf16 v[58:61], a[220:223], v[120:127], v0
  s_cselect_b64 s[52:53], s[48:49], 0
  ds_read_b128 v[120:123], v3 offset:1792
  v_mfma_f32_16x16x32_bf16 v[116:119], a[96:99], v[220:223], 0
  s_cmp_eq_u32 s64, 72
  ds_read_b128 v[124:127], v6 offset:64
  v_mfma_f32_16x16x32_bf16 v[116:119], a[100:103], v[224:227], v[116:119]
  s_cselect_b64 s[52:53], s[50:51], s[52:53]
  v_mul_f32 v94, v58, v58
  v_add_f32 v136, v58, v59
  v_mfma_f32_16x16x32_bf16 v[116:119], a[104:107], v[228:231], v[116:119]
  s_waitcnt lgkmcnt(6)
  v_fmac_f32 v94, v59, v59
  v_add_f32 v136, v136, v60
  v_smfmac_f32_16x16x64_bf16 v[62:65], a[226:229], v[150:157], v0
  s_waitcnt lgkmcnt(4)
  v_fmac_f32 v94, v60, v60
  v_smfmac_f32_16x16x64_bf16 v[62:65], a[230:233], v[160:167], v0
  s_add_u32 s31, s31, 1
  v_add_f32 v136, v136, v61
  v_mfma_f32_16x16x32_bf16 v[116:119], a[108:111], v[232:235], v[116:119]
  s_mov_b32 m0, s58
  v_fmac_f32 v94, v61, v61
  v_cndmask_b32 v137, v21, 2.0, s[52:53]
  v_mfma_f32_16x16x32_bf16 v[116:119], a[112:115], v[236:239], v[116:119]
  v_add_f32 v136, v136, v62
  v_fmac_f32 v94, v62, v62
  v_mfma_f32_16x16x32_bf16 v[116:119], a[116:119], v[240:243], v[116:119]
  s_waitcnt lgkmcnt(2)
  ds_read_b64 v[114:115], v10
  v_add_f32 v136, v136, v63
  v_smfmac_f32_16x16x64_bf16 v[66:69], a[236:239], v[128:135], v0
  s_waitcnt lgkmcnt(1)
  ds_read_b64 v[198:199], v10 offset:32
  v_fmac_f32 v94, v63, v63
  v_smfmac_f32_16x16x64_bf16 v[66:69], a[240:243], v[120:127], v0
  ds_read_b64 v[158:159], v10 offset:64
  v_cvt_pk_bf16_f32 v194, v116, v117
  v_mfma_f32_16x16x32_bf16 v[168:171], a[120:123], v[220:223], 0
  ds_read_b128 v[120:123], v4
  ds_read_b128 v[124:127], v4 offset:864
  v_mfma_f32_16x16x32_bf16 v[168:171], a[124:127], v[224:227], v[168:171]
  ds_read_b128 v[128:131], v4 offset:1728
  v_cvt_pk_bf16_f32 v195, v118, v119
  v_mfma_f32_16x16x32_bf16 v[168:171], a[128:131], v[228:231], v[168:171]
  ds_read_b128 v[132:135], v7
  v_add_f32 v136, v136, v64
  v_mfma_f32_16x16x32_bf16 v[168:171], a[132:135], v[232:235], v[168:171]
  v_fmac_f32 v94, v64, v64
  v_add_f32 v136, v136, v65
  v_mfma_f32_16x16x32_bf16 v[168:171], a[136:139], v[236:239], v[168:171]
  v_fmac_f32 v94, v65, v65
  v_add_f32 v136, v136, v66
  v_mfma_f32_16x16x32_bf16 v[168:171], a[140:143], v[240:243], v[168:171]
  ds_read_b128 v[160:163], v4 offset:32
  ds_read_b128 v[164:167], v4 offset:896
  v_mfma_f32_16x16x32_bf16 v[244:247], a[0:3], v[220:223], 0
  ds_read_b128 v[150:153], v4 offset:1760
  v_fmac_f32 v94, v66, v66
  v_mfma_f32_16x16x32_bf16 v[244:247], a[4:7], v[224:227], v[244:247]
  ds_read_b128 v[154:157], v7 offset:32
  v_cvt_pk_bf16_f32 v196, v168, v169
  v_mfma_f32_16x16x32_bf16 v[244:247], a[8:11], v[228:231], v[244:247]
  v_cvt_pk_bf16_f32 v197, v170, v171
  v_add_f32 v136, v136, v67
  v_mfma_f32_16x16x32_bf16 v[244:247], a[12:15], v[232:235], v[244:247]
  v_fmac_f32 v94, v67, v67
  v_add_f32 v136, v136, v68
  v_mfma_f32_16x16x32_bf16 v[244:247], a[16:19], v[236:239], v[244:247]
  ds_read_b128 v[168:171], v4 offset:64
  ds_read_b128 v[172:175], v4 offset:928
  v_mfma_f32_16x16x32_bf16 v[244:247], a[20:23], v[240:243], v[244:247]
  s_waitcnt lgkmcnt(8)
  ds_read_b128 v[176:179], v4 offset:1792
  v_fmac_f32 v94, v68, v68
  v_add_f32 v136, v136, v69
  v_mfma_f32_16x16x16_bf16 v[70:73], a[224:225], v[114:115], 0
  v_fmac_f32 v94, v69, v69
  v_mfma_f32_16x16x16_bf16 v[74:77], a[234:235], v[198:199], 0
  ds_read_b128 v[180:183], v7 offset:64
  v_cvt_pk_bf16_f32 v114, v244, v245
  v_cvt_pk_bf16_f32 v115, v246, v247
  v_mfma_f32_16x16x16_bf16 v[78:81], a[244:245], v[158:159], 0
  v_permlane32_swap_b32 v136, v94
  v_add_f32 v136, v136, v94
  v_smfmac_f32_16x16x64_bf16 v[70:73], a[216:219], v[120:127], v0
  s_waitcnt lgkmcnt(8)
  v_smfmac_f32_16x16x64_bf16 v[70:73], a[220:223], v[128:135], v0
  v_mfma_f32_16x16x32_bf16 v[128:131], a[24:27], v[220:223], 0
  v_mfma_f32_16x16x32_bf16 v[128:131], a[28:31], v[224:227], v[128:131]
  v_mul_f32 v96, v70, v70
  v_add_f32 v98, v70, v71
  v_mfma_f32_16x16x32_bf16 v[128:131], a[32:35], v[228:231], v[128:131]
  s_waitcnt lgkmcnt(6)
  v_fmac_f32 v96, v71, v71
  v_add_f32 v98, v98, v72
  v_smfmac_f32_16x16x64_bf16 v[74:77], a[226:229], v[160:167], v0
  s_waitcnt lgkmcnt(4)
  v_fmac_f32 v96, v72, v72
  v_smfmac_f32_16x16x64_bf16 v[74:77], a[230:233], v[150:157], v0
  v_add_f32 v98, v98, v73
  v_mfma_f32_16x16x32_bf16 v[128:131], a[36:39], v[232:235], v[128:131]
  v_fmac_f32 v96, v73, v73
  v_mfma_f32_16x16x32_bf16 v[128:131], a[40:43], v[236:239], v[128:131]
  v_add_f32 v98, v98, v74
  v_fmac_f32 v96, v74, v74
  v_mfma_f32_16x16x32_bf16 v[128:131], a[44:47], v[240:243], v[128:131]
  s_waitcnt lgkmcnt(2)
  ds_read_b64 v[158:159], v11
  v_add_f32 v98, v98, v75
  v_smfmac_f32_16x16x64_bf16 v[78:81], a[236:239], v[168:175], v0
  s_waitcnt lgkmcnt(1)
  ds_read_b64 v[198:199], v11 offset:32
  v_fmac_f32 v96, v75, v75
  v_smfmac_f32_16x16x64_bf16 v[78:81], a[240:243], v[176:183], v0
  ds_read_b64 v[94:95], v11 offset:64
  v_cvt_pk_bf16_f32 v116, v128, v129
  v_mfma_f32_16x16x32_bf16 v[132:135], a[48:51], v[220:223], 0
  ds_read_b128 v[176:179], v5
  ds_read_b128 v[180:183], v5 offset:864
  v_mfma_f32_16x16x32_bf16 v[132:135], a[52:55], v[224:227], v[132:135]
  ds_read_b128 v[168:171], v5 offset:1728
  v_cvt_pk_bf16_f32 v117, v130, v131
  v_mfma_f32_16x16x32_bf16 v[132:135], a[56:59], v[228:231], v[132:135]
  ds_read_b128 v[172:175], v8
  v_add_f32 v98, v98, v76
  v_mfma_f32_16x16x32_bf16 v[132:135], a[60:63], v[232:235], v[132:135]
  v_fmac_f32 v96, v76, v76
  v_add_f32 v98, v98, v77
  v_mfma_f32_16x16x32_bf16 v[132:135], a[64:67], v[236:239], v[132:135]
  v_fmac_f32 v96, v77, v77
  v_add_f32 v98, v98, v78
  v_mfma_f32_16x16x32_bf16 v[132:135], a[68:71], v[240:243], v[132:135]
  ds_read_b128 v[160:163], v5 offset:32
  ds_read_b128 v[164:167], v5 offset:896
  v_mfma_f32_16x16x32_bf16 v[244:247], v[220:223], a[144:147], 0
  ds_read_b128 v[150:153], v5 offset:1760
  v_fmac_f32 v96, v78, v78
  v_mfma_f32_16x16x32_bf16 v[244:247], v[224:227], a[148:151], v[244:247]
  ds_read_b128 v[154:157], v8 offset:32
  v_cvt_pk_bf16_f32 v118, v132, v133
  v_mfma_f32_16x16x32_bf16 v[244:247], v[228:231], a[152:155], v[244:247]
  v_cvt_pk_bf16_f32 v119, v134, v135
  v_add_f32 v98, v98, v79
  v_mfma_f32_16x16x32_bf16 v[244:247], v[232:235], a[156:159], v[244:247]
  v_fmac_f32 v96, v79, v79
  v_add_f32 v98, v98, v80
  v_mfma_f32_16x16x32_bf16 v[244:247], v[236:239], a[160:163], v[244:247]
  ds_read_b128 v[128:131], v5 offset:64
  ds_read_b128 v[132:135], v5 offset:928
  v_mfma_f32_16x16x32_bf16 v[244:247], v[240:243], a[164:167], v[244:247]
  s_waitcnt lgkmcnt(8)
  ds_read_b128 v[120:123], v5 offset:1792
  v_fmac_f32 v96, v80, v80
  v_add_f32 v98, v98, v81
  v_mfma_f32_16x16x16_bf16 v[82:85], a[224:225], v[158:159], 0
  v_fmac_f32 v96, v81, v81
  v_mfma_f32_16x16x16_bf16 v[86:89], a[234:235], v[198:199], 0
  ds_read_b128 v[124:127], v8 offset:64
  v_permlane32_swap_b32 v98, v96
  v_mfma_f32_16x16x16_bf16 v[90:93], a[244:245], v[94:95], 0
  v_add_f32 v98, v98, v96
  v_cvt_pk_bf16_f32 v206, v244, v245
  v_cvt_pk_bf16_f32 v207, v246, v247
  v_smfmac_f32_16x16x64_bf16 v[82:85], a[216:219], v[176:183], v0
  s_waitcnt lgkmcnt(8)
  v_smfmac_f32_16x16x64_bf16 v[82:85], a[220:223], v[168:175], v0
  v_mfma_f32_16x16x32_bf16 v[168:171], v[220:223], a[168:171], 0
  v_permlane16_swap_b32 v136, v98
  v_mfma_f32_16x16x32_bf16 v[168:171], v[224:227], a[172:175], v[168:171]
  s_waitcnt lgkmcnt(0)
  buffer_load_dwordx4 v137, s[4:7], s36 offen lds
  v_mfma_f32_16x16x32_bf16 v[168:171], v[228:231], a[176:179], v[168:171]
  buffer_load_dwordx4 v137, s[4:7], s37 offen offset:864 lds
  v_smfmac_f32_16x16x64_bf16 v[86:89], a[226:229], v[160:167], v0
  ds_read_b128 v[172:175], v15 offset:14336
  v_mul_f32 v96, v82, v82
  v_smfmac_f32_16x16x64_bf16 v[86:89], a[230:233], v[150:157], v0
  ds_read_b128 v[176:179], v15 offset:15360
  v_add_f32 v150, v82, v83
  v_mfma_f32_16x16x32_bf16 v[168:171], v[232:235], a[180:183], v[168:171]
  ds_read_b128 v[180:183], v15 offset:16384
  v_fmac_f32 v96, v83, v83
  v_mfma_f32_16x16x32_bf16 v[168:171], v[236:239], a[184:187], v[168:171]
  ds_read_b128 v[244:247], v15 offset:17408
  v_add_f32 v150, v150, v84
  v_mfma_f32_16x16x32_bf16 v[168:171], v[240:243], a[188:191], v[168:171]
  ds_read_b128 v[156:159], v15 offset:18432
  v_fmac_f32 v96, v84, v84
  v_smfmac_f32_16x16x64_bf16 v[90:93], a[236:239], v[128:135], v0
  ds_read_b128 v[128:131], v15 offset:19456
  v_add_f32 v150, v150, v85
  v_smfmac_f32_16x16x64_bf16 v[90:93], a[240:243], v[120:127], v0
  buffer_load_dwordx4 v137, s[4:7], s38 offen offset:1728 lds
  v_mfma_f32_16x16x32_bf16 v[160:163], v[220:223], a[192:195], 0
  buffer_load_dwordx4 v137, s[4:7], s39 offen offset:2592 lds
  v_mfma_f32_16x16x32_bf16 v[160:163], v[224:227], a[196:199], v[160:163]
  buffer_load_dwordx4 v137, s[4:7], s40 offen offset:3456 lds
  v_mfma_f32_16x16x32_bf16 v[160:163], v[228:231], a[200:203], v[160:163]
  s_mov_b32 m0, s59
  v_fmac_f32 v96, v85, v85
  v_add_f32 v150, v150, v86
  v_mfma_f32_16x16x32_bf16 v[160:163], v[232:235], a[204:207], v[160:163]
  s_mov_b32 s32, s33
  buffer_load_dwordx4 v137, s[4:7], s41 offen lds
  v_mfma_f32_16x16x32_bf16 v[160:163], v[236:239], a[208:211], v[160:163]
  s_mov_b32 s33, s34
  v_fmac_f32 v96, v86, v86
  v_add_f32 v150, v150, v87
  v_mfma_f32_16x16x32_bf16 v[160:163], v[240:243], a[212:215], v[160:163]
  s_mov_b32 s34, s35
  v_fmac_f32 v96, v87, v87
  v_add_f32 v150, v150, v88
  v_fmac_f32 v96, v88, v88
  v_mfma_f32_16x16x16_bf16 v[164:167], v[196:197], v[142:143], 0
  v_add_f32 v150, v150, v89
  v_fmac_f32 v96, v89, v89
  v_add_f32 v150, v150, v90
  v_mfma_f32_16x16x16_bf16 v[120:123], v[148:149], v[118:119], 0
  v_fmac_f32 v96, v90, v90
  v_add_f32 v150, v150, v91
  v_fmac_f32 v96, v91, v91
  v_add_f32 v150, v150, v92
  v_mfma_f32_16x16x32_bf16 v[164:167], v[192:195], v[138:141], v[164:167]
  v_fmac_f32 v96, v92, v92
  v_add_f32 v150, v150, v93
  v_mfma_f32_16x16x32_bf16 v[120:123], v[144:147], v[114:117], v[120:123]
  s_waitcnt lgkmcnt(5)
  v_fmac_f32 v96, v93, v93
  v_add_f32 v136, v136, v98
  v_mfma_f32_16x16x32_bf16 v[240:243], a[72:75], v[172:175], 0
  s_waitcnt lgkmcnt(4)
  ds_write_b32 v97, v136
  v_mfma_f32_16x16x32_bf16 v[240:243], a[76:79], v[176:179], v[240:243]
  s_waitcnt lgkmcnt(4)
  v_permlane32_swap_b32 v150, v96
  v_mfma_f32_16x16x32_bf16 v[240:243], a[80:83], v[180:183], v[240:243]
  s_waitcnt lgkmcnt(3)
  v_add_f32 v150, v150, v96
  v_mov_b32 v236, v150
  v_mfma_f32_16x16x32_bf16 v[240:243], a[84:87], v[244:247], v[240:243]
  s_waitcnt lgkmcnt(2)
  v_permlane16_swap_b32 v150, v236
  v_mfma_f32_16x16x32_bf16 v[240:243], a[88:91], v[156:159], v[240:243]
  s_waitcnt lgkmcnt(1)
  v_add_f32 v150, v150, v236
  v_cvt_pk_bf16_f32 v210, v168, v169
  v_mfma_f32_16x16x32_bf16 v[240:243], a[92:95], v[128:131], v[240:243]
  ds_write_b32 v97, v150 offset:512
  v_mfma_f32_16x16x32_bf16 v[236:239], a[96:99], v[172:175], 0
  buffer_load_dwordx4 v137, s[4:7], s42 offen offset:864 lds
  v_mfma_f32_16x16x32_bf16 v[236:239], a[100:103], v[176:179], v[236:239]
  buffer_load_dwordx4 v137, s[4:7], s43 offen offset:1728 lds
  v_mfma_f32_16x16x32_bf16 v[236:239], a[104:107], v[180:183], v[236:239]
  buffer_load_dwordx4 v137, s[4:7], s44 offen offset:2592 lds
  v_mfma_f32_16x16x32_bf16 v[236:239], a[108:111], v[244:247], v[236:239]
  v_cvt_pk_bf16_f32 v150, v240, v241
  v_cvt_pk_bf16_f32 v151, v242, v243
  v_mfma_f32_16x16x32_bf16 v[236:239], a[112:115], v[156:159], v[236:239]
  v_exp_f32 v164, v164
  v_mfma_f32_16x16x32_bf16 v[236:239], a[116:119], v[128:131], v[236:239]
  s_waitcnt lgkmcnt(0)
  s_barrier
  v_mfma_f32_16x16x32_bf16 v[240:243], a[120:123], v[172:175], 0
  ds_read_b128 v[124:127], v15
  ds_read_b128 v[132:135], v15 offset:1024
  v_mfma_f32_16x16x32_bf16 v[240:243], a[124:127], v[176:179], v[240:243]
  v_cvt_pk_bf16_f32 v152, v236, v237
  v_cvt_pk_bf16_f32 v153, v238, v239
  v_mfma_f32_16x16x32_bf16 v[240:243], a[128:131], v[180:183], v[240:243]
  v_exp_f32 v165, v165
  v_mfma_f32_16x16x32_bf16 v[240:243], a[132:135], v[244:247], v[240:243]
  v_exp_f32 v166, v166
  v_mfma_f32_16x16x32_bf16 v[240:243], a[136:139], v[156:159], v[240:243]
  v_exp_f32 v167, v167
  v_mfma_f32_16x16x32_bf16 v[240:243], a[140:143], v[128:131], v[240:243]
  v_cvt_pk_bf16_f32 v202, v164, v165
  v_cvt_pk_bf16_f32 v203, v166, v167
  v_cvt_pk_bf16_f32 v211, v170, v171
  v_mfma_f32_16x16x16_bf16 v[168:171], v[196:197], v[118:119], 0
  v_cvt_pk_bf16_f32 v214, v160, v161
  v_cvt_pk_bf16_f32 v215, v162, v163
  v_mfma_f32_16x16x16_bf16 v[236:239], v[196:197], v[188:189], 0
  ds_read_b64 v[164:165], v19 offset:16
  ds_read2_b64 v[160:163], v19 offset0:0 offset1:1
  v_cvt_pk_bf16_f32 v154, v240, v241
  v_cvt_pk_bf16_f32 v155, v242, v243
  v_mfma_f32_16x16x32_bf16 v[168:171], v[192:195], v[114:117], v[168:171]
  s_waitcnt lgkmcnt(2)
  v_add_f32 v124, v124, v125
  v_add_f32 v126, v126, v127
  v_mfma_f32_16x16x32_bf16 v[236:239], v[192:195], v[184:187], v[236:239]
  v_add_f32 v132, v132, v133
  v_add_f32 v134, v134, v135
  v_mfma_f32_16x16x32_bf16 v[240:243], v[172:175], a[144:147], 0
  v_add_f32 v124, v124, v126
  v_add_f32 v132, v132, v134
  v_mfma_f32_16x16x32_bf16 v[240:243], v[176:179], a[148:151], v[240:243]
  v_mul_f32 v125, 0x3baaaaab, v124
  v_fma_f32 v132, -v125, v124, v132
  v_mfma_f32_16x16x32_bf16 v[240:243], v[180:183], a[152:155], v[240:243]
  v_max_f32 v132, 0, v132
  v_add_f32 v132, 0x3afba882, v132
  v_mfma_f32_16x16x32_bf16 v[240:243], v[244:247], a[156:159], v[240:243]
  v_rsq_f32 v132, v132
  v_mfma_f32_16x16x32_bf16 v[240:243], v[156:159], a[160:163], v[240:243]
  v_mul_f32 v132, 0x40ca568a, v132
  v_mul_f32 v133, -v125, v132
  v_mfma_f32_16x16x32_bf16 v[240:243], v[128:131], a[164:167], v[240:243]
  ds_write_b64 v101, v[132:133]
  v_mfma_f32_16x16x32_bf16 v[124:127], v[172:175], a[168:171], 0
  ds_read_b64 v[166:167], v105 offset:768
  v_add_u32 v19, 1152, v19
  v_mfma_f32_16x16x32_bf16 v[124:127], v[176:179], a[172:175], v[124:127]
  v_cvt_pk_bf16_f32 v94, v240, v241
  v_cvt_pk_bf16_f32 v95, v242, v243
  v_mfma_f32_16x16x32_bf16 v[124:127], v[180:183], a[176:179], v[124:127]
  v_exp_f32 v120, v120
  v_mfma_f32_16x16x32_bf16 v[124:127], v[244:247], a[180:183], v[124:127]
  v_exp_f32 v121, v121
  v_mfma_f32_16x16x32_bf16 v[124:127], v[156:159], a[184:187], v[124:127]
  v_exp_f32 v122, v122
  v_mfma_f32_16x16x32_bf16 v[124:127], v[128:131], a[188:191], v[124:127]
  s_waitcnt lgkmcnt(3)
  v_exp_f32 v123, v123
  v_cvt_pk_bf16_f32 v132, v120, v121
  v_mfma_f32_16x16x16_bf16 v[240:243], v[154:155], v[142:143], 0
  v_exp_f32 v168, v168
  v_cvt_pk_bf16_f32 v133, v122, v123
  v_mfma_f32_16x16x16_bf16 v[120:123], v[164:165], v[142:143], v[2:5]
  v_cvt_pk_bf16_f32 v98, v124, v125
  v_cvt_pk_bf16_f32 v99, v126, v127
  v_exp_f32 v169, v169
  v_mfma_f32_16x16x32_bf16 v[240:243], v[150:153], v[138:141], v[240:243]
  s_waitcnt lgkmcnt(0)
  v_exp_f32 v170, v170
  v_mfma_f32_16x16x32_bf16 v[120:123], v[160:163], v[138:141], v[120:123]
  v_exp_f32 v171, v171
  v_mfma_f32_16x16x32_bf16 v[140:143], v[172:175], a[192:195], 0
  v_exp_f32 v240, v240
  v_mfma_f32_16x16x32_bf16 v[140:143], v[176:179], a[196:199], v[140:143]
  v_exp_f32 v241, v241
  v_mfma_f32_16x16x32_bf16 v[140:143], v[180:183], a[200:203], v[140:143]
  ds_read_u16 v96, v20
  v_cvt_pk_bf16_f32 v106, v240, v241
  v_mfma_f32_16x16x32_bf16 v[140:143], v[244:247], a[204:207], v[140:143]
  v_exp_f32 v242, v242
  v_mfma_f32_16x16x32_bf16 v[140:143], v[156:159], a[208:211], v[140:143]
  ds_read_u16 v100, v20 offset:32
  v_cvt_pk_bf16_f32 v134, v168, v169
  v_mfma_f32_16x16x32_bf16 v[140:143], v[128:131], a[212:215], v[140:143]
  v_exp_f32 v243, v243
  v_cvt_pk_bf16_f32 v135, v170, v171
  v_mfma_f32_16x16x16_bf16 v[124:127], v[154:155], v[118:119], 0
  v_exp_f32 v120, v120
  v_cvt_pk_bf16_f32 v107, v242, v243
  v_mfma_f32_16x16x16_bf16 v[136:139], v[164:165], v[118:119], v[2:5]
  v_cvt_pk_bf16_f32 v108, v120, 0
  v_cvt_pk_bf16_f32 v102, v140, v141
  v_cvt_pk_bf16_f32 v103, v142, v143
  v_fma_f32 v140, v58, v166, v167
  v_mfma_f32_16x16x32_bf16 v[124:127], v[150:153], v[114:117], v[124:127]
  ds_read_u16 v104, v20 offset:64
  v_fma_f32 v120, v59, v166, v167
  v_mfma_f32_16x16x32_bf16 v[136:139], v[160:163], v[114:117], v[136:139]
  v_fma_f32 v141, v60, v166, v167
  v_fma_f32 v121, v61, v166, v167
  v_mfma_f32_16x16x32_bf16 v[116:119], a[0:3], v[172:175], 0
  v_exp_f32 v124, v124
  v_mfma_f32_16x16x32_bf16 v[116:119], a[4:7], v[176:179], v[116:119]
  v_exp_f32 v125, v125
  v_mfma_f32_16x16x32_bf16 v[116:119], a[8:11], v[180:183], v[116:119]
  v_exp_f32 v126, v126
  v_mfma_f32_16x16x32_bf16 v[116:119], a[12:15], v[244:247], v[116:119]
  v_exp_f32 v127, v127
  v_mfma_f32_16x16x32_bf16 v[116:119], a[16:19], v[156:159], v[116:119]
  v_exp_f32 v136, v136
  v_mfma_f32_16x16x32_bf16 v[116:119], a[20:23], v[128:131], v[116:119]
  v_cvt_pk_bf16_f32 v110, v124, v125
  v_cvt_pk_bf16_f32 v111, v126, v127
  v_mfma_f32_16x16x32_bf16 v[240:243], a[246:249], v[200:203], 0
  v_cvt_pk_bf16_f32 v112, v136, 0
  v_fma_f32 v142, v62, v166, v167
  v_mfma_f32_16x16x32_bf16 v[240:243], a[246:249], v[106:109], v[240:243]
  v_fma_f32 v124, v63, v166, v167
  v_fma_f32 v143, v64, v166, v167
  v_mfma_f32_16x16x32_bf16 v[168:171], v[204:207], v[200:203], 0
  s_waitcnt lgkmcnt(2)
  v_fma_f32 v125, v65, v166, v167
  v_cvt_pk_bf16_f32 v140, v140, v120
  v_mfma_f32_16x16x32_bf16 v[168:171], v[94:97], v[106:109], v[168:171]
  v_cvt_pk_bf16_f32 v141, v141, v121
  v_cvt_pk_bf16_f32 v142, v142, v124
  v_mfma_f32_16x16x32_bf16 v[232:235], v[208:211], v[200:203], 0
  s_waitcnt lgkmcnt(1)
  v_cvt_pk_bf16_f32 v143, v143, v125
  v_fma_f32 v120, v66, v166, v167
  v_mfma_f32_16x16x32_bf16 v[232:235], v[98:101], v[106:109], v[232:235]
  ds_write_b128 v16, v[140:143] offset:2048
  v_mfma_f32_16x16x32_bf16 v[220:223], v[212:215], v[200:203], 0
  s_waitcnt lgkmcnt(1)
  v_fma_f32 v140, v67, v166, v167
  v_fma_f32 v121, v68, v166, v167
  v_mfma_f32_16x16x32_bf16 v[220:223], v[102:105], v[106:109], v[220:223]
  v_fma_f32 v141, v69, v166, v167
  v_cvt_pk_bf16_f32 v120, v120, v140
  v_mfma_f32_16x16x32_bf16 v[124:127], a[24:27], v[172:175], 0
  v_cvt_pk_bf16_f32 v121, v121, v141
  v_cvt_pk_bf16_f32 v138, v116, v117
  v_mfma_f32_16x16x32_bf16 v[124:127], a[28:31], v[176:179], v[124:127]
  ds_write_b64 v17, v[120:121] offset:2048
  v_mfma_f32_16x16x32_bf16 v[124:127], a[32:35], v[180:183], v[124:127]
  v_exp_f32 v236, v236
  v_mfma_f32_16x16x32_bf16 v[124:127], a[36:39], v[244:247], v[124:127]
  v_exp_f32 v237, v237
  v_mfma_f32_16x16x32_bf16 v[124:127], a[40:43], v[156:159], v[124:127]
  v_exp_f32 v238, v238
  v_mfma_f32_16x16x32_bf16 v[124:127], a[44:47], v[128:131], v[124:127]
  v_exp_f32 v239, v239
  v_cvt_pk_bf16_f32 v218, v236, v237
  v_mfma_f32_16x16x16_bf16 v[120:123], v[154:155], v[188:189], 0
  v_cvt_pk_bf16_f32 v219, v238, v239
  v_cvt_pk_bf16_f32 v139, v118, v119
  v_mul_f32 v240, 0x3ee9a3cd, v240
  v_mfma_f32_16x16x16_bf16 v[116:119], v[164:165], v[188:189], v[2:5]
  v_cvt_pk_bf16_f32 v140, v124, v125
  v_cvt_pk_bf16_f32 v141, v126, v127
  v_rcp_f32 v166, v240
  v_mfma_f32_16x16x32_bf16 v[120:123], v[150:153], v[184:187], v[120:123]
  v_mul_f32 v168, v168, v166
  v_mul_f32 v169, v169, v166
  v_mfma_f32_16x16x32_bf16 v[116:119], v[160:163], v[184:187], v[116:119]
  v_mul_f32 v170, v170, v166
  v_mul_f32 v171, v171, v166
  v_mfma_f32_16x16x32_bf16 v[184:187], a[246:249], v[132:135], 0
  v_exp_f32 v120, v120
  v_mfma_f32_16x16x32_bf16 v[184:187], a[246:249], v[110:113], v[184:187]
  v_exp_f32 v121, v121
  v_mfma_f32_16x16x32_bf16 v[236:239], v[204:207], v[132:135], 0
  v_exp_f32 v122, v122
  v_mfma_f32_16x16x32_bf16 v[236:239], v[94:97], v[110:113], v[236:239]
  v_exp_f32 v123, v123
  v_mfma_f32_16x16x32_bf16 v[200:203], v[208:211], v[132:135], 0
  v_exp_f32 v116, v116
  v_mfma_f32_16x16x32_bf16 v[200:203], v[98:101], v[110:113], v[200:203]
  v_cvt_pk_bf16_f32 v106, v120, v121
  v_cvt_pk_bf16_f32 v107, v122, v123
  v_mfma_f32_16x16x32_bf16 v[188:191], v[212:215], v[132:135], 0
  v_cvt_pk_bf16_f32 v108, v116, 0
  v_mul_f32 v184, 0x3ee9a3cd, v184
  v_mfma_f32_16x16x32_bf16 v[188:191], v[102:105], v[110:113], v[188:191]
  v_rcp_f32 v167, v184
  v_mfma_f32_16x16x32_bf16 v[132:135], a[48:51], v[172:175], 0
  v_mul_f32 v232, v232, v166
  v_mul_f32 v233, v233, v166
  v_mfma_f32_16x16x32_bf16 v[132:135], a[52:55], v[176:179], v[132:135]
  v_mul_f32 v234, v234, v166
  v_mul_f32 v235, v235, v166
  v_mfma_f32_16x16x32_bf16 v[132:135], a[56:59], v[180:183], v[132:135]
  v_mul_f32 v236, v236, v167
  v_mul_f32 v237, v237, v167
  v_mfma_f32_16x16x32_bf16 v[132:135], a[60:63], v[244:247], v[132:135]
  v_mul_f32 v238, v238, v167
  v_mul_f32 v239, v239, v167
  v_mfma_f32_16x16x32_bf16 v[132:135], a[64:67], v[156:159], v[132:135]
  v_mul_f32 v200, v200, v167
  v_mul_f32 v201, v201, v167
  v_mfma_f32_16x16x32_bf16 v[132:135], a[68:71], v[128:131], v[132:135]
  s_waitcnt lgkmcnt(0)
  s_barrier
  v_mfma_f32_16x16x32_bf16 v[156:159], v[216:219], a[246:249], 0
  ds_read_b128 v[114:117], v15 offset:2048
  ds_read_b128 v[118:121], v15 offset:3072
  v_mfma_f32_16x16x32_bf16 v[156:159], v[106:109], a[246:249], v[156:159]
  ds_read_b128 v[122:125], v15 offset:4096
  v_cvt_pk_bf16_f32 v142, v132, v133
  v_mfma_f32_16x16x32_bf16 v[244:247], v[216:219], v[204:207], 0
  ds_read_b128 v[126:129], v15 offset:5120
  v_cvt_pk_bf16_f32 v143, v134, v135
  v_mfma_f32_16x16x32_bf16 v[244:247], v[106:109], v[94:97], v[244:247]
  ds_read_b128 v[130:133], v15 offset:6144
  v_mul_f32 v202, v202, v167
  v_mfma_f32_16x16x32_bf16 v[180:183], v[216:219], v[208:211], 0
  ds_read_b128 v[134:137], v15 offset:7168
  v_mul_f32 v203, v203, v167
  v_mfma_f32_16x16x32_bf16 v[180:183], v[106:109], v[98:101], v[180:183]
  v_cvt_pk_bf16_f32 v176, v168, v169
  v_cvt_pk_bf16_f32 v177, v170, v171
  v_mfma_f32_16x16x32_bf16 v[168:171], v[216:219], v[212:215], 0
  v_cvt_pk_bf16_f32 v178, v232, v233
  v_cvt_pk_bf16_f32 v179, v234, v235
  v_mfma_f32_16x16x32_bf16 v[168:171], v[106:109], v[102:105], v[168:171]
  ds_write_b128 v16, v[176:179] offset:20480
  v_mfma_f32_16x16x16_bf16 v[176:179], v[148:149], v[142:143], 0
  v_cvt_pk_bf16_f32 v232, v236, v237
  v_cvt_pk_bf16_f32 v233, v238, v239
  v_cvt_pk_bf16_f32 v234, v200, v201
  v_mfma_f32_16x16x16_bf16 v[236:239], v[196:197], v[142:143], 0
  v_mul_f32 v156, 0x3ee9a3cd, v156
  v_cvt_pk_bf16_f32 v235, v202, v203
  v_cndmask_b32 v200, v180, v244, s[54:55]
  v_mfma_f32_16x16x16_bf16 v[180:183], v[154:155], v[142:143], 0
  v_rcp_f32 v201, v156
  v_mul_f32 v220, v220, v166
  v_mfma_f32_16x16x16_bf16 v[244:247], v[164:165], v[142:143], v[2:5]
  v_mul_f32 v221, v221, v166
  v_mul_f32 v222, v222, v166
  v_mul_f32 v223, v223, v166
  v_mul_f32 v188, v188, v167
  v_mfma_f32_16x16x32_bf16 v[176:179], v[144:147], v[138:141], v[176:179]
  ds_write_b128 v16, v[232:235] offset:26624
  v_mfma_f32_16x16x32_bf16 v[236:239], v[192:195], v[138:141], v[236:239]
  s_nop 3
  v_exp_f32 v176, v176
  v_mfma_f32_16x16x32_bf16 v[180:183], v[150:153], v[138:141], v[180:183]
  v_exp_f32 v177, v177
  v_mfma_f32_16x16x32_bf16 v[244:247], v[160:163], v[138:141], v[244:247]
  s_waitcnt lgkmcnt(7)
  v_exp_f32 v178, v178
  v_mfma_f32_16x16x32_bf16 v[148:151], a[0:3], v[114:117], 0
  s_waitcnt lgkmcnt(6)
  v_exp_f32 v179, v179
  v_mfma_f32_16x16x32_bf16 v[148:151], a[4:7], v[118:121], v[148:151]
  s_waitcnt lgkmcnt(5)
  v_exp_f32 v236, v236
  v_mfma_f32_16x16x32_bf16 v[148:151], a[8:11], v[122:125], v[148:151]
  s_waitcnt lgkmcnt(4)
  v_exp_f32 v237, v237
  v_mfma_f32_16x16x32_bf16 v[148:151], a[12:15], v[126:129], v[148:151]
  s_waitcnt lgkmcnt(3)
  v_exp_f32 v238, v238
  v_mfma_f32_16x16x32_bf16 v[148:151], a[16:19], v[130:133], v[148:151]
  s_waitcnt lgkmcnt(2)
  v_exp_f32 v239, v239
  v_mfma_f32_16x16x32_bf16 v[148:151], a[20:23], v[134:137], v[148:151]
  v_exp_f32 v180, v180
  v_mfma_f32_16x16x32_bf16 v[144:147], a[24:27], v[114:117], 0
  v_exp_f32 v181, v181
  v_mfma_f32_16x16x32_bf16 v[144:147], a[28:31], v[118:121], v[144:147]
  v_exp_f32 v182, v182
  v_mfma_f32_16x16x32_bf16 v[144:147], a[32:35], v[122:125], v[144:147]
  v_exp_f32 v183, v183
  v_mfma_f32_16x16x32_bf16 v[144:147], a[36:39], v[126:129], v[144:147]
  v_exp_f32 v244, v244
  v_mfma_f32_16x16x32_bf16 v[144:147], a[40:43], v[130:133], v[144:147]
  v_cvt_pk_bf16_f32 v140, v176, v177
  v_cvt_pk_bf16_f32 v141, v178, v179
  v_mfma_f32_16x16x32_bf16 v[144:147], a[44:47], v[134:137], v[144:147]
  v_cvt_pk_bf16_f32 v142, v236, v237
  v_cvt_pk_bf16_f32 v143, v238, v239
  v_mfma_f32_16x16x32_bf16 v[236:239], a[48:51], v[114:117], 0
  v_cvt_pk_bf16_f32 v110, v180, v181
  v_cvt_pk_bf16_f32 v111, v182, v183
  v_mfma_f32_16x16x32_bf16 v[236:239], a[52:55], v[118:121], v[236:239]
  v_cvt_pk_bf16_f32 v112, v244, 0
  v_mul_f32 v189, v189, v167
  v_mfma_f32_16x16x32_bf16 v[236:239], a[56:59], v[122:125], v[236:239]
  v_mul_f32 v190, v190, v167
  v_mul_f32 v191, v191, v167
  v_mfma_f32_16x16x32_bf16 v[236:239], a[60:63], v[126:129], v[236:239]
  v_cndmask_b32 v200, v168, v200, s[56:57]
  v_cvt_pk_bf16_f32 v138, v220, v221
  v_mfma_f32_16x16x32_bf16 v[236:239], a[64:67], v[130:133], v[236:239]
  v_cvt_pk_bf16_f32 v139, v222, v223
  v_cvt_pk_bf16_f32 v152, v188, v189
  v_mfma_f32_16x16x32_bf16 v[236:239], a[68:71], v[134:137], v[236:239]
  ds_write_b64 v17, v[138:139] offset:20480
  v_mfma_f32_16x16x32_bf16 v[220:223], a[246:249], v[140:143], 0
  v_cvt_pk_bf16_f32 v153, v190, v191
  v_mul_f32 v200, v200, v201
  v_mfma_f32_16x16x32_bf16 v[220:223], a[246:249], v[110:113], v[220:223]
  ds_write_b64 v17, v[152:153] offset:26624
  v_mfma_f32_16x16x32_bf16 v[188:191], v[204:207], v[140:143], 0
  v_cvt_pk_bf16_f32 v200, v200, v200
  v_max3_f32 v1, v1, v240, v166
  v_mfma_f32_16x16x32_bf16 v[188:191], v[94:97], v[110:113], v[188:191]
  ds_write_b16 v20, v200 offset:384
  v_mfma_f32_16x16x32_bf16 v[240:243], v[208:211], v[140:143], 0
  v_mul_f32 v220, 0x3ee9a3cd, v220
  v_max3_f32 v1, v1, v184, v167
  v_mfma_f32_16x16x32_bf16 v[240:243], v[98:101], v[110:113], v[240:243]
  v_rcp_f32 v98, v220
  v_mfma_f32_16x16x32_bf16 v[184:187], v[212:215], v[140:143], 0
  v_mul_f32 v188, v188, v98
  v_mul_f32 v189, v189, v98
  v_mfma_f32_16x16x32_bf16 v[184:187], v[102:105], v[110:113], v[184:187]
  v_mul_f32 v190, v190, v98
  v_mul_f32 v191, v191, v98
  v_mfma_f32_16x16x32_bf16 v[212:215], a[72:75], v[114:117], 0
  v_mul_f32 v240, v240, v98
  v_mul_f32 v241, v241, v98
  v_mfma_f32_16x16x32_bf16 v[212:215], a[76:79], v[118:121], v[212:215]
  v_mul_f32 v242, v242, v98
  v_mul_f32 v243, v243, v98
  v_mfma_f32_16x16x32_bf16 v[212:215], a[80:83], v[122:125], v[212:215]
  v_cvt_pk_bf16_f32 v140, v188, v189
  v_cvt_pk_bf16_f32 v141, v190, v191
  v_mfma_f32_16x16x32_bf16 v[212:215], a[84:87], v[126:129], v[212:215]
  v_cvt_pk_bf16_f32 v142, v240, v241
  v_cvt_pk_bf16_f32 v143, v242, v243
  v_mfma_f32_16x16x32_bf16 v[212:215], a[88:91], v[130:133], v[212:215]
  ds_write_b128 v16, v[140:143] offset:32768
  v_mfma_f32_16x16x32_bf16 v[212:215], a[92:95], v[134:137], v[212:215]
  v_mul_f32 v184, v184, v98
  v_mul_f32 v185, v185, v98
  v_mfma_f32_16x16x32_bf16 v[240:243], a[96:99], v[114:117], 0
  v_mul_f32 v186, v186, v98
  v_mul_f32 v187, v187, v98
  v_mfma_f32_16x16x32_bf16 v[240:243], a[100:103], v[118:121], v[240:243]
  v_cvt_pk_bf16_f32 v140, v184, v185
  v_cvt_pk_bf16_f32 v141, v186, v187
  v_mfma_f32_16x16x32_bf16 v[240:243], a[104:107], v[122:125], v[240:243]
  ds_write_b64 v17, v[140:141] offset:32768
  v_mfma_f32_16x16x32_bf16 v[240:243], a[108:111], v[126:129], v[240:243]
  v_max3_f32 v1, v1, v156, v201
  v_cvt_pk_bf16_f32 v138, v148, v149
  v_mfma_f32_16x16x32_bf16 v[240:243], a[112:115], v[130:133], v[240:243]
  v_cvt_pk_bf16_f32 v139, v150, v151
  v_cvt_pk_bf16_f32 v140, v144, v145
  v_mfma_f32_16x16x32_bf16 v[240:243], a[116:119], v[134:137], v[240:243]
  v_cvt_pk_bf16_f32 v141, v146, v147
  v_cvt_pk_bf16_f32 v142, v236, v237
  v_mfma_f32_16x16x32_bf16 v[150:153], a[120:123], v[114:117], 0
  v_cvt_pk_bf16_f32 v143, v238, v239
  v_add_u32 v20, 1152, v20
  v_mfma_f32_16x16x32_bf16 v[150:153], a[124:127], v[118:121], v[150:153]
  v_cvt_pk_bf16_f32 v144, v212, v213
  v_cvt_pk_bf16_f32 v145, v214, v215
  v_mfma_f32_16x16x32_bf16 v[150:153], a[128:131], v[122:125], v[150:153]
  v_max3_f32 v1, v1, v220, v98
  v_cvt_pk_bf16_f32 v146, v240, v241
  v_mfma_f32_16x16x32_bf16 v[150:153], a[132:135], v[126:129], v[150:153]
  v_cvt_pk_bf16_f32 v147, v242, v243
  v_mfma_f32_16x16x32_bf16 v[150:153], a[136:139], v[130:133], v[150:153]
  v_mfma_f32_16x16x32_bf16 v[150:153], a[140:143], v[134:137], v[150:153]
  s_waitcnt lgkmcnt(0)
  s_barrier
  s_mov_b32 s70, 10
.p2align 6
L_loop:
  v_mfma_f32_16x16x32_bf16 v[156:159], v[114:117], a[144:147], 0
  ds_read_b128 v[184:187], v15 offset:20480
  ds_read_b128 v[188:191], v18
  v_mfma_f32_16x16x32_bf16 v[156:159], v[118:121], a[148:151], v[156:159]
  ds_read_b128 v[160:163], v18 offset:1024
  v_cvt_pk_bf16_f32 v148, v150, v151
  v_mfma_f32_16x16x32_bf16 v[156:159], v[122:125], a[152:155], v[156:159]
  ds_read_b128 v[164:167], v15 offset:26624
  v_cvt_pk_bf16_f32 v149, v152, v153
  v_mfma_f32_16x16x32_bf16 v[156:159], v[126:129], a[156:159], v[156:159]
  ds_read_b128 v[150:153], v15 offset:32768
  v_mfma_f32_16x16x32_bf16 v[156:159], v[130:133], a[160:163], v[156:159]
  ds_read_b64 v[216:217], v105 offset:896
  ds_read_b64 v[218:219], v105 offset:1792
  v_mfma_f32_16x16x32_bf16 v[156:159], v[134:137], a[164:167], v[156:159]
  s_waitcnt lgkmcnt(6)
  v_mfma_f32_16x16x32_bf16 v[22:25], a[250:253], v[184:187], v[22:25]
  ds_read_b128 v[192:195], v18 offset:2048
  ds_read_b128 v[168:171], v15 offset:21504
  s_waitcnt lgkmcnt(7)
  v_mfma_f32_16x16x32_bf16 v[26:29], v[188:191], v[184:187], v[26:29]
  ds_read_b128 v[172:175], v18 offset:3072
  s_waitcnt lgkmcnt(7)
  v_mfma_f32_16x16x32_bf16 v[30:33], v[160:163], v[184:187], v[30:33]
  ds_read_b128 v[184:187], v18 offset:4096
  s_waitcnt lgkmcnt(7)
  v_mfma_f32_16x16x32_bf16 v[34:37], a[250:253], v[164:167], v[34:37]
  ds_read_b128 v[196:199], v15 offset:27648
  v_cvt_pk_bf16_f32 v200, v156, v157
  v_mfma_f32_16x16x32_bf16 v[38:41], v[188:191], v[164:167], v[38:41]
  s_waitcnt lgkmcnt(6)
  v_fma_f32 v176, v70, v216, v217
  v_fma_f32 v180, v71, v216, v217
  v_mfma_f32_16x16x32_bf16 v[42:45], v[160:163], v[164:167], v[42:45]
  s_waitcnt lgkmcnt(5)
  v_fma_f32 v177, v72, v216, v217
  v_fma_f32 v181, v73, v216, v217
  v_mfma_f32_16x16x32_bf16 v[46:49], a[250:253], v[150:153], v[46:49]
  ds_read_b128 v[164:167], v15 offset:33792
  v_fma_f32 v178, v74, v216, v217
  v_mfma_f32_16x16x32_bf16 v[50:53], v[188:191], v[150:153], v[50:53]
  v_fma_f32 v188, v75, v216, v217
  v_fma_f32 v179, v76, v216, v217
  v_mfma_f32_16x16x32_bf16 v[54:57], v[160:163], v[150:153], v[54:57]
  v_fma_f32 v189, v77, v216, v217
  v_fma_f32 v160, v82, v218, v219
  v_mfma_f32_16x16x32_bf16 v[150:153], v[114:117], a[168:171], 0
  v_fma_f32 v182, v83, v218, v219
  v_fma_f32 v161, v84, v218, v219
  v_mfma_f32_16x16x32_bf16 v[150:153], v[118:121], a[172:175], v[150:153]
  v_fma_f32 v212, v85, v218, v219
  v_fma_f32 v162, v86, v218, v219
  v_mfma_f32_16x16x32_bf16 v[150:153], v[122:125], a[176:179], v[150:153]
  v_fma_f32 v213, v87, v218, v219
  v_fma_f32 v163, v88, v218, v219
  v_mfma_f32_16x16x32_bf16 v[150:153], v[126:129], a[180:183], v[150:153]
  v_fma_f32 v190, v89, v218, v219
  v_cvt_pk_bf16_f32 v176, v176, v180
  v_mfma_f32_16x16x32_bf16 v[150:153], v[130:133], a[184:187], v[150:153]
  v_cvt_pk_bf16_f32 v177, v177, v181
  v_cvt_pk_bf16_f32 v178, v178, v188
  v_mfma_f32_16x16x32_bf16 v[150:153], v[134:137], a[188:191], v[150:153]
  s_waitcnt lgkmcnt(4)
  v_cvt_pk_bf16_f32 v179, v179, v189
  v_cvt_pk_bf16_f32 v160, v160, v182
  v_mfma_f32_16x16x32_bf16 v[22:25], v[192:195], v[168:171], v[22:25]
  s_waitcnt lgkmcnt(3)
  ds_read_b128 v[180:183], v18 offset:5120
  ds_read_b128 v[204:207], v15 offset:22528
  v_mfma_f32_16x16x32_bf16 v[26:29], v[172:175], v[168:171], v[26:29]
  s_waitcnt lgkmcnt(4)
  ds_read_b128 v[208:211], v18 offset:6144
  v_cvt_pk_bf16_f32 v161, v161, v212
  v_mfma_f32_16x16x32_bf16 v[30:33], v[184:187], v[168:171], v[30:33]
  s_waitcnt lgkmcnt(4)
  ds_read_b128 v[168:171], v18 offset:7168
  v_cvt_pk_bf16_f32 v162, v162, v213
  v_mfma_f32_16x16x32_bf16 v[34:37], v[192:195], v[196:199], v[34:37]
  ds_read_b128 v[212:215], v15 offset:28672
  v_cvt_pk_bf16_f32 v163, v163, v190
  v_mfma_f32_16x16x32_bf16 v[38:41], v[172:175], v[196:199], v[38:41]
  ds_write_b128 v16, v[176:179] offset:8192
  v_mfma_f32_16x16x32_bf16 v[42:45], v[184:187], v[196:199], v[42:45]
  s_waitcnt lgkmcnt(6)
  v_fma_f32 v196, v78, v216, v217
  v_fma_f32 v198, v79, v216, v217
  v_mfma_f32_16x16x32_bf16 v[46:49], v[192:195], v[164:167], v[46:49]
  v_fma_f32 v197, v80, v216, v217
  v_fma_f32 v199, v81, v216, v217
  v_mfma_f32_16x16x32_bf16 v[50:53], v[172:175], v[164:167], v[50:53]
  ds_read_b128 v[192:195], v15 offset:34816
  v_fma_f32 v172, v90, v218, v219
  v_mfma_f32_16x16x32_bf16 v[54:57], v[184:187], v[164:167], v[54:57]
  ds_read_b64 v[188:189], v19 offset:784
  v_fma_f32 v216, v91, v218, v219
  v_mfma_f32_16x16x32_bf16 v[164:167], v[114:117], a[192:195], 0
  ds_read2_b64 v[184:187], v19 offset0:96 offset1:97
  v_fma_f32 v173, v92, v218, v219
  v_mfma_f32_16x16x32_bf16 v[164:167], v[118:121], a[196:199], v[164:167]
  ds_write_b128 v16, v[160:163] offset:14336
  v_mfma_f32_16x16x32_bf16 v[164:167], v[122:125], a[200:203], v[164:167]
  v_fma_f32 v122, v93, v218, v219
  v_cvt_pk_bf16_f32 v196, v196, v198
  v_mfma_f32_16x16x32_bf16 v[164:167], v[126:129], a[204:207], v[164:167]
  v_cvt_pk_bf16_f32 v197, v197, v199
  v_cvt_pk_bf16_f32 v172, v172, v216
  v_mfma_f32_16x16x32_bf16 v[164:167], v[130:133], a[208:211], v[164:167]
  ds_read_b128 v[128:131], v18 offset:8192
  ds_read_b128 v[124:127], v15 offset:23552
  v_mfma_f32_16x16x32_bf16 v[164:167], v[134:137], a[212:215], v[164:167]
  s_waitcnt lgkmcnt(10)
  v_cvt_pk_bf16_f32 v173, v173, v122
  v_cvt_pk_bf16_f32 v201, v158, v159
  v_mfma_f32_16x16x32_bf16 v[22:25], v[180:183], v[204:207], v[22:25]
  s_waitcnt lgkmcnt(9)
  ds_read_b128 v[132:135], v18 offset:9216
  ds_read_b128 v[156:159], v18 offset:10240
  v_mfma_f32_16x16x32_bf16 v[26:29], v[208:211], v[204:207], v[26:29]
  s_waitcnt lgkmcnt(10)
  v_cvt_pk_bf16_f32 v216, v150, v151
  v_cvt_pk_bf16_f32 v217, v152, v153
  v_mfma_f32_16x16x32_bf16 v[30:33], v[168:171], v[204:207], v[30:33]
  s_waitcnt lgkmcnt(9)
  ds_read_b128 v[120:123], v15 offset:29696
  v_cvt_pk_bf16_f32 v204, v164, v165
  v_mfma_f32_16x16x32_bf16 v[34:37], v[180:183], v[212:215], v[34:37]
  ds_write_b64 v17, v[196:197] offset:8192
  v_mfma_f32_16x16x32_bf16 v[38:41], v[208:211], v[212:215], v[38:41]
  ds_read_b128 v[160:163], v15 offset:35840
  v_cvt_pk_bf16_f32 v205, v166, v167
  v_mfma_f32_16x16x32_bf16 v[42:45], v[168:171], v[212:215], v[42:45]
  s_waitcnt lgkmcnt(10)
  ds_write_b64 v17, v[172:173] offset:14336
  v_mfma_f32_16x16x32_bf16 v[46:49], v[180:183], v[192:195], v[46:49]
  v_mfma_f32_16x16x32_bf16 v[50:53], v[208:211], v[192:195], v[50:53]
  ds_read_b128 v[164:167], v18 offset:11264
  ds_read_b128 v[172:175], v15 offset:24576
  v_mfma_f32_16x16x32_bf16 v[54:57], v[168:171], v[192:195], v[54:57]
  s_waitcnt lgkmcnt(12)
  ds_read_b128 v[192:195], v18 offset:12288
  v_mfma_f32_16x16x16_bf16 v[168:171], v[148:149], v[142:143], 0
  ds_read_b128 v[150:153], v18 offset:13312
  v_mfma_f32_16x16x16_bf16 v[180:183], v[148:149], v[188:189], 0
  ds_read_b128 v[196:199], v15 offset:30720
  v_mfma_f32_16x16x32_bf16 v[168:171], v[144:147], v[138:141], v[168:171]
  s_waitcnt lgkmcnt(14)
  v_mfma_f32_16x16x32_bf16 v[180:183], v[144:147], v[184:187], v[180:183]
  s_waitcnt lgkmcnt(11)
  v_mfma_f32_16x16x32_bf16 v[22:25], v[128:131], v[124:127], v[22:25]
  s_waitcnt lgkmcnt(10)
  ds_read_b128 v[208:211], v15 offset:36864
  v_mfma_f32_16x16x32_bf16 v[26:29], v[132:135], v[124:127], v[26:29]
  s_waitcnt lgkmcnt(10)
  v_exp_f32 v168, v168
  v_mfma_f32_16x16x32_bf16 v[30:33], v[156:159], v[124:127], v[30:33]
  s_waitcnt lgkmcnt(9)
  v_exp_f32 v169, v169
  v_mfma_f32_16x16x32_bf16 v[34:37], v[128:131], v[120:123], v[34:37]
  ds_read_b128 v[124:127], v18 offset:14336
  ds_read_b128 v[116:119], v15 offset:25600
  v_mfma_f32_16x16x32_bf16 v[38:41], v[132:135], v[120:123], v[38:41]
  ds_read_b128 v[176:179], v18 offset:15360
  v_cvt_pk_bf16_f32 v212, v168, v169
  v_mfma_f32_16x16x32_bf16 v[42:45], v[156:159], v[120:123], v[42:45]
  s_waitcnt lgkmcnt(10)
  ds_read_b128 v[120:123], v18 offset:16384
  v_mfma_f32_16x16x32_bf16 v[46:49], v[128:131], v[160:163], v[46:49]
  ds_read_b128 v[128:131], v15 offset:31744
  v_mfma_f32_16x16x32_bf16 v[50:53], v[132:135], v[160:163], v[50:53]
  v_exp_f32 v170, v170
  v_mfma_f32_16x16x32_bf16 v[54:57], v[156:159], v[160:163], v[54:57]
  s_waitcnt lgkmcnt(9)
  v_exp_f32 v171, v171
  v_mfma_f32_16x16x32_bf16 v[22:25], v[164:167], v[172:175], v[22:25]
  s_waitcnt lgkmcnt(8)
  ds_read_b128 v[132:135], v15 offset:37888
  v_cvt_pk_bf16_f32 v213, v170, v171
  v_mfma_f32_16x16x32_bf16 v[26:29], v[192:195], v[172:175], v[26:29]
  s_waitcnt lgkmcnt(8)
  v_exp_f32 v180, v180
  v_mfma_f32_16x16x32_bf16 v[30:33], v[150:153], v[172:175], v[30:33]
  s_waitcnt lgkmcnt(7)
  v_exp_f32 v181, v181
  v_mfma_f32_16x16x32_bf16 v[34:37], v[164:167], v[196:199], v[34:37]
  v_exp_f32 v182, v182
  v_mfma_f32_16x16x32_bf16 v[38:41], v[192:195], v[196:199], v[38:41]
  v_exp_f32 v183, v183
  v_mfma_f32_16x16x32_bf16 v[42:45], v[150:153], v[196:199], v[42:45]
  s_waitcnt lgkmcnt(6)
  v_cvt_pk_bf16_f32 v220, v180, v181
  v_cvt_pk_bf16_f32 v221, v182, v183
  v_mfma_f32_16x16x32_bf16 v[46:49], v[164:167], v[208:211], v[46:49]
  v_mfma_f32_16x16x32_bf16 v[50:53], v[192:195], v[208:211], v[50:53]
  v_mfma_f32_16x16x32_bf16 v[54:57], v[150:153], v[208:211], v[54:57]
  s_waitcnt lgkmcnt(4)
  s_barrier
  v_mfma_f32_16x16x32_bf16 v[22:25], v[124:127], v[116:119], v[22:25]
  s_waitcnt lgkmcnt(3)
  ds_read_b128 v[208:211], v15 offset:8192
  ds_read_b128 v[224:227], v15 offset:9216
  v_mfma_f32_16x16x32_bf16 v[26:29], v[176:179], v[116:119], v[26:29]
  s_waitcnt lgkmcnt(4)
  ds_read_b128 v[228:231], v15 offset:10240
  v_mfma_f32_16x16x32_bf16 v[30:33], v[120:123], v[116:119], v[30:33]
  s_waitcnt lgkmcnt(4)
  ds_read_b128 v[232:235], v15 offset:11264
  v_cvt_pk_bf16_f32 v116, v22, v23
  v_mfma_f32_16x16x32_bf16 v[34:37], v[124:127], v[128:131], v[34:37]
  ds_read_b128 v[236:239], v15 offset:12288
  v_cvt_pk_bf16_f32 v117, v24, v25
  v_mfma_f32_16x16x32_bf16 v[38:41], v[176:179], v[128:131], v[38:41]
  ds_read_b128 v[240:243], v15 offset:13312
  v_cvt_pk_bf16_f32 v118, v26, v27
  v_mfma_f32_16x16x32_bf16 v[42:45], v[120:123], v[128:131], v[42:45]
  s_waitcnt lgkmcnt(6)
  v_cvt_pk_bf16_f32 v119, v28, v29
  v_cvt_pk_bf16_f32 v180, v30, v31
  v_mfma_f32_16x16x32_bf16 v[46:49], v[124:127], v[132:135], v[46:49]
  s_waitcnt vmcnt(0)
  ds_read_b64 v[192:193], v9
  ds_read_b64 v[194:195], v9 offset:32
  v_mfma_f32_16x16x32_bf16 v[50:53], v[176:179], v[132:135], v[50:53]
  s_lshl_b32 s60, s31, 5
  ds_read_b64 v[168:169], v9 offset:64
  v_cvt_pk_bf16_f32 v181, v32, v33
  v_mfma_f32_16x16x32_bf16 v[54:57], v[120:123], v[132:135], v[54:57]
  s_waitcnt lgkmcnt(8)
  ds_read_b128 v[128:131], v3
  v_cvt_pk_bf16_f32 v176, v34, v35
  v_mfma_f32_16x16x32_bf16 v[172:175], a[72:75], v[208:211], 0
  s_waitcnt lgkmcnt(8)
  ds_read_b128 v[132:135], v3 offset:864
  v_cvt_pk_bf16_f32 v177, v36, v37
  v_mfma_f32_16x16x32_bf16 v[172:175], a[76:79], v[224:227], v[172:175]
  s_waitcnt lgkmcnt(8)
  ds_read_b128 v[120:123], v3 offset:1728
  v_cvt_pk_bf16_f32 v178, v38, v39
  v_mfma_f32_16x16x32_bf16 v[172:175], a[80:83], v[228:231], v[172:175]
  s_waitcnt lgkmcnt(8)
  ds_read_b128 v[124:127], v6
  v_cvt_pk_bf16_f32 v179, v40, v41
  v_mfma_f32_16x16x32_bf16 v[172:175], a[84:87], v[232:235], v[172:175]
  s_waitcnt lgkmcnt(8)
  ds_read_b128 v[152:155], v3 offset:32
  v_cvt_pk_bf16_f32 v182, v42, v43
  v_mfma_f32_16x16x32_bf16 v[172:175], a[88:91], v[236:239], v[172:175]
  s_waitcnt lgkmcnt(8)
  ds_read_b128 v[156:159], v3 offset:896
  v_cvt_pk_bf16_f32 v183, v44, v45
  v_mfma_f32_16x16x32_bf16 v[172:175], a[92:95], v[240:243], v[172:175]
  s_waitcnt lgkmcnt(6)
  ds_read_b128 v[160:163], v3 offset:1760
  v_cvt_pk_bf16_f32 v114, v46, v47
  v_cvt_pk_bf16_f32 v115, v48, v49
  v_mfma_f32_16x16x16_bf16 v[22:25], a[224:225], v[192:193], 0
  v_cvt_pk_bf16_f32 v244, v50, v51
  v_cvt_pk_bf16_f32 v245, v52, v53
  v_cvt_pk_bf16_f32 v150, v54, v55
  v_mfma_f32_16x16x16_bf16 v[26:29], a[234:235], v[194:195], 0
  v_cvt_pk_bf16_f32 v151, v56, v57
  v_cvt_pk_bf16_f32 v192, v172, v173
  v_cvt_pk_bf16_f32 v193, v174, v175
  v_mfma_f32_16x16x16_bf16 v[30:33], a[244:245], v[168:169], 0
  s_add_u32 s61, s60, s30
  ds_read_b128 v[164:167], v6 offset:32
  ds_read_b128 v[168:171], v3 offset:64
  s_waitcnt lgkmcnt(7)
  v_smfmac_f32_16x16x64_bf16 v[22:25], a[216:219], v[128:135], v0
  s_waitcnt lgkmcnt(5)
  ds_read_b128 v[172:175], v3 offset:928
  v_smfmac_f32_16x16x64_bf16 v[22:25], a[220:223], v[120:127], v0
  s_add_u32 s60, s60, s29
  ds_read_b128 v[120:123], v3 offset:1792
  v_mfma_f32_16x16x32_bf16 v[128:131], a[96:99], v[208:211], 0
  s_mul_i32 s62, s60, 7183
  ds_read_b128 v[124:127], v6 offset:64
  v_mfma_f32_16x16x32_bf16 v[128:131], a[100:103], v[224:227], v[128:131]
  s_lshr_b32 s62, s62, 22
  buffer_store_dwordx2 v[116:117], v12, s[8:11], s32 offen
  v_mul_f32 v94, v22, v22
  v_mfma_f32_16x16x32_bf16 v[128:131], a[104:107], v[228:231], v[128:131]
  s_waitcnt lgkmcnt(6)
  buffer_store_dwordx2 v[118:119], v12, s[8:11], s32 offen offset:32
  v_add_f32 v96, v22, v23
  v_smfmac_f32_16x16x64_bf16 v[26:29], a[226:229], v[152:159], v0
  s_waitcnt lgkmcnt(4)
  buffer_store_dwordx2 v[180:181], v12, s[8:11], s32 offen offset:64
  v_fmac_f32 v94, v23, v23
  v_smfmac_f32_16x16x64_bf16 v[26:29], a[230:233], v[160:167], v0
  s_mul_i32 s63, s62, 584
  buffer_store_dwordx2 v[176:177], v13, s[8:11], s32 offen
  v_add_f32 v96, v96, v24
  v_mfma_f32_16x16x32_bf16 v[128:131], a[108:111], v[232:235], v[128:131]
  s_sub_u32 s63, s60, s63
  buffer_store_dwordx2 v[178:179], v13, s[8:11], s32 offen offset:32
  v_fmac_f32 v94, v24, v24
  v_mfma_f32_16x16x32_bf16 v[128:131], a[112:115], v[236:239], v[128:131]
  s_lshr_b32 s64, s63, 3
  buffer_store_dwordx2 v[182:183], v13, s[8:11], s32 offen offset:64
  v_add_f32 v96, v96, v25
  v_mfma_f32_16x16x32_bf16 v[128:131], a[116:119], v[240:243], v[128:131]
  s_waitcnt lgkmcnt(2)
  ds_read_b64 v[118:119], v10
  v_fmac_f32 v94, v25, v25
  v_smfmac_f32_16x16x64_bf16 v[30:33], a[236:239], v[168:175], v0
  s_waitcnt lgkmcnt(1)
  ds_read_b64 v[116:117], v10 offset:32
  v_add_f32 v96, v96, v26
  v_smfmac_f32_16x16x64_bf16 v[30:33], a[240:243], v[120:127], v0
  s_and_b32 s65, s63, 7
  ds_read_b64 v[198:199], v10 offset:64
  v_cvt_pk_bf16_f32 v194, v128, v129
  v_mfma_f32_16x16x32_bf16 v[132:135], a[120:123], v[208:211], 0
  s_lshl_b32 s66, s62, 3
  ds_read_b128 v[120:123], v4
  ds_read_b128 v[124:127], v4 offset:864
  v_mfma_f32_16x16x32_bf16 v[132:135], a[124:127], v[224:227], v[132:135]
  s_add_u32 s65, s65, s66
  ds_read_b128 v[168:171], v4 offset:1728
  v_cvt_pk_bf16_f32 v195, v130, v131
  v_mfma_f32_16x16x32_bf16 v[132:135], a[128:131], v[228:231], v[132:135]
  s_cmp_ge_u32 s60, 5256
  ds_read_b128 v[172:175], v7
  v_fmac_f32 v94, v26, v26
  v_mfma_f32_16x16x32_bf16 v[132:135], a[132:135], v[232:235], v[132:135]
  s_cselect_b32 s64, s63, s64
  buffer_store_dwordx2 v[114:115], v14, s[8:11], s32 offen
  v_add_f32 v96, v96, v27
  v_mfma_f32_16x16x32_bf16 v[132:135], a[136:139], v[236:239], v[132:135]
  s_cselect_b32 s65, 72, s65
  buffer_store_dwordx2 v[244:245], v14, s[8:11], s32 offen offset:32
  v_fmac_f32 v94, v27, v27
  v_mfma_f32_16x16x32_bf16 v[132:135], a[140:143], v[240:243], v[132:135]
  s_mul_i32 s66, s65, 1373568
  ds_read_b128 v[160:163], v4 offset:32
  ds_read_b128 v[164:167], v4 offset:896
  v_mfma_f32_16x16x32_bf16 v[244:247], a[0:3], v[208:211], 0
  s_mul_i32 s67, s64, 2688
  ds_read_b128 v[152:155], v4 offset:1760
  v_add_f32 v96, v96, v28
  v_mfma_f32_16x16x32_bf16 v[244:247], a[4:7], v[224:227], v[244:247]
  s_add_u32 s35, s66, s67
  ds_read_b128 v[156:159], v7 offset:32
  v_cvt_pk_bf16_f32 v196, v132, v133
  v_mfma_f32_16x16x32_bf16 v[244:247], a[8:11], v[228:231], v[244:247]
  s_cmp_ge_u32 s61, 667
  buffer_store_dwordx2 v[150:151], v14, s[8:11], s32 offen offset:64
  v_cvt_pk_bf16_f32 v197, v134, v135
  v_mfma_f32_16x16x32_bf16 v[244:247], a[12:15], v[232:235], v[244:247]
  s_cselect_b32 s35, 268435456, s35
  v_fmac_f32 v94, v28, v28
  v_add_f32 v96, v96, v29
  v_mfma_f32_16x16x32_bf16 v[244:247], a[16:19], v[236:239], v[244:247]
  s_cmp_ge_u32 s60, 5329
  ds_read_b128 v[128:131], v4 offset:64
  ds_read_b128 v[132:135], v4 offset:928
  v_mfma_f32_16x16x32_bf16 v[244:247], a[20:23], v[240:243], v[244:247]
  s_waitcnt lgkmcnt(8)
  ds_read_b128 v[176:179], v4 offset:1792
  v_fmac_f32 v94, v29, v29
  v_add_f32 v96, v96, v30
  v_mfma_f32_16x16x16_bf16 v[34:37], a[224:225], v[118:119], 0
  v_fmac_f32 v94, v30, v30
  v_add_f32 v96, v96, v31
  v_fmac_f32 v94, v31, v31
  v_mfma_f32_16x16x16_bf16 v[38:41], a[234:235], v[116:117], 0
  v_cvt_pk_bf16_f32 v114, v244, v245
  v_cvt_pk_bf16_f32 v115, v246, v247
  v_add_f32 v96, v96, v32
  v_mfma_f32_16x16x16_bf16 v[42:45], a[244:245], v[198:199], 0
  v_fmac_f32 v94, v32, v32
  v_add_f32 v96, v96, v33
  v_fmac_f32 v94, v33, v33
  v_smfmac_f32_16x16x64_bf16 v[34:37], a[216:219], v[120:127], v0
  s_waitcnt lgkmcnt(7)
  ds_read_b128 v[180:183], v7 offset:64
  v_smfmac_f32_16x16x64_bf16 v[34:37], a[220:223], v[168:175], v0
  s_cselect_b32 s35, 268435456, s35
  v_mfma_f32_16x16x32_bf16 v[168:171], a[24:27], v[208:211], 0
  s_cmp_eq_u32 s65, 0
  v_permlane32_swap_b32 v96, v94
  v_mfma_f32_16x16x32_bf16 v[168:171], a[28:31], v[224:227], v[168:171]
  s_cselect_b32 s36, 268435456, s35
  v_mul_f32 v98, v34, v34
  v_add_f32 v99, v34, v35
  v_mfma_f32_16x16x32_bf16 v[168:171], a[32:35], v[228:231], v[168:171]
  s_waitcnt lgkmcnt(6)
  v_fmac_f32 v98, v35, v35
  v_add_f32 v99, v99, v36
  v_smfmac_f32_16x16x64_bf16 v[38:41], a[226:229], v[160:167], v0
  s_waitcnt lgkmcnt(4)
  v_fmac_f32 v98, v36, v36
  v_smfmac_f32_16x16x64_bf16 v[38:41], a[230:233], v[152:159], v0
  s_add_u32 s37, s35, 195360
  v_add_f32 v99, v99, v37
  v_mfma_f32_16x16x32_bf16 v[168:171], a[36:39], v[232:235], v[168:171]
  s_add_u32 s38, s35, 390720
  v_fmac_f32 v98, v37, v37
  v_add_f32 v96, v96, v94
  v_mfma_f32_16x16x32_bf16 v[168:171], a[40:43], v[236:239], v[168:171]
  s_add_u32 s39, s35, 586080
  v_add_f32 v99, v99, v38
  v_fmac_f32 v98, v38, v38
  v_mfma_f32_16x16x32_bf16 v[168:171], a[44:47], v[240:243], v[168:171]
  s_waitcnt lgkmcnt(2)
  ds_read_b64 v[198:199], v11
  v_add_f32 v99, v99, v39
  v_smfmac_f32_16x16x64_bf16 v[42:45], a[236:239], v[128:135], v0
  s_waitcnt lgkmcnt(1)
  ds_read_b64 v[150:151], v11 offset:32
  v_fmac_f32 v98, v39, v39
  v_smfmac_f32_16x16x64_bf16 v[42:45], a[240:243], v[176:183], v0
  s_add_u32 s40, s35, 781440
  ds_read_b64 v[94:95], v11 offset:64
  v_cvt_pk_bf16_f32 v116, v168, v169
  v_mfma_f32_16x16x32_bf16 v[172:175], a[48:51], v[208:211], 0
  s_add_u32 s41, s35, 981120
  ds_read_b128 v[176:179], v5
  ds_read_b128 v[180:183], v5 offset:864
  v_mfma_f32_16x16x32_bf16 v[172:175], a[52:55], v[224:227], v[172:175]
  s_add_u32 s42, s35, 1176480
  ds_read_b128 v[128:131], v5 offset:1728
  v_cvt_pk_bf16_f32 v117, v170, v171
  v_mfma_f32_16x16x32_bf16 v[172:175], a[56:59], v[228:231], v[172:175]
  s_add_u32 s43, s35, 1371840
  ds_read_b128 v[132:135], v8
  v_add_f32 v99, v99, v40
  v_mfma_f32_16x16x32_bf16 v[172:175], a[60:63], v[232:235], v[172:175]
  s_add_u32 s44, s35, 1567200
  v_fmac_f32 v98, v40, v40
  v_add_f32 v99, v99, v41
  v_mfma_f32_16x16x32_bf16 v[172:175], a[64:67], v[236:239], v[172:175]
  s_cmp_eq_u32 s64, 0
  v_fmac_f32 v98, v41, v41
  v_add_f32 v99, v99, v42
  v_mfma_f32_16x16x32_bf16 v[172:175], a[68:71], v[240:243], v[172:175]
  s_cselect_b64 s[52:53], s[48:49], 0
  ds_read_b128 v[152:155], v5 offset:32
  ds_read_b128 v[156:159], v5 offset:896
  v_mfma_f32_16x16x32_bf16 v[244:247], v[208:211], a[144:147], 0
  s_cmp_eq_u32 s64, 72
  ds_read_b128 v[160:163], v5 offset:1760
  v_fmac_f32 v98, v42, v42
  v_mfma_f32_16x16x32_bf16 v[244:247], v[224:227], a[148:151], v[244:247]
  s_cselect_b64 s[52:53], s[50:51], s[52:53]
  ds_read_b128 v[164:167], v8 offset:32
  v_cvt_pk_bf16_f32 v118, v172, v173
  v_mfma_f32_16x16x32_bf16 v[244:247], v[228:231], a[152:155], v[244:247]
  s_add_u32 s31, s31, 1
  v_cvt_pk_bf16_f32 v119, v174, v175
  v_add_f32 v99, v99, v43
  v_mfma_f32_16x16x32_bf16 v[244:247], v[232:235], a[156:159], v[244:247]
  s_mov_b32 m0, s58
  v_fmac_f32 v98, v43, v43
  v_add_f32 v99, v99, v44
  v_mfma_f32_16x16x32_bf16 v[244:247], v[236:239], a[160:163], v[244:247]
  ds_read_b128 v[168:171], v5 offset:64
  ds_read_b128 v[172:175], v5 offset:928
  v_mfma_f32_16x16x32_bf16 v[244:247], v[240:243], a[164:167], v[244:247]
  s_waitcnt lgkmcnt(8)
  ds_read_b128 v[120:123], v5 offset:1792
  v_fmac_f32 v98, v44, v44
  v_add_f32 v99, v99, v45
  v_mfma_f32_16x16x16_bf16 v[46:49], a[224:225], v[198:199], 0
  v_fmac_f32 v98, v45, v45
  v_cndmask_b32 v198, v21, 2.0, s[52:53]
  v_mfma_f32_16x16x16_bf16 v[50:53], a[234:235], v[150:151], 0
  ds_read_b128 v[124:127], v8 offset:64
  v_permlane32_swap_b32 v99, v98
  v_mfma_f32_16x16x16_bf16 v[54:57], a[244:245], v[94:95], 0
  v_add_f32 v99, v99, v98
  v_cvt_pk_bf16_f32 v202, v244, v245
  v_cvt_pk_bf16_f32 v203, v246, v247
  v_smfmac_f32_16x16x64_bf16 v[46:49], a[216:219], v[176:183], v0
  s_waitcnt lgkmcnt(8)
  v_smfmac_f32_16x16x64_bf16 v[46:49], a[220:223], v[128:135], v0
  v_mfma_f32_16x16x32_bf16 v[128:131], v[208:211], a[168:171], 0
  v_permlane16_swap_b32 v96, v99
  v_mfma_f32_16x16x32_bf16 v[128:131], v[224:227], a[172:175], v[128:131]
  s_waitcnt lgkmcnt(0)
  buffer_load_dwordx4 v198, s[4:7], s36 offen lds
  v_mfma_f32_16x16x32_bf16 v[128:131], v[228:231], a[176:179], v[128:131]
  buffer_load_dwordx4 v198, s[4:7], s37 offen offset:864 lds
  v_smfmac_f32_16x16x64_bf16 v[50:53], a[226:229], v[152:159], v0
  ds_read_b128 v[132:135], v15 offset:14336
  v_mul_f32 v152, v46, v46
  v_smfmac_f32_16x16x64_bf16 v[50:53], a[230:233], v[160:167], v0
  ds_read_b128 v[160:163], v15 offset:15360
  v_add_f32 v153, v46, v47
  v_mfma_f32_16x16x32_bf16 v[128:131], v[232:235], a[180:183], v[128:131]
  ds_read_b128 v[164:167], v15 offset:16384
  v_fmac_f32 v152, v47, v47
  v_mfma_f32_16x16x32_bf16 v[128:131], v[236:239], a[184:187], v[128:131]
  ds_read_b128 v[176:179], v15 offset:17408
  v_add_f32 v153, v153, v48
  v_mfma_f32_16x16x32_bf16 v[128:131], v[240:243], a[188:191], v[128:131]
  ds_read_b128 v[180:183], v15 offset:18432
  v_fmac_f32 v152, v48, v48
  v_smfmac_f32_16x16x64_bf16 v[54:57], a[236:239], v[168:175], v0
  ds_read_b128 v[244:247], v15 offset:19456
  v_add_f32 v153, v153, v49
  v_smfmac_f32_16x16x64_bf16 v[54:57], a[240:243], v[120:127], v0
  buffer_load_dwordx4 v198, s[4:7], s38 offen offset:1728 lds
  v_mfma_f32_16x16x32_bf16 v[168:171], v[208:211], a[192:195], 0
  buffer_load_dwordx4 v198, s[4:7], s39 offen offset:2592 lds
  v_mfma_f32_16x16x32_bf16 v[168:171], v[224:227], a[196:199], v[168:171]
  buffer_load_dwordx4 v198, s[4:7], s40 offen offset:3456 lds
  v_mfma_f32_16x16x32_bf16 v[168:171], v[228:231], a[200:203], v[168:171]
  s_mov_b32 m0, s59
  v_fmac_f32 v152, v49, v49
  v_add_f32 v153, v153, v50
  v_mfma_f32_16x16x32_bf16 v[168:171], v[232:235], a[204:207], v[168:171]
  s_mov_b32 s32, s33
  buffer_load_dwordx4 v198, s[4:7], s41 offen lds
  v_mfma_f32_16x16x32_bf16 v[168:171], v[236:239], a[208:211], v[168:171]
  s_mov_b32 s33, s34
  v_fmac_f32 v152, v50, v50
  v_add_f32 v153, v153, v51
  v_mfma_f32_16x16x32_bf16 v[168:171], v[240:243], a[212:215], v[168:171]
  s_mov_b32 s34, s35
  v_fmac_f32 v152, v51, v51
  v_add_f32 v153, v153, v52
  v_fmac_f32 v152, v52, v52
  v_mfma_f32_16x16x16_bf16 v[172:175], v[196:197], v[142:143], 0
  v_add_f32 v153, v153, v53
  v_fmac_f32 v152, v53, v53
  v_add_f32 v153, v153, v54
  v_mfma_f32_16x16x16_bf16 v[120:123], v[148:149], v[118:119], 0
  v_fmac_f32 v152, v54, v54
  v_add_f32 v153, v153, v55
  v_fmac_f32 v152, v55, v55
  v_add_f32 v153, v153, v56
  v_mfma_f32_16x16x32_bf16 v[172:175], v[192:195], v[138:141], v[172:175]
  v_fmac_f32 v152, v56, v56
  v_add_f32 v153, v153, v57
  v_mfma_f32_16x16x32_bf16 v[120:123], v[144:147], v[114:117], v[120:123]
  s_waitcnt lgkmcnt(5)
  v_fmac_f32 v152, v57, v57
  v_add_f32 v96, v96, v99
  v_mfma_f32_16x16x32_bf16 v[240:243], a[72:75], v[132:135], 0
  s_waitcnt lgkmcnt(4)
  ds_write_b32 v97, v96
  v_mfma_f32_16x16x32_bf16 v[240:243], a[76:79], v[160:163], v[240:243]
  s_waitcnt lgkmcnt(4)
  v_permlane32_swap_b32 v153, v152
  v_mfma_f32_16x16x32_bf16 v[240:243], a[80:83], v[164:167], v[240:243]
  s_waitcnt lgkmcnt(3)
  v_add_f32 v153, v153, v152
  v_mov_b32 v152, v153
  v_mfma_f32_16x16x32_bf16 v[240:243], a[84:87], v[176:179], v[240:243]
  s_waitcnt lgkmcnt(2)
  v_permlane16_swap_b32 v153, v152
  v_mfma_f32_16x16x32_bf16 v[240:243], a[88:91], v[180:183], v[240:243]
  s_waitcnt lgkmcnt(1)
  v_add_f32 v153, v153, v152
  v_cvt_pk_bf16_f32 v218, v128, v129
  v_mfma_f32_16x16x32_bf16 v[240:243], a[92:95], v[244:247], v[240:243]
  ds_write_b32 v97, v153 offset:512
  v_mfma_f32_16x16x32_bf16 v[236:239], a[96:99], v[132:135], 0
  buffer_load_dwordx4 v198, s[4:7], s42 offen offset:864 lds
  v_mfma_f32_16x16x32_bf16 v[236:239], a[100:103], v[160:163], v[236:239]
  buffer_load_dwordx4 v198, s[4:7], s43 offen offset:1728 lds
  v_mfma_f32_16x16x32_bf16 v[236:239], a[104:107], v[164:167], v[236:239]
  buffer_load_dwordx4 v198, s[4:7], s44 offen offset:2592 lds
  v_mfma_f32_16x16x32_bf16 v[236:239], a[108:111], v[176:179], v[236:239]
  v_cvt_pk_bf16_f32 v152, v240, v241
  v_cvt_pk_bf16_f32 v153, v242, v243
  v_mfma_f32_16x16x32_bf16 v[236:239], a[112:115], v[180:183], v[236:239]
  v_exp_f32 v172, v172
  v_mfma_f32_16x16x32_bf16 v[236:239], a[116:119], v[244:247], v[236:239]
  s_waitcnt lgkmcnt(0)
  s_barrier
  v_mfma_f32_16x16x32_bf16 v[240:243], a[120:123], v[132:135], 0
  ds_read_b128 v[124:127], v15
  ds_read_b128 v[232:235], v15 offset:1024
  v_mfma_f32_16x16x32_bf16 v[240:243], a[124:127], v[160:163], v[240:243]
  v_cvt_pk_bf16_f32 v154, v236, v237
  v_cvt_pk_bf16_f32 v155, v238, v239
  v_mfma_f32_16x16x32_bf16 v[240:243], a[128:131], v[164:167], v[240:243]
  v_exp_f32 v173, v173
  v_mfma_f32_16x16x32_bf16 v[240:243], a[132:135], v[176:179], v[240:243]
  v_exp_f32 v174, v174
  v_mfma_f32_16x16x32_bf16 v[240:243], a[136:139], v[180:183], v[240:243]
  v_exp_f32 v175, v175
  v_mfma_f32_16x16x32_bf16 v[240:243], a[140:143], v[244:247], v[240:243]
  v_cvt_pk_bf16_f32 v214, v172, v173
  v_cvt_pk_bf16_f32 v215, v174, v175
  v_cvt_pk_bf16_f32 v219, v130, v131
  v_mfma_f32_16x16x16_bf16 v[128:131], v[196:197], v[118:119], 0
  v_cvt_pk_bf16_f32 v206, v168, v169
  v_cvt_pk_bf16_f32 v207, v170, v171
  v_mfma_f32_16x16x16_bf16 v[236:239], v[196:197], v[188:189], 0
  ds_read_b64 v[172:173], v19 offset:16
  ds_read2_b64 v[168:171], v19 offset0:0 offset1:1
  v_cvt_pk_bf16_f32 v156, v240, v241
  v_cvt_pk_bf16_f32 v157, v242, v243
  v_mfma_f32_16x16x32_bf16 v[128:131], v[192:195], v[114:117], v[128:131]
  s_waitcnt lgkmcnt(2)
  v_add_f32 v124, v124, v125
  v_add_f32 v126, v126, v127
  v_mfma_f32_16x16x32_bf16 v[236:239], v[192:195], v[184:187], v[236:239]
  v_add_f32 v232, v232, v233
  v_add_f32 v234, v234, v235
  v_mfma_f32_16x16x32_bf16 v[240:243], v[132:135], a[144:147], 0
  v_add_f32 v124, v124, v126
  v_add_f32 v232, v232, v234
  v_mfma_f32_16x16x32_bf16 v[240:243], v[160:163], a[148:151], v[240:243]
  v_mul_f32 v125, 0x3baaaaab, v124
  v_fma_f32 v232, -v125, v124, v232
  v_mfma_f32_16x16x32_bf16 v[240:243], v[164:167], a[152:155], v[240:243]
  v_max_f32 v232, 0, v232
  v_add_f32 v232, 0x3afba882, v232
  v_mfma_f32_16x16x32_bf16 v[240:243], v[176:179], a[156:159], v[240:243]
  v_rsq_f32 v232, v232
  v_mfma_f32_16x16x32_bf16 v[240:243], v[180:183], a[160:163], v[240:243]
  v_mul_f32 v232, 0x40ca568a, v232
  v_mul_f32 v233, -v125, v232
  v_mfma_f32_16x16x32_bf16 v[240:243], v[244:247], a[164:167], v[240:243]
  ds_write_b64 v101, v[232:233]
  v_mfma_f32_16x16x32_bf16 v[124:127], v[132:135], a[168:171], 0
  ds_read_b64 v[174:175], v105 offset:768
  v_add_u32 v19, 1152, v19
  v_mfma_f32_16x16x32_bf16 v[124:127], v[160:163], a[172:175], v[124:127]
  v_cvt_pk_bf16_f32 v94, v240, v241
  v_cvt_pk_bf16_f32 v95, v242, v243
  v_mfma_f32_16x16x32_bf16 v[124:127], v[164:167], a[176:179], v[124:127]
  v_exp_f32 v120, v120
  v_mfma_f32_16x16x32_bf16 v[124:127], v[176:179], a[180:183], v[124:127]
  v_exp_f32 v121, v121
  v_mfma_f32_16x16x32_bf16 v[124:127], v[180:183], a[184:187], v[124:127]
  v_exp_f32 v122, v122
  v_mfma_f32_16x16x32_bf16 v[124:127], v[244:247], a[188:191], v[124:127]
  s_waitcnt lgkmcnt(3)
  v_exp_f32 v123, v123
  v_cvt_pk_bf16_f32 v240, v120, v121
  v_mfma_f32_16x16x16_bf16 v[232:235], v[156:157], v[142:143], 0
  v_exp_f32 v128, v128
  v_cvt_pk_bf16_f32 v241, v122, v123
  v_mfma_f32_16x16x16_bf16 v[120:123], v[172:173], v[142:143], v[2:5]
  v_cvt_pk_bf16_f32 v98, v124, v125
  v_cvt_pk_bf16_f32 v99, v126, v127
  v_exp_f32 v129, v129
  v_mfma_f32_16x16x32_bf16 v[232:235], v[152:155], v[138:141], v[232:235]
  s_waitcnt lgkmcnt(0)
  v_exp_f32 v130, v130
  v_mfma_f32_16x16x32_bf16 v[120:123], v[168:171], v[138:141], v[120:123]
  v_exp_f32 v131, v131
  v_mfma_f32_16x16x32_bf16 v[140:143], v[132:135], a[192:195], 0
  v_exp_f32 v232, v232
  v_mfma_f32_16x16x32_bf16 v[140:143], v[160:163], a[196:199], v[140:143]
  v_exp_f32 v233, v233
  v_mfma_f32_16x16x32_bf16 v[140:143], v[164:167], a[200:203], v[140:143]
  ds_read_u16 v96, v20
  v_cvt_pk_bf16_f32 v106, v232, v233
  v_mfma_f32_16x16x32_bf16 v[140:143], v[176:179], a[204:207], v[140:143]
  v_exp_f32 v234, v234
  v_mfma_f32_16x16x32_bf16 v[140:143], v[180:183], a[208:211], v[140:143]
  ds_read_u16 v100, v20 offset:32
  v_cvt_pk_bf16_f32 v242, v128, v129
  v_mfma_f32_16x16x32_bf16 v[140:143], v[244:247], a[212:215], v[140:143]
  v_exp_f32 v235, v235
  v_cvt_pk_bf16_f32 v243, v130, v131
  v_mfma_f32_16x16x16_bf16 v[128:131], v[156:157], v[118:119], 0
  v_exp_f32 v120, v120
  v_cvt_pk_bf16_f32 v107, v234, v235
  v_mfma_f32_16x16x16_bf16 v[124:127], v[172:173], v[118:119], v[2:5]
  v_cvt_pk_bf16_f32 v108, v120, 0
  v_cvt_pk_bf16_f32 v102, v140, v141
  v_cvt_pk_bf16_f32 v103, v142, v143
  v_fma_f32 v140, v22, v174, v175
  v_mfma_f32_16x16x32_bf16 v[128:131], v[152:155], v[114:117], v[128:131]
  ds_read_u16 v104, v20 offset:64
  v_fma_f32 v138, v23, v174, v175
  v_mfma_f32_16x16x32_bf16 v[124:127], v[168:171], v[114:117], v[124:127]
  v_fma_f32 v141, v24, v174, v175
  v_fma_f32 v139, v25, v174, v175
  v_mfma_f32_16x16x32_bf16 v[116:119], a[0:3], v[132:135], 0
  v_exp_f32 v128, v128
  v_mfma_f32_16x16x32_bf16 v[116:119], a[4:7], v[160:163], v[116:119]
  v_exp_f32 v129, v129
  v_mfma_f32_16x16x32_bf16 v[116:119], a[8:11], v[164:167], v[116:119]
  v_exp_f32 v130, v130
  v_mfma_f32_16x16x32_bf16 v[116:119], a[12:15], v[176:179], v[116:119]
  v_exp_f32 v131, v131
  v_mfma_f32_16x16x32_bf16 v[116:119], a[16:19], v[180:183], v[116:119]
  v_exp_f32 v124, v124
  v_mfma_f32_16x16x32_bf16 v[116:119], a[20:23], v[244:247], v[116:119]
  v_cvt_pk_bf16_f32 v110, v128, v129
  v_cvt_pk_bf16_f32 v111, v130, v131
  v_mfma_f32_16x16x32_bf16 v[232:235], a[246:249], v[212:215], 0
  v_cvt_pk_bf16_f32 v112, v124, 0
  v_fma_f32 v142, v26, v174, v175
  v_mfma_f32_16x16x32_bf16 v[232:235], a[246:249], v[106:109], v[232:235]
  v_fma_f32 v128, v27, v174, v175
  v_fma_f32 v143, v28, v174, v175
  v_mfma_f32_16x16x32_bf16 v[228:231], v[200:203], v[212:215], 0
  s_waitcnt lgkmcnt(2)
  v_fma_f32 v129, v29, v174, v175
  v_cvt_pk_bf16_f32 v140, v140, v138
  v_mfma_f32_16x16x32_bf16 v[228:231], v[94:97], v[106:109], v[228:231]
  v_cvt_pk_bf16_f32 v141, v141, v139
  v_cvt_pk_bf16_f32 v142, v142, v128
  v_mfma_f32_16x16x32_bf16 v[224:227], v[216:219], v[212:215], 0
  s_waitcnt lgkmcnt(1)
  v_cvt_pk_bf16_f32 v143, v143, v129
  v_fma_f32 v128, v30, v174, v175
  v_mfma_f32_16x16x32_bf16 v[224:227], v[98:101], v[106:109], v[224:227]
  ds_write_b128 v16, v[140:143] offset:2048
  v_mfma_f32_16x16x32_bf16 v[208:211], v[204:207], v[212:215], 0
  s_waitcnt lgkmcnt(1)
  v_fma_f32 v140, v31, v174, v175
  v_fma_f32 v129, v32, v174, v175
  v_mfma_f32_16x16x32_bf16 v[208:211], v[102:105], v[106:109], v[208:211]
  v_fma_f32 v141, v33, v174, v175
  v_cvt_pk_bf16_f32 v128, v128, v140
  v_mfma_f32_16x16x32_bf16 v[124:127], a[24:27], v[132:135], 0
  v_cvt_pk_bf16_f32 v129, v129, v141
  v_cvt_pk_bf16_f32 v138, v116, v117
  v_mfma_f32_16x16x32_bf16 v[124:127], a[28:31], v[160:163], v[124:127]
  ds_write_b64 v17, v[128:129] offset:2048
  v_mfma_f32_16x16x32_bf16 v[124:127], a[32:35], v[164:167], v[124:127]
  v_exp_f32 v236, v236
  v_mfma_f32_16x16x32_bf16 v[124:127], a[36:39], v[176:179], v[124:127]
  v_exp_f32 v237, v237
  v_mfma_f32_16x16x32_bf16 v[124:127], a[40:43], v[180:183], v[124:127]
  v_exp_f32 v238, v238
  v_mfma_f32_16x16x32_bf16 v[124:127], a[44:47], v[244:247], v[124:127]
  v_exp_f32 v239, v239
  v_cvt_pk_bf16_f32 v222, v236, v237
  v_mfma_f32_16x16x16_bf16 v[128:131], v[156:157], v[188:189], 0
  v_cvt_pk_bf16_f32 v223, v238, v239
  v_cvt_pk_bf16_f32 v139, v118, v119
  v_mul_f32 v232, 0x3ee9a3cd, v232
  v_mfma_f32_16x16x16_bf16 v[116:119], v[172:173], v[188:189], v[2:5]
  v_cvt_pk_bf16_f32 v140, v124, v125
  v_cvt_pk_bf16_f32 v141, v126, v127
  v_rcp_f32 v174, v232
  v_mfma_f32_16x16x32_bf16 v[128:131], v[152:155], v[184:187], v[128:131]
  v_mul_f32 v228, v228, v174
  v_mul_f32 v229, v229, v174
  v_mfma_f32_16x16x32_bf16 v[116:119], v[168:171], v[184:187], v[116:119]
  v_mul_f32 v230, v230, v174
  v_mul_f32 v231, v231, v174
  v_mfma_f32_16x16x32_bf16 v[184:187], a[246:249], v[240:243], 0
  v_exp_f32 v128, v128
  v_mfma_f32_16x16x32_bf16 v[184:187], a[246:249], v[110:113], v[184:187]
  v_exp_f32 v129, v129
  v_mfma_f32_16x16x32_bf16 v[236:239], v[200:203], v[240:243], 0
  v_exp_f32 v130, v130
  v_mfma_f32_16x16x32_bf16 v[236:239], v[94:97], v[110:113], v[236:239]
  v_exp_f32 v131, v131
  v_mfma_f32_16x16x32_bf16 v[212:215], v[216:219], v[240:243], 0
  v_exp_f32 v116, v116
  v_mfma_f32_16x16x32_bf16 v[212:215], v[98:101], v[110:113], v[212:215]
  v_cvt_pk_bf16_f32 v106, v128, v129
  v_cvt_pk_bf16_f32 v107, v130, v131
  v_mfma_f32_16x16x32_bf16 v[188:191], v[204:207], v[240:243], 0
  v_cvt_pk_bf16_f32 v108, v116, 0
  v_mul_f32 v184, 0x3ee9a3cd, v184
  v_mfma_f32_16x16x32_bf16 v[188:191], v[102:105], v[110:113], v[188:191]
  v_rcp_f32 v175, v184
  v_mfma_f32_16x16x32_bf16 v[240:243], a[48:51], v[132:135], 0
  v_mul_f32 v224, v224, v174
  v_mul_f32 v225, v225, v174
  v_mfma_f32_16x16x32_bf16 v[240:243], a[52:55], v[160:163], v[240:243]
  v_mul_f32 v226, v226, v174
  v_mul_f32 v227, v227, v174
  v_mfma_f32_16x16x32_bf16 v[240:243], a[56:59], v[164:167], v[240:243]
  v_mul_f32 v236, v236, v175
  v_mul_f32 v237, v237, v175
  v_mfma_f32_16x16x32_bf16 v[240:243], a[60:63], v[176:179], v[240:243]
  v_mul_f32 v238, v238, v175
  v_mul_f32 v239, v239, v175
  v_mfma_f32_16x16x32_bf16 v[240:243], a[64:67], v[180:183], v[240:243]
  v_mul_f32 v212, v212, v175
  v_mul_f32 v213, v213, v175
  v_mfma_f32_16x16x32_bf16 v[240:243], a[68:71], v[244:247], v[240:243]
  s_waitcnt lgkmcnt(0)
  s_barrier
  v_mfma_f32_16x16x32_bf16 v[244:247], v[220:223], a[246:249], 0
  ds_read_b128 v[114:117], v15 offset:2048
  ds_read_b128 v[118:121], v15 offset:3072
  v_mfma_f32_16x16x32_bf16 v[244:247], v[106:109], a[246:249], v[244:247]
  ds_read_b128 v[122:125], v15 offset:4096
  v_cvt_pk_bf16_f32 v142, v240, v241
  v_mfma_f32_16x16x32_bf16 v[180:183], v[220:223], v[200:203], 0
  ds_read_b128 v[126:129], v15 offset:5120
  v_cvt_pk_bf16_f32 v143, v242, v243
  v_mfma_f32_16x16x32_bf16 v[180:183], v[106:109], v[94:97], v[180:183]
  ds_read_b128 v[130:133], v15 offset:6144
  v_mul_f32 v214, v214, v175
  v_mfma_f32_16x16x32_bf16 v[240:243], v[220:223], v[216:219], 0
  ds_read_b128 v[134:137], v15 offset:7168
  v_mul_f32 v215, v215, v175
  v_mfma_f32_16x16x32_bf16 v[240:243], v[106:109], v[98:101], v[240:243]
  v_cvt_pk_bf16_f32 v176, v228, v229
  v_cvt_pk_bf16_f32 v177, v230, v231
  v_mfma_f32_16x16x32_bf16 v[228:231], v[220:223], v[204:207], 0
  v_cvt_pk_bf16_f32 v178, v224, v225
  v_cvt_pk_bf16_f32 v179, v226, v227
  v_mfma_f32_16x16x32_bf16 v[228:231], v[106:109], v[102:105], v[228:231]
  ds_write_b128 v16, v[176:179] offset:20480
  v_mfma_f32_16x16x16_bf16 v[176:179], v[148:149], v[142:143], 0
  v_cvt_pk_bf16_f32 v224, v236, v237
  v_cvt_pk_bf16_f32 v225, v238, v239
  v_cvt_pk_bf16_f32 v226, v212, v213
  v_mfma_f32_16x16x16_bf16 v[236:239], v[196:197], v[142:143], 0
  v_mul_f32 v244, 0x3ee9a3cd, v244
  v_cvt_pk_bf16_f32 v227, v214, v215
  v_cndmask_b32 v212, v240, v180, s[54:55]
  v_mfma_f32_16x16x16_bf16 v[180:183], v[156:157], v[142:143], 0
  v_rcp_f32 v213, v244
  v_mul_f32 v208, v208, v174
  v_mfma_f32_16x16x16_bf16 v[240:243], v[172:173], v[142:143], v[2:5]
  v_mul_f32 v209, v209, v174
  v_mul_f32 v210, v210, v174
  v_mul_f32 v211, v211, v174
  v_mul_f32 v188, v188, v175
  v_mfma_f32_16x16x32_bf16 v[176:179], v[144:147], v[138:141], v[176:179]
  ds_write_b128 v16, v[224:227] offset:26624
  v_mfma_f32_16x16x32_bf16 v[236:239], v[192:195], v[138:141], v[236:239]
  s_nop 3
  v_exp_f32 v176, v176
  v_mfma_f32_16x16x32_bf16 v[180:183], v[152:155], v[138:141], v[180:183]
  v_exp_f32 v177, v177
  v_mfma_f32_16x16x32_bf16 v[240:243], v[168:171], v[138:141], v[240:243]
  s_waitcnt lgkmcnt(7)
  v_exp_f32 v178, v178
  v_mfma_f32_16x16x32_bf16 v[144:147], a[0:3], v[114:117], 0
  s_waitcnt lgkmcnt(6)
  v_exp_f32 v179, v179
  v_mfma_f32_16x16x32_bf16 v[144:147], a[4:7], v[118:121], v[144:147]
  s_waitcnt lgkmcnt(5)
  v_exp_f32 v236, v236
  v_mfma_f32_16x16x32_bf16 v[144:147], a[8:11], v[122:125], v[144:147]
  s_waitcnt lgkmcnt(4)
  v_exp_f32 v237, v237
  v_mfma_f32_16x16x32_bf16 v[144:147], a[12:15], v[126:129], v[144:147]
  s_waitcnt lgkmcnt(3)
  v_exp_f32 v238, v238
  v_mfma_f32_16x16x32_bf16 v[144:147], a[16:19], v[130:133], v[144:147]
  s_waitcnt lgkmcnt(2)
  v_exp_f32 v239, v239
  v_mfma_f32_16x16x32_bf16 v[144:147], a[20:23], v[134:137], v[144:147]
  v_exp_f32 v180, v180
  v_mfma_f32_16x16x32_bf16 v[152:155], a[24:27], v[114:117], 0
  v_exp_f32 v181, v181
  v_mfma_f32_16x16x32_bf16 v[152:155], a[28:31], v[118:121], v[152:155]
  v_exp_f32 v182, v182
  v_mfma_f32_16x16x32_bf16 v[152:155], a[32:35], v[122:125], v[152:155]
  v_exp_f32 v183, v183
  v_mfma_f32_16x16x32_bf16 v[152:155], a[36:39], v[126:129], v[152:155]
  v_exp_f32 v240, v240
  v_mfma_f32_16x16x32_bf16 v[152:155], a[40:43], v[130:133], v[152:155]
  v_cvt_pk_bf16_f32 v140, v176, v177
  v_cvt_pk_bf16_f32 v141, v178, v179
  v_mfma_f32_16x16x32_bf16 v[152:155], a[44:47], v[134:137], v[152:155]
  v_cvt_pk_bf16_f32 v142, v236, v237
  v_cvt_pk_bf16_f32 v143, v238, v239
  v_mfma_f32_16x16x32_bf16 v[236:239], a[48:51], v[114:117], 0
  v_cvt_pk_bf16_f32 v110, v180, v181
  v_cvt_pk_bf16_f32 v111, v182, v183
  v_mfma_f32_16x16x32_bf16 v[236:239], a[52:55], v[118:121], v[236:239]
  v_cvt_pk_bf16_f32 v112, v240, 0
  v_mul_f32 v189, v189, v175
  v_mfma_f32_16x16x32_bf16 v[236:239], a[56:59], v[122:125], v[236:239]
  v_mul_f32 v190, v190, v175
  v_mul_f32 v191, v191, v175
  v_mfma_f32_16x16x32_bf16 v[236:239], a[60:63], v[126:129], v[236:239]
  v_cndmask_b32 v212, v228, v212, s[56:57]
  v_cvt_pk_bf16_f32 v138, v208, v209
  v_mfma_f32_16x16x32_bf16 v[236:239], a[64:67], v[130:133], v[236:239]
  v_cvt_pk_bf16_f32 v139, v210, v211
  v_cvt_pk_bf16_f32 v148, v188, v189
  v_mfma_f32_16x16x32_bf16 v[236:239], a[68:71], v[134:137], v[236:239]
  ds_write_b64 v17, v[138:139] offset:20480
  v_mfma_f32_16x16x32_bf16 v[208:211], a[246:249], v[140:143], 0
  v_cvt_pk_bf16_f32 v149, v190, v191
  v_mul_f32 v212, v212, v213
  v_mfma_f32_16x16x32_bf16 v[208:211], a[246:249], v[110:113], v[208:211]
  ds_write_b64 v17, v[148:149] offset:26624
  v_mfma_f32_16x16x32_bf16 v[188:191], v[200:203], v[140:143], 0
  v_cvt_pk_bf16_f32 v212, v212, v212
  v_max3_f32 v1, v1, v232, v174
  v_mfma_f32_16x16x32_bf16 v[188:191], v[94:97], v[110:113], v[188:191]
  ds_write_b16 v20, v212 offset:384
  v_mfma_f32_16x16x32_bf16 v[232:235], v[216:219], v[140:143], 0
  v_mul_f32 v208, 0x3ee9a3cd, v208
  v_max3_f32 v1, v1, v184, v175
  v_mfma_f32_16x16x32_bf16 v[232:235], v[98:101], v[110:113], v[232:235]
  v_rcp_f32 v98, v208
  v_mfma_f32_16x16x32_bf16 v[184:187], v[204:207], v[140:143], 0
  v_mul_f32 v188, v188, v98
  v_mul_f32 v189, v189, v98
  v_mfma_f32_16x16x32_bf16 v[184:187], v[102:105], v[110:113], v[184:187]
  v_mul_f32 v190, v190, v98
  v_mul_f32 v191, v191, v98
  v_mfma_f32_16x16x32_bf16 v[204:207], a[72:75], v[114:117], 0
  v_mul_f32 v232, v232, v98
  v_mul_f32 v233, v233, v98
  v_mfma_f32_16x16x32_bf16 v[204:207], a[76:79], v[118:121], v[204:207]
  v_mul_f32 v234, v234, v98
  v_mul_f32 v235, v235, v98
  v_mfma_f32_16x16x32_bf16 v[204:207], a[80:83], v[122:125], v[204:207]
  v_cvt_pk_bf16_f32 v140, v188, v189
  v_cvt_pk_bf16_f32 v141, v190, v191
  v_mfma_f32_16x16x32_bf16 v[204:207], a[84:87], v[126:129], v[204:207]
  v_cvt_pk_bf16_f32 v142, v232, v233
  v_cvt_pk_bf16_f32 v143, v234, v235
  v_mfma_f32_16x16x32_bf16 v[204:207], a[88:91], v[130:133], v[204:207]
  ds_write_b128 v16, v[140:143] offset:32768
  v_mfma_f32_16x16x32_bf16 v[204:207], a[92:95], v[134:137], v[204:207]
  v_mul_f32 v184, v184, v98
  v_mul_f32 v185, v185, v98
  v_mfma_f32_16x16x32_bf16 v[232:235], a[96:99], v[114:117], 0
  v_mul_f32 v186, v186, v98
  v_mul_f32 v187, v187, v98
  v_mfma_f32_16x16x32_bf16 v[232:235], a[100:103], v[118:121], v[232:235]
  v_cvt_pk_bf16_f32 v140, v184, v185
  v_cvt_pk_bf16_f32 v141, v186, v187
  v_mfma_f32_16x16x32_bf16 v[232:235], a[104:107], v[122:125], v[232:235]
  ds_write_b64 v17, v[140:141] offset:32768
  v_mfma_f32_16x16x32_bf16 v[232:235], a[108:111], v[126:129], v[232:235]
  v_max3_f32 v1, v1, v244, v213
  v_cvt_pk_bf16_f32 v138, v144, v145
  v_mfma_f32_16x16x32_bf16 v[232:235], a[112:115], v[130:133], v[232:235]
  v_cvt_pk_bf16_f32 v139, v146, v147
  v_cvt_pk_bf16_f32 v140, v152, v153
  v_mfma_f32_16x16x32_bf16 v[232:235], a[116:119], v[134:137], v[232:235]
  v_cvt_pk_bf16_f32 v141, v154, v155
  v_cvt_pk_bf16_f32 v142, v236, v237
  v_mfma_f32_16x16x32_bf16 v[150:153], a[120:123], v[114:117], 0
  v_cvt_pk_bf16_f32 v143, v238, v239
  v_add_u32 v20, 1152, v20
  v_mfma_f32_16x16x32_bf16 v[150:153], a[124:127], v[118:121], v[150:153]
  v_cvt_pk_bf16_f32 v144, v204, v205
  v_cvt_pk_bf16_f32 v145, v206, v207
  v_mfma_f32_16x16x32_bf16 v[150:153], a[128:131], v[122:125], v[150:153]
  v_max3_f32 v1, v1, v208, v98
  v_cvt_pk_bf16_f32 v146, v232, v233
  v_mfma_f32_16x16x32_bf16 v[150:153], a[132:135], v[126:129], v[150:153]
  v_cvt_pk_bf16_f32 v147, v234, v235
  v_mfma_f32_16x16x32_bf16 v[150:153], a[136:139], v[130:133], v[150:153]
  v_mfma_f32_16x16x32_bf16 v[150:153], a[140:143], v[134:137], v[150:153]
  s_waitcnt lgkmcnt(0)
  s_barrier
  s_sub_u32 s70, s70, 1
  s_cmp_eq_u32 s70, 0
  s_cbranch_scc1 L_last
  v_mfma_f32_16x16x32_bf16 v[156:159], v[114:117], a[144:147], 0
  ds_read_b128 v[184:187], v15 offset:20480
  ds_read_b128 v[188:191], v18
  v_mfma_f32_16x16x32_bf16 v[156:159], v[118:121], a[148:151], v[156:159]
  ds_read_b128 v[160:163], v18 offset:1024
  v_cvt_pk_bf16_f32 v148, v150, v151
  v_mfma_f32_16x16x32_bf16 v[156:159], v[122:125], a[152:155], v[156:159]
  ds_read_b128 v[164:167], v15 offset:26624
  v_cvt_pk_bf16_f32 v149, v152, v153
  v_mfma_f32_16x16x32_bf16 v[156:159], v[126:129], a[156:159], v[156:159]
  ds_read_b128 v[150:153], v15 offset:32768
  v_mfma_f32_16x16x32_bf16 v[156:159], v[130:133], a[160:163], v[156:159]
  ds_read_b64 v[216:217], v105 offset:896
  ds_read_b64 v[218:219], v105 offset:1792
  v_mfma_f32_16x16x32_bf16 v[156:159], v[134:137], a[164:167], v[156:159]
  s_waitcnt lgkmcnt(6)
  v_mfma_f32_16x16x32_bf16 v[58:61], a[250:253], v[184:187], v[58:61]
  ds_read_b128 v[192:195], v18 offset:2048
  ds_read_b128 v[168:171], v15 offset:21504
  s_waitcnt lgkmcnt(7)
  v_mfma_f32_16x16x32_bf16 v[62:65], v[188:191], v[184:187], v[62:65]
  ds_read_b128 v[172:175], v18 offset:3072
  s_waitcnt lgkmcnt(7)
  v_mfma_f32_16x16x32_bf16 v[66:69], v[160:163], v[184:187], v[66:69]
  ds_read_b128 v[184:187], v18 offset:4096
  s_waitcnt lgkmcnt(7)
  v_mfma_f32_16x16x32_bf16 v[70:73], a[250:253], v[164:167], v[70:73]
  ds_read_b128 v[196:199], v15 offset:27648
  v_cvt_pk_bf16_f32 v200, v156, v157
  v_mfma_f32_16x16x32_bf16 v[74:77], v[188:191], v[164:167], v[74:77]
  s_waitcnt lgkmcnt(6)
  v_fma_f32 v176, v34, v216, v217
  v_fma_f32 v180, v35, v216, v217
  v_mfma_f32_16x16x32_bf16 v[78:81], v[160:163], v[164:167], v[78:81]
  s_waitcnt lgkmcnt(5)
  v_fma_f32 v177, v36, v216, v217
  v_fma_f32 v181, v37, v216, v217
  v_mfma_f32_16x16x32_bf16 v[82:85], a[250:253], v[150:153], v[82:85]
  ds_read_b128 v[164:167], v15 offset:33792
  v_fma_f32 v178, v38, v216, v217
  v_mfma_f32_16x16x32_bf16 v[86:89], v[188:191], v[150:153], v[86:89]
  v_fma_f32 v188, v39, v216, v217
  v_fma_f32 v179, v40, v216, v217
  v_mfma_f32_16x16x32_bf16 v[90:93], v[160:163], v[150:153], v[90:93]
  v_fma_f32 v189, v41, v216, v217
  v_fma_f32 v160, v46, v218, v219
  v_mfma_f32_16x16x32_bf16 v[150:153], v[114:117], a[168:171], 0
  v_fma_f32 v182, v47, v218, v219
  v_fma_f32 v161, v48, v218, v219
  v_mfma_f32_16x16x32_bf16 v[150:153], v[118:121], a[172:175], v[150:153]
  v_fma_f32 v212, v49, v218, v219
  v_fma_f32 v162, v50, v218, v219
  v_mfma_f32_16x16x32_bf16 v[150:153], v[122:125], a[176:179], v[150:153]
  v_fma_f32 v213, v51, v218, v219
  v_fma_f32 v163, v52, v218, v219
  v_mfma_f32_16x16x32_bf16 v[150:153], v[126:129], a[180:183], v[150:153]
  v_fma_f32 v190, v53, v218, v219
  v_cvt_pk_bf16_f32 v176, v176, v180
  v_mfma_f32_16x16x32_bf16 v[150:153], v[130:133], a[184:187], v[150:153]
  v_cvt_pk_bf16_f32 v177, v177, v181
  v_cvt_pk_bf16_f32 v178, v178, v188
  v_mfma_f32_16x16x32_bf16 v[150:153], v[134:137], a[188:191], v[150:153]
  s_waitcnt lgkmcnt(4)
  v_cvt_pk_bf16_f32 v179, v179, v189
  v_cvt_pk_bf16_f32 v160, v160, v182
  v_mfma_f32_16x16x32_bf16 v[58:61], v[192:195], v[168:171], v[58:61]
  s_waitcnt lgkmcnt(3)
  ds_read_b128 v[180:183], v18 offset:5120
  ds_read_b128 v[204:207], v15 offset:22528
  v_mfma_f32_16x16x32_bf16 v[62:65], v[172:175], v[168:171], v[62:65]
  s_waitcnt lgkmcnt(4)
  ds_read_b128 v[208:211], v18 offset:6144
  v_cvt_pk_bf16_f32 v161, v161, v212
  v_mfma_f32_16x16x32_bf16 v[66:69], v[184:187], v[168:171], v[66:69]
  s_waitcnt lgkmcnt(4)
  ds_read_b128 v[168:171], v18 offset:7168
  v_cvt_pk_bf16_f32 v162, v162, v213
  v_mfma_f32_16x16x32_bf16 v[70:73], v[192:195], v[196:199], v[70:73]
  ds_read_b128 v[212:215], v15 offset:28672
  v_cvt_pk_bf16_f32 v163, v163, v190
  v_mfma_f32_16x16x32_bf16 v[74:77], v[172:175], v[196:199], v[74:77]
  ds_write_b128 v16, v[176:179] offset:8192
  v_mfma_f32_16x16x32_bf16 v[78:81], v[184:187], v[196:199], v[78:81]
  s_waitcnt lgkmcnt(6)
  v_fma_f32 v196, v42, v216, v217
  v_fma_f32 v198, v43, v216, v217
  v_mfma_f32_16x16x32_bf16 v[82:85], v[192:195], v[164:167], v[82:85]
  v_fma_f32 v197, v44, v216, v217
  v_fma_f32 v199, v45, v216, v217
  v_mfma_f32_16x16x32_bf16 v[86:89], v[172:175], v[164:167], v[86:89]
  ds_read_b128 v[192:195], v15 offset:34816
  v_fma_f32 v172, v54, v218, v219
  v_mfma_f32_16x16x32_bf16 v[90:93], v[184:187], v[164:167], v[90:93]
  ds_read_b64 v[188:189], v19 offset:784
  v_fma_f32 v216, v55, v218, v219
  v_mfma_f32_16x16x32_bf16 v[164:167], v[114:117], a[192:195], 0
  ds_read2_b64 v[184:187], v19 offset0:96 offset1:97
  v_fma_f32 v173, v56, v218, v219
  v_mfma_f32_16x16x32_bf16 v[164:167], v[118:121], a[196:199], v[164:167]
  ds_write_b128 v16, v[160:163] offset:14336
  v_mfma_f32_16x16x32_bf16 v[164:167], v[122:125], a[200:203], v[164:167]
  v_fma_f32 v122, v57, v218, v219
  v_cvt_pk_bf16_f32 v196, v196, v198
  v_mfma_f32_16x16x32_bf16 v[164:167], v[126:129], a[204:207], v[164:167]
  v_cvt_pk_bf16_f32 v197, v197, v199
  v_cvt_pk_bf16_f32 v172, v172, v216
  v_mfma_f32_16x16x32_bf16 v[164:167], v[130:133], a[208:211], v[164:167]
  ds_read_b128 v[128:131], v18 offset:8192
  ds_read_b128 v[124:127], v15 offset:23552
  v_mfma_f32_16x16x32_bf16 v[164:167], v[134:137], a[212:215], v[164:167]
  s_waitcnt lgkmcnt(10)
  v_cvt_pk_bf16_f32 v173, v173, v122
  v_cvt_pk_bf16_f32 v201, v158, v159
  v_mfma_f32_16x16x32_bf16 v[58:61], v[180:183], v[204:207], v[58:61]
  s_waitcnt lgkmcnt(9)
  ds_read_b128 v[132:135], v18 offset:9216
  ds_read_b128 v[156:159], v18 offset:10240
  v_mfma_f32_16x16x32_bf16 v[62:65], v[208:211], v[204:207], v[62:65]
  s_waitcnt lgkmcnt(10)
  v_cvt_pk_bf16_f32 v216, v150, v151
  v_cvt_pk_bf16_f32 v217, v152, v153
  v_mfma_f32_16x16x32_bf16 v[66:69], v[168:171], v[204:207], v[66:69]
  s_waitcnt lgkmcnt(9)
  ds_read_b128 v[120:123], v15 offset:29696
  v_cvt_pk_bf16_f32 v204, v164, v165
  v_mfma_f32_16x16x32_bf16 v[70:73], v[180:183], v[212:215], v[70:73]
  ds_write_b64 v17, v[196:197] offset:8192
  v_mfma_f32_16x16x32_bf16 v[74:77], v[208:211], v[212:215], v[74:77]
  ds_read_b128 v[160:163], v15 offset:35840
  v_cvt_pk_bf16_f32 v205, v166, v167
  v_mfma_f32_16x16x32_bf16 v[78:81], v[168:171], v[212:215], v[78:81]
  s_waitcnt lgkmcnt(10)
  ds_write_b64 v17, v[172:173] offset:14336
  v_mfma_f32_16x16x32_bf16 v[82:85], v[180:183], v[192:195], v[82:85]
  v_mfma_f32_16x16x32_bf16 v[86:89], v[208:211], v[192:195], v[86:89]
  ds_read_b128 v[164:167], v18 offset:11264
  ds_read_b128 v[172:175], v15 offset:24576
  v_mfma_f32_16x16x32_bf16 v[90:93], v[168:171], v[192:195], v[90:93]
  s_waitcnt lgkmcnt(12)
  ds_read_b128 v[192:195], v18 offset:12288
  v_mfma_f32_16x16x16_bf16 v[168:171], v[148:149], v[142:143], 0
  ds_read_b128 v[150:153], v18 offset:13312
  v_mfma_f32_16x16x16_bf16 v[180:183], v[148:149], v[188:189], 0
  ds_read_b128 v[196:199], v15 offset:30720
  v_mfma_f32_16x16x32_bf16 v[168:171], v[144:147], v[138:141], v[168:171]
  s_waitcnt lgkmcnt(14)
  v_mfma_f32_16x16x32_bf16 v[180:183], v[144:147], v[184:187], v[180:183]
  s_waitcnt lgkmcnt(11)
  v_mfma_f32_16x16x32_bf16 v[58:61], v[128:131], v[124:127], v[58:61]
  s_waitcnt lgkmcnt(10)
  ds_read_b128 v[208:211], v15 offset:36864
  v_mfma_f32_16x16x32_bf16 v[62:65], v[132:135], v[124:127], v[62:65]
  s_waitcnt lgkmcnt(10)
  v_exp_f32 v168, v168
  v_mfma_f32_16x16x32_bf16 v[66:69], v[156:159], v[124:127], v[66:69]
  s_waitcnt lgkmcnt(9)
  v_exp_f32 v169, v169
  v_mfma_f32_16x16x32_bf16 v[70:73], v[128:131], v[120:123], v[70:73]
  ds_read_b128 v[124:127], v18 offset:14336
  ds_read_b128 v[116:119], v15 offset:25600
  v_mfma_f32_16x16x32_bf16 v[74:77], v[132:135], v[120:123], v[74:77]
  ds_read_b128 v[176:179], v18 offset:15360
  v_cvt_pk_bf16_f32 v212, v168, v169
  v_mfma_f32_16x16x32_bf16 v[78:81], v[156:159], v[120:123], v[78:81]
  s_waitcnt lgkmcnt(10)
  ds_read_b128 v[120:123], v18 offset:16384
  v_mfma_f32_16x16x32_bf16 v[82:85], v[128:131], v[160:163], v[82:85]
  ds_read_b128 v[128:131], v15 offset:31744
  v_mfma_f32_16x16x32_bf16 v[86:89], v[132:135], v[160:163], v[86:89]
  v_exp_f32 v170, v170
  v_mfma_f32_16x16x32_bf16 v[90:93], v[156:159], v[160:163], v[90:93]
  s_waitcnt lgkmcnt(9)
  v_exp_f32 v171, v171
  v_mfma_f32_16x16x32_bf16 v[58:61], v[164:167], v[172:175], v[58:61]
  s_waitcnt lgkmcnt(8)
  ds_read_b128 v[132:135], v15 offset:37888
  v_cvt_pk_bf16_f32 v213, v170, v171
  v_mfma_f32_16x16x32_bf16 v[62:65], v[192:195], v[172:175], v[62:65]
  s_waitcnt lgkmcnt(8)
  v_exp_f32 v180, v180
  v_mfma_f32_16x16x32_bf16 v[66:69], v[150:153], v[172:175], v[66:69]
  s_waitcnt lgkmcnt(7)
  v_exp_f32 v181, v181
  v_mfma_f32_16x16x32_bf16 v[70:73], v[164:167], v[196:199], v[70:73]
  v_exp_f32 v182, v182
  v_mfma_f32_16x16x32_bf16 v[74:77], v[192:195], v[196:199], v[74:77]
  v_exp_f32 v183, v183
  v_mfma_f32_16x16x32_bf16 v[78:81], v[150:153], v[196:199], v[78:81]
  s_waitcnt lgkmcnt(6)
  v_cvt_pk_bf16_f32 v220, v180, v181
  v_cvt_pk_bf16_f32 v221, v182, v183
  v_mfma_f32_16x16x32_bf16 v[82:85], v[164:167], v[208:211], v[82:85]
  v_mfma_f32_16x16x32_bf16 v[86:89], v[192:195], v[208:211], v[86:89]
  v_mfma_f32_16x16x32_bf16 v[90:93], v[150:153], v[208:211], v[90:93]
  s_waitcnt lgkmcnt(4)
  s_barrier
  v_mfma_f32_16x16x32_bf16 v[58:61], v[124:127], v[116:119], v[58:61]
  s_waitcnt lgkmcnt(3)
  ds_read_b128 v[208:211], v15 offset:8192
  ds_read_b128 v[224:227], v15 offset:9216
  v_mfma_f32_16x16x32_bf16 v[62:65], v[176:179], v[116:119], v[62:65]
  s_waitcnt lgkmcnt(4)
  ds_read_b128 v[228:231], v15 offset:10240
  v_mfma_f32_16x16x32_bf16 v[66:69], v[120:123], v[116:119], v[66:69]
  s_waitcnt lgkmcnt(4)
  ds_read_b128 v[232:235], v15 offset:11264
  v_cvt_pk_bf16_f32 v116, v58, v59
  v_mfma_f32_16x16x32_bf16 v[70:73], v[124:127], v[128:131], v[70:73]
  ds_read_b128 v[236:239], v15 offset:12288
  v_cvt_pk_bf16_f32 v117, v60, v61
  v_mfma_f32_16x16x32_bf16 v[74:77], v[176:179], v[128:131], v[74:77]
  ds_read_b128 v[240:243], v15 offset:13312
  v_cvt_pk_bf16_f32 v118, v62, v63
  v_mfma_f32_16x16x32_bf16 v[78:81], v[120:123], v[128:131], v[78:81]
  s_waitcnt lgkmcnt(6)
  v_cvt_pk_bf16_f32 v119, v64, v65
  v_cvt_pk_bf16_f32 v180, v66, v67
  v_mfma_f32_16x16x32_bf16 v[82:85], v[124:127], v[132:135], v[82:85]
  s_waitcnt vmcnt(0)
  ds_read_b64 v[192:193], v9
  ds_read_b64 v[194:195], v9 offset:32
  v_mfma_f32_16x16x32_bf16 v[86:89], v[176:179], v[132:135], v[86:89]
  s_lshl_b32 s60, s31, 5
  ds_read_b64 v[168:169], v9 offset:64
  v_cvt_pk_bf16_f32 v181, v68, v69
  v_mfma_f32_16x16x32_bf16 v[90:93], v[120:123], v[132:135], v[90:93]
  s_waitcnt lgkmcnt(8)
  ds_read_b128 v[128:131], v3
  v_cvt_pk_bf16_f32 v176, v70, v71
  v_mfma_f32_16x16x32_bf16 v[172:175], a[72:75], v[208:211], 0
  s_waitcnt lgkmcnt(8)
  ds_read_b128 v[132:135], v3 offset:864
  v_cvt_pk_bf16_f32 v177, v72, v73
  v_mfma_f32_16x16x32_bf16 v[172:175], a[76:79], v[224:227], v[172:175]
  s_waitcnt lgkmcnt(8)
  ds_read_b128 v[120:123], v3 offset:1728
  v_cvt_pk_bf16_f32 v178, v74, v75
  v_mfma_f32_16x16x32_bf16 v[172:175], a[80:83], v[228:231], v[172:175]
  s_waitcnt lgkmcnt(8)
  ds_read_b128 v[124:127], v6
  v_cvt_pk_bf16_f32 v179, v76, v77
  v_mfma_f32_16x16x32_bf16 v[172:175], a[84:87], v[232:235], v[172:175]
  s_waitcnt lgkmcnt(8)
  ds_read_b128 v[152:155], v3 offset:32
  v_cvt_pk_bf16_f32 v182, v78, v79
  v_mfma_f32_16x16x32_bf16 v[172:175], a[88:91], v[236:239], v[172:175]
  s_waitcnt lgkmcnt(8)
  ds_read_b128 v[156:159], v3 offset:896
  v_cvt_pk_bf16_f32 v183, v80, v81
  v_mfma_f32_16x16x32_bf16 v[172:175], a[92:95], v[240:243], v[172:175]
  s_waitcnt lgkmcnt(6)
  ds_read_b128 v[160:163], v3 offset:1760
  v_cvt_pk_bf16_f32 v114, v82, v83
  v_cvt_pk_bf16_f32 v115, v84, v85
  v_mfma_f32_16x16x16_bf16 v[58:61], a[224:225], v[192:193], 0
  v_cvt_pk_bf16_f32 v244, v86, v87
  v_cvt_pk_bf16_f32 v245, v88, v89
  v_cvt_pk_bf16_f32 v150, v90, v91
  v_mfma_f32_16x16x16_bf16 v[62:65], a[234:235], v[194:195], 0
  v_cvt_pk_bf16_f32 v151, v92, v93
  v_cvt_pk_bf16_f32 v192, v172, v173
  v_cvt_pk_bf16_f32 v193, v174, v175
  v_mfma_f32_16x16x16_bf16 v[66:69], a[244:245], v[168:169], 0
  s_add_u32 s61, s60, s30
  ds_read_b128 v[164:167], v6 offset:32
  ds_read_b128 v[168:171], v3 offset:64
  s_waitcnt lgkmcnt(7)
  v_smfmac_f32_16x16x64_bf16 v[58:61], a[216:219], v[128:135], v0
  s_waitcnt lgkmcnt(5)
  ds_read_b128 v[172:175], v3 offset:928
  v_smfmac_f32_16x16x64_bf16 v[58:61], a[220:223], v[120:127], v0
  s_add_u32 s60, s60, s29
  ds_read_b128 v[120:123], v3 offset:1792
  v_mfma_f32_16x16x32_bf16 v[128:131], a[96:99], v[208:211], 0
  s_mul_i32 s62, s60, 7183
  ds_read_b128 v[124:127], v6 offset:64
  v_mfma_f32_16x16x32_bf16 v[128:131], a[100:103], v[224:227], v[128:131]
  s_lshr_b32 s62, s62, 22
  buffer_store_dwordx2 v[116:117], v12, s[8:11], s32 offen
  v_mul_f32 v94, v58, v58
  v_mfma_f32_16x16x32_bf16 v[128:131], a[104:107], v[228:231], v[128:131]
  s_waitcnt lgkmcnt(6)
  buffer_store_dwordx2 v[118:119], v12, s[8:11], s32 offen offset:32
  v_add_f32 v96, v58, v59
  v_smfmac_f32_16x16x64_bf16 v[62:65], a[226:229], v[152:159], v0
  s_waitcnt lgkmcnt(4)
  buffer_store_dwordx2 v[180:181], v12, s[8:11], s32 offen offset:64
  v_fmac_f32 v94, v59, v59
  v_smfmac_f32_16x16x64_bf16 v[62:65], a[230:233], v[160:167], v0
  s_mul_i32 s63, s62, 584
  buffer_store_dwordx2 v[176:177], v13, s[8:11], s32 offen
  v_add_f32 v96, v96, v60
  v_mfma_f32_16x16x32_bf16 v[128:131], a[108:111], v[232:235], v[128:131]
  s_sub_u32 s63, s60, s63
  buffer_store_dwordx2 v[178:179], v13, s[8:11], s32 offen offset:32
  v_fmac_f32 v94, v60, v60
  v_mfma_f32_16x16x32_bf16 v[128:131], a[112:115], v[236:239], v[128:131]
  s_lshr_b32 s64, s63, 3
  buffer_store_dwordx2 v[182:183], v13, s[8:11], s32 offen offset:64
  v_add_f32 v96, v96, v61
  v_mfma_f32_16x16x32_bf16 v[128:131], a[116:119], v[240:243], v[128:131]
  s_waitcnt lgkmcnt(2)
  ds_read_b64 v[118:119], v10
  v_fmac_f32 v94, v61, v61
  v_smfmac_f32_16x16x64_bf16 v[66:69], a[236:239], v[168:175], v0
  s_waitcnt lgkmcnt(1)
  ds_read_b64 v[116:117], v10 offset:32
  v_add_f32 v96, v96, v62
  v_smfmac_f32_16x16x64_bf16 v[66:69], a[240:243], v[120:127], v0
  s_and_b32 s65, s63, 7
  ds_read_b64 v[198:199], v10 offset:64
  v_cvt_pk_bf16_f32 v194, v128, v129
  v_mfma_f32_16x16x32_bf16 v[132:135], a[120:123], v[208:211], 0
  s_lshl_b32 s66, s62, 3
  ds_read_b128 v[120:123], v4
  ds_read_b128 v[124:127], v4 offset:864
  v_mfma_f32_16x16x32_bf16 v[132:135], a[124:127], v[224:227], v[132:135]
  s_add_u32 s65, s65, s66
  ds_read_b128 v[168:171], v4 offset:1728
  v_cvt_pk_bf16_f32 v195, v130, v131
  v_mfma_f32_16x16x32_bf16 v[132:135], a[128:131], v[228:231], v[132:135]
  s_cmp_ge_u32 s60, 5256
  ds_read_b128 v[172:175], v7
  v_fmac_f32 v94, v62, v62
  v_mfma_f32_16x16x32_bf16 v[132:135], a[132:135], v[232:235], v[132:135]
  s_cselect_b32 s64, s63, s64
  buffer_store_dwordx2 v[114:115], v14, s[8:11], s32 offen
  v_add_f32 v96, v96, v63
  v_mfma_f32_16x16x32_bf16 v[132:135], a[136:139], v[236:239], v[132:135]
  s_cselect_b32 s65, 72, s65
  buffer_store_dwordx2 v[244:245], v14, s[8:11], s32 offen offset:32
  v_fmac_f32 v94, v63, v63
  v_mfma_f32_16x16x32_bf16 v[132:135], a[140:143], v[240:243], v[132:135]
  s_mul_i32 s66, s65, 1373568
  ds_read_b128 v[160:163], v4 offset:32
  ds_read_b128 v[164:167], v4 offset:896
  v_mfma_f32_16x16x32_bf16 v[244:247], a[0:3], v[208:211], 0
  s_mul_i32 s67, s64, 2688
  ds_read_b128 v[152:155], v4 offset:1760
  v_add_f32 v96, v96, v64
  v_mfma_f32_16x16x32_bf16 v[244:247], a[4:7], v[224:227], v[244:247]
  s_add_u32 s35, s66, s67
  ds_read_b128 v[156:159], v7 offset:32
  v_cvt_pk_bf16_f32 v196, v132, v133
  v_mfma_f32_16x16x32_bf16 v[244:247], a[8:11], v[228:231], v[244:247]
  s_cmp_ge_u32 s61, 667
  buffer_store_dwordx2 v[150:151], v14, s[8:11], s32 offen offset:64
  v_cvt_pk_bf16_f32 v197, v134, v135
  v_mfma_f32_16x16x32_bf16 v[244:247], a[12:15], v[232:235], v[244:247]
  s_cselect_b32 s35, 268435456, s35
  v_fmac_f32 v94, v64, v64
  v_add_f32 v96, v96, v65
  v_mfma_f32_16x16x32_bf16 v[244:247], a[16:19], v[236:239], v[244:247]
  s_cmp_ge_u32 s60, 5329
  ds_read_b128 v[128:131], v4 offset:64
  ds_read_b128 v[132:135], v4 offset:928
  v_mfma_f32_16x16x32_bf16 v[244:247], a[20:23], v[240:243], v[244:247]
  s_waitcnt lgkmcnt(8)
  ds_read_b128 v[176:179], v4 offset:1792
  v_fmac_f32 v94, v65, v65
  v_add_f32 v96, v96, v66
  v_mfma_f32_16x16x16_bf16 v[70:73], a[224:225], v[118:119], 0
  v_fmac_f32 v94, v66, v66
  v_add_f32 v96, v96, v67
  v_fmac_f32 v94, v67, v67
  v_mfma_f32_16x16x16_bf16 v[74:77], a[234:235], v[116:117], 0
  v_cvt_pk_bf16_f32 v114, v244, v245
  v_cvt_pk_bf16_f32 v115, v246, v247
  v_add_f32 v96, v96, v68
  v_mfma_f32_16x16x16_bf16 v[78:81], a[244:245], v[198:199], 0
  v_fmac_f32 v94, v68, v68
  v_add_f32 v96, v96, v69
  v_fmac_f32 v94, v69, v69
  v_smfmac_f32_16x16x64_bf16 v[70:73], a[216:219], v[120:127], v0
  s_waitcnt lgkmcnt(7)
  ds_read_b128 v[180:183], v7 offset:64
  v_smfmac_f32_16x16x64_bf16 v[70:73], a[220:223], v[168:175], v0
  s_cselect_b32 s35, 268435456, s35
  v_mfma_f32_16x16x32_bf16 v[168:171], a[24:27], v[208:211], 0
  s_cmp_eq_u32 s65, 0
  v_permlane32_swap_b32 v96, v94
  v_mfma_f32_16x16x32_bf16 v[168:171], a[28:31], v[224:227], v[168:171]
  s_cselect_b32 s36, 268435456, s35
  v_mul_f32 v98, v70, v70
  v_add_f32 v99, v70, v71
  v_mfma_f32_16x16x32_bf16 v[168:171], a[32:35], v[228:231], v[168:171]
  s_waitcnt lgkmcnt(6)
  v_fmac_f32 v98, v71, v71
  v_add_f32 v99, v99, v72
  v_smfmac_f32_16x16x64_bf16 v[74:77], a[226:229], v[160:167], v0
  s_waitcnt lgkmcnt(4)
  v_fmac_f32 v98, v72, v72
  v_smfmac_f32_16x16x64_bf16 v[74:77], a[230:233], v[152:159], v0
  s_add_u32 s37, s35, 195360
  v_add_f32 v99, v99, v73
  v_mfma_f32_16x16x32_bf16 v[168:171], a[36:39], v[232:235], v[168:171]
  s_add_u32 s38, s35, 390720
  v_fmac_f32 v98, v73, v73
  v_add_f32 v96, v96, v94
  v_mfma_f32_16x16x32_bf16 v[168:171], a[40:43], v[236:239], v[168:171]
  s_add_u32 s39, s35, 586080
  v_add_f32 v99, v99, v74
  v_fmac_f32 v98, v74, v74
  v_mfma_f32_16x16x32_bf16 v[168:171], a[44:47], v[240:243], v[168:171]
  s_waitcnt lgkmcnt(2)
  ds_read_b64 v[198:199], v11
  v_add_f32 v99, v99, v75
  v_smfmac_f32_16x16x64_bf16 v[78:81], a[236:239], v[128:135], v0
  s_waitcnt lgkmcnt(1)
  ds_read_b64 v[150:151], v11 offset:32
  v_fmac_f32 v98, v75, v75
  v_smfmac_f32_16x16x64_bf16 v[78:81], a[240:243], v[176:183], v0
  s_add_u32 s40, s35, 781440
  ds_read_b64 v[94:95], v11 offset:64
  v_cvt_pk_bf16_f32 v116, v168, v169
  v_mfma_f32_16x16x32_bf16 v[172:175], a[48:51], v[208:211], 0
  s_add_u32 s41, s35, 981120
  ds_read_b128 v[176:179], v5
  ds_read_b128 v[180:183], v5 offset:864
  v_mfma_f32_16x16x32_bf16 v[172:175], a[52:55], v[224:227], v[172:175]
  s_add_u32 s42, s35, 1176480
  ds_read_b128 v[128:131], v5 offset:1728
  v_cvt_pk_bf16_f32 v117, v170, v171
  v_mfma_f32_16x16x32_bf16 v[172:175], a[56:59], v[228:231], v[172:175]
  s_add_u32 s43, s35, 1371840
  ds_read_b128 v[132:135], v8
  v_add_f32 v99, v99, v76
  v_mfma_f32_16x16x32_bf16 v[172:175], a[60:63], v[232:235], v[172:175]
  s_add_u32 s44, s35, 1567200
  v_fmac_f32 v98, v76, v76
  v_add_f32 v99, v99, v77
  v_mfma_f32_16x16x32_bf16 v[172:175], a[64:67], v[236:239], v[172:175]
  s_cmp_eq_u32 s64, 0
  v_fmac_f32 v98, v77, v77
  v_add_f32 v99, v99, v78
  v_mfma_f32_16x16x32_bf16 v[172:175], a[68:71], v[240:243], v[172:175]
  s_cselect_b64 s[52:53], s[48:49], 0
  ds_read_b128 v[152:155], v5 offset:32
  ds_read_b128 v[156:159], v5 offset:896
  v_mfma_f32_16x16x32_bf16 v[244:247], v[208:211], a[144:147], 0
  s_cmp_eq_u32 s64, 72
  ds_read_b128 v[160:163], v5 offset:1760
  v_fmac_f32 v98, v78, v78
  v_mfma_f32_16x16x32_bf16 v[244:247], v[224:227], a[148:151], v[244:247]
  s_cselect_b64 s[52:53], s[50:51], s[52:53]
  ds_read_b128 v[164:167], v8 offset:32
  v_cvt_pk_bf16_f32 v118, v172, v173
  v_mfma_f32_16x16x32_bf16 v[244:247], v[228:231], a[152:155], v[244:247]
  s_add_u32 s31, s31, 1
  v_cvt_pk_bf16_f32 v119, v174, v175
  v_add_f32 v99, v99, v79
  v_mfma_f32_16x16x32_bf16 v[244:247], v[232:235], a[156:159], v[244:247]
  s_mov_b32 m0, s58
  v_fmac_f32 v98, v79, v79
  v_add_f32 v99, v99, v80
  v_mfma_f32_16x16x32_bf16 v[244:247], v[236:239], a[160:163], v[244:247]
  ds_read_b128 v[168:171], v5 offset:64
  ds_read_b128 v[172:175], v5 offset:928
  v_mfma_f32_16x16x32_bf16 v[244:247], v[240:243], a[164:167], v[244:247]
  s_waitcnt lgkmcnt(8)
  ds_read_b128 v[120:123], v5 offset:1792
  v_fmac_f32 v98, v80, v80
  v_add_f32 v99, v99, v81
  v_mfma_f32_16x16x16_bf16 v[82:85], a[224:225], v[198:199], 0
  v_fmac_f32 v98, v81, v81
  v_cndmask_b32 v198, v21, 2.0, s[52:53]
  v_mfma_f32_16x16x16_bf16 v[86:89], a[234:235], v[150:151], 0
  ds_read_b128 v[124:127], v8 offset:64
  v_permlane32_swap_b32 v99, v98
  v_mfma_f32_16x16x16_bf16 v[90:93], a[244:245], v[94:95], 0
  v_add_f32 v99, v99, v98
  v_cvt_pk_bf16_f32 v202, v244, v245
  v_cvt_pk_bf16_f32 v203, v246, v247
  v_smfmac_f32_16x16x64_bf16 v[82:85], a[216:219], v[176:183], v0
  s_waitcnt lgkmcnt(8)
  v_smfmac_f32_16x16x64_bf16 v[82:85], a[220:223], v[128:135], v0
  v_mfma_f32_16x16x32_bf16 v[128:131], v[208:211], a[168:171], 0
  v_permlane16_swap_b32 v96, v99
  v_mfma_f32_16x16x32_bf16 v[128:131], v[224:227], a[172:175], v[128:131]
  s_waitcnt lgkmcnt(0)
  buffer_load_dwordx4 v198, s[4:7], s36 offen lds
  v_mfma_f32_16x16x32_bf16 v[128:131], v[228:231], a[176:179], v[128:131]
  buffer_load_dwordx4 v198, s[4:7], s37 offen offset:864 lds
  v_smfmac_f32_16x16x64_bf16 v[86:89], a[226:229], v[152:159], v0
  ds_read_b128 v[132:135], v15 offset:14336
  v_mul_f32 v152, v82, v82
  v_smfmac_f32_16x16x64_bf16 v[86:89], a[230:233], v[160:167], v0
  ds_read_b128 v[160:163], v15 offset:15360
  v_add_f32 v153, v82, v83
  v_mfma_f32_16x16x32_bf16 v[128:131], v[232:235], a[180:183], v[128:131]
  ds_read_b128 v[164:167], v15 offset:16384
  v_fmac_f32 v152, v83, v83
  v_mfma_f32_16x16x32_bf16 v[128:131], v[236:239], a[184:187], v[128:131]
  ds_read_b128 v[176:179], v15 offset:17408
  v_add_f32 v153, v153, v84
  v_mfma_f32_16x16x32_bf16 v[128:131], v[240:243], a[188:191], v[128:131]
  ds_read_b128 v[180:183], v15 offset:18432
  v_fmac_f32 v152, v84, v84
  v_smfmac_f32_16x16x64_bf16 v[90:93], a[236:239], v[168:175], v0
  ds_read_b128 v[244:247], v15 offset:19456
  v_add_f32 v153, v153, v85
  v_smfmac_f32_16x16x64_bf16 v[90:93], a[240:243], v[120:127], v0
  buffer_load_dwordx4 v198, s[4:7], s38 offen offset:1728 lds
  v_mfma_f32_16x16x32_bf16 v[168:171], v[208:211], a[192:195], 0
  buffer_load_dwordx4 v198, s[4:7], s39 offen offset:2592 lds
  v_mfma_f32_16x16x32_bf16 v[168:171], v[224:227], a[196:199], v[168:171]
  buffer_load_dwordx4 v198, s[4:7], s40 offen offset:3456 lds
  v_mfma_f32_16x16x32_bf16 v[168:171], v[228:231], a[200:203], v[168:171]
  s_mov_b32 m0, s59
  v_fmac_f32 v152, v85, v85
  v_add_f32 v153, v153, v86
  v_mfma_f32_16x16x32_bf16 v[168:171], v[232:235], a[204:207], v[168:171]
  s_mov_b32 s32, s33
  buffer_load_dwordx4 v198, s[4:7], s41 offen lds
  v_mfma_f32_16x16x32_bf16 v[168:171], v[236:239], a[208:211], v[168:171]
  s_mov_b32 s33, s34
  v_fmac_f32 v152, v86, v86
  v_add_f32 v153, v153, v87
  v_mfma_f32_16x16x32_bf16 v[168:171], v[240:243], a[212:215], v[168:171]
  s_mov_b32 s34, s35
  v_fmac_f32 v152, v87, v87
  v_add_f32 v153, v153, v88
  v_fmac_f32 v152, v88, v88
  v_mfma_f32_16x16x16_bf16 v[172:175], v[196:197], v[142:143], 0
  v_add_f32 v153, v153, v89
  v_fmac_f32 v152, v89, v89
  v_add_f32 v153, v153, v90
  v_mfma_f32_16x16x16_bf16 v[120:123], v[148:149], v[118:119], 0
  v_fmac_f32 v152, v90, v90
  v_add_f32 v153, v153, v91
  v_fmac_f32 v152, v91, v91
  v_add_f32 v153, v153, v92
  v_mfma_f32_16x16x32_bf16 v[172:175], v[192:195], v[138:141], v[172:175]
  v_fmac_f32 v152, v92, v92
  v_add_f32 v153, v153, v93
  v_mfma_f32_16x16x32_bf16 v[120:123], v[144:147], v[114:117], v[120:123]
  s_waitcnt lgkmcnt(5)
  v_fmac_f32 v152, v93, v93
  v_add_f32 v96, v96, v99
  v_mfma_f32_16x16x32_bf16 v[240:243], a[72:75], v[132:135], 0
  s_waitcnt lgkmcnt(4)
  ds_write_b32 v97, v96
  v_mfma_f32_16x16x32_bf16 v[240:243], a[76:79], v[160:163], v[240:243]
  s_waitcnt lgkmcnt(4)
  v_permlane32_swap_b32 v153, v152
  v_mfma_f32_16x16x32_bf16 v[240:243], a[80:83], v[164:167], v[240:243]
  s_waitcnt lgkmcnt(3)
  v_add_f32 v153, v153, v152
  v_mov_b32 v152, v153
  v_mfma_f32_16x16x32_bf16 v[240:243], a[84:87], v[176:179], v[240:243]
  s_waitcnt lgkmcnt(2)
  v_permlane16_swap_b32 v153, v152
  v_mfma_f32_16x16x32_bf16 v[240:243], a[88:91], v[180:183], v[240:243]
  s_waitcnt lgkmcnt(1)
  v_add_f32 v153, v153, v152
  v_cvt_pk_bf16_f32 v218, v128, v129
  v_mfma_f32_16x16x32_bf16 v[240:243], a[92:95], v[244:247], v[240:243]
  ds_write_b32 v97, v153 offset:512
  v_mfma_f32_16x16x32_bf16 v[236:239], a[96:99], v[132:135], 0
  buffer_load_dwordx4 v198, s[4:7], s42 offen offset:864 lds
  v_mfma_f32_16x16x32_bf16 v[236:239], a[100:103], v[160:163], v[236:239]
  buffer_load_dwordx4 v198, s[4:7], s43 offen offset:1728 lds
  v_mfma_f32_16x16x32_bf16 v[236:239], a[104:107], v[164:167], v[236:239]
  buffer_load_dwordx4 v198, s[4:7], s44 offen offset:2592 lds
  v_mfma_f32_16x16x32_bf16 v[236:239], a[108:111], v[176:179], v[236:239]
  v_cvt_pk_bf16_f32 v152, v240, v241
  v_cvt_pk_bf16_f32 v153, v242, v243
  v_mfma_f32_16x16x32_bf16 v[236:239], a[112:115], v[180:183], v[236:239]
  v_exp_f32 v172, v172
  v_mfma_f32_16x16x32_bf16 v[236:239], a[116:119], v[244:247], v[236:239]
  s_waitcnt lgkmcnt(0)
  s_barrier
  v_mfma_f32_16x16x32_bf16 v[240:243], a[120:123], v[132:135], 0
  ds_read_b128 v[124:127], v15
  ds_read_b128 v[232:235], v15 offset:1024
  v_mfma_f32_16x16x32_bf16 v[240:243], a[124:127], v[160:163], v[240:243]
  v_cvt_pk_bf16_f32 v154, v236, v237
  v_cvt_pk_bf16_f32 v155, v238, v239
  v_mfma_f32_16x16x32_bf16 v[240:243], a[128:131], v[164:167], v[240:243]
  v_exp_f32 v173, v173
  v_mfma_f32_16x16x32_bf16 v[240:243], a[132:135], v[176:179], v[240:243]
  v_exp_f32 v174, v174
  v_mfma_f32_16x16x32_bf16 v[240:243], a[136:139], v[180:183], v[240:243]
  v_exp_f32 v175, v175
  v_mfma_f32_16x16x32_bf16 v[240:243], a[140:143], v[244:247], v[240:243]
  v_cvt_pk_bf16_f32 v214, v172, v173
  v_cvt_pk_bf16_f32 v215, v174, v175
  v_cvt_pk_bf16_f32 v219, v130, v131
  v_mfma_f32_16x16x16_bf16 v[128:131], v[196:197], v[118:119], 0
  v_cvt_pk_bf16_f32 v206, v168, v169
  v_cvt_pk_bf16_f32 v207, v170, v171
  v_mfma_f32_16x16x16_bf16 v[236:239], v[196:197], v[188:189], 0
  ds_read_b64 v[172:173], v19 offset:16
  ds_read2_b64 v[168:171], v19 offset0:0 offset1:1
  v_cvt_pk_bf16_f32 v156, v240, v241
  v_cvt_pk_bf16_f32 v157, v242, v243
  v_mfma_f32_16x16x32_bf16 v[128:131], v[192:195], v[114:117], v[128:131]
  s_waitcnt lgkmcnt(2)
  v_add_f32 v124, v124, v125
  v_add_f32 v126, v126, v127
  v_mfma_f32_16x16x32_bf16 v[236:239], v[192:195], v[184:187], v[236:239]
  v_add_f32 v232, v232, v233
  v_add_f32 v234, v234, v235
  v_mfma_f32_16x16x32_bf16 v[240:243], v[132:135], a[144:147], 0
  v_add_f32 v124, v124, v126
  v_add_f32 v232, v232, v234
  v_mfma_f32_16x16x32_bf16 v[240:243], v[160:163], a[148:151], v[240:243]
  v_mul_f32 v125, 0x3baaaaab, v124
  v_fma_f32 v232, -v125, v124, v232
  v_mfma_f32_16x16x32_bf16 v[240:243], v[164:167], a[152:155], v[240:243]
  v_max_f32 v232, 0, v232
  v_add_f32 v232, 0x3afba882, v232
  v_mfma_f32_16x16x32_bf16 v[240:243], v[176:179], a[156:159], v[240:243]
  v_rsq_f32 v232, v232
  v_mfma_f32_16x16x32_bf16 v[240:243], v[180:183], a[160:163], v[240:243]
  v_mul_f32 v232, 0x40ca568a, v232
  v_mul_f32 v233, -v125, v232
  v_mfma_f32_16x16x32_bf16 v[240:243], v[244:247], a[164:167], v[240:243]
  ds_write_b64 v101, v[232:233]
  v_mfma_f32_16x16x32_bf16 v[124:127], v[132:135], a[168:171], 0
  ds_read_b64 v[174:175], v105 offset:768
  v_add_u32 v19, 1152, v19
  v_mfma_f32_16x16x32_bf16 v[124:127], v[160:163], a[172:175], v[124:127]
  v_cvt_pk_bf16_f32 v94, v240, v241
  v_cvt_pk_bf16_f32 v95, v242, v243
  v_mfma_f32_16x16x32_bf16 v[124:127], v[164:167], a[176:179], v[124:127]
  v_exp_f32 v120, v120
  v_mfma_f32_16x16x32_bf16 v[124:127], v[176:179], a[180:183], v[124:127]
  v_exp_f32 v121, v121
  v_mfma_f32_16x16x32_bf16 v[124:127], v[180:183], a[184:187], v[124:127]
  v_exp_f32 v122, v122
  v_mfma_f32_16x16x32_bf16 v[124:127], v[244:247], a[188:191], v[124:127]
  s_waitcnt lgkmcnt(3)
  v_exp_f32 v123, v123
  v_cvt_pk_bf16_f32 v240, v120, v121
  v_mfma_f32_16x16x16_bf16 v[232:235], v[156:157], v[142:143], 0
  v_exp_f32 v128, v128
  v_cvt_pk_bf16_f32 v241, v122, v123
  v_mfma_f32_16x16x16_bf16 v[120:123], v[172:173], v[142:143], v[2:5]
  v_cvt_pk_bf16_f32 v98, v124, v125
  v_cvt_pk_bf16_f32 v99, v126, v127
  v_exp_f32 v129, v129
  v_mfma_f32_16x16x32_bf16 v[232:235], v[152:155], v[138:141], v[232:235]
  s_waitcnt lgkmcnt(0)
  v_exp_f32 v130, v130
  v_mfma_f32_16x16x32_bf16 v[120:123], v[168:171], v[138:141], v[120:123]
  v_exp_f32 v131, v131
  v_mfma_f32_16x16x32_bf16 v[140:143], v[132:135], a[192:195], 0
  v_exp_f32 v232, v232
  v_mfma_f32_16x16x32_bf16 v[140:143], v[160:163], a[196:199], v[140:143]
  v_exp_f32 v233, v233
  v_mfma_f32_16x16x32_bf16 v[140:143], v[164:167], a[200:203], v[140:143]
  ds_read_u16 v96, v20
  v_cvt_pk_bf16_f32 v106, v232, v233
  v_mfma_f32_16x16x32_bf16 v[140:143], v[176:179], a[204:207], v[140:143]
  v_exp_f32 v234, v234
  v_mfma_f32_16x16x32_bf16 v[140:143], v[180:183], a[208:211], v[140:143]
  ds_read_u16 v100, v20 offset:32
  v_cvt_pk_bf16_f32 v242, v128, v129
  v_mfma_f32_16x16x32_bf16 v[140:143], v[244:247], a[212:215], v[140:143]
  v_exp_f32 v235, v235
  v_cvt_pk_bf16_f32 v243, v130, v131
  v_mfma_f32_16x16x16_bf16 v[128:131], v[156:157], v[118:119], 0
  v_exp_f32 v120, v120
  v_cvt_pk_bf16_f32 v107, v234, v235
  v_mfma_f32_16x16x16_bf16 v[124:127], v[172:173], v[118:119], v[2:5]
  v_cvt_pk_bf16_f32 v108, v120, 0
  v_cvt_pk_bf16_f32 v102, v140, v141
  v_cvt_pk_bf16_f32 v103, v142, v143
  v_fma_f32 v140, v58, v174, v175
  v_mfma_f32_16x16x32_bf16 v[128:131], v[152:155], v[114:117], v[128:131]
  ds_read_u16 v104, v20 offset:64
  v_fma_f32 v138, v59, v174, v175
  v_mfma_f32_16x16x32_bf16 v[124:127], v[168:171], v[114:117], v[124:127]
  v_fma_f32 v141, v60, v174, v175
  v_fma_f32 v139, v61, v174, v175
  v_mfma_f32_16x16x32_bf16 v[116:119], a[0:3], v[132:135], 0
  v_exp_f32 v128, v128
  v_mfma_f32_16x16x32_bf16 v[116:119], a[4:7], v[160:163], v[116:119]
  v_exp_f32 v129, v129
  v_mfma_f32_16x16x32_bf16 v[116:119], a[8:11], v[164:167], v[116:119]
  v_exp_f32 v130, v130
  v_mfma_f32_16x16x32_bf16 v[116:119], a[12:15], v[176:179], v[116:119]
  v_exp_f32 v131, v131
  v_mfma_f32_16x16x32_bf16 v[116:119], a[16:19], v[180:183], v[116:119]
  v_exp_f32 v124, v124
  v_mfma_f32_16x16x32_bf16 v[116:119], a[20:23], v[244:247], v[116:119]
  v_cvt_pk_bf16_f32 v110, v128, v129
  v_cvt_pk_bf16_f32 v111, v130, v131
  v_mfma_f32_16x16x32_bf16 v[232:235], a[246:249], v[212:215], 0
  v_cvt_pk_bf16_f32 v112, v124, 0
  v_fma_f32 v142, v62, v174, v175
  v_mfma_f32_16x16x32_bf16 v[232:235], a[246:249], v[106:109], v[232:235]
  v_fma_f32 v128, v63, v174, v175
  v_fma_f32 v143, v64, v174, v175
  v_mfma_f32_16x16x32_bf16 v[228:231], v[200:203], v[212:215], 0
  s_waitcnt lgkmcnt(2)
  v_fma_f32 v129, v65, v174, v175
  v_cvt_pk_bf16_f32 v140, v140, v138
  v_mfma_f32_16x16x32_bf16 v[228:231], v[94:97], v[106:109], v[228:231]
  v_cvt_pk_bf16_f32 v141, v141, v139
  v_cvt_pk_bf16_f32 v142, v142, v128
  v_mfma_f32_16x16x32_bf16 v[224:227], v[216:219], v[212:215], 0
  s_waitcnt lgkmcnt(1)
  v_cvt_pk_bf16_f32 v143, v143, v129
  v_fma_f32 v128, v66, v174, v175
  v_mfma_f32_16x16x32_bf16 v[224:227], v[98:101], v[106:109], v[224:227]
  ds_write_b128 v16, v[140:143] offset:2048
  v_mfma_f32_16x16x32_bf16 v[208:211], v[204:207], v[212:215], 0
  s_waitcnt lgkmcnt(1)
  v_fma_f32 v140, v67, v174, v175
  v_fma_f32 v129, v68, v174, v175
  v_mfma_f32_16x16x32_bf16 v[208:211], v[102:105], v[106:109], v[208:211]
  v_fma_f32 v141, v69, v174, v175
  v_cvt_pk_bf16_f32 v128, v128, v140
  v_mfma_f32_16x16x32_bf16 v[124:127], a[24:27], v[132:135], 0
  v_cvt_pk_bf16_f32 v129, v129, v141
  v_cvt_pk_bf16_f32 v138, v116, v117
  v_mfma_f32_16x16x32_bf16 v[124:127], a[28:31], v[160:163], v[124:127]
  ds_write_b64 v17, v[128:129] offset:2048
  v_mfma_f32_16x16x32_bf16 v[124:127], a[32:35], v[164:167], v[124:127]
  v_exp_f32 v236, v236
  v_mfma_f32_16x16x32_bf16 v[124:127], a[36:39], v[176:179], v[124:127]
  v_exp_f32 v237, v237
  v_mfma_f32_16x16x32_bf16 v[124:127], a[40:43], v[180:183], v[124:127]
  v_exp_f32 v238, v238
  v_mfma_f32_16x16x32_bf16 v[124:127], a[44:47], v[244:247], v[124:127]
  v_exp_f32 v239, v239
  v_cvt_pk_bf16_f32 v222, v236, v237
  v_mfma_f32_16x16x16_bf16 v[128:131], v[156:157], v[188:189], 0
  v_cvt_pk_bf16_f32 v223, v238, v239
  v_cvt_pk_bf16_f32 v139, v118, v119
  v_mul_f32 v232, 0x3ee9a3cd, v232
  v_mfma_f32_16x16x16_bf16 v[116:119], v[172:173], v[188:189], v[2:5]
  v_cvt_pk_bf16_f32 v140, v124, v125
  v_cvt_pk_bf16_f32 v141, v126, v127
  v_rcp_f32 v174, v232
  v_mfma_f32_16x16x32_bf16 v[128:131], v[152:155], v[184:187], v[128:131]
  v_mul_f32 v228, v228, v174
  v_mul_f32 v229, v229, v174
  v_mfma_f32_16x16x32_bf16 v[116:119], v[168:171], v[184:187], v[116:119]
  v_mul_f32 v230, v230, v174
  v_mul_f32 v231, v231, v174
  v_mfma_f32_16x16x32_bf16 v[184:187], a[246:249], v[240:243], 0
  v_exp_f32 v128, v128
  v_mfma_f32_16x16x32_bf16 v[184:187], a[246:249], v[110:113], v[184:187]
  v_exp_f32 v129, v129
  v_mfma_f32_16x16x32_bf16 v[236:239], v[200:203], v[240:243], 0
  v_exp_f32 v130, v130
  v_mfma_f32_16x16x32_bf16 v[236:239], v[94:97], v[110:113], v[236:239]
  v_exp_f32 v131, v131
  v_mfma_f32_16x16x32_bf16 v[212:215], v[216:219], v[240:243], 0
  v_exp_f32 v116, v116
  v_mfma_f32_16x16x32_bf16 v[212:215], v[98:101], v[110:113], v[212:215]
  v_cvt_pk_bf16_f32 v106, v128, v129
  v_cvt_pk_bf16_f32 v107, v130, v131
  v_mfma_f32_16x16x32_bf16 v[188:191], v[204:207], v[240:243], 0
  v_cvt_pk_bf16_f32 v108, v116, 0
  v_mul_f32 v184, 0x3ee9a3cd, v184
  v_mfma_f32_16x16x32_bf16 v[188:191], v[102:105], v[110:113], v[188:191]
  v_rcp_f32 v175, v184
  v_mfma_f32_16x16x32_bf16 v[240:243], a[48:51], v[132:135], 0
  v_mul_f32 v224, v224, v174
  v_mul_f32 v225, v225, v174
  v_mfma_f32_16x16x32_bf16 v[240:243], a[52:55], v[160:163], v[240:243]
  v_mul_f32 v226, v226, v174
  v_mul_f32 v227, v227, v174
  v_mfma_f32_16x16x32_bf16 v[240:243], a[56:59], v[164:167], v[240:243]
  v_mul_f32 v236, v236, v175
  v_mul_f32 v237, v237, v175
  v_mfma_f32_16x16x32_bf16 v[240:243], a[60:63], v[176:179], v[240:243]
  v_mul_f32 v238, v238, v175
  v_mul_f32 v239, v239, v175
  v_mfma_f32_16x16x32_bf16 v[240:243], a[64:67], v[180:183], v[240:243]
  v_mul_f32 v212, v212, v175
  v_mul_f32 v213, v213, v175
  v_mfma_f32_16x16x32_bf16 v[240:243], a[68:71], v[244:247], v[240:243]
  s_waitcnt lgkmcnt(0)
  s_barrier
  v_mfma_f32_16x16x32_bf16 v[244:247], v[220:223], a[246:249], 0
  ds_read_b128 v[114:117], v15 offset:2048
  ds_read_b128 v[118:121], v15 offset:3072
  v_mfma_f32_16x16x32_bf16 v[244:247], v[106:109], a[246:249], v[244:247]
  ds_read_b128 v[122:125], v15 offset:4096
  v_cvt_pk_bf16_f32 v142, v240, v241
  v_mfma_f32_16x16x32_bf16 v[180:183], v[220:223], v[200:203], 0
  ds_read_b128 v[126:129], v15 offset:5120
  v_cvt_pk_bf16_f32 v143, v242, v243
  v_mfma_f32_16x16x32_bf16 v[180:183], v[106:109], v[94:97], v[180:183]
  ds_read_b128 v[130:133], v15 offset:6144
  v_mul_f32 v214, v214, v175
  v_mfma_f32_16x16x32_bf16 v[240:243], v[220:223], v[216:219], 0
  ds_read_b128 v[134:137], v15 offset:7168
  v_mul_f32 v215, v215, v175
  v_mfma_f32_16x16x32_bf16 v[240:243], v[106:109], v[98:101], v[240:243]
  v_cvt_pk_bf16_f32 v176, v228, v229
  v_cvt_pk_bf16_f32 v177, v230, v231
  v_mfma_f32_16x16x32_bf16 v[228:231], v[220:223], v[204:207], 0
  v_cvt_pk_bf16_f32 v178, v224, v225
  v_cvt_pk_bf16_f32 v179, v226, v227
  v_mfma_f32_16x16x32_bf16 v[228:231], v[106:109], v[102:105], v[228:231]
  ds_write_b128 v16, v[176:179] offset:20480
  v_mfma_f32_16x16x16_bf16 v[176:179], v[148:149], v[142:143], 0
  v_cvt_pk_bf16_f32 v224, v236, v237
  v_cvt_pk_bf16_f32 v225, v238, v239
  v_cvt_pk_bf16_f32 v226, v212, v213
  v_mfma_f32_16x16x16_bf16 v[236:239], v[196:197], v[142:143], 0
  v_mul_f32 v244, 0x3ee9a3cd, v244
  v_cvt_pk_bf16_f32 v227, v214, v215
  v_cndmask_b32 v212, v240, v180, s[54:55]
  v_mfma_f32_16x16x16_bf16 v[180:183], v[156:157], v[142:143], 0
  v_rcp_f32 v213, v244
  v_mul_f32 v208, v208, v174
  v_mfma_f32_16x16x16_bf16 v[240:243], v[172:173], v[142:143], v[2:5]
  v_mul_f32 v209, v209, v174
  v_mul_f32 v210, v210, v174
  v_mul_f32 v211, v211, v174
  v_mul_f32 v188, v188, v175
  v_mfma_f32_16x16x32_bf16 v[176:179], v[144:147], v[138:141], v[176:179]
  ds_write_b128 v16, v[224:227] offset:26624
  v_mfma_f32_16x16x32_bf16 v[236:239], v[192:195], v[138:141], v[236:239]
  s_nop 3
  v_exp_f32 v176, v176
  v_mfma_f32_16x16x32_bf16 v[180:183], v[152:155], v[138:141], v[180:183]
  v_exp_f32 v177, v177
  v_mfma_f32_16x16x32_bf16 v[240:243], v[168:171], v[138:141], v[240:243]
  s_waitcnt lgkmcnt(7)
  v_exp_f32 v178, v178
  v_mfma_f32_16x16x32_bf16 v[144:147], a[0:3], v[114:117], 0
  s_waitcnt lgkmcnt(6)
  v_exp_f32 v179, v179
  v_mfma_f32_16x16x32_bf16 v[144:147], a[4:7], v[118:121], v[144:147]
  s_waitcnt lgkmcnt(5)
  v_exp_f32 v236, v236
  v_mfma_f32_16x16x32_bf16 v[144:147], a[8:11], v[122:125], v[144:147]
  s_waitcnt lgkmcnt(4)
  v_exp_f32 v237, v237
  v_mfma_f32_16x16x32_bf16 v[144:147], a[12:15], v[126:129], v[144:147]
  s_waitcnt lgkmcnt(3)
  v_exp_f32 v238, v238
  v_mfma_f32_16x16x32_bf16 v[144:147], a[16:19], v[130:133], v[144:147]
  s_waitcnt lgkmcnt(2)
  v_exp_f32 v239, v239
  v_mfma_f32_16x16x32_bf16 v[144:147], a[20:23], v[134:137], v[144:147]
  v_exp_f32 v180, v180
  v_mfma_f32_16x16x32_bf16 v[152:155], a[24:27], v[114:117], 0
  v_exp_f32 v181, v181
  v_mfma_f32_16x16x32_bf16 v[152:155], a[28:31], v[118:121], v[152:155]
  v_exp_f32 v182, v182
  v_mfma_f32_16x16x32_bf16 v[152:155], a[32:35], v[122:125], v[152:155]
  v_exp_f32 v183, v183
  v_mfma_f32_16x16x32_bf16 v[152:155], a[36:39], v[126:129], v[152:155]
  v_exp_f32 v240, v240
  v_mfma_f32_16x16x32_bf16 v[152:155], a[40:43], v[130:133], v[152:155]
  v_cvt_pk_bf16_f32 v140, v176, v177
  v_cvt_pk_bf16_f32 v141, v178, v179
  v_mfma_f32_16x16x32_bf16 v[152:155], a[44:47], v[134:137], v[152:155]
  v_cvt_pk_bf16_f32 v142, v236, v237
  v_cvt_pk_bf16_f32 v143, v238, v239
  v_mfma_f32_16x16x32_bf16 v[236:239], a[48:51], v[114:117], 0
  v_cvt_pk_bf16_f32 v110, v180, v181
  v_cvt_pk_bf16_f32 v111, v182, v183
  v_mfma_f32_16x16x32_bf16 v[236:239], a[52:55], v[118:121], v[236:239]
  v_cvt_pk_bf16_f32 v112, v240, 0
  v_mul_f32 v189, v189, v175
  v_mfma_f32_16x16x32_bf16 v[236:239], a[56:59], v[122:125], v[236:239]
  v_mul_f32 v190, v190, v175
  v_mul_f32 v191, v191, v175
  v_mfma_f32_16x16x32_bf16 v[236:239], a[60:63], v[126:129], v[236:239]
  v_cndmask_b32 v212, v228, v212, s[56:57]
  v_cvt_pk_bf16_f32 v138, v208, v209
  v_mfma_f32_16x16x32_bf16 v[236:239], a[64:67], v[130:133], v[236:239]
  v_cvt_pk_bf16_f32 v139, v210, v211
  v_cvt_pk_bf16_f32 v148, v188, v189
  v_mfma_f32_16x16x32_bf16 v[236:239], a[68:71], v[134:137], v[236:239]
  ds_write_b64 v17, v[138:139] offset:20480
  v_mfma_f32_16x16x32_bf16 v[208:211], a[246:249], v[140:143], 0
  v_cvt_pk_bf16_f32 v149, v190, v191
  v_mul_f32 v212, v212, v213
  v_mfma_f32_16x16x32_bf16 v[208:211], a[246:249], v[110:113], v[208:211]
  ds_write_b64 v17, v[148:149] offset:26624
  v_mfma_f32_16x16x32_bf16 v[188:191], v[200:203], v[140:143], 0
  v_cvt_pk_bf16_f32 v212, v212, v212
  v_max3_f32 v1, v1, v232, v174
  v_mfma_f32_16x16x32_bf16 v[188:191], v[94:97], v[110:113], v[188:191]
  ds_write_b16 v20, v212 offset:384
  v_mfma_f32_16x16x32_bf16 v[232:235], v[216:219], v[140:143], 0
  v_mul_f32 v208, 0x3ee9a3cd, v208
  v_max3_f32 v1, v1, v184, v175
  v_mfma_f32_16x16x32_bf16 v[232:235], v[98:101], v[110:113], v[232:235]
  v_rcp_f32 v98, v208
  v_mfma_f32_16x16x32_bf16 v[184:187], v[204:207], v[140:143], 0
  v_mul_f32 v188, v188, v98
  v_mul_f32 v189, v189, v98
  v_mfma_f32_16x16x32_bf16 v[184:187], v[102:105], v[110:113], v[184:187]
  v_mul_f32 v190, v190, v98
  v_mul_f32 v191, v191, v98
  v_mfma_f32_16x16x32_bf16 v[204:207], a[72:75], v[114:117], 0
  v_mul_f32 v232, v232, v98
  v_mul_f32 v233, v233, v98
  v_mfma_f32_16x16x32_bf16 v[204:207], a[76:79], v[118:121], v[204:207]
  v_mul_f32 v234, v234, v98
  v_mul_f32 v235, v235, v98
  v_mfma_f32_16x16x32_bf16 v[204:207], a[80:83], v[122:125], v[204:207]
  v_cvt_pk_bf16_f32 v140, v188, v189
  v_cvt_pk_bf16_f32 v141, v190, v191
  v_mfma_f32_16x16x32_bf16 v[204:207], a[84:87], v[126:129], v[204:207]
  v_cvt_pk_bf16_f32 v142, v232, v233
  v_cvt_pk_bf16_f32 v143, v234, v235
  v_mfma_f32_16x16x32_bf16 v[204:207], a[88:91], v[130:133], v[204:207]
  ds_write_b128 v16, v[140:143] offset:32768
  v_mfma_f32_16x16x32_bf16 v[204:207], a[92:95], v[134:137], v[204:207]
  v_mul_f32 v184, v184, v98
  v_mul_f32 v185, v185, v98
  v_mfma_f32_16x16x32_bf16 v[232:235], a[96:99], v[114:117], 0
  v_mul_f32 v186, v186, v98
  v_mul_f32 v187, v187, v98
  v_mfma_f32_16x16x32_bf16 v[232:235], a[100:103], v[118:121], v[232:235]
  v_cvt_pk_bf16_f32 v140, v184, v185
  v_cvt_pk_bf16_f32 v141, v186, v187
  v_mfma_f32_16x16x32_bf16 v[232:235], a[104:107], v[122:125], v[232:235]
  ds_write_b64 v17, v[140:141] offset:32768
  v_mfma_f32_16x16x32_bf16 v[232:235], a[108:111], v[126:129], v[232:235]
  v_max3_f32 v1, v1, v244, v213
  v_cvt_pk_bf16_f32 v138, v144, v145
  v_mfma_f32_16x16x32_bf16 v[232:235], a[112:115], v[130:133], v[232:235]
  v_cvt_pk_bf16_f32 v139, v146, v147
  v_cvt_pk_bf16_f32 v140, v152, v153
  v_mfma_f32_16x16x32_bf16 v[232:235], a[116:119], v[134:137], v[232:235]
  v_cvt_pk_bf16_f32 v141, v154, v155
  v_cvt_pk_bf16_f32 v142, v236, v237
  v_mfma_f32_16x16x32_bf16 v[150:153], a[120:123], v[114:117], 0
  v_cvt_pk_bf16_f32 v143, v238, v239
  v_add_u32 v20, 1152, v20
  v_mfma_f32_16x16x32_bf16 v[150:153], a[124:127], v[118:121], v[150:153]
  v_cvt_pk_bf16_f32 v144, v204, v205
  v_cvt_pk_bf16_f32 v145, v206, v207
  v_mfma_f32_16x16x32_bf16 v[150:153], a[128:131], v[122:125], v[150:153]
  v_max3_f32 v1, v1, v208, v98
  v_cvt_pk_bf16_f32 v146, v232, v233
  v_mfma_f32_16x16x32_bf16 v[150:153], a[132:135], v[126:129], v[150:153]
  v_cvt_pk_bf16_f32 v147, v234, v235
  v_mfma_f32_16x16x32_bf16 v[150:153], a[136:139], v[130:133], v[150:153]
  v_mfma_f32_16x16x32_bf16 v[150:153], a[140:143], v[134:137], v[150:153]
  s_waitcnt lgkmcnt(0)
  s_barrier
  s_branch L_loop
L_last:
  v_mfma_f32_16x16x32_bf16 v[156:159], v[114:117], a[144:147], 0
  ds_read_b128 v[160:163], v15 offset:20480
  ds_read_b128 v[164:167], v18
  v_mfma_f32_16x16x32_bf16 v[156:159], v[118:121], a[148:151], v[156:159]
  ds_read_b128 v[168:171], v18 offset:1024
  v_cvt_pk_bf16_f32 v148, v150, v151
  v_mfma_f32_16x16x32_bf16 v[156:159], v[122:125], a[152:155], v[156:159]
  ds_read_b128 v[172:175], v15 offset:26624
  v_cvt_pk_bf16_f32 v149, v152, v153
  v_mfma_f32_16x16x32_bf16 v[156:159], v[126:129], a[156:159], v[156:159]
  ds_read_b128 v[150:153], v15 offset:32768
  v_mfma_f32_16x16x32_bf16 v[156:159], v[130:133], a[160:163], v[156:159]
  ds_read_b64 v[154:155], v105 offset:896
  ds_read_b64 v[94:95], v105 offset:1792
  v_mfma_f32_16x16x32_bf16 v[156:159], v[134:137], a[164:167], v[156:159]
  s_waitcnt lgkmcnt(6)
  v_mfma_f32_16x16x32_bf16 v[58:61], a[250:253], v[160:163], v[58:61]
  ds_read_b128 v[176:179], v18 offset:2048
  ds_read_b128 v[180:183], v15 offset:21504
  s_waitcnt lgkmcnt(7)
  v_mfma_f32_16x16x32_bf16 v[62:65], v[164:167], v[160:163], v[62:65]
  ds_read_b128 v[184:187], v18 offset:3072
  s_waitcnt lgkmcnt(7)
  v_mfma_f32_16x16x32_bf16 v[66:69], v[168:171], v[160:163], v[66:69]
  ds_read_b128 v[160:163], v18 offset:4096
  s_waitcnt lgkmcnt(7)
  v_mfma_f32_16x16x32_bf16 v[70:73], a[250:253], v[172:175], v[70:73]
  ds_read_b128 v[188:191], v15 offset:27648
  v_cvt_pk_bf16_f32 v192, v156, v157
  v_mfma_f32_16x16x32_bf16 v[74:77], v[164:167], v[172:175], v[74:77]
  s_waitcnt lgkmcnt(6)
  v_fma_f32 v196, v34, v154, v155
  v_fma_f32 v200, v35, v154, v155
  v_mfma_f32_16x16x32_bf16 v[78:81], v[168:171], v[172:175], v[78:81]
  s_waitcnt lgkmcnt(5)
  v_fma_f32 v197, v36, v154, v155
  v_fma_f32 v201, v37, v154, v155
  v_mfma_f32_16x16x32_bf16 v[82:85], a[250:253], v[150:153], v[82:85]
  ds_read_b128 v[172:175], v15 offset:33792
  v_fma_f32 v198, v38, v154, v155
  v_mfma_f32_16x16x32_bf16 v[86:89], v[164:167], v[150:153], v[86:89]
  v_fma_f32 v202, v39, v154, v155
  v_fma_f32 v199, v40, v154, v155
  v_mfma_f32_16x16x32_bf16 v[90:93], v[168:171], v[150:153], v[90:93]
  v_fma_f32 v150, v41, v154, v155
  v_fma_f32 v168, v46, v94, v95
  v_mfma_f32_16x16x32_bf16 v[164:167], v[114:117], a[168:171], 0
  v_fma_f32 v151, v47, v94, v95
  v_fma_f32 v169, v48, v94, v95
  v_mfma_f32_16x16x32_bf16 v[164:167], v[118:121], a[172:175], v[164:167]
  v_fma_f32 v152, v49, v94, v95
  v_fma_f32 v170, v50, v94, v95
  v_mfma_f32_16x16x32_bf16 v[164:167], v[122:125], a[176:179], v[164:167]
  v_fma_f32 v153, v51, v94, v95
  v_fma_f32 v171, v52, v94, v95
  v_mfma_f32_16x16x32_bf16 v[164:167], v[126:129], a[180:183], v[164:167]
  v_fma_f32 v96, v53, v94, v95
  v_cvt_pk_bf16_f32 v196, v196, v200
  v_mfma_f32_16x16x32_bf16 v[164:167], v[130:133], a[184:187], v[164:167]
  v_cvt_pk_bf16_f32 v197, v197, v201
  v_cvt_pk_bf16_f32 v198, v198, v202
  v_mfma_f32_16x16x32_bf16 v[164:167], v[134:137], a[188:191], v[164:167]
  s_waitcnt lgkmcnt(4)
  v_cvt_pk_bf16_f32 v199, v199, v150
  v_cvt_pk_bf16_f32 v168, v168, v151
  v_mfma_f32_16x16x32_bf16 v[58:61], v[176:179], v[180:183], v[58:61]
  s_waitcnt lgkmcnt(3)
  ds_read_b128 v[200:203], v18 offset:5120
  ds_read_b128 v[204:207], v15 offset:22528
  v_mfma_f32_16x16x32_bf16 v[62:65], v[184:187], v[180:183], v[62:65]
  s_waitcnt lgkmcnt(4)
  ds_read_b128 v[208:211], v18 offset:6144
  v_cvt_pk_bf16_f32 v169, v169, v152
  v_mfma_f32_16x16x32_bf16 v[66:69], v[160:163], v[180:183], v[66:69]
  s_waitcnt lgkmcnt(4)
  ds_read_b128 v[180:183], v18 offset:7168
  v_cvt_pk_bf16_f32 v170, v170, v153
  v_mfma_f32_16x16x32_bf16 v[70:73], v[176:179], v[188:191], v[70:73]
  ds_read_b128 v[212:215], v15 offset:28672
  v_cvt_pk_bf16_f32 v171, v171, v96
  v_mfma_f32_16x16x32_bf16 v[74:77], v[184:187], v[188:191], v[74:77]
  ds_write_b128 v16, v[196:199] offset:8192
  v_mfma_f32_16x16x32_bf16 v[78:81], v[160:163], v[188:191], v[78:81]
  s_waitcnt lgkmcnt(6)
  v_fma_f32 v188, v42, v154, v155
  v_fma_f32 v190, v43, v154, v155
  v_mfma_f32_16x16x32_bf16 v[82:85], v[176:179], v[172:175], v[82:85]
  v_fma_f32 v189, v44, v154, v155
  v_fma_f32 v178, v45, v154, v155
  v_mfma_f32_16x16x32_bf16 v[86:89], v[184:187], v[172:175], v[86:89]
  ds_read_b128 v[184:187], v15 offset:34816
  v_fma_f32 v176, v54, v94, v95
  v_mfma_f32_16x16x32_bf16 v[90:93], v[160:163], v[172:175], v[90:93]
  ds_read_b64 v[154:155], v19 offset:784
  v_fma_f32 v172, v55, v94, v95
  v_mfma_f32_16x16x32_bf16 v[160:163], v[114:117], a[192:195], 0
  ds_read2_b64 v[150:153], v19 offset0:96 offset1:97
  v_fma_f32 v177, v56, v94, v95
  v_mfma_f32_16x16x32_bf16 v[160:163], v[118:121], a[196:199], v[160:163]
  ds_write_b128 v16, v[168:171] offset:14336
  v_mfma_f32_16x16x32_bf16 v[160:163], v[122:125], a[200:203], v[160:163]
  v_fma_f32 v168, v57, v94, v95
  v_cvt_pk_bf16_f32 v188, v188, v190
  v_mfma_f32_16x16x32_bf16 v[160:163], v[126:129], a[204:207], v[160:163]
  v_cvt_pk_bf16_f32 v189, v189, v178
  v_cvt_pk_bf16_f32 v176, v176, v172
  v_mfma_f32_16x16x32_bf16 v[160:163], v[130:133], a[208:211], v[160:163]
  ds_read_b128 v[124:127], v18 offset:8192
  ds_read_b128 v[130:133], v15 offset:23552
  v_mfma_f32_16x16x32_bf16 v[160:163], v[134:137], a[212:215], v[160:163]
  s_waitcnt lgkmcnt(10)
  v_cvt_pk_bf16_f32 v177, v177, v168
  v_cvt_pk_bf16_f32 v193, v158, v159
  v_mfma_f32_16x16x32_bf16 v[58:61], v[200:203], v[204:207], v[58:61]
  s_waitcnt lgkmcnt(9)
  ds_read_b128 v[134:137], v18 offset:9216
  ds_read_b128 v[156:159], v18 offset:10240
  v_mfma_f32_16x16x32_bf16 v[62:65], v[208:211], v[204:207], v[62:65]
  s_waitcnt lgkmcnt(10)
  v_cvt_pk_bf16_f32 v168, v164, v165
  v_cvt_pk_bf16_f32 v169, v166, v167
  v_mfma_f32_16x16x32_bf16 v[66:69], v[180:183], v[204:207], v[66:69]
  s_waitcnt lgkmcnt(9)
  ds_read_b128 v[204:207], v15 offset:29696
  v_cvt_pk_bf16_f32 v164, v160, v161
  v_mfma_f32_16x16x32_bf16 v[70:73], v[200:203], v[212:215], v[70:73]
  ds_write_b64 v17, v[188:189] offset:8192
  v_mfma_f32_16x16x32_bf16 v[74:77], v[208:211], v[212:215], v[74:77]
  ds_read_b128 v[116:119], v15 offset:35840
  v_cvt_pk_bf16_f32 v165, v162, v163
  v_mfma_f32_16x16x32_bf16 v[78:81], v[180:183], v[212:215], v[78:81]
  s_waitcnt lgkmcnt(10)
  ds_write_b64 v17, v[176:177] offset:14336
  v_mfma_f32_16x16x32_bf16 v[82:85], v[200:203], v[184:187], v[82:85]
  v_mfma_f32_16x16x32_bf16 v[86:89], v[208:211], v[184:187], v[86:89]
  ds_read_b128 v[160:163], v18 offset:11264
  ds_read_b128 v[208:211], v15 offset:24576
  v_mfma_f32_16x16x32_bf16 v[90:93], v[180:183], v[184:187], v[90:93]
  s_waitcnt lgkmcnt(12)
  ds_read_b128 v[180:183], v18 offset:12288
  v_mfma_f32_16x16x16_bf16 v[184:187], v[148:149], v[142:143], 0
  ds_read_b128 v[200:203], v18 offset:13312
  v_mfma_f32_16x16x16_bf16 v[212:215], v[148:149], v[154:155], 0
  ds_read_b128 v[120:123], v15 offset:30720
  v_mfma_f32_16x16x32_bf16 v[184:187], v[144:147], v[138:141], v[184:187]
  s_waitcnt lgkmcnt(14)
  v_mfma_f32_16x16x32_bf16 v[212:215], v[144:147], v[150:153], v[212:215]
  s_waitcnt lgkmcnt(11)
  v_mfma_f32_16x16x32_bf16 v[58:61], v[124:127], v[130:133], v[58:61]
  s_waitcnt lgkmcnt(10)
  ds_read_b128 v[172:175], v15 offset:36864
  v_mfma_f32_16x16x32_bf16 v[62:65], v[134:137], v[130:133], v[62:65]
  s_waitcnt lgkmcnt(10)
  v_exp_f32 v184, v184
  v_mfma_f32_16x16x32_bf16 v[66:69], v[156:159], v[130:133], v[66:69]
  s_waitcnt lgkmcnt(9)
  v_exp_f32 v185, v185
  v_mfma_f32_16x16x32_bf16 v[70:73], v[124:127], v[204:207], v[70:73]
  ds_read_b128 v[130:133], v18 offset:14336
  ds_read_b128 v[176:179], v15 offset:25600
  v_mfma_f32_16x16x32_bf16 v[74:77], v[134:137], v[204:207], v[74:77]
  ds_read_b128 v[188:191], v18 offset:15360
  v_cvt_pk_bf16_f32 v196, v184, v185
  v_mfma_f32_16x16x32_bf16 v[78:81], v[156:159], v[204:207], v[78:81]
  s_waitcnt lgkmcnt(10)
  ds_read_b128 v[204:207], v18 offset:16384
  v_mfma_f32_16x16x32_bf16 v[82:85], v[124:127], v[116:119], v[82:85]
  ds_read_b128 v[124:127], v15 offset:31744
  v_mfma_f32_16x16x32_bf16 v[86:89], v[134:137], v[116:119], v[86:89]
  v_exp_f32 v186, v186
  v_mfma_f32_16x16x32_bf16 v[90:93], v[156:159], v[116:119], v[90:93]
  s_waitcnt lgkmcnt(9)
  v_exp_f32 v187, v187
  v_mfma_f32_16x16x32_bf16 v[58:61], v[160:163], v[208:211], v[58:61]
  s_waitcnt lgkmcnt(8)
  ds_read_b128 v[134:137], v15 offset:37888
  v_cvt_pk_bf16_f32 v197, v186, v187
  v_mfma_f32_16x16x32_bf16 v[62:65], v[180:183], v[208:211], v[62:65]
  s_waitcnt lgkmcnt(8)
  v_exp_f32 v212, v212
  v_mfma_f32_16x16x32_bf16 v[66:69], v[200:203], v[208:211], v[66:69]
  s_waitcnt lgkmcnt(7)
  v_exp_f32 v213, v213
  v_mfma_f32_16x16x32_bf16 v[70:73], v[160:163], v[120:123], v[70:73]
  v_exp_f32 v214, v214
  v_mfma_f32_16x16x32_bf16 v[74:77], v[180:183], v[120:123], v[74:77]
  v_exp_f32 v215, v215
  v_mfma_f32_16x16x32_bf16 v[78:81], v[200:203], v[120:123], v[78:81]
  s_waitcnt lgkmcnt(6)
  v_cvt_pk_bf16_f32 v208, v212, v213
  v_cvt_pk_bf16_f32 v209, v214, v215
  v_mfma_f32_16x16x32_bf16 v[82:85], v[160:163], v[172:175], v[82:85]
  v_mfma_f32_16x16x32_bf16 v[86:89], v[180:183], v[172:175], v[86:89]
  v_mfma_f32_16x16x32_bf16 v[90:93], v[200:203], v[172:175], v[90:93]
  s_waitcnt lgkmcnt(4)
  s_barrier
  v_mfma_f32_16x16x32_bf16 v[58:61], v[130:133], v[176:179], v[58:61]
  s_waitcnt lgkmcnt(3)
  ds_read_b128 v[118:121], v15 offset:8192
  ds_read_b128 v[158:161], v15 offset:9216
  v_mfma_f32_16x16x32_bf16 v[62:65], v[188:191], v[176:179], v[62:65]
  s_waitcnt lgkmcnt(4)
  ds_read_b128 v[114:117], v15 offset:10240
  v_mfma_f32_16x16x32_bf16 v[66:69], v[204:207], v[176:179], v[66:69]
  s_waitcnt lgkmcnt(4)
  ds_read_b128 v[176:179], v15 offset:11264
  v_cvt_pk_bf16_f32 v180, v58, v59
  v_mfma_f32_16x16x32_bf16 v[70:73], v[130:133], v[124:127], v[70:73]
  ds_read_b128 v[172:175], v15 offset:12288
  v_cvt_pk_bf16_f32 v181, v60, v61
  v_mfma_f32_16x16x32_bf16 v[74:77], v[188:191], v[124:127], v[74:77]
  ds_read_b128 v[200:203], v15 offset:13312
  v_cvt_pk_bf16_f32 v182, v62, v63
  v_mfma_f32_16x16x32_bf16 v[78:81], v[204:207], v[124:127], v[78:81]
  s_waitcnt lgkmcnt(6)
  buffer_store_dwordx2 v[180:181], v12, s[8:11], s32 offen
  v_cvt_pk_bf16_f32 v183, v64, v65
  v_mfma_f32_16x16x32_bf16 v[82:85], v[130:133], v[134:137], v[82:85]
  buffer_store_dwordx2 v[182:183], v12, s[8:11], s32 offen offset:32
  v_cvt_pk_bf16_f32 v124, v66, v67
  v_mfma_f32_16x16x32_bf16 v[86:89], v[188:191], v[134:137], v[86:89]
  v_cvt_pk_bf16_f32 v125, v68, v69
  v_cvt_pk_bf16_f32 v130, v70, v71
  v_mfma_f32_16x16x32_bf16 v[90:93], v[204:207], v[134:137], v[90:93]
  s_waitcnt lgkmcnt(5)
  buffer_store_dwordx2 v[124:125], v12, s[8:11], s32 offen offset:64
  v_cvt_pk_bf16_f32 v131, v72, v73
  v_mfma_f32_16x16x32_bf16 v[124:127], a[72:75], v[118:121], 0
  s_waitcnt lgkmcnt(4)
  buffer_store_dwordx2 v[130:131], v13, s[8:11], s32 offen
  v_cvt_pk_bf16_f32 v130, v74, v75
  v_mfma_f32_16x16x32_bf16 v[124:127], a[76:79], v[158:161], v[124:127]
  s_waitcnt lgkmcnt(3)
  v_cvt_pk_bf16_f32 v131, v76, v77
  v_cvt_pk_bf16_f32 v134, v78, v79
  v_mfma_f32_16x16x32_bf16 v[124:127], a[80:83], v[114:117], v[124:127]
  s_waitcnt lgkmcnt(2)
  buffer_store_dwordx2 v[130:131], v13, s[8:11], s32 offen offset:32
  v_cvt_pk_bf16_f32 v135, v80, v81
  v_mfma_f32_16x16x32_bf16 v[124:127], a[84:87], v[176:179], v[124:127]
  s_waitcnt lgkmcnt(1)
  buffer_store_dwordx2 v[134:135], v13, s[8:11], s32 offen offset:64
  v_cvt_pk_bf16_f32 v134, v82, v83
  v_mfma_f32_16x16x32_bf16 v[124:127], a[88:91], v[172:175], v[124:127]
  s_waitcnt lgkmcnt(0)
  v_cvt_pk_bf16_f32 v135, v84, v85
  v_cvt_pk_bf16_f32 v136, v86, v87
  v_mfma_f32_16x16x32_bf16 v[124:127], a[92:95], v[200:203], v[124:127]
  buffer_store_dwordx2 v[134:135], v14, s[8:11], s32 offen
  v_cvt_pk_bf16_f32 v137, v88, v89
  v_mfma_f32_16x16x32_bf16 v[128:131], a[96:99], v[118:121], 0
  buffer_store_dwordx2 v[136:137], v14, s[8:11], s32 offen offset:32
  s_nop 2
  v_cvt_pk_bf16_f32 v132, v124, v125
  v_mfma_f32_16x16x32_bf16 v[128:131], a[100:103], v[158:161], v[128:131]
  v_cvt_pk_bf16_f32 v133, v126, v127
  v_cvt_pk_bf16_f32 v124, v90, v91
  v_mfma_f32_16x16x32_bf16 v[128:131], a[104:107], v[114:117], v[128:131]
  v_cvt_pk_bf16_f32 v125, v92, v93
  v_mfma_f32_16x16x32_bf16 v[128:131], a[108:111], v[176:179], v[128:131]
  buffer_store_dwordx2 v[124:125], v14, s[8:11], s32 offen offset:64
  v_mfma_f32_16x16x32_bf16 v[128:131], a[112:115], v[172:175], v[128:131]
  s_mov_b32 s32, s33
  v_mfma_f32_16x16x32_bf16 v[128:131], a[116:119], v[200:203], v[128:131]
  s_mov_b32 s33, s34
  v_mfma_f32_16x16x32_bf16 v[124:127], a[120:123], v[118:121], 0
  s_mov_b32 s34, s35
  v_mfma_f32_16x16x32_bf16 v[124:127], a[124:127], v[158:161], v[124:127]
  v_cvt_pk_bf16_f32 v134, v128, v129
  v_cvt_pk_bf16_f32 v135, v130, v131
  v_mfma_f32_16x16x32_bf16 v[124:127], a[128:131], v[114:117], v[124:127]
  v_mfma_f32_16x16x32_bf16 v[124:127], a[132:135], v[176:179], v[124:127]
  v_mfma_f32_16x16x32_bf16 v[124:127], a[136:139], v[172:175], v[124:127]
  v_mfma_f32_16x16x32_bf16 v[124:127], a[140:143], v[200:203], v[124:127]
  v_mfma_f32_16x16x32_bf16 v[204:207], a[0:3], v[118:121], 0
  v_mfma_f32_16x16x32_bf16 v[204:207], a[4:7], v[158:161], v[204:207]
  v_cvt_pk_bf16_f32 v136, v124, v125
  v_cvt_pk_bf16_f32 v137, v126, v127
  v_mfma_f32_16x16x32_bf16 v[204:207], a[8:11], v[114:117], v[204:207]
  v_mfma_f32_16x16x32_bf16 v[204:207], a[12:15], v[176:179], v[204:207]
  v_mfma_f32_16x16x32_bf16 v[204:207], a[16:19], v[172:175], v[204:207]
  v_mfma_f32_16x16x32_bf16 v[204:207], a[20:23], v[200:203], v[204:207]
  v_mfma_f32_16x16x32_bf16 v[188:191], a[24:27], v[118:121], 0
  v_mfma_f32_16x16x32_bf16 v[188:191], a[28:31], v[158:161], v[188:191]
  v_cvt_pk_bf16_f32 v124, v204, v205
  v_cvt_pk_bf16_f32 v125, v206, v207
  v_mfma_f32_16x16x32_bf16 v[188:191], a[32:35], v[114:117], v[188:191]
  v_mfma_f32_16x16x32_bf16 v[188:191], a[36:39], v[176:179], v[188:191]
  v_mfma_f32_16x16x32_bf16 v[188:191], a[40:43], v[172:175], v[188:191]
  v_mfma_f32_16x16x32_bf16 v[188:191], a[44:47], v[200:203], v[188:191]
  v_mfma_f32_16x16x32_bf16 v[204:207], a[48:51], v[118:121], 0
  v_mfma_f32_16x16x32_bf16 v[204:207], a[52:55], v[158:161], v[204:207]
  v_cvt_pk_bf16_f32 v126, v188, v189
  v_cvt_pk_bf16_f32 v127, v190, v191
  v_mfma_f32_16x16x32_bf16 v[204:207], a[56:59], v[114:117], v[204:207]
  v_mfma_f32_16x16x32_bf16 v[204:207], a[60:63], v[176:179], v[204:207]
  v_mfma_f32_16x16x32_bf16 v[204:207], a[64:67], v[172:175], v[204:207]
  v_mfma_f32_16x16x32_bf16 v[204:207], a[68:71], v[200:203], v[204:207]
  v_mfma_f32_16x16x32_bf16 v[188:191], v[118:121], a[144:147], 0
  v_mfma_f32_16x16x32_bf16 v[188:191], v[158:161], a[148:151], v[188:191]
  v_cvt_pk_bf16_f32 v128, v204, v205
  v_cvt_pk_bf16_f32 v129, v206, v207
  v_mfma_f32_16x16x32_bf16 v[188:191], v[114:117], a[152:155], v[188:191]
  v_mfma_f32_16x16x32_bf16 v[188:191], v[176:179], a[156:159], v[188:191]
  v_mfma_f32_16x16x32_bf16 v[188:191], v[172:175], a[160:163], v[188:191]
  v_mfma_f32_16x16x32_bf16 v[188:191], v[200:203], a[164:167], v[188:191]
  ds_read_b128 v[204:207], v15 offset:14336
  v_mfma_f32_16x16x32_bf16 v[180:183], v[118:121], a[168:171], 0
  ds_read_b128 v[212:215], v15 offset:15360
  v_mfma_f32_16x16x32_bf16 v[180:183], v[158:161], a[172:175], v[180:183]
  ds_read_b128 v[184:187], v15 offset:16384
  v_cvt_pk_bf16_f32 v194, v188, v189
  v_mfma_f32_16x16x32_bf16 v[180:183], v[114:117], a[176:179], v[180:183]
  ds_read_b128 v[216:219], v15 offset:17408
  v_cvt_pk_bf16_f32 v195, v190, v191
  v_mfma_f32_16x16x32_bf16 v[180:183], v[176:179], a[180:183], v[180:183]
  ds_read_b128 v[188:191], v15 offset:18432
  v_mfma_f32_16x16x32_bf16 v[180:183], v[172:175], a[184:187], v[180:183]
  ds_read_b128 v[220:223], v15 offset:19456
  v_mfma_f32_16x16x32_bf16 v[180:183], v[200:203], a[188:191], v[180:183]
  v_mfma_f32_16x16x32_bf16 v[224:227], v[118:121], a[192:195], 0
  v_mfma_f32_16x16x32_bf16 v[224:227], v[158:161], a[196:199], v[224:227]
  v_cvt_pk_bf16_f32 v170, v180, v181
  v_cvt_pk_bf16_f32 v171, v182, v183
  v_mfma_f32_16x16x32_bf16 v[224:227], v[114:117], a[200:203], v[224:227]
  v_mfma_f32_16x16x32_bf16 v[224:227], v[176:179], a[204:207], v[224:227]
  v_mfma_f32_16x16x32_bf16 v[224:227], v[172:175], a[208:211], v[224:227]
  v_mfma_f32_16x16x32_bf16 v[224:227], v[200:203], a[212:215], v[224:227]
  v_mfma_f32_16x16x16_bf16 v[116:119], v[136:137], v[142:143], 0
  v_mfma_f32_16x16x16_bf16 v[158:161], v[148:149], v[128:129], 0
  v_cvt_pk_bf16_f32 v166, v224, v225
  v_cvt_pk_bf16_f32 v167, v226, v227
  v_mfma_f32_16x16x32_bf16 v[116:119], v[132:135], v[138:141], v[116:119]
  v_mfma_f32_16x16x32_bf16 v[158:161], v[144:147], v[124:127], v[158:161]
  s_waitcnt lgkmcnt(5)
  v_mfma_f32_16x16x32_bf16 v[224:227], a[72:75], v[204:207], 0
  s_waitcnt lgkmcnt(4)
  v_exp_f32 v116, v116
  v_mfma_f32_16x16x32_bf16 v[224:227], a[76:79], v[212:215], v[224:227]
  s_waitcnt lgkmcnt(3)
  v_exp_f32 v117, v117
  v_mfma_f32_16x16x32_bf16 v[224:227], a[80:83], v[184:187], v[224:227]
  s_waitcnt lgkmcnt(2)
  v_exp_f32 v118, v118
  v_mfma_f32_16x16x32_bf16 v[224:227], a[84:87], v[216:219], v[224:227]
  s_waitcnt lgkmcnt(1)
  v_exp_f32 v119, v119
  v_mfma_f32_16x16x32_bf16 v[224:227], a[88:91], v[188:191], v[224:227]
  s_waitcnt lgkmcnt(0)
  v_cvt_pk_bf16_f32 v198, v116, v117
  v_cvt_pk_bf16_f32 v199, v118, v119
  v_mfma_f32_16x16x32_bf16 v[224:227], a[92:95], v[220:223], v[224:227]
  v_exp_f32 v158, v158
  v_mfma_f32_16x16x32_bf16 v[200:203], a[96:99], v[204:207], 0
  v_exp_f32 v159, v159
  v_mfma_f32_16x16x32_bf16 v[200:203], a[100:103], v[212:215], v[200:203]
  v_cvt_pk_bf16_f32 v116, v224, v225
  v_cvt_pk_bf16_f32 v117, v226, v227
  v_mfma_f32_16x16x32_bf16 v[200:203], a[104:107], v[184:187], v[200:203]
  v_exp_f32 v160, v160
  v_mfma_f32_16x16x32_bf16 v[200:203], a[108:111], v[216:219], v[200:203]
  v_exp_f32 v161, v161
  v_mfma_f32_16x16x32_bf16 v[200:203], a[112:115], v[188:191], v[200:203]
  v_cvt_pk_bf16_f32 v224, v158, v159
  v_cvt_pk_bf16_f32 v225, v160, v161
  v_mfma_f32_16x16x32_bf16 v[200:203], a[116:119], v[220:223], v[200:203]
  s_barrier
  v_mfma_f32_16x16x32_bf16 v[172:175], a[120:123], v[204:207], 0
  v_mfma_f32_16x16x32_bf16 v[172:175], a[124:127], v[212:215], v[172:175]
  v_cvt_pk_bf16_f32 v118, v200, v201
  v_cvt_pk_bf16_f32 v119, v202, v203
  v_mfma_f32_16x16x32_bf16 v[172:175], a[128:131], v[184:187], v[172:175]
  v_mfma_f32_16x16x32_bf16 v[172:175], a[132:135], v[216:219], v[172:175]
  v_mfma_f32_16x16x32_bf16 v[172:175], a[136:139], v[188:191], v[172:175]
  v_mfma_f32_16x16x32_bf16 v[172:175], a[140:143], v[220:223], v[172:175]
  v_mfma_f32_16x16x16_bf16 v[200:203], v[136:137], v[128:129], 0
  ds_read_b64 v[160:161], v19 offset:16
  v_mfma_f32_16x16x16_bf16 v[176:179], v[136:137], v[154:155], 0
  ds_read2_b64 v[156:159], v19 offset0:0 offset1:1
  v_cvt_pk_bf16_f32 v120, v172, v173
  v_cvt_pk_bf16_f32 v121, v174, v175
  v_add_u32 v19, 1152, v19
  v_mfma_f32_16x16x32_bf16 v[200:203], v[132:135], v[124:127], v[200:203]
  v_mfma_f32_16x16x32_bf16 v[176:179], v[132:135], v[150:153], v[176:179]
  v_mfma_f32_16x16x32_bf16 v[172:175], v[204:207], a[144:147], 0
  v_exp_f32 v200, v200
  v_mfma_f32_16x16x32_bf16 v[172:175], v[212:215], a[148:151], v[172:175]
  v_exp_f32 v201, v201
  v_mfma_f32_16x16x32_bf16 v[172:175], v[184:187], a[152:155], v[172:175]
  v_exp_f32 v202, v202
  v_mfma_f32_16x16x32_bf16 v[172:175], v[216:219], a[156:159], v[172:175]
  v_exp_f32 v203, v203
  v_mfma_f32_16x16x32_bf16 v[172:175], v[188:191], a[160:163], v[172:175]
  v_cvt_pk_bf16_f32 v226, v200, v201
  v_cvt_pk_bf16_f32 v227, v202, v203
  v_mfma_f32_16x16x32_bf16 v[172:175], v[220:223], a[164:167], v[172:175]
  v_exp_f32 v176, v176
  v_mfma_f32_16x16x32_bf16 v[200:203], v[204:207], a[168:171], 0
  v_exp_f32 v177, v177
  v_mfma_f32_16x16x32_bf16 v[200:203], v[212:215], a[172:175], v[200:203]
  v_cvt_pk_bf16_f32 v94, v172, v173
  v_cvt_pk_bf16_f32 v95, v174, v175
  v_mfma_f32_16x16x32_bf16 v[200:203], v[184:187], a[176:179], v[200:203]
  v_exp_f32 v178, v178
  v_mfma_f32_16x16x32_bf16 v[200:203], v[216:219], a[180:183], v[200:203]
  v_exp_f32 v179, v179
  v_mfma_f32_16x16x32_bf16 v[200:203], v[188:191], a[184:187], v[200:203]
  v_cvt_pk_bf16_f32 v210, v176, v177
  v_cvt_pk_bf16_f32 v211, v178, v179
  v_mfma_f32_16x16x32_bf16 v[200:203], v[220:223], a[188:191], v[200:203]
  s_waitcnt lgkmcnt(1)
  v_mfma_f32_16x16x16_bf16 v[176:179], v[120:121], v[142:143], 0
  v_mfma_f32_16x16x16_bf16 v[172:175], v[160:161], v[142:143], v[2:5]
  v_cvt_pk_bf16_f32 v98, v200, v201
  v_cvt_pk_bf16_f32 v99, v202, v203
  v_mfma_f32_16x16x32_bf16 v[176:179], v[116:119], v[138:141], v[176:179]
  s_waitcnt lgkmcnt(0)
  v_mfma_f32_16x16x32_bf16 v[172:175], v[156:159], v[138:141], v[172:175]
  v_mfma_f32_16x16x32_bf16 v[140:143], v[204:207], a[192:195], 0
  v_exp_f32 v176, v176
  v_mfma_f32_16x16x32_bf16 v[140:143], v[212:215], a[196:199], v[140:143]
  v_exp_f32 v177, v177
  v_mfma_f32_16x16x32_bf16 v[140:143], v[184:187], a[200:203], v[140:143]
  ds_read_u16 v96, v20
  v_cvt_pk_bf16_f32 v106, v176, v177
  v_mfma_f32_16x16x32_bf16 v[140:143], v[216:219], a[204:207], v[140:143]
  v_exp_f32 v178, v178
  v_mfma_f32_16x16x32_bf16 v[140:143], v[188:191], a[208:211], v[140:143]
  ds_read_u16 v100, v20 offset:32
  v_mfma_f32_16x16x32_bf16 v[140:143], v[220:223], a[212:215], v[140:143]
  v_exp_f32 v179, v179
  v_mfma_f32_16x16x16_bf16 v[200:203], v[120:121], v[128:129], 0
  ds_read_u16 v104, v20 offset:64
  v_exp_f32 v172, v172
  v_mfma_f32_16x16x16_bf16 v[180:183], v[160:161], v[128:129], v[2:5]
  v_cvt_pk_bf16_f32 v107, v178, v179
  v_cvt_pk_bf16_f32 v108, v172, 0
  v_cvt_pk_bf16_f32 v102, v140, v141
  v_cvt_pk_bf16_f32 v103, v142, v143
  v_mfma_f32_16x16x32_bf16 v[200:203], v[116:119], v[124:127], v[200:203]
  v_mfma_f32_16x16x32_bf16 v[180:183], v[156:159], v[124:127], v[180:183]
  v_mfma_f32_16x16x32_bf16 v[140:143], a[0:3], v[204:207], 0
  v_exp_f32 v200, v200
  v_mfma_f32_16x16x32_bf16 v[140:143], a[4:7], v[212:215], v[140:143]
  v_exp_f32 v201, v201
  v_mfma_f32_16x16x32_bf16 v[140:143], a[8:11], v[184:187], v[140:143]
  v_exp_f32 v202, v202
  v_mfma_f32_16x16x32_bf16 v[140:143], a[12:15], v[216:219], v[140:143]
  v_exp_f32 v203, v203
  v_mfma_f32_16x16x32_bf16 v[140:143], a[16:19], v[188:191], v[140:143]
  v_exp_f32 v180, v180
  v_mfma_f32_16x16x32_bf16 v[140:143], a[20:23], v[220:223], v[140:143]
  v_cvt_pk_bf16_f32 v110, v200, v201
  v_cvt_pk_bf16_f32 v111, v202, v203
  v_mfma_f32_16x16x32_bf16 v[200:203], a[246:249], v[196:199], 0
  v_cvt_pk_bf16_f32 v112, v180, 0
  v_mfma_f32_16x16x32_bf16 v[200:203], a[246:249], v[106:109], v[200:203]
  v_cvt_pk_bf16_f32 v124, v140, v141
  v_cvt_pk_bf16_f32 v125, v142, v143
  v_mfma_f32_16x16x32_bf16 v[140:143], v[192:195], v[196:199], 0
  s_waitcnt lgkmcnt(2)
  v_mfma_f32_16x16x32_bf16 v[140:143], v[94:97], v[106:109], v[140:143]
  v_mul_f32 v200, 0x3ee9a3cd, v200
  v_mfma_f32_16x16x32_bf16 v[180:183], v[168:171], v[196:199], 0
  s_waitcnt lgkmcnt(1)
  v_rcp_f32 v138, v200
  v_mfma_f32_16x16x32_bf16 v[180:183], v[98:101], v[106:109], v[180:183]
  v_mul_f32 v140, v140, v138
  v_mul_f32 v141, v141, v138
  v_mfma_f32_16x16x32_bf16 v[172:175], v[164:167], v[196:199], 0
  s_waitcnt lgkmcnt(0)
  v_mul_f32 v142, v142, v138
  v_mul_f32 v143, v143, v138
  v_mfma_f32_16x16x32_bf16 v[172:175], v[102:105], v[106:109], v[172:175]
  v_mul_f32 v180, v180, v138
  v_mul_f32 v181, v181, v138
  v_mfma_f32_16x16x32_bf16 v[196:199], a[24:27], v[204:207], 0
  v_mul_f32 v182, v182, v138
  v_mul_f32 v183, v183, v138
  v_mfma_f32_16x16x32_bf16 v[196:199], a[28:31], v[212:215], v[196:199]
  v_cvt_pk_bf16_f32 v176, v140, v141
  v_cvt_pk_bf16_f32 v177, v142, v143
  v_mfma_f32_16x16x32_bf16 v[196:199], a[32:35], v[184:187], v[196:199]
  v_cvt_pk_bf16_f32 v178, v180, v181
  v_cvt_pk_bf16_f32 v179, v182, v183
  v_mfma_f32_16x16x32_bf16 v[196:199], a[36:39], v[216:219], v[196:199]
  ds_write_b128 v16, v[176:179] offset:20480
  v_mfma_f32_16x16x32_bf16 v[196:199], a[40:43], v[188:191], v[196:199]
  v_mul_f32 v172, v172, v138
  v_mul_f32 v173, v173, v138
  v_mfma_f32_16x16x32_bf16 v[196:199], a[44:47], v[220:223], v[196:199]
  v_mul_f32 v174, v174, v138
  v_mul_f32 v175, v175, v138
  v_cvt_pk_bf16_f32 v106, v172, v173
  v_mfma_f32_16x16x16_bf16 v[176:179], v[120:121], v[154:155], 0
  v_cvt_pk_bf16_f32 v107, v174, v175
  v_max3_f32 v1, v1, v200, v138
  v_mfma_f32_16x16x16_bf16 v[200:203], v[160:161], v[154:155], v[2:5]
  ds_write_b64 v17, v[106:107] offset:20480
  v_cvt_pk_bf16_f32 v126, v196, v197
  v_mfma_f32_16x16x32_bf16 v[176:179], v[116:119], v[150:153], v[176:179]
  v_cvt_pk_bf16_f32 v127, v198, v199
  v_mfma_f32_16x16x32_bf16 v[200:203], v[156:159], v[150:153], v[200:203]
  v_mfma_f32_16x16x32_bf16 v[152:155], a[246:249], v[224:227], 0
  v_exp_f32 v176, v176
  v_mfma_f32_16x16x32_bf16 v[152:155], a[246:249], v[110:113], v[152:155]
  v_exp_f32 v177, v177
  v_mfma_f32_16x16x32_bf16 v[196:199], v[192:195], v[224:227], 0
  v_exp_f32 v178, v178
  v_mfma_f32_16x16x32_bf16 v[196:199], v[94:97], v[110:113], v[196:199]
  v_exp_f32 v179, v179
  v_mfma_f32_16x16x32_bf16 v[172:175], v[168:171], v[224:227], 0
  v_exp_f32 v200, v200
  v_mfma_f32_16x16x32_bf16 v[172:175], v[98:101], v[110:113], v[172:175]
  v_cvt_pk_bf16_f32 v106, v176, v177
  v_cvt_pk_bf16_f32 v107, v178, v179
  v_mfma_f32_16x16x32_bf16 v[176:179], v[164:167], v[224:227], 0
  v_cvt_pk_bf16_f32 v108, v200, 0
  v_mul_f32 v152, 0x3ee9a3cd, v152
  v_mfma_f32_16x16x32_bf16 v[176:179], v[102:105], v[110:113], v[176:179]
  v_rcp_f32 v112, v152
  v_mfma_f32_16x16x32_bf16 v[200:203], a[48:51], v[204:207], 0
  v_mul_f32 v196, v196, v112
  v_mul_f32 v197, v197, v112
  v_mfma_f32_16x16x32_bf16 v[200:203], a[52:55], v[212:215], v[200:203]
  v_mul_f32 v198, v198, v112
  v_mul_f32 v199, v199, v112
  v_mfma_f32_16x16x32_bf16 v[200:203], a[56:59], v[184:187], v[200:203]
  v_mul_f32 v172, v172, v112
  v_mul_f32 v173, v173, v112
  v_mfma_f32_16x16x32_bf16 v[200:203], a[60:63], v[216:219], v[200:203]
  v_mul_f32 v174, v174, v112
  v_mul_f32 v175, v175, v112
  v_mfma_f32_16x16x32_bf16 v[200:203], a[64:67], v[188:191], v[200:203]
  v_cvt_pk_bf16_f32 v188, v196, v197
  v_cvt_pk_bf16_f32 v189, v198, v199
  v_mfma_f32_16x16x32_bf16 v[200:203], a[68:71], v[220:223], v[200:203]
  s_barrier
  v_cvt_pk_bf16_f32 v190, v172, v173
  v_cvt_pk_bf16_f32 v191, v174, v175
  v_mul_f32 v176, v176, v112
  v_mul_f32 v177, v177, v112
  v_mul_f32 v178, v178, v112
  s_nop 1
  v_cvt_pk_bf16_f32 v128, v200, v201
  v_cvt_pk_bf16_f32 v129, v202, v203
  v_mul_f32 v179, v179, v112
  v_cvt_pk_bf16_f32 v110, v176, v177
  v_mfma_f32_16x16x16_bf16 v[200:203], v[148:149], v[128:129], 0
  v_cvt_pk_bf16_f32 v111, v178, v179
  v_max3_f32 v1, v1, v152, v112
  v_mfma_f32_16x16x16_bf16 v[152:155], v[136:137], v[128:129], 0
  ds_write_b128 v16, v[188:191] offset:26624
  v_mfma_f32_16x16x16_bf16 v[188:191], v[120:121], v[128:129], 0
  v_mfma_f32_16x16x16_bf16 v[176:179], v[160:161], v[128:129], v[2:5]
  ds_write_b64 v17, v[110:111] offset:26624
  v_mfma_f32_16x16x32_bf16 v[200:203], v[144:147], v[124:127], v[200:203]
  v_mfma_f32_16x16x32_bf16 v[152:155], v[132:135], v[124:127], v[152:155]
  v_mfma_f32_16x16x32_bf16 v[188:191], v[116:119], v[124:127], v[188:191]
  v_exp_f32 v200, v200
  v_mfma_f32_16x16x32_bf16 v[176:179], v[156:159], v[124:127], v[176:179]
  v_exp_f32 v201, v201
  v_mfma_f32_16x16x32_bf16 v[124:127], v[208:211], a[246:249], 0
  v_exp_f32 v202, v202
  v_mfma_f32_16x16x32_bf16 v[124:127], v[106:109], a[246:249], v[124:127]
  v_exp_f32 v203, v203
  v_mfma_f32_16x16x32_bf16 v[156:159], v[208:211], v[192:195], 0
  v_exp_f32 v152, v152
  v_mfma_f32_16x16x32_bf16 v[156:159], v[106:109], v[94:97], v[156:159]
  v_exp_f32 v153, v153
  v_mfma_f32_16x16x32_bf16 v[116:119], v[208:211], v[168:171], 0
  v_exp_f32 v154, v154
  v_mfma_f32_16x16x32_bf16 v[116:119], v[106:109], v[98:101], v[116:119]
  v_exp_f32 v155, v155
  v_mfma_f32_16x16x32_bf16 v[132:135], v[208:211], v[164:167], 0
  v_mul_f32 v124, 0x3ee9a3cd, v124
  v_cvt_pk_bf16_f32 v208, v200, v201
  v_mfma_f32_16x16x32_bf16 v[132:135], v[106:109], v[102:105], v[132:135]
  v_exp_f32 v188, v188
  v_exp_f32 v189, v189
  v_exp_f32 v190, v190
  v_exp_f32 v191, v191
  v_exp_f32 v176, v176
  v_cvt_pk_bf16_f32 v209, v202, v203
  v_cvt_pk_bf16_f32 v210, v152, v153
  v_cvt_pk_bf16_f32 v211, v154, v155
  v_rcp_f32 v200, v124
  s_nop 0
  v_mfma_f32_16x16x32_bf16 v[152:155], a[246:249], v[208:211], 0
  v_cndmask_b32 v201, v116, v156, s[54:55]
  v_cndmask_b32 v201, v132, v201, s[56:57]
  v_cvt_pk_bf16_f32 v110, v188, v189
  v_cvt_pk_bf16_f32 v111, v190, v191
  v_cvt_pk_bf16_f32 v112, v176, 0
  v_mul_f32 v201, v201, v200
  v_cvt_pk_bf16_f32 v201, v201, v201
  v_mfma_f32_16x16x32_bf16 v[152:155], a[246:249], v[110:113], v[152:155]
  ds_write_b16 v20, v201 offset:384
  v_mfma_f32_16x16x32_bf16 v[176:179], v[192:195], v[208:211], 0
  v_max3_f32 v1, v1, v124, v200
  v_add_u32 v20, 1152, v20
  v_mfma_f32_16x16x32_bf16 v[176:179], v[94:97], v[110:113], v[176:179]
  v_mul_f32 v152, 0x3ee9a3cd, v152
  v_mfma_f32_16x16x32_bf16 v[124:127], v[168:171], v[208:211], 0
  v_rcp_f32 v94, v152
  v_mfma_f32_16x16x32_bf16 v[124:127], v[98:101], v[110:113], v[124:127]
  v_mul_f32 v176, v176, v94
  v_mul_f32 v177, v177, v94
  v_mfma_f32_16x16x32_bf16 v[168:171], v[164:167], v[208:211], 0
  v_mul_f32 v178, v178, v94
  v_mul_f32 v179, v179, v94
  v_mfma_f32_16x16x32_bf16 v[168:171], v[102:105], v[110:113], v[168:171]
  s_waitcnt lgkmcnt(0)
  v_mul_f32 v124, v124, v94
  v_mul_f32 v125, v125, v94
  v_mul_f32 v126, v126, v94
  v_mul_f32 v127, v127, v94
  v_cvt_pk_bf16_f32 v164, v176, v177
  v_cvt_pk_bf16_f32 v165, v178, v179
  v_cvt_pk_bf16_f32 v166, v124, v125
  v_cvt_pk_bf16_f32 v167, v126, v127
  ds_write_b128 v16, v[164:167] offset:32768
  v_mul_f32 v168, v168, v94
  v_mul_f32 v169, v169, v94
  v_mul_f32 v170, v170, v94
  v_mul_f32 v171, v171, v94
  v_cvt_pk_bf16_f32 v164, v168, v169
  v_cvt_pk_bf16_f32 v165, v170, v171
  ds_write_b64 v17, v[164:165] offset:32768
  v_max3_f32 v1, v1, v152, v94
  s_waitcnt lgkmcnt(0)
  s_barrier
  v_mbcnt_lo_u32_b32 v250, -1, 0
  v_mbcnt_hi_u32_b32 v250, -1, v250
  v_lshrrev_b32 v251, 4, v250
  v_and_b32 v252, 15, v250
  v_add_u32 v246, 0, v252
  v_lshlrev_b32 v246, 5, v246
  v_add_u32 v247, s30, v246
  v_cmp_gt_u32 s[60:61], s72, v247
  v_add_u32 v246, s29, v246
  v_cmp_gt_u32 s[62:63], s73, v246
  s_nop 1
  s_and_b64 s[60:61], s[60:61], s[62:63]
  v_mul_u32_u24 v247, 7183, v246
  v_lshrrev_b32 v247, 22, v247
  v_mul_u32_u24 v248, 584, v247
  v_sub_u32 v248, v246, v248
  v_cmp_le_u32 vcc, 5256, v246
  v_and_b32 v245, 7, v248
  v_lshl_add_u32 v247, v247, 3, v245
  v_mov_b32 v245, 72
  v_cndmask_b32 v247, v247, v245, vcc
  v_lshrrev_b32 v245, 3, v248
  v_cndmask_b32 v248, v245, v248, vcc
  v_mul_u32_u24 v247, 1373568, v247
  v_mul_u32_u24 v248, 2688, v248
  v_add_u32 v245, v247, v248
  v_cndmask_b32 v245, 2.0, v245, s[60:61]
  v_lshl_add_u32 v245, v251, 3, v245
  v_add_u32 v245, s74, v245
  v_add_u32 v226, 589824, v245
  v_add_u32 v246, 16, v252
  v_lshlrev_b32 v246, 5, v246
  v_add_u32 v247, s30, v246
  v_cmp_gt_u32 s[60:61], s72, v247
  v_add_u32 v246, s29, v246
  v_cmp_gt_u32 s[62:63], s73, v246
  s_nop 1
  s_and_b64 s[60:61], s[60:61], s[62:63]
  v_mul_u32_u24 v247, 7183, v246
  v_lshrrev_b32 v247, 22, v247
  v_mul_u32_u24 v248, 584, v247
  v_sub_u32 v248, v246, v248
  v_cmp_le_u32 vcc, 5256, v246
  v_and_b32 v245, 7, v248
  v_lshl_add_u32 v247, v247, 3, v245
  v_mov_b32 v245, 72
  v_cndmask_b32 v247, v247, v245, vcc
  v_lshrrev_b32 v245, 3, v248
  v_cndmask_b32 v248, v245, v248, vcc
  v_mul_u32_u24 v247, 1373568, v247
  v_mul_u32_u24 v248, 2688, v248
  v_add_u32 v245, v247, v248
  v_cndmask_b32 v245, 2.0, v245, s[60:61]
  v_lshl_add_u32 v245, v251, 3, v245
  v_add_u32 v245, s74, v245
  v_add_u32 v227, 589824, v245
  v_mul_u32_u24 v246, 1152, v252
  v_lshl_add_u32 v246, v251, 3, v246
  v_add_u32 v228, 38912, v246
  v_add_u32 v229, s75, v15
  s_mov_b32 s60, 0
  buffer_load_dwordx4 v[58:61], v229, s[12:15], s60 offen
  s_mov_b32 s61, 4096
  buffer_load_dwordx4 v[62:65], v229, s[12:15], s61 offen
  s_mov_b32 s62, 8192
  buffer_load_dwordx4 v[66:69], v229, s[12:15], s62 offen
  s_mov_b32 s63, 12288
  buffer_load_dwordx4 v[70:73], v229, s[12:15], s63 offen
  s_mov_b32 s64, 16384
  buffer_load_dwordx4 v[74:77], v229, s[12:15], s64 offen
  s_mov_b32 s65, 20480
  buffer_load_dwordx4 v[78:81], v229, s[12:15], s65 offen
  ds_read_b128 v[116:119], v15 offset:20480
  ds_read_b128 v[120:123], v18
  v_add_u32 v229, 18432, v228
  ds_read_b128 v[124:127], v18 offset:1024
  ds_read_b128 v[128:131], v15 offset:26624
  ds_read_b128 v[132:135], v15 offset:32768
  ds_read2_b64 v[136:139], v228 offset0:0 offset1:4
  s_waitcnt lgkmcnt(5)
  v_mfma_f32_16x16x32_bf16 v[22:25], a[250:253], v[116:119], v[22:25]
  s_waitcnt lgkmcnt(4)
  v_mfma_f32_16x16x32_bf16 v[26:29], v[120:123], v[116:119], v[26:29]
  s_waitcnt lgkmcnt(3)
  v_mfma_f32_16x16x32_bf16 v[30:33], v[124:127], v[116:119], v[30:33]
  ds_read2_b64 v[116:119], v229 offset0:0 offset1:4
  s_waitcnt lgkmcnt(3)
  v_mfma_f32_16x16x32_bf16 v[34:37], a[250:253], v[128:131], v[34:37]
  v_mfma_f32_16x16x32_bf16 v[38:41], v[120:123], v[128:131], v[38:41]
  v_mfma_f32_16x16x32_bf16 v[42:45], v[124:127], v[128:131], v[42:45]
  s_waitcnt lgkmcnt(2)
  v_mfma_f32_16x16x32_bf16 v[46:49], a[250:253], v[132:135], v[46:49]
  ds_read_b128 v[128:131], v18 offset:2048
  v_mfma_f32_16x16x32_bf16 v[50:53], v[120:123], v[132:135], v[50:53]
  ds_read_b128 v[140:143], v15 offset:21504
  v_mfma_f32_16x16x32_bf16 v[54:57], v[124:127], v[132:135], v[54:57]
  s_waitcnt lgkmcnt(3)
  ds_read_b128 v[132:135], v18 offset:3072
  ds_read_b128 v[144:147], v18 offset:4096
  ds_read_b128 v[148:151], v15 offset:27648
  ds_read_b128 v[152:155], v15 offset:33792
  ds_read2_b64 v[156:159], v228 offset0:12 offset1:16
  ds_read2_b64 v[160:163], v229 offset0:12 offset1:16
  s_waitcnt vmcnt(5)
  v_mfma_f32_16x16x32_bf16 v[58:61], a[250:253], v[136:139], v[58:61]
  s_waitcnt vmcnt(4)
  v_mfma_f32_16x16x32_bf16 v[62:65], v[120:123], v[136:139], v[62:65]
  s_waitcnt vmcnt(3)
  v_mfma_f32_16x16x32_bf16 v[66:69], v[124:127], v[136:139], v[66:69]
  s_waitcnt vmcnt(2) lgkmcnt(8)
  v_mfma_f32_16x16x32_bf16 v[70:73], a[250:253], v[116:119], v[70:73]
  s_waitcnt vmcnt(1)
  v_mfma_f32_16x16x32_bf16 v[74:77], v[120:123], v[116:119], v[74:77]
  s_waitcnt vmcnt(0)
  v_mfma_f32_16x16x32_bf16 v[78:81], v[124:127], v[116:119], v[78:81]
  s_waitcnt lgkmcnt(6)
  v_mfma_f32_16x16x32_bf16 v[22:25], v[128:131], v[140:143], v[22:25]
  s_waitcnt lgkmcnt(5)
  ds_read_b128 v[116:119], v18 offset:5120
  ds_read_b128 v[124:127], v15 offset:22528
  v_mfma_f32_16x16x32_bf16 v[26:29], v[132:135], v[140:143], v[26:29]
  s_waitcnt lgkmcnt(6)
  ds_read_b128 v[120:123], v18 offset:6144
  v_mfma_f32_16x16x32_bf16 v[30:33], v[144:147], v[140:143], v[30:33]
  s_waitcnt lgkmcnt(6)
  ds_read_b128 v[140:143], v18 offset:7168
  v_mfma_f32_16x16x32_bf16 v[34:37], v[128:131], v[148:151], v[34:37]
  ds_read_b128 v[136:139], v15 offset:28672
  v_mfma_f32_16x16x32_bf16 v[38:41], v[132:135], v[148:151], v[38:41]
  ds_read2_b64 v[164:167], v228 offset0:24 offset1:28
  v_mfma_f32_16x16x32_bf16 v[42:45], v[144:147], v[148:151], v[42:45]
  s_waitcnt lgkmcnt(8)
  v_mfma_f32_16x16x32_bf16 v[46:49], v[128:131], v[152:155], v[46:49]
  v_mfma_f32_16x16x32_bf16 v[50:53], v[132:135], v[152:155], v[50:53]
  v_mfma_f32_16x16x32_bf16 v[54:57], v[144:147], v[152:155], v[54:57]
  s_waitcnt lgkmcnt(7)
  ds_read_b128 v[152:155], v15 offset:34816
  v_mfma_f32_16x16x32_bf16 v[58:61], v[128:131], v[156:159], v[58:61]
  ds_read2_b64 v[148:151], v229 offset0:24 offset1:28
  v_mfma_f32_16x16x32_bf16 v[62:65], v[132:135], v[156:159], v[62:65]
  v_mfma_f32_16x16x32_bf16 v[66:69], v[144:147], v[156:159], v[66:69]
  s_waitcnt lgkmcnt(8)
  v_mfma_f32_16x16x32_bf16 v[70:73], v[128:131], v[160:163], v[70:73]
  v_mfma_f32_16x16x32_bf16 v[74:77], v[132:135], v[160:163], v[74:77]
  v_mfma_f32_16x16x32_bf16 v[78:81], v[144:147], v[160:163], v[78:81]
  s_waitcnt lgkmcnt(6)
  v_mfma_f32_16x16x32_bf16 v[22:25], v[116:119], v[124:127], v[22:25]
  s_waitcnt lgkmcnt(5)
  ds_read_b128 v[144:147], v18 offset:8192
  ds_read_b128 v[160:163], v15 offset:23552
  v_mfma_f32_16x16x32_bf16 v[26:29], v[120:123], v[124:127], v[26:29]
  s_waitcnt lgkmcnt(6)
  ds_read_b128 v[132:135], v18 offset:9216
  v_mfma_f32_16x16x32_bf16 v[30:33], v[140:143], v[124:127], v[30:33]
  s_waitcnt lgkmcnt(6)
  ds_read_b128 v[124:127], v18 offset:10240
  v_mfma_f32_16x16x32_bf16 v[34:37], v[116:119], v[136:139], v[34:37]
  ds_read_b128 v[128:131], v15 offset:29696
  v_mfma_f32_16x16x32_bf16 v[38:41], v[120:123], v[136:139], v[38:41]
  ds_read2_b64 v[156:159], v228 offset0:36 offset1:40
  v_mfma_f32_16x16x32_bf16 v[42:45], v[140:143], v[136:139], v[42:45]
  s_waitcnt lgkmcnt(7)
  v_mfma_f32_16x16x32_bf16 v[46:49], v[116:119], v[152:155], v[46:49]
  v_mfma_f32_16x16x32_bf16 v[50:53], v[120:123], v[152:155], v[50:53]
  v_mfma_f32_16x16x32_bf16 v[54:57], v[140:143], v[152:155], v[54:57]
  ds_read_b128 v[152:155], v15 offset:35840
  v_mfma_f32_16x16x32_bf16 v[58:61], v[116:119], v[164:167], v[58:61]
  ds_read2_b64 v[136:139], v229 offset0:36 offset1:40
  v_mfma_f32_16x16x32_bf16 v[62:65], v[120:123], v[164:167], v[62:65]
  v_mfma_f32_16x16x32_bf16 v[66:69], v[140:143], v[164:167], v[66:69]
  s_waitcnt lgkmcnt(8)
  v_mfma_f32_16x16x32_bf16 v[70:73], v[116:119], v[148:151], v[70:73]
  v_mfma_f32_16x16x32_bf16 v[74:77], v[120:123], v[148:151], v[74:77]
  v_mfma_f32_16x16x32_bf16 v[78:81], v[140:143], v[148:151], v[78:81]
  s_waitcnt lgkmcnt(6)
  v_mfma_f32_16x16x32_bf16 v[22:25], v[144:147], v[160:163], v[22:25]
  s_waitcnt lgkmcnt(5)
  ds_read_b128 v[140:143], v18 offset:11264
  ds_read_b128 v[148:151], v15 offset:24576
  v_mfma_f32_16x16x32_bf16 v[26:29], v[132:135], v[160:163], v[26:29]
  s_waitcnt lgkmcnt(6)
  ds_read_b128 v[120:123], v18 offset:12288
  v_mfma_f32_16x16x32_bf16 v[30:33], v[124:127], v[160:163], v[30:33]
  s_waitcnt lgkmcnt(6)
  ds_read_b128 v[160:163], v18 offset:13312
  v_mfma_f32_16x16x32_bf16 v[34:37], v[144:147], v[128:131], v[34:37]
  ds_read_b128 v[116:119], v15 offset:30720
  v_mfma_f32_16x16x32_bf16 v[38:41], v[132:135], v[128:131], v[38:41]
  ds_read2_b64 v[164:167], v228 offset0:8 offset1:20
  v_mfma_f32_16x16x32_bf16 v[42:45], v[124:127], v[128:131], v[42:45]
  s_waitcnt lgkmcnt(7)
  v_mfma_f32_16x16x32_bf16 v[46:49], v[144:147], v[152:155], v[46:49]
  v_mfma_f32_16x16x32_bf16 v[50:53], v[132:135], v[152:155], v[50:53]
  v_mfma_f32_16x16x32_bf16 v[54:57], v[124:127], v[152:155], v[54:57]
  ds_read_b128 v[152:155], v15 offset:36864
  v_mfma_f32_16x16x32_bf16 v[58:61], v[144:147], v[156:159], v[58:61]
  ds_read2_b64 v[128:131], v229 offset0:8 offset1:20
  v_mfma_f32_16x16x32_bf16 v[62:65], v[132:135], v[156:159], v[62:65]
  v_mfma_f32_16x16x32_bf16 v[66:69], v[124:127], v[156:159], v[66:69]
  s_waitcnt lgkmcnt(8)
  v_mfma_f32_16x16x32_bf16 v[70:73], v[144:147], v[136:139], v[70:73]
  v_mfma_f32_16x16x32_bf16 v[74:77], v[132:135], v[136:139], v[74:77]
  v_mfma_f32_16x16x32_bf16 v[78:81], v[124:127], v[136:139], v[78:81]
  s_waitcnt lgkmcnt(6)
  v_mfma_f32_16x16x32_bf16 v[22:25], v[140:143], v[148:151], v[22:25]
  s_waitcnt lgkmcnt(5)
  ds_read_b128 v[124:127], v18 offset:14336
  ds_read_b128 v[136:139], v15 offset:25600
  v_mfma_f32_16x16x32_bf16 v[26:29], v[120:123], v[148:151], v[26:29]
  s_waitcnt lgkmcnt(6)
  ds_read_b128 v[132:135], v18 offset:15360
  v_mfma_f32_16x16x32_bf16 v[30:33], v[160:163], v[148:151], v[30:33]
  s_waitcnt lgkmcnt(6)
  ds_read_b128 v[148:151], v18 offset:16384
  v_mfma_f32_16x16x32_bf16 v[34:37], v[140:143], v[116:119], v[34:37]
  ds_read_b128 v[144:147], v15 offset:31744
  v_mfma_f32_16x16x32_bf16 v[38:41], v[120:123], v[116:119], v[38:41]
  ds_read2_b64 v[156:159], v228 offset0:32 offset1:44
  v_mfma_f32_16x16x32_bf16 v[42:45], v[160:163], v[116:119], v[42:45]
  s_waitcnt lgkmcnt(7)
  v_mfma_f32_16x16x32_bf16 v[46:49], v[140:143], v[152:155], v[46:49]
  v_mfma_f32_16x16x32_bf16 v[50:53], v[120:123], v[152:155], v[50:53]
  v_mfma_f32_16x16x32_bf16 v[54:57], v[160:163], v[152:155], v[54:57]
  ds_read_b128 v[152:155], v15 offset:37888
  v_mfma_f32_16x16x32_bf16 v[58:61], v[140:143], v[164:167], v[58:61]
  ds_read2_b64 v[116:119], v229 offset0:32 offset1:44
  v_mfma_f32_16x16x32_bf16 v[62:65], v[120:123], v[164:167], v[62:65]
  v_mfma_f32_16x16x32_bf16 v[66:69], v[160:163], v[164:167], v[66:69]
  s_waitcnt lgkmcnt(8)
  v_mfma_f32_16x16x32_bf16 v[70:73], v[140:143], v[128:131], v[70:73]
  v_mfma_f32_16x16x32_bf16 v[74:77], v[120:123], v[128:131], v[74:77]
  v_mfma_f32_16x16x32_bf16 v[78:81], v[160:163], v[128:131], v[78:81]
  s_waitcnt lgkmcnt(6)
  v_mfma_f32_16x16x32_bf16 v[22:25], v[124:127], v[136:139], v[22:25]
  s_waitcnt lgkmcnt(5)
  v_mfma_f32_16x16x32_bf16 v[26:29], v[132:135], v[136:139], v[26:29]
  s_waitcnt lgkmcnt(4)
  v_mfma_f32_16x16x32_bf16 v[30:33], v[148:151], v[136:139], v[30:33]
  s_waitcnt lgkmcnt(3)
  v_cvt_pk_bf16_f32 v136, v22, v23
  v_cvt_pk_bf16_f32 v137, v24, v25
  v_mfma_f32_16x16x32_bf16 v[34:37], v[124:127], v[144:147], v[34:37]
  buffer_store_dwordx2 v[136:137], v12, s[8:11], s32 offen
  v_cvt_pk_bf16_f32 v136, v26, v27
  v_mfma_f32_16x16x32_bf16 v[38:41], v[132:135], v[144:147], v[38:41]
  v_cvt_pk_bf16_f32 v137, v28, v29
  v_cvt_pk_bf16_f32 v138, v30, v31
  v_mfma_f32_16x16x32_bf16 v[42:45], v[148:151], v[144:147], v[42:45]
  s_waitcnt lgkmcnt(1)
  buffer_store_dwordx2 v[136:137], v12, s[8:11], s32 offen offset:32
  v_cvt_pk_bf16_f32 v139, v32, v33
  v_mfma_f32_16x16x32_bf16 v[46:49], v[124:127], v[152:155], v[46:49]
  buffer_store_dwordx2 v[138:139], v12, s[8:11], s32 offen offset:64
  v_cvt_pk_bf16_f32 v138, v34, v35
  v_mfma_f32_16x16x32_bf16 v[50:53], v[132:135], v[152:155], v[50:53]
  v_cvt_pk_bf16_f32 v139, v36, v37
  v_cvt_pk_bf16_f32 v136, v38, v39
  v_mfma_f32_16x16x32_bf16 v[54:57], v[148:151], v[152:155], v[54:57]
  buffer_store_dwordx2 v[138:139], v13, s[8:11], s32 offen
  v_cvt_pk_bf16_f32 v137, v40, v41
  v_mfma_f32_16x16x32_bf16 v[58:61], v[124:127], v[156:159], v[58:61]
  buffer_store_dwordx2 v[136:137], v13, s[8:11], s32 offen offset:32
  v_cvt_pk_bf16_f32 v136, v42, v43
  v_mfma_f32_16x16x32_bf16 v[62:65], v[132:135], v[156:159], v[62:65]
  v_cvt_pk_bf16_f32 v137, v44, v45
  v_cvt_pk_bf16_f32 v138, v46, v47
  v_mfma_f32_16x16x32_bf16 v[66:69], v[148:151], v[156:159], v[66:69]
  s_waitcnt lgkmcnt(0)
  buffer_store_dwordx2 v[136:137], v13, s[8:11], s32 offen offset:64
  v_cvt_pk_bf16_f32 v139, v48, v49
  v_mfma_f32_16x16x32_bf16 v[70:73], v[124:127], v[116:119], v[70:73]
  buffer_store_dwordx2 v[138:139], v14, s[8:11], s32 offen
  v_cvt_pk_bf16_f32 v138, v50, v51
  v_mfma_f32_16x16x32_bf16 v[74:77], v[132:135], v[116:119], v[74:77]
  v_cvt_pk_bf16_f32 v139, v52, v53
  v_cvt_pk_bf16_f32 v132, v54, v55
  v_mfma_f32_16x16x32_bf16 v[78:81], v[148:151], v[116:119], v[78:81]
  v_cvt_pk_bf16_f32 v133, v56, v57
  v_cvt_pk_bf16_f32 v116, v58, v59
  v_cvt_pk_bf16_f32 v117, v60, v61
  v_cvt_pk_bf16_f32 v118, v62, v63
  v_cvt_pk_bf16_f32 v119, v64, v65
  v_cvt_pk_bf16_f32 v148, v66, v67
  v_cvt_pk_bf16_f32 v149, v68, v69
  v_cvt_pk_bf16_f32 v150, v70, v71
  v_cvt_pk_bf16_f32 v151, v72, v73
  v_cvt_pk_bf16_f32 v134, v74, v75
  v_cvt_pk_bf16_f32 v135, v76, v77
  v_cvt_pk_bf16_f32 v124, v78, v79
  v_cvt_pk_bf16_f32 v125, v80, v81
  buffer_store_dwordx2 v[138:139], v14, s[8:11], s32 offen offset:32
  buffer_store_dwordx2 v[132:133], v14, s[8:11], s32 offen offset:64
  buffer_store_dwordx2 v[116:117], v226, s[8:11], 0 offen
  buffer_store_dwordx2 v[118:119], v226, s[8:11], 0 offen offset:32
  buffer_store_dwordx2 v[148:149], v226, s[8:11], 0 offen offset:64
  buffer_store_dwordx2 v[150:151], v227, s[8:11], 0 offen
  buffer_store_dwordx2 v[134:135], v227, s[8:11], 0 offen offset:32
  buffer_store_dwordx2 v[124:125], v227, s[8:11], 0 offen offset:64
L_exit:
  s_endpgm
.section .rodata,"a"
.p2align 6
.amdhsa_kernel standalone__window_attn_davit__vision_kernel
  .amdhsa_next_free_vgpr 512
  .amdhsa_next_free_sgpr 102
  .amdhsa_accum_offset 256
  .amdhsa_group_segment_fixed_size 0
  .amdhsa_kernarg_size 56
  .amdhsa_user_sgpr_count 2
  .amdhsa_user_sgpr_kernarg_segment_ptr 1
  .amdhsa_system_sgpr_workgroup_id_x 1
.end_amdhsa_kernel
```

```asm
; @launch grid=(256,1,1) block=(256,1,1) lds=163840
.amdgcn_target "amdgcn-amd-amdhsa--gfx950"
.text
.globl standalone__window_attn_davit__vision_kernel
.p2align 8
.type standalone__window_attn_davit__vision_kernel,@function
standalone__window_attn_davit__vision_kernel:
  s_cmp_ge_u32 s2, 256
  s_cbranch_scc1 L_exit
  s_load_dwordx8 s[36:43], s[0:1], 0
  s_load_dwordx2 s[44:45], s[0:1], 32
  s_load_dwordx2 s[46:47], s[0:1], 48
  v_lshrrev_b32 v1, 6, v0
  s_and_b32 s60, s2, 7
  s_lshr_b32 s30, s2, 3
  v_readfirstlane_b32 s28, v1
  v_and_b32 v250, 63, v0
  s_mul_i32 s29, s60, 667
  s_add_u32 s29, s29, s30
  s_mov_b32 s72, 667
  s_mov_b32 s73, 5329
  s_mul_i32 s74, s28, 96
  s_mul_i32 s81, s28, 27872
  s_add_u32 s81, s81, 20480
  s_lshl_b32 s76, s28, 10
  v_add_u32 v246, 0, v250
  v_lshlrev_b32 v246, 5, v246
  v_add_u32 v247, s30, v246
  v_cmp_gt_u32 s[60:61], s72, v247
  v_add_u32 v246, s29, v246
  v_cmp_gt_u32 s[62:63], s73, v246
  v_mul_u32_u24 v247, 7183, v246
  v_lshrrev_b32 v247, 22, v247
  s_and_b64 s[60:61], s[60:61], s[62:63]
  v_mul_u32_u24 v248, 584, v247
  v_sub_u32 v248, v246, v248
  v_cmp_le_u32 vcc, 5256, v246
  v_and_b32 v245, 7, v248
  v_lshl_add_u32 v247, v247, 3, v245
  v_mov_b32 v245, 72
  v_cndmask_b32 v247, v247, v245, vcc
  v_lshrrev_b32 v245, 3, v248
  v_cndmask_b32 v248, v245, v248, vcc
  v_mul_u32_u24 v247, 1373568, v247
  v_mul_u32_u24 v248, 2688, v248
  v_add_u32 v245, v247, v248
  v_cndmask_b32 v245, 2.0, v245, s[60:61]
  v_mul_u32_u24 v246, 43, v250
  v_lshrrev_b32 v246, 8, v246
  v_mul_u32_u24 v247, 6, v246
  v_sub_u32 v247, v250, v247
  v_lshl_add_u32 v247, v247, 4, s74
  v_cmp_gt_u32 vcc, 54, v250
  v_mul_u32_u24 v248, 384, v246
  v_add_u32 v247, v247, v248
  v_cndmask_b32 v21, 2.0, v247, vcc
  v_mul_u32_u24 v246, 11, v246
  v_lshrrev_b32 v246, 5, v246
  v_mul_u32_u24 v246, 195072, v246
  v_add_u32 v247, 589824, v247
  v_add_u32 v247, v247, v246
  v_cndmask_b32 v244, 2.0, v247, vcc
  v_readlane_b32 s60, v245, 0
  v_readlane_b32 s61, v245, 1
  v_readlane_b32 s62, v245, 2
  v_lshlrev_b32 v246, 6, v250
  v_cmp_gt_u32 vcc, 27, v250
  s_lshl_b32 s69, s30, 2
  s_add_u32 s69, s69, s28
  v_cndmask_b32 v247, 2.0, v246, vcc
  v_cmp_gt_u32 vcc, 9, v250
  s_mul_i32 s70, s69, 1728
  s_mul_i32 s71, s69, 576
  v_cndmask_b32 v248, 2.0, v246, vcc
  s_waitcnt lgkmcnt(0)
  s_mov_b32 s16, s40
  s_mov_b32 s17, s41
  s_mov_b32 s18, 221184
  s_mov_b32 s19, 0x20000
  buffer_load_dword v255, v247, s[16:19], s70 offen
  s_mov_b32 s24, s38
  s_mov_b32 s25, s39
  s_mov_b32 s26, 3456
  s_mov_b32 s27, 0x20000
  s_add_u32 m0, s76, 8192
  s_sub_u32 s4, s36, 196608
  s_subb_u32 s5, s37, 0
  s_mov_b32 s6, 100467072
  s_mov_b32 s7, 0x20000
  buffer_load_dwordx4 v21, s[24:27], 0 offen lds
  s_add_u32 m0, s81, 9216
  s_nop 0
  buffer_load_dwordx4 v244, s[4:7], s60 offen nt lds
  s_add_u32 m0, s81, 10080
  s_nop 0
  buffer_load_dwordx4 v244, s[4:7], s61 offen nt lds
  s_add_u32 m0, s81, 10944
  s_nop 0
  buffer_load_dwordx4 v244, s[4:7], s62 offen nt lds
  s_mov_b32 s20, s42
  s_mov_b32 s21, s43
  s_mov_b32 s22, 73728
  s_mov_b32 s23, 0x20000
  buffer_load_dword v225, v248, s[20:23], s71 offen
  s_getpc_b64 s[62:63]
  L_pc:
  s_mul_i32 s69, s69, 320
  s_min_u32 s69, s69, L_exit-L_pc-320
  s_add_u32 s62, s62, s69
  s_addc_u32 s63, s63, 0
  v_min_u32 v247, 4, v250
  v_lshlrev_b32 v247, 6, v247
  global_load_dword v224, v247, s[62:63]
  v_readlane_b32 s63, v245, 3
  v_readlane_b32 s64, v245, 4
  v_readlane_b32 s65, v245, 5
  v_readlane_b32 s66, v245, 6
  v_readlane_b32 s67, v245, 7
  v_readlane_b32 s68, v245, 8
  v_add_u32 v246, 0, v250
  v_mul_u32_u24 v247, 171, v246
  v_lshrrev_b32 v247, 10, v247
  v_mul_u32_u24 v248, 6, v247
  v_sub_u32 v248, v246, v248
  v_lshl_add_u32 v248, v248, 4, s74
  v_subrev_u32 v248, 0, v248
  v_mul_u32_u24 v246, 1152, v247
  v_add_u32 v232, v246, v248
  v_mul_u32_u24 v246, 384, v247
  v_add_u32 v235, v246, v248
  v_add_u32 v246, 64, v250
  v_mul_u32_u24 v247, 171, v246
  v_lshrrev_b32 v247, 10, v247
  v_mul_u32_u24 v248, 6, v247
  v_sub_u32 v248, v246, v248
  v_lshl_add_u32 v248, v248, 4, s74
  v_subrev_u32 v248, 1024, v248
  v_mul_u32_u24 v246, 1152, v247
  v_add_u32 v233, v246, v248
  v_mul_u32_u24 v246, 384, v247
  v_add_u32 v236, v246, v248
  v_add_u32 v246, 128, v250
  v_mul_u32_u24 v247, 171, v246
  v_lshrrev_b32 v247, 10, v247
  v_mul_u32_u24 v248, 6, v247
  v_sub_u32 v248, v246, v248
  v_lshl_add_u32 v248, v248, 4, s74
  v_subrev_u32 v248, 2048, v248
  v_mul_u32_u24 v246, 1152, v247
  v_add_u32 v234, v246, v248
  v_mul_u32_u24 v246, 384, v247
  v_add_u32 v237, v246, v248
  s_add_u32 m0, s81, 0
  s_mov_b32 s98, 0
  buffer_load_dwordx4 v232, s[16:19], s98 offen lds
  buffer_load_dwordx4 v233, s[16:19], s98 offen offset:1024 lds
  buffer_load_dwordx4 v234, s[16:19], s98 offen offset:2048 lds
  s_add_u32 m0, s81, 11808
  s_nop 0
  buffer_load_dwordx4 v244, s[4:7], s63 offen nt lds
  s_add_u32 m0, s81, 12672
  s_nop 0
  buffer_load_dwordx4 v244, s[4:7], s64 offen nt lds
  s_add_u32 m0, s81, 13536
  s_nop 0
  buffer_load_dwordx4 v244, s[4:7], s65 offen nt lds
  s_add_u32 m0, s81, 3072
  s_mov_b32 s98, 36864
  buffer_load_dwordx4 v232, s[16:19], s98 offen lds
  buffer_load_dwordx4 v233, s[16:19], s98 offen offset:1024 lds
  buffer_load_dwordx4 v234, s[16:19], s98 offen offset:2048 lds
  s_add_u32 m0, s81, 14400
  s_nop 0
  buffer_load_dwordx4 v244, s[4:7], s66 offen nt lds
  s_add_u32 m0, s81, 15264
  s_nop 0
  buffer_load_dwordx4 v244, s[4:7], s67 offen nt lds
  s_add_u32 m0, s81, 16128
  s_nop 0
  buffer_load_dwordx4 v244, s[4:7], s68 offen nt lds
  s_add_u32 m0, s81, 6144
  s_mov_b32 s98, 73728
  buffer_load_dwordx4 v232, s[16:19], s98 offen lds
  buffer_load_dwordx4 v233, s[16:19], s98 offen offset:1024 lds
  buffer_load_dwordx4 v234, s[16:19], s98 offen offset:2048 lds
  s_mov_b32 s8, s44
  s_mov_b32 s9, s45
  s_mov_b32 s10, 100270464
  s_mov_b32 s11, 0x20000
  s_mov_b32 s12, s46
  s_mov_b32 s13, s47
  s_mov_b32 s14, 16777216
  s_mov_b32 s15, 0x20000
  v_readlane_b32 s36, v245, 9
  v_readlane_b32 s37, v245, 10
  v_readlane_b32 s38, v245, 11
  v_readlane_b32 s39, v245, 12
  v_readlane_b32 s40, v245, 13
  v_readlane_b32 s41, v245, 14
  v_readlane_b32 s42, v245, 15
  v_readlane_b32 s43, v245, 16
  v_readlane_b32 s44, v245, 17
  v_readlane_b32 s45, v245, 18
  v_readlane_b32 s46, v245, 19
  v_readlane_b32 s47, v245, 20
  s_add_u32 m0, s81, 16992
  s_nop 0
  buffer_load_dwordx4 v244, s[4:7], s36 offen nt lds
  s_add_u32 m0, s81, 17856
  s_nop 0
  buffer_load_dwordx4 v244, s[4:7], s37 offen nt lds
  s_add_u32 m0, s81, 18720
  s_nop 0
  buffer_load_dwordx4 v244, s[4:7], s38 offen nt lds
  s_mov_b64 s[48:49], 0x3f
  s_mov_b32 s50, 0
  s_mov_b32 s51, 0x3f0000
  s_mov_b32 s54, 0xffff
  s_mov_b32 s55, 0
  s_mov_b32 s56, -1
  s_mov_b32 s57, 0
  s_mul_i32 s58, s28, 7936
  s_add_u32 s58, s58, 131968
  s_add_u32 s59, s58, 4320
  s_mul_i32 s75, s2, 65536
  s_mul_i32 s77, s28, 12288
  s_add_u32 s75, s75, s77
  s_add_u32 s77, s75, 4096
  s_add_u32 s78, s75, 8192
  s_mov_b32 s31, 0
  s_mov_b32 s79, 0x4310
  s_mov_b32 s80, 0x5276
  v_lshrrev_b32 v251, 4, v250
  v_and_b32 v252, 15, v250
  v_and_b32 v246, 3, v250
  v_mul_u32_u24 v0, 0x5555, v246
  v_mov_b32 v1, 0
  v_mov_b32 v246, 0xf149f2ca
  v_cndmask_b32 v2, v246, 0, s[54:55]
  v_mov_b32 v119, 0
  v_mov_b32 v123, 0
  v_lshrrev_b32 v253, 1, v251
  v_and_b32 v249, 1, v251
  v_cmp_eq_u32 s[94:95], 1, v249
  v_lshlrev_b32 v249, 4, v249
  v_lshlrev_b32 v254, 4, v253
  v_lshl_add_u32 v254, v249, 1, v254
  v_add_u32 v254, s74, v254
  v_mov_b32 v246, 0x03020100
  v_cmp_le_u32 vcc, 4, v252
  v_mov_b32 v247, 0x13121110
  s_nop 0
  v_cndmask_b32 v246, v246, v247, vcc
  v_cmp_le_u32 vcc, 8, v252
  v_mov_b32 v247, 0x26251514
  s_nop 0
  v_cndmask_b32 v246, v246, v247, vcc
  v_cmp_le_u32 vcc, 12, v252
  v_mov_b32 v247, 0x16060504
  s_nop 0
  v_cndmask_b32 v246, v246, v247, vcc
  v_and_b32 v247, 3, v252
  v_lshlrev_b32 v247, 3, v247
  v_bfe_u32 v246, v246, v247, 8
  v_lshrrev_b32 v247, 4, v246
  v_and_b32 v246, 15, v246
  v_mul_u32_u24 v12, 196224, v247
  v_mul_u32_u24 v248, 384, v246
  v_add3_u32 v12, v12, v248, v254
  v_mul_u32_u24 v247, 9, v247
  v_add_u32 v246, v246, v247
  v_mul_u32_u24 v246, 96, v246
  v_add_u32 v246, s58, v246
  v_mul_u32_u24 v247, 96, v253
  v_add3_u32 v3, v246, v247, v249
  v_mul_u32_u24 v247, 864, v253
  v_add3_u32 v6, v246, v247, v249
  v_add_u32 v6, 192, v6
  v_lshl_add_u32 v9, v251, 3, v246
  v_add_u32 v9, 1920, v9
  v_mov_b32 v246, 0x23222120
  v_cmp_le_u32 vcc, 4, v252
  v_mov_b32 v247, 0x42323130
  s_nop 0
  v_cndmask_b32 v246, v246, v247, vcc
  v_cmp_le_u32 vcc, 8, v252
  v_mov_b32 v247, 0x46454443
  s_nop 0
  v_cndmask_b32 v246, v246, v247, vcc
  v_cmp_le_u32 vcc, 12, v252
  v_mov_b32 v247, 0x36353424
  s_nop 0
  v_cndmask_b32 v246, v246, v247, vcc
  v_and_b32 v247, 3, v252
  v_lshlrev_b32 v247, 3, v247
  v_bfe_u32 v246, v246, v247, 8
  v_lshrrev_b32 v247, 4, v246
  v_and_b32 v246, 15, v246
  v_mul_u32_u24 v13, 196224, v247
  v_mul_u32_u24 v248, 384, v246
  v_add3_u32 v13, v13, v248, v254
  v_mul_u32_u24 v247, 9, v247
  v_add_u32 v246, v246, v247
  v_mul_u32_u24 v246, 96, v246
  v_add_u32 v246, s58, v246
  v_mul_u32_u24 v247, 96, v253
  v_add3_u32 v4, v246, v247, v249
  v_mul_u32_u24 v247, 864, v253
  v_add3_u32 v7, v246, v247, v249
  v_add_u32 v7, 192, v7
  v_lshl_add_u32 v10, v251, 3, v246
  v_add_u32 v10, 1920, v10
  v_mov_b32 v246, 0x52514140
  v_cmp_le_u32 vcc, 4, v252
  v_mov_b32 v247, 0x62616050
  s_nop 0
  v_cndmask_b32 v246, v246, v247, vcc
  v_cmp_le_u32 vcc, 8, v252
  v_mov_b32 v247, 0x66656463
  s_nop 0
  v_cndmask_b32 v246, v246, v247, vcc
  v_cmp_le_u32 vcc, 12, v252
  v_mov_b32 v247, 0x56555453
  s_nop 0
  v_cndmask_b32 v246, v246, v247, vcc
  v_and_b32 v247, 3, v252
  v_lshlrev_b32 v247, 3, v247
  v_bfe_u32 v246, v246, v247, 8
  v_lshrrev_b32 v247, 4, v246
  v_and_b32 v246, 15, v246
  v_mul_u32_u24 v14, 196224, v247
  v_mul_u32_u24 v248, 384, v246
  v_add3_u32 v23, v14, v248, s74
  v_lshl_add_u32 v23, v251, 3, v23
  v_add_u32 v23, 64, v23
  v_add3_u32 v14, v14, v248, v254
  v_mul_u32_u24 v247, 9, v247
  v_add_u32 v246, v246, v247
  v_mul_u32_u24 v246, 96, v246
  v_add_u32 v246, s58, v246
  v_mul_u32_u24 v247, 96, v253
  v_add3_u32 v5, v246, v247, v249
  v_mul_u32_u24 v247, 864, v253
  v_add3_u32 v8, v246, v247, v249
  v_add_u32 v8, 192, v8
  v_lshl_add_u32 v11, v251, 3, v246
  v_add_u32 v11, 1920, v11
  v_add_u32 v246, 64, v12
  v_add_u32 v247, 32, v13
  v_cndmask_b32 v22, v246, v247, s[94:95]
  v_lshlrev_b32 v15, 4, v250
  v_add_u32 v16, s76, v15
  s_lshr_b32 s60, s28, 1
  s_add_u32 s60, s60, 4
  s_lshl_b32 s60, s60, 10
  s_and_b32 s61, s28, 1
  s_lshl_b32 s61, s61, 3
  s_add_u32 s60, s60, s61
  v_add_u32 v17, s60, v15
  s_mul_i32 s60, s28, 15360
  s_add_u32 s60, s60, 63280
  v_add_u32 v18, s60, v15
  v_add_u32 v246, v249, v252
  v_lshlrev_b32 v247, 10, v253
  v_lshl_add_u32 v107, v246, 4, v247
  s_lshl_b32 s60, s28, 2
  v_add_u32 v107, s60, v107
  v_lshl_add_u32 v111, v246, 3, v247
  v_add_u32 v111, 768, v111
  v_lshlrev_b32 v115, 3, v252
  v_mov_b32 v246, 0x3f803f80
  v_accvgpr_write_b32 a246, v246
  v_accvgpr_write_b32 a247, v246
  v_accvgpr_write_b32 a248, v246
  v_accvgpr_write_b32 a249, v246
  s_add_u32 s60, s74, 38912
  v_mul_u32_u24 v246, 24, v251
  v_add_u32 v19, s60, v246
  v_min_u32 v246, 2, v251
  v_lshl_add_u32 v246, v246, 4, v252
  s_add_u32 s60, s60, 384
  v_lshl_add_u32 v20, v246, 1, s60
  v_cmp_gt_u32 vcc, 5, v252
  v_mul_u32_u24 v246, 1160, v252
  v_add_u32 v240, v19, v246
  v_lshl_add_u32 v246, v251, 3, v246
  v_add_u32 v242, s60, v246
  v_mov_b32 v247, 0x30000
  v_add_u32 v248, 18560, v240
  v_cndmask_b32 v241, v247, v248, vcc
  v_add_u32 v248, 18560, v242
  v_cndmask_b32 v243, v247, v248, vcc
  v_mul_u32_u24 v246, 864, v252
  s_add_u32 s60, s81, 9216
  v_add_u32 v246, s60, v246
  v_mul_u32_u24 v247, 96, v253
  v_add3_u32 v226, v246, v247, v249
  v_mul_u32_u24 v247, 288, v253
  v_add3_u32 v227, v246, v247, v249
  v_add_u32 v227, 192, v227
  v_lshl_add_u32 v228, v251, 3, v246
  v_add_u32 v228, 768, v228
  s_add_u32 s60, s76, 8192
  v_lshl_add_u32 v246, v252, 1, s60
  v_lshlrev_b32 v247, 2, v251
  v_lshrrev_b32 v248, v247, s79
  v_and_b32 v248, 15, v248
  v_mul_u32_u24 v248, 96, v248
  v_add_u32 v229, v246, v248
  v_lshrrev_b32 v248, v247, s80
  v_and_b32 v248, 15, v248
  v_mul_u32_u24 v248, 96, v248
  v_add_u32 v230, v246, v248
  v_add_u32 v231, 768, v246
  v_lshrrev_b32 v246, 2, v250
  v_mul_u32_u24 v246, 96, v246
  v_and_b32 v247, 3, v250
  v_lshl_add_u32 v246, v247, 3, v246
  v_add_u32 v238, s81, v246
  v_add_u32 v246, 0, v252
  v_lshlrev_b32 v246, 5, v246
  v_add_u32 v247, s30, v246
  v_cmp_gt_u32 s[60:61], s72, v247
  v_add_u32 v246, s29, v246
  v_cmp_gt_u32 s[62:63], s73, v246
  v_mul_u32_u24 v247, 7183, v246
  v_lshrrev_b32 v247, 22, v247
  s_and_b64 s[60:61], s[60:61], s[62:63]
  v_mul_u32_u24 v248, 584, v247
  v_sub_u32 v248, v246, v248
  v_cmp_le_u32 vcc, 5256, v246
  v_and_b32 v220, 7, v248
  v_lshl_add_u32 v247, v247, 3, v220
  v_mov_b32 v220, 72
  v_cndmask_b32 v247, v247, v220, vcc
  v_lshrrev_b32 v220, 3, v248
  v_cndmask_b32 v248, v220, v248, vcc
  v_mul_u32_u24 v247, 1373568, v247
  v_mul_u32_u24 v248, 2688, v248
  v_add_u32 v220, v247, v248
  v_cndmask_b32 v220, 2.0, v220, s[60:61]
  v_add_u32 v220, 589824, v220
  v_add_u32 v220, v254, v220
  v_add_u32 v246, 16, v252
  v_lshlrev_b32 v246, 5, v246
  v_add_u32 v247, s30, v246
  v_cmp_gt_u32 s[60:61], s72, v247
  v_add_u32 v246, s29, v246
  v_cmp_gt_u32 s[62:63], s73, v246
  v_mul_u32_u24 v247, 7183, v246
  v_lshrrev_b32 v247, 22, v247
  s_and_b64 s[60:61], s[60:61], s[62:63]
  v_mul_u32_u24 v248, 584, v247
  v_sub_u32 v248, v246, v248
  v_cmp_le_u32 vcc, 5256, v246
  v_and_b32 v221, 7, v248
  v_lshl_add_u32 v247, v247, 3, v221
  v_mov_b32 v221, 72
  v_cndmask_b32 v247, v247, v221, vcc
  v_lshrrev_b32 v221, 3, v248
  v_cndmask_b32 v248, v221, v248, vcc
  v_mul_u32_u24 v247, 1373568, v247
  v_mul_u32_u24 v248, 2688, v248
  v_add_u32 v221, v247, v248
  v_cndmask_b32 v221, 2.0, v221, s[60:61]
  v_add_u32 v221, 589824, v221
  v_add_u32 v221, v254, v221
  v_add_u32 v246, 64, v220
  v_add_u32 v247, 32, v221
  v_cndmask_b32 v222, v246, v247, s[94:95]
  v_mul_u32_u24 v246, 1160, v252
  v_lshl_add_u32 v246, v251, 3, v246
  v_add_u32 v223, 39680, v246
  v_lshrrev_b32 v246, 2, v252
  v_cmp_eq_u32 s[82:83], 0, v246
  v_cmp_eq_u32 s[84:85], 1, v246
  v_cmp_eq_u32 s[86:87], 2, v246
  v_cmp_eq_u32 s[88:89], 3, v246
  v_cmp_eq_u32 s[90:91], 3, v251
  v_cmp_eq_u32 s[92:93], v246, v251
  v_and_b32 v246, 2, v252
  v_cmp_eq_u32 s[96:97], 0, v246
  v_and_b32 v239, 1, v252
  v_lshlrev_b32 v239, 4, v239
  s_add_u32 m0, s81, 0
  s_mov_b32 s98, 110592
  s_waitcnt vmcnt(23)
  ds_read_u16 v132, v231
  ds_read_u16 v133, v231 offset:32
  ds_read_u16 v245, v231 offset:64
  ds_read_u16 v231, v229
  ds_read_u16 v246, v230
  ds_read_u16 v247, v229 offset:32
  ds_read_u16 v248, v230 offset:32
  ds_read_u16 v249, v229 offset:64
  ds_read_u16 v250, v230 offset:64
  v_cndmask_b32 v230, 0, 1.0, s[90:91]
  v_cndmask_b32 v229, 0, 1.0, s[90:91]
  v_cndmask_b32 v251, 0, 1.0, s[90:91]
  buffer_store_dwordx4 v[220:223], v15, s[12:15], s77 offen offset:2048
  s_waitcnt lgkmcnt(8)
  v_lshlrev_b32 v132, v239, v132
  v_cndmask_b32 v132, 0, v132, s[92:93]
  v_cndmask_b32 v220, 0, v132, s[96:97]
  v_cndmask_b32 v221, v132, 0, s[96:97]
  s_waitcnt lgkmcnt(7)
  v_lshlrev_b32 v133, v239, v133
  v_accvgpr_write_b32 a224, v220
  v_accvgpr_write_b32 a225, v221
  v_cndmask_b32 v133, 0, v133, s[92:93]
  v_cndmask_b32 v221, 0, v133, s[96:97]
  v_cndmask_b32 v132, v133, 0, s[96:97]
  s_waitcnt lgkmcnt(6)
  v_lshlrev_b32 v245, v239, v245
  v_accvgpr_write_b32 a234, v221
  v_accvgpr_write_b32 a235, v132
  v_cndmask_b32 v245, 0, v245, s[92:93]
  v_cndmask_b32 v132, 0, v245, s[96:97]
  v_cndmask_b32 v133, v245, 0, s[96:97]
  v_accvgpr_write_b32 a244, v132
  v_accvgpr_write_b32 a245, v133
  s_waitcnt lgkmcnt(5)
  v_or_b32 v231, v231, v230
  v_cndmask_b32 v133, 0, v231, s[82:83]
  v_cndmask_b32 v132, 0, v231, s[84:85]
  v_cndmask_b32 v245, 0, v231, s[86:87]
  v_cndmask_b32 v221, 0, v231, s[88:89]
  v_accvgpr_write_b32 a216, v133
  v_accvgpr_write_b32 a217, v132
  v_accvgpr_write_b32 a218, v245
  v_accvgpr_write_b32 a219, v221
  s_waitcnt lgkmcnt(4)
  v_cndmask_b32 v132, 0, v246, s[82:83]
  v_cndmask_b32 v245, 0, v246, s[84:85]
  v_cndmask_b32 v133, 0, v246, s[86:87]
  v_cndmask_b32 v221, 0, v246, s[88:89]
  v_accvgpr_write_b32 a220, v132
  v_accvgpr_write_b32 a221, v245
  v_accvgpr_write_b32 a222, v133
  v_accvgpr_write_b32 a223, v221
  s_waitcnt lgkmcnt(3)
  v_or_b32 v247, v247, v229
  v_cndmask_b32 v133, 0, v247, s[82:83]
  v_cndmask_b32 v132, 0, v247, s[84:85]
  v_cndmask_b32 v221, 0, v247, s[86:87]
  v_cndmask_b32 v245, 0, v247, s[88:89]
  v_accvgpr_write_b32 a226, v133
  v_accvgpr_write_b32 a227, v132
  v_accvgpr_write_b32 a228, v221
  v_accvgpr_write_b32 a229, v245
  s_waitcnt lgkmcnt(2)
  v_cndmask_b32 v245, 0, v248, s[82:83]
  v_cndmask_b32 v132, 0, v248, s[84:85]
  v_cndmask_b32 v133, 0, v248, s[86:87]
  v_cndmask_b32 v221, 0, v248, s[88:89]
  v_accvgpr_write_b32 a230, v245
  v_accvgpr_write_b32 a231, v132
  v_accvgpr_write_b32 a232, v133
  v_accvgpr_write_b32 a233, v221
  s_waitcnt lgkmcnt(1)
  v_or_b32 v249, v249, v251
  v_cndmask_b32 v251, 0, v249, s[82:83]
  v_cndmask_b32 v133, 0, v249, s[84:85]
  v_cndmask_b32 v132, 0, v249, s[86:87]
  v_cndmask_b32 v221, 0, v249, s[88:89]
  v_accvgpr_write_b32 a236, v251
  v_accvgpr_write_b32 a237, v133
  v_accvgpr_write_b32 a238, v132
  v_accvgpr_write_b32 a239, v221
  s_waitcnt lgkmcnt(0)
  v_cndmask_b32 v132, 0, v250, s[82:83]
  v_cndmask_b32 v133, 0, v250, s[84:85]
  v_cndmask_b32 v221, 0, v250, s[86:87]
  v_cndmask_b32 v251, 0, v250, s[88:89]
  v_accvgpr_write_b32 a240, v132
  v_accvgpr_write_b32 a241, v133
  v_accvgpr_write_b32 a242, v221
  v_accvgpr_write_b32 a243, v251
  s_waitcnt vmcnt(19)
  v_mov_b32 v255, 0
  v_mov_b32 v225, 0
  v_mov_b32 v224, 0
  s_waitcnt vmcnt(16)
  ds_read_b64_tr_b16 a[0:1], v238
  ds_read_b64_tr_b16 a[24:25], v238 offset:32
  ds_read_b64_tr_b16 a[48:49], v238 offset:64
  ds_read_b64_tr_b16 a[2:3], v238 offset:1536
  ds_read_b64_tr_b16 a[26:27], v238 offset:1568
  ds_read_b64_tr_b16 a[50:51], v238 offset:1600
  s_waitcnt lgkmcnt(0)
  buffer_load_dwordx4 v232, s[16:19], s98 offen lds
  buffer_load_dwordx4 v233, s[16:19], s98 offen offset:1024 lds
  buffer_load_dwordx4 v234, s[16:19], s98 offen offset:2048 lds
  s_add_u32 m0, s81, 19584
  s_nop 0
  buffer_load_dwordx4 v244, s[4:7], s39 offen nt lds
  s_add_u32 m0, s81, 20448
  s_nop 0
  buffer_load_dwordx4 v244, s[4:7], s40 offen nt lds
  s_add_u32 m0, s81, 21312
  s_nop 0
  buffer_load_dwordx4 v244, s[4:7], s41 offen nt lds
  s_add_u32 m0, s81, 3072
  s_mov_b32 s98, 147456
  s_waitcnt vmcnt(16)
  ds_read_b64_tr_b16 a[16:17], v238 offset:3072
  ds_read_b64_tr_b16 a[40:41], v238 offset:3104
  ds_read_b64_tr_b16 a[64:65], v238 offset:3136
  ds_read_b64_tr_b16 a[4:5], v238 offset:4608
  ds_read_b64_tr_b16 a[28:29], v238 offset:4640
  ds_read_b64_tr_b16 a[52:53], v238 offset:4672
  s_waitcnt lgkmcnt(0)
  buffer_load_dwordx4 v232, s[16:19], s98 offen lds
  buffer_load_dwordx4 v233, s[16:19], s98 offen offset:1024 lds
  buffer_load_dwordx4 v234, s[16:19], s98 offen offset:2048 lds
  s_add_u32 m0, s81, 22176
  s_nop 0
  buffer_load_dwordx4 v244, s[4:7], s42 offen nt lds
  s_add_u32 m0, s81, 23040
  s_nop 0
  buffer_load_dwordx4 v244, s[4:7], s43 offen nt lds
  s_add_u32 m0, s81, 23904
  s_nop 0
  buffer_load_dwordx4 v244, s[4:7], s44 offen nt lds
  s_add_u32 m0, s81, 6144
  s_mov_b32 s98, 184320
  s_waitcnt vmcnt(16)
  ds_read_b64_tr_b16 a[6:7], v238 offset:6144
  ds_read_b64_tr_b16 a[30:31], v238 offset:6176
  ds_read_b64_tr_b16 a[54:55], v238 offset:6208
  ds_read_b64_tr_b16 a[18:19], v238 offset:7680
  ds_read_b64_tr_b16 a[42:43], v238 offset:7712
  ds_read_b64_tr_b16 a[66:67], v238 offset:7744
  s_waitcnt lgkmcnt(0)
  buffer_load_dwordx4 v232, s[16:19], s98 offen lds
  buffer_load_dwordx4 v233, s[16:19], s98 offen offset:1024 lds
  buffer_load_dwordx4 v234, s[16:19], s98 offen offset:2048 lds
  s_add_u32 m0, s81, 24768
  s_nop 0
  buffer_load_dwordx4 v244, s[4:7], s45 offen nt lds
  s_add_u32 m0, s81, 25632
  s_nop 0
  buffer_load_dwordx4 v244, s[4:7], s46 offen nt lds
  s_add_u32 m0, s81, 26496
  s_nop 0
  buffer_load_dwordx4 v244, s[4:7], s47 offen nt lds
  s_add_u32 m0, s81, 0
  s_mov_b32 s98, 384
  s_waitcnt vmcnt(15)
  ds_read_b64_tr_b16 a[8:9], v238
  ds_read_b64_tr_b16 a[32:33], v238 offset:32
  ds_read_b64_tr_b16 a[56:57], v238 offset:64
  ds_read_b64_tr_b16 a[10:11], v238 offset:1536
  ds_read_b64_tr_b16 a[34:35], v238 offset:1568
  ds_read_b64_tr_b16 a[58:59], v238 offset:1600
  s_waitcnt lgkmcnt(0)
  buffer_load_dwordx4 v232, s[16:19], s98 offen lds
  buffer_load_dwordx4 v233, s[16:19], s98 offen offset:1024 lds
  buffer_load_dwordx4 v234, s[16:19], s98 offen offset:2048 lds
  s_lshl_b32 s60, s31, 5
  s_add_u32 s61, s60, s30
  s_add_u32 s60, s60, s29
  s_mul_i32 s62, s60, 7183
  s_lshr_b32 s62, s62, 22
  s_mul_i32 s63, s62, 584
  s_sub_u32 s63, s60, s63
  s_lshr_b32 s64, s63, 3
  s_and_b32 s65, s63, 7
  s_lshl_b32 s66, s62, 3
  s_add_u32 s65, s65, s66
  s_cmp_ge_u32 s60, 5256
  s_cselect_b32 s64, s63, s64
  s_cselect_b32 s65, 72, s65
  s_mul_i32 s66, s65, 1373568
  s_mul_i32 s67, s64, 2688
  s_add_u32 s35, s66, s67
  s_cmp_ge_u32 s61, 667
  s_cselect_b32 s35, 268435456, s35
  s_cmp_ge_u32 s60, 5329
  s_cselect_b32 s35, 268435456, s35
  s_cmp_eq_u32 s65, 0
  s_cselect_b32 s36, 268435456, s35
  s_add_u32 s37, s35, 195360
  s_add_u32 s38, s35, 390720
  s_add_u32 s39, s35, 586080
  s_add_u32 s40, s35, 781440
  s_add_u32 s41, s35, 981120
  s_add_u32 s42, s35, 1176480
  s_add_u32 s43, s35, 1371840
  s_add_u32 s44, s35, 1567200
  s_cmp_eq_u32 s64, 0
  s_cselect_b64 s[52:53], s[48:49], 0
  s_cmp_eq_u32 s64, 72
  s_cselect_b64 s[52:53], s[50:51], s[52:53]
  s_add_u32 s31, s31, 1
  s_mov_b32 s33, s35
  v_cndmask_b32 v176, v21, 2.0, s[52:53]
  s_mov_b32 m0, s58
  s_nop 0
  buffer_load_dwordx4 v176, s[4:7], s36 offen nt lds
  s_add_u32 m0, s81, 9216
  s_mov_b32 s98, 37248
  s_waitcnt vmcnt(13)
  ds_read_b64_tr_b16 a[20:21], v238 offset:3072
  ds_read_b64_tr_b16 a[44:45], v238 offset:3104
  ds_read_b64_tr_b16 a[68:69], v238 offset:3136
  ds_read_b64_tr_b16 a[12:13], v238 offset:4608
  ds_read_b64_tr_b16 a[36:37], v238 offset:4640
  ds_read_b64_tr_b16 a[60:61], v238 offset:4672
  s_waitcnt vmcnt(12)
  ds_read_b64 v[132:133], v228
  ds_read_b128 v[244:247], v226
  ds_read_b128 v[248:251], v226 offset:288
  ds_read_b128 v[218:221], v226 offset:576
  ds_read_b128 v[222:225], v227
  ds_read_b64 v[148:149], v228 offset:32
  ds_read_b128 v[124:127], v226 offset:32
  s_waitcnt lgkmcnt(6)
  v_mfma_f32_16x16x16_bf16 v[60:63], a[224:225], v[132:133], 0
  ds_read_b128 v[128:131], v226 offset:320
  ds_read_b128 v[132:135], v226 offset:608
  ds_read_b128 v[136:139], v227 offset:32
  ds_read_b64 v[254:255], v228 offset:64
  ds_read_b128 v[140:143], v226 offset:64
  s_waitcnt lgkmcnt(6)
  v_mfma_f32_16x16x16_bf16 v[64:67], a[234:235], v[148:149], 0
  ds_read_b128 v[144:147], v226 offset:352
  ds_read_b128 v[148:151], v226 offset:640
  ds_read_b128 v[152:155], v227 offset:64
  s_waitcnt lgkmcnt(4)
  v_mfma_f32_16x16x16_bf16 v[68:71], a[244:245], v[254:255], 0
  v_smfmac_f32_16x16x64_bf16 v[60:63], a[216:219], v[244:251], v0
  v_smfmac_f32_16x16x64_bf16 v[60:63], a[220:223], v[218:225], v0
  v_smfmac_f32_16x16x64_bf16 v[64:67], a[226:229], v[124:131], v0
  v_smfmac_f32_16x16x64_bf16 v[64:67], a[230:233], v[132:139], v0
  s_waitcnt lgkmcnt(0)
  buffer_load_dwordx4 v232, s[16:19], s98 offen lds
  v_smfmac_f32_16x16x64_bf16 v[68:71], a[236:239], v[140:147], v0
  buffer_load_dwordx4 v233, s[16:19], s98 offen offset:1024 lds
  v_smfmac_f32_16x16x64_bf16 v[68:71], a[240:243], v[148:155], v0
  buffer_load_dwordx4 v234, s[16:19], s98 offen offset:2048 lds
  s_mov_b32 m0, s58
  s_nop 0
  buffer_load_dwordx4 v176, s[4:7], s37 offen offset:864 nt lds
  s_add_u32 m0, s81, 12288
  s_mov_b32 s98, 74112
  v_mul_f32 v148, v60, v60
  v_add_f32 v224, v60, v61
  v_fmac_f32 v148, v61, v61
  v_add_f32 v224, v224, v62
  buffer_load_dwordx4 v232, s[16:19], s98 offen lds
  v_fmac_f32 v148, v62, v62
  v_add_f32 v224, v224, v63
  v_fmac_f32 v148, v63, v63
  v_add_f32 v224, v224, v64
  v_fmac_f32 v148, v64, v64
  v_add_f32 v224, v224, v65
  v_fmac_f32 v148, v65, v65
  v_add_f32 v224, v224, v66
  v_fmac_f32 v148, v66, v66
  v_add_f32 v224, v224, v67
  v_fmac_f32 v148, v67, v67
  v_add_f32 v224, v224, v68
  v_fmac_f32 v148, v68, v68
  v_add_f32 v224, v224, v69
  buffer_load_dwordx4 v233, s[16:19], s98 offen offset:1024 lds
  v_fmac_f32 v148, v69, v69
  v_add_f32 v224, v224, v70
  v_fmac_f32 v148, v70, v70
  v_add_f32 v224, v224, v71
  v_fmac_f32 v148, v71, v71
  s_nop 1
  v_permlane32_swap_b32 v224, v148
  v_add_f32 v224, v224, v148
  buffer_load_dwordx4 v234, s[16:19], s98 offen offset:2048 lds
  s_mov_b32 m0, s58
  s_nop 0
  buffer_load_dwordx4 v176, s[4:7], s38 offen offset:1728 nt lds
  s_add_u32 m0, s81, 15360
  s_mov_b32 s98, 110976
  buffer_load_dwordx4 v232, s[16:19], s98 offen lds
  buffer_load_dwordx4 v233, s[16:19], s98 offen offset:1024 lds
  buffer_load_dwordx4 v234, s[16:19], s98 offen offset:2048 lds
  s_mov_b32 m0, s58
  s_waitcnt vmcnt(18)
  ds_read_b64_tr_b16 a[14:15], v238 offset:6144
  ds_read_b64_tr_b16 a[22:23], v238 offset:7680
  ds_read_b64_tr_b16 a[38:39], v238 offset:6176
  ds_read_b64_tr_b16 a[62:63], v238 offset:6208
  ds_read_b64_tr_b16 a[46:47], v238 offset:7712
  buffer_load_dwordx4 v176, s[4:7], s39 offen offset:2592 nt lds
  ds_read_b64_tr_b16 a[70:71], v238 offset:7744
  s_add_u32 m0, s81, 18432
  s_mov_b32 s98, 147840
  buffer_load_dwordx4 v232, s[16:19], s98 offen lds
  buffer_load_dwordx4 v233, s[16:19], s98 offen offset:1024 lds
  buffer_load_dwordx4 v234, s[16:19], s98 offen offset:2048 lds
  s_mov_b32 m0, s58
  s_nop 0
  buffer_load_dwordx4 v176, s[4:7], s40 offen offset:3456 nt lds
  s_add_u32 m0, s81, 3072
  s_mov_b32 s98, 184704
  buffer_load_dwordx4 v232, s[16:19], s98 offen lds
  buffer_load_dwordx4 v233, s[16:19], s98 offen offset:1024 lds
  buffer_load_dwordx4 v234, s[16:19], s98 offen offset:2048 lds
  s_mov_b32 m0, s59
  s_nop 0
  buffer_load_dwordx4 v176, s[4:7], s41 offen nt lds
  s_add_u32 m0, s81, 6144
  s_mov_b32 s98, 768
  s_waitcnt lgkmcnt(0)
  buffer_load_dwordx4 v232, s[16:19], s98 offen lds
  buffer_load_dwordx4 v233, s[16:19], s98 offen offset:1024 lds
  s_waitcnt vmcnt(26)
  ds_read_b64 v[132:133], v228 offset:13824
  ds_read_b64 v[124:125], v228 offset:13856
  ds_read_b64 v[126:127], v228 offset:13888
  ds_read_b128 v[148:151], v226 offset:13824
  ds_read_b128 v[152:155], v226 offset:14112
  buffer_load_dwordx4 v234, s[16:19], s98 offen offset:2048 lds
  ds_read_b128 v[140:143], v226 offset:14400
  s_mov_b32 m0, s59
  ds_read_b128 v[144:147], v227 offset:13824
  s_waitcnt lgkmcnt(6)
  v_mfma_f32_16x16x16_bf16 v[72:75], a[224:225], v[132:133], 0
  ds_read_b128 v[132:135], v226 offset:13856
  s_waitcnt lgkmcnt(6)
  v_mfma_f32_16x16x16_bf16 v[76:79], a[234:235], v[124:125], 0
  ds_read_b128 v[136:139], v226 offset:14144
  s_waitcnt lgkmcnt(6)
  v_mfma_f32_16x16x16_bf16 v[80:83], a[244:245], v[126:127], 0
  ds_read_b128 v[124:127], v226 offset:14432
  buffer_load_dwordx4 v176, s[4:7], s42 offen offset:864 nt lds
  ds_read_b128 v[128:131], v227 offset:13856
  s_add_u32 m0, s81, 21504
  s_mov_b32 s98, 37632
  s_waitcnt lgkmcnt(6)
  v_smfmac_f32_16x16x64_bf16 v[72:75], a[216:219], v[148:155], v0
  ds_read_b128 v[148:151], v226 offset:13888
  ds_read_b128 v[152:155], v226 offset:14176
  s_waitcnt lgkmcnt(6)
  v_smfmac_f32_16x16x64_bf16 v[72:75], a[220:223], v[140:147], v0
  ds_read_b128 v[140:143], v226 offset:14464
  ds_read_b128 v[144:147], v227 offset:13888
  s_waitcnt lgkmcnt(6)
  v_smfmac_f32_16x16x64_bf16 v[76:79], a[226:229], v[132:139], v0
  s_waitcnt vmcnt(25)
  ds_read_b64_tr_b16 a[72:73], v238
  ds_read_b64_tr_b16 a[74:75], v238 offset:1536
  ds_read_b64_tr_b16 a[96:97], v238 offset:32
  s_waitcnt lgkmcnt(7)
  v_smfmac_f32_16x16x64_bf16 v[76:79], a[230:233], v[124:131], v0
  ds_read_b64_tr_b16 a[98:99], v238 offset:1568
  ds_read_b64_tr_b16 a[120:121], v238 offset:64
  v_mul_f32 v227, v72, v72
  v_add_f32 v226, v72, v73
  s_waitcnt lgkmcnt(7)
  v_smfmac_f32_16x16x64_bf16 v[80:83], a[236:239], v[148:155], v0
  ds_read_b64_tr_b16 a[122:123], v238 offset:1600
  v_fmac_f32 v227, v73, v73
  v_add_f32 v226, v226, v74
  v_fmac_f32 v227, v74, v74
  v_add_f32 v226, v226, v75
  s_waitcnt lgkmcnt(6)
  v_smfmac_f32_16x16x64_bf16 v[80:83], a[240:243], v[140:147], v0
  buffer_load_dwordx4 v232, s[16:19], s98 offen lds
  buffer_load_dwordx4 v233, s[16:19], s98 offen offset:1024 lds
  buffer_load_dwordx4 v234, s[16:19], s98 offen offset:2048 lds
  v_fmac_f32 v227, v75, v75
  v_add_f32 v226, v226, v76
  v_fmac_f32 v227, v76, v76
  v_add_f32 v226, v226, v77
  v_fmac_f32 v227, v77, v77
  v_add_f32 v226, v226, v78
  v_fmac_f32 v227, v78, v78
  v_add_f32 v226, v226, v79
  v_fmac_f32 v227, v79, v79
  v_add_f32 v226, v226, v80
  v_fmac_f32 v227, v80, v80
  v_add_f32 v226, v226, v81
  v_fmac_f32 v227, v81, v81
  v_add_f32 v226, v226, v82
  v_fmac_f32 v227, v82, v82
  v_add_f32 v226, v226, v83
  v_fmac_f32 v227, v83, v83
  s_mov_b32 m0, s59
  s_nop 0
  buffer_load_dwordx4 v176, s[4:7], s43 offen offset:1728 nt lds
  v_permlane32_swap_b32 v226, v227
  v_add_f32 v226, v226, v227
  s_add_u32 m0, s81, 24576
  s_mov_b32 s98, 74496
  v_permlane16_swap_b32 v224, v226
  v_add_f32 v224, v224, v226
  ds_write_b32 v107, v224 offset:2048
  buffer_load_dwordx4 v232, s[16:19], s98 offen lds
  s_waitcnt lgkmcnt(0)
  s_barrier
  buffer_load_dwordx4 v233, s[16:19], s98 offen offset:1024 lds
  s_waitcnt vmcnt(27)
  ds_read_b64_tr_b16 a[76:77], v238 offset:10752
  ds_read_b64_tr_b16 a[88:89], v238 offset:9216
  ds_read_b64_tr_b16 a[100:101], v238 offset:10784
  ds_read_b64_tr_b16 a[112:113], v238 offset:9248
  ds_read_b64_tr_b16 a[136:137], v238 offset:9280
  ds_read_b64_tr_b16 a[124:125], v238 offset:10816
  buffer_load_dwordx4 v234, s[16:19], s98 offen offset:2048 lds
  ds_read_b128 v[148:151], v15 offset:2048
  s_mov_b32 m0, s59
  ds_read_b128 v[152:155], v15 offset:3072
  buffer_load_dwordx4 v176, s[4:7], s44 offen offset:2592 nt lds
  s_add_u32 m0, s81, 0
  s_mov_b32 s98, 111360
  s_waitcnt lgkmcnt(1)
  v_add_f32 v148, v148, v149
  v_add_f32 v150, v150, v151
  v_add_f32 v148, v148, v150
  s_waitcnt lgkmcnt(0)
  v_add_f32 v152, v152, v153
  buffer_load_dwordx4 v232, s[16:19], s98 offen lds
  v_add_f32 v154, v154, v155
  v_mul_f32 v149, 0x3baaaaab, v148
  v_add_f32 v152, v152, v154
  v_fma_f32 v152, -v149, v148, v152
  v_max_f32 v152, 0, v152
  v_add_f32 v152, 0x3afba882, v152
  v_rsq_f32 v152, v152
  s_nop 0
  v_mul_f32 v152, 0x40ca568a, v152
  v_mul_f32 v153, -v149, v152
  ds_write_b64 v111, v[152:153] offset:2048
  buffer_load_dwordx4 v233, s[16:19], s98 offen offset:1024 lds
  ds_read_b64 v[226:227], v115 offset:2816
  ds_read_b64 v[224:225], v115 offset:2944
  s_waitcnt vmcnt(27)
  ds_read_b64_tr_b16 a[78:79], v238 offset:12288
  ds_read_b64_tr_b16 a[90:91], v238 offset:13824
  ds_read_b64_tr_b16 a[102:103], v238 offset:12320
  ds_read_b64_tr_b16 a[114:115], v238 offset:13856
  ds_read_b64_tr_b16 a[126:127], v238 offset:12352
  buffer_load_dwordx4 v234, s[16:19], s98 offen offset:2048 lds
  ds_read_b64_tr_b16 a[138:139], v238 offset:13888
  s_add_u32 m0, s81, 9216
  s_waitcnt lgkmcnt(7)
  v_fma_f32 v148, v60, v226, v227
  v_fma_f32 v152, v61, v226, v227
  v_cvt_pk_bf16_f32 v148, v148, v152
  v_fma_f32 v149, v62, v226, v227
  v_fma_f32 v152, v63, v226, v227
  v_cvt_pk_bf16_f32 v149, v149, v152
  v_fma_f32 v150, v64, v226, v227
  v_fma_f32 v152, v65, v226, v227
  v_cvt_pk_bf16_f32 v150, v150, v152
  v_fma_f32 v151, v66, v226, v227
  v_fma_f32 v152, v67, v226, v227
  v_cvt_pk_bf16_f32 v151, v151, v152
  s_waitcnt lgkmcnt(6)
  v_fma_f32 v152, v72, v224, v225
  v_fma_f32 v176, v73, v224, v225
  v_cvt_pk_bf16_f32 v152, v152, v176
  v_fma_f32 v153, v74, v224, v225
  v_fma_f32 v176, v75, v224, v225
  v_cvt_pk_bf16_f32 v153, v153, v176
  v_fma_f32 v154, v76, v224, v225
  v_fma_f32 v176, v77, v224, v225
  v_cvt_pk_bf16_f32 v154, v154, v176
  v_fma_f32 v155, v78, v224, v225
  v_fma_f32 v176, v79, v224, v225
  v_cvt_pk_bf16_f32 v155, v155, v176
  s_mov_b32 s98, 148224
  buffer_load_dwordx4 v232, s[16:19], s98 offen lds
  buffer_load_dwordx4 v233, s[16:19], s98 offen offset:1024 lds
  ds_write_b128 v16, v[148:151] offset:8192
  v_fma_f32 v148, v68, v226, v227
  ds_write_b128 v16, v[152:155] offset:14336
  v_fma_f32 v176, v69, v226, v227
  buffer_load_dwordx4 v234, s[16:19], s98 offen offset:2048 lds
  v_cvt_pk_bf16_f32 v148, v148, v176
  v_fma_f32 v149, v70, v226, v227
  v_fma_f32 v176, v71, v226, v227
  v_cvt_pk_bf16_f32 v149, v149, v176
  v_fma_f32 v226, v80, v224, v225
  v_fma_f32 v176, v81, v224, v225
  v_cvt_pk_bf16_f32 v226, v226, v176
  v_fma_f32 v227, v82, v224, v225
  v_fma_f32 v176, v83, v224, v225
  v_cvt_pk_bf16_f32 v227, v227, v176
  s_add_u32 m0, s81, 12288
  s_mov_b32 s98, 185088
  s_waitcnt lgkmcnt(2)
  s_waitcnt vmcnt(27)
  ds_read_b64_tr_b16 a[80:81], v238 offset:15360
  buffer_load_dwordx4 v232, s[16:19], s98 offen lds
  ds_read_b64_tr_b16 a[82:83], v238 offset:16896
  ds_read_b64_tr_b16 a[104:105], v238 offset:15392
  ds_read_b64_tr_b16 a[106:107], v238 offset:16928
  ds_read_b64_tr_b16 a[128:129], v238 offset:15424
  ds_read_b64_tr_b16 a[130:131], v238 offset:16960
  ds_write_b64 v17, v[148:149] offset:8192
  buffer_load_dwordx4 v233, s[16:19], s98 offen offset:1024 lds
  ds_write_b64 v17, v[226:227] offset:14336
  buffer_load_dwordx4 v234, s[16:19], s98 offen offset:2048 lds
  s_add_u32 m0, s81, 15360
  s_mov_b32 s98, 0
  s_waitcnt lgkmcnt(2)
  s_waitcnt lgkmcnt(0)
  s_barrier
  ds_read_b128 v[224:227], v15 offset:8192
  ds_read_b128 v[176:179], v15 offset:9216
  buffer_load_dwordx4 v235, s[20:23], s98 offen lds
  ds_read_b128 v[180:183], v15 offset:10240
  ds_read_b128 v[184:187], v15 offset:11264
  ds_read_b128 v[188:191], v15 offset:12288
  ds_read_b128 v[192:195], v15 offset:13312
  s_waitcnt lgkmcnt(5)
  v_mfma_f32_16x16x32_bf16 v[154:157], a[0:3], v[224:227], 0
  buffer_load_dwordx4 v236, s[20:23], s98 offen offset:1024 lds
  s_waitcnt lgkmcnt(4)
  v_mfma_f32_16x16x32_bf16 v[154:157], a[4:7], v[176:179], v[154:157]
  s_waitcnt lgkmcnt(3)
  v_mfma_f32_16x16x32_bf16 v[154:157], a[8:11], v[180:183], v[154:157]
  s_waitcnt vmcnt(28)
  ds_read_b64_tr_b16 a[84:85], v238 offset:19968
  s_waitcnt lgkmcnt(3)
  v_mfma_f32_16x16x32_bf16 v[154:157], a[12:15], v[184:187], v[154:157]
  ds_read_b64_tr_b16 a[92:93], v238 offset:18432
  s_waitcnt lgkmcnt(3)
  v_mfma_f32_16x16x32_bf16 v[154:157], a[16:19], v[188:191], v[154:157]
  ds_read_b64_tr_b16 a[108:109], v238 offset:20000
  s_waitcnt lgkmcnt(3)
  v_mfma_f32_16x16x32_bf16 v[154:157], a[20:23], v[192:195], v[154:157]
  buffer_load_dwordx4 v237, s[20:23], s98 offen offset:2048 lds
  v_mfma_f32_16x16x32_bf16 v[158:161], a[24:27], v[224:227], 0
  s_add_u32 m0, s81, 18432
  ds_read_b64_tr_b16 a[116:117], v238 offset:18464
  ds_read_b64_tr_b16 a[132:133], v238 offset:20032
  v_mfma_f32_16x16x32_bf16 v[158:161], a[28:31], v[176:179], v[158:161]
  s_mov_b32 s98, 12288
  ds_read_b64_tr_b16 a[140:141], v238 offset:18496
  ds_read_b128 v[196:199], v15 offset:14336
  v_mfma_f32_16x16x32_bf16 v[158:161], a[32:35], v[180:183], v[158:161]
  ds_read_b128 v[200:203], v15 offset:15360
  v_cvt_pk_bf16_f32 v148, v154, v155
  v_mfma_f32_16x16x32_bf16 v[158:161], a[36:39], v[184:187], v[158:161]
  ds_read_b128 v[204:207], v15 offset:16384
  v_cvt_pk_bf16_f32 v149, v156, v157
  v_mfma_f32_16x16x32_bf16 v[158:161], a[40:43], v[188:191], v[158:161]
  ds_read_b128 v[208:211], v15 offset:17408
  v_mfma_f32_16x16x32_bf16 v[158:161], a[44:47], v[192:195], v[158:161]
  ds_read_b128 v[212:215], v15 offset:18432
  v_mfma_f32_16x16x32_bf16 v[154:157], a[48:51], v[224:227], 0
  ds_read_b128 v[216:219], v15 offset:19456
  v_mfma_f32_16x16x32_bf16 v[154:157], a[52:55], v[176:179], v[154:157]
  s_waitcnt lgkmcnt(6)
  buffer_load_dwordx4 v235, s[20:23], s98 offen lds
  v_mfma_f32_16x16x32_bf16 v[154:157], a[56:59], v[180:183], v[154:157]
  buffer_load_dwordx4 v236, s[20:23], s98 offen offset:1024 lds
  v_mfma_f32_16x16x32_bf16 v[154:157], a[60:63], v[184:187], v[154:157]
  v_cvt_pk_bf16_f32 v150, v158, v159
  v_cvt_pk_bf16_f32 v151, v160, v161
  v_mfma_f32_16x16x32_bf16 v[154:157], a[64:67], v[188:191], v[154:157]
  v_mfma_f32_16x16x32_bf16 v[154:157], a[68:71], v[192:195], v[154:157]
  s_waitcnt lgkmcnt(5)
  buffer_load_dwordx4 v237, s[20:23], s98 offen offset:2048 lds
  v_mfma_f32_16x16x32_bf16 v[160:163], a[0:3], v[196:199], 0
  s_waitcnt lgkmcnt(4)
  v_mfma_f32_16x16x32_bf16 v[160:163], a[4:7], v[200:203], v[160:163]
  s_waitcnt lgkmcnt(3)
  v_cvt_pk_bf16_f32 v152, v154, v155
  v_cvt_pk_bf16_f32 v153, v156, v157
  v_mfma_f32_16x16x32_bf16 v[160:163], a[8:11], v[204:207], v[160:163]
  s_waitcnt lgkmcnt(2)
  v_mfma_f32_16x16x32_bf16 v[160:163], a[12:15], v[208:211], v[160:163]
  s_waitcnt lgkmcnt(1)
  v_mfma_f32_16x16x32_bf16 v[160:163], a[16:19], v[212:215], v[160:163]
  s_waitcnt vmcnt(28) lgkmcnt(0)
  ds_read_b64_tr_b16 a[86:87], v238 offset:3072
  ds_read_b64_tr_b16 a[94:95], v238 offset:4608
  v_mfma_f32_16x16x32_bf16 v[160:163], a[20:23], v[216:219], v[160:163]
  s_add_u32 m0, s81, 3072
  ds_read_b64_tr_b16 a[110:111], v238 offset:3104
  ds_read_b64_tr_b16 a[118:119], v238 offset:4640
  v_mfma_f32_16x16x32_bf16 v[230:233], a[24:27], v[196:199], 0
  s_mov_b32 s98, 24576
  ds_read_b64_tr_b16 a[134:135], v238 offset:3136
  v_mfma_f32_16x16x32_bf16 v[230:233], a[28:31], v[200:203], v[230:233]
  ds_read_b64_tr_b16 a[142:143], v238 offset:4672
  v_cvt_pk_bf16_f32 v154, v160, v161
  v_mfma_f32_16x16x32_bf16 v[230:233], a[32:35], v[204:207], v[230:233]
  v_cvt_pk_bf16_f32 v155, v162, v163
  v_mfma_f32_16x16x32_bf16 v[230:233], a[36:39], v[208:211], v[230:233]
  v_mfma_f32_16x16x32_bf16 v[230:233], a[40:43], v[212:215], v[230:233]
  v_mfma_f32_16x16x32_bf16 v[230:233], a[44:47], v[216:219], v[230:233]
  v_mfma_f32_16x16x32_bf16 v[160:163], a[48:51], v[196:199], 0
  v_mfma_f32_16x16x32_bf16 v[160:163], a[52:55], v[200:203], v[160:163]
  s_waitcnt lgkmcnt(0)
  buffer_load_dwordx4 v235, s[20:23], s98 offen lds
  v_mfma_f32_16x16x32_bf16 v[160:163], a[56:59], v[204:207], v[160:163]
  buffer_load_dwordx4 v236, s[20:23], s98 offen offset:1024 lds
  v_mfma_f32_16x16x32_bf16 v[160:163], a[60:63], v[208:211], v[160:163]
  buffer_load_dwordx4 v237, s[20:23], s98 offen offset:2048 lds
  v_mfma_f32_16x16x32_bf16 v[160:163], a[64:67], v[212:215], v[160:163]
  s_add_u32 m0, s81, 6144
  v_cvt_pk_bf16_f32 v156, v230, v231
  v_cvt_pk_bf16_f32 v157, v232, v233
  v_mfma_f32_16x16x32_bf16 v[160:163], a[68:71], v[216:219], v[160:163]
  s_mov_b32 s98, 36864
  v_mfma_f32_16x16x32_bf16 v[230:233], a[72:75], v[224:227], 0
  v_mfma_f32_16x16x32_bf16 v[230:233], a[76:79], v[176:179], v[230:233]
  v_cvt_pk_bf16_f32 v158, v160, v161
  v_cvt_pk_bf16_f32 v159, v162, v163
  v_mfma_f32_16x16x32_bf16 v[230:233], a[80:83], v[180:183], v[230:233]
  v_mfma_f32_16x16x32_bf16 v[230:233], a[84:87], v[184:187], v[230:233]
  v_mfma_f32_16x16x32_bf16 v[230:233], a[88:91], v[188:191], v[230:233]
  v_mfma_f32_16x16x32_bf16 v[230:233], a[92:95], v[192:195], v[230:233]
  v_mfma_f32_16x16x32_bf16 v[168:171], a[96:99], v[224:227], 0
  v_mfma_f32_16x16x32_bf16 v[168:171], a[100:103], v[176:179], v[168:171]
  s_waitcnt vmcnt(27)
  ds_read_b64_tr_b16 a[144:145], v238 offset:6144
  ds_read_b64_tr_b16 a[168:169], v238 offset:6176
  v_mfma_f32_16x16x32_bf16 v[168:171], a[104:107], v[180:183], v[168:171]
  ds_read_b64_tr_b16 a[192:193], v238 offset:6208
  ds_read_b64_tr_b16 a[146:147], v238 offset:7680
  v_mfma_f32_16x16x32_bf16 v[168:171], a[108:111], v[184:187], v[168:171]
  ds_read_b64_tr_b16 a[170:171], v238 offset:7712
  v_cvt_pk_bf16_f32 v160, v230, v231
  v_mfma_f32_16x16x32_bf16 v[168:171], a[112:115], v[188:191], v[168:171]
  ds_read_b64_tr_b16 a[194:195], v238 offset:7744
  v_cvt_pk_bf16_f32 v161, v232, v233
  v_mfma_f32_16x16x32_bf16 v[168:171], a[116:119], v[192:195], v[168:171]
  v_mfma_f32_16x16x32_bf16 v[230:233], a[120:123], v[224:227], 0
  buffer_store_dwordx4 v[60:63], v15, s[12:15], s75 offen
  s_nop 2
  v_cvt_pk_bf16_f32 v162, v168, v169
  v_mfma_f32_16x16x32_bf16 v[230:233], a[124:127], v[176:179], v[230:233]
  v_cvt_pk_bf16_f32 v163, v170, v171
  v_mfma_f32_16x16x32_bf16 v[230:233], a[128:131], v[180:183], v[230:233]
  v_mfma_f32_16x16x32_bf16 v[230:233], a[132:135], v[184:187], v[230:233]
  v_mfma_f32_16x16x32_bf16 v[230:233], a[136:139], v[188:191], v[230:233]
  s_waitcnt lgkmcnt(0)
  buffer_load_dwordx4 v235, s[20:23], s98 offen lds
  v_mfma_f32_16x16x32_bf16 v[230:233], a[140:143], v[192:195], v[230:233]
  buffer_load_dwordx4 v236, s[20:23], s98 offen offset:1024 lds
  v_mfma_f32_16x16x32_bf16 v[124:127], a[72:75], v[196:199], 0
  buffer_load_dwordx4 v237, s[20:23], s98 offen offset:2048 lds
  v_mfma_f32_16x16x32_bf16 v[124:127], a[76:79], v[200:203], v[124:127]
  s_add_u32 m0, s81, 21504
  v_cvt_pk_bf16_f32 v164, v230, v231
  v_cvt_pk_bf16_f32 v165, v232, v233
  v_mfma_f32_16x16x32_bf16 v[124:127], a[80:83], v[204:207], v[124:127]
  s_mov_b32 s98, 49152
  v_mfma_f32_16x16x32_bf16 v[124:127], a[84:87], v[208:211], v[124:127]
  v_mfma_f32_16x16x32_bf16 v[124:127], a[88:91], v[212:215], v[124:127]
  v_mfma_f32_16x16x32_bf16 v[124:127], a[92:95], v[216:219], v[124:127]
  v_mfma_f32_16x16x32_bf16 v[230:233], a[96:99], v[196:199], 0
  v_mfma_f32_16x16x32_bf16 v[230:233], a[100:103], v[200:203], v[230:233]
  v_cvt_pk_bf16_f32 v168, v124, v125
  v_cvt_pk_bf16_f32 v169, v126, v127
  v_mfma_f32_16x16x32_bf16 v[230:233], a[104:107], v[204:207], v[230:233]
  v_mfma_f32_16x16x32_bf16 v[230:233], a[108:111], v[208:211], v[230:233]
  s_waitcnt vmcnt(27)
  ds_read_b64_tr_b16 a[160:161], v238 offset:21504
  ds_read_b64_tr_b16 a[184:185], v238 offset:21536
  v_mfma_f32_16x16x32_bf16 v[230:233], a[112:115], v[212:215], v[230:233]
  ds_read_b64_tr_b16 a[208:209], v238 offset:21568
  ds_read_b64_tr_b16 a[148:149], v238 offset:23040
  v_mfma_f32_16x16x32_bf16 v[230:233], a[116:119], v[216:219], v[230:233]
  ds_read_b64_tr_b16 a[172:173], v238 offset:23072
  v_mfma_f32_16x16x32_bf16 v[124:127], a[120:123], v[196:199], 0
  ds_read_b64_tr_b16 a[196:197], v238 offset:23104
  v_mfma_f32_16x16x32_bf16 v[124:127], a[124:127], v[200:203], v[124:127]
  buffer_store_dwordx4 v[64:67], v15, s[12:15], s75 offen offset:1024
  v_cvt_pk_bf16_f32 v170, v230, v231
  v_mfma_f32_16x16x32_bf16 v[124:127], a[128:131], v[204:207], v[124:127]
  v_cvt_pk_bf16_f32 v171, v232, v233
  v_mfma_f32_16x16x32_bf16 v[124:127], a[132:135], v[208:211], v[124:127]
  v_mfma_f32_16x16x32_bf16 v[124:127], a[136:139], v[212:215], v[124:127]
  v_mfma_f32_16x16x32_bf16 v[124:127], a[140:143], v[216:219], v[124:127]
  s_waitcnt lgkmcnt(0)
  buffer_load_dwordx4 v235, s[20:23], s98 offen lds
  buffer_load_dwordx4 v236, s[20:23], s98 offen offset:1024 lds
  buffer_load_dwordx4 v237, s[20:23], s98 offen offset:2048 lds
  s_nop 3
  v_cvt_pk_bf16_f32 v172, v124, v125
  v_cvt_pk_bf16_f32 v173, v126, v127
  s_add_u32 m0, s81, 24576
  s_mov_b32 s98, 61440
  s_waitcnt vmcnt(27)
  ds_read_b64_tr_b16 a[150:151], v238 offset:24576
  ds_read_b64_tr_b16 a[174:175], v238 offset:24608
  ds_read_b64_tr_b16 a[198:199], v238 offset:24640
  ds_read_b64_tr_b16 a[162:163], v238 offset:26112
  ds_read_b64_tr_b16 a[186:187], v238 offset:26144
  ds_read_b64_tr_b16 a[210:211], v238 offset:26176
  buffer_store_dwordx4 v[68:71], v15, s[12:15], s75 offen offset:2048
  s_waitcnt vmcnt(27)
  ds_read_b64 v[132:133], v9
  ds_read_b64 v[140:141], v9 offset:32
  ds_read_b64 v[142:143], v9 offset:64
  s_waitcnt lgkmcnt(3)
  buffer_load_dwordx4 v235, s[20:23], s98 offen lds
  buffer_load_dwordx4 v236, s[20:23], s98 offen offset:1024 lds
  buffer_load_dwordx4 v237, s[20:23], s98 offen offset:2048 lds
  ds_read_b128 v[230:233], v3
  ds_read_b128 v[234:237], v3 offset:864
  s_lshl_b32 s60, s31, 5
  ds_read_b128 v[124:127], v3 offset:1728
  s_add_u32 s61, s60, s30
  s_add_u32 s60, s60, s29
  s_mul_i32 s62, s60, 7183
  ds_read_b128 v[128:131], v6
  s_waitcnt lgkmcnt(6)
  v_mfma_f32_16x16x16_bf16 v[24:27], a[224:225], v[132:133], 0
  s_lshr_b32 s62, s62, 22
  ds_read_b128 v[132:135], v3 offset:32
  s_waitcnt lgkmcnt(6)
  v_mfma_f32_16x16x16_bf16 v[28:31], a[234:235], v[140:141], 0
  s_mul_i32 s63, s62, 584
  ds_read_b128 v[136:139], v3 offset:896
  s_waitcnt lgkmcnt(6)
  v_mfma_f32_16x16x16_bf16 v[32:35], a[244:245], v[142:143], 0
  s_sub_u32 s63, s60, s63
  ds_read_b128 v[140:143], v3 offset:1760
  s_lshr_b32 s64, s63, 3
  s_and_b32 s65, s63, 7
  s_lshl_b32 s66, s62, 3
  ds_read_b128 v[144:147], v6 offset:32
  s_add_u32 s65, s65, s66
  s_cmp_ge_u32 s60, 5256
  s_waitcnt lgkmcnt(6)
  v_smfmac_f32_16x16x64_bf16 v[24:27], a[216:219], v[230:237], v0
  s_cselect_b32 s64, s63, s64
  ds_read_b128 v[230:233], v3 offset:64
  s_cselect_b32 s65, 72, s65
  ds_read_b128 v[234:237], v3 offset:928
  s_mul_i32 s66, s65, 1373568
  s_mul_i32 s67, s64, 2688
  s_waitcnt lgkmcnt(6)
  v_smfmac_f32_16x16x64_bf16 v[24:27], a[220:223], v[124:131], v0
  s_add_u32 s35, s66, s67
  ds_read_b128 v[124:127], v3 offset:1792
  s_cmp_ge_u32 s61, 667
  ds_read_b128 v[128:131], v6 offset:64
  s_cselect_b32 s35, 268435456, s35
  s_cmp_ge_u32 s60, 5329
  s_waitcnt lgkmcnt(6)
  v_smfmac_f32_16x16x64_bf16 v[28:31], a[226:229], v[132:139], v0
  s_waitcnt vmcnt(27)
  ds_read_b64_tr_b16 a[152:153], v238
  ds_read_b64_tr_b16 a[154:155], v238 offset:1536
  s_cselect_b32 s35, 268435456, s35
  s_cmp_eq_u32 s65, 0
  ds_read_b64_tr_b16 a[176:177], v238 offset:32
  s_waitcnt lgkmcnt(7)
  v_smfmac_f32_16x16x64_bf16 v[28:31], a[230:233], v[140:147], v0
  s_cselect_b32 s36, 268435456, s35
  ds_read_b64_tr_b16 a[178:179], v238 offset:1568
  s_add_u32 s37, s35, 195360
  ds_read_b64_tr_b16 a[200:201], v238 offset:64
  v_mul_f32 v248, v24, v24
  v_add_f32 v249, v24, v25
  s_waitcnt lgkmcnt(7)
  v_smfmac_f32_16x16x64_bf16 v[32:35], a[236:239], v[230:237], v0
  s_add_u32 s38, s35, 390720
  ds_read_b64_tr_b16 a[202:203], v238 offset:1600
  ds_read_b64 v[140:141], v10
  s_add_u32 s39, s35, 586080
  s_add_u32 s40, s35, 781440
  ds_read_b64 v[132:133], v10 offset:32
  s_waitcnt lgkmcnt(8)
  v_smfmac_f32_16x16x64_bf16 v[32:35], a[240:243], v[124:131], v0
  s_add_u32 s41, s35, 981120
  ds_read_b64 v[134:135], v10 offset:64
  v_fmac_f32 v248, v25, v25
  s_add_u32 s42, s35, 1176480
  s_add_u32 s43, s35, 1371840
  ds_read_b128 v[124:127], v4
  v_add_f32 v249, v249, v26
  s_add_u32 s44, s35, 1567200
  s_cmp_eq_u32 s64, 0
  ds_read_b128 v[128:131], v4 offset:864
  v_fmac_f32 v248, v26, v26
  s_cselect_b64 s[52:53], s[48:49], 0
  s_cmp_eq_u32 s64, 72
  ds_read_b128 v[230:233], v4 offset:1728
  v_add_f32 v249, v249, v27
  s_cselect_b64 s[52:53], s[50:51], s[52:53]
  s_add_u32 s31, s31, 1
  v_cndmask_b32 v239, v21, 2.0, s[52:53]
  v_fmac_f32 v248, v27, v27
  v_add_f32 v249, v249, v28
  s_waitcnt lgkmcnt(5)
  v_mfma_f32_16x16x16_bf16 v[36:39], a[224:225], v[140:141], 0
  ds_read_b128 v[234:237], v7
  ds_read_b128 v[140:143], v4 offset:32
  s_waitcnt lgkmcnt(6)
  v_mfma_f32_16x16x16_bf16 v[40:43], a[234:235], v[132:133], 0
  ds_read_b128 v[144:147], v4 offset:896
  v_fmac_f32 v248, v28, v28
  s_waitcnt lgkmcnt(6)
  v_mfma_f32_16x16x16_bf16 v[44:47], a[244:245], v[134:135], 0
  ds_read_b128 v[132:135], v4 offset:1760
  s_mov_b32 m0, s58
  ds_read_b128 v[136:139], v7 offset:32
  v_add_f32 v249, v249, v29
  v_fmac_f32 v248, v29, v29
  s_waitcnt lgkmcnt(6)
  v_smfmac_f32_16x16x64_bf16 v[36:39], a[216:219], v[124:131], v0
  s_waitcnt vmcnt(24)
  ds_read_b64_tr_b16 a[156:157], v238 offset:10752
  ds_read_b64_tr_b16 a[164:165], v238 offset:9216
  ds_read_b64_tr_b16 a[180:181], v238 offset:10784
  s_waitcnt lgkmcnt(7)
  v_smfmac_f32_16x16x64_bf16 v[36:39], a[220:223], v[230:237], v0
  ds_read_b64_tr_b16 a[188:189], v238 offset:9248
  ds_read_b64_tr_b16 a[204:205], v238 offset:10816
  v_add_f32 v249, v249, v30
  v_fmac_f32 v248, v30, v30
  s_waitcnt lgkmcnt(7)
  v_smfmac_f32_16x16x64_bf16 v[40:43], a[226:229], v[140:147], v0
  ds_read_b64_tr_b16 a[212:213], v238 offset:9280
  ds_read_b128 v[140:143], v4 offset:64
  ds_read_b128 v[144:147], v4 offset:928
  s_waitcnt lgkmcnt(8)
  v_smfmac_f32_16x16x64_bf16 v[40:43], a[230:233], v[132:139], v0
  ds_read_b128 v[132:135], v4 offset:1792
  v_mul_f32 v220, v36, v36
  ds_read_b128 v[136:139], v7 offset:64
  v_add_f32 v221, v36, v37
  ds_read_b64 v[124:125], v11
  v_fmac_f32 v220, v37, v37
  ds_read_b64 v[126:127], v11 offset:32
  v_add_f32 v221, v221, v38
  ds_read_b64 v[128:129], v11 offset:64
  v_fmac_f32 v220, v38, v38
  ds_read_b128 v[230:233], v5
  v_add_f32 v221, v221, v39
  v_fmac_f32 v220, v39, v39
  s_waitcnt lgkmcnt(6)
  v_smfmac_f32_16x16x64_bf16 v[44:47], a[236:239], v[140:147], v0
  s_waitcnt vmcnt(21)
  ds_read_b64_tr_b16 a[158:159], v238 offset:12288
  ds_read_b64_tr_b16 a[166:167], v238 offset:13824
  ds_read_b64_tr_b16 a[182:183], v238 offset:12320
  s_waitcnt lgkmcnt(7)
  v_smfmac_f32_16x16x64_bf16 v[44:47], a[240:243], v[132:139], v0
  ds_read_b64_tr_b16 a[190:191], v238 offset:13856
  v_add_f32 v221, v221, v40
  s_waitcnt lgkmcnt(7)
  v_mfma_f32_16x16x16_bf16 v[48:51], a[224:225], v[124:125], 0
  ds_read_b64_tr_b16 a[206:207], v238 offset:12352
  ds_read_b64_tr_b16 a[214:215], v238 offset:13888
  s_waitcnt lgkmcnt(8)
  v_mfma_f32_16x16x16_bf16 v[52:55], a[234:235], v[126:127], 0
  ds_read_b128 v[234:237], v5 offset:864
  v_fmac_f32 v220, v40, v40
  s_waitcnt lgkmcnt(8)
  v_mfma_f32_16x16x16_bf16 v[56:59], a[244:245], v[128:129], 0
  ds_read_b128 v[132:135], v5 offset:1728
  v_add_f32 v221, v221, v41
  ds_read_b128 v[136:139], v8
  v_fmac_f32 v220, v41, v41
  ds_read_b128 v[140:143], v5 offset:32
  v_add_f32 v221, v221, v42
  ds_read_b128 v[144:147], v5 offset:896
  v_fmac_f32 v220, v42, v42
  ds_read_b128 v[124:127], v5 offset:1760
  v_add_f32 v249, v249, v31
  ds_read_b128 v[128:131], v8 offset:32
  v_fmac_f32 v248, v31, v31
  v_add_f32 v221, v221, v43
  s_waitcnt lgkmcnt(6)
  v_smfmac_f32_16x16x64_bf16 v[48:51], a[216:219], v[230:237], v0
  s_waitcnt vmcnt(18)
  ds_read_b64_tr_b16 a[250:251], v238 offset:15360
  ds_read_b64_tr_b16 v[96:97], v238 offset:15392
  ds_read_b64_tr_b16 v[100:101], v238 offset:15424
  s_waitcnt lgkmcnt(7)
  v_smfmac_f32_16x16x64_bf16 v[48:51], a[220:223], v[132:139], v0
  ds_read_b64_tr_b16 a[252:253], v238 offset:16896
  ds_read_b64_tr_b16 v[98:99], v238 offset:16928
  v_fmac_f32 v220, v43, v43
  v_add_f32 v249, v249, v32
  s_waitcnt lgkmcnt(7)
  v_smfmac_f32_16x16x64_bf16 v[52:55], a[226:229], v[140:147], v0
  ds_read_b64_tr_b16 v[102:103], v238 offset:16960
  ds_read_b128 v[140:143], v5 offset:64
  ds_read_b128 v[144:147], v5 offset:928
  s_waitcnt lgkmcnt(8)
  v_smfmac_f32_16x16x64_bf16 v[52:55], a[230:233], v[124:131], v0
  ds_read_b128 v[124:127], v5 offset:1792
  v_mul_f32 v236, v48, v48
  ds_read_b128 v[128:131], v8 offset:64
  v_add_f32 v237, v48, v49
  v_fmac_f32 v236, v49, v49
  v_add_f32 v237, v237, v50
  v_fmac_f32 v236, v50, v50
  v_add_f32 v237, v237, v51
  v_fmac_f32 v236, v51, v51
  v_add_f32 v237, v237, v52
  v_fmac_f32 v236, v52, v52
  v_add_f32 v237, v237, v53
  v_fmac_f32 v236, v53, v53
  v_add_f32 v237, v237, v54
  v_fmac_f32 v236, v54, v54
  v_add_f32 v237, v237, v55
  v_fmac_f32 v236, v55, v55
  v_fmac_f32 v248, v32, v32
  v_add_f32 v221, v221, v44
  v_fmac_f32 v220, v44, v44
  v_add_f32 v249, v249, v33
  s_waitcnt lgkmcnt(2)
  v_smfmac_f32_16x16x64_bf16 v[56:59], a[236:239], v[140:147], v0
  v_fmac_f32 v248, v33, v33
  v_add_f32 v221, v221, v45
  v_fmac_f32 v220, v45, v45
  v_add_f32 v249, v249, v34
  s_waitcnt lgkmcnt(0)
  v_smfmac_f32_16x16x64_bf16 v[56:59], a[240:243], v[124:131], v0
  s_waitcnt vmcnt(15)
  buffer_load_dwordx4 v239, s[4:7], s36 offen nt lds
  v_mfma_f32_16x16x32_bf16 v[140:143], a[144:147], v[224:227], 0
  buffer_load_dwordx4 v239, s[4:7], s37 offen offset:864 nt lds
  v_mfma_f32_16x16x32_bf16 v[140:143], a[148:151], v[176:179], v[140:143]
  buffer_load_dwordx4 v239, s[4:7], s38 offen offset:1728 nt lds
  v_mfma_f32_16x16x32_bf16 v[140:143], a[152:155], v[180:183], v[140:143]
  buffer_load_dwordx4 v239, s[4:7], s39 offen offset:2592 nt lds
  v_mfma_f32_16x16x32_bf16 v[140:143], a[156:159], v[184:187], v[140:143]
  ds_read_b64_tr_b16 v[130:131], v238 offset:18496
  ds_read_b64_tr_b16 v[92:93], v238 offset:19968
  v_mfma_f32_16x16x32_bf16 v[140:143], a[160:163], v[188:191], v[140:143]
  ds_read_b64_tr_b16 v[136:137], v238 offset:20032
  ds_read_b64_tr_b16 v[60:61], v238 offset:18464
  v_mfma_f32_16x16x32_bf16 v[140:143], a[164:167], v[192:195], v[140:143]
  buffer_load_dwordx4 v239, s[4:7], s40 offen offset:3456 nt lds
  v_mfma_f32_16x16x32_bf16 v[144:147], a[168:171], v[224:227], 0
  s_mov_b32 m0, s59
  v_add_f32 v237, v237, v56
  v_fmac_f32 v236, v56, v56
  v_mfma_f32_16x16x32_bf16 v[144:147], a[172:175], v[176:179], v[144:147]
  s_mov_b32 s34, s35
  v_add_f32 v237, v237, v57
  v_fmac_f32 v236, v57, v57
  v_mfma_f32_16x16x32_bf16 v[144:147], a[176:179], v[180:183], v[144:147]
  v_add_f32 v237, v237, v58
  v_fmac_f32 v236, v58, v58
  v_mfma_f32_16x16x32_bf16 v[144:147], a[180:183], v[184:187], v[144:147]
  buffer_load_dwordx4 v239, s[4:7], s41 offen nt lds
  v_mfma_f32_16x16x32_bf16 v[144:147], a[184:187], v[188:191], v[144:147]
  v_fmac_f32 v248, v34, v34
  v_add_f32 v221, v221, v46
  v_mfma_f32_16x16x32_bf16 v[144:147], a[188:191], v[192:195], v[144:147]
  v_fmac_f32 v220, v46, v46
  v_add_f32 v237, v237, v59
  v_mfma_f32_16x16x32_bf16 v[232:235], a[192:195], v[224:227], 0
  s_waitcnt vmcnt(18)
  ds_read_b64_tr_b16 v[94:95], v238 offset:3072
  ds_read_b64_tr_b16 v[138:139], v238 offset:3136
  v_mfma_f32_16x16x32_bf16 v[232:235], a[196:199], v[176:179], v[232:235]
  ds_read_b64_tr_b16 v[132:133], v238 offset:4672
  ds_read_b64_tr_b16 v[62:63], v238 offset:4640
  v_mfma_f32_16x16x32_bf16 v[232:235], a[200:203], v[180:183], v[232:235]
  buffer_load_dwordx4 v239, s[4:7], s42 offen offset:864 nt lds
  v_mfma_f32_16x16x32_bf16 v[232:235], a[204:207], v[184:187], v[232:235]
  v_fmac_f32 v236, v59, v59
  v_add_f32 v249, v249, v35
  v_mfma_f32_16x16x32_bf16 v[232:235], a[208:211], v[188:191], v[232:235]
  v_fmac_f32 v248, v35, v35
  v_add_f32 v221, v221, v47
  v_mfma_f32_16x16x32_bf16 v[232:235], a[212:215], v[192:195], v[232:235]
  v_fmac_f32 v220, v47, v47
  v_permlane32_swap_b32 v237, v236
  buffer_load_dwordx4 v239, s[4:7], s43 offen offset:1728 nt lds
  v_permlane32_swap_b32 v249, v248
  v_permlane32_swap_b32 v221, v220
  v_add_f32 v237, v237, v236
  v_add_f32 v249, v249, v248
  v_add_f32 v221, v221, v220
  v_mov_b32 v176, v237
  v_cvt_pk_bf16_f32 v124, v140, v141
  v_permlane16_swap_b32 v249, v221
  v_permlane16_swap_b32 v237, v176
  buffer_load_dwordx4 v239, s[4:7], s44 offen offset:2592 nt lds
  v_add_f32 v249, v249, v221
  v_add_f32 v237, v237, v176
  s_lshl_b32 s60, s31, 5
  s_add_u32 s61, s60, s30
  ds_write_b32 v107, v249
  ds_write_b32 v107, v237 offset:512
  v_cvt_pk_bf16_f32 v125, v142, v143
  v_cvt_pk_bf16_f32 v126, v144, v145
  v_cvt_pk_bf16_f32 v127, v146, v147
  v_cvt_pk_bf16_f32 v128, v232, v233
  v_cvt_pk_bf16_f32 v129, v234, v235
  s_add_u32 s60, s60, s29
  s_mul_i32 s62, s60, 7183
  s_lshr_b32 s62, s62, 22
  s_mul_i32 s63, s62, 584
  s_sub_u32 s63, s60, s63
  s_lshr_b32 s64, s63, 3
  s_and_b32 s65, s63, 7
  s_lshl_b32 s66, s62, 3
  s_add_u32 s65, s65, s66
  s_cmp_ge_u32 s60, 5256
  s_cselect_b32 s64, s63, s64
  s_cselect_b32 s65, 72, s65
  s_mul_i32 s66, s65, 1373568
  s_mul_i32 s67, s64, 2688
  s_add_u32 s35, s66, s67
  s_cmp_ge_u32 s61, 667
  s_cselect_b32 s35, 268435456, s35
  s_waitcnt lgkmcnt(0)
  s_barrier
  v_mfma_f32_16x16x32_bf16 v[176:179], a[144:147], v[196:199], 0
  s_waitcnt vmcnt(17)
  ds_read_b64_tr_b16 v[88:89], v238 offset:6144
  ds_read_b64_tr_b16 v[232:233], v238 offset:6208
  v_mfma_f32_16x16x32_bf16 v[176:179], a[148:151], v[200:203], v[176:179]
  s_cmp_ge_u32 s60, 5329
  ds_read_b64_tr_b16 v[90:91], v238 offset:7680
  ds_read_b64_tr_b16 v[234:235], v238 offset:7744
  v_mfma_f32_16x16x32_bf16 v[176:179], a[152:155], v[204:207], v[176:179]
  s_cselect_b32 s35, 268435456, s35
  ds_read_b64_tr_b16 v[68:69], v238 offset:6176
  v_mfma_f32_16x16x32_bf16 v[176:179], a[156:159], v[208:211], v[176:179]
  s_cmp_eq_u32 s65, 0
  ds_read_b64_tr_b16 v[70:71], v238 offset:7712
  ds_read_b128 v[184:187], v15
  v_mfma_f32_16x16x32_bf16 v[176:179], a[160:163], v[212:215], v[176:179]
  s_cselect_b32 s36, 268435456, s35
  ds_read_b128 v[180:183], v15 offset:1024
  v_mfma_f32_16x16x32_bf16 v[176:179], a[164:167], v[216:219], v[176:179]
  s_add_u32 s37, s35, 195360
  v_mfma_f32_16x16x32_bf16 v[188:191], a[168:171], v[196:199], 0
  s_add_u32 s38, s35, 390720
  v_mfma_f32_16x16x32_bf16 v[188:191], a[172:175], v[200:203], v[188:191]
  s_add_u32 s39, s35, 586080
  v_cvt_pk_bf16_f32 v140, v176, v177
  v_cvt_pk_bf16_f32 v141, v178, v179
  v_mfma_f32_16x16x32_bf16 v[188:191], a[176:179], v[204:207], v[188:191]
  s_add_u32 s40, s35, 781440
  buffer_store_dwordx4 v[72:75], v15, s[12:15], s75 offen offset:3072
  s_nop 1
  ds_read_b64_tr_b16 v[72:73], v238 offset:20000
  v_mfma_f32_16x16x32_bf16 v[188:191], a[180:183], v[208:211], v[188:191]
  s_add_u32 s41, s35, 981120
  ds_read_b64_tr_b16 v[74:75], v238 offset:3104
  v_mfma_f32_16x16x32_bf16 v[188:191], a[184:187], v[212:215], v[188:191]
  s_waitcnt lgkmcnt(3)
  v_add_f32 v184, v184, v185
  v_add_f32 v186, v186, v187
  v_mfma_f32_16x16x32_bf16 v[188:191], a[188:191], v[216:219], v[188:191]
  s_waitcnt lgkmcnt(2)
  v_add_f32 v180, v180, v181
  v_add_f32 v182, v182, v183
  v_mfma_f32_16x16x32_bf16 v[176:179], a[192:195], v[196:199], 0
  s_add_u32 s42, s35, 1176480
  v_add_f32 v184, v184, v186
  v_add_f32 v180, v180, v182
  v_mfma_f32_16x16x32_bf16 v[176:179], a[196:199], v[200:203], v[176:179]
  s_add_u32 s43, s35, 1371840
  v_mul_f32 v185, 0x3baaaaab, v184
  v_fma_f32 v180, -v185, v184, v180
  v_mfma_f32_16x16x32_bf16 v[176:179], a[200:203], v[204:207], v[176:179]
  s_add_u32 s44, s35, 1567200
  v_max_f32 v180, 0, v180
  v_add_f32 v180, 0x3afba882, v180
  v_mfma_f32_16x16x32_bf16 v[176:179], a[204:207], v[208:211], v[176:179]
  s_cmp_eq_u32 s64, 0
  v_rsq_f32 v180, v180
  v_mfma_f32_16x16x32_bf16 v[176:179], a[208:211], v[212:215], v[176:179]
  s_cselect_b64 s[52:53], s[48:49], 0
  v_mul_f32 v180, 0x40ca568a, v180
  v_mul_f32 v181, -v185, v180
  v_mfma_f32_16x16x32_bf16 v[176:179], a[212:215], v[216:219], v[176:179]
  s_waitcnt vmcnt(14)
  ds_read_b64_tr_b16 v[216:217], v238 offset:21536
  ds_read_b64_tr_b16 v[212:213], v238 offset:21568
  ds_read_b64_tr_b16 v[84:85], v238 offset:23040
  s_cmp_eq_u32 s64, 72
  ds_read_b64_tr_b16 v[64:65], v238 offset:23072
  s_cselect_b64 s[52:53], s[50:51], s[52:53]
  s_add_u32 s31, s31, 1
  ds_read_b64_tr_b16 v[208:209], v238 offset:23104
  s_mov_b32 m0, s58
  ds_write_b64 v111, v[180:181]
  v_cvt_pk_bf16_f32 v142, v188, v189
  v_cvt_pk_bf16_f32 v143, v190, v191
  ds_read_b64 v[190:191], v115 offset:768
  buffer_store_dwordx4 v[76:79], v15, s[12:15], s77 offen
  s_nop 1
  ds_read_b64_tr_b16 v[76:77], v238 offset:21504
  v_cvt_pk_bf16_f32 v144, v176, v177
  v_cvt_pk_bf16_f32 v145, v178, v179
  ds_read_b64 v[188:189], v115 offset:896
  ds_read_b64 v[248:249], v115 offset:1792
  v_cndmask_b32 v182, v21, 2.0, s[52:53]
  s_waitcnt lgkmcnt(3)
  v_fma_f32 v176, v24, v190, v191
  v_fma_f32 v204, v25, v190, v191
  v_cvt_pk_bf16_f32 v176, v176, v204
  v_fma_f32 v177, v26, v190, v191
  v_fma_f32 v204, v27, v190, v191
  v_cvt_pk_bf16_f32 v177, v177, v204
  v_fma_f32 v178, v28, v190, v191
  v_fma_f32 v204, v29, v190, v191
  v_cvt_pk_bf16_f32 v178, v178, v204
  v_fma_f32 v179, v30, v190, v191
  v_fma_f32 v204, v31, v190, v191
  v_cvt_pk_bf16_f32 v179, v179, v204
  ds_write_b128 v16, v[176:179] offset:2048
  v_fma_f32 v176, v32, v190, v191
  v_fma_f32 v204, v33, v190, v191
  v_cvt_pk_bf16_f32 v176, v176, v204
  v_fma_f32 v177, v34, v190, v191
  v_fma_f32 v204, v35, v190, v191
  v_cvt_pk_bf16_f32 v177, v177, v204
  ds_write_b64 v17, v[176:177] offset:2048
  buffer_store_dwordx4 v[80:83], v15, s[12:15], s77 offen offset:1024
  s_nop 1
  ds_read_b64_tr_b16 v[80:81], v238 offset:18432
  ds_read_b64_tr_b16 v[82:83], v238 offset:4608
  s_waitcnt vmcnt(12)
  ds_read_b64_tr_b16 v[86:87], v238 offset:24576
  ds_read_b64_tr_b16 v[66:67], v238 offset:24608
  ds_read_b64_tr_b16 v[210:211], v238 offset:24640
  ds_read_b64_tr_b16 v[218:219], v238 offset:26144
  ds_read_b64_tr_b16 v[214:215], v238 offset:26176
  ds_read_b64_tr_b16 v[78:79], v238 offset:26112
  s_waitcnt lgkmcnt(8)
  s_barrier
  ds_read_b128 v[236:239], v15 offset:2048
  ds_read_b128 v[204:207], v15 offset:3072
  v_fma_f32 v200, v36, v188, v189
  ds_read_b128 v[196:199], v15 offset:4096
  v_fma_f32 v176, v37, v188, v189
  ds_read_b128 v[190:193], v15 offset:5120
  v_cvt_pk_bf16_f32 v200, v200, v176
  ds_read_b128 v[224:227], v15 offset:6144
  v_fma_f32 v201, v38, v188, v189
  ds_read_b128 v[220:223], v15 offset:7168
  v_fma_f32 v176, v39, v188, v189
  v_cvt_pk_bf16_f32 v201, v201, v176
  v_fma_f32 v202, v40, v188, v189
  v_fma_f32 v176, v41, v188, v189
  v_cvt_pk_bf16_f32 v202, v202, v176
  v_fma_f32 v203, v42, v188, v189
  s_waitcnt lgkmcnt(5)
  v_mfma_f32_16x16x32_bf16 v[184:187], a[0:3], v[236:239], 0
  v_fma_f32 v176, v43, v188, v189
  s_waitcnt lgkmcnt(4)
  v_mfma_f32_16x16x32_bf16 v[184:187], a[4:7], v[204:207], v[184:187]
  v_cvt_pk_bf16_f32 v203, v203, v176
  s_waitcnt lgkmcnt(3)
  v_mfma_f32_16x16x32_bf16 v[184:187], a[8:11], v[196:199], v[184:187]
  v_fma_f32 v228, v48, v248, v249
  s_waitcnt lgkmcnt(2)
  v_mfma_f32_16x16x32_bf16 v[184:187], a[12:15], v[190:193], v[184:187]
  v_fma_f32 v176, v49, v248, v249
  s_waitcnt lgkmcnt(1)
  v_mfma_f32_16x16x32_bf16 v[184:187], a[16:19], v[224:227], v[184:187]
  v_cvt_pk_bf16_f32 v228, v228, v176
  s_waitcnt lgkmcnt(0)
  v_mfma_f32_16x16x32_bf16 v[184:187], a[20:23], v[220:223], v[184:187]
  buffer_store_dwordx4 v[148:151], v15, s[12:15], s77 offen offset:3072
  v_fma_f32 v229, v50, v248, v249
  v_mfma_f32_16x16x32_bf16 v[244:247], a[24:27], v[236:239], 0
  s_nop 3
  v_cvt_pk_bf16_f32 v176, v184, v185
  v_cvt_pk_bf16_f32 v177, v186, v187
  v_mfma_f32_16x16x32_bf16 v[244:247], a[28:31], v[204:207], v[244:247]
  v_fma_f32 v184, v51, v248, v249
  v_cvt_pk_bf16_f32 v229, v229, v184
  v_mfma_f32_16x16x32_bf16 v[244:247], a[32:35], v[196:199], v[244:247]
  v_fma_f32 v230, v52, v248, v249
  v_fma_f32 v184, v53, v248, v249
  v_mfma_f32_16x16x32_bf16 v[244:247], a[36:39], v[190:193], v[244:247]
  v_cvt_pk_bf16_f32 v230, v230, v184
  v_fma_f32 v231, v54, v248, v249
  v_mfma_f32_16x16x32_bf16 v[244:247], a[40:43], v[224:227], v[244:247]
  buffer_store_dwordx2 v[152:153], v15, s[12:15], s78 offen
  v_fma_f32 v184, v55, v248, v249
  v_mfma_f32_16x16x32_bf16 v[244:247], a[44:47], v[220:223], v[244:247]
  v_cvt_pk_bf16_f32 v231, v231, v184
  v_fma_f32 v146, v44, v188, v189
  v_mfma_f32_16x16x32_bf16 v[184:187], a[48:51], v[236:239], 0
  v_fma_f32 v134, v45, v188, v189
  v_cvt_pk_bf16_f32 v146, v146, v134
  v_mfma_f32_16x16x32_bf16 v[184:187], a[52:55], v[204:207], v[184:187]
  v_cvt_pk_bf16_f32 v178, v244, v245
  v_cvt_pk_bf16_f32 v179, v246, v247
  v_mfma_f32_16x16x32_bf16 v[184:187], a[56:59], v[196:199], v[184:187]
  v_fma_f32 v147, v46, v188, v189
  v_fma_f32 v134, v47, v188, v189
  v_mfma_f32_16x16x32_bf16 v[184:187], a[60:63], v[190:193], v[184:187]
  v_cvt_pk_bf16_f32 v147, v147, v134
  v_fma_f32 v134, v56, v248, v249
  v_mfma_f32_16x16x32_bf16 v[184:187], a[64:67], v[224:227], v[184:187]
  buffer_store_dwordx4 v[154:157], v15, s[12:15], s78 offen offset:1024
  v_fma_f32 v188, v57, v248, v249
  v_mfma_f32_16x16x32_bf16 v[184:187], a[68:71], v[220:223], v[184:187]
  s_barrier
  v_mfma_f32_16x16x32_bf16 v[244:247], a[72:75], v[236:239], 0
  ds_write_b128 v18, v[60:63] offset:10240
  v_mfma_f32_16x16x32_bf16 v[244:247], a[76:79], v[204:207], v[244:247]
  v_cvt_pk_bf16_f32 v180, v184, v185
  v_cvt_pk_bf16_f32 v181, v186, v187
  v_mfma_f32_16x16x32_bf16 v[244:247], a[80:83], v[196:199], v[244:247]
  ds_write_b128 v18, v[64:67] offset:7168
  v_mfma_f32_16x16x32_bf16 v[244:247], a[84:87], v[190:193], v[244:247]
  buffer_store_dwordx2 v[158:159], v15, s[12:15], s78 offen offset:2048
  v_cvt_pk_bf16_f32 v134, v134, v188
  v_mfma_f32_16x16x32_bf16 v[244:247], a[88:91], v[224:227], v[244:247]
  ds_write_b128 v18, v[68:71] offset:4096
  v_mfma_f32_16x16x32_bf16 v[244:247], a[92:95], v[220:223], v[244:247]
  v_fma_f32 v135, v58, v248, v249
  v_fma_f32 v183, v59, v248, v249
  v_mfma_f32_16x16x32_bf16 v[248:251], a[96:99], v[236:239], 0
  ds_write_b128 v18, v[72:75] offset:1024
  v_mfma_f32_16x16x32_bf16 v[248:251], a[100:103], v[204:207], v[248:251]
  v_cvt_pk_bf16_f32 v184, v244, v245
  v_cvt_pk_bf16_f32 v185, v246, v247
  v_mfma_f32_16x16x32_bf16 v[248:251], a[104:107], v[196:199], v[248:251]
  v_cvt_pk_bf16_f32 v135, v135, v183
  v_mfma_f32_16x16x32_bf16 v[248:251], a[108:111], v[190:193], v[248:251]
  ds_write_b128 v18, v[76:79] offset:12288
  v_mfma_f32_16x16x32_bf16 v[248:251], a[112:115], v[224:227], v[248:251]
  v_mfma_f32_16x16x32_bf16 v[248:251], a[116:119], v[220:223], v[248:251]
  ds_write_b128 v18, v[80:83] offset:9216
  v_mfma_f32_16x16x32_bf16 v[244:247], a[120:123], v[236:239], 0
  s_nop 3
  v_cvt_pk_bf16_f32 v186, v248, v249
  v_cvt_pk_bf16_f32 v187, v250, v251
  v_mfma_f32_16x16x32_bf16 v[244:247], a[124:127], v[204:207], v[244:247]
  v_mfma_f32_16x16x32_bf16 v[244:247], a[128:131], v[196:199], v[244:247]
  ds_write_b128 v18, v[84:87] offset:6144
  v_mfma_f32_16x16x32_bf16 v[244:247], a[132:135], v[190:193], v[244:247]
  v_mfma_f32_16x16x32_bf16 v[244:247], a[136:139], v[224:227], v[244:247]
  ds_write_b128 v18, v[88:91] offset:3072
  v_mfma_f32_16x16x32_bf16 v[244:247], a[140:143], v[220:223], v[244:247]
  v_mfma_f32_16x16x32_bf16 v[248:251], v[236:239], a[144:147], 0
  v_mfma_f32_16x16x32_bf16 v[248:251], v[204:207], a[148:151], v[248:251]
  ds_write_b128 v18, v[92:95]
  v_mfma_f32_16x16x32_bf16 v[248:251], v[196:199], a[152:155], v[248:251]
  v_cvt_pk_bf16_f32 v188, v244, v245
  v_cvt_pk_bf16_f32 v189, v246, v247
  v_mfma_f32_16x16x32_bf16 v[248:251], v[190:193], a[156:159], v[248:251]
  ds_write_b128 v18, v[136:139] offset:2048
  v_mfma_f32_16x16x32_bf16 v[248:251], v[224:227], a[160:163], v[248:251]
  v_mfma_f32_16x16x32_bf16 v[248:251], v[220:223], a[164:167], v[248:251]
  v_mfma_f32_16x16x32_bf16 v[136:139], v[236:239], a[168:171], 0
  ds_write_b128 v18, v[232:235] offset:5120
  v_mfma_f32_16x16x32_bf16 v[136:139], v[204:207], a[172:175], v[136:139]
  v_cvt_pk_bf16_f32 v232, v248, v249
  v_cvt_pk_bf16_f32 v233, v250, v251
  v_mfma_f32_16x16x32_bf16 v[136:139], v[196:199], a[176:179], v[136:139]
  ds_write_b128 v18, v[208:211] offset:8192
  v_mfma_f32_16x16x32_bf16 v[136:139], v[190:193], a[180:183], v[136:139]
  v_mfma_f32_16x16x32_bf16 v[136:139], v[224:227], a[184:187], v[136:139]
  v_mfma_f32_16x16x32_bf16 v[136:139], v[220:223], a[188:191], v[136:139]
  ds_write_b128 v18, v[130:133] offset:11264
  v_mfma_f32_16x16x32_bf16 v[130:133], v[236:239], a[192:195], 0
  s_nop 3
  v_cvt_pk_bf16_f32 v208, v136, v137
  v_cvt_pk_bf16_f32 v209, v138, v139
  v_mfma_f32_16x16x32_bf16 v[130:133], v[204:207], a[196:199], v[130:133]
  ds_write_b128 v18, v[216:219] offset:13312
  v_mfma_f32_16x16x32_bf16 v[130:133], v[196:199], a[200:203], v[130:133]
  v_mfma_f32_16x16x32_bf16 v[130:133], v[190:193], a[204:207], v[130:133]
  v_mfma_f32_16x16x32_bf16 v[130:133], v[224:227], a[208:211], v[130:133]
  ds_write_b128 v18, v[212:215] offset:14336
  v_mfma_f32_16x16x32_bf16 v[130:133], v[220:223], a[212:215], v[130:133]
  ds_write_b128 v16, v[200:203] offset:8192
  s_nop 6
  v_cvt_pk_bf16_f32 v200, v130, v131
  v_cvt_pk_bf16_f32 v201, v132, v133
  ds_write_b128 v16, v[228:231] offset:14336
  ds_write_b64 v240, v[148:149] offset:768
  ds_write_b64 v240, v[150:151] offset:776
  ds_write_b64 v240, v[152:153] offset:784
  ds_write_b64 v241, v[154:155] offset:768
  ds_write_b64 v241, v[156:157] offset:776
  ds_write_b64 v241, v[158:159] offset:784
  ds_write_b64 v240, v[160:161]
  ds_write_b64 v240, v[162:163] offset:8
  ds_write_b64 v240, v[164:165] offset:16
  ds_write_b64 v241, v[168:169]
  ds_write_b64 v241, v[170:171] offset:8
  ds_write_b64 v241, v[172:173] offset:16
  ds_write_b64 v242, v[124:125]
  ds_write_b64 v242, v[126:127] offset:32
  ds_write_b64 v242, v[128:129] offset:64
  ds_write_b64 v243, v[140:141]
  ds_write_b64 v243, v[142:143] offset:32
  ds_write_b64 v243, v[144:145] offset:64
  ds_write_b64 v17, v[146:147] offset:8192
  ds_write_b64 v17, v[134:135] offset:14336
  ds_read_b64 v[160:161], v19 offset:784
  ds_read2_b64 v[156:159], v19 offset0:96 offset1:97
  s_waitcnt lgkmcnt(2)
  s_barrier
  v_mfma_f32_16x16x16_bf16 v[240:243], v[188:189], v[180:181], 0
  ds_read_b128 v[228:231], v15 offset:8192
  ds_read_b128 v[220:223], v15 offset:9216
  s_waitcnt lgkmcnt(3)
  v_mfma_f32_16x16x16_bf16 v[124:127], v[188:189], v[160:161], 0
  ds_read_b128 v[212:215], v15 offset:10240
  ds_read_b128 v[224:227], v15 offset:11264
  v_mfma_f32_16x16x32_bf16 v[240:243], v[184:187], v[176:179], v[240:243]
  s_waitcnt lgkmcnt(4)
  ds_read_b128 v[196:199], v15 offset:12288
  v_mfma_f32_16x16x32_bf16 v[124:127], v[184:187], v[156:159], v[124:127]
  ds_read_b128 v[216:219], v15 offset:13312
  s_nop 2
  v_exp_f32 v240, v240
  v_exp_f32 v241, v241
  s_waitcnt lgkmcnt(5)
  v_mfma_f32_16x16x32_bf16 v[140:143], a[72:75], v[228:231], 0
  v_exp_f32 v242, v242
  s_waitcnt lgkmcnt(4)
  v_mfma_f32_16x16x32_bf16 v[140:143], a[76:79], v[220:223], v[140:143]
  v_cvt_pk_bf16_f32 v204, v240, v241
  s_waitcnt lgkmcnt(3)
  v_mfma_f32_16x16x32_bf16 v[140:143], a[80:83], v[212:215], v[140:143]
  s_waitcnt lgkmcnt(2)
  v_mfma_f32_16x16x32_bf16 v[140:143], a[84:87], v[224:227], v[140:143]
  s_waitcnt lgkmcnt(1)
  v_mfma_f32_16x16x32_bf16 v[140:143], a[88:91], v[196:199], v[140:143]
  s_waitcnt lgkmcnt(0)
  v_mfma_f32_16x16x32_bf16 v[140:143], a[92:95], v[216:219], v[140:143]
  v_exp_f32 v243, v243
  v_exp_f32 v124, v124
  v_exp_f32 v125, v125
  v_exp_f32 v126, v126
  v_exp_f32 v127, v127
  s_nop 2
  v_cvt_pk_bf16_f32 v168, v140, v141
  v_cvt_pk_bf16_f32 v169, v142, v143
  v_cvt_pk_bf16_f32 v205, v242, v243
  v_cvt_pk_bf16_f32 v190, v124, v125
  v_cvt_pk_bf16_f32 v191, v126, v127
  s_waitcnt vmcnt(7)
  ds_read_b64 v[140:141], v9
  ds_read_b64 v[142:143], v9 offset:32
  ds_read_b64 v[146:147], v9 offset:64
  ds_read_b128 v[236:239], v3
  ds_read_b128 v[240:243], v3 offset:864
  ds_read_b128 v[124:127], v3 offset:1728
  ds_read_b128 v[128:131], v6
  s_waitcnt lgkmcnt(6)
  v_mfma_f32_16x16x16_bf16 v[60:63], a[224:225], v[140:141], 0
  ds_read_b128 v[132:135], v3 offset:32
  s_waitcnt lgkmcnt(6)
  v_mfma_f32_16x16x16_bf16 v[64:67], a[234:235], v[142:143], 0
  ds_read_b128 v[136:139], v3 offset:896
  s_waitcnt lgkmcnt(6)
  v_mfma_f32_16x16x16_bf16 v[68:71], a[244:245], v[146:147], 0
  ds_read_b128 v[140:143], v3 offset:1760
  ds_read_b128 v[144:147], v6 offset:32
  s_waitcnt lgkmcnt(6)
  v_smfmac_f32_16x16x64_bf16 v[60:63], a[216:219], v[236:243], v0
  ds_read_b128 v[236:239], v3 offset:64
  ds_read_b128 v[240:243], v3 offset:928
  s_waitcnt lgkmcnt(6)
  v_smfmac_f32_16x16x64_bf16 v[60:63], a[220:223], v[124:131], v0
  ds_read_b128 v[124:127], v3 offset:1792
  v_mfma_f32_16x16x32_bf16 v[162:165], a[96:99], v[228:231], 0
  ds_read_b128 v[128:131], v6 offset:64
  v_mfma_f32_16x16x32_bf16 v[162:165], a[100:103], v[220:223], v[162:165]
  v_mul_f32 v150, v60, v60
  v_add_f32 v104, v60, v61
  v_mfma_f32_16x16x32_bf16 v[162:165], a[104:107], v[212:215], v[162:165]
  s_waitcnt lgkmcnt(6)
  v_fmac_f32 v150, v61, v61
  v_add_f32 v104, v104, v62
  v_smfmac_f32_16x16x64_bf16 v[64:67], a[226:229], v[132:139], v0
  s_waitcnt lgkmcnt(4)
  v_fmac_f32 v150, v62, v62
  v_smfmac_f32_16x16x64_bf16 v[64:67], a[230:233], v[140:147], v0
  v_add_f32 v104, v104, v63
  v_mfma_f32_16x16x32_bf16 v[162:165], a[108:111], v[224:227], v[162:165]
  v_fmac_f32 v150, v63, v63
  v_mfma_f32_16x16x32_bf16 v[162:165], a[112:115], v[196:199], v[162:165]
  v_add_f32 v104, v104, v64
  v_fmac_f32 v150, v64, v64
  v_mfma_f32_16x16x32_bf16 v[162:165], a[116:119], v[216:219], v[162:165]
  s_waitcnt lgkmcnt(2)
  v_add_f32 v104, v104, v65
  v_fmac_f32 v150, v65, v65
  v_smfmac_f32_16x16x64_bf16 v[68:71], a[236:239], v[236:243], v0
  s_waitcnt lgkmcnt(0)
  v_add_f32 v104, v104, v66
  v_smfmac_f32_16x16x64_bf16 v[68:71], a[240:243], v[124:131], v0
  v_cvt_pk_bf16_f32 v170, v162, v163
  v_mfma_f32_16x16x32_bf16 v[140:143], a[120:123], v[228:231], 0
  v_cvt_pk_bf16_f32 v171, v164, v165
  v_fmac_f32 v150, v66, v66
  v_mfma_f32_16x16x32_bf16 v[140:143], a[124:127], v[220:223], v[140:143]
  ds_read_b64 v[162:163], v10
  v_add_f32 v104, v104, v67
  v_mfma_f32_16x16x32_bf16 v[140:143], a[128:131], v[212:215], v[140:143]
  ds_read_b64 v[164:165], v10 offset:32
  v_fmac_f32 v150, v67, v67
  v_mfma_f32_16x16x32_bf16 v[140:143], a[132:135], v[224:227], v[140:143]
  ds_read_b64 v[148:149], v10 offset:64
  v_add_f32 v104, v104, v68
  v_mfma_f32_16x16x32_bf16 v[140:143], a[136:139], v[196:199], v[140:143]
  ds_read_b128 v[124:127], v4
  ds_read_b128 v[128:131], v4 offset:864
  v_mfma_f32_16x16x32_bf16 v[140:143], a[140:143], v[216:219], v[140:143]
  ds_read_b128 v[236:239], v4 offset:1728
  v_fmac_f32 v150, v68, v68
  v_mfma_f32_16x16x32_bf16 v[152:155], a[0:3], v[228:231], 0
  ds_read_b128 v[240:243], v7
  v_add_f32 v104, v104, v69
  v_mfma_f32_16x16x32_bf16 v[152:155], a[4:7], v[220:223], v[152:155]
  v_cvt_pk_bf16_f32 v172, v140, v141
  v_cvt_pk_bf16_f32 v173, v142, v143
  v_mfma_f32_16x16x32_bf16 v[152:155], a[8:11], v[212:215], v[152:155]
  v_fmac_f32 v150, v69, v69
  v_add_f32 v104, v104, v70
  v_mfma_f32_16x16x32_bf16 v[152:155], a[12:15], v[224:227], v[152:155]
  ds_read_b128 v[140:143], v4 offset:32
  ds_read_b128 v[144:147], v4 offset:896
  v_mfma_f32_16x16x32_bf16 v[152:155], a[16:19], v[196:199], v[152:155]
  ds_read_b128 v[132:135], v4 offset:1760
  v_fmac_f32 v150, v70, v70
  v_mfma_f32_16x16x32_bf16 v[152:155], a[20:23], v[216:219], v[152:155]
  s_waitcnt lgkmcnt(5)
  ds_read_b128 v[136:139], v7 offset:32
  v_add_f32 v104, v104, v71
  v_fmac_f32 v150, v71, v71
  v_mfma_f32_16x16x16_bf16 v[72:75], a[224:225], v[162:163], 0
  s_nop 0
  v_permlane32_swap_b32 v104, v150
  v_mfma_f32_16x16x16_bf16 v[76:79], a[234:235], v[164:165], 0
  v_cvt_pk_bf16_f32 v162, v152, v153
  v_cvt_pk_bf16_f32 v163, v154, v155
  v_add_f32 v104, v104, v150
  v_mfma_f32_16x16x16_bf16 v[80:83], a[244:245], v[148:149], 0
  ds_read_b128 v[148:151], v4 offset:64
  ds_read_b128 v[152:155], v4 offset:928
  v_smfmac_f32_16x16x64_bf16 v[72:75], a[216:219], v[124:131], v0
  s_waitcnt lgkmcnt(6)
  ds_read_b128 v[124:127], v4 offset:1792
  v_smfmac_f32_16x16x64_bf16 v[72:75], a[220:223], v[236:243], v0
  ds_read_b128 v[128:131], v7 offset:64
  v_mfma_f32_16x16x32_bf16 v[236:239], a[24:27], v[228:231], 0
  v_mfma_f32_16x16x32_bf16 v[236:239], a[28:31], v[220:223], v[236:239]
  v_mul_f32 v105, v72, v72
  v_add_f32 v106, v72, v73
  v_mfma_f32_16x16x32_bf16 v[236:239], a[32:35], v[212:215], v[236:239]
  s_waitcnt lgkmcnt(6)
  v_fmac_f32 v105, v73, v73
  v_add_f32 v106, v106, v74
  v_smfmac_f32_16x16x64_bf16 v[76:79], a[226:229], v[140:147], v0
  s_waitcnt lgkmcnt(4)
  v_fmac_f32 v105, v74, v74
  v_smfmac_f32_16x16x64_bf16 v[76:79], a[230:233], v[132:139], v0
  v_add_f32 v106, v106, v75
  v_mfma_f32_16x16x32_bf16 v[236:239], a[36:39], v[224:227], v[236:239]
  v_fmac_f32 v105, v75, v75
  v_mfma_f32_16x16x32_bf16 v[236:239], a[40:43], v[196:199], v[236:239]
  v_add_f32 v106, v106, v76
  v_fmac_f32 v105, v76, v76
  v_mfma_f32_16x16x32_bf16 v[236:239], a[44:47], v[216:219], v[236:239]
  s_waitcnt lgkmcnt(2)
  v_add_f32 v106, v106, v77
  v_fmac_f32 v105, v77, v77
  v_smfmac_f32_16x16x64_bf16 v[80:83], a[236:239], v[148:155], v0
  s_waitcnt lgkmcnt(0)
  v_add_f32 v106, v106, v78
  v_smfmac_f32_16x16x64_bf16 v[80:83], a[240:243], v[124:131], v0
  v_cvt_pk_bf16_f32 v164, v236, v237
  v_mfma_f32_16x16x32_bf16 v[132:135], a[48:51], v[228:231], 0
  v_cvt_pk_bf16_f32 v165, v238, v239
  v_fmac_f32 v105, v78, v78
  v_mfma_f32_16x16x32_bf16 v[132:135], a[52:55], v[220:223], v[132:135]
  ds_read_b64 v[240:241], v11
  v_add_f32 v106, v106, v79
  v_mfma_f32_16x16x32_bf16 v[132:135], a[56:59], v[212:215], v[132:135]
  ds_read_b64 v[242:243], v11 offset:32
  v_fmac_f32 v105, v79, v79
  v_mfma_f32_16x16x32_bf16 v[132:135], a[60:63], v[224:227], v[132:135]
  ds_read_b64 v[244:245], v11 offset:64
  v_add_f32 v106, v106, v80
  v_mfma_f32_16x16x32_bf16 v[132:135], a[64:67], v[196:199], v[132:135]
  ds_read_b128 v[124:127], v5
  ds_read_b128 v[128:131], v5 offset:864
  v_mfma_f32_16x16x32_bf16 v[132:135], a[68:71], v[216:219], v[132:135]
  ds_read_b128 v[148:151], v5 offset:1728
  v_fmac_f32 v105, v80, v80
  v_mfma_f32_16x16x32_bf16 v[236:239], v[228:231], a[144:147], 0
  ds_read_b128 v[152:155], v8
  v_add_f32 v106, v106, v81
  v_mfma_f32_16x16x32_bf16 v[236:239], v[220:223], a[148:151], v[236:239]
  v_cvt_pk_bf16_f32 v166, v132, v133
  v_cvt_pk_bf16_f32 v167, v134, v135
  v_mfma_f32_16x16x32_bf16 v[236:239], v[212:215], a[152:155], v[236:239]
  v_fmac_f32 v105, v81, v81
  v_add_f32 v106, v106, v82
  v_mfma_f32_16x16x32_bf16 v[236:239], v[224:227], a[156:159], v[236:239]
  ds_read_b128 v[132:135], v5 offset:32
  ds_read_b128 v[136:139], v5 offset:896
  v_mfma_f32_16x16x32_bf16 v[236:239], v[196:199], a[160:163], v[236:239]
  ds_read_b128 v[140:143], v5 offset:1760
  v_fmac_f32 v105, v82, v82
  v_mfma_f32_16x16x32_bf16 v[236:239], v[216:219], a[164:167], v[236:239]
  s_waitcnt lgkmcnt(5)
  ds_read_b128 v[144:147], v8 offset:32
  v_add_f32 v106, v106, v83
  v_fmac_f32 v105, v83, v83
  v_mfma_f32_16x16x16_bf16 v[84:87], a[224:225], v[240:241], 0
  s_nop 0
  v_permlane32_swap_b32 v106, v105
  v_mfma_f32_16x16x16_bf16 v[88:91], a[234:235], v[242:243], 0
  v_cvt_pk_bf16_f32 v234, v236, v237
  v_cvt_pk_bf16_f32 v235, v238, v239
  v_add_f32 v106, v106, v105
  v_mfma_f32_16x16x16_bf16 v[92:95], a[244:245], v[244:245], 0
  ds_read_b128 v[236:239], v5 offset:64
  ds_read_b128 v[240:243], v5 offset:928
  v_smfmac_f32_16x16x64_bf16 v[84:87], a[216:219], v[124:131], v0
  s_waitcnt lgkmcnt(6)
  ds_read_b128 v[124:127], v5 offset:1792
  v_smfmac_f32_16x16x64_bf16 v[84:87], a[220:223], v[148:155], v0
  ds_read_b128 v[128:131], v8 offset:64
  v_mfma_f32_16x16x32_bf16 v[148:151], v[228:231], a[168:171], 0
  v_permlane16_swap_b32 v104, v106
  v_mfma_f32_16x16x32_bf16 v[148:151], v[220:223], a[172:175], v[148:151]
  v_mul_f32 v152, v84, v84
  v_add_f32 v153, v84, v85
  v_mfma_f32_16x16x32_bf16 v[148:151], v[212:215], a[176:179], v[148:151]
  s_waitcnt lgkmcnt(6)
  v_fmac_f32 v152, v85, v85
  v_add_f32 v153, v153, v86
  v_smfmac_f32_16x16x64_bf16 v[88:91], a[226:229], v[132:139], v0
  s_waitcnt lgkmcnt(4)
  v_fmac_f32 v152, v86, v86
  v_smfmac_f32_16x16x64_bf16 v[88:91], a[230:233], v[140:147], v0
  v_add_f32 v153, v153, v87
  v_mfma_f32_16x16x32_bf16 v[148:151], v[224:227], a[180:183], v[148:151]
  v_fmac_f32 v152, v87, v87
  v_add_f32 v104, v104, v106
  v_mfma_f32_16x16x32_bf16 v[148:151], v[196:199], a[184:187], v[148:151]
  s_waitcnt lgkmcnt(0)
  buffer_load_dwordx4 v182, s[4:7], s36 offen nt lds
  v_mfma_f32_16x16x32_bf16 v[148:151], v[216:219], a[188:191], v[148:151]
  buffer_load_dwordx4 v182, s[4:7], s37 offen offset:864 nt lds
  v_smfmac_f32_16x16x64_bf16 v[92:95], a[236:239], v[236:243], v0
  buffer_load_dwordx4 v182, s[4:7], s38 offen offset:1728 nt lds
  v_smfmac_f32_16x16x64_bf16 v[92:95], a[240:243], v[124:131], v0
  buffer_load_dwordx4 v182, s[4:7], s39 offen offset:2592 nt lds
  v_mfma_f32_16x16x32_bf16 v[236:239], v[228:231], a[192:195], 0
  ds_read_b128 v[124:127], v15 offset:14336
  ds_read_b128 v[128:131], v15 offset:15360
  v_mfma_f32_16x16x32_bf16 v[236:239], v[220:223], a[196:199], v[236:239]
  ds_read_b128 v[132:135], v15 offset:16384
  v_add_f32 v153, v153, v88
  v_mfma_f32_16x16x32_bf16 v[236:239], v[212:215], a[200:203], v[236:239]
  buffer_load_dwordx4 v182, s[4:7], s40 offen offset:3456 nt lds
  v_mfma_f32_16x16x32_bf16 v[236:239], v[224:227], a[204:207], v[236:239]
  s_mov_b32 m0, s59
  ds_read_b128 v[140:143], v15 offset:17408
  ds_read_b128 v[136:139], v15 offset:18432
  v_mfma_f32_16x16x32_bf16 v[236:239], v[196:199], a[208:211], v[236:239]
  s_mov_b32 s32, s33
  ds_read_b128 v[144:147], v15 offset:19456
  v_fmac_f32 v152, v88, v88
  v_mfma_f32_16x16x32_bf16 v[236:239], v[216:219], a[212:215], v[236:239]
  s_mov_b32 s33, s34
  v_add_f32 v153, v153, v89
  v_fmac_f32 v152, v89, v89
  v_add_f32 v153, v153, v90
  v_mfma_f32_16x16x16_bf16 v[240:243], v[172:173], v[180:181], 0
  v_fmac_f32 v152, v90, v90
  v_add_f32 v153, v153, v91
  v_fmac_f32 v152, v91, v91
  v_mfma_f32_16x16x16_bf16 v[216:219], v[188:189], v[166:167], 0
  v_add_f32 v153, v153, v92
  v_fmac_f32 v152, v92, v92
  v_cvt_pk_bf16_f32 v210, v148, v149
  v_cvt_pk_bf16_f32 v211, v150, v151
  v_mfma_f32_16x16x32_bf16 v[240:243], v[168:171], v[176:179], v[240:243]
  s_mov_b32 s34, s35
  buffer_load_dwordx4 v182, s[4:7], s41 offen nt lds
  v_mfma_f32_16x16x32_bf16 v[216:219], v[184:187], v[162:165], v[216:219]
  s_waitcnt lgkmcnt(5)
  v_add_f32 v153, v153, v93
  v_fmac_f32 v152, v93, v93
  v_mfma_f32_16x16x32_bf16 v[196:199], a[72:75], v[124:127], 0
  s_waitcnt lgkmcnt(4)
  buffer_load_dwordx4 v182, s[4:7], s42 offen offset:864 nt lds
  v_mfma_f32_16x16x32_bf16 v[196:199], a[76:79], v[128:131], v[196:199]
  s_waitcnt lgkmcnt(3)
  v_add_f32 v153, v153, v94
  v_fmac_f32 v152, v94, v94
  v_mfma_f32_16x16x32_bf16 v[196:199], a[80:83], v[132:135], v[196:199]
  s_waitcnt lgkmcnt(2)
  v_add_f32 v153, v153, v95
  v_fmac_f32 v152, v95, v95
  v_mfma_f32_16x16x32_bf16 v[196:199], a[84:87], v[140:143], v[196:199]
  s_waitcnt lgkmcnt(1)
  ds_write_b32 v107, v104
  v_mfma_f32_16x16x32_bf16 v[196:199], a[88:91], v[136:139], v[196:199]
  s_waitcnt lgkmcnt(1)
  v_permlane32_swap_b32 v153, v152
  v_mfma_f32_16x16x32_bf16 v[196:199], a[92:95], v[144:147], v[196:199]
  buffer_load_dwordx4 v182, s[4:7], s43 offen offset:1728 nt lds
  v_mfma_f32_16x16x32_bf16 v[224:227], a[96:99], v[124:127], 0
  v_add_f32 v153, v153, v152
  v_mov_b32 v152, v153
  v_mfma_f32_16x16x32_bf16 v[224:227], a[100:103], v[128:131], v[224:227]
  s_nop 0
  v_permlane16_swap_b32 v153, v152
  v_mfma_f32_16x16x32_bf16 v[224:227], a[104:107], v[132:135], v[224:227]
  v_add_f32 v153, v153, v152
  v_cvt_pk_bf16_f32 v202, v236, v237
  v_mfma_f32_16x16x32_bf16 v[224:227], a[108:111], v[140:143], v[224:227]
  buffer_load_dwordx4 v182, s[4:7], s44 offen offset:2592 nt lds
  v_mfma_f32_16x16x32_bf16 v[224:227], a[112:115], v[136:139], v[224:227]
  ds_write_b32 v107, v153 offset:512
  v_mfma_f32_16x16x32_bf16 v[224:227], a[116:119], v[144:147], v[224:227]
  s_waitcnt lgkmcnt(1)
  v_cvt_pk_bf16_f32 v203, v238, v239
  v_exp_f32 v240, v240
  v_exp_f32 v241, v241
  v_exp_f32 v242, v242
  v_exp_f32 v243, v243
  v_exp_f32 v216, v216
  v_exp_f32 v217, v217
  v_exp_f32 v218, v218
  v_exp_f32 v219, v219
  v_cvt_pk_bf16_f32 v148, v196, v197
  s_waitcnt lgkmcnt(0)
  s_barrier
  v_mfma_f32_16x16x32_bf16 v[212:215], a[120:123], v[124:127], 0
  ds_read_b128 v[220:223], v15
  ds_read_b128 v[228:231], v15 offset:1024
  v_mfma_f32_16x16x32_bf16 v[212:215], a[124:127], v[128:131], v[212:215]
  v_cvt_pk_bf16_f32 v149, v198, v199
  v_cvt_pk_bf16_f32 v150, v224, v225
  v_mfma_f32_16x16x32_bf16 v[212:215], a[128:131], v[132:135], v[212:215]
  v_cvt_pk_bf16_f32 v151, v226, v227
  v_cvt_pk_bf16_f32 v206, v240, v241
  v_mfma_f32_16x16x32_bf16 v[212:215], a[132:135], v[140:143], v[212:215]
  v_cvt_pk_bf16_f32 v207, v242, v243
  v_cvt_pk_bf16_f32 v224, v216, v217
  v_mfma_f32_16x16x32_bf16 v[212:215], a[136:139], v[136:139], v[212:215]
  v_cvt_pk_bf16_f32 v225, v218, v219
  v_mfma_f32_16x16x32_bf16 v[212:215], a[140:143], v[144:147], v[212:215]
  v_mfma_f32_16x16x16_bf16 v[216:219], v[172:173], v[166:167], 0
  ds_read_b64 v[240:241], v19 offset:16
  v_mfma_f32_16x16x16_bf16 v[196:199], v[172:173], v[160:161], 0
  ds_read2_b64 v[236:239], v19 offset0:0 offset1:1
  v_cvt_pk_bf16_f32 v152, v212, v213
  v_cvt_pk_bf16_f32 v153, v214, v215
  v_add_u32 v19, 1160, v19
  v_mfma_f32_16x16x32_bf16 v[216:219], v[168:171], v[162:165], v[216:219]
  s_waitcnt lgkmcnt(2)
  v_add_f32 v220, v220, v221
  v_add_f32 v222, v222, v223
  v_mfma_f32_16x16x32_bf16 v[196:199], v[168:171], v[156:159], v[196:199]
  v_add_f32 v228, v228, v229
  v_add_f32 v230, v230, v231
  v_mfma_f32_16x16x32_bf16 v[212:215], v[124:127], a[144:147], 0
  v_exp_f32 v216, v216
  v_mfma_f32_16x16x32_bf16 v[212:215], v[128:131], a[148:151], v[212:215]
  v_exp_f32 v217, v217
  v_mfma_f32_16x16x32_bf16 v[212:215], v[132:135], a[152:155], v[212:215]
  v_exp_f32 v218, v218
  v_mfma_f32_16x16x32_bf16 v[212:215], v[140:143], a[156:159], v[212:215]
  v_exp_f32 v219, v219
  v_mfma_f32_16x16x32_bf16 v[212:215], v[136:139], a[160:163], v[212:215]
  v_exp_f32 v196, v196
  v_mfma_f32_16x16x32_bf16 v[212:215], v[144:147], a[164:167], v[212:215]
  v_exp_f32 v197, v197
  v_mfma_f32_16x16x32_bf16 v[242:245], v[124:127], a[168:171], 0
  v_exp_f32 v198, v198
  v_mfma_f32_16x16x32_bf16 v[242:245], v[128:131], a[172:175], v[242:245]
  v_exp_f32 v199, v199
  v_mfma_f32_16x16x32_bf16 v[242:245], v[132:135], a[176:179], v[242:245]
  v_cvt_pk_bf16_f32 v226, v216, v217
  v_cvt_pk_bf16_f32 v227, v218, v219
  v_mfma_f32_16x16x32_bf16 v[242:245], v[140:143], a[180:183], v[242:245]
  v_cvt_pk_bf16_f32 v104, v212, v213
  v_cvt_pk_bf16_f32 v105, v214, v215
  v_mfma_f32_16x16x32_bf16 v[242:245], v[136:139], a[184:187], v[242:245]
  v_cvt_pk_bf16_f32 v192, v196, v197
  v_cvt_pk_bf16_f32 v193, v198, v199
  v_mfma_f32_16x16x32_bf16 v[242:245], v[144:147], a[188:191], v[242:245]
  s_waitcnt lgkmcnt(1)
  v_add_f32 v220, v220, v222
  v_add_f32 v228, v228, v230
  v_mul_f32 v221, 0x3baaaaab, v220
  v_mfma_f32_16x16x16_bf16 v[196:199], v[152:153], v[180:181], 0
  v_fma_f32 v228, -v221, v220, v228
  v_max_f32 v228, 0, v228
  v_add_f32 v228, 0x3afba882, v228
  v_mfma_f32_16x16x16_bf16 v[212:215], v[240:241], v[180:181], v[2:5]
  v_cvt_pk_bf16_f32 v108, v242, v243
  v_cvt_pk_bf16_f32 v109, v244, v245
  v_rsq_f32 v228, v228
  v_mfma_f32_16x16x32_bf16 v[196:199], v[148:151], v[176:179], v[196:199]
  s_waitcnt lgkmcnt(0)
  v_mul_f32 v228, 0x40ca568a, v228
  v_mul_f32 v229, -v221, v228
  v_mfma_f32_16x16x32_bf16 v[212:215], v[236:239], v[176:179], v[212:215]
  ds_write_b64 v111, v[228:229]
  v_mfma_f32_16x16x32_bf16 v[228:231], v[124:127], a[192:195], 0
  ds_read_b64 v[242:243], v115 offset:768
  v_mfma_f32_16x16x32_bf16 v[228:231], v[128:131], a[196:199], v[228:231]
  v_exp_f32 v196, v196
  v_mfma_f32_16x16x32_bf16 v[228:231], v[132:135], a[200:203], v[228:231]
  ds_read_u16 v106, v20
  v_mfma_f32_16x16x32_bf16 v[228:231], v[140:143], a[204:207], v[228:231]
  v_exp_f32 v197, v197
  v_mfma_f32_16x16x32_bf16 v[228:231], v[136:139], a[208:211], v[228:231]
  ds_read_u16 v110, v20 offset:32
  v_cvt_pk_bf16_f32 v116, v196, v197
  v_mfma_f32_16x16x32_bf16 v[228:231], v[144:147], a[212:215], v[228:231]
  v_exp_f32 v198, v198
  v_mfma_f32_16x16x16_bf16 v[176:179], v[152:153], v[166:167], 0
  ds_read_u16 v114, v20 offset:64
  v_exp_f32 v199, v199
  v_mfma_f32_16x16x16_bf16 v[220:223], v[240:241], v[166:167], v[2:5]
  v_exp_f32 v212, v212
  v_cvt_pk_bf16_f32 v117, v198, v199
  v_cvt_pk_bf16_f32 v118, v212, 0
  v_mfma_f32_16x16x32_bf16 v[176:179], v[148:151], v[162:165], v[176:179]
  s_waitcnt lgkmcnt(3)
  v_cvt_pk_bf16_f32 v112, v228, v229
  v_cvt_pk_bf16_f32 v113, v230, v231
  v_mfma_f32_16x16x32_bf16 v[220:223], v[236:239], v[162:165], v[220:223]
  v_fma_f32 v228, v60, v242, v243
  v_fma_f32 v162, v61, v242, v243
  v_mfma_f32_16x16x32_bf16 v[212:215], a[0:3], v[124:127], 0
  v_exp_f32 v176, v176
  v_mfma_f32_16x16x32_bf16 v[212:215], a[4:7], v[128:131], v[212:215]
  v_exp_f32 v177, v177
  v_mfma_f32_16x16x32_bf16 v[212:215], a[8:11], v[132:135], v[212:215]
  v_exp_f32 v178, v178
  v_mfma_f32_16x16x32_bf16 v[212:215], a[12:15], v[140:143], v[212:215]
  v_exp_f32 v179, v179
  v_mfma_f32_16x16x32_bf16 v[212:215], a[16:19], v[136:139], v[212:215]
  v_exp_f32 v220, v220
  v_mfma_f32_16x16x32_bf16 v[212:215], a[20:23], v[144:147], v[212:215]
  v_cvt_pk_bf16_f32 v120, v176, v177
  v_cvt_pk_bf16_f32 v121, v178, v179
  v_mfma_f32_16x16x32_bf16 v[176:179], a[246:249], v[204:207], 0
  v_cvt_pk_bf16_f32 v122, v220, 0
  v_cvt_pk_bf16_f32 v228, v228, v162
  v_mfma_f32_16x16x32_bf16 v[176:179], a[246:249], v[116:119], v[176:179]
  v_cvt_pk_bf16_f32 v162, v212, v213
  v_cvt_pk_bf16_f32 v163, v214, v215
  v_mfma_f32_16x16x32_bf16 v[212:215], v[232:235], v[204:207], 0
  s_waitcnt lgkmcnt(2)
  v_fma_f32 v229, v62, v242, v243
  v_fma_f32 v220, v63, v242, v243
  v_mfma_f32_16x16x32_bf16 v[212:215], v[104:107], v[116:119], v[212:215]
  v_cvt_pk_bf16_f32 v229, v229, v220
  v_fma_f32 v230, v64, v242, v243
  v_mfma_f32_16x16x32_bf16 v[220:223], v[208:211], v[204:207], 0
  s_waitcnt lgkmcnt(1)
  v_fma_f32 v196, v65, v242, v243
  v_cvt_pk_bf16_f32 v230, v230, v196
  v_mfma_f32_16x16x32_bf16 v[220:223], v[108:111], v[116:119], v[220:223]
  v_fma_f32 v231, v66, v242, v243
  v_fma_f32 v244, v67, v242, v243
  v_mfma_f32_16x16x32_bf16 v[196:199], v[200:203], v[204:207], 0
  s_waitcnt lgkmcnt(0)
  v_cvt_pk_bf16_f32 v231, v231, v244
  v_fma_f32 v204, v68, v242, v243
  v_mfma_f32_16x16x32_bf16 v[196:199], v[112:115], v[116:119], v[196:199]
  ds_write_b128 v16, v[228:231] offset:2048
  v_mfma_f32_16x16x32_bf16 v[228:231], a[24:27], v[124:127], 0
  v_fma_f32 v244, v69, v242, v243
  v_cvt_pk_bf16_f32 v204, v204, v244
  v_mfma_f32_16x16x32_bf16 v[228:231], a[28:31], v[128:131], v[228:231]
  v_fma_f32 v205, v70, v242, v243
  v_fma_f32 v244, v71, v242, v243
  v_mfma_f32_16x16x32_bf16 v[228:231], a[32:35], v[132:135], v[228:231]
  v_cvt_pk_bf16_f32 v205, v205, v244
  v_mul_f32 v176, 0x3ee9a3cd, v176
  v_mfma_f32_16x16x32_bf16 v[228:231], a[36:39], v[140:143], v[228:231]
  ds_write_b64 v17, v[204:205] offset:2048
  v_mfma_f32_16x16x32_bf16 v[228:231], a[40:43], v[136:139], v[228:231]
  v_rcp_f32 v180, v176
  v_mfma_f32_16x16x32_bf16 v[228:231], a[44:47], v[144:147], v[228:231]
  v_mul_f32 v212, v212, v180
  v_mul_f32 v213, v213, v180
  v_cvt_pk_bf16_f32 v204, v212, v213
  v_mfma_f32_16x16x16_bf16 v[242:245], v[152:153], v[160:161], 0
  v_mul_f32 v214, v214, v180
  v_mul_f32 v215, v215, v180
  v_cvt_pk_bf16_f32 v205, v214, v215
  v_mfma_f32_16x16x16_bf16 v[212:215], v[240:241], v[160:161], v[2:5]
  v_cvt_pk_bf16_f32 v164, v228, v229
  v_cvt_pk_bf16_f32 v165, v230, v231
  v_mul_f32 v220, v220, v180
  v_mul_f32 v221, v221, v180
  v_mfma_f32_16x16x32_bf16 v[242:245], v[148:151], v[156:159], v[242:245]
  v_cvt_pk_bf16_f32 v206, v220, v221
  v_mul_f32 v222, v222, v180
  v_mfma_f32_16x16x32_bf16 v[212:215], v[236:239], v[156:159], v[212:215]
  v_mul_f32 v223, v223, v180
  v_cvt_pk_bf16_f32 v207, v222, v223
  v_mfma_f32_16x16x32_bf16 v[156:159], a[246:249], v[224:227], 0
  ds_write_b128 v16, v[204:207] offset:20480
  v_mfma_f32_16x16x32_bf16 v[156:159], a[246:249], v[120:123], v[156:159]
  v_exp_f32 v242, v242
  v_mfma_f32_16x16x32_bf16 v[204:207], v[232:235], v[224:227], 0
  v_exp_f32 v243, v243
  v_mfma_f32_16x16x32_bf16 v[204:207], v[104:107], v[120:123], v[204:207]
  v_exp_f32 v244, v244
  v_mfma_f32_16x16x32_bf16 v[220:223], v[208:211], v[224:227], 0
  v_exp_f32 v245, v245
  v_mfma_f32_16x16x32_bf16 v[220:223], v[108:111], v[120:123], v[220:223]
  v_exp_f32 v212, v212
  v_mfma_f32_16x16x32_bf16 v[228:231], v[200:203], v[224:227], 0
  v_cvt_pk_bf16_f32 v116, v242, v243
  v_cvt_pk_bf16_f32 v117, v244, v245
  v_mfma_f32_16x16x32_bf16 v[228:231], v[112:115], v[120:123], v[228:231]
  v_cvt_pk_bf16_f32 v118, v212, 0
  v_mul_f32 v156, 0x3ee9a3cd, v156
  v_mfma_f32_16x16x32_bf16 v[212:215], a[48:51], v[124:127], 0
  v_rcp_f32 v242, v156
  v_mfma_f32_16x16x32_bf16 v[212:215], a[52:55], v[128:131], v[212:215]
  v_mul_f32 v204, v204, v242
  v_mul_f32 v205, v205, v242
  v_mfma_f32_16x16x32_bf16 v[212:215], a[56:59], v[132:135], v[212:215]
  v_cvt_pk_bf16_f32 v124, v204, v205
  v_mul_f32 v206, v206, v242
  v_mfma_f32_16x16x32_bf16 v[212:215], a[60:63], v[140:143], v[212:215]
  v_mul_f32 v207, v207, v242
  v_cvt_pk_bf16_f32 v125, v206, v207
  v_mfma_f32_16x16x32_bf16 v[212:215], a[64:67], v[136:139], v[212:215]
  v_mul_f32 v220, v220, v242
  v_mul_f32 v221, v221, v242
  v_mfma_f32_16x16x32_bf16 v[212:215], a[68:71], v[144:147], v[212:215]
  s_waitcnt lgkmcnt(1)
  s_barrier
  v_mfma_f32_16x16x32_bf16 v[204:207], v[190:193], a[246:249], 0
  v_cvt_pk_bf16_f32 v126, v220, v221
  v_mul_f32 v222, v222, v242
  v_mfma_f32_16x16x32_bf16 v[204:207], v[116:119], a[246:249], v[204:207]
  v_cvt_pk_bf16_f32 v166, v212, v213
  v_cvt_pk_bf16_f32 v167, v214, v215
  v_mfma_f32_16x16x32_bf16 v[136:139], v[190:193], v[232:235], 0
  v_mul_f32 v223, v223, v242
  v_cvt_pk_bf16_f32 v127, v222, v223
  v_mfma_f32_16x16x32_bf16 v[136:139], v[116:119], v[104:107], v[136:139]
  ds_write_b128 v16, v[124:127] offset:26624
  v_mfma_f32_16x16x32_bf16 v[144:147], v[190:193], v[208:211], 0
  v_mul_f32 v204, 0x3ee9a3cd, v204
  v_mul_f32 v196, v196, v180
  v_mfma_f32_16x16x32_bf16 v[144:147], v[116:119], v[108:111], v[144:147]
  ds_read_b128 v[124:127], v15 offset:2048
  v_mul_f32 v197, v197, v180
  v_mfma_f32_16x16x32_bf16 v[140:143], v[190:193], v[200:203], 0
  ds_read_b128 v[128:131], v15 offset:3072
  v_cvt_pk_bf16_f32 v120, v196, v197
  v_mfma_f32_16x16x32_bf16 v[140:143], v[116:119], v[112:115], v[140:143]
  ds_read_b128 v[132:135], v15 offset:4096
  v_rcp_f32 v116, v204
  v_mfma_f32_16x16x16_bf16 v[190:193], v[188:189], v[166:167], 0
  v_cndmask_b32 v122, v144, v136, s[54:55]
  v_mul_f32 v198, v198, v180
  v_mul_f32 v199, v199, v180
  v_mfma_f32_16x16x16_bf16 v[220:223], v[172:173], v[166:167], 0
  v_cvt_pk_bf16_f32 v121, v198, v199
  v_mul_f32 v228, v228, v242
  v_mul_f32 v229, v229, v242
  v_mfma_f32_16x16x16_bf16 v[196:199], v[152:153], v[166:167], 0
  v_cvt_pk_bf16_f32 v160, v228, v229
  v_mul_f32 v230, v230, v242
  v_mul_f32 v231, v231, v242
  v_mfma_f32_16x16x16_bf16 v[212:215], v[240:241], v[166:167], v[2:5]
  v_cvt_pk_bf16_f32 v161, v230, v231
  v_cndmask_b32 v122, v140, v122, s[56:57]
  v_mul_f32 v122, v122, v116
  v_cvt_pk_bf16_f32 v122, v122, v122
  v_mfma_f32_16x16x32_bf16 v[190:193], v[184:187], v[162:165], v[190:193]
  ds_read_b128 v[136:139], v15 offset:5120
  ds_read_b128 v[140:143], v15 offset:6144
  v_mfma_f32_16x16x32_bf16 v[220:223], v[168:171], v[162:165], v[220:223]
  ds_read_b128 v[144:147], v15 offset:7168
  v_max3_f32 v1, v1, v176, v180
  v_mfma_f32_16x16x32_bf16 v[196:199], v[148:151], v[162:165], v[196:199]
  ds_write_b64 v17, v[120:121] offset:20480
  v_mfma_f32_16x16x32_bf16 v[212:215], v[236:239], v[162:165], v[212:215]
  s_waitcnt lgkmcnt(6)
  v_exp_f32 v190, v190
  v_mfma_f32_16x16x32_bf16 v[162:165], a[0:3], v[124:127], 0
  s_waitcnt lgkmcnt(5)
  ds_write_b64 v17, v[160:161] offset:26624
  v_mfma_f32_16x16x32_bf16 v[162:165], a[4:7], v[128:131], v[162:165]
  s_waitcnt lgkmcnt(5)
  ds_write_b16 v20, v122 offset:384
  v_mfma_f32_16x16x32_bf16 v[162:165], a[8:11], v[132:135], v[162:165]
  s_waitcnt lgkmcnt(5)
  v_exp_f32 v191, v191
  v_mfma_f32_16x16x32_bf16 v[162:165], a[12:15], v[136:139], v[162:165]
  s_waitcnt lgkmcnt(4)
  v_exp_f32 v192, v192
  v_mfma_f32_16x16x32_bf16 v[162:165], a[16:19], v[140:143], v[162:165]
  s_waitcnt lgkmcnt(3)
  v_exp_f32 v193, v193
  v_mfma_f32_16x16x32_bf16 v[162:165], a[20:23], v[144:147], v[162:165]
  v_exp_f32 v220, v220
  v_mfma_f32_16x16x32_bf16 v[236:239], a[24:27], v[124:127], 0
  v_exp_f32 v221, v221
  v_mfma_f32_16x16x32_bf16 v[236:239], a[28:31], v[128:131], v[236:239]
  v_exp_f32 v222, v222
  v_mfma_f32_16x16x32_bf16 v[236:239], a[32:35], v[132:135], v[236:239]
  v_exp_f32 v223, v223
  v_mfma_f32_16x16x32_bf16 v[236:239], a[36:39], v[136:139], v[236:239]
  v_exp_f32 v196, v196
  v_mfma_f32_16x16x32_bf16 v[236:239], a[40:43], v[140:143], v[236:239]
  v_exp_f32 v197, v197
  v_mfma_f32_16x16x32_bf16 v[236:239], a[44:47], v[144:147], v[236:239]
  v_exp_f32 v198, v198
  v_mfma_f32_16x16x32_bf16 v[176:179], a[48:51], v[124:127], 0
  v_exp_f32 v199, v199
  v_mfma_f32_16x16x32_bf16 v[176:179], a[52:55], v[128:131], v[176:179]
  v_exp_f32 v212, v212
  v_mfma_f32_16x16x32_bf16 v[176:179], a[56:59], v[132:135], v[176:179]
  v_cvt_pk_bf16_f32 v168, v190, v191
  v_cvt_pk_bf16_f32 v169, v192, v193
  v_mfma_f32_16x16x32_bf16 v[176:179], a[60:63], v[136:139], v[176:179]
  v_cvt_pk_bf16_f32 v170, v220, v221
  v_cvt_pk_bf16_f32 v171, v222, v223
  v_mfma_f32_16x16x32_bf16 v[176:179], a[64:67], v[140:143], v[176:179]
  v_cvt_pk_bf16_f32 v148, v162, v163
  v_cvt_pk_bf16_f32 v149, v164, v165
  v_mfma_f32_16x16x32_bf16 v[176:179], a[68:71], v[144:147], v[176:179]
  v_cvt_pk_bf16_f32 v120, v196, v197
  v_cvt_pk_bf16_f32 v121, v198, v199
  v_mfma_f32_16x16x32_bf16 v[162:165], a[246:249], v[168:171], 0
  v_cvt_pk_bf16_f32 v122, v212, 0
  v_cvt_pk_bf16_f32 v150, v236, v237
  v_cvt_pk_bf16_f32 v151, v238, v239
  v_mfma_f32_16x16x32_bf16 v[162:165], a[246:249], v[120:123], v[162:165]
  v_cvt_pk_bf16_f32 v152, v176, v177
  v_cvt_pk_bf16_f32 v153, v178, v179
  v_mfma_f32_16x16x32_bf16 v[176:179], v[232:235], v[168:171], 0
  v_max3_f32 v1, v1, v156, v242
  v_max3_f32 v1, v1, v204, v116
  v_mfma_f32_16x16x32_bf16 v[176:179], v[104:107], v[120:123], v[176:179]
  v_mul_f32 v162, 0x3ee9a3cd, v162
  v_add_u32 v20, 1160, v20
  v_mfma_f32_16x16x32_bf16 v[156:159], v[208:211], v[168:171], 0
  v_rcp_f32 v160, v162
  v_mfma_f32_16x16x32_bf16 v[156:159], v[108:111], v[120:123], v[156:159]
  v_mul_f32 v176, v176, v160
  v_mul_f32 v177, v177, v160
  v_mfma_f32_16x16x32_bf16 v[208:211], v[200:203], v[168:171], 0
  v_mul_f32 v178, v178, v160
  v_mul_f32 v179, v179, v160
  v_mfma_f32_16x16x32_bf16 v[208:211], v[112:115], v[120:123], v[208:211]
  v_mul_f32 v156, v156, v160
  v_mul_f32 v157, v157, v160
  v_mfma_f32_16x16x32_bf16 v[168:171], a[72:75], v[124:127], 0
  v_mul_f32 v158, v158, v160
  v_mul_f32 v159, v159, v160
  v_mfma_f32_16x16x32_bf16 v[168:171], a[76:79], v[128:131], v[168:171]
  v_cvt_pk_bf16_f32 v200, v176, v177
  v_cvt_pk_bf16_f32 v201, v178, v179
  v_mfma_f32_16x16x32_bf16 v[168:171], a[80:83], v[132:135], v[168:171]
  v_cvt_pk_bf16_f32 v202, v156, v157
  v_cvt_pk_bf16_f32 v203, v158, v159
  v_mfma_f32_16x16x32_bf16 v[168:171], a[84:87], v[136:139], v[168:171]
  ds_write_b128 v16, v[200:203] offset:32768
  v_mfma_f32_16x16x32_bf16 v[168:171], a[88:91], v[140:143], v[168:171]
  v_mul_f32 v208, v208, v160
  v_mul_f32 v209, v209, v160
  v_mfma_f32_16x16x32_bf16 v[168:171], a[92:95], v[144:147], v[168:171]
  v_mul_f32 v210, v210, v160
  v_mul_f32 v211, v211, v160
  v_mfma_f32_16x16x32_bf16 v[200:203], a[96:99], v[124:127], 0
  v_cvt_pk_bf16_f32 v156, v208, v209
  v_cvt_pk_bf16_f32 v157, v210, v211
  v_mfma_f32_16x16x32_bf16 v[200:203], a[100:103], v[128:131], v[200:203]
  ds_write_b64 v17, v[156:157] offset:32768
  v_mfma_f32_16x16x32_bf16 v[200:203], a[104:107], v[132:135], v[200:203]
  v_cvt_pk_bf16_f32 v154, v168, v169
  v_cvt_pk_bf16_f32 v155, v170, v171
  v_mfma_f32_16x16x32_bf16 v[200:203], a[108:111], v[136:139], v[200:203]
  v_max3_f32 v1, v1, v162, v160
  v_mfma_f32_16x16x32_bf16 v[200:203], a[112:115], v[140:143], v[200:203]
  v_mfma_f32_16x16x32_bf16 v[200:203], a[116:119], v[144:147], v[200:203]
  v_mfma_f32_16x16x32_bf16 v[160:163], a[120:123], v[124:127], 0
  v_mfma_f32_16x16x32_bf16 v[160:163], a[124:127], v[128:131], v[160:163]
  v_cvt_pk_bf16_f32 v156, v200, v201
  v_cvt_pk_bf16_f32 v157, v202, v203
  v_mfma_f32_16x16x32_bf16 v[160:163], a[128:131], v[132:135], v[160:163]
  v_mfma_f32_16x16x32_bf16 v[160:163], a[132:135], v[136:139], v[160:163]
  v_mfma_f32_16x16x32_bf16 v[160:163], a[136:139], v[140:143], v[160:163]
  v_mfma_f32_16x16x32_bf16 v[160:163], a[140:143], v[144:147], v[160:163]
  s_waitcnt lgkmcnt(0)
  s_barrier
  s_mov_b32 s70, 10
.p2align 6
L_loop:
  v_mfma_f32_16x16x32_bf16 v[168:171], v[124:127], a[144:147], 0
  ds_read_b128 v[172:175], v15 offset:20480
  ds_read_b128 v[164:167], v15 offset:26624
  v_mfma_f32_16x16x32_bf16 v[168:171], v[128:131], a[148:151], v[168:171]
  ds_read_b128 v[176:179], v15 offset:32768
  v_cvt_pk_bf16_f32 v158, v160, v161
  v_mfma_f32_16x16x32_bf16 v[168:171], v[132:135], a[152:155], v[168:171]
  ds_read_b64 v[212:213], v115 offset:896
  ds_read_b64 v[216:217], v115 offset:1792
  v_mfma_f32_16x16x32_bf16 v[168:171], v[136:139], a[156:159], v[168:171]
  v_cvt_pk_bf16_f32 v159, v162, v163
  v_mfma_f32_16x16x32_bf16 v[168:171], v[140:143], a[160:163], v[168:171]
  v_mfma_f32_16x16x32_bf16 v[168:171], v[144:147], a[164:167], v[168:171]
  s_waitcnt lgkmcnt(4)
  v_mfma_f32_16x16x32_bf16 v[24:27], a[250:253], v[172:175], v[24:27]
  v_mfma_f32_16x16x32_bf16 v[28:31], v[96:99], v[172:175], v[28:31]
  v_cvt_pk_bf16_f32 v200, v168, v169
  v_cvt_pk_bf16_f32 v201, v170, v171
  v_mfma_f32_16x16x32_bf16 v[32:35], v[100:103], v[172:175], v[32:35]
  s_waitcnt lgkmcnt(1)
  ds_read_b128 v[168:171], v18
  ds_read_b128 v[172:175], v15 offset:21504
  v_mfma_f32_16x16x32_bf16 v[36:39], a[250:253], v[164:167], v[36:39]
  s_waitcnt lgkmcnt(2)
  ds_read_b128 v[160:163], v18 offset:1024
  v_fma_f32 v180, v72, v212, v213
  v_mfma_f32_16x16x32_bf16 v[40:43], v[96:99], v[164:167], v[40:43]
  ds_read_b128 v[184:187], v18 offset:2048
  v_fma_f32 v188, v73, v212, v213
  v_mfma_f32_16x16x32_bf16 v[44:47], v[100:103], v[164:167], v[44:47]
  ds_read_b128 v[164:167], v15 offset:27648
  v_cvt_pk_bf16_f32 v180, v180, v188
  v_mfma_f32_16x16x32_bf16 v[48:51], a[250:253], v[176:179], v[48:51]
  v_fma_f32 v181, v74, v212, v213
  v_fma_f32 v188, v75, v212, v213
  v_mfma_f32_16x16x32_bf16 v[52:55], v[96:99], v[176:179], v[52:55]
  v_cvt_pk_bf16_f32 v181, v181, v188
  v_fma_f32 v182, v76, v212, v213
  v_mfma_f32_16x16x32_bf16 v[56:59], v[100:103], v[176:179], v[56:59]
  ds_read_b128 v[176:179], v15 offset:33792
  v_fma_f32 v204, v77, v212, v213
  v_mfma_f32_16x16x32_bf16 v[188:191], v[124:127], a[168:171], 0
  v_cvt_pk_bf16_f32 v182, v182, v204
  v_fma_f32 v183, v78, v212, v213
  v_mfma_f32_16x16x32_bf16 v[188:191], v[128:131], a[172:175], v[188:191]
  v_fma_f32 v204, v79, v212, v213
  v_cvt_pk_bf16_f32 v183, v183, v204
  v_mfma_f32_16x16x32_bf16 v[188:191], v[132:135], a[176:179], v[188:191]
  ds_write_b128 v16, v[180:183] offset:8192
  v_mfma_f32_16x16x32_bf16 v[188:191], v[136:139], a[180:183], v[188:191]
  v_fma_f32 v180, v84, v216, v217
  v_fma_f32 v204, v85, v216, v217
  v_mfma_f32_16x16x32_bf16 v[188:191], v[140:143], a[184:187], v[188:191]
  v_cvt_pk_bf16_f32 v180, v180, v204
  v_fma_f32 v181, v86, v216, v217
  v_mfma_f32_16x16x32_bf16 v[188:191], v[144:147], a[188:191], v[188:191]
  s_waitcnt lgkmcnt(5)
  v_fma_f32 v204, v87, v216, v217
  v_cvt_pk_bf16_f32 v181, v181, v204
  v_mfma_f32_16x16x32_bf16 v[24:27], v[168:171], v[172:175], v[24:27]
  s_waitcnt lgkmcnt(4)
  v_fma_f32 v182, v88, v216, v217
  v_fma_f32 v208, v89, v216, v217
  v_mfma_f32_16x16x32_bf16 v[28:31], v[160:163], v[172:175], v[28:31]
  s_waitcnt lgkmcnt(3)
  v_cvt_pk_bf16_f32 v204, v188, v189
  v_cvt_pk_bf16_f32 v205, v190, v191
  v_mfma_f32_16x16x32_bf16 v[32:35], v[184:187], v[172:175], v[32:35]
  s_waitcnt lgkmcnt(2)
  ds_read_b128 v[188:191], v18 offset:3072
  ds_read_b128 v[192:195], v15 offset:22528
  v_mfma_f32_16x16x32_bf16 v[36:39], v[168:171], v[164:167], v[36:39]
  ds_read_b128 v[196:199], v18 offset:4096
  v_cvt_pk_bf16_f32 v182, v182, v208
  v_mfma_f32_16x16x32_bf16 v[40:43], v[160:163], v[164:167], v[40:43]
  ds_read_b128 v[208:211], v18 offset:5120
  v_fma_f32 v183, v90, v216, v217
  v_mfma_f32_16x16x32_bf16 v[44:47], v[184:187], v[164:167], v[44:47]
  s_waitcnt lgkmcnt(5)
  ds_read_b128 v[164:167], v15 offset:28672
  v_fma_f32 v172, v91, v216, v217
  v_mfma_f32_16x16x32_bf16 v[48:51], v[168:171], v[176:179], v[48:51]
  v_cvt_pk_bf16_f32 v183, v183, v172
  v_fma_f32 v214, v80, v212, v213
  v_mfma_f32_16x16x32_bf16 v[52:55], v[160:163], v[176:179], v[52:55]
  ds_write_b128 v16, v[180:183] offset:14336
  v_mfma_f32_16x16x32_bf16 v[56:59], v[184:187], v[176:179], v[56:59]
  v_fma_f32 v176, v81, v212, v213
  v_cvt_pk_bf16_f32 v214, v214, v176
  v_mfma_f32_16x16x32_bf16 v[176:179], v[124:127], a[192:195], 0
  ds_read_b128 v[124:127], v15 offset:34816
  ds_read_b64 v[172:173], v19 offset:784
  v_mfma_f32_16x16x32_bf16 v[176:179], v[128:131], a[196:199], v[176:179]
  ds_read2_b64 v[168:171], v19 offset0:96 offset1:97
  v_fma_f32 v215, v82, v212, v213
  v_mfma_f32_16x16x32_bf16 v[176:179], v[132:135], a[200:203], v[176:179]
  v_fma_f32 v128, v83, v212, v213
  v_cvt_pk_bf16_f32 v215, v215, v128
  v_mfma_f32_16x16x32_bf16 v[176:179], v[136:139], a[204:207], v[176:179]
  ds_write_b64 v17, v[214:215] offset:8192
  v_mfma_f32_16x16x32_bf16 v[176:179], v[140:143], a[208:211], v[176:179]
  v_fma_f32 v128, v92, v216, v217
  v_fma_f32 v140, v93, v216, v217
  v_mfma_f32_16x16x32_bf16 v[176:179], v[144:147], a[212:215], v[176:179]
  s_waitcnt lgkmcnt(8)
  v_cvt_pk_bf16_f32 v128, v128, v140
  v_fma_f32 v129, v94, v216, v217
  v_mfma_f32_16x16x32_bf16 v[24:27], v[188:191], v[192:195], v[24:27]
  s_waitcnt lgkmcnt(7)
  ds_read_b128 v[144:147], v18 offset:6144
  ds_read_b128 v[140:143], v15 offset:23552
  v_mfma_f32_16x16x32_bf16 v[28:31], v[196:199], v[192:195], v[28:31]
  s_waitcnt lgkmcnt(8)
  ds_read_b128 v[136:139], v18 offset:7168
  v_cvt_pk_bf16_f32 v212, v176, v177
  v_mfma_f32_16x16x32_bf16 v[32:35], v[208:211], v[192:195], v[32:35]
  s_waitcnt lgkmcnt(8)
  ds_read_b128 v[132:135], v18 offset:8192
  v_cvt_pk_bf16_f32 v213, v178, v179
  v_mfma_f32_16x16x32_bf16 v[36:39], v[188:191], v[164:167], v[36:39]
  ds_read_b128 v[176:179], v15 offset:29696
  v_fma_f32 v130, v95, v216, v217
  v_mfma_f32_16x16x32_bf16 v[40:43], v[196:199], v[164:167], v[40:43]
  v_cvt_pk_bf16_f32 v129, v129, v130
  v_mfma_f32_16x16x32_bf16 v[44:47], v[208:211], v[164:167], v[44:47]
  s_waitcnt lgkmcnt(8)
  ds_write_b64 v17, v[128:129] offset:14336
  v_mfma_f32_16x16x32_bf16 v[48:51], v[188:191], v[124:127], v[48:51]
  ds_read_b128 v[164:167], v15 offset:35840
  v_mfma_f32_16x16x32_bf16 v[52:55], v[196:199], v[124:127], v[52:55]
  v_mfma_f32_16x16x32_bf16 v[56:59], v[208:211], v[124:127], v[56:59]
  s_waitcnt lgkmcnt(9)
  v_mfma_f32_16x16x16_bf16 v[124:127], v[158:159], v[152:153], 0
  ds_read_b128 v[128:131], v18 offset:9216
  ds_read_b128 v[160:163], v15 offset:24576
  v_mfma_f32_16x16x16_bf16 v[180:183], v[158:159], v[172:173], 0
  ds_read_b128 v[188:191], v18 offset:10240
  v_mfma_f32_16x16x32_bf16 v[124:127], v[154:157], v[148:151], v[124:127]
  s_waitcnt lgkmcnt(11)
  ds_read_b128 v[208:211], v18 offset:11264
  v_mfma_f32_16x16x32_bf16 v[180:183], v[154:157], v[168:171], v[180:183]
  s_waitcnt lgkmcnt(9)
  ds_read_b128 v[196:199], v15 offset:30720
  v_mfma_f32_16x16x32_bf16 v[24:27], v[144:147], v[140:143], v[24:27]
  s_waitcnt lgkmcnt(9)
  v_exp_f32 v124, v124
  v_mfma_f32_16x16x32_bf16 v[28:31], v[136:139], v[140:143], v[28:31]
  s_waitcnt lgkmcnt(8)
  v_exp_f32 v125, v125
  v_mfma_f32_16x16x32_bf16 v[32:35], v[132:135], v[140:143], v[32:35]
  s_waitcnt lgkmcnt(7)
  ds_read_b128 v[140:143], v15 offset:36864
  v_cvt_pk_bf16_f32 v216, v124, v125
  v_mfma_f32_16x16x32_bf16 v[36:39], v[144:147], v[176:179], v[36:39]
  v_exp_f32 v126, v126
  v_mfma_f32_16x16x32_bf16 v[40:43], v[136:139], v[176:179], v[40:43]
  v_exp_f32 v127, v127
  v_mfma_f32_16x16x32_bf16 v[44:47], v[132:135], v[176:179], v[44:47]
  s_waitcnt lgkmcnt(6)
  ds_read_b128 v[176:179], v18 offset:12288
  ds_read_b128 v[184:187], v15 offset:25600
  v_mfma_f32_16x16x32_bf16 v[48:51], v[144:147], v[164:167], v[48:51]
  ds_read_b128 v[144:147], v18 offset:13312
  v_cvt_pk_bf16_f32 v217, v126, v127
  v_mfma_f32_16x16x32_bf16 v[52:55], v[136:139], v[164:167], v[52:55]
  ds_read_b128 v[136:139], v18 offset:14336
  v_mfma_f32_16x16x32_bf16 v[56:59], v[132:135], v[164:167], v[56:59]
  s_waitcnt lgkmcnt(8)
  ds_read_b128 v[132:135], v15 offset:31744
  v_mfma_f32_16x16x32_bf16 v[24:27], v[128:131], v[160:163], v[24:27]
  s_waitcnt lgkmcnt(8)
  v_exp_f32 v180, v180
  v_mfma_f32_16x16x32_bf16 v[28:31], v[188:191], v[160:163], v[28:31]
  s_waitcnt lgkmcnt(7)
  v_exp_f32 v181, v181
  v_mfma_f32_16x16x32_bf16 v[32:35], v[208:211], v[160:163], v[32:35]
  s_waitcnt lgkmcnt(6)
  v_exp_f32 v182, v182
  v_mfma_f32_16x16x32_bf16 v[36:39], v[128:131], v[196:199], v[36:39]
  v_exp_f32 v183, v183
  v_mfma_f32_16x16x32_bf16 v[40:43], v[188:191], v[196:199], v[40:43]
  ds_read_b128 v[124:127], v15 offset:37888
  v_cvt_pk_bf16_f32 v220, v180, v181
  v_mfma_f32_16x16x32_bf16 v[44:47], v[208:211], v[196:199], v[44:47]
  s_waitcnt lgkmcnt(6)
  v_cvt_pk_bf16_f32 v221, v182, v183
  v_mfma_f32_16x16x32_bf16 v[48:51], v[128:131], v[140:143], v[48:51]
  v_mfma_f32_16x16x32_bf16 v[52:55], v[188:191], v[140:143], v[52:55]
  v_mfma_f32_16x16x32_bf16 v[56:59], v[208:211], v[140:143], v[56:59]
  s_waitcnt lgkmcnt(4)
  s_barrier
  v_mfma_f32_16x16x32_bf16 v[24:27], v[176:179], v[184:187], v[24:27]
  s_waitcnt lgkmcnt(3)
  ds_read_b128 v[194:197], v15 offset:8192
  ds_read_b128 v[190:193], v15 offset:9216
  v_mfma_f32_16x16x32_bf16 v[28:31], v[144:147], v[184:187], v[28:31]
  s_waitcnt lgkmcnt(4)
  ds_read_b128 v[208:211], v15 offset:10240
  v_mfma_f32_16x16x32_bf16 v[32:35], v[136:139], v[184:187], v[32:35]
  s_waitcnt lgkmcnt(4)
  ds_read_b128 v[224:227], v15 offset:11264
  v_cvt_pk_bf16_f32 v140, v24, v25
  v_mfma_f32_16x16x32_bf16 v[36:39], v[176:179], v[132:135], v[36:39]
  ds_read_b128 v[228:231], v15 offset:12288
  v_cvt_pk_bf16_f32 v141, v26, v27
  v_mfma_f32_16x16x32_bf16 v[40:43], v[144:147], v[132:135], v[40:43]
  ds_read_b128 v[232:235], v15 offset:13312
  v_cvt_pk_bf16_f32 v142, v28, v29
  v_mfma_f32_16x16x32_bf16 v[44:47], v[136:139], v[132:135], v[44:47]
  s_waitcnt lgkmcnt(6)
  v_cvt_pk_bf16_f32 v143, v30, v31
  v_cvt_pk_bf16_f32 v236, v32, v33
  v_mfma_f32_16x16x32_bf16 v[48:51], v[176:179], v[124:127], v[48:51]
  s_waitcnt vmcnt(0)
  ds_read_b64 v[176:177], v9
  ds_read_b64 v[178:179], v9 offset:32
  v_mfma_f32_16x16x32_bf16 v[52:55], v[144:147], v[124:127], v[52:55]
  s_lshl_b32 s60, s31, 5
  ds_read_b64 v[160:161], v9 offset:64
  v_cvt_pk_bf16_f32 v237, v34, v35
  v_mfma_f32_16x16x32_bf16 v[56:59], v[136:139], v[124:127], v[56:59]
  s_waitcnt lgkmcnt(8)
  v_permlane16_swap_b32 v140, v142
  v_mfma_f32_16x16x32_bf16 v[184:187], a[72:75], v[194:197], 0
  s_waitcnt lgkmcnt(7)
  v_permlane16_swap_b32 v141, v143
  v_mfma_f32_16x16x32_bf16 v[184:187], a[76:79], v[190:193], v[184:187]
  s_waitcnt lgkmcnt(6)
  buffer_store_dwordx4 v[140:143], v12, s[8:11], s32 offen
  s_nop 1
  ds_read_b128 v[140:143], v3
  v_mfma_f32_16x16x32_bf16 v[184:187], a[80:83], v[208:211], v[184:187]
  s_waitcnt lgkmcnt(6)
  ds_read_b128 v[144:147], v3 offset:864
  ds_read_b128 v[132:135], v3 offset:1728
  v_mfma_f32_16x16x32_bf16 v[184:187], a[84:87], v[224:227], v[184:187]
  s_waitcnt lgkmcnt(7)
  ds_read_b128 v[136:139], v6
  v_cvt_pk_bf16_f32 v240, v36, v37
  v_mfma_f32_16x16x32_bf16 v[184:187], a[88:91], v[228:231], v[184:187]
  s_waitcnt lgkmcnt(7)
  ds_read_b128 v[124:127], v3 offset:32
  v_cvt_pk_bf16_f32 v241, v38, v39
  v_mfma_f32_16x16x32_bf16 v[184:187], a[92:95], v[232:235], v[184:187]
  s_waitcnt lgkmcnt(5)
  ds_read_b128 v[128:131], v3 offset:896
  v_cvt_pk_bf16_f32 v242, v40, v41
  v_cvt_pk_bf16_f32 v243, v42, v43
  v_mfma_f32_16x16x16_bf16 v[24:27], a[224:225], v[176:177], 0
  v_permlane16_swap_b32 v240, v242
  v_cvt_pk_bf16_f32 v238, v44, v45
  v_mfma_f32_16x16x16_bf16 v[28:31], a[234:235], v[178:179], 0
  v_permlane16_swap_b32 v241, v243
  v_cvt_pk_bf16_f32 v176, v184, v185
  v_mfma_f32_16x16x16_bf16 v[32:35], a[244:245], v[160:161], 0
  s_add_u32 s61, s60, s30
  ds_read_b128 v[160:163], v3 offset:1760
  ds_read_b128 v[164:167], v6 offset:32
  s_waitcnt lgkmcnt(6)
  v_smfmac_f32_16x16x64_bf16 v[24:27], a[216:219], v[140:147], v0
  s_waitcnt lgkmcnt(5)
  ds_read_b128 v[140:143], v3 offset:64
  s_waitcnt lgkmcnt(5)
  v_smfmac_f32_16x16x64_bf16 v[24:27], a[220:223], v[132:139], v0
  s_add_u32 s60, s60, s29
  ds_read_b128 v[144:147], v3 offset:928
  v_cvt_pk_bf16_f32 v177, v186, v187
  v_mfma_f32_16x16x32_bf16 v[184:187], a[96:99], v[194:197], 0
  s_mul_i32 s62, s60, 7183
  ds_read_b128 v[132:135], v3 offset:1792
  v_cvt_pk_bf16_f32 v239, v46, v47
  v_mfma_f32_16x16x32_bf16 v[184:187], a[100:103], v[190:193], v[184:187]
  s_lshr_b32 s62, s62, 22
  ds_read_b128 v[136:139], v6 offset:64
  v_cvt_pk_bf16_f32 v244, v48, v49
  v_mfma_f32_16x16x32_bf16 v[184:187], a[104:107], v[208:211], v[184:187]
  s_waitcnt lgkmcnt(6)
  v_permlane16_swap_b32 v236, v238
  v_smfmac_f32_16x16x64_bf16 v[28:31], a[226:229], v[124:131], v0
  s_waitcnt lgkmcnt(5)
  s_mul_i32 s63, s62, 584
  s_waitcnt lgkmcnt(4)
  v_smfmac_f32_16x16x64_bf16 v[28:31], a[230:233], v[160:167], v0
  s_sub_u32 s63, s60, s63
  v_cvt_pk_bf16_f32 v245, v50, v51
  v_mfma_f32_16x16x32_bf16 v[184:187], a[108:111], v[224:227], v[184:187]
  s_lshr_b32 s64, s63, 3
  v_permlane16_swap_b32 v237, v239
  v_mfma_f32_16x16x32_bf16 v[184:187], a[112:115], v[228:231], v[184:187]
  s_and_b32 s65, s63, 7
  buffer_store_dwordx4 v[240:243], v13, s[8:11], s32 offen
  v_cvt_pk_bf16_f32 v246, v52, v53
  v_mfma_f32_16x16x32_bf16 v[184:187], a[116:119], v[232:235], v[184:187]
  s_waitcnt lgkmcnt(2)
  v_cvt_pk_bf16_f32 v247, v54, v55
  v_cvt_pk_bf16_f32 v198, v56, v57
  v_smfmac_f32_16x16x64_bf16 v[32:35], a[236:239], v[140:147], v0
  s_waitcnt lgkmcnt(0)
  v_cvt_pk_bf16_f32 v199, v58, v59
  v_smfmac_f32_16x16x64_bf16 v[32:35], a[240:243], v[132:139], v0
  s_lshl_b32 s66, s62, 3
  v_cvt_pk_bf16_f32 v178, v184, v185
  v_mfma_f32_16x16x32_bf16 v[160:163], a[120:123], v[194:197], 0
  s_add_u32 s65, s65, s66
  v_cvt_pk_bf16_f32 v179, v186, v187
  v_mul_f32 v104, v24, v24
  v_mfma_f32_16x16x32_bf16 v[160:163], a[124:127], v[190:193], v[160:163]
  s_cmp_ge_u32 s60, 5256
  ds_read_b64 v[184:185], v10
  v_add_f32 v105, v24, v25
  v_mfma_f32_16x16x32_bf16 v[160:163], a[128:131], v[208:211], v[160:163]
  s_cselect_b32 s64, s63, s64
  ds_read_b64 v[186:187], v10 offset:32
  v_fmac_f32 v104, v25, v25
  v_mfma_f32_16x16x32_bf16 v[160:163], a[132:135], v[224:227], v[160:163]
  s_cselect_b32 s65, 72, s65
  ds_read_b64 v[182:183], v10 offset:64
  v_add_f32 v105, v105, v26
  v_mfma_f32_16x16x32_bf16 v[160:163], a[136:139], v[228:231], v[160:163]
  s_mul_i32 s66, s65, 1373568
  ds_read_b128 v[132:135], v4
  ds_read_b128 v[136:139], v4 offset:864
  v_mfma_f32_16x16x32_bf16 v[160:163], a[140:143], v[232:235], v[160:163]
  s_mul_i32 s67, s64, 2688
  ds_read_b128 v[140:143], v4 offset:1728
  v_fmac_f32 v104, v26, v26
  v_mfma_f32_16x16x32_bf16 v[240:243], a[0:3], v[194:197], 0
  s_add_u32 s35, s66, s67
  ds_read_b128 v[144:147], v7
  v_add_f32 v105, v105, v27
  v_mfma_f32_16x16x32_bf16 v[240:243], a[4:7], v[190:193], v[240:243]
  s_cmp_ge_u32 s61, 667
  v_cvt_pk_bf16_f32 v180, v160, v161
  v_cvt_pk_bf16_f32 v181, v162, v163
  v_mfma_f32_16x16x32_bf16 v[240:243], a[8:11], v[208:211], v[240:243]
  s_cselect_b32 s35, 268435456, s35
  v_permlane16_swap_b32 v244, v246
  v_mfma_f32_16x16x32_bf16 v[240:243], a[12:15], v[224:227], v[240:243]
  s_cmp_ge_u32 s60, 5329
  ds_read_b128 v[160:163], v4 offset:32
  ds_read_b128 v[164:167], v4 offset:896
  v_mfma_f32_16x16x32_bf16 v[240:243], a[16:19], v[228:231], v[240:243]
  s_cselect_b32 s35, 268435456, s35
  ds_read_b128 v[124:127], v4 offset:1760
  v_fmac_f32 v104, v27, v27
  v_mfma_f32_16x16x32_bf16 v[240:243], a[20:23], v[232:235], v[240:243]
  s_waitcnt lgkmcnt(5)
  ds_read_b128 v[128:131], v7 offset:32
  v_permlane16_swap_b32 v245, v247
  v_mfma_f32_16x16x16_bf16 v[36:39], a[224:225], v[184:185], 0
  v_add_f32 v105, v105, v28
  v_fmac_f32 v104, v28, v28
  v_add_f32 v105, v105, v29
  v_mfma_f32_16x16x16_bf16 v[40:43], a[234:235], v[186:187], 0
  v_cvt_pk_bf16_f32 v184, v240, v241
  v_cvt_pk_bf16_f32 v185, v242, v243
  v_fmac_f32 v104, v29, v29
  v_mfma_f32_16x16x16_bf16 v[44:47], a[244:245], v[182:183], 0
  v_add_f32 v105, v105, v30
  v_fmac_f32 v104, v30, v30
  v_add_f32 v105, v105, v31
  v_fmac_f32 v104, v31, v31
  v_smfmac_f32_16x16x64_bf16 v[36:39], a[216:219], v[132:139], v0
  s_waitcnt lgkmcnt(4)
  buffer_store_dwordx4 v[236:239], v22, s[8:11], s32 offen
  ds_read_b128 v[132:135], v4 offset:64
  v_smfmac_f32_16x16x64_bf16 v[36:39], a[220:223], v[140:147], v0
  s_cmp_eq_u32 s65, 0
  ds_read_b128 v[136:139], v4 offset:928
  ds_read_b128 v[140:143], v4 offset:1792
  v_mfma_f32_16x16x32_bf16 v[236:239], a[24:27], v[194:197], 0
  s_cselect_b32 s36, 268435456, s35
  ds_read_b128 v[144:147], v7 offset:64
  v_add_f32 v105, v105, v32
  v_mfma_f32_16x16x32_bf16 v[236:239], a[28:31], v[190:193], v[236:239]
  s_add_u32 s37, s35, 195360
  v_mul_f32 v242, v36, v36
  v_add_f32 v243, v36, v37
  v_mfma_f32_16x16x32_bf16 v[236:239], a[32:35], v[208:211], v[236:239]
  s_waitcnt lgkmcnt(6)
  v_fmac_f32 v242, v37, v37
  v_add_f32 v243, v243, v38
  v_smfmac_f32_16x16x64_bf16 v[40:43], a[226:229], v[160:167], v0
  s_waitcnt lgkmcnt(4)
  v_fmac_f32 v242, v38, v38
  v_smfmac_f32_16x16x64_bf16 v[40:43], a[230:233], v[124:131], v0
  s_add_u32 s38, s35, 390720
  v_add_f32 v243, v243, v39
  v_mfma_f32_16x16x32_bf16 v[236:239], a[36:39], v[224:227], v[236:239]
  s_add_u32 s39, s35, 586080
  v_fmac_f32 v242, v39, v39
  v_fmac_f32 v104, v32, v32
  v_mfma_f32_16x16x32_bf16 v[236:239], a[40:43], v[228:231], v[236:239]
  s_add_u32 s40, s35, 781440
  v_add_f32 v243, v243, v40
  v_fmac_f32 v242, v40, v40
  v_mfma_f32_16x16x32_bf16 v[236:239], a[44:47], v[232:235], v[236:239]
  s_waitcnt lgkmcnt(2)
  v_add_f32 v243, v243, v41
  v_fmac_f32 v242, v41, v41
  v_smfmac_f32_16x16x64_bf16 v[44:47], a[236:239], v[132:139], v0
  s_waitcnt lgkmcnt(0)
  v_add_f32 v243, v243, v42
  v_smfmac_f32_16x16x64_bf16 v[44:47], a[240:243], v[140:147], v0
  s_add_u32 s41, s35, 981120
  v_cvt_pk_bf16_f32 v186, v236, v237
  v_mfma_f32_16x16x32_bf16 v[124:127], a[48:51], v[194:197], 0
  s_add_u32 s42, s35, 1176480
  v_cvt_pk_bf16_f32 v187, v238, v239
  v_fmac_f32 v242, v42, v42
  v_mfma_f32_16x16x32_bf16 v[124:127], a[52:55], v[190:193], v[124:127]
  s_add_u32 s43, s35, 1371840
  ds_read_b64 v[236:237], v11
  v_add_f32 v243, v243, v43
  v_mfma_f32_16x16x32_bf16 v[124:127], a[56:59], v[208:211], v[124:127]
  s_add_u32 s44, s35, 1567200
  ds_read_b64 v[238:239], v11 offset:32
  v_fmac_f32 v242, v43, v43
  v_mfma_f32_16x16x32_bf16 v[124:127], a[60:63], v[224:227], v[124:127]
  s_cmp_eq_u32 s64, 0
  ds_read_b64 v[240:241], v11 offset:64
  v_add_f32 v243, v243, v44
  v_mfma_f32_16x16x32_bf16 v[124:127], a[64:67], v[228:231], v[124:127]
  s_cselect_b64 s[52:53], s[48:49], 0
  buffer_store_dwordx4 v[244:247], v14, s[8:11], s32 offen
  ds_read_b128 v[140:143], v5
  v_mfma_f32_16x16x32_bf16 v[124:127], a[68:71], v[232:235], v[124:127]
  s_cmp_eq_u32 s64, 72
  ds_read_b128 v[144:147], v5 offset:864
  ds_read_b128 v[132:135], v5 offset:1728
  v_mfma_f32_16x16x32_bf16 v[244:247], v[194:197], a[144:147], 0
  s_cselect_b64 s[52:53], s[50:51], s[52:53]
  ds_read_b128 v[136:139], v8
  v_fmac_f32 v242, v44, v44
  v_mfma_f32_16x16x32_bf16 v[244:247], v[190:193], a[148:151], v[244:247]
  s_add_u32 s31, s31, 1
  v_cndmask_b32 v106, v21, 2.0, s[52:53]
  v_cvt_pk_bf16_f32 v188, v124, v125
  v_mfma_f32_16x16x32_bf16 v[244:247], v[208:211], a[152:155], v[244:247]
  s_mov_b32 m0, s58
  v_cvt_pk_bf16_f32 v189, v126, v127
  v_add_f32 v105, v105, v33
  v_mfma_f32_16x16x32_bf16 v[244:247], v[224:227], a[156:159], v[244:247]
  ds_read_b128 v[124:127], v5 offset:32
  ds_read_b128 v[128:131], v5 offset:896
  v_mfma_f32_16x16x32_bf16 v[244:247], v[228:231], a[160:163], v[244:247]
  ds_read_b128 v[160:163], v5 offset:1760
  v_fmac_f32 v104, v33, v33
  v_mfma_f32_16x16x32_bf16 v[244:247], v[232:235], a[164:167], v[244:247]
  s_waitcnt lgkmcnt(5)
  ds_read_b128 v[164:167], v8 offset:32
  v_add_f32 v243, v243, v45
  v_fmac_f32 v242, v45, v45
  v_mfma_f32_16x16x16_bf16 v[48:51], a[224:225], v[236:237], 0
  v_add_f32 v105, v105, v34
  v_fmac_f32 v104, v34, v34
  v_add_f32 v243, v243, v46
  v_mfma_f32_16x16x16_bf16 v[52:55], a[234:235], v[238:239], 0
  v_cvt_pk_bf16_f32 v202, v244, v245
  v_cvt_pk_bf16_f32 v203, v246, v247
  v_fmac_f32 v242, v46, v46
  v_mfma_f32_16x16x16_bf16 v[56:59], a[244:245], v[240:241], 0
  v_add_f32 v105, v105, v35
  v_fmac_f32 v104, v35, v35
  v_add_f32 v243, v243, v47
  v_fmac_f32 v242, v47, v47
  v_smfmac_f32_16x16x64_bf16 v[48:51], a[216:219], v[140:147], v0
  s_waitcnt lgkmcnt(4)
  ds_read_b128 v[140:143], v5 offset:64
  ds_read_b128 v[144:147], v5 offset:928
  v_smfmac_f32_16x16x64_bf16 v[48:51], a[220:223], v[132:139], v0
  ds_read_b128 v[132:135], v5 offset:1792
  v_mfma_f32_16x16x32_bf16 v[244:247], v[194:197], a[168:171], 0
  ds_read_b128 v[136:139], v8 offset:64
  v_mfma_f32_16x16x32_bf16 v[244:247], v[190:193], a[172:175], v[244:247]
  v_mul_f32 v238, v48, v48
  v_add_f32 v239, v48, v49
  v_mfma_f32_16x16x32_bf16 v[244:247], v[208:211], a[176:179], v[244:247]
  s_waitcnt lgkmcnt(6)
  v_fmac_f32 v238, v49, v49
  v_add_f32 v239, v239, v50
  v_smfmac_f32_16x16x64_bf16 v[52:55], a[226:229], v[124:131], v0
  s_waitcnt lgkmcnt(4)
  buffer_store_dwordx2 v[198:199], v23, s[8:11], s32 offen
  v_fmac_f32 v238, v50, v50
  v_smfmac_f32_16x16x64_bf16 v[52:55], a[230:233], v[160:167], v0
  v_add_f32 v239, v239, v51
  v_mfma_f32_16x16x32_bf16 v[244:247], v[224:227], a[180:183], v[244:247]
  v_fmac_f32 v238, v51, v51
  v_mfma_f32_16x16x32_bf16 v[244:247], v[228:231], a[184:187], v[244:247]
  v_add_f32 v239, v239, v52
  v_fmac_f32 v238, v52, v52
  v_mfma_f32_16x16x32_bf16 v[244:247], v[232:235], a[188:191], v[244:247]
  s_waitcnt lgkmcnt(0)
  buffer_load_dwordx4 v106, s[4:7], s36 offen nt lds
  v_smfmac_f32_16x16x64_bf16 v[56:59], a[236:239], v[140:147], v0
  v_add_f32 v239, v239, v53
  v_smfmac_f32_16x16x64_bf16 v[56:59], a[240:243], v[132:139], v0
  ds_read_b128 v[132:135], v15 offset:14336
  v_fmac_f32 v238, v53, v53
  v_mfma_f32_16x16x32_bf16 v[160:163], v[194:197], a[192:195], 0
  ds_read_b128 v[124:127], v15 offset:15360
  v_add_f32 v239, v239, v54
  v_mfma_f32_16x16x32_bf16 v[160:163], v[190:193], a[196:199], v[160:163]
  ds_read_b128 v[128:131], v15 offset:16384
  v_fmac_f32 v238, v54, v54
  v_mfma_f32_16x16x32_bf16 v[160:163], v[208:211], a[200:203], v[160:163]
  buffer_load_dwordx4 v106, s[4:7], s37 offen offset:864 nt lds
  v_mfma_f32_16x16x32_bf16 v[160:163], v[224:227], a[204:207], v[160:163]
  ds_read_b128 v[136:139], v15 offset:17408
  ds_read_b128 v[140:143], v15 offset:18432
  v_mfma_f32_16x16x32_bf16 v[160:163], v[228:231], a[208:211], v[160:163]
  ds_read_b128 v[144:147], v15 offset:19456
  v_add_f32 v239, v239, v55
  v_mfma_f32_16x16x32_bf16 v[160:163], v[232:235], a[212:215], v[160:163]
  v_fmac_f32 v238, v55, v55
  v_add_f32 v239, v239, v56
  v_fmac_f32 v238, v56, v56
  v_mfma_f32_16x16x16_bf16 v[192:195], v[180:181], v[152:153], 0
  v_cvt_pk_bf16_f32 v206, v244, v245
  v_cvt_pk_bf16_f32 v207, v246, v247
  v_add_f32 v239, v239, v57
  v_mfma_f32_16x16x16_bf16 v[244:247], v[158:159], v[188:189], 0
  v_fmac_f32 v238, v57, v57
  v_add_f32 v239, v239, v58
  v_fmac_f32 v238, v58, v58
  v_add_f32 v239, v239, v59
  v_mfma_f32_16x16x32_bf16 v[192:195], v[176:179], v[148:151], v[192:195]
  buffer_load_dwordx4 v106, s[4:7], s38 offen offset:1728 nt lds
  v_mfma_f32_16x16x32_bf16 v[244:247], v[154:157], v[184:187], v[244:247]
  s_waitcnt lgkmcnt(5)
  v_fmac_f32 v238, v59, v59
  v_cvt_pk_bf16_f32 v214, v160, v161
  v_mfma_f32_16x16x32_bf16 v[232:235], a[72:75], v[132:135], 0
  s_waitcnt lgkmcnt(4)
  buffer_load_dwordx4 v106, s[4:7], s39 offen offset:2592 nt lds
  v_mfma_f32_16x16x32_bf16 v[232:235], a[76:79], v[124:127], v[232:235]
  s_waitcnt lgkmcnt(3)
  v_permlane32_swap_b32 v239, v238
  v_mfma_f32_16x16x32_bf16 v[232:235], a[80:83], v[128:131], v[232:235]
  s_waitcnt lgkmcnt(2)
  v_permlane32_swap_b32 v105, v104
  v_mfma_f32_16x16x32_bf16 v[232:235], a[84:87], v[136:139], v[232:235]
  s_waitcnt lgkmcnt(1)
  v_permlane32_swap_b32 v243, v242
  v_mfma_f32_16x16x32_bf16 v[232:235], a[88:91], v[140:143], v[232:235]
  s_waitcnt lgkmcnt(0)
  v_add_f32 v239, v239, v238
  v_add_f32 v105, v105, v104
  v_mfma_f32_16x16x32_bf16 v[232:235], a[92:95], v[144:147], v[232:235]
  buffer_load_dwordx4 v106, s[4:7], s40 offen offset:3456 nt lds
  v_mfma_f32_16x16x32_bf16 v[196:199], a[96:99], v[132:135], 0
  s_mov_b32 m0, s59
  v_add_f32 v243, v243, v242
  v_mov_b32 v238, v239
  v_mfma_f32_16x16x32_bf16 v[196:199], a[100:103], v[124:127], v[196:199]
  s_mov_b32 s32, s33
  v_permlane16_swap_b32 v105, v243
  v_mfma_f32_16x16x32_bf16 v[196:199], a[104:107], v[128:131], v[196:199]
  s_mov_b32 s33, s34
  v_permlane16_swap_b32 v239, v238
  v_mfma_f32_16x16x32_bf16 v[196:199], a[108:111], v[136:139], v[196:199]
  s_mov_b32 s34, s35
  buffer_load_dwordx4 v106, s[4:7], s41 offen nt lds
  v_mfma_f32_16x16x32_bf16 v[196:199], a[112:115], v[140:143], v[196:199]
  v_add_f32 v105, v105, v243
  v_add_f32 v239, v239, v238
  v_mfma_f32_16x16x32_bf16 v[196:199], a[116:119], v[144:147], v[196:199]
  ds_write_b32 v107, v105
  ds_write_b32 v107, v239 offset:512
  v_cvt_pk_bf16_f32 v215, v162, v163
  v_exp_f32 v192, v192
  buffer_load_dwordx4 v106, s[4:7], s42 offen offset:864 nt lds
  v_exp_f32 v193, v193
  v_exp_f32 v194, v194
  v_exp_f32 v195, v195
  v_exp_f32 v244, v244
  v_exp_f32 v245, v245
  v_exp_f32 v246, v246
  v_exp_f32 v247, v247
  v_cvt_pk_bf16_f32 v160, v232, v233
  s_waitcnt lgkmcnt(0)
  s_barrier
  v_mfma_f32_16x16x32_bf16 v[228:231], a[120:123], v[132:135], 0
  buffer_load_dwordx4 v106, s[4:7], s43 offen offset:1728 nt lds
  v_mfma_f32_16x16x32_bf16 v[228:231], a[124:127], v[124:127], v[228:231]
  ds_read_b128 v[224:227], v15
  ds_read_b128 v[208:211], v15 offset:1024
  v_mfma_f32_16x16x32_bf16 v[228:231], a[128:131], v[128:131], v[228:231]
  v_cvt_pk_bf16_f32 v161, v234, v235
  v_cvt_pk_bf16_f32 v162, v196, v197
  v_mfma_f32_16x16x32_bf16 v[228:231], a[132:135], v[136:139], v[228:231]
  v_cvt_pk_bf16_f32 v163, v198, v199
  v_cvt_pk_bf16_f32 v218, v192, v193
  v_mfma_f32_16x16x32_bf16 v[228:231], a[136:139], v[140:143], v[228:231]
  buffer_load_dwordx4 v106, s[4:7], s44 offen offset:2592 nt lds
  v_mfma_f32_16x16x32_bf16 v[228:231], a[140:143], v[144:147], v[228:231]
  v_cvt_pk_bf16_f32 v219, v194, v195
  v_cvt_pk_bf16_f32 v232, v244, v245
  v_cvt_pk_bf16_f32 v233, v246, v247
  v_mfma_f32_16x16x16_bf16 v[244:247], v[180:181], v[188:189], 0
  ds_read_b64 v[196:197], v19 offset:16
  v_mfma_f32_16x16x16_bf16 v[236:239], v[180:181], v[172:173], 0
  ds_read2_b64 v[192:195], v19 offset0:0 offset1:1
  v_cvt_pk_bf16_f32 v164, v228, v229
  v_cvt_pk_bf16_f32 v165, v230, v231
  v_add_u32 v19, 1160, v19
  v_mfma_f32_16x16x32_bf16 v[244:247], v[176:179], v[184:187], v[244:247]
  s_waitcnt lgkmcnt(2)
  v_add_f32 v224, v224, v225
  v_add_f32 v226, v226, v227
  v_mfma_f32_16x16x32_bf16 v[236:239], v[176:179], v[168:171], v[236:239]
  v_add_f32 v208, v208, v209
  v_add_f32 v210, v210, v211
  v_mfma_f32_16x16x32_bf16 v[228:231], v[132:135], a[144:147], 0
  v_exp_f32 v244, v244
  v_mfma_f32_16x16x32_bf16 v[228:231], v[124:127], a[148:151], v[228:231]
  v_exp_f32 v245, v245
  v_mfma_f32_16x16x32_bf16 v[228:231], v[128:131], a[152:155], v[228:231]
  v_exp_f32 v246, v246
  v_mfma_f32_16x16x32_bf16 v[228:231], v[136:139], a[156:159], v[228:231]
  v_exp_f32 v247, v247
  v_mfma_f32_16x16x32_bf16 v[228:231], v[140:143], a[160:163], v[228:231]
  v_exp_f32 v236, v236
  v_mfma_f32_16x16x32_bf16 v[228:231], v[144:147], a[164:167], v[228:231]
  v_exp_f32 v237, v237
  v_mfma_f32_16x16x32_bf16 v[240:243], v[132:135], a[168:171], 0
  v_exp_f32 v238, v238
  v_mfma_f32_16x16x32_bf16 v[240:243], v[124:127], a[172:175], v[240:243]
  v_exp_f32 v239, v239
  v_mfma_f32_16x16x32_bf16 v[240:243], v[128:131], a[176:179], v[240:243]
  v_cvt_pk_bf16_f32 v234, v244, v245
  v_cvt_pk_bf16_f32 v235, v246, v247
  v_mfma_f32_16x16x32_bf16 v[240:243], v[136:139], a[180:183], v[240:243]
  v_cvt_pk_bf16_f32 v104, v228, v229
  v_cvt_pk_bf16_f32 v105, v230, v231
  v_mfma_f32_16x16x32_bf16 v[240:243], v[140:143], a[184:187], v[240:243]
  v_cvt_pk_bf16_f32 v222, v236, v237
  v_cvt_pk_bf16_f32 v223, v238, v239
  v_mfma_f32_16x16x32_bf16 v[240:243], v[144:147], a[188:191], v[240:243]
  s_waitcnt lgkmcnt(1)
  v_add_f32 v224, v224, v226
  v_add_f32 v208, v208, v210
  v_mul_f32 v225, 0x3baaaaab, v224
  v_mfma_f32_16x16x16_bf16 v[236:239], v[164:165], v[152:153], 0
  v_fma_f32 v208, -v225, v224, v208
  v_max_f32 v208, 0, v208
  v_add_f32 v208, 0x3afba882, v208
  v_mfma_f32_16x16x16_bf16 v[228:231], v[196:197], v[152:153], v[2:5]
  v_cvt_pk_bf16_f32 v108, v240, v241
  v_cvt_pk_bf16_f32 v109, v242, v243
  v_rsq_f32 v208, v208
  v_mfma_f32_16x16x32_bf16 v[236:239], v[160:163], v[148:151], v[236:239]
  s_waitcnt lgkmcnt(0)
  v_mul_f32 v208, 0x40ca568a, v208
  v_mul_f32 v209, -v225, v208
  v_mfma_f32_16x16x32_bf16 v[228:231], v[192:195], v[148:151], v[228:231]
  ds_write_b64 v111, v[208:209]
  v_mfma_f32_16x16x32_bf16 v[148:151], v[132:135], a[192:195], 0
  ds_read_b64 v[240:241], v115 offset:768
  v_mfma_f32_16x16x32_bf16 v[148:151], v[124:127], a[196:199], v[148:151]
  v_exp_f32 v236, v236
  v_mfma_f32_16x16x32_bf16 v[148:151], v[128:131], a[200:203], v[148:151]
  ds_read_u16 v106, v20
  v_mfma_f32_16x16x32_bf16 v[148:151], v[136:139], a[204:207], v[148:151]
  v_exp_f32 v237, v237
  v_mfma_f32_16x16x32_bf16 v[148:151], v[140:143], a[208:211], v[148:151]
  ds_read_u16 v110, v20 offset:32
  v_cvt_pk_bf16_f32 v116, v236, v237
  v_mfma_f32_16x16x32_bf16 v[148:151], v[144:147], a[212:215], v[148:151]
  v_exp_f32 v238, v238
  v_mfma_f32_16x16x16_bf16 v[208:211], v[164:165], v[188:189], 0
  ds_read_u16 v114, v20 offset:64
  v_exp_f32 v239, v239
  v_mfma_f32_16x16x16_bf16 v[224:227], v[196:197], v[188:189], v[2:5]
  v_exp_f32 v228, v228
  v_cvt_pk_bf16_f32 v117, v238, v239
  v_cvt_pk_bf16_f32 v118, v228, 0
  v_mfma_f32_16x16x32_bf16 v[208:211], v[160:163], v[184:187], v[208:211]
  s_waitcnt lgkmcnt(3)
  v_cvt_pk_bf16_f32 v112, v148, v149
  v_cvt_pk_bf16_f32 v113, v150, v151
  v_mfma_f32_16x16x32_bf16 v[224:227], v[192:195], v[184:187], v[224:227]
  v_fma_f32 v184, v24, v240, v241
  v_fma_f32 v148, v25, v240, v241
  v_mfma_f32_16x16x32_bf16 v[228:231], a[0:3], v[132:135], 0
  v_exp_f32 v208, v208
  v_mfma_f32_16x16x32_bf16 v[228:231], a[4:7], v[124:127], v[228:231]
  v_exp_f32 v209, v209
  v_mfma_f32_16x16x32_bf16 v[228:231], a[8:11], v[128:131], v[228:231]
  v_exp_f32 v210, v210
  v_mfma_f32_16x16x32_bf16 v[228:231], a[12:15], v[136:139], v[228:231]
  v_exp_f32 v211, v211
  v_mfma_f32_16x16x32_bf16 v[228:231], a[16:19], v[140:143], v[228:231]
  v_exp_f32 v224, v224
  v_mfma_f32_16x16x32_bf16 v[228:231], a[20:23], v[144:147], v[228:231]
  v_cvt_pk_bf16_f32 v120, v208, v209
  v_cvt_pk_bf16_f32 v121, v210, v211
  v_mfma_f32_16x16x32_bf16 v[208:211], a[246:249], v[216:219], 0
  v_cvt_pk_bf16_f32 v122, v224, 0
  v_cvt_pk_bf16_f32 v184, v184, v148
  v_mfma_f32_16x16x32_bf16 v[208:211], a[246:249], v[116:119], v[208:211]
  v_cvt_pk_bf16_f32 v148, v228, v229
  v_cvt_pk_bf16_f32 v149, v230, v231
  v_mfma_f32_16x16x32_bf16 v[228:231], v[200:203], v[216:219], 0
  s_waitcnt lgkmcnt(2)
  v_fma_f32 v185, v26, v240, v241
  v_fma_f32 v224, v27, v240, v241
  v_mfma_f32_16x16x32_bf16 v[228:231], v[104:107], v[116:119], v[228:231]
  v_cvt_pk_bf16_f32 v185, v185, v224
  v_fma_f32 v186, v28, v240, v241
  v_mfma_f32_16x16x32_bf16 v[224:227], v[204:207], v[216:219], 0
  s_waitcnt lgkmcnt(1)
  v_fma_f32 v236, v29, v240, v241
  v_cvt_pk_bf16_f32 v186, v186, v236
  v_mfma_f32_16x16x32_bf16 v[224:227], v[108:111], v[116:119], v[224:227]
  v_fma_f32 v187, v30, v240, v241
  v_fma_f32 v242, v31, v240, v241
  v_mfma_f32_16x16x32_bf16 v[236:239], v[212:215], v[216:219], 0
  s_waitcnt lgkmcnt(0)
  v_cvt_pk_bf16_f32 v187, v187, v242
  v_fma_f32 v216, v32, v240, v241
  v_mfma_f32_16x16x32_bf16 v[236:239], v[112:115], v[116:119], v[236:239]
  ds_write_b128 v16, v[184:187] offset:2048
  v_mfma_f32_16x16x32_bf16 v[184:187], a[24:27], v[132:135], 0
  v_fma_f32 v242, v33, v240, v241
  v_cvt_pk_bf16_f32 v216, v216, v242
  v_mfma_f32_16x16x32_bf16 v[184:187], a[28:31], v[124:127], v[184:187]
  v_fma_f32 v217, v34, v240, v241
  v_fma_f32 v242, v35, v240, v241
  v_mfma_f32_16x16x32_bf16 v[184:187], a[32:35], v[128:131], v[184:187]
  v_cvt_pk_bf16_f32 v217, v217, v242
  v_mul_f32 v208, 0x3ee9a3cd, v208
  v_mfma_f32_16x16x32_bf16 v[184:187], a[36:39], v[136:139], v[184:187]
  ds_write_b64 v17, v[216:217] offset:2048
  v_mfma_f32_16x16x32_bf16 v[184:187], a[40:43], v[140:143], v[184:187]
  v_rcp_f32 v188, v208
  v_mfma_f32_16x16x32_bf16 v[184:187], a[44:47], v[144:147], v[184:187]
  v_mul_f32 v228, v228, v188
  v_mul_f32 v229, v229, v188
  v_cvt_pk_bf16_f32 v216, v228, v229
  v_mfma_f32_16x16x16_bf16 v[240:243], v[164:165], v[172:173], 0
  v_mul_f32 v230, v230, v188
  v_mul_f32 v231, v231, v188
  v_cvt_pk_bf16_f32 v217, v230, v231
  v_mfma_f32_16x16x16_bf16 v[228:231], v[196:197], v[172:173], v[2:5]
  v_cvt_pk_bf16_f32 v150, v184, v185
  v_cvt_pk_bf16_f32 v151, v186, v187
  v_mul_f32 v224, v224, v188
  v_mul_f32 v225, v225, v188
  v_mfma_f32_16x16x32_bf16 v[240:243], v[160:163], v[168:171], v[240:243]
  v_cvt_pk_bf16_f32 v218, v224, v225
  v_mul_f32 v226, v226, v188
  v_mfma_f32_16x16x32_bf16 v[228:231], v[192:195], v[168:171], v[228:231]
  v_mul_f32 v227, v227, v188
  v_cvt_pk_bf16_f32 v219, v226, v227
  v_mfma_f32_16x16x32_bf16 v[224:227], a[246:249], v[232:235], 0
  ds_write_b128 v16, v[216:219] offset:20480
  v_mfma_f32_16x16x32_bf16 v[224:227], a[246:249], v[120:123], v[224:227]
  v_exp_f32 v240, v240
  v_mfma_f32_16x16x32_bf16 v[216:219], v[200:203], v[232:235], 0
  v_exp_f32 v241, v241
  v_mfma_f32_16x16x32_bf16 v[216:219], v[104:107], v[120:123], v[216:219]
  v_exp_f32 v242, v242
  v_mfma_f32_16x16x32_bf16 v[168:171], v[204:207], v[232:235], 0
  v_exp_f32 v243, v243
  v_mfma_f32_16x16x32_bf16 v[168:171], v[108:111], v[120:123], v[168:171]
  v_exp_f32 v228, v228
  v_mfma_f32_16x16x32_bf16 v[184:187], v[212:215], v[232:235], 0
  v_cvt_pk_bf16_f32 v116, v240, v241
  v_cvt_pk_bf16_f32 v117, v242, v243
  v_mfma_f32_16x16x32_bf16 v[184:187], v[112:115], v[120:123], v[184:187]
  v_cvt_pk_bf16_f32 v118, v228, 0
  v_mul_f32 v224, 0x3ee9a3cd, v224
  v_mfma_f32_16x16x32_bf16 v[228:231], a[48:51], v[132:135], 0
  v_rcp_f32 v240, v224
  v_mfma_f32_16x16x32_bf16 v[228:231], a[52:55], v[124:127], v[228:231]
  v_mul_f32 v216, v216, v240
  v_mul_f32 v217, v217, v240
  v_mfma_f32_16x16x32_bf16 v[228:231], a[56:59], v[128:131], v[228:231]
  v_cvt_pk_bf16_f32 v124, v216, v217
  v_mul_f32 v218, v218, v240
  v_mfma_f32_16x16x32_bf16 v[228:231], a[60:63], v[136:139], v[228:231]
  v_mul_f32 v219, v219, v240
  v_cvt_pk_bf16_f32 v125, v218, v219
  v_mfma_f32_16x16x32_bf16 v[228:231], a[64:67], v[140:143], v[228:231]
  v_mul_f32 v168, v168, v240
  v_mul_f32 v169, v169, v240
  v_mfma_f32_16x16x32_bf16 v[228:231], a[68:71], v[144:147], v[228:231]
  s_waitcnt lgkmcnt(1)
  s_barrier
  v_mfma_f32_16x16x32_bf16 v[216:219], v[220:223], a[246:249], 0
  v_cvt_pk_bf16_f32 v126, v168, v169
  v_mul_f32 v170, v170, v240
  v_mfma_f32_16x16x32_bf16 v[216:219], v[116:119], a[246:249], v[216:219]
  v_cvt_pk_bf16_f32 v152, v228, v229
  v_cvt_pk_bf16_f32 v153, v230, v231
  v_mfma_f32_16x16x32_bf16 v[144:147], v[220:223], v[200:203], 0
  v_mul_f32 v171, v171, v240
  v_cvt_pk_bf16_f32 v127, v170, v171
  v_mfma_f32_16x16x32_bf16 v[144:147], v[116:119], v[104:107], v[144:147]
  ds_write_b128 v16, v[124:127] offset:26624
  v_mfma_f32_16x16x32_bf16 v[140:143], v[220:223], v[204:207], 0
  v_mul_f32 v216, 0x3ee9a3cd, v216
  v_mul_f32 v236, v236, v188
  v_mfma_f32_16x16x32_bf16 v[140:143], v[116:119], v[108:111], v[140:143]
  ds_read_b128 v[124:127], v15 offset:2048
  v_mul_f32 v237, v237, v188
  v_mfma_f32_16x16x32_bf16 v[136:139], v[220:223], v[212:215], 0
  ds_read_b128 v[128:131], v15 offset:3072
  v_cvt_pk_bf16_f32 v120, v236, v237
  v_mfma_f32_16x16x32_bf16 v[136:139], v[116:119], v[112:115], v[136:139]
  ds_read_b128 v[132:135], v15 offset:4096
  v_rcp_f32 v118, v216
  v_mfma_f32_16x16x16_bf16 v[220:223], v[158:159], v[152:153], 0
  v_cndmask_b32 v122, v140, v144, s[54:55]
  v_mul_f32 v238, v238, v188
  v_mul_f32 v239, v239, v188
  v_mfma_f32_16x16x16_bf16 v[168:171], v[180:181], v[152:153], 0
  v_cvt_pk_bf16_f32 v121, v238, v239
  v_mul_f32 v184, v184, v240
  v_mul_f32 v185, v185, v240
  v_mfma_f32_16x16x16_bf16 v[236:239], v[164:165], v[152:153], 0
  v_cvt_pk_bf16_f32 v116, v184, v185
  v_mul_f32 v186, v186, v240
  v_mul_f32 v187, v187, v240
  v_mfma_f32_16x16x16_bf16 v[228:231], v[196:197], v[152:153], v[2:5]
  v_cvt_pk_bf16_f32 v117, v186, v187
  v_cndmask_b32 v122, v136, v122, s[56:57]
  v_mul_f32 v122, v122, v118
  v_cvt_pk_bf16_f32 v122, v122, v122
  v_mfma_f32_16x16x32_bf16 v[220:223], v[154:157], v[148:151], v[220:223]
  ds_read_b128 v[136:139], v15 offset:5120
  ds_read_b128 v[140:143], v15 offset:6144
  v_mfma_f32_16x16x32_bf16 v[168:171], v[176:179], v[148:151], v[168:171]
  ds_read_b128 v[144:147], v15 offset:7168
  v_max3_f32 v1, v1, v208, v188
  v_mfma_f32_16x16x32_bf16 v[236:239], v[160:163], v[148:151], v[236:239]
  ds_write_b64 v17, v[120:121] offset:20480
  v_mfma_f32_16x16x32_bf16 v[228:231], v[192:195], v[148:151], v[228:231]
  s_waitcnt lgkmcnt(6)
  v_exp_f32 v220, v220
  v_mfma_f32_16x16x32_bf16 v[156:159], a[0:3], v[124:127], 0
  s_waitcnt lgkmcnt(5)
  ds_write_b64 v17, v[116:117] offset:26624
  v_mfma_f32_16x16x32_bf16 v[156:159], a[4:7], v[128:131], v[156:159]
  s_waitcnt lgkmcnt(5)
  ds_write_b16 v20, v122 offset:384
  v_mfma_f32_16x16x32_bf16 v[156:159], a[8:11], v[132:135], v[156:159]
  s_waitcnt lgkmcnt(5)
  v_exp_f32 v221, v221
  v_mfma_f32_16x16x32_bf16 v[156:159], a[12:15], v[136:139], v[156:159]
  s_waitcnt lgkmcnt(4)
  v_exp_f32 v222, v222
  v_mfma_f32_16x16x32_bf16 v[156:159], a[16:19], v[140:143], v[156:159]
  s_waitcnt lgkmcnt(3)
  v_exp_f32 v223, v223
  v_mfma_f32_16x16x32_bf16 v[156:159], a[20:23], v[144:147], v[156:159]
  v_exp_f32 v168, v168
  v_mfma_f32_16x16x32_bf16 v[160:163], a[24:27], v[124:127], 0
  v_exp_f32 v169, v169
  v_mfma_f32_16x16x32_bf16 v[160:163], a[28:31], v[128:131], v[160:163]
  v_exp_f32 v170, v170
  v_mfma_f32_16x16x32_bf16 v[160:163], a[32:35], v[132:135], v[160:163]
  v_exp_f32 v171, v171
  v_mfma_f32_16x16x32_bf16 v[160:163], a[36:39], v[136:139], v[160:163]
  v_exp_f32 v236, v236
  v_mfma_f32_16x16x32_bf16 v[160:163], a[40:43], v[140:143], v[160:163]
  v_exp_f32 v237, v237
  v_mfma_f32_16x16x32_bf16 v[160:163], a[44:47], v[144:147], v[160:163]
  v_exp_f32 v238, v238
  v_mfma_f32_16x16x32_bf16 v[192:195], a[48:51], v[124:127], 0
  v_exp_f32 v239, v239
  v_mfma_f32_16x16x32_bf16 v[192:195], a[52:55], v[128:131], v[192:195]
  v_exp_f32 v228, v228
  v_mfma_f32_16x16x32_bf16 v[192:195], a[56:59], v[132:135], v[192:195]
  v_cvt_pk_bf16_f32 v208, v220, v221
  v_cvt_pk_bf16_f32 v209, v222, v223
  v_mfma_f32_16x16x32_bf16 v[192:195], a[60:63], v[136:139], v[192:195]
  v_cvt_pk_bf16_f32 v210, v168, v169
  v_cvt_pk_bf16_f32 v211, v170, v171
  v_mfma_f32_16x16x32_bf16 v[192:195], a[64:67], v[140:143], v[192:195]
  v_cvt_pk_bf16_f32 v148, v156, v157
  v_cvt_pk_bf16_f32 v149, v158, v159
  v_mfma_f32_16x16x32_bf16 v[192:195], a[68:71], v[144:147], v[192:195]
  v_cvt_pk_bf16_f32 v120, v236, v237
  v_cvt_pk_bf16_f32 v121, v238, v239
  v_mfma_f32_16x16x32_bf16 v[236:239], a[246:249], v[208:211], 0
  v_cvt_pk_bf16_f32 v122, v228, 0
  v_cvt_pk_bf16_f32 v150, v160, v161
  v_cvt_pk_bf16_f32 v151, v162, v163
  v_mfma_f32_16x16x32_bf16 v[236:239], a[246:249], v[120:123], v[236:239]
  v_cvt_pk_bf16_f32 v152, v192, v193
  v_cvt_pk_bf16_f32 v153, v194, v195
  v_mfma_f32_16x16x32_bf16 v[160:163], v[200:203], v[208:211], 0
  v_max3_f32 v1, v1, v224, v240
  v_max3_f32 v1, v1, v216, v118
  v_mfma_f32_16x16x32_bf16 v[160:163], v[104:107], v[120:123], v[160:163]
  v_mul_f32 v236, 0x3ee9a3cd, v236
  v_add_u32 v20, 1160, v20
  v_mfma_f32_16x16x32_bf16 v[156:159], v[204:207], v[208:211], 0
  v_rcp_f32 v104, v236
  v_mfma_f32_16x16x32_bf16 v[156:159], v[108:111], v[120:123], v[156:159]
  v_mul_f32 v160, v160, v104
  v_mul_f32 v161, v161, v104
  v_mfma_f32_16x16x32_bf16 v[204:207], v[212:215], v[208:211], 0
  v_mul_f32 v162, v162, v104
  v_mul_f32 v163, v163, v104
  v_mfma_f32_16x16x32_bf16 v[204:207], v[112:115], v[120:123], v[204:207]
  v_mul_f32 v156, v156, v104
  v_mul_f32 v157, v157, v104
  v_mfma_f32_16x16x32_bf16 v[208:211], a[72:75], v[124:127], 0
  v_mul_f32 v158, v158, v104
  v_mul_f32 v159, v159, v104
  v_mfma_f32_16x16x32_bf16 v[208:211], a[76:79], v[128:131], v[208:211]
  v_cvt_pk_bf16_f32 v212, v160, v161
  v_cvt_pk_bf16_f32 v213, v162, v163
  v_mfma_f32_16x16x32_bf16 v[208:211], a[80:83], v[132:135], v[208:211]
  v_cvt_pk_bf16_f32 v214, v156, v157
  v_cvt_pk_bf16_f32 v215, v158, v159
  v_mfma_f32_16x16x32_bf16 v[208:211], a[84:87], v[136:139], v[208:211]
  ds_write_b128 v16, v[212:215] offset:32768
  v_mfma_f32_16x16x32_bf16 v[208:211], a[88:91], v[140:143], v[208:211]
  v_mul_f32 v204, v204, v104
  v_mul_f32 v205, v205, v104
  v_mfma_f32_16x16x32_bf16 v[208:211], a[92:95], v[144:147], v[208:211]
  v_mul_f32 v206, v206, v104
  v_mul_f32 v207, v207, v104
  v_mfma_f32_16x16x32_bf16 v[212:215], a[96:99], v[124:127], 0
  v_cvt_pk_bf16_f32 v156, v204, v205
  v_cvt_pk_bf16_f32 v157, v206, v207
  v_mfma_f32_16x16x32_bf16 v[212:215], a[100:103], v[128:131], v[212:215]
  ds_write_b64 v17, v[156:157] offset:32768
  v_mfma_f32_16x16x32_bf16 v[212:215], a[104:107], v[132:135], v[212:215]
  v_cvt_pk_bf16_f32 v154, v208, v209
  v_cvt_pk_bf16_f32 v155, v210, v211
  v_mfma_f32_16x16x32_bf16 v[212:215], a[108:111], v[136:139], v[212:215]
  v_max3_f32 v1, v1, v236, v104
  v_mfma_f32_16x16x32_bf16 v[212:215], a[112:115], v[140:143], v[212:215]
  v_mfma_f32_16x16x32_bf16 v[212:215], a[116:119], v[144:147], v[212:215]
  v_mfma_f32_16x16x32_bf16 v[160:163], a[120:123], v[124:127], 0
  v_mfma_f32_16x16x32_bf16 v[160:163], a[124:127], v[128:131], v[160:163]
  v_cvt_pk_bf16_f32 v156, v212, v213
  v_cvt_pk_bf16_f32 v157, v214, v215
  v_mfma_f32_16x16x32_bf16 v[160:163], a[128:131], v[132:135], v[160:163]
  v_mfma_f32_16x16x32_bf16 v[160:163], a[132:135], v[136:139], v[160:163]
  v_mfma_f32_16x16x32_bf16 v[160:163], a[136:139], v[140:143], v[160:163]
  v_mfma_f32_16x16x32_bf16 v[160:163], a[140:143], v[144:147], v[160:163]
  s_waitcnt lgkmcnt(0)
  s_barrier
  s_sub_u32 s70, s70, 1
  s_cmp_eq_u32 s70, 0
  s_cbranch_scc1 L_last
  v_mfma_f32_16x16x32_bf16 v[168:171], v[124:127], a[144:147], 0
  ds_read_b128 v[172:175], v15 offset:20480
  ds_read_b128 v[164:167], v15 offset:26624
  v_mfma_f32_16x16x32_bf16 v[168:171], v[128:131], a[148:151], v[168:171]
  ds_read_b128 v[176:179], v15 offset:32768
  v_cvt_pk_bf16_f32 v158, v160, v161
  v_mfma_f32_16x16x32_bf16 v[168:171], v[132:135], a[152:155], v[168:171]
  ds_read_b64 v[212:213], v115 offset:896
  ds_read_b64 v[216:217], v115 offset:1792
  v_mfma_f32_16x16x32_bf16 v[168:171], v[136:139], a[156:159], v[168:171]
  v_cvt_pk_bf16_f32 v159, v162, v163
  v_mfma_f32_16x16x32_bf16 v[168:171], v[140:143], a[160:163], v[168:171]
  v_mfma_f32_16x16x32_bf16 v[168:171], v[144:147], a[164:167], v[168:171]
  s_waitcnt lgkmcnt(4)
  v_mfma_f32_16x16x32_bf16 v[60:63], a[250:253], v[172:175], v[60:63]
  v_mfma_f32_16x16x32_bf16 v[64:67], v[96:99], v[172:175], v[64:67]
  v_cvt_pk_bf16_f32 v200, v168, v169
  v_cvt_pk_bf16_f32 v201, v170, v171
  v_mfma_f32_16x16x32_bf16 v[68:71], v[100:103], v[172:175], v[68:71]
  s_waitcnt lgkmcnt(1)
  ds_read_b128 v[168:171], v18
  ds_read_b128 v[172:175], v15 offset:21504
  v_mfma_f32_16x16x32_bf16 v[72:75], a[250:253], v[164:167], v[72:75]
  s_waitcnt lgkmcnt(2)
  ds_read_b128 v[160:163], v18 offset:1024
  v_fma_f32 v180, v36, v212, v213
  v_mfma_f32_16x16x32_bf16 v[76:79], v[96:99], v[164:167], v[76:79]
  ds_read_b128 v[184:187], v18 offset:2048
  v_fma_f32 v188, v37, v212, v213
  v_mfma_f32_16x16x32_bf16 v[80:83], v[100:103], v[164:167], v[80:83]
  ds_read_b128 v[164:167], v15 offset:27648
  v_cvt_pk_bf16_f32 v180, v180, v188
  v_mfma_f32_16x16x32_bf16 v[84:87], a[250:253], v[176:179], v[84:87]
  v_fma_f32 v181, v38, v212, v213
  v_fma_f32 v188, v39, v212, v213
  v_mfma_f32_16x16x32_bf16 v[88:91], v[96:99], v[176:179], v[88:91]
  v_cvt_pk_bf16_f32 v181, v181, v188
  v_fma_f32 v182, v40, v212, v213
  v_mfma_f32_16x16x32_bf16 v[92:95], v[100:103], v[176:179], v[92:95]
  ds_read_b128 v[176:179], v15 offset:33792
  v_fma_f32 v204, v41, v212, v213
  v_mfma_f32_16x16x32_bf16 v[188:191], v[124:127], a[168:171], 0
  v_cvt_pk_bf16_f32 v182, v182, v204
  v_fma_f32 v183, v42, v212, v213
  v_mfma_f32_16x16x32_bf16 v[188:191], v[128:131], a[172:175], v[188:191]
  v_fma_f32 v204, v43, v212, v213
  v_cvt_pk_bf16_f32 v183, v183, v204
  v_mfma_f32_16x16x32_bf16 v[188:191], v[132:135], a[176:179], v[188:191]
  ds_write_b128 v16, v[180:183] offset:8192
  v_mfma_f32_16x16x32_bf16 v[188:191], v[136:139], a[180:183], v[188:191]
  v_fma_f32 v180, v48, v216, v217
  v_fma_f32 v204, v49, v216, v217
  v_mfma_f32_16x16x32_bf16 v[188:191], v[140:143], a[184:187], v[188:191]
  v_cvt_pk_bf16_f32 v180, v180, v204
  v_fma_f32 v181, v50, v216, v217
  v_mfma_f32_16x16x32_bf16 v[188:191], v[144:147], a[188:191], v[188:191]
  s_waitcnt lgkmcnt(5)
  v_fma_f32 v204, v51, v216, v217
  v_cvt_pk_bf16_f32 v181, v181, v204
  v_mfma_f32_16x16x32_bf16 v[60:63], v[168:171], v[172:175], v[60:63]
  s_waitcnt lgkmcnt(4)
  v_fma_f32 v182, v52, v216, v217
  v_fma_f32 v208, v53, v216, v217
  v_mfma_f32_16x16x32_bf16 v[64:67], v[160:163], v[172:175], v[64:67]
  s_waitcnt lgkmcnt(3)
  v_cvt_pk_bf16_f32 v204, v188, v189
  v_cvt_pk_bf16_f32 v205, v190, v191
  v_mfma_f32_16x16x32_bf16 v[68:71], v[184:187], v[172:175], v[68:71]
  s_waitcnt lgkmcnt(2)
  ds_read_b128 v[188:191], v18 offset:3072
  ds_read_b128 v[192:195], v15 offset:22528
  v_mfma_f32_16x16x32_bf16 v[72:75], v[168:171], v[164:167], v[72:75]
  ds_read_b128 v[196:199], v18 offset:4096
  v_cvt_pk_bf16_f32 v182, v182, v208
  v_mfma_f32_16x16x32_bf16 v[76:79], v[160:163], v[164:167], v[76:79]
  ds_read_b128 v[208:211], v18 offset:5120
  v_fma_f32 v183, v54, v216, v217
  v_mfma_f32_16x16x32_bf16 v[80:83], v[184:187], v[164:167], v[80:83]
  s_waitcnt lgkmcnt(5)
  ds_read_b128 v[164:167], v15 offset:28672
  v_fma_f32 v172, v55, v216, v217
  v_mfma_f32_16x16x32_bf16 v[84:87], v[168:171], v[176:179], v[84:87]
  v_cvt_pk_bf16_f32 v183, v183, v172
  v_fma_f32 v214, v44, v212, v213
  v_mfma_f32_16x16x32_bf16 v[88:91], v[160:163], v[176:179], v[88:91]
  ds_write_b128 v16, v[180:183] offset:14336
  v_mfma_f32_16x16x32_bf16 v[92:95], v[184:187], v[176:179], v[92:95]
  v_fma_f32 v176, v45, v212, v213
  v_cvt_pk_bf16_f32 v214, v214, v176
  v_mfma_f32_16x16x32_bf16 v[176:179], v[124:127], a[192:195], 0
  ds_read_b128 v[124:127], v15 offset:34816
  ds_read_b64 v[172:173], v19 offset:784
  v_mfma_f32_16x16x32_bf16 v[176:179], v[128:131], a[196:199], v[176:179]
  ds_read2_b64 v[168:171], v19 offset0:96 offset1:97
  v_fma_f32 v215, v46, v212, v213
  v_mfma_f32_16x16x32_bf16 v[176:179], v[132:135], a[200:203], v[176:179]
  v_fma_f32 v128, v47, v212, v213
  v_cvt_pk_bf16_f32 v215, v215, v128
  v_mfma_f32_16x16x32_bf16 v[176:179], v[136:139], a[204:207], v[176:179]
  ds_write_b64 v17, v[214:215] offset:8192
  v_mfma_f32_16x16x32_bf16 v[176:179], v[140:143], a[208:211], v[176:179]
  v_fma_f32 v128, v56, v216, v217
  v_fma_f32 v140, v57, v216, v217
  v_mfma_f32_16x16x32_bf16 v[176:179], v[144:147], a[212:215], v[176:179]
  s_waitcnt lgkmcnt(8)
  v_cvt_pk_bf16_f32 v128, v128, v140
  v_fma_f32 v129, v58, v216, v217
  v_mfma_f32_16x16x32_bf16 v[60:63], v[188:191], v[192:195], v[60:63]
  s_waitcnt lgkmcnt(7)
  ds_read_b128 v[144:147], v18 offset:6144
  ds_read_b128 v[140:143], v15 offset:23552
  v_mfma_f32_16x16x32_bf16 v[64:67], v[196:199], v[192:195], v[64:67]
  s_waitcnt lgkmcnt(8)
  ds_read_b128 v[136:139], v18 offset:7168
  v_cvt_pk_bf16_f32 v212, v176, v177
  v_mfma_f32_16x16x32_bf16 v[68:71], v[208:211], v[192:195], v[68:71]
  s_waitcnt lgkmcnt(8)
  ds_read_b128 v[132:135], v18 offset:8192
  v_cvt_pk_bf16_f32 v213, v178, v179
  v_mfma_f32_16x16x32_bf16 v[72:75], v[188:191], v[164:167], v[72:75]
  ds_read_b128 v[176:179], v15 offset:29696
  v_fma_f32 v130, v59, v216, v217
  v_mfma_f32_16x16x32_bf16 v[76:79], v[196:199], v[164:167], v[76:79]
  v_cvt_pk_bf16_f32 v129, v129, v130
  v_mfma_f32_16x16x32_bf16 v[80:83], v[208:211], v[164:167], v[80:83]
  s_waitcnt lgkmcnt(8)
  ds_write_b64 v17, v[128:129] offset:14336
  v_mfma_f32_16x16x32_bf16 v[84:87], v[188:191], v[124:127], v[84:87]
  ds_read_b128 v[164:167], v15 offset:35840
  v_mfma_f32_16x16x32_bf16 v[88:91], v[196:199], v[124:127], v[88:91]
  v_mfma_f32_16x16x32_bf16 v[92:95], v[208:211], v[124:127], v[92:95]
  s_waitcnt lgkmcnt(9)
  v_mfma_f32_16x16x16_bf16 v[124:127], v[158:159], v[152:153], 0
  ds_read_b128 v[128:131], v18 offset:9216
  ds_read_b128 v[160:163], v15 offset:24576
  v_mfma_f32_16x16x16_bf16 v[180:183], v[158:159], v[172:173], 0
  ds_read_b128 v[188:191], v18 offset:10240
  v_mfma_f32_16x16x32_bf16 v[124:127], v[154:157], v[148:151], v[124:127]
  s_waitcnt lgkmcnt(11)
  ds_read_b128 v[208:211], v18 offset:11264
  v_mfma_f32_16x16x32_bf16 v[180:183], v[154:157], v[168:171], v[180:183]
  s_waitcnt lgkmcnt(9)
  ds_read_b128 v[196:199], v15 offset:30720
  v_mfma_f32_16x16x32_bf16 v[60:63], v[144:147], v[140:143], v[60:63]
  s_waitcnt lgkmcnt(9)
  v_exp_f32 v124, v124
  v_mfma_f32_16x16x32_bf16 v[64:67], v[136:139], v[140:143], v[64:67]
  s_waitcnt lgkmcnt(8)
  v_exp_f32 v125, v125
  v_mfma_f32_16x16x32_bf16 v[68:71], v[132:135], v[140:143], v[68:71]
  s_waitcnt lgkmcnt(7)
  ds_read_b128 v[140:143], v15 offset:36864
  v_cvt_pk_bf16_f32 v216, v124, v125
  v_mfma_f32_16x16x32_bf16 v[72:75], v[144:147], v[176:179], v[72:75]
  v_exp_f32 v126, v126
  v_mfma_f32_16x16x32_bf16 v[76:79], v[136:139], v[176:179], v[76:79]
  v_exp_f32 v127, v127
  v_mfma_f32_16x16x32_bf16 v[80:83], v[132:135], v[176:179], v[80:83]
  s_waitcnt lgkmcnt(6)
  ds_read_b128 v[176:179], v18 offset:12288
  ds_read_b128 v[184:187], v15 offset:25600
  v_mfma_f32_16x16x32_bf16 v[84:87], v[144:147], v[164:167], v[84:87]
  ds_read_b128 v[144:147], v18 offset:13312
  v_cvt_pk_bf16_f32 v217, v126, v127
  v_mfma_f32_16x16x32_bf16 v[88:91], v[136:139], v[164:167], v[88:91]
  ds_read_b128 v[136:139], v18 offset:14336
  v_mfma_f32_16x16x32_bf16 v[92:95], v[132:135], v[164:167], v[92:95]
  s_waitcnt lgkmcnt(8)
  ds_read_b128 v[132:135], v15 offset:31744
  v_mfma_f32_16x16x32_bf16 v[60:63], v[128:131], v[160:163], v[60:63]
  s_waitcnt lgkmcnt(8)
  v_exp_f32 v180, v180
  v_mfma_f32_16x16x32_bf16 v[64:67], v[188:191], v[160:163], v[64:67]
  s_waitcnt lgkmcnt(7)
  v_exp_f32 v181, v181
  v_mfma_f32_16x16x32_bf16 v[68:71], v[208:211], v[160:163], v[68:71]
  s_waitcnt lgkmcnt(6)
  v_exp_f32 v182, v182
  v_mfma_f32_16x16x32_bf16 v[72:75], v[128:131], v[196:199], v[72:75]
  v_exp_f32 v183, v183
  v_mfma_f32_16x16x32_bf16 v[76:79], v[188:191], v[196:199], v[76:79]
  ds_read_b128 v[124:127], v15 offset:37888
  v_cvt_pk_bf16_f32 v220, v180, v181
  v_mfma_f32_16x16x32_bf16 v[80:83], v[208:211], v[196:199], v[80:83]
  s_waitcnt lgkmcnt(6)
  v_cvt_pk_bf16_f32 v221, v182, v183
  v_mfma_f32_16x16x32_bf16 v[84:87], v[128:131], v[140:143], v[84:87]
  v_mfma_f32_16x16x32_bf16 v[88:91], v[188:191], v[140:143], v[88:91]
  v_mfma_f32_16x16x32_bf16 v[92:95], v[208:211], v[140:143], v[92:95]
  s_waitcnt lgkmcnt(4)
  s_barrier
  v_mfma_f32_16x16x32_bf16 v[60:63], v[176:179], v[184:187], v[60:63]
  s_waitcnt lgkmcnt(3)
  ds_read_b128 v[194:197], v15 offset:8192
  ds_read_b128 v[190:193], v15 offset:9216
  v_mfma_f32_16x16x32_bf16 v[64:67], v[144:147], v[184:187], v[64:67]
  s_waitcnt lgkmcnt(4)
  ds_read_b128 v[208:211], v15 offset:10240
  v_mfma_f32_16x16x32_bf16 v[68:71], v[136:139], v[184:187], v[68:71]
  s_waitcnt lgkmcnt(4)
  ds_read_b128 v[224:227], v15 offset:11264
  v_cvt_pk_bf16_f32 v140, v60, v61
  v_mfma_f32_16x16x32_bf16 v[72:75], v[176:179], v[132:135], v[72:75]
  ds_read_b128 v[228:231], v15 offset:12288
  v_cvt_pk_bf16_f32 v141, v62, v63
  v_mfma_f32_16x16x32_bf16 v[76:79], v[144:147], v[132:135], v[76:79]
  ds_read_b128 v[232:235], v15 offset:13312
  v_cvt_pk_bf16_f32 v142, v64, v65
  v_mfma_f32_16x16x32_bf16 v[80:83], v[136:139], v[132:135], v[80:83]
  s_waitcnt lgkmcnt(6)
  v_cvt_pk_bf16_f32 v143, v66, v67
  v_cvt_pk_bf16_f32 v236, v68, v69
  v_mfma_f32_16x16x32_bf16 v[84:87], v[176:179], v[124:127], v[84:87]
  s_waitcnt vmcnt(0)
  ds_read_b64 v[176:177], v9
  ds_read_b64 v[178:179], v9 offset:32
  v_mfma_f32_16x16x32_bf16 v[88:91], v[144:147], v[124:127], v[88:91]
  s_lshl_b32 s60, s31, 5
  ds_read_b64 v[160:161], v9 offset:64
  v_cvt_pk_bf16_f32 v237, v70, v71
  v_mfma_f32_16x16x32_bf16 v[92:95], v[136:139], v[124:127], v[92:95]
  s_waitcnt lgkmcnt(8)
  v_permlane16_swap_b32 v140, v142
  v_mfma_f32_16x16x32_bf16 v[184:187], a[72:75], v[194:197], 0
  s_waitcnt lgkmcnt(7)
  v_permlane16_swap_b32 v141, v143
  v_mfma_f32_16x16x32_bf16 v[184:187], a[76:79], v[190:193], v[184:187]
  s_waitcnt lgkmcnt(6)
  buffer_store_dwordx4 v[140:143], v12, s[8:11], s32 offen
  s_nop 1
  ds_read_b128 v[140:143], v3
  v_mfma_f32_16x16x32_bf16 v[184:187], a[80:83], v[208:211], v[184:187]
  s_waitcnt lgkmcnt(6)
  ds_read_b128 v[144:147], v3 offset:864
  ds_read_b128 v[132:135], v3 offset:1728
  v_mfma_f32_16x16x32_bf16 v[184:187], a[84:87], v[224:227], v[184:187]
  s_waitcnt lgkmcnt(7)
  ds_read_b128 v[136:139], v6
  v_cvt_pk_bf16_f32 v240, v72, v73
  v_mfma_f32_16x16x32_bf16 v[184:187], a[88:91], v[228:231], v[184:187]
  s_waitcnt lgkmcnt(7)
  ds_read_b128 v[124:127], v3 offset:32
  v_cvt_pk_bf16_f32 v241, v74, v75
  v_mfma_f32_16x16x32_bf16 v[184:187], a[92:95], v[232:235], v[184:187]
  s_waitcnt lgkmcnt(5)
  ds_read_b128 v[128:131], v3 offset:896
  v_cvt_pk_bf16_f32 v242, v76, v77
  v_cvt_pk_bf16_f32 v243, v78, v79
  v_mfma_f32_16x16x16_bf16 v[60:63], a[224:225], v[176:177], 0
  v_permlane16_swap_b32 v240, v242
  v_cvt_pk_bf16_f32 v238, v80, v81
  v_mfma_f32_16x16x16_bf16 v[64:67], a[234:235], v[178:179], 0
  v_permlane16_swap_b32 v241, v243
  v_cvt_pk_bf16_f32 v176, v184, v185
  v_mfma_f32_16x16x16_bf16 v[68:71], a[244:245], v[160:161], 0
  s_add_u32 s61, s60, s30
  ds_read_b128 v[160:163], v3 offset:1760
  ds_read_b128 v[164:167], v6 offset:32
  s_waitcnt lgkmcnt(6)
  v_smfmac_f32_16x16x64_bf16 v[60:63], a[216:219], v[140:147], v0
  s_waitcnt lgkmcnt(5)
  ds_read_b128 v[140:143], v3 offset:64
  s_waitcnt lgkmcnt(5)
  v_smfmac_f32_16x16x64_bf16 v[60:63], a[220:223], v[132:139], v0
  s_add_u32 s60, s60, s29
  ds_read_b128 v[144:147], v3 offset:928
  v_cvt_pk_bf16_f32 v177, v186, v187
  v_mfma_f32_16x16x32_bf16 v[184:187], a[96:99], v[194:197], 0
  s_mul_i32 s62, s60, 7183
  ds_read_b128 v[132:135], v3 offset:1792
  v_cvt_pk_bf16_f32 v239, v82, v83
  v_mfma_f32_16x16x32_bf16 v[184:187], a[100:103], v[190:193], v[184:187]
  s_lshr_b32 s62, s62, 22
  ds_read_b128 v[136:139], v6 offset:64
  v_cvt_pk_bf16_f32 v244, v84, v85
  v_mfma_f32_16x16x32_bf16 v[184:187], a[104:107], v[208:211], v[184:187]
  s_waitcnt lgkmcnt(6)
  v_permlane16_swap_b32 v236, v238
  v_smfmac_f32_16x16x64_bf16 v[64:67], a[226:229], v[124:131], v0
  s_waitcnt lgkmcnt(5)
  s_mul_i32 s63, s62, 584
  s_waitcnt lgkmcnt(4)
  v_smfmac_f32_16x16x64_bf16 v[64:67], a[230:233], v[160:167], v0
  s_sub_u32 s63, s60, s63
  v_cvt_pk_bf16_f32 v245, v86, v87
  v_mfma_f32_16x16x32_bf16 v[184:187], a[108:111], v[224:227], v[184:187]
  s_lshr_b32 s64, s63, 3
  v_permlane16_swap_b32 v237, v239
  v_mfma_f32_16x16x32_bf16 v[184:187], a[112:115], v[228:231], v[184:187]
  s_and_b32 s65, s63, 7
  buffer_store_dwordx4 v[240:243], v13, s[8:11], s32 offen
  v_cvt_pk_bf16_f32 v246, v88, v89
  v_mfma_f32_16x16x32_bf16 v[184:187], a[116:119], v[232:235], v[184:187]
  s_waitcnt lgkmcnt(2)
  v_cvt_pk_bf16_f32 v247, v90, v91
  v_cvt_pk_bf16_f32 v198, v92, v93
  v_smfmac_f32_16x16x64_bf16 v[68:71], a[236:239], v[140:147], v0
  s_waitcnt lgkmcnt(0)
  v_cvt_pk_bf16_f32 v199, v94, v95
  v_smfmac_f32_16x16x64_bf16 v[68:71], a[240:243], v[132:139], v0
  s_lshl_b32 s66, s62, 3
  v_cvt_pk_bf16_f32 v178, v184, v185
  v_mfma_f32_16x16x32_bf16 v[160:163], a[120:123], v[194:197], 0
  s_add_u32 s65, s65, s66
  v_cvt_pk_bf16_f32 v179, v186, v187
  v_mul_f32 v104, v60, v60
  v_mfma_f32_16x16x32_bf16 v[160:163], a[124:127], v[190:193], v[160:163]
  s_cmp_ge_u32 s60, 5256
  ds_read_b64 v[184:185], v10
  v_add_f32 v105, v60, v61
  v_mfma_f32_16x16x32_bf16 v[160:163], a[128:131], v[208:211], v[160:163]
  s_cselect_b32 s64, s63, s64
  ds_read_b64 v[186:187], v10 offset:32
  v_fmac_f32 v104, v61, v61
  v_mfma_f32_16x16x32_bf16 v[160:163], a[132:135], v[224:227], v[160:163]
  s_cselect_b32 s65, 72, s65
  ds_read_b64 v[182:183], v10 offset:64
  v_add_f32 v105, v105, v62
  v_mfma_f32_16x16x32_bf16 v[160:163], a[136:139], v[228:231], v[160:163]
  s_mul_i32 s66, s65, 1373568
  ds_read_b128 v[132:135], v4
  ds_read_b128 v[136:139], v4 offset:864
  v_mfma_f32_16x16x32_bf16 v[160:163], a[140:143], v[232:235], v[160:163]
  s_mul_i32 s67, s64, 2688
  ds_read_b128 v[140:143], v4 offset:1728
  v_fmac_f32 v104, v62, v62
  v_mfma_f32_16x16x32_bf16 v[240:243], a[0:3], v[194:197], 0
  s_add_u32 s35, s66, s67
  ds_read_b128 v[144:147], v7
  v_add_f32 v105, v105, v63
  v_mfma_f32_16x16x32_bf16 v[240:243], a[4:7], v[190:193], v[240:243]
  s_cmp_ge_u32 s61, 667
  v_cvt_pk_bf16_f32 v180, v160, v161
  v_cvt_pk_bf16_f32 v181, v162, v163
  v_mfma_f32_16x16x32_bf16 v[240:243], a[8:11], v[208:211], v[240:243]
  s_cselect_b32 s35, 268435456, s35
  v_permlane16_swap_b32 v244, v246
  v_mfma_f32_16x16x32_bf16 v[240:243], a[12:15], v[224:227], v[240:243]
  s_cmp_ge_u32 s60, 5329
  ds_read_b128 v[160:163], v4 offset:32
  ds_read_b128 v[164:167], v4 offset:896
  v_mfma_f32_16x16x32_bf16 v[240:243], a[16:19], v[228:231], v[240:243]
  s_cselect_b32 s35, 268435456, s35
  ds_read_b128 v[124:127], v4 offset:1760
  v_fmac_f32 v104, v63, v63
  v_mfma_f32_16x16x32_bf16 v[240:243], a[20:23], v[232:235], v[240:243]
  s_waitcnt lgkmcnt(5)
  ds_read_b128 v[128:131], v7 offset:32
  v_permlane16_swap_b32 v245, v247
  v_mfma_f32_16x16x16_bf16 v[72:75], a[224:225], v[184:185], 0
  v_add_f32 v105, v105, v64
  v_fmac_f32 v104, v64, v64
  v_add_f32 v105, v105, v65
  v_mfma_f32_16x16x16_bf16 v[76:79], a[234:235], v[186:187], 0
  v_cvt_pk_bf16_f32 v184, v240, v241
  v_cvt_pk_bf16_f32 v185, v242, v243
  v_fmac_f32 v104, v65, v65
  v_mfma_f32_16x16x16_bf16 v[80:83], a[244:245], v[182:183], 0
  v_add_f32 v105, v105, v66
  v_fmac_f32 v104, v66, v66
  v_add_f32 v105, v105, v67
  v_fmac_f32 v104, v67, v67
  v_smfmac_f32_16x16x64_bf16 v[72:75], a[216:219], v[132:139], v0
  s_waitcnt lgkmcnt(4)
  buffer_store_dwordx4 v[236:239], v22, s[8:11], s32 offen
  ds_read_b128 v[132:135], v4 offset:64
  v_smfmac_f32_16x16x64_bf16 v[72:75], a[220:223], v[140:147], v0
  s_cmp_eq_u32 s65, 0
  ds_read_b128 v[136:139], v4 offset:928
  ds_read_b128 v[140:143], v4 offset:1792
  v_mfma_f32_16x16x32_bf16 v[236:239], a[24:27], v[194:197], 0
  s_cselect_b32 s36, 268435456, s35
  ds_read_b128 v[144:147], v7 offset:64
  v_add_f32 v105, v105, v68
  v_mfma_f32_16x16x32_bf16 v[236:239], a[28:31], v[190:193], v[236:239]
  s_add_u32 s37, s35, 195360
  v_mul_f32 v242, v72, v72
  v_add_f32 v243, v72, v73
  v_mfma_f32_16x16x32_bf16 v[236:239], a[32:35], v[208:211], v[236:239]
  s_waitcnt lgkmcnt(6)
  v_fmac_f32 v242, v73, v73
  v_add_f32 v243, v243, v74
  v_smfmac_f32_16x16x64_bf16 v[76:79], a[226:229], v[160:167], v0
  s_waitcnt lgkmcnt(4)
  v_fmac_f32 v242, v74, v74
  v_smfmac_f32_16x16x64_bf16 v[76:79], a[230:233], v[124:131], v0
  s_add_u32 s38, s35, 390720
  v_add_f32 v243, v243, v75
  v_mfma_f32_16x16x32_bf16 v[236:239], a[36:39], v[224:227], v[236:239]
  s_add_u32 s39, s35, 586080
  v_fmac_f32 v242, v75, v75
  v_fmac_f32 v104, v68, v68
  v_mfma_f32_16x16x32_bf16 v[236:239], a[40:43], v[228:231], v[236:239]
  s_add_u32 s40, s35, 781440
  v_add_f32 v243, v243, v76
  v_fmac_f32 v242, v76, v76
  v_mfma_f32_16x16x32_bf16 v[236:239], a[44:47], v[232:235], v[236:239]
  s_waitcnt lgkmcnt(2)
  v_add_f32 v243, v243, v77
  v_fmac_f32 v242, v77, v77
  v_smfmac_f32_16x16x64_bf16 v[80:83], a[236:239], v[132:139], v0
  s_waitcnt lgkmcnt(0)
  v_add_f32 v243, v243, v78
  v_smfmac_f32_16x16x64_bf16 v[80:83], a[240:243], v[140:147], v0
  s_add_u32 s41, s35, 981120
  v_cvt_pk_bf16_f32 v186, v236, v237
  v_mfma_f32_16x16x32_bf16 v[124:127], a[48:51], v[194:197], 0
  s_add_u32 s42, s35, 1176480
  v_cvt_pk_bf16_f32 v187, v238, v239
  v_fmac_f32 v242, v78, v78
  v_mfma_f32_16x16x32_bf16 v[124:127], a[52:55], v[190:193], v[124:127]
  s_add_u32 s43, s35, 1371840
  ds_read_b64 v[236:237], v11
  v_add_f32 v243, v243, v79
  v_mfma_f32_16x16x32_bf16 v[124:127], a[56:59], v[208:211], v[124:127]
  s_add_u32 s44, s35, 1567200
  ds_read_b64 v[238:239], v11 offset:32
  v_fmac_f32 v242, v79, v79
  v_mfma_f32_16x16x32_bf16 v[124:127], a[60:63], v[224:227], v[124:127]
  s_cmp_eq_u32 s64, 0
  ds_read_b64 v[240:241], v11 offset:64
  v_add_f32 v243, v243, v80
  v_mfma_f32_16x16x32_bf16 v[124:127], a[64:67], v[228:231], v[124:127]
  s_cselect_b64 s[52:53], s[48:49], 0
  buffer_store_dwordx4 v[244:247], v14, s[8:11], s32 offen
  ds_read_b128 v[140:143], v5
  v_mfma_f32_16x16x32_bf16 v[124:127], a[68:71], v[232:235], v[124:127]
  s_cmp_eq_u32 s64, 72
  ds_read_b128 v[144:147], v5 offset:864
  ds_read_b128 v[132:135], v5 offset:1728
  v_mfma_f32_16x16x32_bf16 v[244:247], v[194:197], a[144:147], 0
  s_cselect_b64 s[52:53], s[50:51], s[52:53]
  ds_read_b128 v[136:139], v8
  v_fmac_f32 v242, v80, v80
  v_mfma_f32_16x16x32_bf16 v[244:247], v[190:193], a[148:151], v[244:247]
  s_add_u32 s31, s31, 1
  v_cndmask_b32 v106, v21, 2.0, s[52:53]
  v_cvt_pk_bf16_f32 v188, v124, v125
  v_mfma_f32_16x16x32_bf16 v[244:247], v[208:211], a[152:155], v[244:247]
  s_mov_b32 m0, s58
  v_cvt_pk_bf16_f32 v189, v126, v127
  v_add_f32 v105, v105, v69
  v_mfma_f32_16x16x32_bf16 v[244:247], v[224:227], a[156:159], v[244:247]
  ds_read_b128 v[124:127], v5 offset:32
  ds_read_b128 v[128:131], v5 offset:896
  v_mfma_f32_16x16x32_bf16 v[244:247], v[228:231], a[160:163], v[244:247]
  ds_read_b128 v[160:163], v5 offset:1760
  v_fmac_f32 v104, v69, v69
  v_mfma_f32_16x16x32_bf16 v[244:247], v[232:235], a[164:167], v[244:247]
  s_waitcnt lgkmcnt(5)
  ds_read_b128 v[164:167], v8 offset:32
  v_add_f32 v243, v243, v81
  v_fmac_f32 v242, v81, v81
  v_mfma_f32_16x16x16_bf16 v[84:87], a[224:225], v[236:237], 0
  v_add_f32 v105, v105, v70
  v_fmac_f32 v104, v70, v70
  v_add_f32 v243, v243, v82
  v_mfma_f32_16x16x16_bf16 v[88:91], a[234:235], v[238:239], 0
  v_cvt_pk_bf16_f32 v202, v244, v245
  v_cvt_pk_bf16_f32 v203, v246, v247
  v_fmac_f32 v242, v82, v82
  v_mfma_f32_16x16x16_bf16 v[92:95], a[244:245], v[240:241], 0
  v_add_f32 v105, v105, v71
  v_fmac_f32 v104, v71, v71
  v_add_f32 v243, v243, v83
  v_fmac_f32 v242, v83, v83
  v_smfmac_f32_16x16x64_bf16 v[84:87], a[216:219], v[140:147], v0
  s_waitcnt lgkmcnt(4)
  ds_read_b128 v[140:143], v5 offset:64
  ds_read_b128 v[144:147], v5 offset:928
  v_smfmac_f32_16x16x64_bf16 v[84:87], a[220:223], v[132:139], v0
  ds_read_b128 v[132:135], v5 offset:1792
  v_mfma_f32_16x16x32_bf16 v[244:247], v[194:197], a[168:171], 0
  ds_read_b128 v[136:139], v8 offset:64
  v_mfma_f32_16x16x32_bf16 v[244:247], v[190:193], a[172:175], v[244:247]
  v_mul_f32 v238, v84, v84
  v_add_f32 v239, v84, v85
  v_mfma_f32_16x16x32_bf16 v[244:247], v[208:211], a[176:179], v[244:247]
  s_waitcnt lgkmcnt(6)
  v_fmac_f32 v238, v85, v85
  v_add_f32 v239, v239, v86
  v_smfmac_f32_16x16x64_bf16 v[88:91], a[226:229], v[124:131], v0
  s_waitcnt lgkmcnt(4)
  buffer_store_dwordx2 v[198:199], v23, s[8:11], s32 offen
  v_fmac_f32 v238, v86, v86
  v_smfmac_f32_16x16x64_bf16 v[88:91], a[230:233], v[160:167], v0
  v_add_f32 v239, v239, v87
  v_mfma_f32_16x16x32_bf16 v[244:247], v[224:227], a[180:183], v[244:247]
  v_fmac_f32 v238, v87, v87
  v_mfma_f32_16x16x32_bf16 v[244:247], v[228:231], a[184:187], v[244:247]
  v_add_f32 v239, v239, v88
  v_fmac_f32 v238, v88, v88
  v_mfma_f32_16x16x32_bf16 v[244:247], v[232:235], a[188:191], v[244:247]
  s_waitcnt lgkmcnt(0)
  buffer_load_dwordx4 v106, s[4:7], s36 offen nt lds
  v_smfmac_f32_16x16x64_bf16 v[92:95], a[236:239], v[140:147], v0
  v_add_f32 v239, v239, v89
  v_smfmac_f32_16x16x64_bf16 v[92:95], a[240:243], v[132:139], v0
  ds_read_b128 v[132:135], v15 offset:14336
  v_fmac_f32 v238, v89, v89
  v_mfma_f32_16x16x32_bf16 v[160:163], v[194:197], a[192:195], 0
  ds_read_b128 v[124:127], v15 offset:15360
  v_add_f32 v239, v239, v90
  v_mfma_f32_16x16x32_bf16 v[160:163], v[190:193], a[196:199], v[160:163]
  ds_read_b128 v[128:131], v15 offset:16384
  v_fmac_f32 v238, v90, v90
  v_mfma_f32_16x16x32_bf16 v[160:163], v[208:211], a[200:203], v[160:163]
  buffer_load_dwordx4 v106, s[4:7], s37 offen offset:864 nt lds
  v_mfma_f32_16x16x32_bf16 v[160:163], v[224:227], a[204:207], v[160:163]
  ds_read_b128 v[136:139], v15 offset:17408
  ds_read_b128 v[140:143], v15 offset:18432
  v_mfma_f32_16x16x32_bf16 v[160:163], v[228:231], a[208:211], v[160:163]
  ds_read_b128 v[144:147], v15 offset:19456
  v_add_f32 v239, v239, v91
  v_mfma_f32_16x16x32_bf16 v[160:163], v[232:235], a[212:215], v[160:163]
  v_fmac_f32 v238, v91, v91
  v_add_f32 v239, v239, v92
  v_fmac_f32 v238, v92, v92
  v_mfma_f32_16x16x16_bf16 v[192:195], v[180:181], v[152:153], 0
  v_cvt_pk_bf16_f32 v206, v244, v245
  v_cvt_pk_bf16_f32 v207, v246, v247
  v_add_f32 v239, v239, v93
  v_mfma_f32_16x16x16_bf16 v[244:247], v[158:159], v[188:189], 0
  v_fmac_f32 v238, v93, v93
  v_add_f32 v239, v239, v94
  v_fmac_f32 v238, v94, v94
  v_add_f32 v239, v239, v95
  v_mfma_f32_16x16x32_bf16 v[192:195], v[176:179], v[148:151], v[192:195]
  buffer_load_dwordx4 v106, s[4:7], s38 offen offset:1728 nt lds
  v_mfma_f32_16x16x32_bf16 v[244:247], v[154:157], v[184:187], v[244:247]
  s_waitcnt lgkmcnt(5)
  v_fmac_f32 v238, v95, v95
  v_cvt_pk_bf16_f32 v214, v160, v161
  v_mfma_f32_16x16x32_bf16 v[232:235], a[72:75], v[132:135], 0
  s_waitcnt lgkmcnt(4)
  buffer_load_dwordx4 v106, s[4:7], s39 offen offset:2592 nt lds
  v_mfma_f32_16x16x32_bf16 v[232:235], a[76:79], v[124:127], v[232:235]
  s_waitcnt lgkmcnt(3)
  v_permlane32_swap_b32 v239, v238
  v_mfma_f32_16x16x32_bf16 v[232:235], a[80:83], v[128:131], v[232:235]
  s_waitcnt lgkmcnt(2)
  v_permlane32_swap_b32 v105, v104
  v_mfma_f32_16x16x32_bf16 v[232:235], a[84:87], v[136:139], v[232:235]
  s_waitcnt lgkmcnt(1)
  v_permlane32_swap_b32 v243, v242
  v_mfma_f32_16x16x32_bf16 v[232:235], a[88:91], v[140:143], v[232:235]
  s_waitcnt lgkmcnt(0)
  v_add_f32 v239, v239, v238
  v_add_f32 v105, v105, v104
  v_mfma_f32_16x16x32_bf16 v[232:235], a[92:95], v[144:147], v[232:235]
  buffer_load_dwordx4 v106, s[4:7], s40 offen offset:3456 nt lds
  v_mfma_f32_16x16x32_bf16 v[196:199], a[96:99], v[132:135], 0
  s_mov_b32 m0, s59
  v_add_f32 v243, v243, v242
  v_mov_b32 v238, v239
  v_mfma_f32_16x16x32_bf16 v[196:199], a[100:103], v[124:127], v[196:199]
  s_mov_b32 s32, s33
  v_permlane16_swap_b32 v105, v243
  v_mfma_f32_16x16x32_bf16 v[196:199], a[104:107], v[128:131], v[196:199]
  s_mov_b32 s33, s34
  v_permlane16_swap_b32 v239, v238
  v_mfma_f32_16x16x32_bf16 v[196:199], a[108:111], v[136:139], v[196:199]
  s_mov_b32 s34, s35
  buffer_load_dwordx4 v106, s[4:7], s41 offen nt lds
  v_mfma_f32_16x16x32_bf16 v[196:199], a[112:115], v[140:143], v[196:199]
  v_add_f32 v105, v105, v243
  v_add_f32 v239, v239, v238
  v_mfma_f32_16x16x32_bf16 v[196:199], a[116:119], v[144:147], v[196:199]
  ds_write_b32 v107, v105
  ds_write_b32 v107, v239 offset:512
  v_cvt_pk_bf16_f32 v215, v162, v163
  v_exp_f32 v192, v192
  buffer_load_dwordx4 v106, s[4:7], s42 offen offset:864 nt lds
  v_exp_f32 v193, v193
  v_exp_f32 v194, v194
  v_exp_f32 v195, v195
  v_exp_f32 v244, v244
  v_exp_f32 v245, v245
  v_exp_f32 v246, v246
  v_exp_f32 v247, v247
  v_cvt_pk_bf16_f32 v160, v232, v233
  s_waitcnt lgkmcnt(0)
  s_barrier
  v_mfma_f32_16x16x32_bf16 v[228:231], a[120:123], v[132:135], 0
  buffer_load_dwordx4 v106, s[4:7], s43 offen offset:1728 nt lds
  v_mfma_f32_16x16x32_bf16 v[228:231], a[124:127], v[124:127], v[228:231]
  ds_read_b128 v[224:227], v15
  ds_read_b128 v[208:211], v15 offset:1024
  v_mfma_f32_16x16x32_bf16 v[228:231], a[128:131], v[128:131], v[228:231]
  v_cvt_pk_bf16_f32 v161, v234, v235
  v_cvt_pk_bf16_f32 v162, v196, v197
  v_mfma_f32_16x16x32_bf16 v[228:231], a[132:135], v[136:139], v[228:231]
  v_cvt_pk_bf16_f32 v163, v198, v199
  v_cvt_pk_bf16_f32 v218, v192, v193
  v_mfma_f32_16x16x32_bf16 v[228:231], a[136:139], v[140:143], v[228:231]
  buffer_load_dwordx4 v106, s[4:7], s44 offen offset:2592 nt lds
  v_mfma_f32_16x16x32_bf16 v[228:231], a[140:143], v[144:147], v[228:231]
  v_cvt_pk_bf16_f32 v219, v194, v195
  v_cvt_pk_bf16_f32 v232, v244, v245
  v_cvt_pk_bf16_f32 v233, v246, v247
  v_mfma_f32_16x16x16_bf16 v[244:247], v[180:181], v[188:189], 0
  ds_read_b64 v[196:197], v19 offset:16
  v_mfma_f32_16x16x16_bf16 v[236:239], v[180:181], v[172:173], 0
  ds_read2_b64 v[192:195], v19 offset0:0 offset1:1
  v_cvt_pk_bf16_f32 v164, v228, v229
  v_cvt_pk_bf16_f32 v165, v230, v231
  v_add_u32 v19, 1160, v19
  v_mfma_f32_16x16x32_bf16 v[244:247], v[176:179], v[184:187], v[244:247]
  s_waitcnt lgkmcnt(2)
  v_add_f32 v224, v224, v225
  v_add_f32 v226, v226, v227
  v_mfma_f32_16x16x32_bf16 v[236:239], v[176:179], v[168:171], v[236:239]
  v_add_f32 v208, v208, v209
  v_add_f32 v210, v210, v211
  v_mfma_f32_16x16x32_bf16 v[228:231], v[132:135], a[144:147], 0
  v_exp_f32 v244, v244
  v_mfma_f32_16x16x32_bf16 v[228:231], v[124:127], a[148:151], v[228:231]
  v_exp_f32 v245, v245
  v_mfma_f32_16x16x32_bf16 v[228:231], v[128:131], a[152:155], v[228:231]
  v_exp_f32 v246, v246
  v_mfma_f32_16x16x32_bf16 v[228:231], v[136:139], a[156:159], v[228:231]
  v_exp_f32 v247, v247
  v_mfma_f32_16x16x32_bf16 v[228:231], v[140:143], a[160:163], v[228:231]
  v_exp_f32 v236, v236
  v_mfma_f32_16x16x32_bf16 v[228:231], v[144:147], a[164:167], v[228:231]
  v_exp_f32 v237, v237
  v_mfma_f32_16x16x32_bf16 v[240:243], v[132:135], a[168:171], 0
  v_exp_f32 v238, v238
  v_mfma_f32_16x16x32_bf16 v[240:243], v[124:127], a[172:175], v[240:243]
  v_exp_f32 v239, v239
  v_mfma_f32_16x16x32_bf16 v[240:243], v[128:131], a[176:179], v[240:243]
  v_cvt_pk_bf16_f32 v234, v244, v245
  v_cvt_pk_bf16_f32 v235, v246, v247
  v_mfma_f32_16x16x32_bf16 v[240:243], v[136:139], a[180:183], v[240:243]
  v_cvt_pk_bf16_f32 v104, v228, v229
  v_cvt_pk_bf16_f32 v105, v230, v231
  v_mfma_f32_16x16x32_bf16 v[240:243], v[140:143], a[184:187], v[240:243]
  v_cvt_pk_bf16_f32 v222, v236, v237
  v_cvt_pk_bf16_f32 v223, v238, v239
  v_mfma_f32_16x16x32_bf16 v[240:243], v[144:147], a[188:191], v[240:243]
  s_waitcnt lgkmcnt(1)
  v_add_f32 v224, v224, v226
  v_add_f32 v208, v208, v210
  v_mul_f32 v225, 0x3baaaaab, v224
  v_mfma_f32_16x16x16_bf16 v[236:239], v[164:165], v[152:153], 0
  v_fma_f32 v208, -v225, v224, v208
  v_max_f32 v208, 0, v208
  v_add_f32 v208, 0x3afba882, v208
  v_mfma_f32_16x16x16_bf16 v[228:231], v[196:197], v[152:153], v[2:5]
  v_cvt_pk_bf16_f32 v108, v240, v241
  v_cvt_pk_bf16_f32 v109, v242, v243
  v_rsq_f32 v208, v208
  v_mfma_f32_16x16x32_bf16 v[236:239], v[160:163], v[148:151], v[236:239]
  s_waitcnt lgkmcnt(0)
  v_mul_f32 v208, 0x40ca568a, v208
  v_mul_f32 v209, -v225, v208
  v_mfma_f32_16x16x32_bf16 v[228:231], v[192:195], v[148:151], v[228:231]
  ds_write_b64 v111, v[208:209]
  v_mfma_f32_16x16x32_bf16 v[148:151], v[132:135], a[192:195], 0
  ds_read_b64 v[240:241], v115 offset:768
  v_mfma_f32_16x16x32_bf16 v[148:151], v[124:127], a[196:199], v[148:151]
  v_exp_f32 v236, v236
  v_mfma_f32_16x16x32_bf16 v[148:151], v[128:131], a[200:203], v[148:151]
  ds_read_u16 v106, v20
  v_mfma_f32_16x16x32_bf16 v[148:151], v[136:139], a[204:207], v[148:151]
  v_exp_f32 v237, v237
  v_mfma_f32_16x16x32_bf16 v[148:151], v[140:143], a[208:211], v[148:151]
  ds_read_u16 v110, v20 offset:32
  v_cvt_pk_bf16_f32 v116, v236, v237
  v_mfma_f32_16x16x32_bf16 v[148:151], v[144:147], a[212:215], v[148:151]
  v_exp_f32 v238, v238
  v_mfma_f32_16x16x16_bf16 v[208:211], v[164:165], v[188:189], 0
  ds_read_u16 v114, v20 offset:64
  v_exp_f32 v239, v239
  v_mfma_f32_16x16x16_bf16 v[224:227], v[196:197], v[188:189], v[2:5]
  v_exp_f32 v228, v228
  v_cvt_pk_bf16_f32 v117, v238, v239
  v_cvt_pk_bf16_f32 v118, v228, 0
  v_mfma_f32_16x16x32_bf16 v[208:211], v[160:163], v[184:187], v[208:211]
  s_waitcnt lgkmcnt(3)
  v_cvt_pk_bf16_f32 v112, v148, v149
  v_cvt_pk_bf16_f32 v113, v150, v151
  v_mfma_f32_16x16x32_bf16 v[224:227], v[192:195], v[184:187], v[224:227]
  v_fma_f32 v184, v60, v240, v241
  v_fma_f32 v148, v61, v240, v241
  v_mfma_f32_16x16x32_bf16 v[228:231], a[0:3], v[132:135], 0
  v_exp_f32 v208, v208
  v_mfma_f32_16x16x32_bf16 v[228:231], a[4:7], v[124:127], v[228:231]
  v_exp_f32 v209, v209
  v_mfma_f32_16x16x32_bf16 v[228:231], a[8:11], v[128:131], v[228:231]
  v_exp_f32 v210, v210
  v_mfma_f32_16x16x32_bf16 v[228:231], a[12:15], v[136:139], v[228:231]
  v_exp_f32 v211, v211
  v_mfma_f32_16x16x32_bf16 v[228:231], a[16:19], v[140:143], v[228:231]
  v_exp_f32 v224, v224
  v_mfma_f32_16x16x32_bf16 v[228:231], a[20:23], v[144:147], v[228:231]
  v_cvt_pk_bf16_f32 v120, v208, v209
  v_cvt_pk_bf16_f32 v121, v210, v211
  v_mfma_f32_16x16x32_bf16 v[208:211], a[246:249], v[216:219], 0
  v_cvt_pk_bf16_f32 v122, v224, 0
  v_cvt_pk_bf16_f32 v184, v184, v148
  v_mfma_f32_16x16x32_bf16 v[208:211], a[246:249], v[116:119], v[208:211]
  v_cvt_pk_bf16_f32 v148, v228, v229
  v_cvt_pk_bf16_f32 v149, v230, v231
  v_mfma_f32_16x16x32_bf16 v[228:231], v[200:203], v[216:219], 0
  s_waitcnt lgkmcnt(2)
  v_fma_f32 v185, v62, v240, v241
  v_fma_f32 v224, v63, v240, v241
  v_mfma_f32_16x16x32_bf16 v[228:231], v[104:107], v[116:119], v[228:231]
  v_cvt_pk_bf16_f32 v185, v185, v224
  v_fma_f32 v186, v64, v240, v241
  v_mfma_f32_16x16x32_bf16 v[224:227], v[204:207], v[216:219], 0
  s_waitcnt lgkmcnt(1)
  v_fma_f32 v236, v65, v240, v241
  v_cvt_pk_bf16_f32 v186, v186, v236
  v_mfma_f32_16x16x32_bf16 v[224:227], v[108:111], v[116:119], v[224:227]
  v_fma_f32 v187, v66, v240, v241
  v_fma_f32 v242, v67, v240, v241
  v_mfma_f32_16x16x32_bf16 v[236:239], v[212:215], v[216:219], 0
  s_waitcnt lgkmcnt(0)
  v_cvt_pk_bf16_f32 v187, v187, v242
  v_fma_f32 v216, v68, v240, v241
  v_mfma_f32_16x16x32_bf16 v[236:239], v[112:115], v[116:119], v[236:239]
  ds_write_b128 v16, v[184:187] offset:2048
  v_mfma_f32_16x16x32_bf16 v[184:187], a[24:27], v[132:135], 0
  v_fma_f32 v242, v69, v240, v241
  v_cvt_pk_bf16_f32 v216, v216, v242
  v_mfma_f32_16x16x32_bf16 v[184:187], a[28:31], v[124:127], v[184:187]
  v_fma_f32 v217, v70, v240, v241
  v_fma_f32 v242, v71, v240, v241
  v_mfma_f32_16x16x32_bf16 v[184:187], a[32:35], v[128:131], v[184:187]
  v_cvt_pk_bf16_f32 v217, v217, v242
  v_mul_f32 v208, 0x3ee9a3cd, v208
  v_mfma_f32_16x16x32_bf16 v[184:187], a[36:39], v[136:139], v[184:187]
  ds_write_b64 v17, v[216:217] offset:2048
  v_mfma_f32_16x16x32_bf16 v[184:187], a[40:43], v[140:143], v[184:187]
  v_rcp_f32 v188, v208
  v_mfma_f32_16x16x32_bf16 v[184:187], a[44:47], v[144:147], v[184:187]
  v_mul_f32 v228, v228, v188
  v_mul_f32 v229, v229, v188
  v_cvt_pk_bf16_f32 v216, v228, v229
  v_mfma_f32_16x16x16_bf16 v[240:243], v[164:165], v[172:173], 0
  v_mul_f32 v230, v230, v188
  v_mul_f32 v231, v231, v188
  v_cvt_pk_bf16_f32 v217, v230, v231
  v_mfma_f32_16x16x16_bf16 v[228:231], v[196:197], v[172:173], v[2:5]
  v_cvt_pk_bf16_f32 v150, v184, v185
  v_cvt_pk_bf16_f32 v151, v186, v187
  v_mul_f32 v224, v224, v188
  v_mul_f32 v225, v225, v188
  v_mfma_f32_16x16x32_bf16 v[240:243], v[160:163], v[168:171], v[240:243]
  v_cvt_pk_bf16_f32 v218, v224, v225
  v_mul_f32 v226, v226, v188
  v_mfma_f32_16x16x32_bf16 v[228:231], v[192:195], v[168:171], v[228:231]
  v_mul_f32 v227, v227, v188
  v_cvt_pk_bf16_f32 v219, v226, v227
  v_mfma_f32_16x16x32_bf16 v[224:227], a[246:249], v[232:235], 0
  ds_write_b128 v16, v[216:219] offset:20480
  v_mfma_f32_16x16x32_bf16 v[224:227], a[246:249], v[120:123], v[224:227]
  v_exp_f32 v240, v240
  v_mfma_f32_16x16x32_bf16 v[216:219], v[200:203], v[232:235], 0
  v_exp_f32 v241, v241
  v_mfma_f32_16x16x32_bf16 v[216:219], v[104:107], v[120:123], v[216:219]
  v_exp_f32 v242, v242
  v_mfma_f32_16x16x32_bf16 v[168:171], v[204:207], v[232:235], 0
  v_exp_f32 v243, v243
  v_mfma_f32_16x16x32_bf16 v[168:171], v[108:111], v[120:123], v[168:171]
  v_exp_f32 v228, v228
  v_mfma_f32_16x16x32_bf16 v[184:187], v[212:215], v[232:235], 0
  v_cvt_pk_bf16_f32 v116, v240, v241
  v_cvt_pk_bf16_f32 v117, v242, v243
  v_mfma_f32_16x16x32_bf16 v[184:187], v[112:115], v[120:123], v[184:187]
  v_cvt_pk_bf16_f32 v118, v228, 0
  v_mul_f32 v224, 0x3ee9a3cd, v224
  v_mfma_f32_16x16x32_bf16 v[228:231], a[48:51], v[132:135], 0
  v_rcp_f32 v240, v224
  v_mfma_f32_16x16x32_bf16 v[228:231], a[52:55], v[124:127], v[228:231]
  v_mul_f32 v216, v216, v240
  v_mul_f32 v217, v217, v240
  v_mfma_f32_16x16x32_bf16 v[228:231], a[56:59], v[128:131], v[228:231]
  v_cvt_pk_bf16_f32 v124, v216, v217
  v_mul_f32 v218, v218, v240
  v_mfma_f32_16x16x32_bf16 v[228:231], a[60:63], v[136:139], v[228:231]
  v_mul_f32 v219, v219, v240
  v_cvt_pk_bf16_f32 v125, v218, v219
  v_mfma_f32_16x16x32_bf16 v[228:231], a[64:67], v[140:143], v[228:231]
  v_mul_f32 v168, v168, v240
  v_mul_f32 v169, v169, v240
  v_mfma_f32_16x16x32_bf16 v[228:231], a[68:71], v[144:147], v[228:231]
  s_waitcnt lgkmcnt(1)
  s_barrier
  v_mfma_f32_16x16x32_bf16 v[216:219], v[220:223], a[246:249], 0
  v_cvt_pk_bf16_f32 v126, v168, v169
  v_mul_f32 v170, v170, v240
  v_mfma_f32_16x16x32_bf16 v[216:219], v[116:119], a[246:249], v[216:219]
  v_cvt_pk_bf16_f32 v152, v228, v229
  v_cvt_pk_bf16_f32 v153, v230, v231
  v_mfma_f32_16x16x32_bf16 v[144:147], v[220:223], v[200:203], 0
  v_mul_f32 v171, v171, v240
  v_cvt_pk_bf16_f32 v127, v170, v171
  v_mfma_f32_16x16x32_bf16 v[144:147], v[116:119], v[104:107], v[144:147]
  ds_write_b128 v16, v[124:127] offset:26624
  v_mfma_f32_16x16x32_bf16 v[140:143], v[220:223], v[204:207], 0
  v_mul_f32 v216, 0x3ee9a3cd, v216
  v_mul_f32 v236, v236, v188
  v_mfma_f32_16x16x32_bf16 v[140:143], v[116:119], v[108:111], v[140:143]
  ds_read_b128 v[124:127], v15 offset:2048
  v_mul_f32 v237, v237, v188
  v_mfma_f32_16x16x32_bf16 v[136:139], v[220:223], v[212:215], 0
  ds_read_b128 v[128:131], v15 offset:3072
  v_cvt_pk_bf16_f32 v120, v236, v237
  v_mfma_f32_16x16x32_bf16 v[136:139], v[116:119], v[112:115], v[136:139]
  ds_read_b128 v[132:135], v15 offset:4096
  v_rcp_f32 v118, v216
  v_mfma_f32_16x16x16_bf16 v[220:223], v[158:159], v[152:153], 0
  v_cndmask_b32 v122, v140, v144, s[54:55]
  v_mul_f32 v238, v238, v188
  v_mul_f32 v239, v239, v188
  v_mfma_f32_16x16x16_bf16 v[168:171], v[180:181], v[152:153], 0
  v_cvt_pk_bf16_f32 v121, v238, v239
  v_mul_f32 v184, v184, v240
  v_mul_f32 v185, v185, v240
  v_mfma_f32_16x16x16_bf16 v[236:239], v[164:165], v[152:153], 0
  v_cvt_pk_bf16_f32 v116, v184, v185
  v_mul_f32 v186, v186, v240
  v_mul_f32 v187, v187, v240
  v_mfma_f32_16x16x16_bf16 v[228:231], v[196:197], v[152:153], v[2:5]
  v_cvt_pk_bf16_f32 v117, v186, v187
  v_cndmask_b32 v122, v136, v122, s[56:57]
  v_mul_f32 v122, v122, v118
  v_cvt_pk_bf16_f32 v122, v122, v122
  v_mfma_f32_16x16x32_bf16 v[220:223], v[154:157], v[148:151], v[220:223]
  ds_read_b128 v[136:139], v15 offset:5120
  ds_read_b128 v[140:143], v15 offset:6144
  v_mfma_f32_16x16x32_bf16 v[168:171], v[176:179], v[148:151], v[168:171]
  ds_read_b128 v[144:147], v15 offset:7168
  v_max3_f32 v1, v1, v208, v188
  v_mfma_f32_16x16x32_bf16 v[236:239], v[160:163], v[148:151], v[236:239]
  ds_write_b64 v17, v[120:121] offset:20480
  v_mfma_f32_16x16x32_bf16 v[228:231], v[192:195], v[148:151], v[228:231]
  s_waitcnt lgkmcnt(6)
  v_exp_f32 v220, v220
  v_mfma_f32_16x16x32_bf16 v[156:159], a[0:3], v[124:127], 0
  s_waitcnt lgkmcnt(5)
  ds_write_b64 v17, v[116:117] offset:26624
  v_mfma_f32_16x16x32_bf16 v[156:159], a[4:7], v[128:131], v[156:159]
  s_waitcnt lgkmcnt(5)
  ds_write_b16 v20, v122 offset:384
  v_mfma_f32_16x16x32_bf16 v[156:159], a[8:11], v[132:135], v[156:159]
  s_waitcnt lgkmcnt(5)
  v_exp_f32 v221, v221
  v_mfma_f32_16x16x32_bf16 v[156:159], a[12:15], v[136:139], v[156:159]
  s_waitcnt lgkmcnt(4)
  v_exp_f32 v222, v222
  v_mfma_f32_16x16x32_bf16 v[156:159], a[16:19], v[140:143], v[156:159]
  s_waitcnt lgkmcnt(3)
  v_exp_f32 v223, v223
  v_mfma_f32_16x16x32_bf16 v[156:159], a[20:23], v[144:147], v[156:159]
  v_exp_f32 v168, v168
  v_mfma_f32_16x16x32_bf16 v[160:163], a[24:27], v[124:127], 0
  v_exp_f32 v169, v169
  v_mfma_f32_16x16x32_bf16 v[160:163], a[28:31], v[128:131], v[160:163]
  v_exp_f32 v170, v170
  v_mfma_f32_16x16x32_bf16 v[160:163], a[32:35], v[132:135], v[160:163]
  v_exp_f32 v171, v171
  v_mfma_f32_16x16x32_bf16 v[160:163], a[36:39], v[136:139], v[160:163]
  v_exp_f32 v236, v236
  v_mfma_f32_16x16x32_bf16 v[160:163], a[40:43], v[140:143], v[160:163]
  v_exp_f32 v237, v237
  v_mfma_f32_16x16x32_bf16 v[160:163], a[44:47], v[144:147], v[160:163]
  v_exp_f32 v238, v238
  v_mfma_f32_16x16x32_bf16 v[192:195], a[48:51], v[124:127], 0
  v_exp_f32 v239, v239
  v_mfma_f32_16x16x32_bf16 v[192:195], a[52:55], v[128:131], v[192:195]
  v_exp_f32 v228, v228
  v_mfma_f32_16x16x32_bf16 v[192:195], a[56:59], v[132:135], v[192:195]
  v_cvt_pk_bf16_f32 v208, v220, v221
  v_cvt_pk_bf16_f32 v209, v222, v223
  v_mfma_f32_16x16x32_bf16 v[192:195], a[60:63], v[136:139], v[192:195]
  v_cvt_pk_bf16_f32 v210, v168, v169
  v_cvt_pk_bf16_f32 v211, v170, v171
  v_mfma_f32_16x16x32_bf16 v[192:195], a[64:67], v[140:143], v[192:195]
  v_cvt_pk_bf16_f32 v148, v156, v157
  v_cvt_pk_bf16_f32 v149, v158, v159
  v_mfma_f32_16x16x32_bf16 v[192:195], a[68:71], v[144:147], v[192:195]
  v_cvt_pk_bf16_f32 v120, v236, v237
  v_cvt_pk_bf16_f32 v121, v238, v239
  v_mfma_f32_16x16x32_bf16 v[236:239], a[246:249], v[208:211], 0
  v_cvt_pk_bf16_f32 v122, v228, 0
  v_cvt_pk_bf16_f32 v150, v160, v161
  v_cvt_pk_bf16_f32 v151, v162, v163
  v_mfma_f32_16x16x32_bf16 v[236:239], a[246:249], v[120:123], v[236:239]
  v_cvt_pk_bf16_f32 v152, v192, v193
  v_cvt_pk_bf16_f32 v153, v194, v195
  v_mfma_f32_16x16x32_bf16 v[160:163], v[200:203], v[208:211], 0
  v_max3_f32 v1, v1, v224, v240
  v_max3_f32 v1, v1, v216, v118
  v_mfma_f32_16x16x32_bf16 v[160:163], v[104:107], v[120:123], v[160:163]
  v_mul_f32 v236, 0x3ee9a3cd, v236
  v_add_u32 v20, 1160, v20
  v_mfma_f32_16x16x32_bf16 v[156:159], v[204:207], v[208:211], 0
  v_rcp_f32 v104, v236
  v_mfma_f32_16x16x32_bf16 v[156:159], v[108:111], v[120:123], v[156:159]
  v_mul_f32 v160, v160, v104
  v_mul_f32 v161, v161, v104
  v_mfma_f32_16x16x32_bf16 v[204:207], v[212:215], v[208:211], 0
  v_mul_f32 v162, v162, v104
  v_mul_f32 v163, v163, v104
  v_mfma_f32_16x16x32_bf16 v[204:207], v[112:115], v[120:123], v[204:207]
  v_mul_f32 v156, v156, v104
  v_mul_f32 v157, v157, v104
  v_mfma_f32_16x16x32_bf16 v[208:211], a[72:75], v[124:127], 0
  v_mul_f32 v158, v158, v104
  v_mul_f32 v159, v159, v104
  v_mfma_f32_16x16x32_bf16 v[208:211], a[76:79], v[128:131], v[208:211]
  v_cvt_pk_bf16_f32 v212, v160, v161
  v_cvt_pk_bf16_f32 v213, v162, v163
  v_mfma_f32_16x16x32_bf16 v[208:211], a[80:83], v[132:135], v[208:211]
  v_cvt_pk_bf16_f32 v214, v156, v157
  v_cvt_pk_bf16_f32 v215, v158, v159
  v_mfma_f32_16x16x32_bf16 v[208:211], a[84:87], v[136:139], v[208:211]
  ds_write_b128 v16, v[212:215] offset:32768
  v_mfma_f32_16x16x32_bf16 v[208:211], a[88:91], v[140:143], v[208:211]
  v_mul_f32 v204, v204, v104
  v_mul_f32 v205, v205, v104
  v_mfma_f32_16x16x32_bf16 v[208:211], a[92:95], v[144:147], v[208:211]
  v_mul_f32 v206, v206, v104
  v_mul_f32 v207, v207, v104
  v_mfma_f32_16x16x32_bf16 v[212:215], a[96:99], v[124:127], 0
  v_cvt_pk_bf16_f32 v156, v204, v205
  v_cvt_pk_bf16_f32 v157, v206, v207
  v_mfma_f32_16x16x32_bf16 v[212:215], a[100:103], v[128:131], v[212:215]
  ds_write_b64 v17, v[156:157] offset:32768
  v_mfma_f32_16x16x32_bf16 v[212:215], a[104:107], v[132:135], v[212:215]
  v_cvt_pk_bf16_f32 v154, v208, v209
  v_cvt_pk_bf16_f32 v155, v210, v211
  v_mfma_f32_16x16x32_bf16 v[212:215], a[108:111], v[136:139], v[212:215]
  v_max3_f32 v1, v1, v236, v104
  v_mfma_f32_16x16x32_bf16 v[212:215], a[112:115], v[140:143], v[212:215]
  v_mfma_f32_16x16x32_bf16 v[212:215], a[116:119], v[144:147], v[212:215]
  v_mfma_f32_16x16x32_bf16 v[160:163], a[120:123], v[124:127], 0
  v_mfma_f32_16x16x32_bf16 v[160:163], a[124:127], v[128:131], v[160:163]
  v_cvt_pk_bf16_f32 v156, v212, v213
  v_cvt_pk_bf16_f32 v157, v214, v215
  v_mfma_f32_16x16x32_bf16 v[160:163], a[128:131], v[132:135], v[160:163]
  v_mfma_f32_16x16x32_bf16 v[160:163], a[132:135], v[136:139], v[160:163]
  v_mfma_f32_16x16x32_bf16 v[160:163], a[136:139], v[140:143], v[160:163]
  v_mfma_f32_16x16x32_bf16 v[160:163], a[140:143], v[144:147], v[160:163]
  s_waitcnt lgkmcnt(0)
  s_barrier
  s_branch L_loop
L_last:
  v_mfma_f32_16x16x32_bf16 v[164:167], v[124:127], a[144:147], 0
  ds_read_b128 v[168:171], v15 offset:20480
  ds_read_b128 v[172:175], v15 offset:26624
  v_mfma_f32_16x16x32_bf16 v[164:167], v[128:131], a[148:151], v[164:167]
  ds_read_b128 v[176:179], v15 offset:32768
  v_cvt_pk_bf16_f32 v158, v160, v161
  v_mfma_f32_16x16x32_bf16 v[164:167], v[132:135], a[152:155], v[164:167]
  ds_read_b64 v[216:217], v115 offset:896
  ds_read_b64 v[218:219], v115 offset:1792
  v_mfma_f32_16x16x32_bf16 v[164:167], v[136:139], a[156:159], v[164:167]
  buffer_load_dwordx4 v[180:183], v15, s[12:15], s77 offen offset:2048
  v_mfma_f32_16x16x32_bf16 v[164:167], v[140:143], a[160:163], v[164:167]
  v_cvt_pk_bf16_f32 v159, v162, v163
  v_and_b32 v244, -16, v107
  v_mfma_f32_16x16x32_bf16 v[164:167], v[144:147], a[164:167], v[164:167]
  s_waitcnt lgkmcnt(4)
  v_mfma_f32_16x16x32_bf16 v[60:63], a[250:253], v[168:171], v[60:63]
  v_mfma_f32_16x16x32_bf16 v[64:67], v[96:99], v[168:171], v[64:67]
  v_cvt_pk_bf16_f32 v184, v164, v165
  v_cvt_pk_bf16_f32 v185, v166, v167
  v_mfma_f32_16x16x32_bf16 v[68:71], v[100:103], v[168:171], v[68:71]
  s_waitcnt lgkmcnt(1)
  ds_read_b128 v[160:163], v18
  ds_read_b128 v[164:167], v15 offset:21504
  v_mfma_f32_16x16x32_bf16 v[72:75], a[250:253], v[172:175], v[72:75]
  s_waitcnt lgkmcnt(2)
  ds_read_b128 v[168:171], v18 offset:1024
  v_fma_f32 v188, v36, v216, v217
  v_mfma_f32_16x16x32_bf16 v[76:79], v[96:99], v[172:175], v[76:79]
  ds_read_b128 v[192:195], v18 offset:2048
  v_fma_f32 v196, v37, v216, v217
  v_mfma_f32_16x16x32_bf16 v[80:83], v[100:103], v[172:175], v[80:83]
  ds_read_b128 v[172:175], v15 offset:27648
  v_cvt_pk_bf16_f32 v188, v188, v196
  v_mfma_f32_16x16x32_bf16 v[84:87], a[250:253], v[176:179], v[84:87]
  v_fma_f32 v189, v38, v216, v217
  v_fma_f32 v196, v39, v216, v217
  v_mfma_f32_16x16x32_bf16 v[88:91], v[96:99], v[176:179], v[88:91]
  v_cvt_pk_bf16_f32 v189, v189, v196
  v_fma_f32 v190, v40, v216, v217
  v_mfma_f32_16x16x32_bf16 v[92:95], v[100:103], v[176:179], v[92:95]
  ds_read_b128 v[176:179], v15 offset:33792
  v_fma_f32 v200, v41, v216, v217
  v_mfma_f32_16x16x32_bf16 v[196:199], v[124:127], a[168:171], 0
  v_cvt_pk_bf16_f32 v190, v190, v200
  v_fma_f32 v191, v42, v216, v217
  v_mfma_f32_16x16x32_bf16 v[196:199], v[128:131], a[172:175], v[196:199]
  v_fma_f32 v200, v43, v216, v217
  v_cvt_pk_bf16_f32 v191, v191, v200
  v_mfma_f32_16x16x32_bf16 v[196:199], v[132:135], a[176:179], v[196:199]
  ds_write_b128 v16, v[188:191] offset:8192
  v_mfma_f32_16x16x32_bf16 v[196:199], v[136:139], a[180:183], v[196:199]
  v_fma_f32 v188, v48, v218, v219
  v_fma_f32 v200, v49, v218, v219
  v_mfma_f32_16x16x32_bf16 v[196:199], v[140:143], a[184:187], v[196:199]
  v_cvt_pk_bf16_f32 v188, v188, v200
  v_fma_f32 v189, v50, v218, v219
  v_mfma_f32_16x16x32_bf16 v[196:199], v[144:147], a[188:191], v[196:199]
  s_waitcnt lgkmcnt(5)
  v_fma_f32 v200, v51, v218, v219
  v_cvt_pk_bf16_f32 v189, v189, v200
  v_mfma_f32_16x16x32_bf16 v[60:63], v[160:163], v[164:167], v[60:63]
  s_waitcnt lgkmcnt(4)
  v_fma_f32 v190, v52, v218, v219
  v_fma_f32 v212, v53, v218, v219
  v_mfma_f32_16x16x32_bf16 v[64:67], v[168:171], v[164:167], v[64:67]
  s_waitcnt lgkmcnt(3)
  v_cvt_pk_bf16_f32 v200, v196, v197
  v_cvt_pk_bf16_f32 v201, v198, v199
  v_mfma_f32_16x16x32_bf16 v[68:71], v[192:195], v[164:167], v[68:71]
  s_waitcnt lgkmcnt(2)
  ds_read_b128 v[196:199], v18 offset:3072
  ds_read_b128 v[204:207], v15 offset:22528
  v_mfma_f32_16x16x32_bf16 v[72:75], v[160:163], v[172:175], v[72:75]
  ds_read_b128 v[208:211], v18 offset:4096
  v_cvt_pk_bf16_f32 v190, v190, v212
  v_mfma_f32_16x16x32_bf16 v[76:79], v[168:171], v[172:175], v[76:79]
  ds_read_b128 v[212:215], v18 offset:5120
  v_fma_f32 v191, v54, v218, v219
  v_mfma_f32_16x16x32_bf16 v[80:83], v[192:195], v[172:175], v[80:83]
  s_waitcnt lgkmcnt(5)
  ds_read_b128 v[172:175], v15 offset:28672
  v_fma_f32 v166, v55, v218, v219
  v_mfma_f32_16x16x32_bf16 v[84:87], v[160:163], v[176:179], v[84:87]
  v_cvt_pk_bf16_f32 v191, v191, v166
  v_fma_f32 v166, v44, v216, v217
  v_mfma_f32_16x16x32_bf16 v[88:91], v[168:171], v[176:179], v[88:91]
  ds_write_b128 v16, v[188:191] offset:14336
  v_mfma_f32_16x16x32_bf16 v[92:95], v[192:195], v[176:179], v[92:95]
  v_fma_f32 v176, v45, v216, v217
  v_cvt_pk_bf16_f32 v166, v166, v176
  v_mfma_f32_16x16x32_bf16 v[176:179], v[124:127], a[192:195], 0
  ds_read_b128 v[124:127], v15 offset:34816
  ds_read_b64 v[164:165], v19 offset:784
  v_mfma_f32_16x16x32_bf16 v[176:179], v[128:131], a[196:199], v[176:179]
  ds_read2_b64 v[160:163], v19 offset0:96 offset1:97
  v_fma_f32 v167, v46, v216, v217
  v_mfma_f32_16x16x32_bf16 v[176:179], v[132:135], a[200:203], v[176:179]
  v_fma_f32 v128, v47, v216, v217
  v_cvt_pk_bf16_f32 v167, v167, v128
  v_mfma_f32_16x16x32_bf16 v[176:179], v[136:139], a[204:207], v[176:179]
  ds_write_b64 v17, v[166:167] offset:8192
  v_mfma_f32_16x16x32_bf16 v[176:179], v[140:143], a[208:211], v[176:179]
  v_fma_f32 v128, v56, v218, v219
  v_fma_f32 v140, v57, v218, v219
  v_mfma_f32_16x16x32_bf16 v[176:179], v[144:147], a[212:215], v[176:179]
  s_waitcnt lgkmcnt(8)
  v_cvt_pk_bf16_f32 v128, v128, v140
  v_fma_f32 v129, v58, v218, v219
  v_mfma_f32_16x16x32_bf16 v[60:63], v[196:199], v[204:207], v[60:63]
  s_waitcnt lgkmcnt(7)
  ds_read_b128 v[140:143], v18 offset:6144
  ds_read_b128 v[132:135], v15 offset:23552
  v_mfma_f32_16x16x32_bf16 v[64:67], v[208:211], v[204:207], v[64:67]
  s_waitcnt lgkmcnt(8)
  ds_read_b128 v[144:147], v18 offset:7168
  v_cvt_pk_bf16_f32 v192, v176, v177
  v_mfma_f32_16x16x32_bf16 v[68:71], v[212:215], v[204:207], v[68:71]
  s_waitcnt lgkmcnt(8)
  ds_read_b128 v[136:139], v18 offset:8192
  v_cvt_pk_bf16_f32 v193, v178, v179
  v_mfma_f32_16x16x32_bf16 v[72:75], v[196:199], v[172:175], v[72:75]
  ds_read_b128 v[176:179], v15 offset:29696
  v_fma_f32 v204, v59, v218, v219
  v_mfma_f32_16x16x32_bf16 v[76:79], v[208:211], v[172:175], v[76:79]
  v_cvt_pk_bf16_f32 v129, v129, v204
  v_mfma_f32_16x16x32_bf16 v[80:83], v[212:215], v[172:175], v[80:83]
  s_waitcnt lgkmcnt(8)
  ds_write_b64 v17, v[128:129] offset:14336
  v_mfma_f32_16x16x32_bf16 v[84:87], v[196:199], v[124:127], v[84:87]
  ds_read_b128 v[196:199], v15 offset:35840
  v_mfma_f32_16x16x32_bf16 v[88:91], v[208:211], v[124:127], v[88:91]
  v_mfma_f32_16x16x32_bf16 v[92:95], v[212:215], v[124:127], v[92:95]
  s_waitcnt lgkmcnt(9)
  v_mfma_f32_16x16x16_bf16 v[124:127], v[158:159], v[152:153], 0
  ds_read_b128 v[212:215], v18 offset:9216
  ds_read_b128 v[208:211], v15 offset:24576
  v_mfma_f32_16x16x16_bf16 v[172:175], v[158:159], v[164:165], 0
  ds_read_b128 v[204:207], v18 offset:10240
  v_mfma_f32_16x16x32_bf16 v[124:127], v[154:157], v[148:151], v[124:127]
  s_waitcnt lgkmcnt(11)
  ds_read_b128 v[128:131], v18 offset:11264
  v_mfma_f32_16x16x32_bf16 v[172:175], v[154:157], v[160:163], v[172:175]
  s_waitcnt lgkmcnt(9)
  ds_read_b128 v[168:171], v15 offset:30720
  v_mfma_f32_16x16x32_bf16 v[60:63], v[140:143], v[132:135], v[60:63]
  s_waitcnt vmcnt(0) lgkmcnt(9)
  v_exp_f32 v124, v124
  v_mfma_f32_16x16x32_bf16 v[64:67], v[144:147], v[132:135], v[64:67]
  s_waitcnt lgkmcnt(8)
  v_exp_f32 v125, v125
  v_mfma_f32_16x16x32_bf16 v[68:71], v[136:139], v[132:135], v[68:71]
  s_waitcnt lgkmcnt(7)
  ds_read_b128 v[132:135], v15 offset:36864
  v_cvt_pk_bf16_f32 v188, v124, v125
  v_mfma_f32_16x16x32_bf16 v[72:75], v[140:143], v[176:179], v[72:75]
  v_exp_f32 v126, v126
  v_mfma_f32_16x16x32_bf16 v[76:79], v[144:147], v[176:179], v[76:79]
  v_exp_f32 v127, v127
  v_mfma_f32_16x16x32_bf16 v[80:83], v[136:139], v[176:179], v[80:83]
  s_waitcnt lgkmcnt(6)
  ds_read_b128 v[176:179], v18 offset:12288
  ds_read_b128 v[216:219], v15 offset:25600
  v_mfma_f32_16x16x32_bf16 v[84:87], v[140:143], v[196:199], v[84:87]
  ds_read_b128 v[140:143], v18 offset:13312
  v_cvt_pk_bf16_f32 v189, v126, v127
  v_mfma_f32_16x16x32_bf16 v[88:91], v[144:147], v[196:199], v[88:91]
  ds_read_b128 v[144:147], v18 offset:14336
  v_add_u32 v248, 18560, v183
  v_mfma_f32_16x16x32_bf16 v[92:95], v[136:139], v[196:199], v[92:95]
  s_waitcnt lgkmcnt(8)
  ds_read_b128 v[136:139], v15 offset:31744
  v_mfma_f32_16x16x32_bf16 v[60:63], v[212:215], v[208:211], v[60:63]
  s_waitcnt lgkmcnt(8)
  v_exp_f32 v172, v172
  v_mfma_f32_16x16x32_bf16 v[64:67], v[204:207], v[208:211], v[64:67]
  s_waitcnt lgkmcnt(7)
  v_exp_f32 v173, v173
  v_mfma_f32_16x16x32_bf16 v[68:71], v[128:131], v[208:211], v[68:71]
  s_waitcnt lgkmcnt(6)
  v_exp_f32 v174, v174
  v_mfma_f32_16x16x32_bf16 v[72:75], v[212:215], v[168:171], v[72:75]
  v_exp_f32 v175, v175
  v_mfma_f32_16x16x32_bf16 v[76:79], v[204:207], v[168:171], v[76:79]
  ds_read_b128 v[124:127], v15 offset:37888
  v_cvt_pk_bf16_f32 v208, v172, v173
  v_mfma_f32_16x16x32_bf16 v[80:83], v[128:131], v[168:171], v[80:83]
  s_waitcnt lgkmcnt(6)
  v_cvt_pk_bf16_f32 v209, v174, v175
  v_mfma_f32_16x16x32_bf16 v[84:87], v[212:215], v[132:135], v[84:87]
  v_mfma_f32_16x16x32_bf16 v[88:91], v[204:207], v[132:135], v[88:91]
  v_mfma_f32_16x16x32_bf16 v[92:95], v[128:131], v[132:135], v[92:95]
  s_waitcnt lgkmcnt(4)
  s_barrier
  v_mfma_f32_16x16x32_bf16 v[60:63], v[176:179], v[216:219], v[60:63]
  s_waitcnt lgkmcnt(3)
  ds_read_b128 v[168:171], v15 offset:8192
  ds_read_b128 v[128:131], v15 offset:9216
  v_mfma_f32_16x16x32_bf16 v[64:67], v[140:143], v[216:219], v[64:67]
  s_waitcnt lgkmcnt(4)
  ds_read_b128 v[172:175], v15 offset:10240
  v_mfma_f32_16x16x32_bf16 v[68:71], v[144:147], v[216:219], v[68:71]
  s_waitcnt lgkmcnt(4)
  ds_read_b128 v[216:219], v15 offset:11264
  v_cvt_pk_bf16_f32 v132, v60, v61
  v_mfma_f32_16x16x32_bf16 v[72:75], v[176:179], v[136:139], v[72:75]
  ds_read_b128 v[204:207], v15 offset:12288
  v_cvt_pk_bf16_f32 v133, v62, v63
  v_mfma_f32_16x16x32_bf16 v[76:79], v[140:143], v[136:139], v[76:79]
  ds_read_b128 v[212:215], v15 offset:13312
  v_cvt_pk_bf16_f32 v134, v64, v65
  v_mfma_f32_16x16x32_bf16 v[80:83], v[144:147], v[136:139], v[80:83]
  s_waitcnt lgkmcnt(6)
  v_cvt_pk_bf16_f32 v135, v66, v67
  v_cvt_pk_bf16_f32 v196, v72, v73
  v_mfma_f32_16x16x32_bf16 v[84:87], v[176:179], v[124:127], v[84:87]
  v_permlane16_swap_b32 v132, v134
  v_mfma_f32_16x16x32_bf16 v[88:91], v[140:143], v[124:127], v[88:91]
  v_permlane16_swap_b32 v133, v135
  v_mfma_f32_16x16x32_bf16 v[92:95], v[144:147], v[124:127], v[92:95]
  s_waitcnt lgkmcnt(5)
  buffer_store_dwordx4 v[132:135], v12, s[8:11], s32 offen
  v_cvt_pk_bf16_f32 v197, v74, v75
  s_nop 0
  v_mfma_f32_16x16x32_bf16 v[132:135], a[72:75], v[168:171], 0
  s_waitcnt lgkmcnt(4)
  v_cvt_pk_bf16_f32 v198, v76, v77
  v_cvt_pk_bf16_f32 v199, v78, v79
  v_mfma_f32_16x16x32_bf16 v[132:135], a[76:79], v[128:131], v[132:135]
  s_waitcnt lgkmcnt(3)
  v_permlane16_swap_b32 v196, v198
  v_mfma_f32_16x16x32_bf16 v[132:135], a[80:83], v[172:175], v[132:135]
  s_waitcnt lgkmcnt(2)
  v_permlane16_swap_b32 v197, v199
  v_mfma_f32_16x16x32_bf16 v[132:135], a[84:87], v[216:219], v[132:135]
  s_waitcnt lgkmcnt(1)
  buffer_load_dwordx4 v[60:63], v15, s[12:15], s75 offen
  v_mfma_f32_16x16x32_bf16 v[132:135], a[88:91], v[204:207], v[132:135]
  s_waitcnt lgkmcnt(0)
  v_cvt_pk_bf16_f32 v124, v68, v69
  v_cvt_pk_bf16_f32 v125, v70, v71
  v_mfma_f32_16x16x32_bf16 v[132:135], a[92:95], v[212:215], v[132:135]
  v_cvt_pk_bf16_f32 v126, v80, v81
  v_cvt_pk_bf16_f32 v127, v82, v83
  v_mfma_f32_16x16x32_bf16 v[136:139], a[96:99], v[168:171], 0
  v_permlane16_swap_b32 v124, v126
  v_mfma_f32_16x16x32_bf16 v[136:139], a[100:103], v[128:131], v[136:139]
  buffer_load_dwordx4 v[64:67], v15, s[12:15], s75 offen offset:1024
  v_mfma_f32_16x16x32_bf16 v[136:139], a[104:107], v[172:175], v[136:139]
  v_cvt_pk_bf16_f32 v140, v132, v133
  v_cvt_pk_bf16_f32 v141, v134, v135
  v_mfma_f32_16x16x32_bf16 v[136:139], a[108:111], v[216:219], v[136:139]
  v_permlane16_swap_b32 v125, v127
  v_mfma_f32_16x16x32_bf16 v[136:139], a[112:115], v[204:207], v[136:139]
  v_cvt_pk_bf16_f32 v176, v84, v85
  v_cvt_pk_bf16_f32 v177, v86, v87
  v_mfma_f32_16x16x32_bf16 v[136:139], a[116:119], v[212:215], v[136:139]
  v_cvt_pk_bf16_f32 v178, v88, v89
  v_cvt_pk_bf16_f32 v179, v90, v91
  v_mfma_f32_16x16x32_bf16 v[132:135], a[120:123], v[168:171], 0
  buffer_load_dwordx4 v[68:71], v15, s[12:15], s75 offen offset:2048
  v_mfma_f32_16x16x32_bf16 v[132:135], a[124:127], v[128:131], v[132:135]
  v_cvt_pk_bf16_f32 v142, v136, v137
  v_cvt_pk_bf16_f32 v143, v138, v139
  v_mfma_f32_16x16x32_bf16 v[132:135], a[128:131], v[172:175], v[132:135]
  v_permlane16_swap_b32 v176, v178
  v_mfma_f32_16x16x32_bf16 v[132:135], a[132:135], v[216:219], v[132:135]
  v_permlane16_swap_b32 v177, v179
  v_mfma_f32_16x16x32_bf16 v[132:135], a[136:139], v[204:207], v[132:135]
  buffer_load_dwordx4 v[72:75], v15, s[12:15], s75 offen offset:3072
  v_mfma_f32_16x16x32_bf16 v[132:135], a[140:143], v[212:215], v[132:135]
  v_cvt_pk_bf16_f32 v138, v92, v93
  v_cvt_pk_bf16_f32 v139, v94, v95
  v_mfma_f32_16x16x32_bf16 v[220:223], a[0:3], v[168:171], 0
  v_mfma_f32_16x16x32_bf16 v[220:223], a[4:7], v[128:131], v[220:223]
  v_cvt_pk_bf16_f32 v144, v132, v133
  v_cvt_pk_bf16_f32 v145, v134, v135
  v_mfma_f32_16x16x32_bf16 v[220:223], a[8:11], v[172:175], v[220:223]
  v_mfma_f32_16x16x32_bf16 v[220:223], a[12:15], v[216:219], v[220:223]
  buffer_load_dwordx4 v[76:79], v15, s[12:15], s77 offen
  v_mfma_f32_16x16x32_bf16 v[220:223], a[16:19], v[204:207], v[220:223]
  v_mfma_f32_16x16x32_bf16 v[220:223], a[20:23], v[212:215], v[220:223]
  v_mfma_f32_16x16x32_bf16 v[224:227], a[24:27], v[168:171], 0
  v_mfma_f32_16x16x32_bf16 v[224:227], a[28:31], v[128:131], v[224:227]
  buffer_load_dwordx4 v[80:83], v15, s[12:15], s77 offen offset:1024
  v_mfma_f32_16x16x32_bf16 v[224:227], a[32:35], v[172:175], v[224:227]
  v_cvt_pk_bf16_f32 v132, v220, v221
  v_cvt_pk_bf16_f32 v133, v222, v223
  v_mfma_f32_16x16x32_bf16 v[224:227], a[36:39], v[216:219], v[224:227]
  v_mfma_f32_16x16x32_bf16 v[224:227], a[40:43], v[204:207], v[224:227]
  v_mfma_f32_16x16x32_bf16 v[224:227], a[44:47], v[212:215], v[224:227]
  v_mfma_f32_16x16x32_bf16 v[220:223], a[48:51], v[168:171], 0
  v_mfma_f32_16x16x32_bf16 v[220:223], a[52:55], v[128:131], v[220:223]
  v_cvt_pk_bf16_f32 v134, v224, v225
  v_cvt_pk_bf16_f32 v135, v226, v227
  v_mfma_f32_16x16x32_bf16 v[220:223], a[56:59], v[172:175], v[220:223]
  v_mfma_f32_16x16x32_bf16 v[220:223], a[60:63], v[216:219], v[220:223]
  v_mfma_f32_16x16x32_bf16 v[220:223], a[64:67], v[204:207], v[220:223]
  v_mfma_f32_16x16x32_bf16 v[220:223], a[68:71], v[212:215], v[220:223]
  v_mfma_f32_16x16x32_bf16 v[224:227], v[168:171], a[144:147], 0
  v_mfma_f32_16x16x32_bf16 v[224:227], v[128:131], a[148:151], v[224:227]
  v_cvt_pk_bf16_f32 v136, v220, v221
  v_cvt_pk_bf16_f32 v137, v222, v223
  v_mfma_f32_16x16x32_bf16 v[224:227], v[172:175], a[152:155], v[224:227]
  v_mfma_f32_16x16x32_bf16 v[224:227], v[216:219], a[156:159], v[224:227]
  v_mfma_f32_16x16x32_bf16 v[224:227], v[204:207], a[160:163], v[224:227]
  v_mfma_f32_16x16x32_bf16 v[224:227], v[212:215], a[164:167], v[224:227]
  v_mfma_f32_16x16x32_bf16 v[220:223], v[168:171], a[168:171], 0
  buffer_store_dwordx4 v[196:199], v13, s[8:11], s32 offen
  s_nop 2
  v_cvt_pk_bf16_f32 v186, v224, v225
  v_mfma_f32_16x16x32_bf16 v[220:223], v[128:131], a[172:175], v[220:223]
  v_cvt_pk_bf16_f32 v187, v226, v227
  v_mfma_f32_16x16x32_bf16 v[220:223], v[172:175], a[176:179], v[220:223]
  v_mfma_f32_16x16x32_bf16 v[220:223], v[216:219], a[180:183], v[220:223]
  v_mfma_f32_16x16x32_bf16 v[220:223], v[204:207], a[184:187], v[220:223]
  v_mfma_f32_16x16x32_bf16 v[220:223], v[212:215], a[188:191], v[220:223]
  ds_read_b128 v[224:227], v15 offset:14336
  v_mfma_f32_16x16x32_bf16 v[196:199], v[168:171], a[192:195], 0
  ds_read_b128 v[228:231], v15 offset:15360
  v_mfma_f32_16x16x32_bf16 v[196:199], v[128:131], a[196:199], v[196:199]
  ds_read_b128 v[232:235], v15 offset:16384
  v_cvt_pk_bf16_f32 v202, v220, v221
  v_mfma_f32_16x16x32_bf16 v[196:199], v[172:175], a[200:203], v[196:199]
  ds_read_b128 v[236:239], v15 offset:17408
  v_cvt_pk_bf16_f32 v203, v222, v223
  v_mfma_f32_16x16x32_bf16 v[196:199], v[216:219], a[204:207], v[196:199]
  ds_read_b128 v[216:219], v15 offset:18432
  v_mfma_f32_16x16x32_bf16 v[196:199], v[204:207], a[208:211], v[196:199]
  ds_read_b128 v[204:207], v15 offset:19456
  v_mfma_f32_16x16x32_bf16 v[196:199], v[212:215], a[212:215], v[196:199]
  v_mfma_f32_16x16x16_bf16 v[168:171], v[144:145], v[152:153], 0
  v_mfma_f32_16x16x16_bf16 v[172:175], v[158:159], v[136:137], 0
  v_cvt_pk_bf16_f32 v194, v196, v197
  v_cvt_pk_bf16_f32 v195, v198, v199
  v_mfma_f32_16x16x32_bf16 v[168:171], v[140:143], v[148:151], v[168:171]
  v_mfma_f32_16x16x32_bf16 v[172:175], v[154:157], v[132:135], v[172:175]
  s_waitcnt lgkmcnt(5)
  v_mfma_f32_16x16x32_bf16 v[196:199], a[72:75], v[224:227], 0
  s_waitcnt lgkmcnt(4)
  buffer_store_dwordx4 v[124:127], v22, s[8:11], s32 offen
  v_mfma_f32_16x16x32_bf16 v[196:199], a[76:79], v[228:231], v[196:199]
  s_waitcnt lgkmcnt(3)
  v_exp_f32 v168, v168
  v_mfma_f32_16x16x32_bf16 v[196:199], a[80:83], v[232:235], v[196:199]
  s_waitcnt lgkmcnt(2)
  v_exp_f32 v169, v169
  v_mfma_f32_16x16x32_bf16 v[196:199], a[84:87], v[236:239], v[196:199]
  s_waitcnt lgkmcnt(1)
  v_exp_f32 v170, v170
  v_mfma_f32_16x16x32_bf16 v[196:199], a[88:91], v[216:219], v[196:199]
  s_waitcnt lgkmcnt(0)
  v_exp_f32 v171, v171
  v_mfma_f32_16x16x32_bf16 v[196:199], a[92:95], v[204:207], v[196:199]
  v_exp_f32 v172, v172
  v_mfma_f32_16x16x32_bf16 v[212:215], a[96:99], v[224:227], 0
  v_exp_f32 v173, v173
  v_mfma_f32_16x16x32_bf16 v[212:215], a[100:103], v[228:231], v[212:215]
  v_exp_f32 v174, v174
  v_mfma_f32_16x16x32_bf16 v[212:215], a[104:107], v[232:235], v[212:215]
  v_exp_f32 v175, v175
  v_mfma_f32_16x16x32_bf16 v[212:215], a[108:111], v[236:239], v[212:215]
  v_cvt_pk_bf16_f32 v190, v168, v169
  v_cvt_pk_bf16_f32 v191, v170, v171
  v_mfma_f32_16x16x32_bf16 v[212:215], a[112:115], v[216:219], v[212:215]
  v_cvt_pk_bf16_f32 v124, v196, v197
  v_cvt_pk_bf16_f32 v125, v198, v199
  v_mfma_f32_16x16x32_bf16 v[212:215], a[116:119], v[204:207], v[212:215]
  s_barrier
  v_mfma_f32_16x16x32_bf16 v[196:199], a[120:123], v[224:227], 0
  v_cvt_pk_bf16_f32 v220, v172, v173
  v_cvt_pk_bf16_f32 v221, v174, v175
  v_mfma_f32_16x16x32_bf16 v[196:199], a[124:127], v[228:231], v[196:199]
  v_cvt_pk_bf16_f32 v126, v212, v213
  v_cvt_pk_bf16_f32 v127, v214, v215
  v_mfma_f32_16x16x32_bf16 v[196:199], a[128:131], v[232:235], v[196:199]
  v_mfma_f32_16x16x32_bf16 v[196:199], a[132:135], v[236:239], v[196:199]
  v_mfma_f32_16x16x32_bf16 v[196:199], a[136:139], v[216:219], v[196:199]
  buffer_store_dwordx4 v[176:179], v14, s[8:11], s32 offen
  v_mfma_f32_16x16x32_bf16 v[196:199], a[140:143], v[204:207], v[196:199]
  v_mfma_f32_16x16x16_bf16 v[176:179], v[144:145], v[136:137], 0
  ds_read_b64 v[172:173], v19 offset:16
  v_mfma_f32_16x16x16_bf16 v[212:215], v[144:145], v[164:165], 0
  ds_read2_b64 v[168:171], v19 offset0:0 offset1:1
  v_cvt_pk_bf16_f32 v128, v196, v197
  v_cvt_pk_bf16_f32 v129, v198, v199
  v_add_u32 v19, 1160, v19
  v_mfma_f32_16x16x32_bf16 v[176:179], v[140:143], v[132:135], v[176:179]
  v_mfma_f32_16x16x32_bf16 v[212:215], v[140:143], v[160:163], v[212:215]
  v_mfma_f32_16x16x32_bf16 v[196:199], v[224:227], a[144:147], 0
  v_exp_f32 v176, v176
  v_mfma_f32_16x16x32_bf16 v[196:199], v[228:231], a[148:151], v[196:199]
  v_exp_f32 v177, v177
  v_mfma_f32_16x16x32_bf16 v[196:199], v[232:235], a[152:155], v[196:199]
  v_exp_f32 v178, v178
  v_mfma_f32_16x16x32_bf16 v[196:199], v[236:239], a[156:159], v[196:199]
  v_exp_f32 v179, v179
  v_mfma_f32_16x16x32_bf16 v[196:199], v[216:219], a[160:163], v[196:199]
  v_exp_f32 v212, v212
  v_mfma_f32_16x16x32_bf16 v[196:199], v[204:207], a[164:167], v[196:199]
  v_exp_f32 v213, v213
  v_mfma_f32_16x16x32_bf16 v[240:243], v[224:227], a[168:171], 0
  v_exp_f32 v214, v214
  v_mfma_f32_16x16x32_bf16 v[240:243], v[228:231], a[172:175], v[240:243]
  v_exp_f32 v215, v215
  v_mfma_f32_16x16x32_bf16 v[240:243], v[232:235], a[176:179], v[240:243]
  v_cvt_pk_bf16_f32 v222, v176, v177
  v_cvt_pk_bf16_f32 v223, v178, v179
  v_mfma_f32_16x16x32_bf16 v[240:243], v[236:239], a[180:183], v[240:243]
  v_cvt_pk_bf16_f32 v104, v196, v197
  v_cvt_pk_bf16_f32 v105, v198, v199
  v_mfma_f32_16x16x32_bf16 v[240:243], v[216:219], a[184:187], v[240:243]
  buffer_store_dwordx2 v[138:139], v23, s[8:11], s32 offen
  v_cvt_pk_bf16_f32 v210, v212, v213
  v_mfma_f32_16x16x32_bf16 v[240:243], v[204:207], a[188:191], v[240:243]
  s_waitcnt lgkmcnt(1)
  v_cvt_pk_bf16_f32 v211, v214, v215
  v_mfma_f32_16x16x16_bf16 v[212:215], v[128:129], v[152:153], 0
  v_mfma_f32_16x16x16_bf16 v[196:199], v[172:173], v[152:153], v[2:5]
  v_cvt_pk_bf16_f32 v108, v240, v241
  v_cvt_pk_bf16_f32 v109, v242, v243
  v_mfma_f32_16x16x32_bf16 v[212:215], v[124:127], v[148:151], v[212:215]
  s_waitcnt lgkmcnt(0)
  v_mfma_f32_16x16x32_bf16 v[196:199], v[168:171], v[148:151], v[196:199]
  v_mfma_f32_16x16x32_bf16 v[148:151], v[224:227], a[192:195], 0
  v_exp_f32 v212, v212
  v_mfma_f32_16x16x32_bf16 v[148:151], v[228:231], a[196:199], v[148:151]
  v_exp_f32 v213, v213
  v_mfma_f32_16x16x32_bf16 v[148:151], v[232:235], a[200:203], v[148:151]
  ds_read_u16 v106, v20
  v_cvt_pk_bf16_f32 v116, v212, v213
  v_mfma_f32_16x16x32_bf16 v[148:151], v[236:239], a[204:207], v[148:151]
  v_exp_f32 v214, v214
  v_mfma_f32_16x16x32_bf16 v[148:151], v[216:219], a[208:211], v[148:151]
  ds_read_u16 v110, v20 offset:32
  v_mfma_f32_16x16x32_bf16 v[148:151], v[204:207], a[212:215], v[148:151]
  v_exp_f32 v215, v215
  v_mfma_f32_16x16x16_bf16 v[240:243], v[128:129], v[136:137], 0
  ds_read_u16 v114, v20 offset:64
  v_exp_f32 v196, v196
  v_mfma_f32_16x16x16_bf16 v[176:179], v[172:173], v[136:137], v[2:5]
  v_cvt_pk_bf16_f32 v117, v214, v215
  v_cvt_pk_bf16_f32 v118, v196, 0
  v_cvt_pk_bf16_f32 v112, v148, v149
  v_cvt_pk_bf16_f32 v113, v150, v151
  v_mfma_f32_16x16x32_bf16 v[240:243], v[124:127], v[132:135], v[240:243]
  v_mfma_f32_16x16x32_bf16 v[176:179], v[168:171], v[132:135], v[176:179]
  v_mfma_f32_16x16x32_bf16 v[148:151], a[0:3], v[224:227], 0
  v_exp_f32 v240, v240
  v_mfma_f32_16x16x32_bf16 v[148:151], a[4:7], v[228:231], v[148:151]
  v_exp_f32 v241, v241
  v_mfma_f32_16x16x32_bf16 v[148:151], a[8:11], v[232:235], v[148:151]
  v_exp_f32 v242, v242
  v_mfma_f32_16x16x32_bf16 v[148:151], a[12:15], v[236:239], v[148:151]
  v_exp_f32 v243, v243
  v_mfma_f32_16x16x32_bf16 v[148:151], a[16:19], v[216:219], v[148:151]
  v_exp_f32 v176, v176
  v_mfma_f32_16x16x32_bf16 v[148:151], a[20:23], v[204:207], v[148:151]
  v_cvt_pk_bf16_f32 v120, v240, v241
  v_cvt_pk_bf16_f32 v121, v242, v243
  v_mfma_f32_16x16x32_bf16 v[240:243], a[246:249], v[188:191], 0
  v_cvt_pk_bf16_f32 v122, v176, 0
  v_mfma_f32_16x16x32_bf16 v[240:243], a[246:249], v[116:119], v[240:243]
  v_cvt_pk_bf16_f32 v132, v148, v149
  v_cvt_pk_bf16_f32 v133, v150, v151
  v_mfma_f32_16x16x32_bf16 v[148:151], v[184:187], v[188:191], 0
  s_waitcnt lgkmcnt(2)
  v_mfma_f32_16x16x32_bf16 v[148:151], v[104:107], v[116:119], v[148:151]
  v_mul_f32 v240, 0x3ee9a3cd, v240
  v_mfma_f32_16x16x32_bf16 v[176:179], v[200:203], v[188:191], 0
  s_waitcnt lgkmcnt(1)
  v_rcp_f32 v212, v240
  v_mfma_f32_16x16x32_bf16 v[176:179], v[108:111], v[116:119], v[176:179]
  v_mul_f32 v148, v148, v212
  v_mul_f32 v149, v149, v212
  v_mfma_f32_16x16x32_bf16 v[196:199], v[192:195], v[188:191], 0
  s_waitcnt lgkmcnt(0)
  v_cvt_pk_bf16_f32 v188, v148, v149
  v_mul_f32 v150, v150, v212
  v_mfma_f32_16x16x32_bf16 v[196:199], v[112:115], v[116:119], v[196:199]
  v_mul_f32 v151, v151, v212
  v_cvt_pk_bf16_f32 v189, v150, v151
  v_mfma_f32_16x16x32_bf16 v[148:151], a[24:27], v[224:227], 0
  v_mul_f32 v176, v176, v212
  v_mul_f32 v177, v177, v212
  v_mfma_f32_16x16x32_bf16 v[148:151], a[28:31], v[228:231], v[148:151]
  v_cvt_pk_bf16_f32 v190, v176, v177
  v_mul_f32 v178, v178, v212
  v_mfma_f32_16x16x32_bf16 v[148:151], a[32:35], v[232:235], v[148:151]
  v_mul_f32 v179, v179, v212
  v_cvt_pk_bf16_f32 v191, v178, v179
  v_mfma_f32_16x16x32_bf16 v[148:151], a[36:39], v[236:239], v[148:151]
  ds_write_b128 v16, v[188:191] offset:20480
  v_mfma_f32_16x16x32_bf16 v[148:151], a[40:43], v[216:219], v[148:151]
  v_max3_f32 v1, v1, v240, v212
  v_mul_f32 v196, v196, v212
  v_mfma_f32_16x16x32_bf16 v[148:151], a[44:47], v[204:207], v[148:151]
  v_mul_f32 v197, v197, v212
  v_cvt_pk_bf16_f32 v188, v196, v197
  v_mul_f32 v198, v198, v212
  v_mfma_f32_16x16x16_bf16 v[240:243], v[128:129], v[164:165], 0
  v_mul_f32 v199, v199, v212
  v_cvt_pk_bf16_f32 v189, v198, v199
  v_mfma_f32_16x16x16_bf16 v[196:199], v[172:173], v[164:165], v[2:5]
  ds_write_b64 v17, v[188:189] offset:20480
  v_cvt_pk_bf16_f32 v134, v148, v149
  v_mfma_f32_16x16x32_bf16 v[240:243], v[124:127], v[160:163], v[240:243]
  v_cvt_pk_bf16_f32 v135, v150, v151
  v_mfma_f32_16x16x32_bf16 v[196:199], v[168:171], v[160:163], v[196:199]
  v_mfma_f32_16x16x32_bf16 v[160:163], a[246:249], v[220:223], 0
  v_exp_f32 v240, v240
  v_mfma_f32_16x16x32_bf16 v[160:163], a[246:249], v[120:123], v[160:163]
  v_exp_f32 v241, v241
  v_mfma_f32_16x16x32_bf16 v[148:151], v[184:187], v[220:223], 0
  v_exp_f32 v242, v242
  v_mfma_f32_16x16x32_bf16 v[148:151], v[104:107], v[120:123], v[148:151]
  v_exp_f32 v243, v243
  v_mfma_f32_16x16x32_bf16 v[188:191], v[200:203], v[220:223], 0
  v_exp_f32 v196, v196
  v_mfma_f32_16x16x32_bf16 v[188:191], v[108:111], v[120:123], v[188:191]
  v_cvt_pk_bf16_f32 v116, v240, v241
  v_cvt_pk_bf16_f32 v117, v242, v243
  v_mfma_f32_16x16x32_bf16 v[240:243], v[192:195], v[220:223], 0
  v_cvt_pk_bf16_f32 v118, v196, 0
  v_mul_f32 v160, 0x3ee9a3cd, v160
  v_mfma_f32_16x16x32_bf16 v[240:243], v[112:115], v[120:123], v[240:243]
  v_rcp_f32 v164, v160
  v_mfma_f32_16x16x32_bf16 v[196:199], a[48:51], v[224:227], 0
  v_mul_f32 v148, v148, v164
  v_mul_f32 v149, v149, v164
  v_mfma_f32_16x16x32_bf16 v[196:199], a[52:55], v[228:231], v[196:199]
  v_cvt_pk_bf16_f32 v228, v148, v149
  v_mul_f32 v150, v150, v164
  v_mfma_f32_16x16x32_bf16 v[196:199], a[56:59], v[232:235], v[196:199]
  v_mul_f32 v151, v151, v164
  v_cvt_pk_bf16_f32 v229, v150, v151
  v_mfma_f32_16x16x32_bf16 v[196:199], a[60:63], v[236:239], v[196:199]
  v_mul_f32 v188, v188, v164
  v_mul_f32 v189, v189, v164
  v_mfma_f32_16x16x32_bf16 v[196:199], a[64:67], v[216:219], v[196:199]
  ds_read2_b64 v[216:219], v183 offset0:0 offset1:4
  v_cvt_pk_bf16_f32 v230, v188, v189
  v_mfma_f32_16x16x32_bf16 v[196:199], a[68:71], v[204:207], v[196:199]
  ds_read2_b64 v[204:207], v183 offset0:12 offset1:16
  v_mul_f32 v190, v190, v164
  v_mfma_f32_16x16x32_bf16 v[236:239], v[208:211], a[246:249], 0
  v_mul_f32 v191, v191, v164
  v_cvt_pk_bf16_f32 v231, v190, v191
  v_mfma_f32_16x16x32_bf16 v[236:239], v[116:119], a[246:249], v[236:239]
  ds_read_b128 v[188:191], v18
  v_cvt_pk_bf16_f32 v136, v196, v197
  v_mfma_f32_16x16x32_bf16 v[148:151], v[208:211], v[184:187], 0
  ds_read2_b64 v[232:235], v183 offset0:24 offset1:28
  v_cvt_pk_bf16_f32 v137, v198, v199
  v_mfma_f32_16x16x32_bf16 v[148:151], v[116:119], v[104:107], v[148:151]
  v_mul_f32 v236, 0x3ee9a3cd, v236
  v_mul_f32 v240, v240, v164
  v_mfma_f32_16x16x32_bf16 v[196:199], v[208:211], v[200:203], 0
  ds_read_b128 v[224:227], v18 offset:3072
  v_mul_f32 v241, v241, v164
  v_mfma_f32_16x16x32_bf16 v[196:199], v[116:119], v[108:111], v[196:199]
  ds_read2_b64 v[220:223], v183 offset0:36 offset1:40
  v_cvt_pk_bf16_f32 v212, v240, v241
  v_mfma_f32_16x16x32_bf16 v[176:179], v[208:211], v[192:195], 0
  v_rcp_f32 v165, v236
  v_mfma_f32_16x16x32_bf16 v[176:179], v[116:119], v[112:115], v[176:179]
  ds_read_b128 v[208:211], v18 offset:6144
  v_cndmask_b32 v116, v196, v148, s[54:55]
  v_mul_f32 v242, v242, v164
  v_mfma_f32_16x16x16_bf16 v[148:151], v[158:159], v[136:137], 0
  v_mul_f32 v243, v243, v164
  v_cvt_pk_bf16_f32 v213, v242, v243
  v_max3_f32 v1, v1, v160, v164
  v_mfma_f32_16x16x16_bf16 v[160:163], v[144:145], v[136:137], 0
  v_cndmask_b32 v116, v176, v116, s[56:57]
  v_max3_f32 v1, v1, v236, v165
  v_mul_f32 v116, v116, v165
  v_mfma_f32_16x16x16_bf16 v[236:239], v[128:129], v[136:137], 0
  v_cvt_pk_bf16_f32 v116, v116, v116
  v_mfma_f32_16x16x16_bf16 v[176:179], v[172:173], v[136:137], v[2:5]
  ds_read2_b64 v[240:243], v183 offset0:8 offset1:20
  ds_read_b128 v[196:199], v18 offset:9216
  v_mfma_f32_16x16x32_bf16 v[148:151], v[154:157], v[132:135], v[148:151]
  ds_read2_b64 v[156:159], v183 offset0:32 offset1:44
  v_mfma_f32_16x16x32_bf16 v[160:163], v[140:143], v[132:135], v[160:163]
  v_mfma_f32_16x16x32_bf16 v[236:239], v[124:127], v[132:135], v[236:239]
  v_exp_f32 v148, v148
  v_mfma_f32_16x16x32_bf16 v[176:179], v[168:171], v[132:135], v[176:179]
  s_waitcnt vmcnt(9) lgkmcnt(9)
  ds_read_b128 v[132:135], v18 offset:12288
  ds_read_b128 v[168:171], v18 offset:1024
  v_mfma_f32_16x16x32_bf16 v[60:63], a[250:253], v[216:219], v[60:63]
  s_waitcnt lgkmcnt(9)
  v_exp_f32 v149, v149
  v_mfma_f32_16x16x32_bf16 v[60:63], v[188:191], v[204:207], v[60:63]
  s_waitcnt lgkmcnt(7)
  ds_read_b128 v[124:127], v18 offset:4096
  ds_read_b128 v[140:143], v18 offset:7168
  v_mfma_f32_16x16x32_bf16 v[60:63], v[224:227], v[232:235], v[60:63]
  s_waitcnt lgkmcnt(7)
  v_exp_f32 v150, v150
  v_mfma_f32_16x16x32_bf16 v[60:63], v[208:211], v[220:223], v[60:63]
  s_waitcnt lgkmcnt(5)
  ds_read_b128 v[152:155], v18 offset:10240
  ds_read_b128 v[136:139], v18 offset:13312
  v_mfma_f32_16x16x32_bf16 v[60:63], v[196:199], v[240:243], v[60:63]
  s_waitcnt lgkmcnt(6)
  v_exp_f32 v151, v151
  v_exp_f32 v160, v160
  s_waitcnt lgkmcnt(5)
  v_mfma_f32_16x16x32_bf16 v[60:63], v[132:135], v[156:159], v[60:63]
  s_waitcnt vmcnt(8)
  ds_read_b128 v[172:175], v18 offset:2048
  ds_read_b128 v[128:131], v18 offset:5120
  v_mfma_f32_16x16x32_bf16 v[64:67], v[96:99], v[216:219], v[64:67]
  s_waitcnt lgkmcnt(6)
  ds_read_b128 v[144:147], v18 offset:8192
  v_cvt_pk_bf16_f32 v164, v148, v149
  v_mfma_f32_16x16x32_bf16 v[64:67], v[168:171], v[204:207], v[64:67]
  s_waitcnt lgkmcnt(6)
  v_exp_f32 v161, v161
  v_mfma_f32_16x16x32_bf16 v[64:67], v[124:127], v[232:235], v[64:67]
  s_waitcnt lgkmcnt(5)
  v_exp_f32 v162, v162
  v_mfma_f32_16x16x32_bf16 v[64:67], v[140:143], v[220:223], v[64:67]
  s_waitcnt lgkmcnt(4)
  v_exp_f32 v163, v163
  v_mfma_f32_16x16x32_bf16 v[64:67], v[152:155], v[240:243], v[64:67]
  s_waitcnt lgkmcnt(3)
  v_exp_f32 v236, v236
  v_mfma_f32_16x16x32_bf16 v[64:67], v[136:139], v[156:159], v[64:67]
  v_exp_f32 v237, v237
  v_exp_f32 v238, v238
  v_exp_f32 v239, v239
  v_exp_f32 v176, v176
  v_cvt_pk_bf16_f32 v165, v150, v151
  v_cvt_pk_bf16_f32 v166, v160, v161
  v_cvt_pk_bf16_f32 v167, v162, v163
  v_cvt_pk_bf16_f32 v120, v236, v237
  v_cvt_pk_bf16_f32 v121, v238, v239
  v_mfma_f32_16x16x32_bf16 v[236:239], a[246:249], v[164:167], 0
  v_cvt_pk_bf16_f32 v122, v176, 0
  v_cvt_pk_bf16_f32 v176, v60, v61
  v_cvt_pk_bf16_f32 v177, v62, v63
  v_mfma_f32_16x16x32_bf16 v[236:239], a[246:249], v[120:123], v[236:239]
  ds_write_b128 v16, v[228:231] offset:26624
  v_mfma_f32_16x16x32_bf16 v[228:231], v[184:187], v[164:167], 0
  s_nop 3
  v_mul_f32 v236, 0x3ee9a3cd, v236
  v_cvt_pk_bf16_f32 v178, v64, v65
  v_mfma_f32_16x16x32_bf16 v[228:231], v[104:107], v[120:123], v[228:231]
  ds_read_b128 v[184:187], v18 offset:11264
  ds_read_b128 v[160:163], v18 offset:14336
  v_mfma_f32_16x16x32_bf16 v[148:151], v[200:203], v[164:167], 0
  v_rcp_f32 v104, v236
  v_mfma_f32_16x16x32_bf16 v[148:151], v[108:111], v[120:123], v[148:151]
  ds_write_b64 v17, v[212:213] offset:26624
  v_mfma_f32_16x16x32_bf16 v[200:203], v[192:195], v[164:167], 0
  ds_write_b16 v20, v116 offset:384
  v_mfma_f32_16x16x32_bf16 v[200:203], v[112:115], v[120:123], v[200:203]
  s_waitcnt vmcnt(7)
  v_mul_f32 v228, v228, v104
  v_mul_f32 v229, v229, v104
  v_mfma_f32_16x16x32_bf16 v[68:71], v[100:103], v[216:219], v[68:71]
  s_waitcnt lgkmcnt(7)
  v_mul_f32 v230, v230, v104
  v_mul_f32 v231, v231, v104
  v_mfma_f32_16x16x32_bf16 v[68:71], v[172:175], v[204:207], v[68:71]
  s_waitcnt lgkmcnt(6)
  v_mul_f32 v148, v148, v104
  v_mul_f32 v149, v149, v104
  v_mfma_f32_16x16x32_bf16 v[68:71], v[128:131], v[232:235], v[68:71]
  s_waitcnt lgkmcnt(5)
  v_mul_f32 v150, v150, v104
  v_mul_f32 v151, v151, v104
  v_mfma_f32_16x16x32_bf16 v[68:71], v[144:147], v[220:223], v[68:71]
  s_waitcnt lgkmcnt(3)
  v_cvt_pk_bf16_f32 v220, v228, v229
  v_cvt_pk_bf16_f32 v221, v230, v231
  v_mfma_f32_16x16x32_bf16 v[68:71], v[184:187], v[240:243], v[68:71]
  s_waitcnt lgkmcnt(2)
  v_cvt_pk_bf16_f32 v222, v148, v149
  v_cvt_pk_bf16_f32 v223, v150, v151
  v_mfma_f32_16x16x32_bf16 v[68:71], v[160:163], v[156:159], v[68:71]
  s_waitcnt lgkmcnt(0)
  ds_write_b128 v16, v[220:223] offset:32768
  v_mul_f32 v200, v200, v104
  v_mul_f32 v201, v201, v104
  v_mul_f32 v202, v202, v104
  v_mul_f32 v203, v203, v104
  v_cvt_pk_bf16_f32 v220, v200, v201
  v_cvt_pk_bf16_f32 v221, v202, v203
  ds_write_b64 v17, v[220:221] offset:32768
  v_max3_f32 v1, v1, v236, v104
  ds_write_b32 v107, v1
  v_cvt_pk_bf16_f32 v179, v66, v67
  v_cvt_pk_bf16_f32 v236, v68, v69
  v_cvt_pk_bf16_f32 v237, v70, v71
  v_permlane16_swap_b32 v176, v178
  v_permlane16_swap_b32 v177, v179
  v_add_u32 v20, 1160, v20
  buffer_store_dwordx4 v[176:179], v180, s[8:11], 0 offen
  s_waitcnt lgkmcnt(0)
  s_barrier
  ds_read_b128 v[176:179], v15 offset:20480
  ds_read_b128 v[200:203], v15 offset:21504
  ds_read_b128 v[220:223], v15 offset:22528
  ds_read_b128 v[156:159], v15 offset:23552
  ds_read_b128 v[148:151], v15 offset:24576
  ds_read_b128 v[240:243], v15 offset:25600
  ds_read_b128 v[228:231], v244
  s_waitcnt lgkmcnt(6)
  v_mfma_f32_16x16x32_bf16 v[24:27], a[250:253], v[176:179], v[24:27]
  s_waitcnt lgkmcnt(5)
  v_mfma_f32_16x16x32_bf16 v[24:27], v[188:191], v[200:203], v[24:27]
  s_waitcnt lgkmcnt(4)
  v_mfma_f32_16x16x32_bf16 v[24:27], v[224:227], v[220:223], v[24:27]
  s_waitcnt lgkmcnt(3)
  v_mfma_f32_16x16x32_bf16 v[24:27], v[208:211], v[156:159], v[24:27]
  s_waitcnt lgkmcnt(2)
  v_mfma_f32_16x16x32_bf16 v[24:27], v[196:199], v[148:151], v[24:27]
  s_waitcnt lgkmcnt(1)
  v_mfma_f32_16x16x32_bf16 v[24:27], v[132:135], v[240:243], v[24:27]
  ds_read_b128 v[232:235], v15 offset:26624
  v_mfma_f32_16x16x32_bf16 v[28:31], v[96:99], v[176:179], v[28:31]
  s_waitcnt lgkmcnt(1)
  ds_read_b128 v[204:207], v15 offset:27648
  v_max3_f32 v1, v228, v229, v230
  v_mfma_f32_16x16x32_bf16 v[28:31], v[168:171], v[200:203], v[28:31]
  ds_read_b128 v[216:219], v15 offset:28672
  v_cvt_pk_bf16_f32 v164, v24, v25
  v_mfma_f32_16x16x32_bf16 v[28:31], v[124:127], v[220:223], v[28:31]
  ds_read_b128 v[192:195], v15 offset:29696
  v_cvt_pk_bf16_f32 v165, v26, v27
  v_mfma_f32_16x16x32_bf16 v[28:31], v[140:143], v[156:159], v[28:31]
  ds_read_b128 v[212:215], v15 offset:30720
  v_max_f32 v1, v1, v231
  v_mfma_f32_16x16x32_bf16 v[28:31], v[152:155], v[148:151], v[28:31]
  ds_read_b128 v[228:231], v15 offset:31744
  v_mfma_f32_16x16x32_bf16 v[28:31], v[136:139], v[240:243], v[28:31]
  v_mfma_f32_16x16x32_bf16 v[32:35], v[100:103], v[176:179], v[32:35]
  v_mfma_f32_16x16x32_bf16 v[32:35], v[172:175], v[200:203], v[32:35]
  v_cvt_pk_bf16_f32 v166, v28, v29
  v_cvt_pk_bf16_f32 v167, v30, v31
  v_mfma_f32_16x16x32_bf16 v[32:35], v[128:131], v[220:223], v[32:35]
  v_permlane16_swap_b32 v164, v166
  v_mfma_f32_16x16x32_bf16 v[32:35], v[144:147], v[156:159], v[32:35]
  v_permlane16_swap_b32 v165, v167
  v_mfma_f32_16x16x32_bf16 v[32:35], v[184:187], v[148:151], v[32:35]
  buffer_store_dwordx4 v[164:167], v12, s[8:11], s33 offen
  v_mfma_f32_16x16x32_bf16 v[32:35], v[160:163], v[240:243], v[32:35]
  s_waitcnt lgkmcnt(5)
  v_mfma_f32_16x16x32_bf16 v[36:39], a[250:253], v[232:235], v[36:39]
  s_waitcnt lgkmcnt(4)
  v_mfma_f32_16x16x32_bf16 v[36:39], v[188:191], v[204:207], v[36:39]
  s_waitcnt lgkmcnt(3)
  v_cvt_pk_bf16_f32 v240, v32, v33
  v_cvt_pk_bf16_f32 v241, v34, v35
  v_mfma_f32_16x16x32_bf16 v[36:39], v[224:227], v[216:219], v[36:39]
  s_waitcnt lgkmcnt(2)
  v_mfma_f32_16x16x32_bf16 v[36:39], v[208:211], v[192:195], v[36:39]
  s_waitcnt lgkmcnt(1)
  v_mfma_f32_16x16x32_bf16 v[36:39], v[196:199], v[212:215], v[36:39]
  s_waitcnt lgkmcnt(0)
  v_mfma_f32_16x16x32_bf16 v[36:39], v[132:135], v[228:231], v[36:39]
  ds_read_b128 v[164:167], v15 offset:32768
  v_mfma_f32_16x16x32_bf16 v[40:43], v[96:99], v[232:235], v[40:43]
  ds_read_b128 v[148:151], v15 offset:33792
  v_mfma_f32_16x16x32_bf16 v[40:43], v[168:171], v[204:207], v[40:43]
  ds_read_b128 v[156:159], v15 offset:34816
  v_cvt_pk_bf16_f32 v220, v36, v37
  v_mfma_f32_16x16x32_bf16 v[40:43], v[124:127], v[216:219], v[40:43]
  ds_read_b128 v[200:203], v15 offset:35840
  v_cvt_pk_bf16_f32 v221, v38, v39
  v_mfma_f32_16x16x32_bf16 v[40:43], v[140:143], v[192:195], v[40:43]
  ds_read_b128 v[176:179], v15 offset:36864
  v_mfma_f32_16x16x32_bf16 v[40:43], v[152:155], v[212:215], v[40:43]
  ds_read_b128 v[244:247], v15 offset:37888
  v_mfma_f32_16x16x32_bf16 v[40:43], v[136:139], v[228:231], v[40:43]
  v_mfma_f32_16x16x32_bf16 v[44:47], v[100:103], v[232:235], v[44:47]
  v_mfma_f32_16x16x32_bf16 v[44:47], v[172:175], v[204:207], v[44:47]
  v_cvt_pk_bf16_f32 v222, v40, v41
  v_cvt_pk_bf16_f32 v223, v42, v43
  v_mfma_f32_16x16x32_bf16 v[44:47], v[128:131], v[216:219], v[44:47]
  v_permlane16_swap_b32 v220, v222
  v_mfma_f32_16x16x32_bf16 v[44:47], v[144:147], v[192:195], v[44:47]
  v_permlane16_swap_b32 v221, v223
  v_mfma_f32_16x16x32_bf16 v[44:47], v[184:187], v[212:215], v[44:47]
  buffer_store_dwordx4 v[220:223], v13, s[8:11], s33 offen
  v_mfma_f32_16x16x32_bf16 v[44:47], v[160:163], v[228:231], v[44:47]
  s_waitcnt lgkmcnt(5)
  v_mfma_f32_16x16x32_bf16 v[48:51], a[250:253], v[164:167], v[48:51]
  s_waitcnt lgkmcnt(4)
  ds_read2_b64 v[228:231], v248 offset0:0 offset1:4
  v_mfma_f32_16x16x32_bf16 v[48:51], v[188:191], v[148:151], v[48:51]
  s_waitcnt lgkmcnt(4)
  ds_read2_b64 v[220:223], v248 offset0:12 offset1:16
  v_cvt_pk_bf16_f32 v242, v44, v45
  v_mfma_f32_16x16x32_bf16 v[48:51], v[224:227], v[156:159], v[48:51]
  s_waitcnt lgkmcnt(4)
  v_cvt_pk_bf16_f32 v243, v46, v47
  v_mfma_f32_16x16x32_bf16 v[48:51], v[208:211], v[200:203], v[48:51]
  s_waitcnt lgkmcnt(3)
  ds_read2_b64 v[212:215], v248 offset0:24 offset1:28
  v_mfma_f32_16x16x32_bf16 v[48:51], v[196:199], v[176:179], v[48:51]
  s_waitcnt lgkmcnt(3)
  v_permlane16_swap_b32 v240, v242
  v_mfma_f32_16x16x32_bf16 v[48:51], v[132:135], v[244:247], v[48:51]
  ds_read2_b64 v[192:195], v248 offset0:36 offset1:40
  v_mfma_f32_16x16x32_bf16 v[52:55], v[96:99], v[164:167], v[52:55]
  v_permlane16_swap_b32 v241, v243
  v_mfma_f32_16x16x32_bf16 v[52:55], v[168:171], v[148:151], v[52:55]
  ds_read2_b64 v[216:219], v248 offset0:8 offset1:20
  v_cvt_pk_bf16_f32 v204, v48, v49
  v_mfma_f32_16x16x32_bf16 v[52:55], v[124:127], v[156:159], v[52:55]
  v_cvt_pk_bf16_f32 v205, v50, v51
  v_mfma_f32_16x16x32_bf16 v[52:55], v[140:143], v[200:203], v[52:55]
  ds_read2_b64 v[232:235], v248 offset0:32 offset1:44
  v_mfma_f32_16x16x32_bf16 v[52:55], v[152:155], v[176:179], v[52:55]
  v_mfma_f32_16x16x32_bf16 v[52:55], v[136:139], v[244:247], v[52:55]
  v_mfma_f32_16x16x32_bf16 v[56:59], v[100:103], v[164:167], v[56:59]
  v_mfma_f32_16x16x32_bf16 v[56:59], v[172:175], v[148:151], v[56:59]
  v_cvt_pk_bf16_f32 v206, v52, v53
  v_cvt_pk_bf16_f32 v207, v54, v55
  v_mfma_f32_16x16x32_bf16 v[56:59], v[128:131], v[156:159], v[56:59]
  buffer_store_dwordx4 v[240:243], v22, s[8:11], s33 offen
  v_mfma_f32_16x16x32_bf16 v[56:59], v[144:147], v[200:203], v[56:59]
  v_permlane16_swap_b32 v204, v206
  v_mfma_f32_16x16x32_bf16 v[56:59], v[184:187], v[176:179], v[56:59]
  v_permlane16_swap_b32 v205, v207
  v_mfma_f32_16x16x32_bf16 v[56:59], v[160:163], v[244:247], v[56:59]
  s_waitcnt vmcnt(10) lgkmcnt(5)
  v_mfma_f32_16x16x32_bf16 v[72:75], a[250:253], v[228:231], v[72:75]
  s_waitcnt lgkmcnt(4)
  v_mfma_f32_16x16x32_bf16 v[72:75], v[188:191], v[220:223], v[72:75]
  s_waitcnt lgkmcnt(3)
  v_cvt_pk_bf16_f32 v188, v56, v57
  v_cvt_pk_bf16_f32 v189, v58, v59
  v_mfma_f32_16x16x32_bf16 v[72:75], v[224:227], v[212:215], v[72:75]
  s_waitcnt lgkmcnt(2)
  v_mfma_f32_16x16x32_bf16 v[72:75], v[208:211], v[192:195], v[72:75]
  s_waitcnt lgkmcnt(1)
  v_mfma_f32_16x16x32_bf16 v[72:75], v[196:199], v[216:219], v[72:75]
  s_waitcnt lgkmcnt(0)
  v_mfma_f32_16x16x32_bf16 v[72:75], v[132:135], v[232:235], v[72:75]
  s_waitcnt vmcnt(9)
  v_mfma_f32_16x16x32_bf16 v[76:79], v[96:99], v[228:231], v[76:79]
  v_mfma_f32_16x16x32_bf16 v[76:79], v[168:171], v[220:223], v[76:79]
  v_cvt_pk_bf16_f32 v168, v72, v73
  v_cvt_pk_bf16_f32 v169, v74, v75
  v_mfma_f32_16x16x32_bf16 v[76:79], v[124:127], v[212:215], v[76:79]
  v_mfma_f32_16x16x32_bf16 v[76:79], v[140:143], v[192:195], v[76:79]
  v_mfma_f32_16x16x32_bf16 v[76:79], v[152:155], v[216:219], v[76:79]
  v_mfma_f32_16x16x32_bf16 v[76:79], v[136:139], v[232:235], v[76:79]
  s_waitcnt vmcnt(8)
  v_mfma_f32_16x16x32_bf16 v[80:83], v[100:103], v[228:231], v[80:83]
  buffer_store_dwordx4 v[204:207], v14, s[8:11], s33 offen
  s_nop 2
  v_cvt_pk_bf16_f32 v170, v76, v77
  v_mfma_f32_16x16x32_bf16 v[80:83], v[172:175], v[220:223], v[80:83]
  v_cvt_pk_bf16_f32 v171, v78, v79
  v_mfma_f32_16x16x32_bf16 v[80:83], v[128:131], v[212:215], v[80:83]
  v_permlane16_swap_b32 v168, v170
  v_mfma_f32_16x16x32_bf16 v[80:83], v[144:147], v[192:195], v[80:83]
  v_permlane16_swap_b32 v169, v171
  v_mfma_f32_16x16x32_bf16 v[80:83], v[184:187], v[216:219], v[80:83]
  v_mfma_f32_16x16x32_bf16 v[80:83], v[160:163], v[232:235], v[80:83]
  s_nop 7
  v_cvt_pk_bf16_f32 v238, v80, v81
  v_cvt_pk_bf16_f32 v239, v82, v83
  s_nop 0
  v_permlane16_swap_b32 v236, v238
  v_permlane16_swap_b32 v237, v239
  buffer_store_dwordx2 v[188:189], v23, s[8:11], s33 offen
  buffer_store_dwordx4 v[168:171], v181, s[8:11], 0 offen
  buffer_store_dwordx4 v[236:239], v182, s[8:11], 0 offen
L_exit:
  s_endpgm
.section .rodata,"a"
.p2align 6
.amdhsa_kernel standalone__window_attn_davit__vision_kernel
  .amdhsa_next_free_vgpr 512
  .amdhsa_next_free_sgpr 102
  .amdhsa_accum_offset 256
  .amdhsa_group_segment_fixed_size 0
  .amdhsa_kernarg_size 56
  .amdhsa_user_sgpr_count 2
  .amdhsa_user_sgpr_kernarg_segment_ptr 1
  .amdhsa_system_sgpr_workgroup_id_x 1
.end_amdhsa_kernel
```

```asm
; @launch grid=(256,1,1) block=(256,1,1) lds=163840
.amdgcn_target "amdgcn-amd-amdhsa--gfx950"
.text
.globl standalone__window_attn_davit__vision_kernel
.p2align 8
.type standalone__window_attn_davit__vision_kernel,@function
standalone__window_attn_davit__vision_kernel:
  s_cmp_ge_u32 s2, 256
  s_cbranch_scc1 L_exit
  s_load_dwordx8 s[36:43], s[0:1], 0
  s_load_dwordx2 s[44:45], s[0:1], 32
  s_load_dwordx2 s[46:47], s[0:1], 48
  v_lshrrev_b32 v1, 6, v0
  s_and_b32 s60, s2, 7
  s_lshr_b32 s30, s2, 3
  v_readfirstlane_b32 s28, v1
  v_and_b32 v220, 63, v0
  s_mul_i32 s29, s60, 667
  s_add_u32 s29, s29, s30
  s_mov_b32 s72, 667
  s_mov_b32 s73, 5329
  s_mul_i32 s74, s28, 96
  s_mul_i32 s81, s28, 27872
  s_add_u32 s81, s81, 20480
  s_lshl_b32 s76, s28, 10
  v_add_u32 v223, 0, v220
  v_lshlrev_b32 v223, 5, v223
  v_add_u32 v224, s30, v223
  v_cmp_gt_u32 s[60:61], s72, v224
  v_add_u32 v223, s29, v223
  v_cmp_gt_u32 s[62:63], s73, v223
  v_mul_u32_u24 v224, 7183, v223
  v_lshrrev_b32 v224, 22, v224
  s_and_b64 s[60:61], s[60:61], s[62:63]
  v_mul_u32_u24 v225, 584, v224
  v_sub_u32 v225, v223, v225
  v_cmp_le_u32 vcc, 5256, v223
  v_and_b32 v227, 7, v225
  v_lshl_add_u32 v224, v224, 3, v227
  v_mov_b32 v227, 72
  v_cndmask_b32 v224, v224, v227, vcc
  v_lshrrev_b32 v227, 3, v225
  v_cndmask_b32 v225, v227, v225, vcc
  v_mul_u32_u24 v224, 1373568, v224
  v_mul_u32_u24 v225, 2688, v225
  v_add_u32 v227, v224, v225
  v_cndmask_b32 v227, 2.0, v227, s[60:61]
  v_mul_u32_u24 v223, 43, v220
  v_lshrrev_b32 v223, 8, v223
  v_mul_u32_u24 v224, 6, v223
  v_sub_u32 v224, v220, v224
  v_lshl_add_u32 v224, v224, 4, s74
  v_cmp_gt_u32 vcc, 54, v220
  v_mul_u32_u24 v225, 384, v223
  v_add_u32 v224, v224, v225
  v_cndmask_b32 v21, 2.0, v224, vcc
  v_mul_u32_u24 v223, 11, v223
  v_lshrrev_b32 v223, 5, v223
  v_mul_u32_u24 v223, 195072, v223
  v_add_u32 v224, 589824, v224
  v_add_u32 v224, v224, v223
  v_cndmask_b32 v242, 2.0, v224, vcc
  v_readlane_b32 s60, v227, 0
  v_readlane_b32 s61, v227, 1
  v_readlane_b32 s62, v227, 2
  v_lshlrev_b32 v223, 6, v220
  v_cmp_gt_u32 vcc, 27, v220
  s_lshl_b32 s69, s30, 2
  s_add_u32 s69, s69, s28
  v_cndmask_b32 v224, 2.0, v223, vcc
  v_cmp_gt_u32 vcc, 9, v220
  s_mul_i32 s70, s69, 1728
  s_mul_i32 s71, s69, 576
  v_cndmask_b32 v225, 2.0, v223, vcc
  s_waitcnt lgkmcnt(0)
  s_mov_b32 s16, s40
  s_mov_b32 s17, s41
  s_mov_b32 s18, 221184
  s_mov_b32 s19, 0x20000
  buffer_load_dword v232, v224, s[16:19], s70 offen
  s_mov_b32 s24, s38
  s_mov_b32 s25, s39
  s_mov_b32 s26, 3456
  s_mov_b32 s27, 0x20000
  s_add_u32 m0, s76, 8192
  s_sub_u32 s4, s36, 196608
  s_subb_u32 s5, s37, 0
  s_mov_b32 s6, 100467072
  s_mov_b32 s7, 0x20000
  buffer_load_dwordx4 v21, s[24:27], 0 offen lds
  s_add_u32 m0, s81, 9216
  s_nop 0
  buffer_load_dwordx4 v242, s[4:7], s60 offen lds
  s_add_u32 m0, s81, 10080
  s_nop 0
  buffer_load_dwordx4 v242, s[4:7], s61 offen lds
  s_add_u32 m0, s81, 10944
  s_nop 0
  buffer_load_dwordx4 v242, s[4:7], s62 offen lds
  s_mov_b32 s20, s42
  s_mov_b32 s21, s43
  s_mov_b32 s22, 73728
  s_mov_b32 s23, 0x20000
  buffer_load_dword v233, v225, s[20:23], s71 offen
  s_getpc_b64 s[62:63]
  L_pc:
  s_mul_i32 s69, s69, 320
  s_min_u32 s69, s69, L_safe-L_pc-256
  s_add_u32 s62, s62, s69
  s_addc_u32 s63, s63, 0
  v_min_u32 v224, 4, v220
  v_lshlrev_b32 v224, 6, v224
  global_load_dword v234, v224, s[62:63]
  v_readlane_b32 s63, v227, 3
  v_readlane_b32 s64, v227, 4
  v_readlane_b32 s65, v227, 5
  v_readlane_b32 s66, v227, 6
  v_readlane_b32 s67, v227, 7
  v_readlane_b32 s68, v227, 8
  s_mov_b32 s8, s44
  s_mov_b32 s9, s45
  s_mov_b32 s10, 100270464
  s_mov_b32 s11, 0x20000
  s_mov_b32 s12, s46
  s_mov_b32 s13, s47
  s_mov_b32 s14, 16777216
  s_mov_b32 s15, 0x20000
  s_mov_b32 s24, s36
  s_mov_b32 s25, s37
  s_mov_b32 s26, 100270464
  s_add_u32 m0, s81, 11808
  s_nop 0
  buffer_load_dwordx4 v242, s[4:7], s63 offen lds
  s_add_u32 m0, s81, 12672
  s_nop 0
  buffer_load_dwordx4 v242, s[4:7], s64 offen lds
  s_add_u32 m0, s81, 13536
  s_nop 0
  buffer_load_dwordx4 v242, s[4:7], s65 offen lds
  s_add_u32 m0, s81, 14400
  s_nop 0
  buffer_load_dwordx4 v242, s[4:7], s66 offen lds
  s_add_u32 m0, s81, 15264
  s_nop 0
  buffer_load_dwordx4 v242, s[4:7], s67 offen lds
  s_add_u32 m0, s81, 16128
  s_nop 0
  buffer_load_dwordx4 v242, s[4:7], s68 offen lds
  v_readlane_b32 s36, v227, 9
  v_readlane_b32 s37, v227, 10
  v_readlane_b32 s38, v227, 11
  v_readlane_b32 s39, v227, 12
  v_readlane_b32 s40, v227, 13
  v_readlane_b32 s41, v227, 14
  v_readlane_b32 s42, v227, 15
  v_readlane_b32 s43, v227, 16
  v_readlane_b32 s44, v227, 17
  v_readlane_b32 s45, v227, 18
  v_readlane_b32 s46, v227, 19
  v_readlane_b32 s47, v227, 20
  v_add_u32 v223, 0, v220
  v_mul_u32_u24 v224, 171, v223
  v_lshrrev_b32 v224, 10, v224
  v_mul_u32_u24 v225, 6, v224
  v_sub_u32 v225, v223, v225
  v_lshl_add_u32 v225, v225, 4, s74
  v_subrev_u32 v225, 0, v225
  v_mul_u32_u24 v223, 1152, v224
  v_add_u32 v243, v223, v225
  v_mul_u32_u24 v223, 384, v224
  v_add_u32 v251, v223, v225
  v_add_u32 v223, 64, v220
  v_mul_u32_u24 v224, 171, v223
  v_lshrrev_b32 v224, 10, v224
  v_mul_u32_u24 v225, 6, v224
  v_sub_u32 v225, v223, v225
  v_lshl_add_u32 v225, v225, 4, s74
  v_subrev_u32 v225, 1024, v225
  v_mul_u32_u24 v223, 1152, v224
  v_add_u32 v244, v223, v225
  v_mul_u32_u24 v223, 384, v224
  v_add_u32 v252, v223, v225
  v_add_u32 v223, 128, v220
  v_mul_u32_u24 v224, 171, v223
  v_lshrrev_b32 v224, 10, v224
  v_mul_u32_u24 v225, 6, v224
  v_sub_u32 v225, v223, v225
  v_lshl_add_u32 v225, v225, 4, s74
  v_subrev_u32 v225, 2048, v225
  v_mul_u32_u24 v223, 1152, v224
  v_add_u32 v245, v223, v225
  v_mul_u32_u24 v223, 384, v224
  v_add_u32 v253, v223, v225
  s_mov_b64 s[48:49], 0x3f
  s_mov_b32 s50, 0
  s_mov_b32 s51, 0x3f0000
  s_mov_b32 s54, 0xffff
  s_mov_b32 s55, 0
  s_mov_b32 s56, -1
  s_mov_b32 s57, 0
  s_mul_i32 s58, s28, 7936
  s_add_u32 s58, s58, 131968
  s_add_u32 s59, s58, 4320
  s_mul_i32 s75, s2, 65536
  s_mul_i32 s77, s28, 12288
  s_add_u32 s75, s75, s77
  s_add_u32 s77, s75, 4096
  s_add_u32 s78, s75, 8192
  s_mov_b32 s31, 0
  s_mov_b32 s79, 0x4310
  s_mov_b32 s80, 0x5276
  v_lshrrev_b32 v221, 4, v220
  v_and_b32 v222, 15, v220
  v_and_b32 v223, 3, v220
  v_mul_u32_u24 v0, 0x5555, v223
  v_mov_b32 v1, 0
  v_mov_b32 v223, 0xff800000
  v_cndmask_b32 v2, v223, 0, s[54:55]
  v_mov_b32 v121, 0
  v_mov_b32 v125, 0
  v_lshrrev_b32 v219, 1, v221
  v_and_b32 v226, 1, v221
  v_cmp_eq_u32 s[94:95], 1, v226
  v_lshlrev_b32 v226, 4, v226
  v_lshlrev_b32 v218, 4, v219
  v_lshl_add_u32 v218, v226, 1, v218
  v_add_u32 v218, s74, v218
  v_mov_b32 v223, 0x03020100
  v_cmp_le_u32 vcc, 4, v222
  v_mov_b32 v224, 0x13121110
  s_nop 0
  v_cndmask_b32 v223, v223, v224, vcc
  v_cmp_le_u32 vcc, 8, v222
  v_mov_b32 v224, 0x26251514
  s_nop 0
  v_cndmask_b32 v223, v223, v224, vcc
  v_cmp_le_u32 vcc, 12, v222
  v_mov_b32 v224, 0x16060504
  s_nop 0
  v_cndmask_b32 v223, v223, v224, vcc
  v_and_b32 v224, 3, v222
  v_lshlrev_b32 v224, 3, v224
  v_bfe_u32 v223, v223, v224, 8
  v_lshrrev_b32 v224, 4, v223
  v_and_b32 v223, 15, v223
  v_mul_u32_u24 v12, 196224, v224
  v_mul_u32_u24 v225, 384, v223
  v_add3_u32 v12, v12, v225, v218
  v_mul_u32_u24 v224, 9, v224
  v_add_u32 v223, v223, v224
  v_mul_u32_u24 v223, 96, v223
  v_add_u32 v223, s58, v223
  v_mul_u32_u24 v224, 96, v219
  v_add3_u32 v3, v223, v224, v226
  v_mul_u32_u24 v224, 864, v219
  v_add3_u32 v6, v223, v224, v226
  v_add_u32 v6, 192, v6
  v_lshl_add_u32 v9, v221, 3, v223
  v_add_u32 v9, 1920, v9
  v_mov_b32 v223, 0x23222120
  v_cmp_le_u32 vcc, 4, v222
  v_mov_b32 v224, 0x42323130
  s_nop 0
  v_cndmask_b32 v223, v223, v224, vcc
  v_cmp_le_u32 vcc, 8, v222
  v_mov_b32 v224, 0x46454443
  s_nop 0
  v_cndmask_b32 v223, v223, v224, vcc
  v_cmp_le_u32 vcc, 12, v222
  v_mov_b32 v224, 0x36353424
  s_nop 0
  v_cndmask_b32 v223, v223, v224, vcc
  v_and_b32 v224, 3, v222
  v_lshlrev_b32 v224, 3, v224
  v_bfe_u32 v223, v223, v224, 8
  v_lshrrev_b32 v224, 4, v223
  v_and_b32 v223, 15, v223
  v_mul_u32_u24 v13, 196224, v224
  v_mul_u32_u24 v225, 384, v223
  v_add3_u32 v13, v13, v225, v218
  v_mul_u32_u24 v224, 9, v224
  v_add_u32 v223, v223, v224
  v_mul_u32_u24 v223, 96, v223
  v_add_u32 v223, s58, v223
  v_mul_u32_u24 v224, 96, v219
  v_add3_u32 v4, v223, v224, v226
  v_mul_u32_u24 v224, 864, v219
  v_add3_u32 v7, v223, v224, v226
  v_add_u32 v7, 192, v7
  v_lshl_add_u32 v10, v221, 3, v223
  v_add_u32 v10, 1920, v10
  v_mov_b32 v223, 0x52514140
  v_cmp_le_u32 vcc, 4, v222
  v_mov_b32 v224, 0x62616050
  s_nop 0
  v_cndmask_b32 v223, v223, v224, vcc
  v_cmp_le_u32 vcc, 8, v222
  v_mov_b32 v224, 0x66656463
  s_nop 0
  v_cndmask_b32 v223, v223, v224, vcc
  v_cmp_le_u32 vcc, 12, v222
  v_mov_b32 v224, 0x56555453
  s_nop 0
  v_cndmask_b32 v223, v223, v224, vcc
  v_and_b32 v224, 3, v222
  v_lshlrev_b32 v224, 3, v224
  v_bfe_u32 v223, v223, v224, 8
  v_lshrrev_b32 v224, 4, v223
  v_and_b32 v223, 15, v223
  v_mul_u32_u24 v14, 196224, v224
  v_mul_u32_u24 v225, 384, v223
  v_add3_u32 v23, v14, v225, s74
  v_lshl_add_u32 v23, v221, 3, v23
  v_add_u32 v23, 64, v23
  v_add3_u32 v14, v14, v225, v218
  v_mul_u32_u24 v224, 9, v224
  v_add_u32 v223, v223, v224
  v_mul_u32_u24 v223, 96, v223
  v_add_u32 v223, s58, v223
  v_mul_u32_u24 v224, 96, v219
  v_add3_u32 v5, v223, v224, v226
  v_mul_u32_u24 v224, 864, v219
  v_add3_u32 v8, v223, v224, v226
  v_add_u32 v8, 192, v8
  v_lshl_add_u32 v11, v221, 3, v223
  v_add_u32 v11, 1920, v11
  v_add_u32 v223, 64, v12
  v_add_u32 v224, 32, v13
  v_cndmask_b32 v22, v223, v224, s[94:95]
  v_lshlrev_b32 v15, 4, v220
  v_add_u32 v16, s76, v15
  s_lshr_b32 s60, s28, 1
  s_add_u32 s60, s60, 4
  s_lshl_b32 s60, s60, 10
  s_and_b32 s61, s28, 1
  s_lshl_b32 s61, s61, 3
  s_add_u32 s60, s60, s61
  v_add_u32 v17, s60, v15
  s_mul_i32 s60, s28, 15360
  s_add_u32 s60, s60, 63280
  v_add_u32 v18, s60, v15
  v_add_u32 v223, v226, v222
  v_lshlrev_b32 v224, 10, v219
  v_lshl_add_u32 v109, v223, 4, v224
  s_lshl_b32 s60, s28, 2
  v_add_u32 v109, s60, v109
  v_lshl_add_u32 v113, v223, 3, v224
  v_add_u32 v113, 768, v113
  v_lshlrev_b32 v117, 3, v222
  v_mov_b32 v223, 0x3f803f80
  v_accvgpr_write_b32 a246, v223
  v_accvgpr_write_b32 a247, v223
  v_accvgpr_write_b32 a248, v223
  v_accvgpr_write_b32 a249, v223
  s_add_u32 s60, s74, 38912
  v_mul_u32_u24 v223, 24, v221
  v_add_u32 v19, s60, v223
  v_min_u32 v223, 2, v221
  v_lshl_add_u32 v223, v223, 4, v222
  s_add_u32 s60, s60, 384
  v_lshl_add_u32 v20, v223, 1, s60
  v_cmp_gt_u32 vcc, 5, v222
  v_mul_u32_u24 v223, 1160, v222
  v_add_u32 v249, v19, v223
  v_lshl_add_u32 v223, v221, 3, v223
  v_add_u32 v247, s60, v223
  v_mov_b32 v224, 0x30000
  v_add_u32 v225, 18560, v249
  v_cndmask_b32 v250, v224, v225, vcc
  v_add_u32 v225, 18560, v247
  v_cndmask_b32 v248, v224, v225, vcc
  v_mul_u32_u24 v223, 864, v222
  s_add_u32 s60, s81, 9216
  v_add_u32 v223, s60, v223
  v_mul_u32_u24 v224, 96, v219
  v_add3_u32 v239, v223, v224, v226
  v_mul_u32_u24 v224, 288, v219
  v_add3_u32 v240, v223, v224, v226
  v_add_u32 v240, 192, v240
  v_lshl_add_u32 v241, v221, 3, v223
  v_add_u32 v241, 768, v241
  s_add_u32 s60, s76, 8192
  v_lshl_add_u32 v223, v222, 1, s60
  v_lshlrev_b32 v224, 2, v221
  v_lshrrev_b32 v225, v224, s79
  v_and_b32 v225, 15, v225
  v_mul_u32_u24 v225, 96, v225
  v_add_u32 v236, v223, v225
  v_lshrrev_b32 v225, v224, s80
  v_and_b32 v225, 15, v225
  v_mul_u32_u24 v225, 96, v225
  v_add_u32 v237, v223, v225
  v_add_u32 v238, 768, v223
  v_lshrrev_b32 v223, 2, v220
  v_mul_u32_u24 v223, 96, v223
  v_and_b32 v224, 3, v220
  v_lshl_add_u32 v223, v224, 3, v223
  v_add_u32 v246, s81, v223
  s_mul_i32 s70, s28, 15360
  s_add_u32 s70, s70, 63280
  v_add_u32 v255, s70, v223
  s_mul_i32 s71, s28, 3072
  s_add_u32 s71, s71, 20480
  v_add_u32 v254, s71, v223
  s_mul_i32 s60, s28, 61
  v_add_u32 v223, s60, v220
  v_mul_u32_u24 v224, 2428, v223
  v_lshrrev_b32 v224, 16, v224
  v_mul_u32_u24 v224, 192768, v224
  v_lshl_add_u32 v224, v223, 7, v224
  v_cmp_gt_u32 vcc, 61, v220
  s_nop 1
  v_cndmask_b32 v224, 2.0, v224, vcc
  v_cmp_gt_u32 vcc, 243, v223
  s_nop 1
  v_cndmask_b32 v24, 2.0, v224, vcc
  v_add_u32 v223, 0, v222
  v_lshlrev_b32 v223, 5, v223
  v_add_u32 v224, s30, v223
  v_cmp_gt_u32 s[60:61], s72, v224
  v_add_u32 v223, s29, v223
  v_cmp_gt_u32 s[62:63], s73, v223
  v_mul_u32_u24 v224, 7183, v223
  v_lshrrev_b32 v224, 22, v224
  s_and_b64 s[60:61], s[60:61], s[62:63]
  v_mul_u32_u24 v225, 584, v224
  v_sub_u32 v225, v223, v225
  v_cmp_le_u32 vcc, 5256, v223
  v_and_b32 v228, 7, v225
  v_lshl_add_u32 v224, v224, 3, v228
  v_mov_b32 v228, 72
  v_cndmask_b32 v224, v224, v228, vcc
  v_lshrrev_b32 v228, 3, v225
  v_cndmask_b32 v225, v228, v225, vcc
  v_mul_u32_u24 v224, 1373568, v224
  v_mul_u32_u24 v225, 2688, v225
  v_add_u32 v228, v224, v225
  v_cndmask_b32 v228, 2.0, v228, s[60:61]
  v_add_u32 v228, 589824, v228
  v_add_u32 v228, v218, v228
  v_add_u32 v223, 16, v222
  v_lshlrev_b32 v223, 5, v223
  v_add_u32 v224, s30, v223
  v_cmp_gt_u32 s[60:61], s72, v224
  v_add_u32 v223, s29, v223
  v_cmp_gt_u32 s[62:63], s73, v223
  v_mul_u32_u24 v224, 7183, v223
  v_lshrrev_b32 v224, 22, v224
  s_and_b64 s[60:61], s[60:61], s[62:63]
  v_mul_u32_u24 v225, 584, v224
  v_sub_u32 v225, v223, v225
  v_cmp_le_u32 vcc, 5256, v223
  v_and_b32 v229, 7, v225
  v_lshl_add_u32 v224, v224, 3, v229
  v_mov_b32 v229, 72
  v_cndmask_b32 v224, v224, v229, vcc
  v_lshrrev_b32 v229, 3, v225
  v_cndmask_b32 v225, v229, v225, vcc
  v_mul_u32_u24 v224, 1373568, v224
  v_mul_u32_u24 v225, 2688, v225
  v_add_u32 v229, v224, v225
  v_cndmask_b32 v229, 2.0, v229, s[60:61]
  v_add_u32 v229, 589824, v229
  v_add_u32 v229, v218, v229
  v_add_u32 v223, 64, v228
  v_add_u32 v224, 32, v229
  v_cndmask_b32 v230, v223, v224, s[94:95]
  v_mul_u32_u24 v223, 1160, v222
  v_lshl_add_u32 v223, v221, 3, v223
  v_add_u32 v231, 39680, v223
  v_lshrrev_b32 v223, 2, v222
  v_cmp_eq_u32 s[82:83], 0, v223
  v_cmp_eq_u32 s[84:85], 1, v223
  v_cmp_eq_u32 s[86:87], 2, v223
  v_cmp_eq_u32 s[88:89], 3, v223
  v_cmp_eq_u32 s[90:91], 3, v221
  v_cmp_eq_u32 s[92:93], v223, v221
  v_and_b32 v223, 2, v222
  v_cmp_eq_u32 s[96:97], 0, v223
  v_and_b32 v235, 1, v222
  v_lshlrev_b32 v235, 4, v235
  s_add_u32 m0, s81, 16992
  s_waitcnt vmcnt(11)
  ds_read_u16 v108, v238
  ds_read_u16 v112, v238 offset:32
  ds_read_u16 v116, v238 offset:64
  ds_read_u16 v238, v236
  ds_read_u16 v120, v237
  ds_read_u16 v124, v236 offset:32
  ds_read_u16 v106, v237 offset:32
  ds_read_u16 v107, v236 offset:64
  ds_read_u16 v236, v237 offset:64
  v_cndmask_b32 v237, 0, 1.0, s[90:91]
  v_cndmask_b32 v226, 0, 1.0, s[90:91]
  v_cndmask_b32 v227, 0, 1.0, s[90:91]
  buffer_store_dwordx4 v[228:231], v15, s[12:15], s77 offen offset:2048
  s_waitcnt lgkmcnt(8)
  v_lshlrev_b32 v108, v235, v108
  v_cndmask_b32 v108, 0, v108, s[92:93]
  v_cndmask_b32 v230, 0, v108, s[96:97]
  v_cndmask_b32 v231, v108, 0, s[96:97]
  s_waitcnt lgkmcnt(7)
  v_lshlrev_b32 v112, v235, v112
  v_accvgpr_write_b32 a224, v230
  v_accvgpr_write_b32 a225, v231
  v_cndmask_b32 v112, 0, v112, s[92:93]
  v_cndmask_b32 v108, 0, v112, s[96:97]
  v_cndmask_b32 v231, v112, 0, s[96:97]
  s_waitcnt lgkmcnt(6)
  v_lshlrev_b32 v116, v235, v116
  v_accvgpr_write_b32 a234, v108
  v_accvgpr_write_b32 a235, v231
  v_cndmask_b32 v116, 0, v116, s[92:93]
  v_cndmask_b32 v235, 0, v116, s[96:97]
  v_cndmask_b32 v108, v116, 0, s[96:97]
  v_accvgpr_write_b32 a244, v235
  v_accvgpr_write_b32 a245, v108
  s_waitcnt lgkmcnt(5)
  v_or_b32 v238, v238, v237
  v_cndmask_b32 v237, 0, v238, s[82:83]
  v_cndmask_b32 v235, 0, v238, s[84:85]
  v_cndmask_b32 v108, 0, v238, s[86:87]
  v_cndmask_b32 v116, 0, v238, s[88:89]
  v_accvgpr_write_b32 a216, v237
  v_accvgpr_write_b32 a217, v235
  v_accvgpr_write_b32 a218, v108
  v_accvgpr_write_b32 a219, v116
  s_waitcnt lgkmcnt(4)
  v_cndmask_b32 v235, 0, v120, s[82:83]
  v_cndmask_b32 v237, 0, v120, s[84:85]
  v_cndmask_b32 v116, 0, v120, s[86:87]
  v_cndmask_b32 v108, 0, v120, s[88:89]
  v_accvgpr_write_b32 a220, v235
  v_accvgpr_write_b32 a221, v237
  v_accvgpr_write_b32 a222, v116
  v_accvgpr_write_b32 a223, v108
  s_waitcnt lgkmcnt(3)
  v_or_b32 v124, v124, v226
  v_cndmask_b32 v226, 0, v124, s[82:83]
  v_cndmask_b32 v237, 0, v124, s[84:85]
  v_cndmask_b32 v235, 0, v124, s[86:87]
  v_cndmask_b32 v108, 0, v124, s[88:89]
  v_accvgpr_write_b32 a226, v226
  v_accvgpr_write_b32 a227, v237
  v_accvgpr_write_b32 a228, v235
  v_accvgpr_write_b32 a229, v108
  buffer_load_dwordx4 v242, s[4:7], s36 offen lds
  s_add_u32 m0, s81, 17856
  s_waitcnt lgkmcnt(2)
  v_cndmask_b32 v235, 0, v106, s[82:83]
  v_cndmask_b32 v237, 0, v106, s[84:85]
  v_cndmask_b32 v226, 0, v106, s[86:87]
  v_cndmask_b32 v108, 0, v106, s[88:89]
  v_accvgpr_write_b32 a230, v235
  v_accvgpr_write_b32 a231, v237
  v_accvgpr_write_b32 a232, v226
  v_accvgpr_write_b32 a233, v108
  s_waitcnt lgkmcnt(1)
  v_or_b32 v107, v107, v227
  v_cndmask_b32 v237, 0, v107, s[82:83]
  v_cndmask_b32 v106, 0, v107, s[84:85]
  v_cndmask_b32 v235, 0, v107, s[86:87]
  v_cndmask_b32 v108, 0, v107, s[88:89]
  v_accvgpr_write_b32 a236, v237
  v_accvgpr_write_b32 a237, v106
  v_accvgpr_write_b32 a238, v235
  v_accvgpr_write_b32 a239, v108
  s_waitcnt lgkmcnt(0)
  v_cndmask_b32 v235, 0, v236, s[82:83]
  v_cndmask_b32 v237, 0, v236, s[84:85]
  v_cndmask_b32 v108, 0, v236, s[86:87]
  v_cndmask_b32 v124, 0, v236, s[88:89]
  v_accvgpr_write_b32 a240, v235
  v_accvgpr_write_b32 a241, v237
  v_accvgpr_write_b32 a242, v108
  v_accvgpr_write_b32 a243, v124
  buffer_load_dwordx4 v242, s[4:7], s37 offen lds
  s_add_u32 m0, s81, 18720
  s_nop 0
  buffer_load_dwordx4 v242, s[4:7], s38 offen lds
  s_add_u32 m0, s81, 19584
  s_waitcnt vmcnt(10)
  v_mov_b32 v232, 0
  v_mov_b32 v233, 0
  v_mov_b32 v234, 0
  buffer_load_dwordx4 v242, s[4:7], s39 offen lds
  s_add_u32 m0, s81, 20448
  s_nop 0
  buffer_load_dwordx4 v242, s[4:7], s40 offen lds
  s_add_u32 m0, s81, 21312
  s_nop 0
  buffer_load_dwordx4 v242, s[4:7], s41 offen lds
  s_add_u32 m0, s81, 22176
  s_nop 0
  buffer_load_dwordx4 v242, s[4:7], s42 offen lds
  s_add_u32 m0, s81, 23040
  s_nop 0
  buffer_load_dwordx4 v242, s[4:7], s43 offen lds
  s_add_u32 m0, s81, 23904
  s_nop 0
  buffer_load_dwordx4 v242, s[4:7], s44 offen lds
  s_add_u32 m0, s81, 24768
  s_nop 0
  buffer_load_dwordx4 v242, s[4:7], s45 offen lds
  s_add_u32 m0, s81, 25632
  s_nop 0
  buffer_load_dwordx4 v242, s[4:7], s46 offen lds
  s_add_u32 m0, s81, 26496
  s_nop 0
  buffer_load_dwordx4 v242, s[4:7], s47 offen lds
  s_lshl_b32 s60, s31, 5
  s_add_u32 s61, s60, s30
  s_add_u32 s60, s60, s29
  s_mul_i32 s62, s60, 7183
  s_lshr_b32 s62, s62, 22
  s_mul_i32 s63, s62, 584
  s_sub_u32 s63, s60, s63
  s_lshr_b32 s64, s63, 3
  s_and_b32 s65, s63, 7
  s_lshl_b32 s66, s62, 3
  s_add_u32 s65, s65, s66
  s_cmp_ge_u32 s60, 5256
  s_cselect_b32 s64, s63, s64
  s_cselect_b32 s65, 72, s65
  s_mul_i32 s66, s65, 1373568
  s_mul_i32 s67, s64, 2688
  s_add_u32 s35, s66, s67
  s_cmp_ge_u32 s61, 667
  s_cselect_b32 s35, 268435456, s35
  s_cmp_ge_u32 s60, 5329
  s_cselect_b32 s35, 268435456, s35
  s_cmp_eq_u32 s65, 0
  s_cselect_b32 s36, 268435456, s35
  s_add_u32 s37, s35, 195360
  s_add_u32 s38, s35, 390720
  s_add_u32 s39, s35, 586080
  s_add_u32 s40, s35, 781440
  s_add_u32 s41, s35, 981120
  s_add_u32 s42, s35, 1176480
  s_add_u32 s43, s35, 1371840
  s_add_u32 s44, s35, 1567200
  s_cmp_eq_u32 s64, 0
  s_cselect_b64 s[52:53], s[48:49], 0
  s_cmp_eq_u32 s64, 72
  s_cselect_b64 s[52:53], s[50:51], s[52:53]
  s_add_u32 s31, s31, 1
  s_mov_b32 s33, s35
  v_cndmask_b32 v242, v21, 2.0, s[52:53]
  s_mov_b32 m0, s58
  s_nop 0
  buffer_load_dwordx4 v242, s[4:7], s36 offen lds
  s_mov_b32 m0, s58
  s_nop 0
  buffer_load_dwordx4 v242, s[4:7], s37 offen offset:864 lds
  s_mov_b32 m0, s58
  s_nop 0
  buffer_load_dwordx4 v242, s[4:7], s38 offen offset:1728 lds
  s_mov_b32 m0, s58
  s_nop 0
  buffer_load_dwordx4 v242, s[4:7], s39 offen offset:2592 lds
  s_waitcnt vmcnt(9)
  ds_read_b64 v[106:107], v241
  ds_read_b128 v[230:233], v239
  s_mov_b32 m0, s58
  ds_read_b128 v[234:237], v239 offset:288
  ds_read_b128 v[222:225], v239 offset:576
  ds_read_b128 v[226:229], v240
  ds_read_b64 v[110:111], v241 offset:32
  ds_read_b128 v[126:129], v239 offset:32
  s_waitcnt lgkmcnt(6)
  v_mfma_f32_16x16x16_bf16 v[62:65], a[224:225], v[106:107], 0
  ds_read_b128 v[130:133], v239 offset:320
  ds_read_b128 v[134:137], v239 offset:608
  ds_read_b128 v[138:141], v240 offset:32
  ds_read_b64 v[106:107], v241 offset:64
  ds_read_b128 v[142:145], v239 offset:64
  s_waitcnt lgkmcnt(6)
  v_mfma_f32_16x16x16_bf16 v[66:69], a[234:235], v[110:111], 0
  ds_read_b128 v[146:149], v239 offset:352
  ds_read_b128 v[150:153], v239 offset:640
  ds_read_b128 v[154:157], v240 offset:64
  s_waitcnt lgkmcnt(4)
  v_mfma_f32_16x16x16_bf16 v[70:73], a[244:245], v[106:107], 0
  v_smfmac_f32_16x16x64_bf16 v[62:65], a[216:219], v[230:237], v0
  v_smfmac_f32_16x16x64_bf16 v[62:65], a[220:223], v[222:229], v0
  v_smfmac_f32_16x16x64_bf16 v[66:69], a[226:229], v[126:133], v0
  v_smfmac_f32_16x16x64_bf16 v[66:69], a[230:233], v[134:141], v0
  s_waitcnt lgkmcnt(2)
  buffer_load_dwordx4 v242, s[4:7], s40 offen offset:3456 lds
  v_smfmac_f32_16x16x64_bf16 v[70:73], a[236:239], v[142:149], v0
  s_waitcnt lgkmcnt(0)
  v_mul_f32 v124, v62, v62
  v_smfmac_f32_16x16x64_bf16 v[70:73], a[240:243], v[150:157], v0
  s_mov_b32 m0, s59
  v_add_f32 v108, v62, v63
  v_fmac_f32 v124, v63, v63
  v_add_f32 v108, v108, v64
  v_fmac_f32 v124, v64, v64
  v_add_f32 v108, v108, v65
  v_fmac_f32 v124, v65, v65
  v_add_f32 v108, v108, v66
  v_fmac_f32 v124, v66, v66
  v_add_f32 v108, v108, v67
  v_fmac_f32 v124, v67, v67
  v_add_f32 v108, v108, v68
  v_fmac_f32 v124, v68, v68
  v_add_f32 v108, v108, v69
  v_fmac_f32 v124, v69, v69
  v_add_f32 v108, v108, v70
  v_fmac_f32 v124, v70, v70
  v_add_f32 v108, v108, v71
  v_fmac_f32 v124, v71, v71
  v_add_f32 v108, v108, v72
  v_fmac_f32 v124, v72, v72
  v_add_f32 v108, v108, v73
  v_fmac_f32 v124, v73, v73
  s_nop 1
  v_permlane32_swap_b32 v108, v124
  v_add_f32 v108, v108, v124
  buffer_store_dwordx4 v[62:65], v15, s[12:15], s75 offen
  buffer_store_dwordx4 v[66:69], v15, s[12:15], s75 offen offset:1024
  buffer_load_dwordx4 v242, s[4:7], s41 offen lds
  s_mov_b32 m0, s59
  buffer_store_dwordx4 v[70:73], v15, s[12:15], s75 offen offset:2048
  buffer_load_dwordx4 v242, s[4:7], s42 offen offset:864 lds
  s_mov_b32 m0, s59
  s_nop 0
  buffer_load_dwordx4 v242, s[4:7], s43 offen offset:1728 lds
  s_mov_b32 m0, s59
  s_nop 0
  buffer_load_dwordx4 v242, s[4:7], s44 offen offset:2592 lds
  s_waitcnt vmcnt(12)
  ds_read_b64 v[106:107], v241 offset:13824
  ds_read_b64 v[110:111], v241 offset:13856
  s_lshl_b32 s60, s31, 5
  ds_read_b64 v[114:115], v241 offset:13888
  s_add_u32 s61, s60, s30
  s_add_u32 s60, s60, s29
  s_mul_i32 s62, s60, 7183
  ds_read_b128 v[150:153], v239 offset:13824
  s_lshr_b32 s62, s62, 22
  s_mul_i32 s63, s62, 584
  s_sub_u32 s63, s60, s63
  ds_read_b128 v[154:157], v239 offset:14112
  s_lshr_b32 s64, s63, 3
  s_and_b32 s65, s63, 7
  s_lshl_b32 s66, s62, 3
  ds_read_b128 v[142:145], v239 offset:14400
  s_add_u32 s65, s65, s66
  s_cmp_ge_u32 s60, 5256
  s_cselect_b32 s64, s63, s64
  ds_read_b128 v[146:149], v240 offset:13824
  s_cselect_b32 s65, 72, s65
  s_mul_i32 s66, s65, 1373568
  s_waitcnt lgkmcnt(6)
  v_mfma_f32_16x16x16_bf16 v[74:77], a[224:225], v[106:107], 0
  ds_read_b128 v[134:137], v239 offset:13856
  s_mul_i32 s67, s64, 2688
  s_waitcnt lgkmcnt(6)
  v_mfma_f32_16x16x16_bf16 v[78:81], a[234:235], v[110:111], 0
  ds_read_b128 v[138:141], v239 offset:14144
  s_add_u32 s35, s66, s67
  s_waitcnt lgkmcnt(6)
  v_mfma_f32_16x16x16_bf16 v[82:85], a[244:245], v[114:115], 0
  ds_read_b128 v[126:129], v239 offset:14432
  s_cmp_ge_u32 s61, 667
  s_cselect_b32 s35, 268435456, s35
  ds_read_b128 v[130:133], v240 offset:13856
  s_cmp_ge_u32 s60, 5329
  s_cselect_b32 s35, 268435456, s35
  s_waitcnt lgkmcnt(6)
  v_smfmac_f32_16x16x64_bf16 v[74:77], a[216:219], v[150:157], v0
  s_cmp_eq_u32 s65, 0
  ds_read_b128 v[150:153], v239 offset:13888
  s_cselect_b32 s36, 268435456, s35
  ds_read_b128 v[154:157], v239 offset:14176
  s_add_u32 s37, s35, 195360
  s_add_u32 s38, s35, 390720
  s_waitcnt lgkmcnt(6)
  v_smfmac_f32_16x16x64_bf16 v[74:77], a[220:223], v[142:149], v0
  s_add_u32 s39, s35, 586080
  ds_read_b128 v[142:145], v239 offset:14464
  s_add_u32 s40, s35, 781440
  ds_read_b128 v[146:149], v240 offset:13888
  s_add_u32 s41, s35, 981120
  s_add_u32 s42, s35, 1176480
  s_waitcnt lgkmcnt(6)
  v_smfmac_f32_16x16x64_bf16 v[78:81], a[226:229], v[134:141], v0
  s_add_u32 s43, s35, 1371840
  s_add_u32 s44, s35, 1567200
  s_cmp_eq_u32 s64, 0
  s_cselect_b64 s[52:53], s[48:49], 0
  s_cmp_eq_u32 s64, 72
  s_cselect_b64 s[52:53], s[50:51], s[52:53]
  s_waitcnt lgkmcnt(4)
  v_smfmac_f32_16x16x64_bf16 v[78:81], a[230:233], v[126:133], v0
  s_add_u32 s31, s31, 1
  s_mov_b32 s34, s35
  s_add_u32 m0, s81, 0
  s_mov_b32 s98, 0
  buffer_load_dwordx4 v243, s[16:19], s98 offen lds
  s_waitcnt lgkmcnt(2)
  v_smfmac_f32_16x16x64_bf16 v[82:85], a[236:239], v[150:157], v0
  v_mul_f32 v242, v74, v74
  v_add_f32 v124, v74, v75
  v_fmac_f32 v242, v75, v75
  v_add_f32 v124, v124, v76
  s_waitcnt lgkmcnt(0)
  v_smfmac_f32_16x16x64_bf16 v[82:85], a[240:243], v[142:149], v0
  v_fmac_f32 v242, v76, v76
  v_add_f32 v124, v124, v77
  v_fmac_f32 v242, v77, v77
  v_add_f32 v124, v124, v78
  v_fmac_f32 v242, v78, v78
  v_add_f32 v124, v124, v79
  v_fmac_f32 v242, v79, v79
  v_add_f32 v124, v124, v80
  v_fmac_f32 v242, v80, v80
  v_add_f32 v124, v124, v81
  v_fmac_f32 v242, v81, v81
  v_add_f32 v124, v124, v82
  v_fmac_f32 v242, v82, v82
  v_add_f32 v124, v124, v83
  v_fmac_f32 v242, v83, v83
  v_add_f32 v124, v124, v84
  v_fmac_f32 v242, v84, v84
  v_add_f32 v124, v124, v85
  v_fmac_f32 v242, v85, v85
  v_cndmask_b32 v116, v21, 2.0, s[52:53]
  s_nop 0
  v_permlane32_swap_b32 v124, v242
  buffer_load_dwordx4 v244, s[16:19], s98 offen offset:1024 lds
  v_add_f32 v124, v124, v242
  s_nop 1
  v_permlane16_swap_b32 v108, v124
  v_add_f32 v108, v108, v124
  ds_write_b32 v109, v108 offset:2048
  buffer_store_dwordx4 v[82:85], v15, s[12:15], s77 offen offset:1024
  s_waitcnt lgkmcnt(0)
  s_barrier
  ds_read_b128 v[142:145], v15 offset:2048
  ds_read_b128 v[146:149], v15 offset:3072
  buffer_store_dwordx4 v[78:81], v15, s[12:15], s77 offen
  s_waitcnt lgkmcnt(1)
  v_add_f32 v142, v142, v143
  v_add_f32 v144, v144, v145
  v_add_f32 v142, v142, v144
  s_waitcnt lgkmcnt(0)
  v_add_f32 v146, v146, v147
  v_add_f32 v148, v148, v149
  v_mul_f32 v143, 0x3baaaaab, v142
  v_add_f32 v146, v146, v148
  v_fma_f32 v146, -v143, v142, v146
  v_max_f32 v146, 0, v146
  v_add_f32 v146, 0x3afba882, v146
  v_rsq_f32 v146, v146
  s_nop 0
  v_mul_f32 v146, 0x40ca568a, v146
  v_mul_f32 v147, -v143, v146
  ds_write_b64 v113, v[146:147] offset:2048
  ds_read_b64 v[114:115], v117 offset:2816
  ds_read_b64 v[110:111], v117 offset:2944
  buffer_store_dwordx4 v[74:77], v15, s[12:15], s75 offen offset:3072
  s_waitcnt lgkmcnt(1)
  v_fma_f32 v146, v62, v114, v115
  v_fma_f32 v108, v63, v114, v115
  v_cvt_pk_bf16_f32 v146, v146, v108
  v_fma_f32 v147, v64, v114, v115
  v_fma_f32 v108, v65, v114, v115
  v_cvt_pk_bf16_f32 v147, v147, v108
  buffer_load_dwordx4 v245, s[16:19], s98 offen offset:2048 lds
  s_add_u32 m0, s81, 3072
  s_mov_b32 s98, 36864
  v_fma_f32 v148, v66, v114, v115
  v_fma_f32 v108, v67, v114, v115
  v_cvt_pk_bf16_f32 v148, v148, v108
  v_fma_f32 v149, v68, v114, v115
  v_fma_f32 v108, v69, v114, v115
  v_cvt_pk_bf16_f32 v149, v149, v108
  s_waitcnt lgkmcnt(0)
  v_fma_f32 v142, v74, v110, v111
  v_fma_f32 v108, v75, v110, v111
  v_cvt_pk_bf16_f32 v142, v142, v108
  v_fma_f32 v143, v76, v110, v111
  v_fma_f32 v108, v77, v110, v111
  v_cvt_pk_bf16_f32 v143, v143, v108
  v_fma_f32 v144, v78, v110, v111
  v_fma_f32 v108, v79, v110, v111
  v_cvt_pk_bf16_f32 v144, v144, v108
  v_fma_f32 v145, v80, v110, v111
  v_fma_f32 v108, v81, v110, v111
  v_cvt_pk_bf16_f32 v145, v145, v108
  ds_write_b128 v16, v[146:149] offset:8192
  v_fma_f32 v106, v70, v114, v115
  ds_write_b128 v16, v[142:145] offset:14336
  v_fma_f32 v108, v71, v114, v115
  v_cvt_pk_bf16_f32 v106, v106, v108
  v_fma_f32 v107, v72, v114, v115
  v_fma_f32 v108, v73, v114, v115
  v_cvt_pk_bf16_f32 v107, v107, v108
  v_fma_f32 v114, v82, v110, v111
  v_fma_f32 v108, v83, v110, v111
  v_cvt_pk_bf16_f32 v114, v114, v108
  v_fma_f32 v115, v84, v110, v111
  v_fma_f32 v108, v85, v110, v111
  v_cvt_pk_bf16_f32 v115, v115, v108
  ds_write_b64 v17, v[106:107] offset:8192
  buffer_load_dwordx4 v243, s[16:19], s98 offen lds
  ds_write_b64 v17, v[114:115] offset:14336
  s_waitcnt lgkmcnt(0)
  s_barrier
  buffer_load_dwordx4 v244, s[16:19], s98 offen offset:1024 lds
  buffer_load_dwordx4 v245, s[16:19], s98 offen offset:2048 lds
  s_add_u32 m0, s81, 6144
  s_mov_b32 s98, 73728
  buffer_load_dwordx4 v243, s[16:19], s98 offen lds
  buffer_load_dwordx4 v244, s[16:19], s98 offen offset:1024 lds
  s_waitcnt vmcnt(11)
  ds_read_b64 v[114:115], v9
  ds_read_b64 v[106:107], v9 offset:32
  ds_read_b64 v[110:111], v9 offset:64
  ds_read_b128 v[142:145], v3
  ds_read_b128 v[146:149], v3 offset:864
  buffer_load_dwordx4 v245, s[16:19], s98 offen offset:2048 lds
  s_add_u32 m0, s81, 9216
  s_mov_b32 s98, 110592
  ds_read_b128 v[150:153], v3 offset:1728
  ds_read_b128 v[154:157], v6
  s_waitcnt lgkmcnt(6)
  v_mfma_f32_16x16x16_bf16 v[26:29], a[224:225], v[114:115], 0
  ds_read_b128 v[126:129], v3 offset:32
  s_waitcnt lgkmcnt(6)
  v_mfma_f32_16x16x16_bf16 v[30:33], a[234:235], v[106:107], 0
  ds_read_b128 v[130:133], v3 offset:896
  s_waitcnt lgkmcnt(6)
  v_mfma_f32_16x16x16_bf16 v[34:37], a[244:245], v[110:111], 0
  ds_read_b128 v[134:137], v3 offset:1760
  buffer_load_dwordx4 v243, s[16:19], s98 offen lds
  ds_read_b128 v[138:141], v6 offset:32
  s_waitcnt lgkmcnt(6)
  v_smfmac_f32_16x16x64_bf16 v[26:29], a[216:219], v[142:149], v0
  ds_read_b128 v[142:145], v3 offset:64
  ds_read_b128 v[146:149], v3 offset:928
  s_waitcnt lgkmcnt(6)
  v_smfmac_f32_16x16x64_bf16 v[26:29], a[220:223], v[150:157], v0
  ds_read_b128 v[150:153], v3 offset:1792
  ds_read_b128 v[154:157], v6 offset:64
  s_waitcnt lgkmcnt(6)
  v_smfmac_f32_16x16x64_bf16 v[30:33], a[226:229], v[126:133], v0
  ds_read_b64 v[110:111], v10
  ds_read_b64 v[106:107], v10 offset:32
  s_nop 1
  v_mul_f32 v108, v26, v26
  v_add_f32 v124, v26, v27
  s_waitcnt lgkmcnt(6)
  v_smfmac_f32_16x16x64_bf16 v[30:33], a[230:233], v[134:141], v0
  ds_read_b64 v[114:115], v10 offset:64
  ds_read_b128 v[134:137], v4
  v_fmac_f32 v108, v27, v27
  v_add_f32 v124, v124, v28
  s_waitcnt lgkmcnt(6)
  v_smfmac_f32_16x16x64_bf16 v[34:37], a[236:239], v[142:149], v0
  ds_read_b128 v[138:141], v4 offset:864
  ds_read_b128 v[142:145], v4 offset:1728
  v_fmac_f32 v108, v28, v28
  v_add_f32 v124, v124, v29
  s_waitcnt lgkmcnt(6)
  v_smfmac_f32_16x16x64_bf16 v[34:37], a[240:243], v[150:157], v0
  ds_read_b128 v[146:149], v7
  v_fmac_f32 v108, v29, v29
  s_waitcnt lgkmcnt(6)
  v_mfma_f32_16x16x16_bf16 v[38:41], a[224:225], v[110:111], 0
  ds_read_b128 v[150:153], v4 offset:32
  v_add_f32 v124, v124, v30
  s_waitcnt lgkmcnt(6)
  v_mfma_f32_16x16x16_bf16 v[42:45], a[234:235], v[106:107], 0
  ds_read_b128 v[154:157], v4 offset:896
  v_fmac_f32 v108, v30, v30
  s_waitcnt lgkmcnt(6)
  v_mfma_f32_16x16x16_bf16 v[46:49], a[244:245], v[114:115], 0
  ds_read_b128 v[126:129], v4 offset:1760
  ds_read_b128 v[130:133], v7 offset:32
  v_add_f32 v124, v124, v31
  v_fmac_f32 v108, v31, v31
  s_waitcnt lgkmcnt(6)
  v_smfmac_f32_16x16x64_bf16 v[38:41], a[216:219], v[134:141], v0
  ds_read_b128 v[134:137], v4 offset:64
  ds_read_b128 v[138:141], v4 offset:928
  v_add_f32 v124, v124, v32
  v_fmac_f32 v108, v32, v32
  s_waitcnt lgkmcnt(6)
  v_smfmac_f32_16x16x64_bf16 v[38:41], a[220:223], v[142:149], v0
  ds_read_b128 v[142:145], v4 offset:1792
  ds_read_b128 v[146:149], v7 offset:64
  v_add_f32 v124, v124, v33
  v_fmac_f32 v108, v33, v33
  s_waitcnt lgkmcnt(6)
  v_smfmac_f32_16x16x64_bf16 v[42:45], a[226:229], v[150:157], v0
  ds_read_b64 v[114:115], v11
  buffer_load_dwordx4 v244, s[16:19], s98 offen offset:1024 lds
  ds_read_b64 v[106:107], v11 offset:32
  s_waitcnt lgkmcnt(6)
  v_smfmac_f32_16x16x64_bf16 v[42:45], a[230:233], v[126:133], v0
  s_waitcnt vmcnt(8)
  ds_read_b64_tr_b16 a[0:1], v246
  ds_read_b64_tr_b16 a[24:25], v246 offset:32
  ds_read_b64_tr_b16 a[48:49], v246 offset:64
  s_waitcnt lgkmcnt(7)
  v_smfmac_f32_16x16x64_bf16 v[46:49], a[236:239], v[134:141], v0
  ds_read_b64_tr_b16 a[2:3], v246 offset:1536
  ds_read_b64_tr_b16 a[26:27], v246 offset:1568
  v_mul_f32 v242, v38, v38
  v_add_f32 v112, v38, v39
  s_waitcnt lgkmcnt(7)
  v_smfmac_f32_16x16x64_bf16 v[46:49], a[240:243], v[142:149], v0
  buffer_load_dwordx4 v245, s[16:19], s98 offen offset:2048 lds
  s_waitcnt lgkmcnt(6)
  v_mfma_f32_16x16x16_bf16 v[50:53], a[224:225], v[114:115], 0
  ds_read_b64_tr_b16 a[50:51], v246 offset:1600
  s_add_u32 m0, s81, 12288
  s_waitcnt lgkmcnt(6)
  v_mfma_f32_16x16x16_bf16 v[54:57], a[234:235], v[106:107], 0
  s_mov_b32 s98, 147456
  ds_read_b64 v[106:107], v11 offset:64
  ds_read_b128 v[142:145], v5
  ds_read_b128 v[146:149], v5 offset:864
  buffer_load_dwordx4 v243, s[16:19], s98 offen lds
  ds_read_b128 v[134:137], v5 offset:1728
  v_fmac_f32 v242, v39, v39
  ds_read_b128 v[138:141], v8
  v_add_f32 v112, v112, v40
  ds_read_b128 v[126:129], v5 offset:32
  v_fmac_f32 v242, v40, v40
  ds_read_b128 v[130:133], v5 offset:896
  v_add_f32 v112, v112, v41
  v_fmac_f32 v242, v41, v41
  s_waitcnt lgkmcnt(6)
  v_mfma_f32_16x16x16_bf16 v[58:61], a[244:245], v[106:107], 0
  buffer_load_dwordx4 v244, s[16:19], s98 offen offset:1024 lds
  ds_read_b128 v[150:153], v5 offset:1760
  ds_read_b128 v[154:157], v8 offset:32
  v_add_f32 v112, v112, v42
  v_fmac_f32 v242, v42, v42
  s_waitcnt lgkmcnt(6)
  v_smfmac_f32_16x16x64_bf16 v[50:53], a[216:219], v[142:149], v0
  s_waitcnt vmcnt(8)
  ds_read_b64_tr_b16 a[16:17], v246 offset:3072
  ds_read_b64_tr_b16 a[40:41], v246 offset:3104
  ds_read_b64_tr_b16 a[64:65], v246 offset:3136
  s_waitcnt lgkmcnt(7)
  v_smfmac_f32_16x16x64_bf16 v[50:53], a[220:223], v[134:141], v0
  buffer_load_dwordx4 v245, s[16:19], s98 offen offset:2048 lds
  ds_read_b64_tr_b16 a[4:5], v246 offset:4608
  ds_read_b64_tr_b16 a[28:29], v246 offset:4640
  s_add_u32 m0, s81, 15360
  s_waitcnt lgkmcnt(7)
  v_smfmac_f32_16x16x64_bf16 v[54:57], a[226:229], v[126:133], v0
  s_mov_b32 s98, 184320
  ds_read_b64_tr_b16 a[52:53], v246 offset:4672
  ds_read_b128 v[126:129], v5 offset:64
  ds_read_b128 v[130:133], v5 offset:928
  s_waitcnt lgkmcnt(8)
  v_smfmac_f32_16x16x64_bf16 v[54:57], a[230:233], v[150:157], v0
  ds_read_b128 v[150:153], v5 offset:1792
  buffer_load_dwordx4 v243, s[16:19], s98 offen lds
  ds_read_b128 v[154:157], v8 offset:64
  v_mul_f32 v106, v50, v50
  ds_read_b128 v[94:97], v15 offset:8192
  v_add_f32 v107, v50, v51
  ds_read_b128 v[90:93], v15 offset:9216
  v_fmac_f32 v106, v51, v51
  ds_read_b128 v[86:89], v15 offset:10240
  v_add_f32 v107, v107, v52
  buffer_load_dwordx4 v244, s[16:19], s98 offen offset:1024 lds
  ds_read_b128 v[82:85], v15 offset:11264
  s_waitcnt lgkmcnt(6)
  v_smfmac_f32_16x16x64_bf16 v[58:61], a[236:239], v[126:133], v0
  s_waitcnt vmcnt(8)
  ds_read_b64_tr_b16 a[6:7], v246 offset:6144
  ds_read_b64_tr_b16 a[30:31], v246 offset:6176
  ds_read_b64_tr_b16 a[54:55], v246 offset:6208
  s_waitcnt lgkmcnt(7)
  v_smfmac_f32_16x16x64_bf16 v[58:61], a[240:243], v[150:157], v0
  ds_read_b64_tr_b16 a[18:19], v246 offset:7680
  s_waitcnt lgkmcnt(7)
  v_mfma_f32_16x16x32_bf16 v[150:153], a[0:3], v[94:97], 0
  buffer_load_dwordx4 v245, s[16:19], s98 offen offset:2048 lds
  ds_read_b64_tr_b16 a[42:43], v246 offset:7712
  ds_read_b64_tr_b16 a[66:67], v246 offset:7744
  s_add_u32 m0, s81, 18432
  s_mov_b32 s98, 384
  ds_read_b128 v[78:81], v15 offset:12288
  ds_read_b128 v[74:77], v15 offset:13312
  v_fmac_f32 v106, v52, v52
  v_add_f32 v107, v107, v53
  v_fmac_f32 v106, v53, v53
  s_waitcnt lgkmcnt(7)
  v_mfma_f32_16x16x32_bf16 v[150:153], a[4:7], v[90:93], v[150:153]
  v_add_f32 v107, v107, v54
  buffer_load_dwordx4 v243, s[16:19], s98 offen lds
  v_fmac_f32 v106, v54, v54
  v_add_f32 v107, v107, v55
  v_fmac_f32 v106, v55, v55
  v_add_f32 v112, v112, v43
  v_fmac_f32 v242, v43, v43
  v_add_f32 v107, v107, v56
  v_fmac_f32 v106, v56, v56
  v_add_f32 v112, v112, v44
  v_fmac_f32 v242, v44, v44
  v_add_f32 v107, v107, v57
  v_fmac_f32 v106, v57, v57
  v_add_f32 v112, v112, v45
  v_fmac_f32 v242, v45, v45
  v_add_f32 v107, v107, v58
  buffer_load_dwordx4 v244, s[16:19], s98 offen offset:1024 lds
  s_waitcnt vmcnt(8)
  ds_read_b64_tr_b16 a[8:9], v246 offset:9216
  ds_read_b64_tr_b16 a[10:11], v246 offset:10752
  ds_read_b64_tr_b16 a[32:33], v246 offset:9248
  ds_read_b64_tr_b16 a[34:35], v246 offset:10784
  ds_read_b64_tr_b16 a[56:57], v246 offset:9280
  ds_read_b64_tr_b16 a[58:59], v246 offset:10816
  v_fmac_f32 v106, v58, v58
  v_add_f32 v124, v124, v34
  buffer_load_dwordx4 v245, s[16:19], s98 offen offset:2048 lds
  s_add_u32 m0, s81, 21504
  s_mov_b32 s98, 37248
  v_fmac_f32 v108, v34, v34
  v_add_f32 v112, v112, v46
  v_fmac_f32 v242, v46, v46
  v_add_f32 v107, v107, v59
  v_fmac_f32 v106, v59, v59
  s_waitcnt lgkmcnt(4)
  v_mfma_f32_16x16x32_bf16 v[150:153], a[8:11], v[86:89], v[150:153]
  v_add_f32 v124, v124, v35
  v_fmac_f32 v108, v35, v35
  v_add_f32 v112, v112, v47
  v_fmac_f32 v242, v47, v47
  buffer_load_dwordx4 v243, s[16:19], s98 offen lds
  v_add_f32 v107, v107, v60
  v_fmac_f32 v106, v60, v60
  v_add_f32 v124, v124, v36
  v_fmac_f32 v108, v36, v36
  v_add_f32 v112, v112, v48
  v_fmac_f32 v242, v48, v48
  v_add_f32 v107, v107, v61
  v_fmac_f32 v106, v61, v61
  v_add_f32 v124, v124, v37
  v_fmac_f32 v108, v37, v37
  v_add_f32 v112, v112, v49
  v_fmac_f32 v242, v49, v49
  v_permlane32_swap_b32 v107, v106
  buffer_load_dwordx4 v244, s[16:19], s98 offen offset:1024 lds
  s_waitcnt vmcnt(8)
  ds_read_b64_tr_b16 a[12:13], v246 offset:13824
  ds_read_b64_tr_b16 a[20:21], v246 offset:12288
  ds_read_b64_tr_b16 a[36:37], v246 offset:13856
  ds_read_b64_tr_b16 a[44:45], v246 offset:12320
  ds_read_b64_tr_b16 a[60:61], v246 offset:13888
  ds_read_b64_tr_b16 a[68:69], v246 offset:12352
  v_permlane32_swap_b32 v124, v108
  buffer_load_dwordx4 v245, s[16:19], s98 offen offset:2048 lds
  s_add_u32 m0, s81, 24576
  s_mov_b32 s98, 74112
  v_permlane32_swap_b32 v112, v242
  v_add_f32 v107, v107, v106
  v_add_f32 v124, v124, v108
  v_add_f32 v112, v112, v242
  v_mov_b32 v106, v107
  s_nop 0
  v_permlane16_swap_b32 v124, v112
  v_permlane16_swap_b32 v107, v106
  v_add_f32 v124, v124, v112
  buffer_load_dwordx4 v243, s[16:19], s98 offen lds
  v_add_f32 v107, v107, v106
  ds_write_b32 v109, v124
  ds_write_b32 v109, v107 offset:512
  buffer_load_dwordx4 v244, s[16:19], s98 offen offset:1024 lds
  s_waitcnt vmcnt(8)
  ds_read_b64_tr_b16 a[14:15], v246 offset:15360
  ds_read_b64_tr_b16 a[22:23], v246 offset:16896
  ds_read_b64_tr_b16 a[38:39], v246 offset:15392
  ds_read_b64_tr_b16 a[46:47], v246 offset:16928
  ds_read_b64_tr_b16 a[62:63], v246 offset:15424
  ds_read_b64_tr_b16 a[70:71], v246 offset:16960
  buffer_load_dwordx4 v245, s[16:19], s98 offen offset:2048 lds
  s_add_u32 m0, s81, 0
  s_mov_b32 s98, 110976
  s_waitcnt lgkmcnt(5)
  v_mfma_f32_16x16x32_bf16 v[150:153], a[12:15], v[82:85], v[150:153]
  v_mfma_f32_16x16x32_bf16 v[150:153], a[16:19], v[78:81], v[150:153]
  s_waitcnt lgkmcnt(4)
  v_mfma_f32_16x16x32_bf16 v[150:153], a[20:23], v[74:77], v[150:153]
  v_mfma_f32_16x16x32_bf16 v[154:157], a[24:27], v[94:97], 0
  buffer_load_dwordx4 v243, s[16:19], s98 offen lds
  v_mfma_f32_16x16x32_bf16 v[154:157], a[28:31], v[90:93], v[154:157]
  ds_read_b128 v[70:73], v15 offset:14336
  ds_read_b128 v[66:69], v15 offset:15360
  v_mfma_f32_16x16x32_bf16 v[154:157], a[32:35], v[86:89], v[154:157]
  s_waitcnt lgkmcnt(5)
  ds_read_b128 v[62:65], v15 offset:16384
  v_cvt_pk_bf16_f32 v126, v150, v151
  v_mfma_f32_16x16x32_bf16 v[154:157], a[36:39], v[82:85], v[154:157]
  ds_read_b128 v[130:133], v15 offset:17408
  v_cvt_pk_bf16_f32 v127, v152, v153
  v_mfma_f32_16x16x32_bf16 v[154:157], a[40:43], v[78:81], v[154:157]
  s_waitcnt vmcnt(7) lgkmcnt(6)
  buffer_load_dwordx4 v244, s[16:19], s98 offen offset:1024 lds
  v_mfma_f32_16x16x32_bf16 v[154:157], a[44:47], v[74:77], v[154:157]
  ds_read_b64_tr_b16 a[72:73], v246 offset:18432
  ds_read_b64_tr_b16 a[74:75], v246 offset:19968
  v_mfma_f32_16x16x32_bf16 v[150:153], a[48:51], v[94:97], 0
  ds_read_b64_tr_b16 a[96:97], v246 offset:18464
  ds_read_b64_tr_b16 a[98:99], v246 offset:20000
  v_mfma_f32_16x16x32_bf16 v[150:153], a[52:55], v[90:93], v[150:153]
  ds_read_b64_tr_b16 a[120:121], v246 offset:18496
  v_cvt_pk_bf16_f32 v128, v154, v155
  v_mfma_f32_16x16x32_bf16 v[150:153], a[56:59], v[86:89], v[150:153]
  s_waitcnt lgkmcnt(10)
  ds_read_b64_tr_b16 a[122:123], v246 offset:20032
  ds_read_b128 v[134:137], v15 offset:18432
  v_mfma_f32_16x16x32_bf16 v[150:153], a[60:63], v[82:85], v[150:153]
  buffer_load_dwordx4 v245, s[16:19], s98 offen offset:2048 lds
  v_mfma_f32_16x16x32_bf16 v[150:153], a[64:67], v[78:81], v[150:153]
  s_waitcnt lgkmcnt(11)
  ds_read_b128 v[138:141], v15 offset:19456
  v_cvt_pk_bf16_f32 v129, v156, v157
  v_mfma_f32_16x16x32_bf16 v[150:153], a[68:71], v[74:77], v[150:153]
  s_waitcnt lgkmcnt(8)
  s_add_u32 m0, s81, 3072
  s_mov_b32 s98, 147840
  buffer_load_dwordx4 v243, s[16:19], s98 offen lds
  s_nop 3
  v_cvt_pk_bf16_f32 v106, v150, v151
  v_cvt_pk_bf16_f32 v107, v152, v153
  s_waitcnt lgkmcnt(0)
  s_barrier
  v_mfma_f32_16x16x32_bf16 v[150:153], a[0:3], v[70:73], 0
  ds_read_b128 v[154:157], v15
  ds_read_b128 v[142:145], v15 offset:1024
  v_mfma_f32_16x16x32_bf16 v[150:153], a[4:7], v[66:69], v[150:153]
  s_waitcnt vmcnt(7)
  buffer_load_dwordx4 v244, s[16:19], s98 offen offset:1024 lds
  v_mfma_f32_16x16x32_bf16 v[150:153], a[8:11], v[62:65], v[150:153]
  ds_read_b64_tr_b16 a[76:77], v246 offset:23040
  ds_read_b64_tr_b16 a[88:89], v246 offset:21504
  v_mfma_f32_16x16x32_bf16 v[150:153], a[12:15], v[130:133], v[150:153]
  ds_read_b64_tr_b16 a[100:101], v246 offset:23072
  ds_read_b64_tr_b16 a[112:113], v246 offset:21536
  v_mfma_f32_16x16x32_bf16 v[150:153], a[16:19], v[134:137], v[150:153]
  ds_read_b64_tr_b16 a[124:125], v246 offset:23104
  v_mfma_f32_16x16x32_bf16 v[150:153], a[20:23], v[138:141], v[150:153]
  buffer_load_dwordx4 v245, s[16:19], s98 offen offset:2048 lds
  v_mfma_f32_16x16x32_bf16 v[146:149], a[24:27], v[70:73], 0
  s_waitcnt lgkmcnt(6)
  ds_read_b64_tr_b16 a[136:137], v246 offset:21568
  v_add_f32 v154, v154, v155
  v_mfma_f32_16x16x32_bf16 v[146:149], a[28:31], v[66:69], v[146:149]
  s_waitcnt lgkmcnt(6)
  v_add_f32 v156, v156, v157
  v_add_f32 v142, v142, v143
  v_mfma_f32_16x16x32_bf16 v[146:149], a[32:35], v[62:65], v[146:149]
  s_add_u32 m0, s81, 6144
  v_add_f32 v144, v144, v145
  v_add_f32 v154, v154, v156
  v_mfma_f32_16x16x32_bf16 v[146:149], a[36:39], v[130:133], v[146:149]
  s_mov_b32 s98, 184704
  v_add_f32 v142, v142, v144
  v_mul_f32 v155, 0x3baaaaab, v154
  v_mfma_f32_16x16x32_bf16 v[146:149], a[40:43], v[134:137], v[146:149]
  buffer_load_dwordx4 v243, s[16:19], s98 offen lds
  v_mfma_f32_16x16x32_bf16 v[146:149], a[44:47], v[138:141], v[146:149]
  v_fma_f32 v142, -v155, v154, v142
  v_max_f32 v142, 0, v142
  v_mfma_f32_16x16x32_bf16 v[158:161], a[48:51], v[70:73], 0
  v_add_f32 v142, 0x3afba882, v142
  v_cvt_pk_bf16_f32 v162, v150, v151
  v_mfma_f32_16x16x32_bf16 v[158:161], a[52:55], v[66:69], v[158:161]
  v_rsq_f32 v142, v142
  v_mfma_f32_16x16x32_bf16 v[158:161], a[56:59], v[62:65], v[158:161]
  s_waitcnt vmcnt(7)
  buffer_load_dwordx4 v244, s[16:19], s98 offen offset:1024 lds
  v_mfma_f32_16x16x32_bf16 v[158:161], a[60:63], v[130:133], v[158:161]
  ds_read_b64_tr_b16 a[78:79], v246 offset:24576
  ds_read_b64_tr_b16 a[90:91], v246 offset:26112
  v_mfma_f32_16x16x32_bf16 v[158:161], a[64:67], v[134:137], v[158:161]
  ds_read_b64_tr_b16 a[102:103], v246 offset:24608
  ds_read_b64_tr_b16 a[114:115], v246 offset:26144
  v_mfma_f32_16x16x32_bf16 v[158:161], a[68:71], v[138:141], v[158:161]
  ds_read_b64_tr_b16 a[126:127], v246 offset:24640
  v_cvt_pk_bf16_f32 v163, v152, v153
  v_mfma_f32_16x16x32_bf16 v[150:153], a[72:75], v[94:97], 0
  s_waitcnt lgkmcnt(10)
  ds_read_b64_tr_b16 a[138:139], v246 offset:26176
  buffer_load_dwordx4 v245, s[16:19], s98 offen offset:2048 lds
  s_add_u32 m0, s81, 9216
  v_mul_f32 v142, 0x40ca568a, v142
  s_mov_b32 s98, 768
  v_mul_f32 v143, -v155, v142
  v_cvt_pk_bf16_f32 v164, v146, v147
  v_cvt_pk_bf16_f32 v165, v148, v149
  s_waitcnt lgkmcnt(5)
  v_mfma_f32_16x16x32_bf16 v[150:153], a[76:79], v[90:93], v[150:153]
  ds_write_b64 v113, v[142:143]
  ds_read_b64 v[114:115], v117 offset:768
  ds_read_b64 v[110:111], v117 offset:896
  ds_read_b64 v[118:119], v117 offset:1792
  buffer_load_dwordx4 v243, s[16:19], s98 offen lds
  v_cvt_pk_bf16_f32 v122, v158, v159
  v_cvt_pk_bf16_f32 v123, v160, v161
  buffer_load_dwordx4 v244, s[16:19], s98 offen offset:1024 lds
  s_waitcnt vmcnt(8)
  ds_read_b64_tr_b16 a[80:81], v246
  ds_read_b64_tr_b16 a[82:83], v246 offset:1536
  ds_read_b64_tr_b16 a[104:105], v246 offset:32
  ds_read_b64_tr_b16 a[106:107], v246 offset:1568
  ds_read_b64_tr_b16 a[128:129], v246 offset:64
  ds_read_b64_tr_b16 a[130:131], v246 offset:1600
  s_waitcnt lgkmcnt(8)
  v_fma_f32 v158, v26, v114, v115
  buffer_load_dwordx4 v245, s[16:19], s98 offen offset:2048 lds
  s_add_u32 m0, s81, 12288
  s_mov_b32 s98, 37632
  v_fma_f32 v242, v27, v114, v115
  v_cvt_pk_bf16_f32 v158, v158, v242
  v_fma_f32 v159, v28, v114, v115
  v_fma_f32 v242, v29, v114, v115
  v_cvt_pk_bf16_f32 v159, v159, v242
  s_waitcnt lgkmcnt(4)
  v_mfma_f32_16x16x32_bf16 v[150:153], a[80:83], v[86:89], v[150:153]
  v_fma_f32 v160, v30, v114, v115
  v_fma_f32 v242, v31, v114, v115
  v_cvt_pk_bf16_f32 v160, v160, v242
  v_fma_f32 v161, v32, v114, v115
  buffer_load_dwordx4 v243, s[16:19], s98 offen lds
  v_fma_f32 v242, v33, v114, v115
  v_cvt_pk_bf16_f32 v161, v161, v242
  v_fma_f32 v142, v38, v110, v111
  v_fma_f32 v242, v39, v110, v111
  v_cvt_pk_bf16_f32 v142, v142, v242
  v_fma_f32 v143, v40, v110, v111
  v_fma_f32 v242, v41, v110, v111
  v_cvt_pk_bf16_f32 v143, v143, v242
  v_fma_f32 v144, v42, v110, v111
  v_fma_f32 v242, v43, v110, v111
  v_cvt_pk_bf16_f32 v144, v144, v242
  v_fma_f32 v145, v44, v110, v111
  v_fma_f32 v242, v45, v110, v111
  v_cvt_pk_bf16_f32 v145, v145, v242
  buffer_load_dwordx4 v244, s[16:19], s98 offen offset:1024 lds
  s_waitcnt vmcnt(8)
  ds_read_b64_tr_b16 a[84:85], v246 offset:4608
  ds_read_b64_tr_b16 a[92:93], v246 offset:3072
  ds_read_b64_tr_b16 a[108:109], v246 offset:4640
  ds_read_b64_tr_b16 a[116:117], v246 offset:3104
  ds_read_b64_tr_b16 a[132:133], v246 offset:4672
  ds_read_b64_tr_b16 a[140:141], v246 offset:3136
  v_fma_f32 v146, v50, v118, v119
  v_fma_f32 v242, v51, v118, v119
  buffer_load_dwordx4 v245, s[16:19], s98 offen offset:2048 lds
  s_add_u32 m0, s81, 15360
  s_mov_b32 s98, 74496
  v_cvt_pk_bf16_f32 v146, v146, v242
  v_fma_f32 v147, v52, v118, v119
  v_fma_f32 v242, v53, v118, v119
  v_cvt_pk_bf16_f32 v147, v147, v242
  v_fma_f32 v148, v54, v118, v119
  v_fma_f32 v242, v55, v118, v119
  v_cvt_pk_bf16_f32 v148, v148, v242
  v_fma_f32 v149, v56, v118, v119
  v_fma_f32 v242, v57, v118, v119
  v_cvt_pk_bf16_f32 v149, v149, v242
  ds_write_b128 v16, v[158:161] offset:2048
  buffer_load_dwordx4 v243, s[16:19], s98 offen lds
  ds_write_b128 v16, v[142:145] offset:8192
  v_fma_f32 v142, v34, v114, v115
  v_fma_f32 v242, v35, v114, v115
  v_cvt_pk_bf16_f32 v142, v142, v242
  v_fma_f32 v143, v36, v114, v115
  v_fma_f32 v242, v37, v114, v115
  buffer_load_dwordx4 v244, s[16:19], s98 offen offset:1024 lds
  s_waitcnt vmcnt(8)
  ds_read_b64_tr_b16 a[86:87], v246 offset:6144
  ds_read_b64_tr_b16 a[94:95], v246 offset:7680
  ds_read_b64_tr_b16 a[110:111], v246 offset:6176
  ds_read_b64_tr_b16 a[118:119], v246 offset:7712
  ds_read_b64_tr_b16 a[134:135], v246 offset:6208
  ds_read_b64_tr_b16 a[142:143], v246 offset:7744
  buffer_load_dwordx4 v245, s[16:19], s98 offen offset:2048 lds
  v_cvt_pk_bf16_f32 v143, v143, v242
  s_add_u32 m0, s81, 18432
  v_fma_f32 v144, v46, v110, v111
  v_fma_f32 v242, v47, v110, v111
  v_cvt_pk_bf16_f32 v144, v144, v242
  v_fma_f32 v145, v48, v110, v111
  v_fma_f32 v242, v49, v110, v111
  s_waitcnt lgkmcnt(5)
  v_mfma_f32_16x16x32_bf16 v[150:153], a[84:87], v[82:85], v[150:153]
  s_mov_b32 s98, 111360
  ds_write_b128 v16, v[146:149] offset:14336
  v_mfma_f32_16x16x32_bf16 v[150:153], a[88:91], v[78:81], v[150:153]
  s_waitcnt lgkmcnt(5)
  buffer_load_dwordx4 v243, s[16:19], s98 offen lds
  v_mfma_f32_16x16x32_bf16 v[150:153], a[92:95], v[74:77], v[150:153]
  ds_write_b64 v17, v[142:143] offset:2048
  v_mfma_f32_16x16x32_bf16 v[146:149], a[96:99], v[94:97], 0
  v_cvt_pk_bf16_f32 v145, v145, v242
  v_fma_f32 v110, v58, v118, v119
  v_mfma_f32_16x16x32_bf16 v[146:149], a[100:103], v[90:93], v[146:149]
  ds_write_b64 v17, v[144:145] offset:8192
  v_mfma_f32_16x16x32_bf16 v[146:149], a[104:107], v[86:89], v[146:149]
  s_waitcnt vmcnt(7) lgkmcnt(6)
  buffer_load_dwordx4 v244, s[16:19], s98 offen offset:1024 lds
  v_mfma_f32_16x16x32_bf16 v[146:149], a[108:111], v[82:85], v[146:149]
  ds_read_b64_tr_b16 a[144:145], v246 offset:9216
  ds_read_b64_tr_b16 a[168:169], v246 offset:9248
  v_mfma_f32_16x16x32_bf16 v[146:149], a[112:115], v[78:81], v[146:149]
  s_waitcnt lgkmcnt(7)
  ds_read_b64_tr_b16 a[192:193], v246 offset:9280
  ds_read_b64_tr_b16 a[146:147], v246 offset:10752
  v_mfma_f32_16x16x32_bf16 v[146:149], a[116:119], v[74:77], v[146:149]
  ds_read_b64_tr_b16 a[170:171], v246 offset:10784
  v_fma_f32 v242, v59, v118, v119
  v_mfma_f32_16x16x32_bf16 v[142:145], a[120:123], v[94:97], 0
  ds_read_b64_tr_b16 a[194:195], v246 offset:10816
  v_cvt_pk_bf16_f32 v110, v110, v242
  v_mfma_f32_16x16x32_bf16 v[142:145], a[124:127], v[90:93], v[142:145]
  buffer_load_dwordx4 v245, s[16:19], s98 offen offset:2048 lds
  v_mfma_f32_16x16x32_bf16 v[142:145], a[128:131], v[86:89], v[142:145]
  s_waitcnt lgkmcnt(10)
  v_fma_f32 v111, v60, v118, v119
  v_fma_f32 v242, v61, v118, v119
  v_mfma_f32_16x16x32_bf16 v[142:145], a[132:135], v[82:85], v[142:145]
  s_add_u32 m0, s81, 21504
  v_cvt_pk_bf16_f32 v111, v111, v242
  v_cvt_pk_bf16_f32 v158, v150, v151
  v_mfma_f32_16x16x32_bf16 v[142:145], a[136:139], v[78:81], v[142:145]
  s_waitcnt lgkmcnt(9)
  ds_write_b64 v17, v[110:111] offset:14336
  v_mfma_f32_16x16x32_bf16 v[142:145], a[140:143], v[74:77], v[142:145]
  s_waitcnt lgkmcnt(7)
  s_mov_b32 s98, 148224
  buffer_load_dwordx4 v243, s[16:19], s98 offen lds
  v_cvt_pk_bf16_f32 v159, v152, v153
  v_cvt_pk_bf16_f32 v160, v146, v147
  v_cvt_pk_bf16_f32 v161, v148, v149
  s_nop 1
  v_cvt_pk_bf16_f32 v110, v142, v143
  v_cvt_pk_bf16_f32 v111, v144, v145
  buffer_load_dwordx4 v244, s[16:19], s98 offen offset:1024 lds
  s_waitcnt lgkmcnt(0)
  s_barrier
  v_mfma_f32_16x16x32_bf16 v[142:145], a[72:75], v[70:73], 0
  s_waitcnt vmcnt(8)
  ds_read_b64_tr_b16 a[160:161], v246 offset:12288
  ds_read_b64_tr_b16 a[184:185], v246 offset:12320
  v_mfma_f32_16x16x32_bf16 v[142:145], a[76:79], v[66:69], v[142:145]
  ds_read_b64_tr_b16 a[208:209], v246 offset:12352
  ds_read_b64_tr_b16 a[148:149], v246 offset:13824
  v_mfma_f32_16x16x32_bf16 v[142:145], a[80:83], v[62:65], v[142:145]
  ds_read_b64_tr_b16 a[172:173], v246 offset:13856
  v_mfma_f32_16x16x32_bf16 v[142:145], a[84:87], v[130:133], v[142:145]
  buffer_load_dwordx4 v245, s[16:19], s98 offen offset:2048 lds
  v_mfma_f32_16x16x32_bf16 v[142:145], a[88:91], v[134:137], v[142:145]
  s_add_u32 m0, s81, 24576
  ds_read_b64_tr_b16 a[196:197], v246 offset:13888
  v_mfma_f32_16x16x32_bf16 v[142:145], a[92:95], v[138:141], v[142:145]
  s_mov_b32 s98, 185088
  v_mfma_f32_16x16x32_bf16 v[146:149], a[96:99], v[70:73], 0
  v_mfma_f32_16x16x32_bf16 v[146:149], a[100:103], v[66:69], v[146:149]
  buffer_load_dwordx4 v243, s[16:19], s98 offen lds
  v_mfma_f32_16x16x32_bf16 v[146:149], a[104:107], v[62:65], v[146:149]
  ds_read_b128 v[150:153], v15 offset:2048
  ds_read_b128 v[154:157], v15 offset:3072
  v_mfma_f32_16x16x32_bf16 v[146:149], a[108:111], v[130:133], v[146:149]
  ds_read_b128 v[166:169], v15 offset:4096
  v_cvt_pk_bf16_f32 v170, v142, v143
  v_mfma_f32_16x16x32_bf16 v[146:149], a[112:115], v[134:137], v[146:149]
  ds_read_b128 v[174:177], v15 offset:5120
  v_cvt_pk_bf16_f32 v171, v144, v145
  v_mfma_f32_16x16x32_bf16 v[146:149], a[116:119], v[138:141], v[146:149]
  ds_read_b128 v[142:145], v15 offset:6144
  v_mfma_f32_16x16x32_bf16 v[178:181], a[120:123], v[70:73], 0
  s_waitcnt vmcnt(7)
  buffer_load_dwordx4 v244, s[16:19], s98 offen offset:1024 lds
  v_mfma_f32_16x16x32_bf16 v[178:181], a[124:127], v[66:69], v[178:181]
  ds_read_b64_tr_b16 a[150:151], v246 offset:15360
  ds_read_b64_tr_b16 a[174:175], v246 offset:15392
  v_mfma_f32_16x16x32_bf16 v[178:181], a[128:131], v[62:65], v[178:181]
  ds_read_b64_tr_b16 a[198:199], v246 offset:15424
  ds_read_b64_tr_b16 a[162:163], v246 offset:16896
  v_mfma_f32_16x16x32_bf16 v[178:181], a[132:135], v[130:133], v[178:181]
  ds_read_b64_tr_b16 a[186:187], v246 offset:16928
  v_cvt_pk_bf16_f32 v172, v146, v147
  v_mfma_f32_16x16x32_bf16 v[178:181], a[136:139], v[134:137], v[178:181]
  buffer_load_dwordx4 v245, s[16:19], s98 offen offset:2048 lds
  v_mfma_f32_16x16x32_bf16 v[178:181], a[140:143], v[138:141], v[178:181]
  s_waitcnt lgkmcnt(9)
  ds_read_b64_tr_b16 a[210:211], v246 offset:16960
  ds_read_b128 v[242:245], v15 offset:7168
  v_mfma_f32_16x16x32_bf16 v[182:185], a[0:3], v[150:153], 0
  s_waitcnt lgkmcnt(10)
  v_cvt_pk_bf16_f32 v173, v148, v149
  v_mfma_f32_16x16x32_bf16 v[182:185], a[4:7], v[154:157], v[182:185]
  s_waitcnt lgkmcnt(9)
  v_cvt_pk_bf16_f32 v118, v178, v179
  v_cvt_pk_bf16_f32 v119, v180, v181
  v_mfma_f32_16x16x32_bf16 v[182:185], a[8:11], v[166:169], v[182:185]
  s_waitcnt lgkmcnt(8)
  v_mfma_f32_16x16x32_bf16 v[182:185], a[12:15], v[174:177], v[182:185]
  s_waitcnt lgkmcnt(7)
  v_mfma_f32_16x16x32_bf16 v[182:185], a[16:19], v[142:145], v[182:185]
  s_mov_b32 m0, s58
  s_nop 0
  buffer_load_dwordx4 v116, s[4:7], s36 offen lds
  s_waitcnt lgkmcnt(0)
  v_mfma_f32_16x16x32_bf16 v[182:185], a[20:23], v[242:245], v[182:185]
  v_mfma_f32_16x16x32_bf16 v[146:149], a[24:27], v[150:153], 0
  s_waitcnt vmcnt(7)
  ds_read_b64_tr_b16 a[152:153], v246 offset:18432
  ds_read_b64_tr_b16 a[176:177], v246 offset:18464
  v_mfma_f32_16x16x32_bf16 v[146:149], a[28:31], v[154:157], v[146:149]
  ds_read_b64_tr_b16 a[200:201], v246 offset:18496
  ds_read_b64_tr_b16 a[154:155], v246 offset:19968
  v_mfma_f32_16x16x32_bf16 v[146:149], a[32:35], v[166:169], v[146:149]
  ds_read_b64_tr_b16 a[178:179], v246 offset:20000
  v_cvt_pk_bf16_f32 v178, v182, v183
  v_mfma_f32_16x16x32_bf16 v[146:149], a[36:39], v[174:177], v[146:149]
  ds_read_b64_tr_b16 a[202:203], v246 offset:20032
  v_cvt_pk_bf16_f32 v179, v184, v185
  v_mfma_f32_16x16x32_bf16 v[146:149], a[40:43], v[142:145], v[146:149]
  buffer_store_dwordx4 v[126:129], v15, s[12:15], s77 offen offset:3072
  v_mfma_f32_16x16x32_bf16 v[146:149], a[44:47], v[242:245], v[146:149]
  buffer_load_dwordx4 v116, s[4:7], s37 offen offset:864 lds
  v_mfma_f32_16x16x32_bf16 v[182:185], a[48:51], v[150:153], 0
  v_mfma_f32_16x16x32_bf16 v[182:185], a[52:55], v[154:157], v[182:185]
  v_cvt_pk_bf16_f32 v180, v146, v147
  v_cvt_pk_bf16_f32 v181, v148, v149
  v_mfma_f32_16x16x32_bf16 v[182:185], a[56:59], v[166:169], v[182:185]
  v_mfma_f32_16x16x32_bf16 v[182:185], a[60:63], v[174:177], v[182:185]
  v_mfma_f32_16x16x32_bf16 v[182:185], a[64:67], v[142:145], v[182:185]
  v_mfma_f32_16x16x32_bf16 v[182:185], a[68:71], v[242:245], v[182:185]
  v_mfma_f32_16x16x32_bf16 v[146:149], a[72:75], v[150:153], 0
  buffer_load_dwordx4 v116, s[4:7], s38 offen offset:1728 lds
  v_mfma_f32_16x16x32_bf16 v[146:149], a[76:79], v[154:157], v[146:149]
  s_waitcnt vmcnt(7)
  ds_read_b64_tr_b16 a[164:165], v246 offset:21504
  ds_read_b64_tr_b16 a[188:189], v246 offset:21536
  v_mfma_f32_16x16x32_bf16 v[146:149], a[80:83], v[166:169], v[146:149]
  ds_read_b64_tr_b16 a[212:213], v246 offset:21568
  ds_read_b64_tr_b16 a[156:157], v246 offset:23040
  v_mfma_f32_16x16x32_bf16 v[146:149], a[84:87], v[174:177], v[146:149]
  ds_read_b64_tr_b16 a[180:181], v246 offset:23072
  v_cvt_pk_bf16_f32 v114, v182, v183
  v_mfma_f32_16x16x32_bf16 v[146:149], a[88:91], v[142:145], v[146:149]
  ds_read_b64_tr_b16 a[204:205], v246 offset:23104
  v_cvt_pk_bf16_f32 v115, v184, v185
  v_mfma_f32_16x16x32_bf16 v[146:149], a[92:95], v[242:245], v[146:149]
  v_mfma_f32_16x16x32_bf16 v[182:185], a[96:99], v[150:153], 0
  buffer_store_dwordx2 v[106:107], v15, s[12:15], s78 offen
  v_mfma_f32_16x16x32_bf16 v[182:185], a[100:103], v[154:157], v[182:185]
  buffer_load_dwordx4 v116, s[4:7], s39 offen offset:2592 lds
  v_mfma_f32_16x16x32_bf16 v[182:185], a[104:107], v[166:169], v[182:185]
  v_cvt_pk_bf16_f32 v186, v146, v147
  v_cvt_pk_bf16_f32 v187, v148, v149
  v_mfma_f32_16x16x32_bf16 v[182:185], a[108:111], v[174:177], v[182:185]
  v_mfma_f32_16x16x32_bf16 v[182:185], a[112:115], v[142:145], v[182:185]
  v_mfma_f32_16x16x32_bf16 v[182:185], a[116:119], v[242:245], v[182:185]
  v_mfma_f32_16x16x32_bf16 v[146:149], a[120:123], v[150:153], 0
  v_mfma_f32_16x16x32_bf16 v[146:149], a[124:127], v[154:157], v[146:149]
  v_cvt_pk_bf16_f32 v188, v182, v183
  v_cvt_pk_bf16_f32 v189, v184, v185
  v_mfma_f32_16x16x32_bf16 v[146:149], a[128:131], v[166:169], v[146:149]
  s_waitcnt vmcnt(6)
  buffer_load_dwordx4 v116, s[4:7], s40 offen offset:3456 lds
  v_mfma_f32_16x16x32_bf16 v[146:149], a[132:135], v[174:177], v[146:149]
  s_mov_b32 m0, s59
  ds_read_b64_tr_b16 a[158:159], v246 offset:24576
  ds_read_b64_tr_b16 a[182:183], v246 offset:24608
  v_mfma_f32_16x16x32_bf16 v[146:149], a[136:139], v[142:145], v[146:149]
  ds_read_b64_tr_b16 a[206:207], v246 offset:24640
  ds_read_b64_tr_b16 a[166:167], v246 offset:26112
  v_mfma_f32_16x16x32_bf16 v[146:149], a[140:143], v[242:245], v[146:149]
  s_waitcnt lgkmcnt(4)
  ds_read_b64_tr_b16 a[190:191], v246 offset:26144
  ds_read_b64_tr_b16 a[214:215], v246 offset:26176
  s_nop 4
  v_cvt_pk_bf16_f32 v230, v146, v147
  v_cvt_pk_bf16_f32 v231, v148, v149
  buffer_load_dwordx4 v116, s[4:7], s41 offen lds
  s_waitcnt lgkmcnt(0)
  s_barrier
  v_mfma_f32_16x16x32_bf16 v[146:149], a[144:147], v[94:97], 0
  ds_write_b64 v249, v[126:127] offset:768
  v_mfma_f32_16x16x32_bf16 v[146:149], a[148:151], v[90:93], v[146:149]
  ds_write_b64 v249, v[128:129] offset:776
  v_mfma_f32_16x16x32_bf16 v[146:149], a[152:155], v[86:89], v[146:149]
  ds_write_b64 v249, v[106:107] offset:784
  v_mfma_f32_16x16x32_bf16 v[146:149], a[156:159], v[82:85], v[146:149]
  buffer_load_dwordx4 v116, s[4:7], s42 offen offset:864 lds
  v_mfma_f32_16x16x32_bf16 v[146:149], a[160:163], v[78:81], v[146:149]
  ds_write_b64 v250, v[162:163] offset:768
  v_mfma_f32_16x16x32_bf16 v[146:149], a[164:167], v[74:77], v[146:149]
  ds_write_b64 v250, v[164:165] offset:776
  v_mfma_f32_16x16x32_bf16 v[126:129], a[168:171], v[94:97], 0
  v_mfma_f32_16x16x32_bf16 v[126:129], a[172:175], v[90:93], v[126:129]
  ds_write_b64 v250, v[122:123] offset:784
  v_mfma_f32_16x16x32_bf16 v[126:129], a[176:179], v[86:89], v[126:129]
  ds_write_b64 v249, v[158:159]
  v_mfma_f32_16x16x32_bf16 v[126:129], a[180:183], v[82:85], v[126:129]
  buffer_load_dwordx4 v116, s[4:7], s43 offen offset:1728 lds
  v_mfma_f32_16x16x32_bf16 v[126:129], a[184:187], v[78:81], v[126:129]
  ds_write_b64 v249, v[160:161] offset:8
  v_mfma_f32_16x16x32_bf16 v[126:129], a[188:191], v[74:77], v[126:129]
  ds_write_b64 v249, v[110:111] offset:16
  v_mfma_f32_16x16x32_bf16 v[158:161], a[192:195], v[94:97], 0
  v_cvt_pk_bf16_f32 v182, v146, v147
  v_cvt_pk_bf16_f32 v183, v148, v149
  v_mfma_f32_16x16x32_bf16 v[158:161], a[196:199], v[90:93], v[158:161]
  ds_write_b64 v250, v[170:171]
  v_mfma_f32_16x16x32_bf16 v[158:161], a[200:203], v[86:89], v[158:161]
  ds_write_b64 v250, v[172:173] offset:8
  v_mfma_f32_16x16x32_bf16 v[158:161], a[204:207], v[82:85], v[158:161]
  buffer_load_dwordx4 v116, s[4:7], s44 offen offset:2592 lds
  v_mfma_f32_16x16x32_bf16 v[158:161], a[208:211], v[78:81], v[158:161]
  s_mov_b32 m0, s71
  ds_write_b64 v250, v[118:119] offset:16
  v_mfma_f32_16x16x32_bf16 v[158:161], a[212:215], v[74:77], v[158:161]
  s_mov_b32 s98, 0
  ds_write_b64 v247, v[182:183]
  v_mfma_f32_16x16x32_bf16 v[146:149], a[144:147], v[70:73], 0
  v_cvt_pk_bf16_f32 v184, v126, v127
  v_cvt_pk_bf16_f32 v185, v128, v129
  v_mfma_f32_16x16x32_bf16 v[146:149], a[148:151], v[66:69], v[146:149]
  ds_write_b64 v247, v[184:185] offset:32
  v_mfma_f32_16x16x32_bf16 v[146:149], a[152:155], v[62:65], v[146:149]
  buffer_store_dwordx4 v[162:165], v15, s[12:15], s78 offen offset:1024
  v_cvt_pk_bf16_f32 v118, v158, v159
  v_mfma_f32_16x16x32_bf16 v[146:149], a[156:159], v[130:133], v[146:149]
  v_cvt_pk_bf16_f32 v119, v160, v161
  v_mfma_f32_16x16x32_bf16 v[146:149], a[160:163], v[134:137], v[146:149]
  ds_write_b64 v247, v[118:119] offset:64
  v_mfma_f32_16x16x32_bf16 v[146:149], a[164:167], v[138:141], v[146:149]
  v_mfma_f32_16x16x32_bf16 v[126:129], a[168:171], v[70:73], 0
  v_mfma_f32_16x16x32_bf16 v[126:129], a[172:175], v[66:69], v[126:129]
  buffer_store_dwordx2 v[122:123], v15, s[12:15], s78 offen offset:2048
  v_cvt_pk_bf16_f32 v158, v146, v147
  v_mfma_f32_16x16x32_bf16 v[126:129], a[176:179], v[62:65], v[126:129]
  v_cvt_pk_bf16_f32 v159, v148, v149
  v_mfma_f32_16x16x32_bf16 v[126:129], a[180:183], v[130:133], v[126:129]
  ds_write_b64 v248, v[158:159]
  v_mfma_f32_16x16x32_bf16 v[126:129], a[184:187], v[134:137], v[126:129]
  v_mfma_f32_16x16x32_bf16 v[126:129], a[188:191], v[138:141], v[126:129]
  v_mfma_f32_16x16x32_bf16 v[146:149], a[192:195], v[70:73], 0
  v_mfma_f32_16x16x32_bf16 v[146:149], a[196:199], v[66:69], v[146:149]
  v_cvt_pk_bf16_f32 v160, v126, v127
  v_cvt_pk_bf16_f32 v161, v128, v129
  v_mfma_f32_16x16x32_bf16 v[146:149], a[200:203], v[62:65], v[146:149]
  ds_write_b64 v248, v[160:161] offset:32
  v_mfma_f32_16x16x32_bf16 v[146:149], a[204:207], v[130:133], v[146:149]
  v_mfma_f32_16x16x32_bf16 v[146:149], a[208:211], v[134:137], v[146:149]
  v_mfma_f32_16x16x32_bf16 v[146:149], a[212:215], v[138:141], v[146:149]
  v_mfma_f32_16x16x32_bf16 v[130:133], v[150:153], a[144:147], 0
  v_mfma_f32_16x16x32_bf16 v[130:133], v[154:157], a[148:151], v[130:133]
  v_cvt_pk_bf16_f32 v246, v146, v147
  v_cvt_pk_bf16_f32 v247, v148, v149
  v_mfma_f32_16x16x32_bf16 v[130:133], v[166:169], a[152:155], v[130:133]
  ds_write_b64 v248, v[246:247] offset:64
  v_mfma_f32_16x16x32_bf16 v[130:133], v[174:177], a[156:159], v[130:133]
  v_mfma_f32_16x16x32_bf16 v[130:133], v[142:145], a[160:163], v[130:133]
  buffer_load_dwordx4 v251, s[20:23], s98 offen lds
  v_mfma_f32_16x16x32_bf16 v[130:133], v[242:245], a[164:167], v[130:133]
  v_mfma_f32_16x16x32_bf16 v[138:141], v[150:153], a[168:171], 0
  v_mfma_f32_16x16x32_bf16 v[138:141], v[154:157], a[172:175], v[138:141]
  ds_read_b128 v[158:161], v15 offset:8192
  v_cvt_pk_bf16_f32 v162, v130, v131
  v_mfma_f32_16x16x32_bf16 v[138:141], v[166:169], a[176:179], v[138:141]
  ds_read_b128 v[182:185], v15 offset:9216
  v_cvt_pk_bf16_f32 v163, v132, v133
  v_mfma_f32_16x16x32_bf16 v[138:141], v[174:177], a[180:183], v[138:141]
  ds_read_b128 v[170:173], v15 offset:10240
  v_mfma_f32_16x16x32_bf16 v[138:141], v[142:145], a[184:187], v[138:141]
  ds_read_b128 v[190:193], v15 offset:11264
  v_mfma_f32_16x16x32_bf16 v[138:141], v[242:245], a[188:191], v[138:141]
  ds_read_b128 v[194:197], v15 offset:12288
  v_mfma_f32_16x16x32_bf16 v[130:133], v[150:153], a[192:195], 0
  ds_read_b128 v[150:153], v15 offset:13312
  v_mfma_f32_16x16x32_bf16 v[130:133], v[154:157], a[196:199], v[130:133]
  v_cvt_pk_bf16_f32 v154, v138, v139
  v_cvt_pk_bf16_f32 v155, v140, v141
  v_mfma_f32_16x16x32_bf16 v[130:133], v[166:169], a[200:203], v[130:133]
  v_mfma_f32_16x16x32_bf16 v[130:133], v[174:177], a[204:207], v[130:133]
  v_mfma_f32_16x16x32_bf16 v[130:133], v[142:145], a[208:211], v[130:133]
  buffer_load_dwordx4 v252, s[20:23], s98 offen offset:1024 lds
  v_mfma_f32_16x16x32_bf16 v[130:133], v[242:245], a[212:215], v[130:133]
  s_waitcnt lgkmcnt(5)
  v_mfma_f32_16x16x32_bf16 v[242:245], a[72:75], v[158:161], 0
  s_waitcnt lgkmcnt(4)
  v_mfma_f32_16x16x32_bf16 v[242:245], a[76:79], v[182:185], v[242:245]
  s_waitcnt lgkmcnt(3)
  v_cvt_pk_bf16_f32 v174, v130, v131
  v_cvt_pk_bf16_f32 v175, v132, v133
  v_mfma_f32_16x16x32_bf16 v[242:245], a[80:83], v[170:173], v[242:245]
  s_waitcnt lgkmcnt(2)
  v_mfma_f32_16x16x32_bf16 v[242:245], a[84:87], v[190:193], v[242:245]
  s_waitcnt lgkmcnt(1)
  v_mfma_f32_16x16x32_bf16 v[242:245], a[88:91], v[194:197], v[242:245]
  s_waitcnt lgkmcnt(0)
  v_mfma_f32_16x16x32_bf16 v[242:245], a[92:95], v[150:153], v[242:245]
  v_mfma_f32_16x16x32_bf16 v[130:133], a[96:99], v[158:161], 0
  v_mfma_f32_16x16x32_bf16 v[130:133], a[100:103], v[182:185], v[130:133]
  v_cvt_pk_bf16_f32 v166, v242, v243
  v_cvt_pk_bf16_f32 v167, v244, v245
  v_mfma_f32_16x16x32_bf16 v[130:133], a[104:107], v[170:173], v[130:133]
  v_mfma_f32_16x16x32_bf16 v[130:133], a[108:111], v[190:193], v[130:133]
  v_mfma_f32_16x16x32_bf16 v[130:133], a[112:115], v[194:197], v[130:133]
  v_mfma_f32_16x16x32_bf16 v[130:133], a[116:119], v[150:153], v[130:133]
  v_mfma_f32_16x16x32_bf16 v[242:245], a[120:123], v[158:161], 0
  v_mfma_f32_16x16x32_bf16 v[242:245], a[124:127], v[182:185], v[242:245]
  v_cvt_pk_bf16_f32 v168, v130, v131
  v_cvt_pk_bf16_f32 v169, v132, v133
  v_mfma_f32_16x16x32_bf16 v[242:245], a[128:131], v[170:173], v[242:245]
  v_mfma_f32_16x16x32_bf16 v[242:245], a[132:135], v[190:193], v[242:245]
  v_mfma_f32_16x16x32_bf16 v[242:245], a[136:139], v[194:197], v[242:245]
  buffer_load_dwordx4 v253, s[20:23], s98 offen offset:2048 lds
  v_mfma_f32_16x16x32_bf16 v[242:245], a[140:143], v[150:153], v[242:245]
  s_add_u32 m0, s70, 0
  v_mfma_f32_16x16x32_bf16 v[130:133], a[0:3], v[158:161], 0
  s_mov_b32 s98, 12288
  v_mfma_f32_16x16x32_bf16 v[130:133], a[4:7], v[182:185], v[130:133]
  v_cvt_pk_bf16_f32 v232, v242, v243
  v_cvt_pk_bf16_f32 v233, v244, v245
  v_mfma_f32_16x16x32_bf16 v[130:133], a[8:11], v[170:173], v[130:133]
  v_mfma_f32_16x16x32_bf16 v[130:133], a[12:15], v[190:193], v[130:133]
  v_mfma_f32_16x16x32_bf16 v[130:133], a[16:19], v[194:197], v[130:133]
  buffer_load_dwordx4 v251, s[20:23], s98 offen lds
  v_mfma_f32_16x16x32_bf16 v[130:133], a[20:23], v[150:153], v[130:133]
  v_mfma_f32_16x16x32_bf16 v[242:245], a[24:27], v[158:161], 0
  v_mfma_f32_16x16x32_bf16 v[242:245], a[28:31], v[182:185], v[242:245]
  v_cvt_pk_bf16_f32 v198, v130, v131
  v_cvt_pk_bf16_f32 v199, v132, v133
  v_mfma_f32_16x16x32_bf16 v[242:245], a[32:35], v[170:173], v[242:245]
  v_mfma_f32_16x16x32_bf16 v[242:245], a[36:39], v[190:193], v[242:245]
  v_mfma_f32_16x16x32_bf16 v[242:245], a[40:43], v[194:197], v[242:245]
  v_mfma_f32_16x16x32_bf16 v[242:245], a[44:47], v[150:153], v[242:245]
  v_mfma_f32_16x16x32_bf16 v[130:133], a[48:51], v[158:161], 0
  v_mfma_f32_16x16x32_bf16 v[130:133], a[52:55], v[182:185], v[130:133]
  buffer_load_dwordx4 v252, s[20:23], s98 offen offset:1024 lds
  v_mfma_f32_16x16x32_bf16 v[130:133], a[56:59], v[170:173], v[130:133]
  v_cvt_pk_bf16_f32 v200, v242, v243
  v_cvt_pk_bf16_f32 v201, v244, v245
  v_mfma_f32_16x16x32_bf16 v[130:133], a[60:63], v[190:193], v[130:133]
  v_mfma_f32_16x16x32_bf16 v[130:133], a[64:67], v[194:197], v[130:133]
  v_mfma_f32_16x16x32_bf16 v[130:133], a[68:71], v[150:153], v[130:133]
  v_mfma_f32_16x16x16_bf16 v[242:245], v[230:231], v[114:115], 0
  v_mfma_f32_16x16x16_bf16 v[138:141], v[232:233], v[114:115], 0
  v_cvt_pk_bf16_f32 v110, v130, v131
  v_cvt_pk_bf16_f32 v111, v132, v133
  v_mfma_f32_16x16x32_bf16 v[242:245], v[186:189], v[178:181], v[242:245]
  buffer_load_dwordx4 v253, s[20:23], s98 offen offset:2048 lds
  v_mfma_f32_16x16x32_bf16 v[138:141], v[166:169], v[178:181], v[138:141]
  s_add_u32 m0, s70, 3072
  v_mfma_f32_16x16x32_bf16 v[130:133], v[158:161], a[144:147], 0
  s_mov_b32 s98, 24576
  v_exp_f32 v242, v242
  v_mfma_f32_16x16x32_bf16 v[130:133], v[182:185], a[148:151], v[130:133]
  v_exp_f32 v243, v243
  v_mfma_f32_16x16x32_bf16 v[130:133], v[170:173], a[152:155], v[130:133]
  v_exp_f32 v244, v244
  v_mfma_f32_16x16x32_bf16 v[130:133], v[190:193], a[156:159], v[130:133]
  v_exp_f32 v245, v245
  v_mfma_f32_16x16x32_bf16 v[130:133], v[194:197], a[160:163], v[130:133]
  v_exp_f32 v138, v138
  v_mfma_f32_16x16x32_bf16 v[130:133], v[150:153], a[164:167], v[130:133]
  v_exp_f32 v139, v139
  buffer_load_dwordx4 v251, s[20:23], s98 offen lds
  v_exp_f32 v140, v140
  v_exp_f32 v141, v141
  v_cvt_pk_bf16_f32 v202, v242, v243
  v_cvt_pk_bf16_f32 v203, v244, v245
  s_nop 1
  v_cvt_pk_bf16_f32 v164, v130, v131
  v_cvt_pk_bf16_f32 v165, v132, v133
  v_cvt_pk_bf16_f32 v204, v138, v139
  v_cvt_pk_bf16_f32 v205, v140, v141
  buffer_load_dwordx4 v252, s[20:23], s98 offen offset:1024 lds
  s_waitcnt vmcnt(10)
  ds_read_b64 v[106:107], v9
  ds_read_b64 v[122:123], v9 offset:32
  ds_read_b64 v[118:119], v9 offset:64
  ds_read_b128 v[242:245], v3
  ds_read_b128 v[246:249], v3 offset:864
  ds_read_b128 v[126:129], v3 offset:1728
  ds_read_b128 v[130:133], v6
  s_waitcnt lgkmcnt(6)
  v_mfma_f32_16x16x16_bf16 v[62:65], a[224:225], v[106:107], 0
  ds_read_b128 v[134:137], v3 offset:32
  s_waitcnt lgkmcnt(6)
  v_mfma_f32_16x16x16_bf16 v[66:69], a[234:235], v[122:123], 0
  ds_read_b128 v[138:141], v3 offset:896
  s_waitcnt lgkmcnt(6)
  v_mfma_f32_16x16x16_bf16 v[70:73], a[244:245], v[118:119], 0
  ds_read_b128 v[142:145], v3 offset:1760
  ds_read_b128 v[146:149], v6 offset:32
  s_waitcnt lgkmcnt(6)
  v_smfmac_f32_16x16x64_bf16 v[62:65], a[216:219], v[242:249], v0
  ds_read_b128 v[242:245], v3 offset:64
  ds_read_b128 v[246:249], v3 offset:928
  s_waitcnt lgkmcnt(6)
  v_smfmac_f32_16x16x64_bf16 v[62:65], a[220:223], v[126:133], v0
  ds_read_b128 v[126:129], v3 offset:1792
  v_mfma_f32_16x16x32_bf16 v[206:209], v[158:161], a[168:171], 0
  ds_read_b128 v[130:133], v6 offset:64
  v_mfma_f32_16x16x32_bf16 v[206:209], v[182:185], a[172:175], v[206:209]
  v_mul_f32 v116, v62, v62
  v_add_f32 v120, v62, v63
  v_mfma_f32_16x16x32_bf16 v[206:209], v[170:173], a[176:179], v[206:209]
  s_waitcnt lgkmcnt(6)
  buffer_load_dwordx4 v253, s[20:23], s98 offen offset:2048 lds
  v_smfmac_f32_16x16x64_bf16 v[66:69], a[226:229], v[134:141], v0
  s_waitcnt lgkmcnt(4)
  v_fmac_f32 v116, v63, v63
  v_smfmac_f32_16x16x64_bf16 v[66:69], a[230:233], v[142:149], v0
  s_add_u32 m0, s70, 6144
  v_add_f32 v120, v120, v64
  v_mfma_f32_16x16x32_bf16 v[206:209], v[190:193], a[180:183], v[206:209]
  s_mov_b32 s98, 36864
  v_fmac_f32 v116, v64, v64
  v_add_f32 v120, v120, v65
  v_mfma_f32_16x16x32_bf16 v[206:209], v[194:197], a[184:187], v[206:209]
  v_fmac_f32 v116, v65, v65
  v_add_f32 v120, v120, v66
  v_mfma_f32_16x16x32_bf16 v[206:209], v[150:153], a[188:191], v[206:209]
  s_waitcnt lgkmcnt(2)
  buffer_load_dwordx4 v251, s[20:23], s98 offen lds
  v_smfmac_f32_16x16x64_bf16 v[70:73], a[236:239], v[242:249], v0
  s_waitcnt lgkmcnt(0)
  v_fmac_f32 v116, v66, v66
  v_smfmac_f32_16x16x64_bf16 v[70:73], a[240:243], v[126:133], v0
  ds_read_b128 v[210:213], v15 offset:14336
  v_cvt_pk_bf16_f32 v156, v206, v207
  v_mfma_f32_16x16x32_bf16 v[126:129], v[158:161], a[192:195], 0
  ds_read_b128 v[158:161], v15 offset:15360
  v_cvt_pk_bf16_f32 v157, v208, v209
  v_mfma_f32_16x16x32_bf16 v[126:129], v[182:185], a[196:199], v[126:129]
  s_waitcnt vmcnt(7)
  buffer_load_dwordx4 v252, s[20:23], s98 offen offset:1024 lds
  v_mfma_f32_16x16x32_bf16 v[126:129], v[170:173], a[200:203], v[126:129]
  ds_read_b128 v[170:173], v15 offset:16384
  ds_read_b128 v[182:185], v15 offset:17408
  v_mfma_f32_16x16x32_bf16 v[126:129], v[190:193], a[204:207], v[126:129]
  ds_read_b128 v[190:193], v15 offset:18432
  v_add_f32 v120, v120, v67
  v_mfma_f32_16x16x32_bf16 v[126:129], v[194:197], a[208:211], v[126:129]
  ds_read_b128 v[194:197], v15 offset:19456
  v_fmac_f32 v116, v67, v67
  v_mfma_f32_16x16x32_bf16 v[126:129], v[150:153], a[212:215], v[126:129]
  ds_read_b64 v[106:107], v10
  v_add_f32 v120, v120, v68
  v_fmac_f32 v116, v68, v68
  v_mfma_f32_16x16x16_bf16 v[150:153], v[230:231], v[110:111], 0
  v_add_f32 v120, v120, v69
  v_fmac_f32 v116, v69, v69
  v_add_f32 v120, v120, v70
  v_mfma_f32_16x16x16_bf16 v[206:209], v[232:233], v[110:111], 0
  v_cvt_pk_bf16_f32 v176, v126, v127
  v_cvt_pk_bf16_f32 v177, v128, v129
  v_fmac_f32 v116, v70, v70
  v_add_f32 v120, v120, v71
  v_mfma_f32_16x16x32_bf16 v[150:153], v[186:189], v[198:201], v[150:153]
  buffer_load_dwordx4 v253, s[20:23], s98 offen offset:2048 lds
  v_mfma_f32_16x16x32_bf16 v[206:209], v[166:169], v[198:201], v[206:209]
  s_waitcnt lgkmcnt(6)
  ds_read_b64 v[118:119], v10 offset:32
  ds_read_b64 v[122:123], v10 offset:64
  v_mfma_f32_16x16x32_bf16 v[214:217], a[72:75], v[210:213], 0
  s_waitcnt lgkmcnt(7)
  ds_read_b128 v[126:129], v4
  v_fmac_f32 v116, v71, v71
  v_mfma_f32_16x16x32_bf16 v[214:217], a[76:79], v[158:161], v[214:217]
  s_waitcnt lgkmcnt(7)
  ds_read_b128 v[130:133], v4 offset:864
  v_add_f32 v120, v120, v72
  v_mfma_f32_16x16x32_bf16 v[214:217], a[80:83], v[170:173], v[214:217]
  s_waitcnt lgkmcnt(7)
  ds_read_b128 v[242:245], v4 offset:1728
  v_fmac_f32 v116, v72, v72
  v_mfma_f32_16x16x32_bf16 v[214:217], a[84:87], v[182:185], v[214:217]
  s_waitcnt lgkmcnt(7)
  ds_read_b128 v[246:249], v7
  v_add_f32 v120, v120, v73
  v_mfma_f32_16x16x32_bf16 v[214:217], a[88:91], v[190:193], v[214:217]
  s_waitcnt lgkmcnt(7)
  ds_read_b128 v[142:145], v4 offset:32
  v_fmac_f32 v116, v73, v73
  v_mfma_f32_16x16x32_bf16 v[214:217], a[92:95], v[194:197], v[214:217]
  s_waitcnt lgkmcnt(6)
  ds_read_b128 v[146:149], v4 offset:896
  v_exp_f32 v150, v150
  v_mfma_f32_16x16x16_bf16 v[74:77], a[224:225], v[106:107], 0
  v_exp_f32 v151, v151
  v_mfma_f32_16x16x16_bf16 v[78:81], a[234:235], v[118:119], 0
  ds_read_b128 v[134:137], v4 offset:1760
  ds_read_b128 v[138:141], v7 offset:32
  s_waitcnt lgkmcnt(8)
  v_mfma_f32_16x16x16_bf16 v[82:85], a[244:245], v[122:123], 0
  v_exp_f32 v152, v152
  v_cvt_pk_bf16_f32 v218, v214, v215
  s_waitcnt lgkmcnt(6)
  v_smfmac_f32_16x16x64_bf16 v[74:77], a[216:219], v[126:133], v0
  s_waitcnt lgkmcnt(4)
  ds_read_b128 v[126:129], v4 offset:64
  ds_read_b128 v[130:133], v4 offset:928
  v_smfmac_f32_16x16x64_bf16 v[74:77], a[220:223], v[242:249], v0
  s_add_u32 m0, s70, 9216
  ds_read_b128 v[242:245], v4 offset:1792
  v_cvt_pk_bf16_f32 v219, v216, v217
  v_mfma_f32_16x16x32_bf16 v[214:217], a[96:99], v[210:213], 0
  s_mov_b32 s98, 49152
  buffer_load_dwordx4 v251, s[20:23], s98 offen lds
  v_mfma_f32_16x16x32_bf16 v[214:217], a[100:103], v[158:161], v[214:217]
  buffer_load_dwordx4 v252, s[20:23], s98 offen offset:1024 lds
  v_mfma_f32_16x16x32_bf16 v[214:217], a[104:107], v[170:173], v[214:217]
  s_waitcnt lgkmcnt(5)
  buffer_load_dwordx4 v253, s[20:23], s98 offen offset:2048 lds
  v_smfmac_f32_16x16x64_bf16 v[78:81], a[226:229], v[142:149], v0
  s_waitcnt lgkmcnt(3)
  ds_read_b128 v[246:249], v7 offset:64
  ds_read_b64 v[222:223], v19 offset:784
  v_smfmac_f32_16x16x64_bf16 v[78:81], a[230:233], v[134:141], v0
  s_add_u32 m0, s70, 12288
  ds_read2_b64 v[142:145], v19 offset0:96 offset1:97
  v_cvt_pk_bf16_f32 v146, v150, v151
  v_mfma_f32_16x16x32_bf16 v[214:217], a[108:111], v[182:185], v[214:217]
  s_mov_b32 s98, 61440
  buffer_load_dwordx4 v251, s[20:23], s98 offen lds
  v_mfma_f32_16x16x32_bf16 v[214:217], a[112:115], v[190:193], v[214:217]
  buffer_load_dwordx4 v252, s[20:23], s98 offen offset:1024 lds
  v_mfma_f32_16x16x32_bf16 v[214:217], a[116:119], v[194:197], v[214:217]
  s_waitcnt lgkmcnt(4)
  v_exp_f32 v153, v153
  v_smfmac_f32_16x16x64_bf16 v[82:85], a[236:239], v[126:133], v0
  s_waitcnt lgkmcnt(3)
  ds_read_b64_tr_b16 a[250:251], v254
  v_cvt_pk_bf16_f32 v147, v152, v153
  s_waitcnt lgkmcnt(3)
  v_smfmac_f32_16x16x64_bf16 v[82:85], a[240:243], v[242:249], v0
  ds_read_b64_tr_b16 v[98:99], v254 offset:32
  ds_read_b64_tr_b16 v[102:103], v254 offset:64
  v_mfma_f32_16x16x32_bf16 v[242:245], a[120:123], v[210:213], 0
  v_exp_f32 v206, v206
  v_mfma_f32_16x16x32_bf16 v[242:245], a[124:127], v[158:161], v[242:245]
  buffer_load_dwordx4 v253, s[20:23], s98 offen offset:2048 lds
  v_mfma_f32_16x16x32_bf16 v[242:245], a[128:131], v[170:173], v[242:245]
  s_lshl_b32 s60, s31, 5
  v_exp_f32 v207, v207
  v_mfma_f32_16x16x32_bf16 v[242:245], a[132:135], v[182:185], v[242:245]
  s_add_u32 s61, s60, s30
  v_exp_f32 v208, v208
  v_mfma_f32_16x16x32_bf16 v[242:245], a[136:139], v[190:193], v[242:245]
  s_add_u32 s60, s60, s29
  v_exp_f32 v209, v209
  v_mfma_f32_16x16x32_bf16 v[242:245], a[140:143], v[194:197], v[242:245]
  s_waitcnt lgkmcnt(3)
  ds_read_b64 v[106:107], v11
  ds_read_b64_tr_b16 a[252:253], v254 offset:1536
  ds_read_b64_tr_b16 v[100:101], v254 offset:1568
  v_mfma_f32_16x16x16_bf16 v[150:153], v[230:231], v[222:223], 0
  v_cvt_pk_bf16_f32 v220, v214, v215
  v_cvt_pk_bf16_f32 v221, v216, v217
  v_cvt_pk_bf16_f32 v148, v206, v207
  v_mfma_f32_16x16x16_bf16 v[214:217], v[232:233], v[222:223], 0
  v_cvt_pk_bf16_f32 v149, v208, v209
  v_cvt_pk_bf16_f32 v234, v242, v243
  v_cvt_pk_bf16_f32 v235, v244, v245
  v_mul_f32 v124, v74, v74
  v_mfma_f32_16x16x32_bf16 v[150:153], v[186:189], v[142:145], v[150:153]
  s_mul_i32 s62, s60, 7183
  ds_read_b64 v[118:119], v11 offset:32
  ds_read_b64 v[122:123], v11 offset:64
  v_mfma_f32_16x16x32_bf16 v[214:217], v[166:169], v[142:145], v[214:217]
  s_lshr_b32 s62, s62, 22
  ds_read_b128 v[242:245], v5
  v_add_f32 v224, v74, v75
  v_mfma_f32_16x16x32_bf16 v[206:209], v[210:213], a[144:147], 0
  s_mul_i32 s63, s62, 584
  ds_read_b128 v[246:249], v5 offset:864
  v_fmac_f32 v124, v75, v75
  v_mfma_f32_16x16x32_bf16 v[206:209], v[158:161], a[148:151], v[206:209]
  s_sub_u32 s63, s60, s63
  ds_read_b128 v[126:129], v5 offset:1728
  v_add_f32 v224, v224, v76
  v_mfma_f32_16x16x32_bf16 v[206:209], v[170:173], a[152:155], v[206:209]
  s_lshr_b32 s64, s63, 3
  ds_read_b128 v[130:133], v8
  v_fmac_f32 v124, v76, v76
  v_mfma_f32_16x16x32_bf16 v[206:209], v[182:185], a[156:159], v[206:209]
  s_and_b32 s65, s63, 7
  ds_read_b128 v[134:137], v5 offset:32
  v_add_f32 v224, v224, v77
  v_mfma_f32_16x16x32_bf16 v[206:209], v[190:193], a[160:163], v[206:209]
  s_lshl_b32 s66, s62, 3
  ds_read_b128 v[138:141], v5 offset:896
  v_fmac_f32 v124, v77, v77
  v_mfma_f32_16x16x32_bf16 v[206:209], v[194:197], a[164:167], v[206:209]
  s_waitcnt lgkmcnt(6)
  ds_read_b64 v[236:237], v19 offset:16
  ds_read_b64_tr_b16 v[104:105], v254 offset:1600
  v_add_f32 v224, v224, v78
  v_mfma_f32_16x16x16_bf16 v[86:89], a[224:225], v[106:107], 0
  v_exp_f32 v150, v150
  v_fmac_f32 v124, v78, v78
  v_mfma_f32_16x16x16_bf16 v[90:93], a[234:235], v[118:119], 0
  v_exp_f32 v151, v151
  v_cvt_pk_bf16_f32 v106, v206, v207
  v_mfma_f32_16x16x16_bf16 v[94:97], a[244:245], v[122:123], 0
  v_exp_f32 v152, v152
  v_cvt_pk_bf16_f32 v107, v208, v209
  s_waitcnt lgkmcnt(6)
  v_smfmac_f32_16x16x64_bf16 v[86:89], a[216:219], v[242:249], v0
  s_waitcnt lgkmcnt(4)
  ds_read_b128 v[242:245], v5 offset:1760
  ds_read_b128 v[246:249], v8 offset:32
  v_smfmac_f32_16x16x64_bf16 v[86:89], a[220:223], v[126:133], v0
  s_add_u32 s65, s65, s66
  ds_read_b128 v[126:129], v5 offset:64
  v_cvt_pk_bf16_f32 v206, v150, v151
  v_mfma_f32_16x16x32_bf16 v[250:253], v[210:213], a[168:171], 0
  s_cmp_ge_u32 s60, 5256
  ds_read_b128 v[130:133], v5 offset:928
  v_add_f32 v224, v224, v79
  v_mfma_f32_16x16x32_bf16 v[250:253], v[158:161], a[172:175], v[250:253]
  s_cselect_b32 s64, s63, s64
  v_exp_f32 v153, v153
  v_mfma_f32_16x16x32_bf16 v[250:253], v[170:173], a[176:179], v[250:253]
  s_waitcnt lgkmcnt(6)
  v_exp_f32 v214, v214
  v_smfmac_f32_16x16x64_bf16 v[90:93], a[226:229], v[134:141], v0
  ds_read_b128 v[134:137], v5 offset:1792
  v_exp_f32 v215, v215
  v_exp_f32 v216, v216
  v_mul_f32 v254, v86, v86
  s_waitcnt lgkmcnt(3)
  v_smfmac_f32_16x16x64_bf16 v[90:93], a[230:233], v[242:249], v0
  s_cselect_b32 s65, 72, s65
  ds_read_b128 v[138:141], v8 offset:64
  ds_read2_b64 v[242:245], v19 offset0:0 offset1:1
  v_mfma_f32_16x16x32_bf16 v[250:253], v[182:185], a[180:183], v[250:253]
  s_mul_i32 s66, s65, 1373568
  v_exp_f32 v217, v217
  v_mfma_f32_16x16x32_bf16 v[250:253], v[190:193], a[184:187], v[250:253]
  s_mul_i32 s67, s64, 2688
  v_add_f32 v225, v86, v87
  v_fmac_f32 v254, v87, v87
  v_mfma_f32_16x16x32_bf16 v[250:253], v[194:197], a[188:191], v[250:253]
  s_waitcnt lgkmcnt(3)
  v_add_f32 v225, v225, v88
  v_fmac_f32 v254, v88, v88
  v_smfmac_f32_16x16x64_bf16 v[94:97], a[236:239], v[126:133], v0
  s_waitcnt lgkmcnt(2)
  s_add_u32 s35, s66, s67
  v_cvt_pk_bf16_f32 v207, v152, v153
  v_add_f32 v225, v225, v89
  v_fmac_f32 v254, v89, v89
  v_add_f32 v225, v225, v90
  v_fmac_f32 v254, v90, v90
  s_waitcnt lgkmcnt(1)
  v_smfmac_f32_16x16x64_bf16 v[94:97], a[240:243], v[134:141], v0
  s_cmp_ge_u32 s61, 667
  v_add_f32 v225, v225, v91
  v_fmac_f32 v254, v91, v91
  v_mfma_f32_16x16x16_bf16 v[134:137], v[234:235], v[114:115], 0
  v_fmac_f32 v124, v79, v79
  v_add_f32 v225, v225, v92
  v_fmac_f32 v254, v92, v92
  v_mfma_f32_16x16x16_bf16 v[138:141], v[236:237], v[114:115], v[2:5]
  v_add_f32 v224, v224, v80
  v_cvt_pk_bf16_f32 v208, v214, v215
  v_fmac_f32 v124, v80, v80
  v_add_f32 v225, v225, v93
  v_mfma_f32_16x16x32_bf16 v[134:137], v[218:221], v[178:181], v[134:137]
  s_waitcnt lgkmcnt(0)
  v_fmac_f32 v254, v93, v93
  v_add_f32 v224, v224, v81
  v_mfma_f32_16x16x32_bf16 v[138:141], v[242:245], v[178:181], v[138:141]
  s_cselect_b32 s35, 268435456, s35
  v_fmac_f32 v124, v81, v81
  v_add_f32 v225, v225, v94
  v_mfma_f32_16x16x32_bf16 v[126:129], v[210:213], a[192:195], 0
  s_cmp_ge_u32 s60, 5329
  v_fmac_f32 v254, v94, v94
  v_add_f32 v224, v224, v82
  v_mfma_f32_16x16x32_bf16 v[126:129], v[158:161], a[196:199], v[126:129]
  s_cselect_b32 s35, 268435456, s35
  v_fmac_f32 v124, v82, v82
  v_add_f32 v225, v225, v95
  v_mfma_f32_16x16x32_bf16 v[126:129], v[170:173], a[200:203], v[126:129]
  s_cmp_eq_u32 s65, 0
  v_fmac_f32 v254, v95, v95
  v_add_f32 v224, v224, v83
  v_mfma_f32_16x16x32_bf16 v[126:129], v[182:185], a[204:207], v[126:129]
  s_cselect_b32 s36, 268435456, s35
  v_fmac_f32 v124, v83, v83
  v_add_f32 v225, v225, v96
  v_mfma_f32_16x16x32_bf16 v[126:129], v[190:193], a[208:211], v[126:129]
  s_add_u32 s37, s35, 195360
  v_fmac_f32 v254, v96, v96
  v_cvt_pk_bf16_f32 v209, v216, v217
  v_mfma_f32_16x16x32_bf16 v[126:129], v[194:197], a[212:215], v[126:129]
  s_add_u32 s38, s35, 390720
  v_add_f32 v224, v224, v84
  v_fmac_f32 v124, v84, v84
  v_add_f32 v225, v225, v97
  v_mfma_f32_16x16x16_bf16 v[130:133], v[234:235], v[110:111], 0
  v_fmac_f32 v254, v97, v97
  v_add_f32 v224, v224, v85
  v_fmac_f32 v124, v85, v85
  v_mfma_f32_16x16x16_bf16 v[150:153], v[236:237], v[110:111], v[2:5]
  v_cvt_pk_bf16_f32 v110, v250, v251
  v_cvt_pk_bf16_f32 v111, v252, v253
  v_permlane32_swap_b32 v225, v254
  v_mfma_f32_16x16x32_bf16 v[130:133], v[218:221], v[198:201], v[130:133]
  s_add_u32 s39, s35, 586080
  v_permlane32_swap_b32 v120, v116
  v_mfma_f32_16x16x32_bf16 v[150:153], v[242:245], v[198:201], v[150:153]
  s_add_u32 s40, s35, 781440
  v_permlane32_swap_b32 v224, v124
  v_mfma_f32_16x16x32_bf16 v[198:201], a[0:3], v[210:213], 0
  s_add_u32 s41, s35, 981120
  v_add_f32 v225, v225, v254
  v_add_f32 v120, v120, v116
  v_mfma_f32_16x16x32_bf16 v[198:201], a[4:7], v[158:161], v[198:201]
  s_add_u32 s42, s35, 1176480
  v_add_f32 v224, v224, v124
  v_mov_b32 v116, v225
  v_mfma_f32_16x16x32_bf16 v[198:201], a[8:11], v[170:173], v[198:201]
  s_add_u32 s43, s35, 1371840
  v_permlane16_swap_b32 v120, v224
  v_mfma_f32_16x16x32_bf16 v[198:201], a[12:15], v[182:185], v[198:201]
  s_add_u32 s44, s35, 1567200
  v_permlane16_swap_b32 v225, v116
  v_mfma_f32_16x16x32_bf16 v[198:201], a[16:19], v[190:193], v[198:201]
  s_cmp_eq_u32 s64, 0
  v_add_f32 v120, v120, v224
  v_add_f32 v225, v225, v116
  v_mfma_f32_16x16x32_bf16 v[198:201], a[20:23], v[194:197], v[198:201]
  s_cselect_b64 s[52:53], s[48:49], 0
  ds_write_b32 v109, v120
  ds_write_b32 v109, v225 offset:512
  v_exp_f32 v134, v134
  v_exp_f32 v135, v135
  v_exp_f32 v136, v136
  v_exp_f32 v137, v137
  v_exp_f32 v138, v138
  v_cvt_pk_bf16_f32 v114, v126, v127
  v_cvt_pk_bf16_f32 v115, v128, v129
  v_exp_f32 v130, v130
  v_exp_f32 v131, v131
  v_exp_f32 v132, v132
  v_exp_f32 v133, v133
  v_exp_f32 v150, v150
  s_waitcnt lgkmcnt(0)
  s_barrier
  v_mfma_f32_16x16x32_bf16 v[126:129], a[24:27], v[210:213], 0
  s_cmp_eq_u32 s64, 72
  ds_read_u16 v108, v20
  ds_read_u16 v112, v20 offset:32
  v_mfma_f32_16x16x32_bf16 v[126:129], a[28:31], v[158:161], v[126:129]
  s_cselect_b64 s[52:53], s[50:51], s[52:53]
  ds_read_u16 v116, v20 offset:64
  ds_read_b128 v[250:253], v15
  v_mfma_f32_16x16x32_bf16 v[126:129], a[32:35], v[170:173], v[126:129]
  s_add_u32 s31, s31, 1
  ds_read_b128 v[214:217], v15 offset:1024
  v_cvt_pk_bf16_f32 v118, v134, v135
  v_mfma_f32_16x16x32_bf16 v[126:129], a[36:39], v[182:185], v[126:129]
  s_sub_u32 s68, s35, 196608
  v_cvt_pk_bf16_f32 v119, v136, v137
  v_cvt_pk_bf16_f32 v120, v138, 0
  v_mfma_f32_16x16x32_bf16 v[126:129], a[40:43], v[190:193], v[126:129]
  s_cselect_b32 s68, s35, s68
  buffer_load_dword v25, v24, s[24:27], s68 offen
  v_mfma_f32_16x16x32_bf16 v[126:129], a[44:47], v[194:197], v[126:129]
  s_mov_b32 s32, s33
  v_cvt_pk_bf16_f32 v134, v198, v199
  v_cvt_pk_bf16_f32 v135, v200, v201
  v_mfma_f32_16x16x32_bf16 v[198:201], a[246:249], v[202:205], 0
  s_mov_b32 s33, s34
  v_cvt_pk_bf16_f32 v122, v130, v131
  v_cvt_pk_bf16_f32 v123, v132, v133
  v_mfma_f32_16x16x32_bf16 v[198:201], a[246:249], v[118:121], v[198:201]
  s_waitcnt lgkmcnt(1)
  v_cvt_pk_bf16_f32 v124, v150, 0
  v_cvt_pk_bf16_f32 v136, v126, v127
  v_mfma_f32_16x16x32_bf16 v[130:133], v[162:165], v[202:205], 0
  s_waitcnt lgkmcnt(0)
  v_cvt_pk_bf16_f32 v137, v128, v129
  v_add_f32 v250, v250, v251
  v_mfma_f32_16x16x32_bf16 v[130:133], v[106:109], v[118:121], v[130:133]
  s_mov_b32 s34, s35
  v_add_f32 v252, v252, v253
  v_add_f32 v214, v214, v215
  v_mfma_f32_16x16x32_bf16 v[138:141], v[154:157], v[202:205], 0
  v_add_f32 v216, v216, v217
  v_add_f32 v250, v250, v252
  v_mfma_f32_16x16x32_bf16 v[138:141], v[110:113], v[118:121], v[138:141]
  v_add_f32 v214, v214, v216
  v_mul_f32 v251, 0x3baaaaab, v250
  v_mfma_f32_16x16x32_bf16 v[178:181], v[174:177], v[202:205], 0
  v_fma_f32 v214, -v251, v250, v214
  v_max_f32 v214, 0, v214
  v_mfma_f32_16x16x32_bf16 v[178:181], v[114:117], v[118:121], v[178:181]
  v_add_f32 v214, 0x3afba882, v214
  v_rsq_f32 v214, v214
  v_mfma_f32_16x16x16_bf16 v[126:129], v[234:235], v[222:223], 0
  v_mul_f32 v214, 0x40ca568a, v214
  v_mul_f32 v215, -v251, v214
  v_mul_f32 v198, 0x3ee9a3cd, v198
  v_mfma_f32_16x16x16_bf16 v[150:153], v[236:237], v[222:223], v[2:5]
  v_rcp_f32 v254, v198
  v_add_u32 v19, 1160, v19
  v_mul_f32 v130, v130, v254
  v_mfma_f32_16x16x32_bf16 v[126:129], v[218:221], v[142:145], v[126:129]
  ds_write_b64 v113, v[214:215]
  v_mfma_f32_16x16x32_bf16 v[150:153], v[242:245], v[142:145], v[150:153]
  ds_read_b64 v[238:239], v117 offset:768
  v_mul_f32 v131, v131, v254
  v_mfma_f32_16x16x32_bf16 v[214:217], a[246:249], v[146:149], 0
  v_exp_f32 v126, v126
  v_mfma_f32_16x16x32_bf16 v[214:217], a[246:249], v[122:125], v[214:217]
  v_exp_f32 v127, v127
  v_mfma_f32_16x16x32_bf16 v[250:253], v[162:165], v[146:149], 0
  v_exp_f32 v128, v128
  v_mfma_f32_16x16x32_bf16 v[250:253], v[106:109], v[122:125], v[250:253]
  v_exp_f32 v129, v129
  v_mfma_f32_16x16x32_bf16 v[202:205], v[154:157], v[146:149], 0
  v_exp_f32 v150, v150
  v_mfma_f32_16x16x32_bf16 v[202:205], v[110:113], v[122:125], v[202:205]
  s_waitcnt lgkmcnt(0)
  v_cvt_pk_bf16_f32 v246, v130, v131
  v_cvt_pk_bf16_f32 v118, v126, v127
  v_mfma_f32_16x16x32_bf16 v[222:225], v[174:177], v[146:149], 0
  v_cvt_pk_bf16_f32 v119, v128, v129
  v_cvt_pk_bf16_f32 v120, v150, 0
  v_mfma_f32_16x16x32_bf16 v[222:225], v[114:117], v[122:125], v[222:225]
  s_waitcnt vmcnt(10)
  ds_read_b64_tr_b16 v[126:127], v255
  ds_read_b64_tr_b16 v[146:147], v255 offset:32
  v_mfma_f32_16x16x32_bf16 v[142:145], a[48:51], v[210:213], 0
  ds_read_b64_tr_b16 v[150:151], v255 offset:64
  ds_read_b64_tr_b16 v[210:211], v255 offset:1536
  v_mfma_f32_16x16x32_bf16 v[142:145], a[52:55], v[158:161], v[142:145]
  ds_read_b64_tr_b16 v[158:159], v255 offset:1568
  v_fma_f32 v226, v62, v238, v239
  v_mfma_f32_16x16x32_bf16 v[142:145], a[56:59], v[170:173], v[142:145]
  ds_read_b64_tr_b16 v[170:171], v255 offset:1600
  ds_read_b64_tr_b16 v[212:213], v255 offset:3072
  v_mfma_f32_16x16x32_bf16 v[142:145], a[60:63], v[182:185], v[142:145]
  ds_read_b64_tr_b16 v[160:161], v255 offset:3104
  v_fma_f32 v124, v63, v238, v239
  v_mfma_f32_16x16x32_bf16 v[142:145], a[64:67], v[190:193], v[142:145]
  ds_read_b64_tr_b16 v[172:173], v255 offset:3136
  v_cvt_pk_bf16_f32 v226, v226, v124
  v_mfma_f32_16x16x32_bf16 v[142:145], a[68:71], v[194:197], v[142:145]
  ds_read_b64_tr_b16 v[128:129], v255 offset:4608
  ds_read_b64_tr_b16 v[148:149], v255 offset:4640
  v_mfma_f32_16x16x32_bf16 v[194:197], v[206:209], a[246:249], 0
  ds_read_b64_tr_b16 v[152:153], v255 offset:4672
  v_fma_f32 v227, v64, v238, v239
  v_mfma_f32_16x16x32_bf16 v[194:197], v[118:121], a[246:249], v[194:197]
  v_fma_f32 v124, v65, v238, v239
  v_cvt_pk_bf16_f32 v227, v227, v124
  v_mfma_f32_16x16x32_bf16 v[190:193], v[206:209], v[162:165], 0
  v_fma_f32 v228, v66, v238, v239
  v_fma_f32 v124, v67, v238, v239
  v_mfma_f32_16x16x32_bf16 v[190:193], v[118:121], v[106:109], v[190:193]
  s_waitcnt lgkmcnt(5)
  ds_write_b128 v18, v[210:213]
  v_mfma_f32_16x16x32_bf16 v[210:213], v[206:209], v[154:157], 0
  s_waitcnt lgkmcnt(4)
  v_cvt_pk_bf16_f32 v228, v228, v124
  v_fma_f32 v229, v68, v238, v239
  v_mfma_f32_16x16x32_bf16 v[210:213], v[118:121], v[110:113], v[210:213]
  s_waitcnt lgkmcnt(2)
  ds_write_b128 v18, v[158:161] offset:1024
  v_mfma_f32_16x16x32_bf16 v[182:185], v[206:209], v[174:177], 0
  s_waitcnt lgkmcnt(2)
  v_fma_f32 v124, v69, v238, v239
  v_cvt_pk_bf16_f32 v229, v229, v124
  v_mfma_f32_16x16x32_bf16 v[182:185], v[118:121], v[114:117], v[182:185]
  ds_write_b128 v18, v[170:173] offset:2048
  v_cvt_pk_bf16_f32 v122, v142, v143
  v_cvt_pk_bf16_f32 v123, v144, v145
  v_fma_f32 v118, v70, v238, v239
  v_fma_f32 v124, v71, v238, v239
  v_mfma_f32_16x16x16_bf16 v[142:145], v[230:231], v[122:123], 0
  v_cvt_pk_bf16_f32 v118, v118, v124
  v_fma_f32 v119, v72, v238, v239
  v_fma_f32 v124, v73, v238, v239
  v_mfma_f32_16x16x16_bf16 v[158:161], v[232:233], v[122:123], 0
  v_cvt_pk_bf16_f32 v119, v119, v124
  v_mul_f32 v214, 0x3ee9a3cd, v214
  v_mul_f32 v132, v132, v254
  v_mfma_f32_16x16x16_bf16 v[170:173], v[234:235], v[122:123], 0
  v_rcp_f32 v120, v214
  v_mul_f32 v133, v133, v254
  v_mfma_f32_16x16x16_bf16 v[206:209], v[236:237], v[122:123], v[2:5]
  v_cvt_pk_bf16_f32 v247, v132, v133
  v_mul_f32 v138, v138, v254
  v_mul_f32 v139, v139, v254
  v_cvt_pk_bf16_f32 v248, v138, v139
  v_mfma_f32_16x16x32_bf16 v[142:145], v[186:189], v[134:137], v[142:145]
  ds_write_b128 v18, v[126:129] offset:3072
  v_mfma_f32_16x16x32_bf16 v[158:161], v[166:169], v[134:137], v[158:161]
  s_nop 3
  v_exp_f32 v142, v142
  v_mfma_f32_16x16x32_bf16 v[170:173], v[218:221], v[134:137], v[170:173]
  ds_write_b128 v18, v[146:149] offset:4096
  v_mfma_f32_16x16x32_bf16 v[206:209], v[242:245], v[134:137], v[206:209]
  v_exp_f32 v143, v143
  ds_write_b128 v18, v[150:153] offset:5120
  v_exp_f32 v144, v144
  v_exp_f32 v145, v145
  v_exp_f32 v158, v158
  ds_write_b128 v16, v[226:229] offset:2048
  v_exp_f32 v159, v159
  v_exp_f32 v160, v160
  v_exp_f32 v161, v161
  ds_write_b64 v17, v[118:119] offset:2048
  v_exp_f32 v170, v170
  v_exp_f32 v171, v171
  v_exp_f32 v172, v172
  v_exp_f32 v173, v173
  v_exp_f32 v206, v206
  v_cvt_pk_bf16_f32 v226, v142, v143
  v_cvt_pk_bf16_f32 v227, v144, v145
  v_cvt_pk_bf16_f32 v228, v158, v159
  v_cvt_pk_bf16_f32 v229, v160, v161
  v_cvt_pk_bf16_f32 v122, v170, v171
  v_cvt_pk_bf16_f32 v123, v172, v173
  v_cvt_pk_bf16_f32 v124, v206, 0
  s_waitcnt vmcnt(7)
  ds_read_b64_tr_b16 v[150:151], v255 offset:6144
  ds_read_b64_tr_b16 v[158:159], v255 offset:6176
  ds_read_b64_tr_b16 v[206:207], v255 offset:6208
  ds_read_b64_tr_b16 v[152:153], v255 offset:7680
  v_mul_f32 v140, v140, v254
  v_mul_f32 v141, v141, v254
  s_waitcnt lgkmcnt(4)
  s_barrier
  ds_read_b128 v[126:129], v15 offset:2048
  ds_read_b128 v[130:133], v15 offset:3072
  ds_read_b128 v[134:137], v15 offset:4096
  v_cvt_pk_bf16_f32 v249, v140, v141
  ds_read_b128 v[138:141], v15 offset:5120
  v_mul_f32 v250, v250, v120
  ds_read_b128 v[142:145], v15 offset:6144
  v_mul_f32 v251, v251, v120
  ds_read_b128 v[146:149], v15 offset:7168
  v_cvt_pk_bf16_f32 v170, v250, v251
  ds_read_b64_tr_b16 v[160:161], v255 offset:7712
  v_mul_f32 v252, v252, v120
  v_mul_f32 v253, v253, v120
  s_waitcnt lgkmcnt(6)
  v_mfma_f32_16x16x32_bf16 v[242:245], a[0:3], v[126:129], 0
  v_cvt_pk_bf16_f32 v171, v252, v253
  s_waitcnt lgkmcnt(5)
  v_mfma_f32_16x16x32_bf16 v[242:245], a[4:7], v[130:133], v[242:245]
  ds_read_b64_tr_b16 v[208:209], v255 offset:7744
  s_waitcnt lgkmcnt(5)
  v_mfma_f32_16x16x32_bf16 v[242:245], a[8:11], v[134:137], v[242:245]
  v_mul_f32 v202, v202, v120
  s_waitcnt lgkmcnt(4)
  v_mfma_f32_16x16x32_bf16 v[242:245], a[12:15], v[138:141], v[242:245]
  v_mul_f32 v203, v203, v120
  s_waitcnt lgkmcnt(3)
  v_mfma_f32_16x16x32_bf16 v[242:245], a[16:19], v[142:145], v[242:245]
  v_cvt_pk_bf16_f32 v172, v202, v203
  s_waitcnt lgkmcnt(2)
  v_mfma_f32_16x16x32_bf16 v[242:245], a[20:23], v[146:149], v[242:245]
  s_waitcnt lgkmcnt(1)
  ds_write_b128 v18, v[150:153] offset:6144
  v_mfma_f32_16x16x32_bf16 v[250:253], a[24:27], v[126:129], 0
  s_waitcnt lgkmcnt(1)
  s_nop 2
  v_cvt_pk_bf16_f32 v150, v242, v243
  v_cvt_pk_bf16_f32 v151, v244, v245
  v_mfma_f32_16x16x32_bf16 v[250:253], a[28:31], v[130:133], v[250:253]
  ds_write_b128 v18, v[158:161] offset:7168
  v_mfma_f32_16x16x32_bf16 v[250:253], a[32:35], v[134:137], v[250:253]
  v_mul_f32 v204, v204, v120
  v_mul_f32 v205, v205, v120
  v_mfma_f32_16x16x32_bf16 v[250:253], a[36:39], v[138:141], v[250:253]
  ds_write_b128 v18, v[206:209] offset:8192
  v_mfma_f32_16x16x32_bf16 v[250:253], a[40:43], v[142:145], v[250:253]
  s_waitcnt vmcnt(1)
  v_cvt_pk_bf16_f32 v173, v204, v205
  v_mul_f32 v194, 0x3ee9a3cd, v194
  v_mfma_f32_16x16x32_bf16 v[250:253], a[44:47], v[146:149], v[250:253]
  v_rcp_f32 v118, v194
  v_mfma_f32_16x16x32_bf16 v[202:205], a[246:249], v[226:229], 0
  ds_write_b128 v16, v[246:249] offset:20480
  v_mfma_f32_16x16x32_bf16 v[202:205], a[246:249], v[122:125], v[202:205]
  v_cvt_pk_bf16_f32 v152, v250, v251
  v_cvt_pk_bf16_f32 v153, v252, v253
  v_mfma_f32_16x16x32_bf16 v[158:161], v[162:165], v[226:229], 0
  ds_write_b128 v16, v[170:173] offset:26624
  v_mfma_f32_16x16x32_bf16 v[158:161], v[106:109], v[122:125], v[158:161]
  v_mul_f32 v202, 0x3ee9a3cd, v202
  v_cndmask_b32 v108, v210, v190, s[54:55]
  v_mfma_f32_16x16x32_bf16 v[162:165], v[154:157], v[226:229], 0
  v_rcp_f32 v119, v202
  v_mfma_f32_16x16x32_bf16 v[162:165], v[110:113], v[122:125], v[162:165]
  ds_read_b64_tr_b16 v[154:155], v255 offset:9216
  ds_read_b64_tr_b16 v[190:191], v255 offset:9248
  v_mfma_f32_16x16x32_bf16 v[210:213], v[174:177], v[226:229], 0
  ds_read_b64_tr_b16 v[174:175], v255 offset:9280
  v_mul_f32 v158, v158, v119
  v_mfma_f32_16x16x32_bf16 v[210:213], v[114:117], v[122:125], v[210:213]
  ds_read_b64_tr_b16 v[226:227], v255 offset:10752
  ds_read_b64_tr_b16 v[170:171], v255 offset:10784
  v_mfma_f32_16x16x32_bf16 v[250:253], a[48:51], v[126:129], 0
  ds_read_b64_tr_b16 v[246:247], v255 offset:10816
  v_mul_f32 v159, v159, v119
  v_mfma_f32_16x16x32_bf16 v[250:253], a[52:55], v[130:133], v[250:253]
  ds_read_b64_tr_b16 v[228:229], v255 offset:12288
  v_cvt_pk_bf16_f32 v206, v158, v159
  v_mfma_f32_16x16x32_bf16 v[250:253], a[56:59], v[134:137], v[250:253]
  ds_read_b64_tr_b16 v[172:173], v255 offset:12320
  ds_read_b64_tr_b16 v[248:249], v255 offset:12352
  v_mfma_f32_16x16x32_bf16 v[250:253], a[60:63], v[138:141], v[250:253]
  ds_read_b64_tr_b16 v[156:157], v255 offset:13824
  v_mul_f32 v160, v160, v119
  v_mfma_f32_16x16x32_bf16 v[250:253], a[64:67], v[142:145], v[250:253]
  ds_read_b64_tr_b16 v[192:193], v255 offset:13856
  v_mul_f32 v161, v161, v119
  v_mfma_f32_16x16x32_bf16 v[250:253], a[68:71], v[146:149], v[250:253]
  ds_read_b64_tr_b16 v[176:177], v255 offset:13888
  v_mul_f32 v162, v162, v119
  v_mfma_f32_16x16x32_bf16 v[242:245], a[72:75], v[126:129], 0
  v_mul_f32 v163, v163, v119
  v_mul_f32 v164, v164, v119
  v_mfma_f32_16x16x32_bf16 v[242:245], a[76:79], v[130:133], v[242:245]
  v_mul_f32 v165, v165, v119
  v_cvt_pk_bf16_f32 v207, v160, v161
  v_mfma_f32_16x16x32_bf16 v[242:245], a[80:83], v[134:137], v[242:245]
  s_waitcnt lgkmcnt(4)
  ds_write_b128 v18, v[226:229] offset:9216
  v_mfma_f32_16x16x32_bf16 v[242:245], a[84:87], v[138:141], v[242:245]
  s_waitcnt lgkmcnt(3)
  v_cvt_pk_bf16_f32 v208, v162, v163
  v_cvt_pk_bf16_f32 v209, v164, v165
  v_mfma_f32_16x16x32_bf16 v[242:245], a[88:91], v[142:145], v[242:245]
  s_waitcnt lgkmcnt(2)
  ds_write_b128 v18, v[170:173] offset:10240
  v_mfma_f32_16x16x32_bf16 v[242:245], a[92:95], v[146:149], v[242:245]
  s_waitcnt lgkmcnt(2)
  v_mul_f32 v178, v178, v254
  v_mul_f32 v179, v179, v254
  v_mfma_f32_16x16x32_bf16 v[170:173], a[96:99], v[126:129], 0
  ds_write_b128 v18, v[246:249] offset:11264
  v_mfma_f32_16x16x32_bf16 v[170:173], a[100:103], v[130:133], v[170:173]
  v_mul_f32 v180, v180, v254
  v_mul_f32 v181, v181, v254
  v_mfma_f32_16x16x32_bf16 v[170:173], a[104:107], v[134:137], v[170:173]
  v_mul_f32 v222, v222, v120
  v_mul_f32 v223, v223, v120
  v_mfma_f32_16x16x32_bf16 v[170:173], a[108:111], v[138:141], v[170:173]
  ds_write_b128 v18, v[154:157] offset:12288
  v_mfma_f32_16x16x32_bf16 v[170:173], a[112:115], v[142:145], v[170:173]
  v_mul_f32 v224, v224, v120
  v_mul_f32 v225, v225, v120
  v_mfma_f32_16x16x32_bf16 v[170:173], a[116:119], v[146:149], v[170:173]
  ds_write_b128 v18, v[190:193] offset:13312
  v_mfma_f32_16x16x32_bf16 v[158:161], a[120:123], v[126:129], 0
  v_mul_f32 v210, v210, v119
  v_mul_f32 v211, v211, v119
  v_mfma_f32_16x16x32_bf16 v[158:161], a[124:127], v[130:133], v[158:161]
  v_mul_f32 v212, v212, v119
  v_mul_f32 v213, v213, v119
  v_mfma_f32_16x16x32_bf16 v[158:161], a[128:131], v[134:137], v[158:161]
  ds_write_b128 v18, v[174:177] offset:14336
  v_mfma_f32_16x16x32_bf16 v[158:161], a[132:135], v[138:141], v[158:161]
  v_cndmask_b32 v108, v182, v108, s[56:57]
  v_cvt_pk_bf16_f32 v114, v178, v179
  v_mfma_f32_16x16x32_bf16 v[158:161], a[136:139], v[142:145], v[158:161]
  ds_write_b128 v16, v[206:209] offset:32768
  v_mfma_f32_16x16x32_bf16 v[158:161], a[140:143], v[146:149], v[158:161]
  v_cvt_pk_bf16_f32 v115, v180, v181
  v_cvt_pk_bf16_f32 v122, v222, v223
  v_cvt_pk_bf16_f32 v123, v224, v225
  v_cvt_pk_bf16_f32 v164, v210, v211
  v_cvt_pk_bf16_f32 v165, v212, v213
  v_mul_f32 v108, v108, v118
  ds_write_b64 v17, v[114:115] offset:20480
  ds_write_b64 v17, v[122:123] offset:26624
  v_cvt_pk_bf16_f32 v108, v108, v108
  v_cvt_pk_bf16_f32 v162, v250, v251
  ds_write_b64 v17, v[164:165] offset:32768
  v_cvt_pk_bf16_f32 v163, v252, v253
  v_max3_f32 v1, v1, v198, v254
  ds_write_b16 v20, v108 offset:384
  v_max3_f32 v1, v1, v214, v120
  v_cvt_pk_bf16_f32 v154, v242, v243
  v_cvt_pk_bf16_f32 v155, v244, v245
  v_max3_f32 v1, v1, v194, v118
  v_cvt_pk_bf16_f32 v156, v170, v171
  v_cvt_pk_bf16_f32 v157, v172, v173
  v_add_u32 v20, 1160, v20
  v_max3_f32 v1, v1, v202, v119
  s_waitcnt lgkmcnt(0)
  s_barrier
  s_mov_b32 s70, 10
.p2align 6
L_loop:
  v_mfma_f32_16x16x32_bf16 v[166:169], v[126:129], a[144:147], 0
  s_mov_b32 m0, s58
  v_cndmask_b32 v108, v21, 2.0, s[52:53]
  v_mfma_f32_16x16x32_bf16 v[166:169], v[130:133], a[148:151], v[166:169]
  buffer_load_dwordx4 v108, s[4:7], s36 offen lds
  v_mfma_f32_16x16x32_bf16 v[166:169], v[134:137], a[152:155], v[166:169]
  ds_read_b128 v[170:173], v15 offset:20480
  ds_read_b128 v[174:177], v15 offset:26624
  v_mfma_f32_16x16x32_bf16 v[166:169], v[138:141], a[156:159], v[166:169]
  ds_read_b128 v[178:181], v15 offset:32768
  v_cvt_pk_bf16_f32 v164, v158, v159
  v_mfma_f32_16x16x32_bf16 v[166:169], v[142:145], a[160:163], v[166:169]
  ds_read_b64 v[106:107], v117 offset:896
  ds_read_b64 v[110:111], v117 offset:1792
  v_mfma_f32_16x16x32_bf16 v[166:169], v[146:149], a[164:167], v[166:169]
  v_cvt_pk_bf16_f32 v165, v160, v161
  s_nop 6
  v_cvt_pk_bf16_f32 v158, v166, v167
  v_cvt_pk_bf16_f32 v159, v168, v169
  s_waitcnt lgkmcnt(4)
  v_mfma_f32_16x16x32_bf16 v[26:29], a[250:253], v[170:173], v[26:29]
  buffer_load_dwordx4 v108, s[4:7], s37 offen offset:864 lds
  v_mfma_f32_16x16x32_bf16 v[30:33], v[98:101], v[170:173], v[30:33]
  v_mfma_f32_16x16x32_bf16 v[34:37], v[102:105], v[170:173], v[34:37]
  s_waitcnt lgkmcnt(1)
  ds_read_b128 v[170:173], v18
  ds_read_b128 v[166:169], v15 offset:21504
  v_mfma_f32_16x16x32_bf16 v[38:41], a[250:253], v[174:177], v[38:41]
  s_waitcnt lgkmcnt(2)
  ds_read_b128 v[182:185], v18 offset:1024
  v_fma_f32 v186, v74, v106, v107
  v_mfma_f32_16x16x32_bf16 v[42:45], v[98:101], v[174:177], v[42:45]
  ds_read_b128 v[190:193], v18 offset:2048
  v_fma_f32 v112, v75, v106, v107
  v_mfma_f32_16x16x32_bf16 v[46:49], v[102:105], v[174:177], v[46:49]
  ds_read_b128 v[174:177], v15 offset:27648
  v_cvt_pk_bf16_f32 v186, v186, v112
  v_mfma_f32_16x16x32_bf16 v[50:53], a[250:253], v[178:181], v[50:53]
  v_fma_f32 v187, v76, v106, v107
  v_fma_f32 v112, v77, v106, v107
  v_mfma_f32_16x16x32_bf16 v[54:57], v[98:101], v[178:181], v[54:57]
  buffer_load_dwordx4 v108, s[4:7], s38 offen offset:1728 lds
  v_mfma_f32_16x16x32_bf16 v[58:61], v[102:105], v[178:181], v[58:61]
  ds_read_b128 v[178:181], v15 offset:33792
  v_cvt_pk_bf16_f32 v187, v187, v112
  v_mfma_f32_16x16x32_bf16 v[194:197], v[126:129], a[168:171], 0
  v_fma_f32 v188, v78, v106, v107
  v_fma_f32 v112, v79, v106, v107
  v_mfma_f32_16x16x32_bf16 v[194:197], v[130:133], a[172:175], v[194:197]
  v_cvt_pk_bf16_f32 v188, v188, v112
  v_fma_f32 v189, v80, v106, v107
  v_mfma_f32_16x16x32_bf16 v[194:197], v[134:137], a[176:179], v[194:197]
  v_fma_f32 v112, v81, v106, v107
  v_cvt_pk_bf16_f32 v189, v189, v112
  v_mfma_f32_16x16x32_bf16 v[194:197], v[138:141], a[180:183], v[194:197]
  ds_write_b128 v16, v[186:189] offset:8192
  v_mfma_f32_16x16x32_bf16 v[194:197], v[142:145], a[184:187], v[194:197]
  v_fma_f32 v186, v86, v110, v111
  v_fma_f32 v112, v87, v110, v111
  v_mfma_f32_16x16x32_bf16 v[194:197], v[146:149], a[188:191], v[194:197]
  s_waitcnt lgkmcnt(5)
  buffer_load_dwordx4 v108, s[4:7], s39 offen offset:2592 lds
  v_mfma_f32_16x16x32_bf16 v[26:29], v[170:173], v[166:169], v[26:29]
  s_waitcnt lgkmcnt(4)
  v_cvt_pk_bf16_f32 v186, v186, v112
  v_fma_f32 v187, v88, v110, v111
  v_mfma_f32_16x16x32_bf16 v[30:33], v[182:185], v[166:169], v[30:33]
  s_waitcnt lgkmcnt(3)
  v_cvt_pk_bf16_f32 v198, v194, v195
  v_cvt_pk_bf16_f32 v199, v196, v197
  v_mfma_f32_16x16x32_bf16 v[34:37], v[190:193], v[166:169], v[34:37]
  s_waitcnt lgkmcnt(2)
  ds_read_b128 v[166:169], v18 offset:6144
  ds_read_b128 v[194:197], v15 offset:22528
  v_mfma_f32_16x16x32_bf16 v[38:41], v[170:173], v[174:177], v[38:41]
  ds_read_b128 v[202:205], v18 offset:7168
  v_fma_f32 v112, v89, v110, v111
  v_mfma_f32_16x16x32_bf16 v[42:45], v[182:185], v[174:177], v[42:45]
  ds_read_b128 v[206:209], v18 offset:8192
  v_cvt_pk_bf16_f32 v187, v187, v112
  v_mfma_f32_16x16x32_bf16 v[46:49], v[190:193], v[174:177], v[46:49]
  s_waitcnt lgkmcnt(5)
  ds_read_b128 v[174:177], v15 offset:28672
  v_fma_f32 v188, v90, v110, v111
  v_mfma_f32_16x16x32_bf16 v[50:53], v[170:173], v[178:181], v[50:53]
  buffer_load_dwordx4 v108, s[4:7], s40 offen offset:3456 lds
  v_mfma_f32_16x16x32_bf16 v[54:57], v[182:185], v[178:181], v[54:57]
  s_mov_b32 m0, s59
  v_fma_f32 v112, v91, v110, v111
  v_cvt_pk_bf16_f32 v188, v188, v112
  v_mfma_f32_16x16x32_bf16 v[58:61], v[190:193], v[178:181], v[58:61]
  ds_read_b128 v[170:173], v15 offset:34816
  ds_read_b64 v[254:255], v19 offset:784
  v_mfma_f32_16x16x32_bf16 v[178:181], v[126:129], a[192:195], 0
  ds_read2_b64 v[190:193], v19 offset0:96 offset1:97
  v_fma_f32 v189, v92, v110, v111
  v_mfma_f32_16x16x32_bf16 v[178:181], v[130:133], a[196:199], v[178:181]
  v_fma_f32 v112, v93, v110, v111
  v_cvt_pk_bf16_f32 v189, v189, v112
  v_mfma_f32_16x16x32_bf16 v[178:181], v[134:137], a[200:203], v[178:181]
  ds_write_b128 v16, v[186:189] offset:14336
  v_mfma_f32_16x16x32_bf16 v[178:181], v[138:141], a[204:207], v[178:181]
  v_fma_f32 v114, v82, v106, v107
  v_fma_f32 v112, v83, v106, v107
  v_mfma_f32_16x16x32_bf16 v[178:181], v[142:145], a[208:211], v[178:181]
  buffer_load_dwordx4 v108, s[4:7], s41 offen lds
  v_mfma_f32_16x16x32_bf16 v[178:181], v[146:149], a[212:215], v[178:181]
  s_waitcnt lgkmcnt(7)
  v_cvt_pk_bf16_f32 v114, v114, v112
  v_fma_f32 v115, v84, v106, v107
  v_mfma_f32_16x16x32_bf16 v[26:29], v[166:169], v[194:197], v[26:29]
  s_waitcnt lgkmcnt(6)
  ds_read_b128 v[146:149], v18 offset:9216
  ds_read_b128 v[142:145], v15 offset:23552
  v_mfma_f32_16x16x32_bf16 v[30:33], v[202:205], v[194:197], v[30:33]
  s_waitcnt lgkmcnt(7)
  ds_read_b128 v[138:141], v18 offset:10240
  v_cvt_pk_bf16_f32 v186, v178, v179
  v_mfma_f32_16x16x32_bf16 v[34:37], v[206:209], v[194:197], v[34:37]
  s_waitcnt lgkmcnt(7)
  ds_read_b128 v[134:137], v18 offset:11264
  v_cvt_pk_bf16_f32 v187, v180, v181
  v_mfma_f32_16x16x32_bf16 v[38:41], v[166:169], v[174:177], v[38:41]
  ds_read_b128 v[130:133], v15 offset:29696
  v_fma_f32 v112, v85, v106, v107
  v_mfma_f32_16x16x32_bf16 v[42:45], v[202:205], v[174:177], v[42:45]
  v_cvt_pk_bf16_f32 v115, v115, v112
  v_fma_f32 v106, v94, v110, v111
  v_mfma_f32_16x16x32_bf16 v[46:49], v[206:209], v[174:177], v[46:49]
  s_waitcnt lgkmcnt(8)
  buffer_load_dwordx4 v108, s[4:7], s42 offen offset:864 lds
  v_mfma_f32_16x16x32_bf16 v[50:53], v[166:169], v[170:173], v[50:53]
  ds_read_b128 v[166:169], v15 offset:35840
  v_fma_f32 v112, v95, v110, v111
  v_mfma_f32_16x16x32_bf16 v[54:57], v[202:205], v[170:173], v[54:57]
  ds_write_b64 v17, v[114:115] offset:8192
  v_mfma_f32_16x16x32_bf16 v[58:61], v[206:209], v[170:173], v[58:61]
  s_waitcnt lgkmcnt(9)
  v_cvt_pk_bf16_f32 v106, v106, v112
  v_fma_f32 v107, v96, v110, v111
  v_fma_f32 v112, v97, v110, v111
  v_mfma_f32_16x16x16_bf16 v[170:173], v[164:165], v[162:163], 0
  v_cvt_pk_bf16_f32 v107, v107, v112
  v_mfma_f32_16x16x16_bf16 v[126:129], v[164:165], v[254:255], 0
  ds_read_b128 v[206:209], v18 offset:3072
  ds_read_b128 v[202:205], v15 offset:24576
  ds_read_b128 v[174:177], v18 offset:4096
  v_mfma_f32_16x16x32_bf16 v[170:173], v[154:157], v[150:153], v[170:173]
  s_waitcnt lgkmcnt(11)
  ds_read_b128 v[178:181], v18 offset:5120
  v_mfma_f32_16x16x32_bf16 v[126:129], v[154:157], v[190:193], v[126:129]
  s_waitcnt lgkmcnt(9)
  buffer_load_dwordx4 v108, s[4:7], s43 offen offset:1728 lds
  v_mfma_f32_16x16x32_bf16 v[26:29], v[146:149], v[142:145], v[26:29]
  s_waitcnt lgkmcnt(8)
  ds_read_b128 v[194:197], v15 offset:30720
  v_mfma_f32_16x16x32_bf16 v[30:33], v[138:141], v[142:145], v[30:33]
  s_waitcnt lgkmcnt(8)
  ds_write_b64 v17, v[106:107] offset:14336
  v_mfma_f32_16x16x32_bf16 v[34:37], v[134:137], v[142:145], v[34:37]
  s_waitcnt lgkmcnt(8)
  ds_read_b128 v[142:145], v15 offset:36864
  v_mfma_f32_16x16x32_bf16 v[38:41], v[146:149], v[130:133], v[38:41]
  v_exp_f32 v170, v170
  v_mfma_f32_16x16x32_bf16 v[42:45], v[138:141], v[130:133], v[42:45]
  v_exp_f32 v171, v171
  v_mfma_f32_16x16x32_bf16 v[46:49], v[134:137], v[130:133], v[46:49]
  s_waitcnt lgkmcnt(8)
  ds_read_b128 v[130:133], v18 offset:12288
  ds_read_b128 v[182:185], v15 offset:25600
  v_mfma_f32_16x16x32_bf16 v[50:53], v[146:149], v[166:169], v[50:53]
  buffer_load_dwordx4 v108, s[4:7], s44 offen offset:2592 lds
  v_mfma_f32_16x16x32_bf16 v[54:57], v[138:141], v[166:169], v[54:57]
  s_lshl_b32 s60, s31, 5
  ds_read_b128 v[146:149], v18 offset:13312
  ds_read_b128 v[138:141], v18 offset:14336
  v_mfma_f32_16x16x32_bf16 v[58:61], v[134:137], v[166:169], v[58:61]
  s_waitcnt lgkmcnt(9)
  v_exp_f32 v172, v172
  v_mfma_f32_16x16x32_bf16 v[26:29], v[206:209], v[202:205], v[26:29]
  s_waitcnt lgkmcnt(8)
  v_exp_f32 v173, v173
  v_mfma_f32_16x16x32_bf16 v[30:33], v[174:177], v[202:205], v[30:33]
  s_waitcnt lgkmcnt(7)
  ds_read_b128 v[134:137], v15 offset:31744
  v_cvt_pk_bf16_f32 v210, v170, v171
  v_mfma_f32_16x16x32_bf16 v[34:37], v[178:181], v[202:205], v[34:37]
  s_waitcnt lgkmcnt(7)
  v_exp_f32 v126, v126
  v_mfma_f32_16x16x32_bf16 v[38:41], v[206:209], v[194:197], v[38:41]
  s_add_u32 s61, s60, s30
  v_exp_f32 v127, v127
  v_mfma_f32_16x16x32_bf16 v[42:45], v[174:177], v[194:197], v[42:45]
  s_add_u32 s60, s60, s29
  v_exp_f32 v128, v128
  v_mfma_f32_16x16x32_bf16 v[46:49], v[178:181], v[194:197], v[46:49]
  s_waitcnt lgkmcnt(5)
  v_exp_f32 v129, v129
  v_mfma_f32_16x16x32_bf16 v[50:53], v[206:209], v[142:145], v[50:53]
  s_mul_i32 s62, s60, 7183
  ds_read_b128 v[166:169], v15 offset:37888
  v_cvt_pk_bf16_f32 v211, v172, v173
  v_mfma_f32_16x16x32_bf16 v[54:57], v[174:177], v[142:145], v[54:57]
  s_lshr_b32 s62, s62, 22
  v_cvt_pk_bf16_f32 v174, v126, v127
  v_cvt_pk_bf16_f32 v175, v128, v129
  v_mfma_f32_16x16x32_bf16 v[58:61], v[178:181], v[142:145], v[58:61]
  s_waitcnt lgkmcnt(4)
  s_barrier
  v_mfma_f32_16x16x32_bf16 v[26:29], v[130:133], v[182:185], v[26:29]
  s_waitcnt lgkmcnt(3)
  ds_read_b128 v[178:181], v15 offset:8192
  ds_read_b128 v[206:209], v15 offset:9216
  v_mfma_f32_16x16x32_bf16 v[30:33], v[146:149], v[182:185], v[30:33]
  s_waitcnt lgkmcnt(4)
  ds_read_b128 v[194:197], v15 offset:10240
  v_mfma_f32_16x16x32_bf16 v[34:37], v[138:141], v[182:185], v[34:37]
  s_waitcnt lgkmcnt(4)
  ds_read_b128 v[182:185], v15 offset:11264
  v_cvt_pk_bf16_f32 v142, v26, v27
  v_mfma_f32_16x16x32_bf16 v[38:41], v[130:133], v[134:137], v[38:41]
  s_mul_i32 s63, s62, 584
  ds_read_b128 v[202:205], v15 offset:12288
  v_cvt_pk_bf16_f32 v143, v28, v29
  v_mfma_f32_16x16x32_bf16 v[42:45], v[146:149], v[134:137], v[42:45]
  s_sub_u32 s63, s60, s63
  ds_read_b128 v[214:217], v15 offset:13312
  v_cvt_pk_bf16_f32 v144, v30, v31
  v_mfma_f32_16x16x32_bf16 v[46:49], v[138:141], v[134:137], v[46:49]
  s_waitcnt lgkmcnt(6)
  v_cvt_pk_bf16_f32 v145, v32, v33
  v_cvt_pk_bf16_f32 v218, v34, v35
  v_mfma_f32_16x16x32_bf16 v[50:53], v[130:133], v[166:169], v[50:53]
  s_lshr_b32 s64, s63, 3
  v_permlane16_swap_b32 v142, v144
  v_mfma_f32_16x16x32_bf16 v[54:57], v[146:149], v[166:169], v[54:57]
  s_and_b32 s65, s63, 7
  v_permlane16_swap_b32 v143, v145
  v_mfma_f32_16x16x32_bf16 v[58:61], v[138:141], v[166:169], v[58:61]
  s_waitcnt lgkmcnt(5)
  buffer_store_dwordx4 v[142:145], v12, s[8:11], s32 offen
  v_cvt_pk_bf16_f32 v219, v36, v37
  v_mfma_f32_16x16x32_bf16 v[166:169], a[72:75], v[178:181], 0
  s_waitcnt lgkmcnt(4)
  v_cvt_pk_bf16_f32 v222, v38, v39
  v_cvt_pk_bf16_f32 v223, v40, v41
  v_mfma_f32_16x16x32_bf16 v[166:169], a[76:79], v[206:209], v[166:169]
  s_waitcnt lgkmcnt(3)
  v_cvt_pk_bf16_f32 v224, v42, v43
  v_cvt_pk_bf16_f32 v225, v44, v45
  v_mfma_f32_16x16x32_bf16 v[166:169], a[80:83], v[194:197], v[166:169]
  s_waitcnt vmcnt(1) lgkmcnt(2)
  ds_read_b64 v[106:107], v9
  ds_read_b64 v[110:111], v9 offset:32
  v_mfma_f32_16x16x32_bf16 v[166:169], a[84:87], v[182:185], v[166:169]
  s_waitcnt lgkmcnt(3)
  ds_read_b64 v[114:115], v9 offset:64
  v_cvt_pk_bf16_f32 v220, v46, v47
  v_mfma_f32_16x16x32_bf16 v[166:169], a[88:91], v[202:205], v[166:169]
  s_waitcnt lgkmcnt(3)
  ds_read_b128 v[142:145], v3
  v_cvt_pk_bf16_f32 v221, v48, v49
  v_mfma_f32_16x16x32_bf16 v[166:169], a[92:95], v[214:217], v[166:169]
  s_lshl_b32 s66, s62, 3
  ds_read_b128 v[146:149], v3 offset:864
  s_add_u32 s65, s65, s66
  s_cmp_ge_u32 s60, 5256
  ds_read_b128 v[134:137], v3 offset:1728
  v_permlane16_swap_b32 v222, v224
  s_cselect_b32 s64, s63, s64
  s_cselect_b32 s65, 72, s65
  ds_read_b128 v[138:141], v6
  v_cvt_pk_bf16_f32 v226, v166, v167
  s_waitcnt lgkmcnt(6)
  v_mfma_f32_16x16x16_bf16 v[26:29], a[224:225], v[106:107], 0
  ds_read_b128 v[126:129], v3 offset:32
  v_cvt_pk_bf16_f32 v227, v168, v169
  s_waitcnt lgkmcnt(6)
  v_mfma_f32_16x16x16_bf16 v[30:33], a[234:235], v[110:111], 0
  ds_read_b128 v[130:133], v3 offset:896
  v_cvt_pk_bf16_f32 v230, v50, v51
  s_waitcnt lgkmcnt(6)
  v_mfma_f32_16x16x16_bf16 v[34:37], a[244:245], v[114:115], 0
  ds_read_b128 v[166:169], v3 offset:1760
  s_mul_i32 s66, s65, 1373568
  s_mul_i32 s67, s64, 2688
  ds_read_b128 v[170:173], v6 offset:32
  v_permlane16_swap_b32 v223, v225
  s_waitcnt lgkmcnt(6)
  v_smfmac_f32_16x16x64_bf16 v[26:29], a[216:219], v[142:149], v0
  s_add_u32 s35, s66, s67
  ds_read_b128 v[142:145], v3 offset:64
  s_cmp_ge_u32 s61, 667
  ds_read_b128 v[146:149], v3 offset:928
  v_permlane16_swap_b32 v218, v220
  s_waitcnt lgkmcnt(6)
  v_smfmac_f32_16x16x64_bf16 v[26:29], a[220:223], v[134:141], v0
  s_cselect_b32 s35, 268435456, s35
  ds_read_b128 v[134:137], v3 offset:1792
  v_cvt_pk_bf16_f32 v231, v52, v53
  v_mfma_f32_16x16x32_bf16 v[234:237], a[96:99], v[178:181], 0
  s_cmp_ge_u32 s60, 5329
  ds_read_b128 v[138:141], v6 offset:64
  v_cvt_pk_bf16_f32 v232, v54, v55
  v_mfma_f32_16x16x32_bf16 v[234:237], a[100:103], v[206:209], v[234:237]
  s_cselect_b32 s35, 268435456, s35
  buffer_store_dwordx4 v[222:225], v13, s[8:11], s32 offen
  v_cvt_pk_bf16_f32 v233, v56, v57
  v_mfma_f32_16x16x32_bf16 v[234:237], a[104:107], v[194:197], v[234:237]
  s_waitcnt lgkmcnt(6)
  v_permlane16_swap_b32 v219, v221
  v_smfmac_f32_16x16x64_bf16 v[30:33], a[226:229], v[126:133], v0
  s_waitcnt lgkmcnt(4)
  v_cvt_pk_bf16_f32 v106, v58, v59
  v_smfmac_f32_16x16x64_bf16 v[30:33], a[230:233], v[166:173], v0
  s_cmp_eq_u32 s65, 0
  v_cvt_pk_bf16_f32 v107, v60, v61
  v_mfma_f32_16x16x32_bf16 v[234:237], a[108:111], v[182:185], v[234:237]
  s_cselect_b32 s36, 268435456, s35
  v_permlane16_swap_b32 v230, v232
  v_mfma_f32_16x16x32_bf16 v[234:237], a[112:115], v[202:205], v[234:237]
  s_add_u32 s37, s35, 195360
  v_permlane16_swap_b32 v231, v233
  v_mfma_f32_16x16x32_bf16 v[234:237], a[116:119], v[214:217], v[234:237]
  s_waitcnt lgkmcnt(2)
  v_mul_f32 v108, v26, v26
  v_add_f32 v112, v26, v27
  v_smfmac_f32_16x16x64_bf16 v[34:37], a[236:239], v[142:149], v0
  s_waitcnt lgkmcnt(0)
  v_fmac_f32 v108, v27, v27
  v_smfmac_f32_16x16x64_bf16 v[34:37], a[240:243], v[134:141], v0
  s_add_u32 s38, s35, 390720
  v_cvt_pk_bf16_f32 v228, v234, v235
  v_mfma_f32_16x16x32_bf16 v[166:169], a[120:123], v[178:181], 0
  s_add_u32 s39, s35, 586080
  v_cvt_pk_bf16_f32 v229, v236, v237
  v_add_f32 v112, v112, v28
  v_mfma_f32_16x16x32_bf16 v[166:169], a[124:127], v[206:209], v[166:169]
  s_add_u32 s40, s35, 781440
  ds_read_b64 v[110:111], v10
  v_fmac_f32 v108, v28, v28
  v_mfma_f32_16x16x32_bf16 v[166:169], a[128:131], v[194:197], v[166:169]
  s_add_u32 s41, s35, 981120
  ds_read_b64 v[114:115], v10 offset:32
  v_add_f32 v112, v112, v29
  v_mfma_f32_16x16x32_bf16 v[166:169], a[132:135], v[182:185], v[166:169]
  s_add_u32 s42, s35, 1176480
  ds_read_b64 v[118:119], v10 offset:64
  v_fmac_f32 v108, v29, v29
  v_mfma_f32_16x16x32_bf16 v[166:169], a[136:139], v[202:205], v[166:169]
  s_add_u32 s43, s35, 1371840
  ds_read_b128 v[134:137], v4
  ds_read_b128 v[138:141], v4 offset:864
  v_mfma_f32_16x16x32_bf16 v[166:169], a[140:143], v[214:217], v[166:169]
  s_add_u32 s44, s35, 1567200
  ds_read_b128 v[142:145], v4 offset:1728
  v_add_f32 v112, v112, v30
  v_mfma_f32_16x16x32_bf16 v[234:237], a[0:3], v[178:181], 0
  s_cmp_eq_u32 s64, 0
  ds_read_b128 v[146:149], v7
  v_fmac_f32 v108, v30, v30
  v_mfma_f32_16x16x32_bf16 v[234:237], a[4:7], v[206:209], v[234:237]
  s_cselect_b64 s[52:53], s[48:49], 0
  buffer_store_dwordx4 v[218:221], v22, s[8:11], s32 offen
  v_cvt_pk_bf16_f32 v222, v166, v167
  v_mfma_f32_16x16x32_bf16 v[234:237], a[8:11], v[194:197], v[234:237]
  s_cmp_eq_u32 s64, 72
  v_cvt_pk_bf16_f32 v223, v168, v169
  v_add_f32 v112, v112, v31
  v_mfma_f32_16x16x32_bf16 v[234:237], a[12:15], v[182:185], v[234:237]
  s_cselect_b64 s[52:53], s[50:51], s[52:53]
  ds_read_b128 v[166:169], v4 offset:32
  ds_read_b128 v[170:173], v4 offset:896
  v_mfma_f32_16x16x32_bf16 v[234:237], a[16:19], v[202:205], v[234:237]
  s_add_u32 s31, s31, 1
  ds_read_b128 v[126:129], v4 offset:1760
  v_fmac_f32 v108, v31, v31
  v_mfma_f32_16x16x32_bf16 v[234:237], a[20:23], v[214:217], v[234:237]
  s_waitcnt lgkmcnt(5)
  ds_read_b128 v[130:133], v7 offset:32
  v_add_f32 v112, v112, v32
  v_fmac_f32 v108, v32, v32
  v_mfma_f32_16x16x16_bf16 v[38:41], a[224:225], v[110:111], 0
  v_add_f32 v112, v112, v33
  v_fmac_f32 v108, v33, v33
  v_add_f32 v112, v112, v34
  v_mfma_f32_16x16x16_bf16 v[42:45], a[234:235], v[114:115], 0
  v_cvt_pk_bf16_f32 v218, v234, v235
  v_cvt_pk_bf16_f32 v219, v236, v237
  v_fmac_f32 v108, v34, v34
  v_mfma_f32_16x16x16_bf16 v[46:49], a[244:245], v[118:119], 0
  v_add_f32 v112, v112, v35
  v_fmac_f32 v108, v35, v35
  v_add_f32 v112, v112, v36
  v_fmac_f32 v108, v36, v36
  v_smfmac_f32_16x16x64_bf16 v[38:41], a[216:219], v[134:141], v0
  s_waitcnt lgkmcnt(4)
  ds_read_b128 v[134:137], v4 offset:64
  ds_read_b128 v[138:141], v4 offset:928
  v_smfmac_f32_16x16x64_bf16 v[38:41], a[220:223], v[142:149], v0
  s_sub_u32 s68, s35, 196608
  ds_read_b128 v[142:145], v4 offset:1792
  v_add_f32 v112, v112, v37
  v_mfma_f32_16x16x32_bf16 v[234:237], a[24:27], v[178:181], 0
  s_cselect_b32 s68, s35, s68
  ds_read_b128 v[146:149], v7 offset:64
  v_fmac_f32 v108, v37, v37
  v_mfma_f32_16x16x32_bf16 v[234:237], a[28:31], v[206:209], v[234:237]
  v_mul_f32 v120, v38, v38
  v_add_f32 v116, v38, v39
  v_mfma_f32_16x16x32_bf16 v[234:237], a[32:35], v[194:197], v[234:237]
  s_waitcnt lgkmcnt(6)
  v_fmac_f32 v120, v39, v39
  v_add_f32 v116, v116, v40
  v_smfmac_f32_16x16x64_bf16 v[42:45], a[226:229], v[166:173], v0
  s_waitcnt lgkmcnt(4)
  v_fmac_f32 v120, v40, v40
  v_smfmac_f32_16x16x64_bf16 v[42:45], a[230:233], v[126:133], v0
  v_add_f32 v116, v116, v41
  v_mfma_f32_16x16x32_bf16 v[234:237], a[36:39], v[182:185], v[234:237]
  v_fmac_f32 v120, v41, v41
  v_mfma_f32_16x16x32_bf16 v[234:237], a[40:43], v[202:205], v[234:237]
  buffer_store_dwordx4 v[230:233], v14, s[8:11], s32 offen
  v_add_f32 v116, v116, v42
  v_mfma_f32_16x16x32_bf16 v[234:237], a[44:47], v[214:217], v[234:237]
  s_waitcnt lgkmcnt(2)
  v_fmac_f32 v120, v42, v42
  v_add_f32 v116, v116, v43
  v_smfmac_f32_16x16x64_bf16 v[46:49], a[236:239], v[134:141], v0
  s_waitcnt lgkmcnt(0)
  v_fmac_f32 v120, v43, v43
  v_smfmac_f32_16x16x64_bf16 v[46:49], a[240:243], v[142:149], v0
  v_cvt_pk_bf16_f32 v220, v234, v235
  v_mfma_f32_16x16x32_bf16 v[126:129], a[48:51], v[178:181], 0
  v_cvt_pk_bf16_f32 v221, v236, v237
  v_add_f32 v116, v116, v44
  v_mfma_f32_16x16x32_bf16 v[126:129], a[52:55], v[206:209], v[126:129]
  ds_read_b64 v[110:111], v11
  v_fmac_f32 v120, v44, v44
  v_mfma_f32_16x16x32_bf16 v[126:129], a[56:59], v[194:197], v[126:129]
  ds_read_b64 v[118:119], v11 offset:32
  v_add_f32 v116, v116, v45
  v_mfma_f32_16x16x32_bf16 v[126:129], a[60:63], v[182:185], v[126:129]
  ds_read_b64 v[114:115], v11 offset:64
  v_fmac_f32 v120, v45, v45
  v_mfma_f32_16x16x32_bf16 v[126:129], a[64:67], v[202:205], v[126:129]
  ds_read_b128 v[142:145], v5
  ds_read_b128 v[146:149], v5 offset:864
  v_mfma_f32_16x16x32_bf16 v[126:129], a[68:71], v[214:217], v[126:129]
  ds_read_b128 v[134:137], v5 offset:1728
  v_add_f32 v116, v116, v46
  v_mfma_f32_16x16x32_bf16 v[234:237], v[178:181], a[144:147], 0
  ds_read_b128 v[138:141], v8
  v_fmac_f32 v120, v46, v46
  v_mfma_f32_16x16x32_bf16 v[234:237], v[206:209], a[148:151], v[234:237]
  v_cvt_pk_bf16_f32 v122, v126, v127
  v_cvt_pk_bf16_f32 v123, v128, v129
  v_mfma_f32_16x16x32_bf16 v[234:237], v[194:197], a[152:155], v[234:237]
  v_add_f32 v116, v116, v47
  v_fmac_f32 v120, v47, v47
  v_mfma_f32_16x16x32_bf16 v[234:237], v[182:185], a[156:159], v[234:237]
  ds_read_b128 v[126:129], v5 offset:32
  ds_read_b128 v[130:133], v5 offset:896
  v_mfma_f32_16x16x32_bf16 v[234:237], v[202:205], a[160:163], v[234:237]
  ds_read_b128 v[166:169], v5 offset:1760
  v_add_f32 v116, v116, v48
  v_mfma_f32_16x16x32_bf16 v[234:237], v[214:217], a[164:167], v[234:237]
  s_waitcnt lgkmcnt(5)
  ds_read_b128 v[170:173], v8 offset:32
  v_fmac_f32 v120, v48, v48
  v_add_f32 v116, v116, v49
  v_mfma_f32_16x16x16_bf16 v[50:53], a[224:225], v[110:111], 0
  v_fmac_f32 v120, v49, v49
  v_permlane32_swap_b32 v112, v108
  v_mfma_f32_16x16x16_bf16 v[54:57], a[234:235], v[118:119], 0
  v_cvt_pk_bf16_f32 v160, v234, v235
  v_cvt_pk_bf16_f32 v161, v236, v237
  v_add_f32 v112, v112, v108
  v_mfma_f32_16x16x16_bf16 v[58:61], a[244:245], v[114:115], 0
  v_permlane32_swap_b32 v116, v120
  v_add_f32 v116, v116, v120
  v_smfmac_f32_16x16x64_bf16 v[50:53], a[216:219], v[142:149], v0
  s_waitcnt lgkmcnt(4)
  buffer_store_dwordx2 v[106:107], v23, s[8:11], s32 offen
  ds_read_b128 v[142:145], v5 offset:64
  v_smfmac_f32_16x16x64_bf16 v[50:53], a[220:223], v[134:141], v0
  s_mov_b32 s32, s33
  ds_read_b128 v[146:149], v5 offset:928
  ds_read_b128 v[134:137], v5 offset:1792
  v_mfma_f32_16x16x32_bf16 v[234:237], v[178:181], a[168:171], 0
  s_mov_b32 s33, s34
  ds_read_b128 v[138:141], v8 offset:64
  v_mfma_f32_16x16x32_bf16 v[234:237], v[206:209], a[172:175], v[234:237]
  s_mov_b32 s34, s35
  v_mul_f32 v108, v50, v50
  v_add_f32 v120, v50, v51
  v_mfma_f32_16x16x32_bf16 v[234:237], v[194:197], a[176:179], v[234:237]
  s_waitcnt lgkmcnt(6)
  buffer_load_dword v25, v24, s[24:27], s68 offen
  v_smfmac_f32_16x16x64_bf16 v[54:57], a[226:229], v[126:133], v0
  s_waitcnt lgkmcnt(4)
  v_fmac_f32 v108, v51, v51
  v_smfmac_f32_16x16x64_bf16 v[54:57], a[230:233], v[166:173], v0
  v_add_f32 v120, v120, v52
  v_mfma_f32_16x16x32_bf16 v[234:237], v[182:185], a[180:183], v[234:237]
  v_fmac_f32 v108, v52, v52
  v_add_f32 v120, v120, v53
  v_mfma_f32_16x16x32_bf16 v[234:237], v[202:205], a[184:187], v[234:237]
  v_fmac_f32 v108, v53, v53
  v_add_f32 v120, v120, v54
  v_mfma_f32_16x16x32_bf16 v[234:237], v[214:217], a[188:191], v[234:237]
  s_waitcnt lgkmcnt(2)
  v_fmac_f32 v108, v54, v54
  v_add_f32 v120, v120, v55
  v_smfmac_f32_16x16x64_bf16 v[58:61], a[236:239], v[142:149], v0
  s_waitcnt lgkmcnt(0)
  v_fmac_f32 v108, v55, v55
  v_smfmac_f32_16x16x64_bf16 v[58:61], a[240:243], v[134:141], v0
  ds_read_b128 v[134:137], v15 offset:14336
  v_add_f32 v120, v120, v56
  v_mfma_f32_16x16x32_bf16 v[126:129], v[178:181], a[192:195], 0
  ds_read_b128 v[130:133], v15 offset:15360
  v_fmac_f32 v108, v56, v56
  v_mfma_f32_16x16x32_bf16 v[126:129], v[206:209], a[196:199], v[126:129]
  ds_read_b128 v[138:141], v15 offset:16384
  v_add_f32 v120, v120, v57
  v_mfma_f32_16x16x32_bf16 v[126:129], v[194:197], a[200:203], v[126:129]
  ds_read_b128 v[142:145], v15 offset:17408
  v_fmac_f32 v108, v57, v57
  v_mfma_f32_16x16x32_bf16 v[126:129], v[182:185], a[204:207], v[126:129]
  ds_read_b128 v[146:149], v15 offset:18432
  v_add_f32 v120, v120, v58
  v_mfma_f32_16x16x32_bf16 v[126:129], v[202:205], a[208:211], v[126:129]
  ds_read_b128 v[202:205], v15 offset:19456
  v_fmac_f32 v108, v58, v58
  v_mfma_f32_16x16x32_bf16 v[126:129], v[214:217], a[212:215], v[126:129]
  v_cvt_pk_bf16_f32 v200, v234, v235
  v_cvt_pk_bf16_f32 v201, v236, v237
  v_add_f32 v120, v120, v59
  v_mfma_f32_16x16x16_bf16 v[234:237], v[222:223], v[162:163], 0
  v_fmac_f32 v108, v59, v59
  v_add_f32 v120, v120, v60
  v_fmac_f32 v108, v60, v60
  v_mfma_f32_16x16x16_bf16 v[214:217], v[164:165], v[122:123], 0
  v_add_f32 v120, v120, v61
  v_fmac_f32 v108, v61, v61
  v_permlane16_swap_b32 v112, v116
  v_mfma_f32_16x16x32_bf16 v[234:237], v[226:229], v[150:153], v[234:237]
  v_permlane32_swap_b32 v120, v108
  v_mfma_f32_16x16x32_bf16 v[214:217], v[154:157], v[218:221], v[214:217]
  s_waitcnt lgkmcnt(5)
  v_add_f32 v120, v120, v108
  v_mov_b32 v108, v120
  v_mfma_f32_16x16x32_bf16 v[182:185], a[72:75], v[134:137], 0
  s_waitcnt lgkmcnt(4)
  v_permlane16_swap_b32 v120, v108
  v_mfma_f32_16x16x32_bf16 v[182:185], a[76:79], v[130:133], v[182:185]
  s_waitcnt lgkmcnt(3)
  v_add_f32 v112, v112, v116
  v_add_f32 v120, v120, v108
  v_mfma_f32_16x16x32_bf16 v[182:185], a[80:83], v[138:141], v[182:185]
  s_waitcnt lgkmcnt(2)
  ds_write_b32 v109, v112
  v_mfma_f32_16x16x32_bf16 v[182:185], a[84:87], v[142:145], v[182:185]
  s_waitcnt lgkmcnt(2)
  ds_write_b32 v109, v120 offset:512
  v_mfma_f32_16x16x32_bf16 v[182:185], a[88:91], v[146:149], v[182:185]
  s_waitcnt lgkmcnt(2)
  v_cvt_pk_bf16_f32 v188, v126, v127
  v_cvt_pk_bf16_f32 v189, v128, v129
  v_mfma_f32_16x16x32_bf16 v[182:185], a[92:95], v[202:205], v[182:185]
  v_exp_f32 v234, v234
  v_mfma_f32_16x16x32_bf16 v[126:129], a[96:99], v[134:137], 0
  v_exp_f32 v235, v235
  v_mfma_f32_16x16x32_bf16 v[126:129], a[100:103], v[130:133], v[126:129]
  v_exp_f32 v236, v236
  v_mfma_f32_16x16x32_bf16 v[126:129], a[104:107], v[138:141], v[126:129]
  v_exp_f32 v237, v237
  v_mfma_f32_16x16x32_bf16 v[126:129], a[108:111], v[142:145], v[126:129]
  v_exp_f32 v214, v214
  v_mfma_f32_16x16x32_bf16 v[126:129], a[112:115], v[146:149], v[126:129]
  v_exp_f32 v215, v215
  v_mfma_f32_16x16x32_bf16 v[126:129], a[116:119], v[202:205], v[126:129]
  s_waitcnt lgkmcnt(0)
  s_barrier
  v_mfma_f32_16x16x32_bf16 v[194:197], a[120:123], v[134:137], 0
  v_exp_f32 v216, v216
  v_mfma_f32_16x16x32_bf16 v[194:197], a[124:127], v[130:133], v[194:197]
  v_exp_f32 v217, v217
  v_mfma_f32_16x16x32_bf16 v[194:197], a[128:131], v[138:141], v[194:197]
  ds_read_b128 v[206:209], v15
  ds_read_b128 v[178:181], v15 offset:1024
  v_mfma_f32_16x16x32_bf16 v[194:197], a[132:135], v[142:145], v[194:197]
  v_cvt_pk_bf16_f32 v166, v182, v183
  v_cvt_pk_bf16_f32 v167, v184, v185
  v_mfma_f32_16x16x32_bf16 v[194:197], a[136:139], v[146:149], v[194:197]
  v_cvt_pk_bf16_f32 v212, v234, v235
  v_cvt_pk_bf16_f32 v213, v236, v237
  v_mfma_f32_16x16x32_bf16 v[194:197], a[140:143], v[202:205], v[194:197]
  v_cvt_pk_bf16_f32 v234, v214, v215
  v_cvt_pk_bf16_f32 v168, v126, v127
  v_cvt_pk_bf16_f32 v169, v128, v129
  v_mfma_f32_16x16x16_bf16 v[126:129], v[222:223], v[122:123], 0
  v_cvt_pk_bf16_f32 v235, v216, v217
  v_mfma_f32_16x16x16_bf16 v[214:217], v[222:223], v[254:255], 0
  ds_read_b64 v[224:225], v19 offset:16
  ds_read2_b64 v[182:185], v19 offset0:0 offset1:1
  v_cvt_pk_bf16_f32 v230, v194, v195
  v_cvt_pk_bf16_f32 v231, v196, v197
  v_mfma_f32_16x16x32_bf16 v[126:129], v[226:229], v[218:221], v[126:129]
  s_waitcnt lgkmcnt(2)
  v_add_f32 v206, v206, v207
  v_add_f32 v208, v208, v209
  v_mfma_f32_16x16x32_bf16 v[214:217], v[226:229], v[190:193], v[214:217]
  v_add_f32 v178, v178, v179
  v_add_f32 v180, v180, v181
  v_mfma_f32_16x16x32_bf16 v[194:197], v[134:137], a[144:147], 0
  v_exp_f32 v126, v126
  v_mfma_f32_16x16x32_bf16 v[194:197], v[130:133], a[148:151], v[194:197]
  v_exp_f32 v127, v127
  v_mfma_f32_16x16x32_bf16 v[194:197], v[138:141], a[152:155], v[194:197]
  v_exp_f32 v128, v128
  v_mfma_f32_16x16x32_bf16 v[194:197], v[142:145], a[156:159], v[194:197]
  v_exp_f32 v129, v129
  v_mfma_f32_16x16x32_bf16 v[194:197], v[146:149], a[160:163], v[194:197]
  v_exp_f32 v214, v214
  v_mfma_f32_16x16x32_bf16 v[194:197], v[202:205], a[164:167], v[194:197]
  v_exp_f32 v215, v215
  v_mfma_f32_16x16x32_bf16 v[170:173], v[134:137], a[168:171], 0
  v_exp_f32 v216, v216
  v_mfma_f32_16x16x32_bf16 v[170:173], v[130:133], a[172:175], v[170:173]
  v_exp_f32 v217, v217
  v_mfma_f32_16x16x32_bf16 v[170:173], v[138:141], a[176:179], v[170:173]
  v_cvt_pk_bf16_f32 v236, v126, v127
  v_cvt_pk_bf16_f32 v237, v128, v129
  v_mfma_f32_16x16x32_bf16 v[170:173], v[142:145], a[180:183], v[170:173]
  v_cvt_pk_bf16_f32 v106, v194, v195
  v_cvt_pk_bf16_f32 v107, v196, v197
  v_mfma_f32_16x16x32_bf16 v[170:173], v[146:149], a[184:187], v[170:173]
  v_cvt_pk_bf16_f32 v176, v214, v215
  v_cvt_pk_bf16_f32 v177, v216, v217
  v_mfma_f32_16x16x32_bf16 v[170:173], v[202:205], a[188:191], v[170:173]
  s_waitcnt lgkmcnt(1)
  v_add_f32 v206, v206, v208
  v_add_f32 v178, v178, v180
  v_mul_f32 v207, 0x3baaaaab, v206
  v_mfma_f32_16x16x16_bf16 v[126:129], v[230:231], v[162:163], 0
  v_fma_f32 v178, -v207, v206, v178
  v_max_f32 v178, 0, v178
  v_add_f32 v178, 0x3afba882, v178
  v_mfma_f32_16x16x16_bf16 v[214:217], v[224:225], v[162:163], v[2:5]
  v_cvt_pk_bf16_f32 v110, v170, v171
  v_cvt_pk_bf16_f32 v111, v172, v173
  v_rsq_f32 v178, v178
  v_mfma_f32_16x16x32_bf16 v[126:129], v[166:169], v[150:153], v[126:129]
  s_waitcnt lgkmcnt(0)
  v_mul_f32 v178, 0x40ca568a, v178
  v_mul_f32 v179, -v207, v178
  v_mfma_f32_16x16x32_bf16 v[214:217], v[182:185], v[150:153], v[214:217]
  ds_write_b64 v113, v[178:179]
  v_mfma_f32_16x16x32_bf16 v[150:153], v[134:137], a[192:195], 0
  ds_read_b64 v[162:163], v117 offset:768
  v_add_u32 v19, 1160, v19
  v_mfma_f32_16x16x32_bf16 v[150:153], v[130:133], a[196:199], v[150:153]
  v_exp_f32 v126, v126
  v_mfma_f32_16x16x32_bf16 v[150:153], v[138:141], a[200:203], v[150:153]
  ds_read_u16 v108, v20
  v_mfma_f32_16x16x32_bf16 v[150:153], v[142:145], a[204:207], v[150:153]
  v_exp_f32 v127, v127
  v_mfma_f32_16x16x32_bf16 v[150:153], v[146:149], a[208:211], v[150:153]
  ds_read_u16 v112, v20 offset:32
  v_cvt_pk_bf16_f32 v118, v126, v127
  v_mfma_f32_16x16x32_bf16 v[150:153], v[202:205], a[212:215], v[150:153]
  v_exp_f32 v128, v128
  v_mfma_f32_16x16x16_bf16 v[178:181], v[230:231], v[122:123], 0
  ds_read_u16 v116, v20 offset:64
  v_exp_f32 v129, v129
  v_mfma_f32_16x16x16_bf16 v[206:209], v[224:225], v[122:123], v[2:5]
  v_exp_f32 v214, v214
  v_cvt_pk_bf16_f32 v119, v128, v129
  v_cvt_pk_bf16_f32 v120, v214, 0
  v_mfma_f32_16x16x32_bf16 v[178:181], v[166:169], v[218:221], v[178:181]
  s_waitcnt lgkmcnt(3)
  v_cvt_pk_bf16_f32 v114, v150, v151
  v_cvt_pk_bf16_f32 v115, v152, v153
  v_mfma_f32_16x16x32_bf16 v[206:209], v[182:185], v[218:221], v[206:209]
  v_fma_f32 v126, v26, v162, v163
  v_fma_f32 v232, v27, v162, v163
  v_mfma_f32_16x16x32_bf16 v[150:153], a[0:3], v[134:137], 0
  v_exp_f32 v178, v178
  v_mfma_f32_16x16x32_bf16 v[150:153], a[4:7], v[130:133], v[150:153]
  v_exp_f32 v179, v179
  v_mfma_f32_16x16x32_bf16 v[150:153], a[8:11], v[138:141], v[150:153]
  v_exp_f32 v180, v180
  v_mfma_f32_16x16x32_bf16 v[150:153], a[12:15], v[142:145], v[150:153]
  v_exp_f32 v181, v181
  v_mfma_f32_16x16x32_bf16 v[150:153], a[16:19], v[146:149], v[150:153]
  v_exp_f32 v206, v206
  v_mfma_f32_16x16x32_bf16 v[150:153], a[20:23], v[202:205], v[150:153]
  v_cvt_pk_bf16_f32 v122, v178, v179
  v_cvt_pk_bf16_f32 v123, v180, v181
  v_mfma_f32_16x16x32_bf16 v[178:181], a[246:249], v[210:213], 0
  v_cvt_pk_bf16_f32 v124, v206, 0
  v_cvt_pk_bf16_f32 v126, v126, v232
  v_mfma_f32_16x16x32_bf16 v[178:181], a[246:249], v[118:121], v[178:181]
  v_cvt_pk_bf16_f32 v206, v150, v151
  v_cvt_pk_bf16_f32 v207, v152, v153
  v_mfma_f32_16x16x32_bf16 v[150:153], v[158:161], v[210:213], 0
  s_waitcnt lgkmcnt(2)
  v_fma_f32 v127, v28, v162, v163
  v_fma_f32 v232, v29, v162, v163
  v_mfma_f32_16x16x32_bf16 v[150:153], v[106:109], v[118:121], v[150:153]
  v_cvt_pk_bf16_f32 v127, v127, v232
  v_fma_f32 v128, v30, v162, v163
  v_mfma_f32_16x16x32_bf16 v[218:221], v[198:201], v[210:213], 0
  s_waitcnt lgkmcnt(1)
  v_fma_f32 v232, v31, v162, v163
  v_cvt_pk_bf16_f32 v128, v128, v232
  v_mfma_f32_16x16x32_bf16 v[218:221], v[110:113], v[118:121], v[218:221]
  v_fma_f32 v129, v32, v162, v163
  v_fma_f32 v232, v33, v162, v163
  v_mfma_f32_16x16x32_bf16 v[214:217], v[186:189], v[210:213], 0
  s_waitcnt lgkmcnt(0)
  v_cvt_pk_bf16_f32 v129, v129, v232
  v_fma_f32 v232, v34, v162, v163
  v_mfma_f32_16x16x32_bf16 v[214:217], v[114:117], v[118:121], v[214:217]
  ds_write_b128 v16, v[126:129] offset:2048
  v_mfma_f32_16x16x32_bf16 v[126:129], a[24:27], v[134:137], 0
  v_fma_f32 v120, v35, v162, v163
  v_cvt_pk_bf16_f32 v232, v232, v120
  v_mfma_f32_16x16x32_bf16 v[126:129], a[28:31], v[130:133], v[126:129]
  v_fma_f32 v233, v36, v162, v163
  v_fma_f32 v120, v37, v162, v163
  v_mfma_f32_16x16x32_bf16 v[126:129], a[32:35], v[138:141], v[126:129]
  v_cvt_pk_bf16_f32 v233, v233, v120
  v_mul_f32 v178, 0x3ee9a3cd, v178
  v_mfma_f32_16x16x32_bf16 v[126:129], a[36:39], v[142:145], v[126:129]
  ds_write_b64 v17, v[232:233] offset:2048
  v_mfma_f32_16x16x32_bf16 v[126:129], a[40:43], v[146:149], v[126:129]
  v_rcp_f32 v232, v178
  v_mfma_f32_16x16x32_bf16 v[126:129], a[44:47], v[202:205], v[126:129]
  v_mul_f32 v150, v150, v232
  v_mul_f32 v151, v151, v232
  v_cvt_pk_bf16_f32 v210, v150, v151
  v_mfma_f32_16x16x16_bf16 v[170:173], v[230:231], v[254:255], 0
  v_mul_f32 v152, v152, v232
  v_mul_f32 v153, v153, v232
  v_cvt_pk_bf16_f32 v211, v152, v153
  v_mfma_f32_16x16x16_bf16 v[150:153], v[224:225], v[254:255], v[2:5]
  v_cvt_pk_bf16_f32 v208, v126, v127
  v_cvt_pk_bf16_f32 v209, v128, v129
  v_mul_f32 v218, v218, v232
  v_mul_f32 v219, v219, v232
  v_mfma_f32_16x16x32_bf16 v[170:173], v[166:169], v[190:193], v[170:173]
  v_cvt_pk_bf16_f32 v212, v218, v219
  v_mul_f32 v220, v220, v232
  v_mfma_f32_16x16x32_bf16 v[150:153], v[182:185], v[190:193], v[150:153]
  v_mul_f32 v221, v221, v232
  v_cvt_pk_bf16_f32 v213, v220, v221
  v_mfma_f32_16x16x32_bf16 v[218:221], a[246:249], v[234:237], 0
  ds_write_b128 v16, v[210:213] offset:20480
  v_mfma_f32_16x16x32_bf16 v[218:221], a[246:249], v[122:125], v[218:221]
  v_exp_f32 v170, v170
  v_mfma_f32_16x16x32_bf16 v[126:129], v[158:161], v[234:237], 0
  v_exp_f32 v171, v171
  v_mfma_f32_16x16x32_bf16 v[126:129], v[106:109], v[122:125], v[126:129]
  v_exp_f32 v172, v172
  v_mfma_f32_16x16x32_bf16 v[210:213], v[198:201], v[234:237], 0
  v_exp_f32 v173, v173
  v_mfma_f32_16x16x32_bf16 v[210:213], v[110:113], v[122:125], v[210:213]
  v_exp_f32 v150, v150
  v_mfma_f32_16x16x32_bf16 v[190:193], v[186:189], v[234:237], 0
  v_cvt_pk_bf16_f32 v118, v170, v171
  v_cvt_pk_bf16_f32 v119, v172, v173
  v_mfma_f32_16x16x32_bf16 v[190:193], v[114:117], v[122:125], v[190:193]
  v_cvt_pk_bf16_f32 v120, v150, 0
  v_mul_f32 v218, 0x3ee9a3cd, v218
  v_mfma_f32_16x16x32_bf16 v[150:153], a[48:51], v[134:137], 0
  v_rcp_f32 v233, v218
  v_mfma_f32_16x16x32_bf16 v[150:153], a[52:55], v[130:133], v[150:153]
  v_mul_f32 v126, v126, v233
  v_mul_f32 v127, v127, v233
  v_mfma_f32_16x16x32_bf16 v[150:153], a[56:59], v[138:141], v[150:153]
  v_cvt_pk_bf16_f32 v130, v126, v127
  v_mul_f32 v128, v128, v233
  v_mfma_f32_16x16x32_bf16 v[150:153], a[60:63], v[142:145], v[150:153]
  v_mul_f32 v129, v129, v233
  v_cvt_pk_bf16_f32 v131, v128, v129
  v_mfma_f32_16x16x32_bf16 v[150:153], a[64:67], v[146:149], v[150:153]
  v_mul_f32 v210, v210, v233
  v_mul_f32 v211, v211, v233
  v_mfma_f32_16x16x32_bf16 v[150:153], a[68:71], v[202:205], v[150:153]
  s_waitcnt lgkmcnt(1)
  s_barrier
  v_mfma_f32_16x16x32_bf16 v[202:205], v[174:177], a[246:249], 0
  v_cvt_pk_bf16_f32 v132, v210, v211
  v_mul_f32 v212, v212, v233
  v_mfma_f32_16x16x32_bf16 v[202:205], v[118:121], a[246:249], v[202:205]
  v_cvt_pk_bf16_f32 v122, v150, v151
  v_cvt_pk_bf16_f32 v123, v152, v153
  v_mfma_f32_16x16x32_bf16 v[146:149], v[174:177], v[158:161], 0
  v_mul_f32 v213, v213, v233
  v_cvt_pk_bf16_f32 v133, v212, v213
  v_mfma_f32_16x16x32_bf16 v[146:149], v[118:121], v[106:109], v[146:149]
  ds_write_b128 v16, v[130:133] offset:26624
  v_mfma_f32_16x16x32_bf16 v[142:145], v[174:177], v[198:201], 0
  v_mul_f32 v202, 0x3ee9a3cd, v202
  v_mul_f32 v214, v214, v232
  v_mfma_f32_16x16x32_bf16 v[142:145], v[118:121], v[110:113], v[142:145]
  ds_read_b128 v[126:129], v15 offset:2048
  v_mul_f32 v215, v215, v232
  v_mfma_f32_16x16x32_bf16 v[138:141], v[174:177], v[186:189], 0
  ds_read_b128 v[130:133], v15 offset:3072
  v_cvt_pk_bf16_f32 v254, v214, v215
  v_mfma_f32_16x16x32_bf16 v[138:141], v[118:121], v[114:117], v[138:141]
  ds_read_b128 v[134:137], v15 offset:4096
  v_rcp_f32 v120, v202
  v_mfma_f32_16x16x16_bf16 v[150:153], v[164:165], v[122:123], 0
  v_cndmask_b32 v124, v142, v146, s[54:55]
  v_mul_f32 v216, v216, v232
  v_mul_f32 v217, v217, v232
  v_mfma_f32_16x16x16_bf16 v[162:165], v[222:223], v[122:123], 0
  v_cvt_pk_bf16_f32 v255, v216, v217
  v_mul_f32 v190, v190, v233
  v_mul_f32 v191, v191, v233
  v_mfma_f32_16x16x16_bf16 v[214:217], v[230:231], v[122:123], 0
  v_cvt_pk_bf16_f32 v222, v190, v191
  v_mul_f32 v192, v192, v233
  v_mul_f32 v193, v193, v233
  v_mfma_f32_16x16x16_bf16 v[174:177], v[224:225], v[122:123], v[2:5]
  v_cvt_pk_bf16_f32 v223, v192, v193
  v_cndmask_b32 v124, v138, v124, s[56:57]
  v_mul_f32 v124, v124, v120
  v_cvt_pk_bf16_f32 v124, v124, v124
  v_mfma_f32_16x16x32_bf16 v[150:153], v[154:157], v[206:209], v[150:153]
  ds_read_b128 v[138:141], v15 offset:5120
  ds_read_b128 v[142:145], v15 offset:6144
  v_mfma_f32_16x16x32_bf16 v[162:165], v[226:229], v[206:209], v[162:165]
  ds_read_b128 v[146:149], v15 offset:7168
  v_max3_f32 v1, v1, v178, v232
  v_mfma_f32_16x16x32_bf16 v[214:217], v[166:169], v[206:209], v[214:217]
  ds_write_b64 v17, v[254:255] offset:20480
  v_mfma_f32_16x16x32_bf16 v[174:177], v[182:185], v[206:209], v[174:177]
  s_waitcnt lgkmcnt(6)
  v_exp_f32 v150, v150
  v_mfma_f32_16x16x32_bf16 v[154:157], a[0:3], v[126:129], 0
  s_waitcnt lgkmcnt(5)
  ds_write_b64 v17, v[222:223] offset:26624
  v_mfma_f32_16x16x32_bf16 v[154:157], a[4:7], v[130:133], v[154:157]
  s_waitcnt lgkmcnt(5)
  ds_write_b16 v20, v124 offset:384
  v_mfma_f32_16x16x32_bf16 v[154:157], a[8:11], v[134:137], v[154:157]
  s_waitcnt lgkmcnt(5)
  v_exp_f32 v151, v151
  v_mfma_f32_16x16x32_bf16 v[154:157], a[12:15], v[138:141], v[154:157]
  s_waitcnt lgkmcnt(4)
  v_exp_f32 v152, v152
  v_mfma_f32_16x16x32_bf16 v[154:157], a[16:19], v[142:145], v[154:157]
  s_waitcnt lgkmcnt(3)
  v_exp_f32 v153, v153
  v_mfma_f32_16x16x32_bf16 v[154:157], a[20:23], v[146:149], v[154:157]
  v_exp_f32 v162, v162
  v_mfma_f32_16x16x32_bf16 v[182:185], a[24:27], v[126:129], 0
  v_exp_f32 v163, v163
  v_mfma_f32_16x16x32_bf16 v[182:185], a[28:31], v[130:133], v[182:185]
  v_exp_f32 v164, v164
  v_mfma_f32_16x16x32_bf16 v[182:185], a[32:35], v[134:137], v[182:185]
  v_exp_f32 v165, v165
  v_mfma_f32_16x16x32_bf16 v[182:185], a[36:39], v[138:141], v[182:185]
  v_exp_f32 v214, v214
  v_mfma_f32_16x16x32_bf16 v[182:185], a[40:43], v[142:145], v[182:185]
  v_exp_f32 v215, v215
  v_mfma_f32_16x16x32_bf16 v[182:185], a[44:47], v[146:149], v[182:185]
  v_exp_f32 v216, v216
  v_mfma_f32_16x16x32_bf16 v[206:209], a[48:51], v[126:129], 0
  v_exp_f32 v217, v217
  v_mfma_f32_16x16x32_bf16 v[206:209], a[52:55], v[130:133], v[206:209]
  v_exp_f32 v174, v174
  v_mfma_f32_16x16x32_bf16 v[206:209], a[56:59], v[134:137], v[206:209]
  v_cvt_pk_bf16_f32 v166, v150, v151
  v_cvt_pk_bf16_f32 v167, v152, v153
  v_mfma_f32_16x16x32_bf16 v[206:209], a[60:63], v[138:141], v[206:209]
  v_cvt_pk_bf16_f32 v168, v162, v163
  v_cvt_pk_bf16_f32 v169, v164, v165
  v_mfma_f32_16x16x32_bf16 v[206:209], a[64:67], v[142:145], v[206:209]
  v_cvt_pk_bf16_f32 v150, v154, v155
  v_cvt_pk_bf16_f32 v151, v156, v157
  v_mfma_f32_16x16x32_bf16 v[206:209], a[68:71], v[146:149], v[206:209]
  v_cvt_pk_bf16_f32 v122, v214, v215
  v_cvt_pk_bf16_f32 v123, v216, v217
  v_mfma_f32_16x16x32_bf16 v[214:217], a[246:249], v[166:169], 0
  v_cvt_pk_bf16_f32 v124, v174, 0
  v_cvt_pk_bf16_f32 v152, v182, v183
  v_cvt_pk_bf16_f32 v153, v184, v185
  v_mfma_f32_16x16x32_bf16 v[214:217], a[246:249], v[122:125], v[214:217]
  v_cvt_pk_bf16_f32 v162, v206, v207
  v_cvt_pk_bf16_f32 v163, v208, v209
  v_mfma_f32_16x16x32_bf16 v[154:157], v[158:161], v[166:169], 0
  v_max3_f32 v1, v1, v218, v233
  v_max3_f32 v1, v1, v202, v120
  v_mfma_f32_16x16x32_bf16 v[154:157], v[106:109], v[122:125], v[154:157]
  v_mul_f32 v214, 0x3ee9a3cd, v214
  v_add_u32 v20, 1160, v20
  v_mfma_f32_16x16x32_bf16 v[158:161], v[198:201], v[166:169], 0
  v_rcp_f32 v108, v214
  v_mfma_f32_16x16x32_bf16 v[158:161], v[110:113], v[122:125], v[158:161]
  v_mul_f32 v154, v154, v108
  v_mul_f32 v155, v155, v108
  v_mfma_f32_16x16x32_bf16 v[198:201], v[186:189], v[166:169], 0
  v_mul_f32 v156, v156, v108
  v_mul_f32 v157, v157, v108
  v_mfma_f32_16x16x32_bf16 v[198:201], v[114:117], v[122:125], v[198:201]
  v_mul_f32 v158, v158, v108
  v_mul_f32 v159, v159, v108
  v_mfma_f32_16x16x32_bf16 v[166:169], a[72:75], v[126:129], 0
  v_mul_f32 v160, v160, v108
  v_mul_f32 v161, v161, v108
  v_mfma_f32_16x16x32_bf16 v[166:169], a[76:79], v[130:133], v[166:169]
  v_cvt_pk_bf16_f32 v186, v154, v155
  v_cvt_pk_bf16_f32 v187, v156, v157
  v_mfma_f32_16x16x32_bf16 v[166:169], a[80:83], v[134:137], v[166:169]
  v_cvt_pk_bf16_f32 v188, v158, v159
  v_cvt_pk_bf16_f32 v189, v160, v161
  v_mfma_f32_16x16x32_bf16 v[166:169], a[84:87], v[138:141], v[166:169]
  ds_write_b128 v16, v[186:189] offset:32768
  v_mfma_f32_16x16x32_bf16 v[166:169], a[88:91], v[142:145], v[166:169]
  v_mul_f32 v198, v198, v108
  v_mul_f32 v199, v199, v108
  v_mfma_f32_16x16x32_bf16 v[166:169], a[92:95], v[146:149], v[166:169]
  v_mul_f32 v200, v200, v108
  v_mul_f32 v201, v201, v108
  v_mfma_f32_16x16x32_bf16 v[186:189], a[96:99], v[126:129], 0
  v_cvt_pk_bf16_f32 v164, v198, v199
  v_cvt_pk_bf16_f32 v165, v200, v201
  v_mfma_f32_16x16x32_bf16 v[186:189], a[100:103], v[130:133], v[186:189]
  ds_write_b64 v17, v[164:165] offset:32768
  v_mfma_f32_16x16x32_bf16 v[186:189], a[104:107], v[134:137], v[186:189]
  v_cvt_pk_bf16_f32 v154, v166, v167
  v_cvt_pk_bf16_f32 v155, v168, v169
  v_mfma_f32_16x16x32_bf16 v[186:189], a[108:111], v[138:141], v[186:189]
  v_max3_f32 v1, v1, v214, v108
  v_mfma_f32_16x16x32_bf16 v[186:189], a[112:115], v[142:145], v[186:189]
  v_mfma_f32_16x16x32_bf16 v[186:189], a[116:119], v[146:149], v[186:189]
  v_mfma_f32_16x16x32_bf16 v[158:161], a[120:123], v[126:129], 0
  v_mfma_f32_16x16x32_bf16 v[158:161], a[124:127], v[130:133], v[158:161]
  v_cvt_pk_bf16_f32 v156, v186, v187
  v_cvt_pk_bf16_f32 v157, v188, v189
  v_mfma_f32_16x16x32_bf16 v[158:161], a[128:131], v[134:137], v[158:161]
  v_mfma_f32_16x16x32_bf16 v[158:161], a[132:135], v[138:141], v[158:161]
  v_mfma_f32_16x16x32_bf16 v[158:161], a[136:139], v[142:145], v[158:161]
  v_mfma_f32_16x16x32_bf16 v[158:161], a[140:143], v[146:149], v[158:161]
  s_waitcnt lgkmcnt(0)
  s_barrier
  s_sub_u32 s70, s70, 1
  s_cmp_eq_u32 s70, 0
  s_cbranch_scc1 L_last
  v_mfma_f32_16x16x32_bf16 v[166:169], v[126:129], a[144:147], 0
  s_mov_b32 m0, s58
  v_cndmask_b32 v108, v21, 2.0, s[52:53]
  v_mfma_f32_16x16x32_bf16 v[166:169], v[130:133], a[148:151], v[166:169]
  buffer_load_dwordx4 v108, s[4:7], s36 offen lds
  v_mfma_f32_16x16x32_bf16 v[166:169], v[134:137], a[152:155], v[166:169]
  ds_read_b128 v[170:173], v15 offset:20480
  ds_read_b128 v[174:177], v15 offset:26624
  v_mfma_f32_16x16x32_bf16 v[166:169], v[138:141], a[156:159], v[166:169]
  ds_read_b128 v[178:181], v15 offset:32768
  v_cvt_pk_bf16_f32 v164, v158, v159
  v_mfma_f32_16x16x32_bf16 v[166:169], v[142:145], a[160:163], v[166:169]
  ds_read_b64 v[106:107], v117 offset:896
  ds_read_b64 v[110:111], v117 offset:1792
  v_mfma_f32_16x16x32_bf16 v[166:169], v[146:149], a[164:167], v[166:169]
  v_cvt_pk_bf16_f32 v165, v160, v161
  s_nop 6
  v_cvt_pk_bf16_f32 v158, v166, v167
  v_cvt_pk_bf16_f32 v159, v168, v169
  s_waitcnt lgkmcnt(4)
  v_mfma_f32_16x16x32_bf16 v[62:65], a[250:253], v[170:173], v[62:65]
  buffer_load_dwordx4 v108, s[4:7], s37 offen offset:864 lds
  v_mfma_f32_16x16x32_bf16 v[66:69], v[98:101], v[170:173], v[66:69]
  v_mfma_f32_16x16x32_bf16 v[70:73], v[102:105], v[170:173], v[70:73]
  s_waitcnt lgkmcnt(1)
  ds_read_b128 v[170:173], v18
  ds_read_b128 v[166:169], v15 offset:21504
  v_mfma_f32_16x16x32_bf16 v[74:77], a[250:253], v[174:177], v[74:77]
  s_waitcnt lgkmcnt(2)
  ds_read_b128 v[182:185], v18 offset:1024
  v_fma_f32 v186, v38, v106, v107
  v_mfma_f32_16x16x32_bf16 v[78:81], v[98:101], v[174:177], v[78:81]
  ds_read_b128 v[190:193], v18 offset:2048
  v_fma_f32 v112, v39, v106, v107
  v_mfma_f32_16x16x32_bf16 v[82:85], v[102:105], v[174:177], v[82:85]
  ds_read_b128 v[174:177], v15 offset:27648
  v_cvt_pk_bf16_f32 v186, v186, v112
  v_mfma_f32_16x16x32_bf16 v[86:89], a[250:253], v[178:181], v[86:89]
  v_fma_f32 v187, v40, v106, v107
  v_fma_f32 v112, v41, v106, v107
  v_mfma_f32_16x16x32_bf16 v[90:93], v[98:101], v[178:181], v[90:93]
  buffer_load_dwordx4 v108, s[4:7], s38 offen offset:1728 lds
  v_mfma_f32_16x16x32_bf16 v[94:97], v[102:105], v[178:181], v[94:97]
  ds_read_b128 v[178:181], v15 offset:33792
  v_cvt_pk_bf16_f32 v187, v187, v112
  v_mfma_f32_16x16x32_bf16 v[194:197], v[126:129], a[168:171], 0
  v_fma_f32 v188, v42, v106, v107
  v_fma_f32 v112, v43, v106, v107
  v_mfma_f32_16x16x32_bf16 v[194:197], v[130:133], a[172:175], v[194:197]
  v_cvt_pk_bf16_f32 v188, v188, v112
  v_fma_f32 v189, v44, v106, v107
  v_mfma_f32_16x16x32_bf16 v[194:197], v[134:137], a[176:179], v[194:197]
  v_fma_f32 v112, v45, v106, v107
  v_cvt_pk_bf16_f32 v189, v189, v112
  v_mfma_f32_16x16x32_bf16 v[194:197], v[138:141], a[180:183], v[194:197]
  ds_write_b128 v16, v[186:189] offset:8192
  v_mfma_f32_16x16x32_bf16 v[194:197], v[142:145], a[184:187], v[194:197]
  v_fma_f32 v186, v50, v110, v111
  v_fma_f32 v112, v51, v110, v111
  v_mfma_f32_16x16x32_bf16 v[194:197], v[146:149], a[188:191], v[194:197]
  s_waitcnt lgkmcnt(5)
  buffer_load_dwordx4 v108, s[4:7], s39 offen offset:2592 lds
  v_mfma_f32_16x16x32_bf16 v[62:65], v[170:173], v[166:169], v[62:65]
  s_waitcnt lgkmcnt(4)
  v_cvt_pk_bf16_f32 v186, v186, v112
  v_fma_f32 v187, v52, v110, v111
  v_mfma_f32_16x16x32_bf16 v[66:69], v[182:185], v[166:169], v[66:69]
  s_waitcnt lgkmcnt(3)
  v_cvt_pk_bf16_f32 v198, v194, v195
  v_cvt_pk_bf16_f32 v199, v196, v197
  v_mfma_f32_16x16x32_bf16 v[70:73], v[190:193], v[166:169], v[70:73]
  s_waitcnt lgkmcnt(2)
  ds_read_b128 v[166:169], v18 offset:6144
  ds_read_b128 v[194:197], v15 offset:22528
  v_mfma_f32_16x16x32_bf16 v[74:77], v[170:173], v[174:177], v[74:77]
  ds_read_b128 v[202:205], v18 offset:7168
  v_fma_f32 v112, v53, v110, v111
  v_mfma_f32_16x16x32_bf16 v[78:81], v[182:185], v[174:177], v[78:81]
  ds_read_b128 v[206:209], v18 offset:8192
  v_cvt_pk_bf16_f32 v187, v187, v112
  v_mfma_f32_16x16x32_bf16 v[82:85], v[190:193], v[174:177], v[82:85]
  s_waitcnt lgkmcnt(5)
  ds_read_b128 v[174:177], v15 offset:28672
  v_fma_f32 v188, v54, v110, v111
  v_mfma_f32_16x16x32_bf16 v[86:89], v[170:173], v[178:181], v[86:89]
  buffer_load_dwordx4 v108, s[4:7], s40 offen offset:3456 lds
  v_mfma_f32_16x16x32_bf16 v[90:93], v[182:185], v[178:181], v[90:93]
  s_mov_b32 m0, s59
  v_fma_f32 v112, v55, v110, v111
  v_cvt_pk_bf16_f32 v188, v188, v112
  v_mfma_f32_16x16x32_bf16 v[94:97], v[190:193], v[178:181], v[94:97]
  ds_read_b128 v[170:173], v15 offset:34816
  ds_read_b64 v[254:255], v19 offset:784
  v_mfma_f32_16x16x32_bf16 v[178:181], v[126:129], a[192:195], 0
  ds_read2_b64 v[190:193], v19 offset0:96 offset1:97
  v_fma_f32 v189, v56, v110, v111
  v_mfma_f32_16x16x32_bf16 v[178:181], v[130:133], a[196:199], v[178:181]
  v_fma_f32 v112, v57, v110, v111
  v_cvt_pk_bf16_f32 v189, v189, v112
  v_mfma_f32_16x16x32_bf16 v[178:181], v[134:137], a[200:203], v[178:181]
  ds_write_b128 v16, v[186:189] offset:14336
  v_mfma_f32_16x16x32_bf16 v[178:181], v[138:141], a[204:207], v[178:181]
  v_fma_f32 v114, v46, v106, v107
  v_fma_f32 v112, v47, v106, v107
  v_mfma_f32_16x16x32_bf16 v[178:181], v[142:145], a[208:211], v[178:181]
  buffer_load_dwordx4 v108, s[4:7], s41 offen lds
  v_mfma_f32_16x16x32_bf16 v[178:181], v[146:149], a[212:215], v[178:181]
  s_waitcnt lgkmcnt(7)
  v_cvt_pk_bf16_f32 v114, v114, v112
  v_fma_f32 v115, v48, v106, v107
  v_mfma_f32_16x16x32_bf16 v[62:65], v[166:169], v[194:197], v[62:65]
  s_waitcnt lgkmcnt(6)
  ds_read_b128 v[146:149], v18 offset:9216
  ds_read_b128 v[142:145], v15 offset:23552
  v_mfma_f32_16x16x32_bf16 v[66:69], v[202:205], v[194:197], v[66:69]
  s_waitcnt lgkmcnt(7)
  ds_read_b128 v[138:141], v18 offset:10240
  v_cvt_pk_bf16_f32 v186, v178, v179
  v_mfma_f32_16x16x32_bf16 v[70:73], v[206:209], v[194:197], v[70:73]
  s_waitcnt lgkmcnt(7)
  ds_read_b128 v[134:137], v18 offset:11264
  v_cvt_pk_bf16_f32 v187, v180, v181
  v_mfma_f32_16x16x32_bf16 v[74:77], v[166:169], v[174:177], v[74:77]
  ds_read_b128 v[130:133], v15 offset:29696
  v_fma_f32 v112, v49, v106, v107
  v_mfma_f32_16x16x32_bf16 v[78:81], v[202:205], v[174:177], v[78:81]
  v_cvt_pk_bf16_f32 v115, v115, v112
  v_fma_f32 v106, v58, v110, v111
  v_mfma_f32_16x16x32_bf16 v[82:85], v[206:209], v[174:177], v[82:85]
  s_waitcnt lgkmcnt(8)
  buffer_load_dwordx4 v108, s[4:7], s42 offen offset:864 lds
  v_mfma_f32_16x16x32_bf16 v[86:89], v[166:169], v[170:173], v[86:89]
  ds_read_b128 v[166:169], v15 offset:35840
  v_fma_f32 v112, v59, v110, v111
  v_mfma_f32_16x16x32_bf16 v[90:93], v[202:205], v[170:173], v[90:93]
  ds_write_b64 v17, v[114:115] offset:8192
  v_mfma_f32_16x16x32_bf16 v[94:97], v[206:209], v[170:173], v[94:97]
  s_waitcnt lgkmcnt(9)
  v_cvt_pk_bf16_f32 v106, v106, v112
  v_fma_f32 v107, v60, v110, v111
  v_fma_f32 v112, v61, v110, v111
  v_mfma_f32_16x16x16_bf16 v[170:173], v[164:165], v[162:163], 0
  v_cvt_pk_bf16_f32 v107, v107, v112
  v_mfma_f32_16x16x16_bf16 v[126:129], v[164:165], v[254:255], 0
  ds_read_b128 v[206:209], v18 offset:3072
  ds_read_b128 v[202:205], v15 offset:24576
  ds_read_b128 v[174:177], v18 offset:4096
  v_mfma_f32_16x16x32_bf16 v[170:173], v[154:157], v[150:153], v[170:173]
  s_waitcnt lgkmcnt(11)
  ds_read_b128 v[178:181], v18 offset:5120
  v_mfma_f32_16x16x32_bf16 v[126:129], v[154:157], v[190:193], v[126:129]
  s_waitcnt lgkmcnt(9)
  buffer_load_dwordx4 v108, s[4:7], s43 offen offset:1728 lds
  v_mfma_f32_16x16x32_bf16 v[62:65], v[146:149], v[142:145], v[62:65]
  s_waitcnt lgkmcnt(8)
  ds_read_b128 v[194:197], v15 offset:30720
  v_mfma_f32_16x16x32_bf16 v[66:69], v[138:141], v[142:145], v[66:69]
  s_waitcnt lgkmcnt(8)
  ds_write_b64 v17, v[106:107] offset:14336
  v_mfma_f32_16x16x32_bf16 v[70:73], v[134:137], v[142:145], v[70:73]
  s_waitcnt lgkmcnt(8)
  ds_read_b128 v[142:145], v15 offset:36864
  v_mfma_f32_16x16x32_bf16 v[74:77], v[146:149], v[130:133], v[74:77]
  v_exp_f32 v170, v170
  v_mfma_f32_16x16x32_bf16 v[78:81], v[138:141], v[130:133], v[78:81]
  v_exp_f32 v171, v171
  v_mfma_f32_16x16x32_bf16 v[82:85], v[134:137], v[130:133], v[82:85]
  s_waitcnt lgkmcnt(8)
  ds_read_b128 v[130:133], v18 offset:12288
  ds_read_b128 v[182:185], v15 offset:25600
  v_mfma_f32_16x16x32_bf16 v[86:89], v[146:149], v[166:169], v[86:89]
  buffer_load_dwordx4 v108, s[4:7], s44 offen offset:2592 lds
  v_mfma_f32_16x16x32_bf16 v[90:93], v[138:141], v[166:169], v[90:93]
  s_lshl_b32 s60, s31, 5
  ds_read_b128 v[146:149], v18 offset:13312
  ds_read_b128 v[138:141], v18 offset:14336
  v_mfma_f32_16x16x32_bf16 v[94:97], v[134:137], v[166:169], v[94:97]
  s_waitcnt lgkmcnt(9)
  v_exp_f32 v172, v172
  v_mfma_f32_16x16x32_bf16 v[62:65], v[206:209], v[202:205], v[62:65]
  s_waitcnt lgkmcnt(8)
  v_exp_f32 v173, v173
  v_mfma_f32_16x16x32_bf16 v[66:69], v[174:177], v[202:205], v[66:69]
  s_waitcnt lgkmcnt(7)
  ds_read_b128 v[134:137], v15 offset:31744
  v_cvt_pk_bf16_f32 v210, v170, v171
  v_mfma_f32_16x16x32_bf16 v[70:73], v[178:181], v[202:205], v[70:73]
  s_waitcnt lgkmcnt(7)
  v_exp_f32 v126, v126
  v_mfma_f32_16x16x32_bf16 v[74:77], v[206:209], v[194:197], v[74:77]
  s_add_u32 s61, s60, s30
  v_exp_f32 v127, v127
  v_mfma_f32_16x16x32_bf16 v[78:81], v[174:177], v[194:197], v[78:81]
  s_add_u32 s60, s60, s29
  v_exp_f32 v128, v128
  v_mfma_f32_16x16x32_bf16 v[82:85], v[178:181], v[194:197], v[82:85]
  s_waitcnt lgkmcnt(5)
  v_exp_f32 v129, v129
  v_mfma_f32_16x16x32_bf16 v[86:89], v[206:209], v[142:145], v[86:89]
  s_mul_i32 s62, s60, 7183
  ds_read_b128 v[166:169], v15 offset:37888
  v_cvt_pk_bf16_f32 v211, v172, v173
  v_mfma_f32_16x16x32_bf16 v[90:93], v[174:177], v[142:145], v[90:93]
  s_lshr_b32 s62, s62, 22
  v_cvt_pk_bf16_f32 v174, v126, v127
  v_cvt_pk_bf16_f32 v175, v128, v129
  v_mfma_f32_16x16x32_bf16 v[94:97], v[178:181], v[142:145], v[94:97]
  s_waitcnt lgkmcnt(4)
  s_barrier
  v_mfma_f32_16x16x32_bf16 v[62:65], v[130:133], v[182:185], v[62:65]
  s_waitcnt lgkmcnt(3)
  ds_read_b128 v[178:181], v15 offset:8192
  ds_read_b128 v[206:209], v15 offset:9216
  v_mfma_f32_16x16x32_bf16 v[66:69], v[146:149], v[182:185], v[66:69]
  s_waitcnt lgkmcnt(4)
  ds_read_b128 v[194:197], v15 offset:10240
  v_mfma_f32_16x16x32_bf16 v[70:73], v[138:141], v[182:185], v[70:73]
  s_waitcnt lgkmcnt(4)
  ds_read_b128 v[182:185], v15 offset:11264
  v_cvt_pk_bf16_f32 v142, v62, v63
  v_mfma_f32_16x16x32_bf16 v[74:77], v[130:133], v[134:137], v[74:77]
  s_mul_i32 s63, s62, 584
  ds_read_b128 v[202:205], v15 offset:12288
  v_cvt_pk_bf16_f32 v143, v64, v65
  v_mfma_f32_16x16x32_bf16 v[78:81], v[146:149], v[134:137], v[78:81]
  s_sub_u32 s63, s60, s63
  ds_read_b128 v[214:217], v15 offset:13312
  v_cvt_pk_bf16_f32 v144, v66, v67
  v_mfma_f32_16x16x32_bf16 v[82:85], v[138:141], v[134:137], v[82:85]
  s_waitcnt lgkmcnt(6)
  v_cvt_pk_bf16_f32 v145, v68, v69
  v_cvt_pk_bf16_f32 v218, v70, v71
  v_mfma_f32_16x16x32_bf16 v[86:89], v[130:133], v[166:169], v[86:89]
  s_lshr_b32 s64, s63, 3
  v_permlane16_swap_b32 v142, v144
  v_mfma_f32_16x16x32_bf16 v[90:93], v[146:149], v[166:169], v[90:93]
  s_and_b32 s65, s63, 7
  v_permlane16_swap_b32 v143, v145
  v_mfma_f32_16x16x32_bf16 v[94:97], v[138:141], v[166:169], v[94:97]
  s_waitcnt lgkmcnt(5)
  buffer_store_dwordx4 v[142:145], v12, s[8:11], s32 offen
  v_cvt_pk_bf16_f32 v219, v72, v73
  v_mfma_f32_16x16x32_bf16 v[166:169], a[72:75], v[178:181], 0
  s_waitcnt lgkmcnt(4)
  v_cvt_pk_bf16_f32 v222, v74, v75
  v_cvt_pk_bf16_f32 v223, v76, v77
  v_mfma_f32_16x16x32_bf16 v[166:169], a[76:79], v[206:209], v[166:169]
  s_waitcnt lgkmcnt(3)
  v_cvt_pk_bf16_f32 v224, v78, v79
  v_cvt_pk_bf16_f32 v225, v80, v81
  v_mfma_f32_16x16x32_bf16 v[166:169], a[80:83], v[194:197], v[166:169]
  s_waitcnt vmcnt(1) lgkmcnt(2)
  ds_read_b64 v[106:107], v9
  ds_read_b64 v[110:111], v9 offset:32
  v_mfma_f32_16x16x32_bf16 v[166:169], a[84:87], v[182:185], v[166:169]
  s_waitcnt lgkmcnt(3)
  ds_read_b64 v[114:115], v9 offset:64
  v_cvt_pk_bf16_f32 v220, v82, v83
  v_mfma_f32_16x16x32_bf16 v[166:169], a[88:91], v[202:205], v[166:169]
  s_waitcnt lgkmcnt(3)
  ds_read_b128 v[142:145], v3
  v_cvt_pk_bf16_f32 v221, v84, v85
  v_mfma_f32_16x16x32_bf16 v[166:169], a[92:95], v[214:217], v[166:169]
  s_lshl_b32 s66, s62, 3
  ds_read_b128 v[146:149], v3 offset:864
  s_add_u32 s65, s65, s66
  s_cmp_ge_u32 s60, 5256
  ds_read_b128 v[134:137], v3 offset:1728
  v_permlane16_swap_b32 v222, v224
  s_cselect_b32 s64, s63, s64
  s_cselect_b32 s65, 72, s65
  ds_read_b128 v[138:141], v6
  v_cvt_pk_bf16_f32 v226, v166, v167
  s_waitcnt lgkmcnt(6)
  v_mfma_f32_16x16x16_bf16 v[62:65], a[224:225], v[106:107], 0
  ds_read_b128 v[126:129], v3 offset:32
  v_cvt_pk_bf16_f32 v227, v168, v169
  s_waitcnt lgkmcnt(6)
  v_mfma_f32_16x16x16_bf16 v[66:69], a[234:235], v[110:111], 0
  ds_read_b128 v[130:133], v3 offset:896
  v_cvt_pk_bf16_f32 v230, v86, v87
  s_waitcnt lgkmcnt(6)
  v_mfma_f32_16x16x16_bf16 v[70:73], a[244:245], v[114:115], 0
  ds_read_b128 v[166:169], v3 offset:1760
  s_mul_i32 s66, s65, 1373568
  s_mul_i32 s67, s64, 2688
  ds_read_b128 v[170:173], v6 offset:32
  v_permlane16_swap_b32 v223, v225
  s_waitcnt lgkmcnt(6)
  v_smfmac_f32_16x16x64_bf16 v[62:65], a[216:219], v[142:149], v0
  s_add_u32 s35, s66, s67
  ds_read_b128 v[142:145], v3 offset:64
  s_cmp_ge_u32 s61, 667
  ds_read_b128 v[146:149], v3 offset:928
  v_permlane16_swap_b32 v218, v220
  s_waitcnt lgkmcnt(6)
  v_smfmac_f32_16x16x64_bf16 v[62:65], a[220:223], v[134:141], v0
  s_cselect_b32 s35, 268435456, s35
  ds_read_b128 v[134:137], v3 offset:1792
  v_cvt_pk_bf16_f32 v231, v88, v89
  v_mfma_f32_16x16x32_bf16 v[234:237], a[96:99], v[178:181], 0
  s_cmp_ge_u32 s60, 5329
  ds_read_b128 v[138:141], v6 offset:64
  v_cvt_pk_bf16_f32 v232, v90, v91
  v_mfma_f32_16x16x32_bf16 v[234:237], a[100:103], v[206:209], v[234:237]
  s_cselect_b32 s35, 268435456, s35
  buffer_store_dwordx4 v[222:225], v13, s[8:11], s32 offen
  v_cvt_pk_bf16_f32 v233, v92, v93
  v_mfma_f32_16x16x32_bf16 v[234:237], a[104:107], v[194:197], v[234:237]
  s_waitcnt lgkmcnt(6)
  v_permlane16_swap_b32 v219, v221
  v_smfmac_f32_16x16x64_bf16 v[66:69], a[226:229], v[126:133], v0
  s_waitcnt lgkmcnt(4)
  v_cvt_pk_bf16_f32 v106, v94, v95
  v_smfmac_f32_16x16x64_bf16 v[66:69], a[230:233], v[166:173], v0
  s_cmp_eq_u32 s65, 0
  v_cvt_pk_bf16_f32 v107, v96, v97
  v_mfma_f32_16x16x32_bf16 v[234:237], a[108:111], v[182:185], v[234:237]
  s_cselect_b32 s36, 268435456, s35
  v_permlane16_swap_b32 v230, v232
  v_mfma_f32_16x16x32_bf16 v[234:237], a[112:115], v[202:205], v[234:237]
  s_add_u32 s37, s35, 195360
  v_permlane16_swap_b32 v231, v233
  v_mfma_f32_16x16x32_bf16 v[234:237], a[116:119], v[214:217], v[234:237]
  s_waitcnt lgkmcnt(2)
  v_mul_f32 v108, v62, v62
  v_add_f32 v112, v62, v63
  v_smfmac_f32_16x16x64_bf16 v[70:73], a[236:239], v[142:149], v0
  s_waitcnt lgkmcnt(0)
  v_fmac_f32 v108, v63, v63
  v_smfmac_f32_16x16x64_bf16 v[70:73], a[240:243], v[134:141], v0
  s_add_u32 s38, s35, 390720
  v_cvt_pk_bf16_f32 v228, v234, v235
  v_mfma_f32_16x16x32_bf16 v[166:169], a[120:123], v[178:181], 0
  s_add_u32 s39, s35, 586080
  v_cvt_pk_bf16_f32 v229, v236, v237
  v_add_f32 v112, v112, v64
  v_mfma_f32_16x16x32_bf16 v[166:169], a[124:127], v[206:209], v[166:169]
  s_add_u32 s40, s35, 781440
  ds_read_b64 v[110:111], v10
  v_fmac_f32 v108, v64, v64
  v_mfma_f32_16x16x32_bf16 v[166:169], a[128:131], v[194:197], v[166:169]
  s_add_u32 s41, s35, 981120
  ds_read_b64 v[114:115], v10 offset:32
  v_add_f32 v112, v112, v65
  v_mfma_f32_16x16x32_bf16 v[166:169], a[132:135], v[182:185], v[166:169]
  s_add_u32 s42, s35, 1176480
  ds_read_b64 v[118:119], v10 offset:64
  v_fmac_f32 v108, v65, v65
  v_mfma_f32_16x16x32_bf16 v[166:169], a[136:139], v[202:205], v[166:169]
  s_add_u32 s43, s35, 1371840
  ds_read_b128 v[134:137], v4
  ds_read_b128 v[138:141], v4 offset:864
  v_mfma_f32_16x16x32_bf16 v[166:169], a[140:143], v[214:217], v[166:169]
  s_add_u32 s44, s35, 1567200
  ds_read_b128 v[142:145], v4 offset:1728
  v_add_f32 v112, v112, v66
  v_mfma_f32_16x16x32_bf16 v[234:237], a[0:3], v[178:181], 0
  s_cmp_eq_u32 s64, 0
  ds_read_b128 v[146:149], v7
  v_fmac_f32 v108, v66, v66
  v_mfma_f32_16x16x32_bf16 v[234:237], a[4:7], v[206:209], v[234:237]
  s_cselect_b64 s[52:53], s[48:49], 0
  buffer_store_dwordx4 v[218:221], v22, s[8:11], s32 offen
  v_cvt_pk_bf16_f32 v222, v166, v167
  v_mfma_f32_16x16x32_bf16 v[234:237], a[8:11], v[194:197], v[234:237]
  s_cmp_eq_u32 s64, 72
  v_cvt_pk_bf16_f32 v223, v168, v169
  v_add_f32 v112, v112, v67
  v_mfma_f32_16x16x32_bf16 v[234:237], a[12:15], v[182:185], v[234:237]
  s_cselect_b64 s[52:53], s[50:51], s[52:53]
  ds_read_b128 v[166:169], v4 offset:32
  ds_read_b128 v[170:173], v4 offset:896
  v_mfma_f32_16x16x32_bf16 v[234:237], a[16:19], v[202:205], v[234:237]
  s_add_u32 s31, s31, 1
  ds_read_b128 v[126:129], v4 offset:1760
  v_fmac_f32 v108, v67, v67
  v_mfma_f32_16x16x32_bf16 v[234:237], a[20:23], v[214:217], v[234:237]
  s_waitcnt lgkmcnt(5)
  ds_read_b128 v[130:133], v7 offset:32
  v_add_f32 v112, v112, v68
  v_fmac_f32 v108, v68, v68
  v_mfma_f32_16x16x16_bf16 v[74:77], a[224:225], v[110:111], 0
  v_add_f32 v112, v112, v69
  v_fmac_f32 v108, v69, v69
  v_add_f32 v112, v112, v70
  v_mfma_f32_16x16x16_bf16 v[78:81], a[234:235], v[114:115], 0
  v_cvt_pk_bf16_f32 v218, v234, v235
  v_cvt_pk_bf16_f32 v219, v236, v237
  v_fmac_f32 v108, v70, v70
  v_mfma_f32_16x16x16_bf16 v[82:85], a[244:245], v[118:119], 0
  v_add_f32 v112, v112, v71
  v_fmac_f32 v108, v71, v71
  v_add_f32 v112, v112, v72
  v_fmac_f32 v108, v72, v72
  v_smfmac_f32_16x16x64_bf16 v[74:77], a[216:219], v[134:141], v0
  s_waitcnt lgkmcnt(4)
  ds_read_b128 v[134:137], v4 offset:64
  ds_read_b128 v[138:141], v4 offset:928
  v_smfmac_f32_16x16x64_bf16 v[74:77], a[220:223], v[142:149], v0
  s_sub_u32 s68, s35, 196608
  ds_read_b128 v[142:145], v4 offset:1792
  v_add_f32 v112, v112, v73
  v_mfma_f32_16x16x32_bf16 v[234:237], a[24:27], v[178:181], 0
  s_cselect_b32 s68, s35, s68
  ds_read_b128 v[146:149], v7 offset:64
  v_fmac_f32 v108, v73, v73
  v_mfma_f32_16x16x32_bf16 v[234:237], a[28:31], v[206:209], v[234:237]
  v_mul_f32 v120, v74, v74
  v_add_f32 v116, v74, v75
  v_mfma_f32_16x16x32_bf16 v[234:237], a[32:35], v[194:197], v[234:237]
  s_waitcnt lgkmcnt(6)
  v_fmac_f32 v120, v75, v75
  v_add_f32 v116, v116, v76
  v_smfmac_f32_16x16x64_bf16 v[78:81], a[226:229], v[166:173], v0
  s_waitcnt lgkmcnt(4)
  v_fmac_f32 v120, v76, v76
  v_smfmac_f32_16x16x64_bf16 v[78:81], a[230:233], v[126:133], v0
  v_add_f32 v116, v116, v77
  v_mfma_f32_16x16x32_bf16 v[234:237], a[36:39], v[182:185], v[234:237]
  v_fmac_f32 v120, v77, v77
  v_mfma_f32_16x16x32_bf16 v[234:237], a[40:43], v[202:205], v[234:237]
  buffer_store_dwordx4 v[230:233], v14, s[8:11], s32 offen
  v_add_f32 v116, v116, v78
  v_mfma_f32_16x16x32_bf16 v[234:237], a[44:47], v[214:217], v[234:237]
  s_waitcnt lgkmcnt(2)
  v_fmac_f32 v120, v78, v78
  v_add_f32 v116, v116, v79
  v_smfmac_f32_16x16x64_bf16 v[82:85], a[236:239], v[134:141], v0
  s_waitcnt lgkmcnt(0)
  v_fmac_f32 v120, v79, v79
  v_smfmac_f32_16x16x64_bf16 v[82:85], a[240:243], v[142:149], v0
  v_cvt_pk_bf16_f32 v220, v234, v235
  v_mfma_f32_16x16x32_bf16 v[126:129], a[48:51], v[178:181], 0
  v_cvt_pk_bf16_f32 v221, v236, v237
  v_add_f32 v116, v116, v80
  v_mfma_f32_16x16x32_bf16 v[126:129], a[52:55], v[206:209], v[126:129]
  ds_read_b64 v[110:111], v11
  v_fmac_f32 v120, v80, v80
  v_mfma_f32_16x16x32_bf16 v[126:129], a[56:59], v[194:197], v[126:129]
  ds_read_b64 v[118:119], v11 offset:32
  v_add_f32 v116, v116, v81
  v_mfma_f32_16x16x32_bf16 v[126:129], a[60:63], v[182:185], v[126:129]
  ds_read_b64 v[114:115], v11 offset:64
  v_fmac_f32 v120, v81, v81
  v_mfma_f32_16x16x32_bf16 v[126:129], a[64:67], v[202:205], v[126:129]
  ds_read_b128 v[142:145], v5
  ds_read_b128 v[146:149], v5 offset:864
  v_mfma_f32_16x16x32_bf16 v[126:129], a[68:71], v[214:217], v[126:129]
  ds_read_b128 v[134:137], v5 offset:1728
  v_add_f32 v116, v116, v82
  v_mfma_f32_16x16x32_bf16 v[234:237], v[178:181], a[144:147], 0
  ds_read_b128 v[138:141], v8
  v_fmac_f32 v120, v82, v82
  v_mfma_f32_16x16x32_bf16 v[234:237], v[206:209], a[148:151], v[234:237]
  v_cvt_pk_bf16_f32 v122, v126, v127
  v_cvt_pk_bf16_f32 v123, v128, v129
  v_mfma_f32_16x16x32_bf16 v[234:237], v[194:197], a[152:155], v[234:237]
  v_add_f32 v116, v116, v83
  v_fmac_f32 v120, v83, v83
  v_mfma_f32_16x16x32_bf16 v[234:237], v[182:185], a[156:159], v[234:237]
  ds_read_b128 v[126:129], v5 offset:32
  ds_read_b128 v[130:133], v5 offset:896
  v_mfma_f32_16x16x32_bf16 v[234:237], v[202:205], a[160:163], v[234:237]
  ds_read_b128 v[166:169], v5 offset:1760
  v_add_f32 v116, v116, v84
  v_mfma_f32_16x16x32_bf16 v[234:237], v[214:217], a[164:167], v[234:237]
  s_waitcnt lgkmcnt(5)
  ds_read_b128 v[170:173], v8 offset:32
  v_fmac_f32 v120, v84, v84
  v_add_f32 v116, v116, v85
  v_mfma_f32_16x16x16_bf16 v[86:89], a[224:225], v[110:111], 0
  v_fmac_f32 v120, v85, v85
  v_permlane32_swap_b32 v112, v108
  v_mfma_f32_16x16x16_bf16 v[90:93], a[234:235], v[118:119], 0
  v_cvt_pk_bf16_f32 v160, v234, v235
  v_cvt_pk_bf16_f32 v161, v236, v237
  v_add_f32 v112, v112, v108
  v_mfma_f32_16x16x16_bf16 v[94:97], a[244:245], v[114:115], 0
  v_permlane32_swap_b32 v116, v120
  v_add_f32 v116, v116, v120
  v_smfmac_f32_16x16x64_bf16 v[86:89], a[216:219], v[142:149], v0
  s_waitcnt lgkmcnt(4)
  buffer_store_dwordx2 v[106:107], v23, s[8:11], s32 offen
  ds_read_b128 v[142:145], v5 offset:64
  v_smfmac_f32_16x16x64_bf16 v[86:89], a[220:223], v[134:141], v0
  s_mov_b32 s32, s33
  ds_read_b128 v[146:149], v5 offset:928
  ds_read_b128 v[134:137], v5 offset:1792
  v_mfma_f32_16x16x32_bf16 v[234:237], v[178:181], a[168:171], 0
  s_mov_b32 s33, s34
  ds_read_b128 v[138:141], v8 offset:64
  v_mfma_f32_16x16x32_bf16 v[234:237], v[206:209], a[172:175], v[234:237]
  s_mov_b32 s34, s35
  v_mul_f32 v108, v86, v86
  v_add_f32 v120, v86, v87
  v_mfma_f32_16x16x32_bf16 v[234:237], v[194:197], a[176:179], v[234:237]
  s_waitcnt lgkmcnt(6)
  buffer_load_dword v25, v24, s[24:27], s68 offen
  v_smfmac_f32_16x16x64_bf16 v[90:93], a[226:229], v[126:133], v0
  s_waitcnt lgkmcnt(4)
  v_fmac_f32 v108, v87, v87
  v_smfmac_f32_16x16x64_bf16 v[90:93], a[230:233], v[166:173], v0
  v_add_f32 v120, v120, v88
  v_mfma_f32_16x16x32_bf16 v[234:237], v[182:185], a[180:183], v[234:237]
  v_fmac_f32 v108, v88, v88
  v_add_f32 v120, v120, v89
  v_mfma_f32_16x16x32_bf16 v[234:237], v[202:205], a[184:187], v[234:237]
  v_fmac_f32 v108, v89, v89
  v_add_f32 v120, v120, v90
  v_mfma_f32_16x16x32_bf16 v[234:237], v[214:217], a[188:191], v[234:237]
  s_waitcnt lgkmcnt(2)
  v_fmac_f32 v108, v90, v90
  v_add_f32 v120, v120, v91
  v_smfmac_f32_16x16x64_bf16 v[94:97], a[236:239], v[142:149], v0
  s_waitcnt lgkmcnt(0)
  v_fmac_f32 v108, v91, v91
  v_smfmac_f32_16x16x64_bf16 v[94:97], a[240:243], v[134:141], v0
  ds_read_b128 v[134:137], v15 offset:14336
  v_add_f32 v120, v120, v92
  v_mfma_f32_16x16x32_bf16 v[126:129], v[178:181], a[192:195], 0
  ds_read_b128 v[130:133], v15 offset:15360
  v_fmac_f32 v108, v92, v92
  v_mfma_f32_16x16x32_bf16 v[126:129], v[206:209], a[196:199], v[126:129]
  ds_read_b128 v[138:141], v15 offset:16384
  v_add_f32 v120, v120, v93
  v_mfma_f32_16x16x32_bf16 v[126:129], v[194:197], a[200:203], v[126:129]
  ds_read_b128 v[142:145], v15 offset:17408
  v_fmac_f32 v108, v93, v93
  v_mfma_f32_16x16x32_bf16 v[126:129], v[182:185], a[204:207], v[126:129]
  ds_read_b128 v[146:149], v15 offset:18432
  v_add_f32 v120, v120, v94
  v_mfma_f32_16x16x32_bf16 v[126:129], v[202:205], a[208:211], v[126:129]
  ds_read_b128 v[202:205], v15 offset:19456
  v_fmac_f32 v108, v94, v94
  v_mfma_f32_16x16x32_bf16 v[126:129], v[214:217], a[212:215], v[126:129]
  v_cvt_pk_bf16_f32 v200, v234, v235
  v_cvt_pk_bf16_f32 v201, v236, v237
  v_add_f32 v120, v120, v95
  v_mfma_f32_16x16x16_bf16 v[234:237], v[222:223], v[162:163], 0
  v_fmac_f32 v108, v95, v95
  v_add_f32 v120, v120, v96
  v_fmac_f32 v108, v96, v96
  v_mfma_f32_16x16x16_bf16 v[214:217], v[164:165], v[122:123], 0
  v_add_f32 v120, v120, v97
  v_fmac_f32 v108, v97, v97
  v_permlane16_swap_b32 v112, v116
  v_mfma_f32_16x16x32_bf16 v[234:237], v[226:229], v[150:153], v[234:237]
  v_permlane32_swap_b32 v120, v108
  v_mfma_f32_16x16x32_bf16 v[214:217], v[154:157], v[218:221], v[214:217]
  s_waitcnt lgkmcnt(5)
  v_add_f32 v120, v120, v108
  v_mov_b32 v108, v120
  v_mfma_f32_16x16x32_bf16 v[182:185], a[72:75], v[134:137], 0
  s_waitcnt lgkmcnt(4)
  v_permlane16_swap_b32 v120, v108
  v_mfma_f32_16x16x32_bf16 v[182:185], a[76:79], v[130:133], v[182:185]
  s_waitcnt lgkmcnt(3)
  v_add_f32 v112, v112, v116
  v_add_f32 v120, v120, v108
  v_mfma_f32_16x16x32_bf16 v[182:185], a[80:83], v[138:141], v[182:185]
  s_waitcnt lgkmcnt(2)
  ds_write_b32 v109, v112
  v_mfma_f32_16x16x32_bf16 v[182:185], a[84:87], v[142:145], v[182:185]
  s_waitcnt lgkmcnt(2)
  ds_write_b32 v109, v120 offset:512
  v_mfma_f32_16x16x32_bf16 v[182:185], a[88:91], v[146:149], v[182:185]
  s_waitcnt lgkmcnt(2)
  v_cvt_pk_bf16_f32 v188, v126, v127
  v_cvt_pk_bf16_f32 v189, v128, v129
  v_mfma_f32_16x16x32_bf16 v[182:185], a[92:95], v[202:205], v[182:185]
  v_exp_f32 v234, v234
  v_mfma_f32_16x16x32_bf16 v[126:129], a[96:99], v[134:137], 0
  v_exp_f32 v235, v235
  v_mfma_f32_16x16x32_bf16 v[126:129], a[100:103], v[130:133], v[126:129]
  v_exp_f32 v236, v236
  v_mfma_f32_16x16x32_bf16 v[126:129], a[104:107], v[138:141], v[126:129]
  v_exp_f32 v237, v237
  v_mfma_f32_16x16x32_bf16 v[126:129], a[108:111], v[142:145], v[126:129]
  v_exp_f32 v214, v214
  v_mfma_f32_16x16x32_bf16 v[126:129], a[112:115], v[146:149], v[126:129]
  v_exp_f32 v215, v215
  v_mfma_f32_16x16x32_bf16 v[126:129], a[116:119], v[202:205], v[126:129]
  s_waitcnt lgkmcnt(0)
  s_barrier
  v_mfma_f32_16x16x32_bf16 v[194:197], a[120:123], v[134:137], 0
  v_exp_f32 v216, v216
  v_mfma_f32_16x16x32_bf16 v[194:197], a[124:127], v[130:133], v[194:197]
  v_exp_f32 v217, v217
  v_mfma_f32_16x16x32_bf16 v[194:197], a[128:131], v[138:141], v[194:197]
  ds_read_b128 v[206:209], v15
  ds_read_b128 v[178:181], v15 offset:1024
  v_mfma_f32_16x16x32_bf16 v[194:197], a[132:135], v[142:145], v[194:197]
  v_cvt_pk_bf16_f32 v166, v182, v183
  v_cvt_pk_bf16_f32 v167, v184, v185
  v_mfma_f32_16x16x32_bf16 v[194:197], a[136:139], v[146:149], v[194:197]
  v_cvt_pk_bf16_f32 v212, v234, v235
  v_cvt_pk_bf16_f32 v213, v236, v237
  v_mfma_f32_16x16x32_bf16 v[194:197], a[140:143], v[202:205], v[194:197]
  v_cvt_pk_bf16_f32 v234, v214, v215
  v_cvt_pk_bf16_f32 v168, v126, v127
  v_cvt_pk_bf16_f32 v169, v128, v129
  v_mfma_f32_16x16x16_bf16 v[126:129], v[222:223], v[122:123], 0
  v_cvt_pk_bf16_f32 v235, v216, v217
  v_mfma_f32_16x16x16_bf16 v[214:217], v[222:223], v[254:255], 0
  ds_read_b64 v[224:225], v19 offset:16
  ds_read2_b64 v[182:185], v19 offset0:0 offset1:1
  v_cvt_pk_bf16_f32 v230, v194, v195
  v_cvt_pk_bf16_f32 v231, v196, v197
  v_mfma_f32_16x16x32_bf16 v[126:129], v[226:229], v[218:221], v[126:129]
  s_waitcnt lgkmcnt(2)
  v_add_f32 v206, v206, v207
  v_add_f32 v208, v208, v209
  v_mfma_f32_16x16x32_bf16 v[214:217], v[226:229], v[190:193], v[214:217]
  v_add_f32 v178, v178, v179
  v_add_f32 v180, v180, v181
  v_mfma_f32_16x16x32_bf16 v[194:197], v[134:137], a[144:147], 0
  v_exp_f32 v126, v126
  v_mfma_f32_16x16x32_bf16 v[194:197], v[130:133], a[148:151], v[194:197]
  v_exp_f32 v127, v127
  v_mfma_f32_16x16x32_bf16 v[194:197], v[138:141], a[152:155], v[194:197]
  v_exp_f32 v128, v128
  v_mfma_f32_16x16x32_bf16 v[194:197], v[142:145], a[156:159], v[194:197]
  v_exp_f32 v129, v129
  v_mfma_f32_16x16x32_bf16 v[194:197], v[146:149], a[160:163], v[194:197]
  v_exp_f32 v214, v214
  v_mfma_f32_16x16x32_bf16 v[194:197], v[202:205], a[164:167], v[194:197]
  v_exp_f32 v215, v215
  v_mfma_f32_16x16x32_bf16 v[170:173], v[134:137], a[168:171], 0
  v_exp_f32 v216, v216
  v_mfma_f32_16x16x32_bf16 v[170:173], v[130:133], a[172:175], v[170:173]
  v_exp_f32 v217, v217
  v_mfma_f32_16x16x32_bf16 v[170:173], v[138:141], a[176:179], v[170:173]
  v_cvt_pk_bf16_f32 v236, v126, v127
  v_cvt_pk_bf16_f32 v237, v128, v129
  v_mfma_f32_16x16x32_bf16 v[170:173], v[142:145], a[180:183], v[170:173]
  v_cvt_pk_bf16_f32 v106, v194, v195
  v_cvt_pk_bf16_f32 v107, v196, v197
  v_mfma_f32_16x16x32_bf16 v[170:173], v[146:149], a[184:187], v[170:173]
  v_cvt_pk_bf16_f32 v176, v214, v215
  v_cvt_pk_bf16_f32 v177, v216, v217
  v_mfma_f32_16x16x32_bf16 v[170:173], v[202:205], a[188:191], v[170:173]
  s_waitcnt lgkmcnt(1)
  v_add_f32 v206, v206, v208
  v_add_f32 v178, v178, v180
  v_mul_f32 v207, 0x3baaaaab, v206
  v_mfma_f32_16x16x16_bf16 v[126:129], v[230:231], v[162:163], 0
  v_fma_f32 v178, -v207, v206, v178
  v_max_f32 v178, 0, v178
  v_add_f32 v178, 0x3afba882, v178
  v_mfma_f32_16x16x16_bf16 v[214:217], v[224:225], v[162:163], v[2:5]
  v_cvt_pk_bf16_f32 v110, v170, v171
  v_cvt_pk_bf16_f32 v111, v172, v173
  v_rsq_f32 v178, v178
  v_mfma_f32_16x16x32_bf16 v[126:129], v[166:169], v[150:153], v[126:129]
  s_waitcnt lgkmcnt(0)
  v_mul_f32 v178, 0x40ca568a, v178
  v_mul_f32 v179, -v207, v178
  v_mfma_f32_16x16x32_bf16 v[214:217], v[182:185], v[150:153], v[214:217]
  ds_write_b64 v113, v[178:179]
  v_mfma_f32_16x16x32_bf16 v[150:153], v[134:137], a[192:195], 0
  ds_read_b64 v[162:163], v117 offset:768
  v_add_u32 v19, 1160, v19
  v_mfma_f32_16x16x32_bf16 v[150:153], v[130:133], a[196:199], v[150:153]
  v_exp_f32 v126, v126
  v_mfma_f32_16x16x32_bf16 v[150:153], v[138:141], a[200:203], v[150:153]
  ds_read_u16 v108, v20
  v_mfma_f32_16x16x32_bf16 v[150:153], v[142:145], a[204:207], v[150:153]
  v_exp_f32 v127, v127
  v_mfma_f32_16x16x32_bf16 v[150:153], v[146:149], a[208:211], v[150:153]
  ds_read_u16 v112, v20 offset:32
  v_cvt_pk_bf16_f32 v118, v126, v127
  v_mfma_f32_16x16x32_bf16 v[150:153], v[202:205], a[212:215], v[150:153]
  v_exp_f32 v128, v128
  v_mfma_f32_16x16x16_bf16 v[178:181], v[230:231], v[122:123], 0
  ds_read_u16 v116, v20 offset:64
  v_exp_f32 v129, v129
  v_mfma_f32_16x16x16_bf16 v[206:209], v[224:225], v[122:123], v[2:5]
  v_exp_f32 v214, v214
  v_cvt_pk_bf16_f32 v119, v128, v129
  v_cvt_pk_bf16_f32 v120, v214, 0
  v_mfma_f32_16x16x32_bf16 v[178:181], v[166:169], v[218:221], v[178:181]
  s_waitcnt lgkmcnt(3)
  v_cvt_pk_bf16_f32 v114, v150, v151
  v_cvt_pk_bf16_f32 v115, v152, v153
  v_mfma_f32_16x16x32_bf16 v[206:209], v[182:185], v[218:221], v[206:209]
  v_fma_f32 v126, v62, v162, v163
  v_fma_f32 v232, v63, v162, v163
  v_mfma_f32_16x16x32_bf16 v[150:153], a[0:3], v[134:137], 0
  v_exp_f32 v178, v178
  v_mfma_f32_16x16x32_bf16 v[150:153], a[4:7], v[130:133], v[150:153]
  v_exp_f32 v179, v179
  v_mfma_f32_16x16x32_bf16 v[150:153], a[8:11], v[138:141], v[150:153]
  v_exp_f32 v180, v180
  v_mfma_f32_16x16x32_bf16 v[150:153], a[12:15], v[142:145], v[150:153]
  v_exp_f32 v181, v181
  v_mfma_f32_16x16x32_bf16 v[150:153], a[16:19], v[146:149], v[150:153]
  v_exp_f32 v206, v206
  v_mfma_f32_16x16x32_bf16 v[150:153], a[20:23], v[202:205], v[150:153]
  v_cvt_pk_bf16_f32 v122, v178, v179
  v_cvt_pk_bf16_f32 v123, v180, v181
  v_mfma_f32_16x16x32_bf16 v[178:181], a[246:249], v[210:213], 0
  v_cvt_pk_bf16_f32 v124, v206, 0
  v_cvt_pk_bf16_f32 v126, v126, v232
  v_mfma_f32_16x16x32_bf16 v[178:181], a[246:249], v[118:121], v[178:181]
  v_cvt_pk_bf16_f32 v206, v150, v151
  v_cvt_pk_bf16_f32 v207, v152, v153
  v_mfma_f32_16x16x32_bf16 v[150:153], v[158:161], v[210:213], 0
  s_waitcnt lgkmcnt(2)
  v_fma_f32 v127, v64, v162, v163
  v_fma_f32 v232, v65, v162, v163
  v_mfma_f32_16x16x32_bf16 v[150:153], v[106:109], v[118:121], v[150:153]
  v_cvt_pk_bf16_f32 v127, v127, v232
  v_fma_f32 v128, v66, v162, v163
  v_mfma_f32_16x16x32_bf16 v[218:221], v[198:201], v[210:213], 0
  s_waitcnt lgkmcnt(1)
  v_fma_f32 v232, v67, v162, v163
  v_cvt_pk_bf16_f32 v128, v128, v232
  v_mfma_f32_16x16x32_bf16 v[218:221], v[110:113], v[118:121], v[218:221]
  v_fma_f32 v129, v68, v162, v163
  v_fma_f32 v232, v69, v162, v163
  v_mfma_f32_16x16x32_bf16 v[214:217], v[186:189], v[210:213], 0
  s_waitcnt lgkmcnt(0)
  v_cvt_pk_bf16_f32 v129, v129, v232
  v_fma_f32 v232, v70, v162, v163
  v_mfma_f32_16x16x32_bf16 v[214:217], v[114:117], v[118:121], v[214:217]
  ds_write_b128 v16, v[126:129] offset:2048
  v_mfma_f32_16x16x32_bf16 v[126:129], a[24:27], v[134:137], 0
  v_fma_f32 v120, v71, v162, v163
  v_cvt_pk_bf16_f32 v232, v232, v120
  v_mfma_f32_16x16x32_bf16 v[126:129], a[28:31], v[130:133], v[126:129]
  v_fma_f32 v233, v72, v162, v163
  v_fma_f32 v120, v73, v162, v163
  v_mfma_f32_16x16x32_bf16 v[126:129], a[32:35], v[138:141], v[126:129]
  v_cvt_pk_bf16_f32 v233, v233, v120
  v_mul_f32 v178, 0x3ee9a3cd, v178
  v_mfma_f32_16x16x32_bf16 v[126:129], a[36:39], v[142:145], v[126:129]
  ds_write_b64 v17, v[232:233] offset:2048
  v_mfma_f32_16x16x32_bf16 v[126:129], a[40:43], v[146:149], v[126:129]
  v_rcp_f32 v232, v178
  v_mfma_f32_16x16x32_bf16 v[126:129], a[44:47], v[202:205], v[126:129]
  v_mul_f32 v150, v150, v232
  v_mul_f32 v151, v151, v232
  v_cvt_pk_bf16_f32 v210, v150, v151
  v_mfma_f32_16x16x16_bf16 v[170:173], v[230:231], v[254:255], 0
  v_mul_f32 v152, v152, v232
  v_mul_f32 v153, v153, v232
  v_cvt_pk_bf16_f32 v211, v152, v153
  v_mfma_f32_16x16x16_bf16 v[150:153], v[224:225], v[254:255], v[2:5]
  v_cvt_pk_bf16_f32 v208, v126, v127
  v_cvt_pk_bf16_f32 v209, v128, v129
  v_mul_f32 v218, v218, v232
  v_mul_f32 v219, v219, v232
  v_mfma_f32_16x16x32_bf16 v[170:173], v[166:169], v[190:193], v[170:173]
  v_cvt_pk_bf16_f32 v212, v218, v219
  v_mul_f32 v220, v220, v232
  v_mfma_f32_16x16x32_bf16 v[150:153], v[182:185], v[190:193], v[150:153]
  v_mul_f32 v221, v221, v232
  v_cvt_pk_bf16_f32 v213, v220, v221
  v_mfma_f32_16x16x32_bf16 v[218:221], a[246:249], v[234:237], 0
  ds_write_b128 v16, v[210:213] offset:20480
  v_mfma_f32_16x16x32_bf16 v[218:221], a[246:249], v[122:125], v[218:221]
  v_exp_f32 v170, v170
  v_mfma_f32_16x16x32_bf16 v[126:129], v[158:161], v[234:237], 0
  v_exp_f32 v171, v171
  v_mfma_f32_16x16x32_bf16 v[126:129], v[106:109], v[122:125], v[126:129]
  v_exp_f32 v172, v172
  v_mfma_f32_16x16x32_bf16 v[210:213], v[198:201], v[234:237], 0
  v_exp_f32 v173, v173
  v_mfma_f32_16x16x32_bf16 v[210:213], v[110:113], v[122:125], v[210:213]
  v_exp_f32 v150, v150
  v_mfma_f32_16x16x32_bf16 v[190:193], v[186:189], v[234:237], 0
  v_cvt_pk_bf16_f32 v118, v170, v171
  v_cvt_pk_bf16_f32 v119, v172, v173
  v_mfma_f32_16x16x32_bf16 v[190:193], v[114:117], v[122:125], v[190:193]
  v_cvt_pk_bf16_f32 v120, v150, 0
  v_mul_f32 v218, 0x3ee9a3cd, v218
  v_mfma_f32_16x16x32_bf16 v[150:153], a[48:51], v[134:137], 0
  v_rcp_f32 v233, v218
  v_mfma_f32_16x16x32_bf16 v[150:153], a[52:55], v[130:133], v[150:153]
  v_mul_f32 v126, v126, v233
  v_mul_f32 v127, v127, v233
  v_mfma_f32_16x16x32_bf16 v[150:153], a[56:59], v[138:141], v[150:153]
  v_cvt_pk_bf16_f32 v130, v126, v127
  v_mul_f32 v128, v128, v233
  v_mfma_f32_16x16x32_bf16 v[150:153], a[60:63], v[142:145], v[150:153]
  v_mul_f32 v129, v129, v233
  v_cvt_pk_bf16_f32 v131, v128, v129
  v_mfma_f32_16x16x32_bf16 v[150:153], a[64:67], v[146:149], v[150:153]
  v_mul_f32 v210, v210, v233
  v_mul_f32 v211, v211, v233
  v_mfma_f32_16x16x32_bf16 v[150:153], a[68:71], v[202:205], v[150:153]
  s_waitcnt lgkmcnt(1)
  s_barrier
  v_mfma_f32_16x16x32_bf16 v[202:205], v[174:177], a[246:249], 0
  v_cvt_pk_bf16_f32 v132, v210, v211
  v_mul_f32 v212, v212, v233
  v_mfma_f32_16x16x32_bf16 v[202:205], v[118:121], a[246:249], v[202:205]
  v_cvt_pk_bf16_f32 v122, v150, v151
  v_cvt_pk_bf16_f32 v123, v152, v153
  v_mfma_f32_16x16x32_bf16 v[146:149], v[174:177], v[158:161], 0
  v_mul_f32 v213, v213, v233
  v_cvt_pk_bf16_f32 v133, v212, v213
  v_mfma_f32_16x16x32_bf16 v[146:149], v[118:121], v[106:109], v[146:149]
  ds_write_b128 v16, v[130:133] offset:26624
  v_mfma_f32_16x16x32_bf16 v[142:145], v[174:177], v[198:201], 0
  v_mul_f32 v202, 0x3ee9a3cd, v202
  v_mul_f32 v214, v214, v232
  v_mfma_f32_16x16x32_bf16 v[142:145], v[118:121], v[110:113], v[142:145]
  ds_read_b128 v[126:129], v15 offset:2048
  v_mul_f32 v215, v215, v232
  v_mfma_f32_16x16x32_bf16 v[138:141], v[174:177], v[186:189], 0
  ds_read_b128 v[130:133], v15 offset:3072
  v_cvt_pk_bf16_f32 v254, v214, v215
  v_mfma_f32_16x16x32_bf16 v[138:141], v[118:121], v[114:117], v[138:141]
  ds_read_b128 v[134:137], v15 offset:4096
  v_rcp_f32 v120, v202
  v_mfma_f32_16x16x16_bf16 v[150:153], v[164:165], v[122:123], 0
  v_cndmask_b32 v124, v142, v146, s[54:55]
  v_mul_f32 v216, v216, v232
  v_mul_f32 v217, v217, v232
  v_mfma_f32_16x16x16_bf16 v[162:165], v[222:223], v[122:123], 0
  v_cvt_pk_bf16_f32 v255, v216, v217
  v_mul_f32 v190, v190, v233
  v_mul_f32 v191, v191, v233
  v_mfma_f32_16x16x16_bf16 v[214:217], v[230:231], v[122:123], 0
  v_cvt_pk_bf16_f32 v222, v190, v191
  v_mul_f32 v192, v192, v233
  v_mul_f32 v193, v193, v233
  v_mfma_f32_16x16x16_bf16 v[174:177], v[224:225], v[122:123], v[2:5]
  v_cvt_pk_bf16_f32 v223, v192, v193
  v_cndmask_b32 v124, v138, v124, s[56:57]
  v_mul_f32 v124, v124, v120
  v_cvt_pk_bf16_f32 v124, v124, v124
  v_mfma_f32_16x16x32_bf16 v[150:153], v[154:157], v[206:209], v[150:153]
  ds_read_b128 v[138:141], v15 offset:5120
  ds_read_b128 v[142:145], v15 offset:6144
  v_mfma_f32_16x16x32_bf16 v[162:165], v[226:229], v[206:209], v[162:165]
  ds_read_b128 v[146:149], v15 offset:7168
  v_max3_f32 v1, v1, v178, v232
  v_mfma_f32_16x16x32_bf16 v[214:217], v[166:169], v[206:209], v[214:217]
  ds_write_b64 v17, v[254:255] offset:20480
  v_mfma_f32_16x16x32_bf16 v[174:177], v[182:185], v[206:209], v[174:177]
  s_waitcnt lgkmcnt(6)
  v_exp_f32 v150, v150
  v_mfma_f32_16x16x32_bf16 v[154:157], a[0:3], v[126:129], 0
  s_waitcnt lgkmcnt(5)
  ds_write_b64 v17, v[222:223] offset:26624
  v_mfma_f32_16x16x32_bf16 v[154:157], a[4:7], v[130:133], v[154:157]
  s_waitcnt lgkmcnt(5)
  ds_write_b16 v20, v124 offset:384
  v_mfma_f32_16x16x32_bf16 v[154:157], a[8:11], v[134:137], v[154:157]
  s_waitcnt lgkmcnt(5)
  v_exp_f32 v151, v151
  v_mfma_f32_16x16x32_bf16 v[154:157], a[12:15], v[138:141], v[154:157]
  s_waitcnt lgkmcnt(4)
  v_exp_f32 v152, v152
  v_mfma_f32_16x16x32_bf16 v[154:157], a[16:19], v[142:145], v[154:157]
  s_waitcnt lgkmcnt(3)
  v_exp_f32 v153, v153
  v_mfma_f32_16x16x32_bf16 v[154:157], a[20:23], v[146:149], v[154:157]
  v_exp_f32 v162, v162
  v_mfma_f32_16x16x32_bf16 v[182:185], a[24:27], v[126:129], 0
  v_exp_f32 v163, v163
  v_mfma_f32_16x16x32_bf16 v[182:185], a[28:31], v[130:133], v[182:185]
  v_exp_f32 v164, v164
  v_mfma_f32_16x16x32_bf16 v[182:185], a[32:35], v[134:137], v[182:185]
  v_exp_f32 v165, v165
  v_mfma_f32_16x16x32_bf16 v[182:185], a[36:39], v[138:141], v[182:185]
  v_exp_f32 v214, v214
  v_mfma_f32_16x16x32_bf16 v[182:185], a[40:43], v[142:145], v[182:185]
  v_exp_f32 v215, v215
  v_mfma_f32_16x16x32_bf16 v[182:185], a[44:47], v[146:149], v[182:185]
  v_exp_f32 v216, v216
  v_mfma_f32_16x16x32_bf16 v[206:209], a[48:51], v[126:129], 0
  v_exp_f32 v217, v217
  v_mfma_f32_16x16x32_bf16 v[206:209], a[52:55], v[130:133], v[206:209]
  v_exp_f32 v174, v174
  v_mfma_f32_16x16x32_bf16 v[206:209], a[56:59], v[134:137], v[206:209]
  v_cvt_pk_bf16_f32 v166, v150, v151
  v_cvt_pk_bf16_f32 v167, v152, v153
  v_mfma_f32_16x16x32_bf16 v[206:209], a[60:63], v[138:141], v[206:209]
  v_cvt_pk_bf16_f32 v168, v162, v163
  v_cvt_pk_bf16_f32 v169, v164, v165
  v_mfma_f32_16x16x32_bf16 v[206:209], a[64:67], v[142:145], v[206:209]
  v_cvt_pk_bf16_f32 v150, v154, v155
  v_cvt_pk_bf16_f32 v151, v156, v157
  v_mfma_f32_16x16x32_bf16 v[206:209], a[68:71], v[146:149], v[206:209]
  v_cvt_pk_bf16_f32 v122, v214, v215
  v_cvt_pk_bf16_f32 v123, v216, v217
  v_mfma_f32_16x16x32_bf16 v[214:217], a[246:249], v[166:169], 0
  v_cvt_pk_bf16_f32 v124, v174, 0
  v_cvt_pk_bf16_f32 v152, v182, v183
  v_cvt_pk_bf16_f32 v153, v184, v185
  v_mfma_f32_16x16x32_bf16 v[214:217], a[246:249], v[122:125], v[214:217]
  v_cvt_pk_bf16_f32 v162, v206, v207
  v_cvt_pk_bf16_f32 v163, v208, v209
  v_mfma_f32_16x16x32_bf16 v[154:157], v[158:161], v[166:169], 0
  v_max3_f32 v1, v1, v218, v233
  v_max3_f32 v1, v1, v202, v120
  v_mfma_f32_16x16x32_bf16 v[154:157], v[106:109], v[122:125], v[154:157]
  v_mul_f32 v214, 0x3ee9a3cd, v214
  v_add_u32 v20, 1160, v20
  v_mfma_f32_16x16x32_bf16 v[158:161], v[198:201], v[166:169], 0
  v_rcp_f32 v108, v214
  v_mfma_f32_16x16x32_bf16 v[158:161], v[110:113], v[122:125], v[158:161]
  v_mul_f32 v154, v154, v108
  v_mul_f32 v155, v155, v108
  v_mfma_f32_16x16x32_bf16 v[198:201], v[186:189], v[166:169], 0
  v_mul_f32 v156, v156, v108
  v_mul_f32 v157, v157, v108
  v_mfma_f32_16x16x32_bf16 v[198:201], v[114:117], v[122:125], v[198:201]
  v_mul_f32 v158, v158, v108
  v_mul_f32 v159, v159, v108
  v_mfma_f32_16x16x32_bf16 v[166:169], a[72:75], v[126:129], 0
  v_mul_f32 v160, v160, v108
  v_mul_f32 v161, v161, v108
  v_mfma_f32_16x16x32_bf16 v[166:169], a[76:79], v[130:133], v[166:169]
  v_cvt_pk_bf16_f32 v186, v154, v155
  v_cvt_pk_bf16_f32 v187, v156, v157
  v_mfma_f32_16x16x32_bf16 v[166:169], a[80:83], v[134:137], v[166:169]
  v_cvt_pk_bf16_f32 v188, v158, v159
  v_cvt_pk_bf16_f32 v189, v160, v161
  v_mfma_f32_16x16x32_bf16 v[166:169], a[84:87], v[138:141], v[166:169]
  ds_write_b128 v16, v[186:189] offset:32768
  v_mfma_f32_16x16x32_bf16 v[166:169], a[88:91], v[142:145], v[166:169]
  v_mul_f32 v198, v198, v108
  v_mul_f32 v199, v199, v108
  v_mfma_f32_16x16x32_bf16 v[166:169], a[92:95], v[146:149], v[166:169]
  v_mul_f32 v200, v200, v108
  v_mul_f32 v201, v201, v108
  v_mfma_f32_16x16x32_bf16 v[186:189], a[96:99], v[126:129], 0
  v_cvt_pk_bf16_f32 v164, v198, v199
  v_cvt_pk_bf16_f32 v165, v200, v201
  v_mfma_f32_16x16x32_bf16 v[186:189], a[100:103], v[130:133], v[186:189]
  ds_write_b64 v17, v[164:165] offset:32768
  v_mfma_f32_16x16x32_bf16 v[186:189], a[104:107], v[134:137], v[186:189]
  v_cvt_pk_bf16_f32 v154, v166, v167
  v_cvt_pk_bf16_f32 v155, v168, v169
  v_mfma_f32_16x16x32_bf16 v[186:189], a[108:111], v[138:141], v[186:189]
  v_max3_f32 v1, v1, v214, v108
  v_mfma_f32_16x16x32_bf16 v[186:189], a[112:115], v[142:145], v[186:189]
  v_mfma_f32_16x16x32_bf16 v[186:189], a[116:119], v[146:149], v[186:189]
  v_mfma_f32_16x16x32_bf16 v[158:161], a[120:123], v[126:129], 0
  v_mfma_f32_16x16x32_bf16 v[158:161], a[124:127], v[130:133], v[158:161]
  v_cvt_pk_bf16_f32 v156, v186, v187
  v_cvt_pk_bf16_f32 v157, v188, v189
  v_mfma_f32_16x16x32_bf16 v[158:161], a[128:131], v[134:137], v[158:161]
  v_mfma_f32_16x16x32_bf16 v[158:161], a[132:135], v[138:141], v[158:161]
  v_mfma_f32_16x16x32_bf16 v[158:161], a[136:139], v[142:145], v[158:161]
  v_mfma_f32_16x16x32_bf16 v[158:161], a[140:143], v[146:149], v[158:161]
  s_waitcnt lgkmcnt(0)
  s_barrier
  s_branch L_loop
L_last:
  v_mfma_f32_16x16x32_bf16 v[166:169], v[126:129], a[144:147], 0
  ds_read_b128 v[170:173], v15 offset:20480
  ds_read_b128 v[174:177], v15 offset:26624
  v_mfma_f32_16x16x32_bf16 v[166:169], v[130:133], a[148:151], v[166:169]
  ds_read_b128 v[178:181], v15 offset:32768
  v_cvt_pk_bf16_f32 v164, v158, v159
  v_mfma_f32_16x16x32_bf16 v[166:169], v[134:137], a[152:155], v[166:169]
  ds_read_b64 v[106:107], v117 offset:896
  ds_read_b64 v[110:111], v117 offset:1792
  v_mfma_f32_16x16x32_bf16 v[166:169], v[138:141], a[156:159], v[166:169]
  buffer_load_dwordx4 v[182:185], v15, s[12:15], s77 offen offset:2048
  v_mfma_f32_16x16x32_bf16 v[166:169], v[142:145], a[160:163], v[166:169]
  v_cvt_pk_bf16_f32 v165, v160, v161
  v_and_b32 v242, -16, v109
  v_mfma_f32_16x16x32_bf16 v[166:169], v[146:149], a[164:167], v[166:169]
  s_waitcnt lgkmcnt(4)
  v_mfma_f32_16x16x32_bf16 v[62:65], a[250:253], v[170:173], v[62:65]
  v_mfma_f32_16x16x32_bf16 v[66:69], v[98:101], v[170:173], v[66:69]
  v_cvt_pk_bf16_f32 v158, v166, v167
  v_cvt_pk_bf16_f32 v159, v168, v169
  v_mfma_f32_16x16x32_bf16 v[70:73], v[102:105], v[170:173], v[70:73]
  s_waitcnt lgkmcnt(1)
  ds_read_b128 v[170:173], v18
  ds_read_b128 v[166:169], v15 offset:21504
  v_mfma_f32_16x16x32_bf16 v[74:77], a[250:253], v[174:177], v[74:77]
  s_waitcnt lgkmcnt(2)
  ds_read_b128 v[186:189], v18 offset:1024
  v_fma_f32 v190, v38, v106, v107
  v_mfma_f32_16x16x32_bf16 v[78:81], v[98:101], v[174:177], v[78:81]
  ds_read_b128 v[194:197], v18 offset:2048
  v_fma_f32 v108, v39, v106, v107
  v_mfma_f32_16x16x32_bf16 v[82:85], v[102:105], v[174:177], v[82:85]
  ds_read_b128 v[174:177], v15 offset:27648
  v_cvt_pk_bf16_f32 v190, v190, v108
  v_mfma_f32_16x16x32_bf16 v[86:89], a[250:253], v[178:181], v[86:89]
  v_fma_f32 v191, v40, v106, v107
  v_fma_f32 v108, v41, v106, v107
  v_mfma_f32_16x16x32_bf16 v[90:93], v[98:101], v[178:181], v[90:93]
  v_cvt_pk_bf16_f32 v191, v191, v108
  v_fma_f32 v192, v42, v106, v107
  v_mfma_f32_16x16x32_bf16 v[94:97], v[102:105], v[178:181], v[94:97]
  ds_read_b128 v[178:181], v15 offset:33792
  v_fma_f32 v108, v43, v106, v107
  v_mfma_f32_16x16x32_bf16 v[198:201], v[126:129], a[168:171], 0
  v_cvt_pk_bf16_f32 v192, v192, v108
  v_fma_f32 v193, v44, v106, v107
  v_mfma_f32_16x16x32_bf16 v[198:201], v[130:133], a[172:175], v[198:201]
  v_fma_f32 v108, v45, v106, v107
  v_cvt_pk_bf16_f32 v193, v193, v108
  v_mfma_f32_16x16x32_bf16 v[198:201], v[134:137], a[176:179], v[198:201]
  ds_write_b128 v16, v[190:193] offset:8192
  v_mfma_f32_16x16x32_bf16 v[198:201], v[138:141], a[180:183], v[198:201]
  v_fma_f32 v190, v50, v110, v111
  v_fma_f32 v108, v51, v110, v111
  v_mfma_f32_16x16x32_bf16 v[198:201], v[142:145], a[184:187], v[198:201]
  v_cvt_pk_bf16_f32 v190, v190, v108
  v_fma_f32 v191, v52, v110, v111
  v_mfma_f32_16x16x32_bf16 v[198:201], v[146:149], a[188:191], v[198:201]
  s_waitcnt lgkmcnt(5)
  v_fma_f32 v108, v53, v110, v111
  v_cvt_pk_bf16_f32 v191, v191, v108
  v_mfma_f32_16x16x32_bf16 v[62:65], v[170:173], v[166:169], v[62:65]
  s_waitcnt lgkmcnt(4)
  v_fma_f32 v192, v54, v110, v111
  v_fma_f32 v108, v55, v110, v111
  v_mfma_f32_16x16x32_bf16 v[66:69], v[186:189], v[166:169], v[66:69]
  s_waitcnt lgkmcnt(3)
  v_cvt_pk_bf16_f32 v202, v198, v199
  v_cvt_pk_bf16_f32 v203, v200, v201
  v_mfma_f32_16x16x32_bf16 v[70:73], v[194:197], v[166:169], v[70:73]
  s_waitcnt lgkmcnt(2)
  ds_read_b128 v[166:169], v18 offset:6144
  ds_read_b128 v[198:201], v15 offset:22528
  v_mfma_f32_16x16x32_bf16 v[74:77], v[170:173], v[174:177], v[74:77]
  ds_read_b128 v[206:209], v18 offset:7168
  v_cvt_pk_bf16_f32 v192, v192, v108
  v_mfma_f32_16x16x32_bf16 v[78:81], v[186:189], v[174:177], v[78:81]
  ds_read_b128 v[210:213], v18 offset:8192
  v_fma_f32 v193, v56, v110, v111
  v_mfma_f32_16x16x32_bf16 v[82:85], v[194:197], v[174:177], v[82:85]
  s_waitcnt lgkmcnt(5)
  ds_read_b128 v[174:177], v15 offset:28672
  v_fma_f32 v108, v57, v110, v111
  v_mfma_f32_16x16x32_bf16 v[86:89], v[170:173], v[178:181], v[86:89]
  v_cvt_pk_bf16_f32 v193, v193, v108
  v_fma_f32 v114, v46, v106, v107
  v_mfma_f32_16x16x32_bf16 v[90:93], v[186:189], v[178:181], v[90:93]
  ds_write_b128 v16, v[190:193] offset:14336
  v_mfma_f32_16x16x32_bf16 v[94:97], v[194:197], v[178:181], v[94:97]
  v_fma_f32 v108, v47, v106, v107
  v_cvt_pk_bf16_f32 v114, v114, v108
  v_mfma_f32_16x16x32_bf16 v[178:181], v[126:129], a[192:195], 0
  ds_read_b128 v[126:129], v15 offset:34816
  ds_read_b64 v[254:255], v19 offset:784
  v_mfma_f32_16x16x32_bf16 v[178:181], v[130:133], a[196:199], v[178:181]
  ds_read2_b64 v[130:133], v19 offset0:96 offset1:97
  v_fma_f32 v115, v48, v106, v107
  v_mfma_f32_16x16x32_bf16 v[178:181], v[134:137], a[200:203], v[178:181]
  v_fma_f32 v108, v49, v106, v107
  v_cvt_pk_bf16_f32 v115, v115, v108
  v_mfma_f32_16x16x32_bf16 v[178:181], v[138:141], a[204:207], v[178:181]
  ds_write_b64 v17, v[114:115] offset:8192
  v_mfma_f32_16x16x32_bf16 v[178:181], v[142:145], a[208:211], v[178:181]
  v_fma_f32 v106, v58, v110, v111
  v_fma_f32 v108, v59, v110, v111
  v_mfma_f32_16x16x32_bf16 v[178:181], v[146:149], a[212:215], v[178:181]
  s_waitcnt lgkmcnt(8)
  v_cvt_pk_bf16_f32 v106, v106, v108
  v_fma_f32 v107, v60, v110, v111
  v_mfma_f32_16x16x32_bf16 v[62:65], v[166:169], v[198:201], v[62:65]
  s_waitcnt lgkmcnt(7)
  ds_read_b128 v[146:149], v18 offset:9216
  ds_read_b128 v[142:145], v15 offset:23552
  v_mfma_f32_16x16x32_bf16 v[66:69], v[206:209], v[198:201], v[66:69]
  s_waitcnt lgkmcnt(8)
  ds_read_b128 v[138:141], v18 offset:10240
  v_cvt_pk_bf16_f32 v134, v178, v179
  v_mfma_f32_16x16x32_bf16 v[70:73], v[210:213], v[198:201], v[70:73]
  s_waitcnt lgkmcnt(8)
  ds_read_b128 v[198:201], v18 offset:11264
  v_cvt_pk_bf16_f32 v135, v180, v181
  v_mfma_f32_16x16x32_bf16 v[74:77], v[166:169], v[174:177], v[74:77]
  ds_read_b128 v[178:181], v15 offset:29696
  v_fma_f32 v108, v61, v110, v111
  v_mfma_f32_16x16x32_bf16 v[78:81], v[206:209], v[174:177], v[78:81]
  v_cvt_pk_bf16_f32 v107, v107, v108
  v_mfma_f32_16x16x32_bf16 v[82:85], v[210:213], v[174:177], v[82:85]
  s_waitcnt lgkmcnt(8)
  ds_write_b64 v17, v[106:107] offset:14336
  v_mfma_f32_16x16x32_bf16 v[86:89], v[166:169], v[126:129], v[86:89]
  ds_read_b128 v[166:169], v15 offset:35840
  v_mfma_f32_16x16x32_bf16 v[90:93], v[206:209], v[126:129], v[90:93]
  v_mfma_f32_16x16x32_bf16 v[94:97], v[210:213], v[126:129], v[94:97]
  s_waitcnt lgkmcnt(9)
  v_mfma_f32_16x16x16_bf16 v[126:129], v[164:165], v[162:163], 0
  ds_read_b128 v[210:213], v18 offset:3072
  ds_read_b128 v[206:209], v15 offset:24576
  v_mfma_f32_16x16x16_bf16 v[174:177], v[164:165], v[254:255], 0
  ds_read_b128 v[194:197], v18 offset:4096
  v_mfma_f32_16x16x32_bf16 v[126:129], v[154:157], v[150:153], v[126:129]
  s_waitcnt lgkmcnt(11)
  ds_read_b128 v[190:193], v18 offset:5120
  v_mfma_f32_16x16x32_bf16 v[174:177], v[154:157], v[130:133], v[174:177]
  s_waitcnt lgkmcnt(9)
  ds_read_b128 v[186:189], v15 offset:30720
  v_mfma_f32_16x16x32_bf16 v[62:65], v[146:149], v[142:145], v[62:65]
  s_waitcnt vmcnt(0) lgkmcnt(9)
  v_exp_f32 v126, v126
  v_mfma_f32_16x16x32_bf16 v[66:69], v[138:141], v[142:145], v[66:69]
  s_waitcnt lgkmcnt(8)
  v_exp_f32 v127, v127
  v_mfma_f32_16x16x32_bf16 v[70:73], v[198:201], v[142:145], v[70:73]
  s_waitcnt lgkmcnt(7)
  ds_read_b128 v[142:145], v15 offset:36864
  v_cvt_pk_bf16_f32 v170, v126, v127
  v_mfma_f32_16x16x32_bf16 v[74:77], v[146:149], v[178:181], v[74:77]
  v_exp_f32 v128, v128
  v_mfma_f32_16x16x32_bf16 v[78:81], v[138:141], v[178:181], v[78:81]
  v_exp_f32 v129, v129
  v_mfma_f32_16x16x32_bf16 v[82:85], v[198:201], v[178:181], v[82:85]
  s_waitcnt lgkmcnt(6)
  ds_read_b128 v[178:181], v18 offset:12288
  ds_read_b128 v[214:217], v15 offset:25600
  v_mfma_f32_16x16x32_bf16 v[86:89], v[146:149], v[166:169], v[86:89]
  ds_read_b128 v[146:149], v18 offset:13312
  v_cvt_pk_bf16_f32 v171, v128, v129
  v_mfma_f32_16x16x32_bf16 v[90:93], v[138:141], v[166:169], v[90:93]
  ds_read_b128 v[138:141], v18 offset:14336
  v_add_u32 v250, 18560, v185
  v_mfma_f32_16x16x32_bf16 v[94:97], v[198:201], v[166:169], v[94:97]
  s_waitcnt lgkmcnt(8)
  ds_read_b128 v[166:169], v15 offset:31744
  v_mfma_f32_16x16x32_bf16 v[62:65], v[210:213], v[206:209], v[62:65]
  s_waitcnt lgkmcnt(8)
  v_exp_f32 v174, v174
  v_mfma_f32_16x16x32_bf16 v[66:69], v[194:197], v[206:209], v[66:69]
  s_waitcnt lgkmcnt(7)
  v_exp_f32 v175, v175
  v_mfma_f32_16x16x32_bf16 v[70:73], v[190:193], v[206:209], v[70:73]
  s_waitcnt lgkmcnt(6)
  v_exp_f32 v176, v176
  v_mfma_f32_16x16x32_bf16 v[74:77], v[210:213], v[186:189], v[74:77]
  v_exp_f32 v177, v177
  v_mfma_f32_16x16x32_bf16 v[78:81], v[194:197], v[186:189], v[78:81]
  ds_read_b128 v[206:209], v15 offset:37888
  v_cvt_pk_bf16_f32 v198, v174, v175
  v_mfma_f32_16x16x32_bf16 v[82:85], v[190:193], v[186:189], v[82:85]
  s_waitcnt lgkmcnt(6)
  v_cvt_pk_bf16_f32 v199, v176, v177
  v_mfma_f32_16x16x32_bf16 v[86:89], v[210:213], v[142:145], v[86:89]
  v_mfma_f32_16x16x32_bf16 v[90:93], v[194:197], v[142:145], v[90:93]
  v_mfma_f32_16x16x32_bf16 v[94:97], v[190:193], v[142:145], v[94:97]
  s_waitcnt lgkmcnt(4)
  s_barrier
  v_mfma_f32_16x16x32_bf16 v[62:65], v[178:181], v[214:217], v[62:65]
  s_waitcnt lgkmcnt(3)
  ds_read_b128 v[142:145], v15 offset:8192
  ds_read_b128 v[190:193], v15 offset:9216
  v_mfma_f32_16x16x32_bf16 v[66:69], v[146:149], v[214:217], v[66:69]
  s_waitcnt lgkmcnt(4)
  ds_read_b128 v[194:197], v15 offset:10240
  v_mfma_f32_16x16x32_bf16 v[70:73], v[138:141], v[214:217], v[70:73]
  s_waitcnt lgkmcnt(4)
  ds_read_b128 v[214:217], v15 offset:11264
  v_cvt_pk_bf16_f32 v210, v62, v63
  v_mfma_f32_16x16x32_bf16 v[74:77], v[178:181], v[166:169], v[74:77]
  ds_read_b128 v[174:177], v15 offset:12288
  v_cvt_pk_bf16_f32 v211, v64, v65
  v_mfma_f32_16x16x32_bf16 v[78:81], v[146:149], v[166:169], v[78:81]
  ds_read_b128 v[186:189], v15 offset:13312
  v_cvt_pk_bf16_f32 v212, v66, v67
  v_mfma_f32_16x16x32_bf16 v[82:85], v[138:141], v[166:169], v[82:85]
  s_waitcnt lgkmcnt(6)
  v_cvt_pk_bf16_f32 v213, v68, v69
  v_cvt_pk_bf16_f32 v166, v74, v75
  v_mfma_f32_16x16x32_bf16 v[86:89], v[178:181], v[206:209], v[86:89]
  v_permlane16_swap_b32 v210, v212
  v_mfma_f32_16x16x32_bf16 v[90:93], v[146:149], v[206:209], v[90:93]
  v_permlane16_swap_b32 v211, v213
  v_mfma_f32_16x16x32_bf16 v[94:97], v[138:141], v[206:209], v[94:97]
  s_waitcnt lgkmcnt(5)
  buffer_store_dwordx4 v[210:213], v12, s[8:11], s32 offen
  v_cvt_pk_bf16_f32 v167, v76, v77
  s_nop 0
  v_mfma_f32_16x16x32_bf16 v[210:213], a[72:75], v[142:145], 0
  s_waitcnt lgkmcnt(4)
  v_cvt_pk_bf16_f32 v168, v78, v79
  v_cvt_pk_bf16_f32 v169, v80, v81
  v_mfma_f32_16x16x32_bf16 v[210:213], a[76:79], v[190:193], v[210:213]
  s_waitcnt lgkmcnt(3)
  v_permlane16_swap_b32 v166, v168
  v_mfma_f32_16x16x32_bf16 v[210:213], a[80:83], v[194:197], v[210:213]
  s_waitcnt lgkmcnt(2)
  v_permlane16_swap_b32 v167, v169
  v_mfma_f32_16x16x32_bf16 v[210:213], a[84:87], v[214:217], v[210:213]
  s_waitcnt lgkmcnt(1)
  buffer_load_dwordx4 v[62:65], v15, s[12:15], s75 offen
  v_mfma_f32_16x16x32_bf16 v[210:213], a[88:91], v[174:177], v[210:213]
  s_waitcnt lgkmcnt(0)
  v_cvt_pk_bf16_f32 v138, v70, v71
  v_cvt_pk_bf16_f32 v139, v72, v73
  v_mfma_f32_16x16x32_bf16 v[210:213], a[92:95], v[186:189], v[210:213]
  v_cvt_pk_bf16_f32 v140, v82, v83
  v_cvt_pk_bf16_f32 v141, v84, v85
  v_mfma_f32_16x16x32_bf16 v[206:209], a[96:99], v[142:145], 0
  v_permlane16_swap_b32 v138, v140
  v_mfma_f32_16x16x32_bf16 v[206:209], a[100:103], v[190:193], v[206:209]
  buffer_load_dwordx4 v[66:69], v15, s[12:15], s75 offen offset:1024
  v_mfma_f32_16x16x32_bf16 v[206:209], a[104:107], v[194:197], v[206:209]
  v_cvt_pk_bf16_f32 v146, v210, v211
  v_cvt_pk_bf16_f32 v147, v212, v213
  v_mfma_f32_16x16x32_bf16 v[206:209], a[108:111], v[214:217], v[206:209]
  v_permlane16_swap_b32 v139, v141
  v_mfma_f32_16x16x32_bf16 v[206:209], a[112:115], v[174:177], v[206:209]
  v_cvt_pk_bf16_f32 v210, v86, v87
  v_cvt_pk_bf16_f32 v211, v88, v89
  v_mfma_f32_16x16x32_bf16 v[206:209], a[116:119], v[186:189], v[206:209]
  v_cvt_pk_bf16_f32 v212, v90, v91
  v_cvt_pk_bf16_f32 v213, v92, v93
  v_mfma_f32_16x16x32_bf16 v[178:181], a[120:123], v[142:145], 0
  buffer_load_dwordx4 v[70:73], v15, s[12:15], s75 offen offset:2048
  v_mfma_f32_16x16x32_bf16 v[178:181], a[124:127], v[190:193], v[178:181]
  v_cvt_pk_bf16_f32 v148, v206, v207
  v_cvt_pk_bf16_f32 v149, v208, v209
  v_mfma_f32_16x16x32_bf16 v[178:181], a[128:131], v[194:197], v[178:181]
  v_permlane16_swap_b32 v210, v212
  v_mfma_f32_16x16x32_bf16 v[178:181], a[132:135], v[214:217], v[178:181]
  v_permlane16_swap_b32 v211, v213
  v_mfma_f32_16x16x32_bf16 v[178:181], a[136:139], v[174:177], v[178:181]
  buffer_load_dwordx4 v[74:77], v15, s[12:15], s75 offen offset:3072
  v_mfma_f32_16x16x32_bf16 v[178:181], a[140:143], v[186:189], v[178:181]
  v_cvt_pk_bf16_f32 v110, v94, v95
  v_cvt_pk_bf16_f32 v111, v96, v97
  v_mfma_f32_16x16x32_bf16 v[206:209], a[0:3], v[142:145], 0
  v_mfma_f32_16x16x32_bf16 v[206:209], a[4:7], v[190:193], v[206:209]
  v_cvt_pk_bf16_f32 v226, v178, v179
  v_cvt_pk_bf16_f32 v227, v180, v181
  v_mfma_f32_16x16x32_bf16 v[206:209], a[8:11], v[194:197], v[206:209]
  v_mfma_f32_16x16x32_bf16 v[206:209], a[12:15], v[214:217], v[206:209]
  buffer_load_dwordx4 v[78:81], v15, s[12:15], s77 offen
  v_mfma_f32_16x16x32_bf16 v[206:209], a[16:19], v[174:177], v[206:209]
  v_mfma_f32_16x16x32_bf16 v[206:209], a[20:23], v[186:189], v[206:209]
  v_mfma_f32_16x16x32_bf16 v[178:181], a[24:27], v[142:145], 0
  v_mfma_f32_16x16x32_bf16 v[178:181], a[28:31], v[190:193], v[178:181]
  buffer_load_dwordx4 v[82:85], v15, s[12:15], s77 offen offset:1024
  v_mfma_f32_16x16x32_bf16 v[178:181], a[32:35], v[194:197], v[178:181]
  v_cvt_pk_bf16_f32 v126, v206, v207
  v_cvt_pk_bf16_f32 v127, v208, v209
  v_mfma_f32_16x16x32_bf16 v[178:181], a[36:39], v[214:217], v[178:181]
  v_mfma_f32_16x16x32_bf16 v[178:181], a[40:43], v[174:177], v[178:181]
  v_mfma_f32_16x16x32_bf16 v[178:181], a[44:47], v[186:189], v[178:181]
  v_mfma_f32_16x16x32_bf16 v[206:209], a[48:51], v[142:145], 0
  v_mfma_f32_16x16x32_bf16 v[206:209], a[52:55], v[190:193], v[206:209]
  v_cvt_pk_bf16_f32 v128, v178, v179
  v_cvt_pk_bf16_f32 v129, v180, v181
  v_mfma_f32_16x16x32_bf16 v[206:209], a[56:59], v[194:197], v[206:209]
  v_mfma_f32_16x16x32_bf16 v[206:209], a[60:63], v[214:217], v[206:209]
  v_mfma_f32_16x16x32_bf16 v[206:209], a[64:67], v[174:177], v[206:209]
  v_mfma_f32_16x16x32_bf16 v[206:209], a[68:71], v[186:189], v[206:209]
  v_mfma_f32_16x16x32_bf16 v[178:181], v[142:145], a[144:147], 0
  v_mfma_f32_16x16x32_bf16 v[178:181], v[190:193], a[148:151], v[178:181]
  v_cvt_pk_bf16_f32 v122, v206, v207
  v_cvt_pk_bf16_f32 v123, v208, v209
  v_mfma_f32_16x16x32_bf16 v[178:181], v[194:197], a[152:155], v[178:181]
  v_mfma_f32_16x16x32_bf16 v[178:181], v[214:217], a[156:159], v[178:181]
  v_mfma_f32_16x16x32_bf16 v[178:181], v[174:177], a[160:163], v[178:181]
  v_mfma_f32_16x16x32_bf16 v[178:181], v[186:189], a[164:167], v[178:181]
  v_mfma_f32_16x16x32_bf16 v[206:209], v[142:145], a[168:171], 0
  buffer_store_dwordx4 v[166:169], v13, s[8:11], s32 offen
  s_nop 2
  v_cvt_pk_bf16_f32 v160, v178, v179
  v_mfma_f32_16x16x32_bf16 v[206:209], v[190:193], a[172:175], v[206:209]
  v_cvt_pk_bf16_f32 v161, v180, v181
  v_mfma_f32_16x16x32_bf16 v[206:209], v[194:197], a[176:179], v[206:209]
  v_mfma_f32_16x16x32_bf16 v[206:209], v[214:217], a[180:183], v[206:209]
  v_mfma_f32_16x16x32_bf16 v[206:209], v[174:177], a[184:187], v[206:209]
  v_mfma_f32_16x16x32_bf16 v[206:209], v[186:189], a[188:191], v[206:209]
  ds_read_b128 v[178:181], v15 offset:14336
  v_mfma_f32_16x16x32_bf16 v[166:169], v[142:145], a[192:195], 0
  ds_read_b128 v[142:145], v15 offset:15360
  v_mfma_f32_16x16x32_bf16 v[166:169], v[190:193], a[196:199], v[166:169]
  ds_read_b128 v[190:193], v15 offset:16384
  v_cvt_pk_bf16_f32 v204, v206, v207
  v_mfma_f32_16x16x32_bf16 v[166:169], v[194:197], a[200:203], v[166:169]
  ds_read_b128 v[194:197], v15 offset:17408
  v_cvt_pk_bf16_f32 v205, v208, v209
  v_mfma_f32_16x16x32_bf16 v[166:169], v[214:217], a[204:207], v[166:169]
  ds_read_b128 v[214:217], v15 offset:18432
  v_mfma_f32_16x16x32_bf16 v[166:169], v[174:177], a[208:211], v[166:169]
  ds_read_b128 v[174:177], v15 offset:19456
  v_mfma_f32_16x16x32_bf16 v[166:169], v[186:189], a[212:215], v[166:169]
  v_mfma_f32_16x16x16_bf16 v[186:189], v[226:227], v[162:163], 0
  v_mfma_f32_16x16x16_bf16 v[206:209], v[164:165], v[122:123], 0
  v_cvt_pk_bf16_f32 v136, v166, v167
  v_cvt_pk_bf16_f32 v137, v168, v169
  v_mfma_f32_16x16x32_bf16 v[186:189], v[146:149], v[150:153], v[186:189]
  v_mfma_f32_16x16x32_bf16 v[206:209], v[154:157], v[126:129], v[206:209]
  s_waitcnt lgkmcnt(5)
  v_mfma_f32_16x16x32_bf16 v[166:169], a[72:75], v[178:181], 0
  s_waitcnt lgkmcnt(4)
  buffer_store_dwordx4 v[138:141], v22, s[8:11], s32 offen
  v_mfma_f32_16x16x32_bf16 v[166:169], a[76:79], v[142:145], v[166:169]
  s_waitcnt lgkmcnt(3)
  v_exp_f32 v186, v186
  v_mfma_f32_16x16x32_bf16 v[166:169], a[80:83], v[190:193], v[166:169]
  s_waitcnt lgkmcnt(2)
  v_exp_f32 v187, v187
  v_mfma_f32_16x16x32_bf16 v[166:169], a[84:87], v[194:197], v[166:169]
  s_waitcnt lgkmcnt(1)
  v_exp_f32 v188, v188
  v_mfma_f32_16x16x32_bf16 v[166:169], a[88:91], v[214:217], v[166:169]
  s_waitcnt lgkmcnt(0)
  v_exp_f32 v189, v189
  v_mfma_f32_16x16x32_bf16 v[166:169], a[92:95], v[174:177], v[166:169]
  v_exp_f32 v206, v206
  v_mfma_f32_16x16x32_bf16 v[138:141], a[96:99], v[178:181], 0
  v_exp_f32 v207, v207
  v_mfma_f32_16x16x32_bf16 v[138:141], a[100:103], v[142:145], v[138:141]
  v_exp_f32 v208, v208
  v_mfma_f32_16x16x32_bf16 v[138:141], a[104:107], v[190:193], v[138:141]
  v_exp_f32 v209, v209
  v_mfma_f32_16x16x32_bf16 v[138:141], a[108:111], v[194:197], v[138:141]
  v_cvt_pk_bf16_f32 v172, v186, v187
  v_cvt_pk_bf16_f32 v173, v188, v189
  v_mfma_f32_16x16x32_bf16 v[138:141], a[112:115], v[214:217], v[138:141]
  v_cvt_pk_bf16_f32 v186, v166, v167
  v_cvt_pk_bf16_f32 v187, v168, v169
  v_mfma_f32_16x16x32_bf16 v[138:141], a[116:119], v[174:177], v[138:141]
  s_barrier
  v_mfma_f32_16x16x32_bf16 v[166:169], a[120:123], v[178:181], 0
  v_cvt_pk_bf16_f32 v218, v206, v207
  v_cvt_pk_bf16_f32 v219, v208, v209
  v_mfma_f32_16x16x32_bf16 v[166:169], a[124:127], v[142:145], v[166:169]
  v_cvt_pk_bf16_f32 v188, v138, v139
  v_cvt_pk_bf16_f32 v189, v140, v141
  v_mfma_f32_16x16x32_bf16 v[166:169], a[128:131], v[190:193], v[166:169]
  v_mfma_f32_16x16x32_bf16 v[166:169], a[132:135], v[194:197], v[166:169]
  v_mfma_f32_16x16x32_bf16 v[166:169], a[136:139], v[214:217], v[166:169]
  buffer_store_dwordx4 v[210:213], v14, s[8:11], s32 offen
  v_mfma_f32_16x16x32_bf16 v[166:169], a[140:143], v[174:177], v[166:169]
  v_mfma_f32_16x16x16_bf16 v[210:213], v[226:227], v[122:123], 0
  ds_read_b64 v[228:229], v19 offset:16
  v_mfma_f32_16x16x16_bf16 v[138:141], v[226:227], v[254:255], 0
  ds_read2_b64 v[206:209], v19 offset0:0 offset1:1
  v_cvt_pk_bf16_f32 v230, v166, v167
  v_cvt_pk_bf16_f32 v231, v168, v169
  v_add_u32 v19, 1160, v19
  v_mfma_f32_16x16x32_bf16 v[210:213], v[146:149], v[126:129], v[210:213]
  v_mfma_f32_16x16x32_bf16 v[138:141], v[146:149], v[130:133], v[138:141]
  v_mfma_f32_16x16x32_bf16 v[166:169], v[178:181], a[144:147], 0
  v_exp_f32 v210, v210
  v_mfma_f32_16x16x32_bf16 v[166:169], v[142:145], a[148:151], v[166:169]
  v_exp_f32 v211, v211
  v_mfma_f32_16x16x32_bf16 v[166:169], v[190:193], a[152:155], v[166:169]
  v_exp_f32 v212, v212
  v_mfma_f32_16x16x32_bf16 v[166:169], v[194:197], a[156:159], v[166:169]
  v_exp_f32 v213, v213
  v_mfma_f32_16x16x32_bf16 v[166:169], v[214:217], a[160:163], v[166:169]
  v_exp_f32 v138, v138
  v_mfma_f32_16x16x32_bf16 v[166:169], v[174:177], a[164:167], v[166:169]
  v_exp_f32 v139, v139
  v_mfma_f32_16x16x32_bf16 v[222:225], v[178:181], a[168:171], 0
  v_exp_f32 v140, v140
  v_mfma_f32_16x16x32_bf16 v[222:225], v[142:145], a[172:175], v[222:225]
  v_exp_f32 v141, v141
  v_mfma_f32_16x16x32_bf16 v[222:225], v[190:193], a[176:179], v[222:225]
  v_cvt_pk_bf16_f32 v220, v210, v211
  v_cvt_pk_bf16_f32 v221, v212, v213
  v_mfma_f32_16x16x32_bf16 v[222:225], v[194:197], a[180:183], v[222:225]
  v_cvt_pk_bf16_f32 v106, v166, v167
  v_cvt_pk_bf16_f32 v107, v168, v169
  v_mfma_f32_16x16x32_bf16 v[222:225], v[214:217], a[184:187], v[222:225]
  buffer_store_dwordx2 v[110:111], v23, s[8:11], s32 offen
  v_cvt_pk_bf16_f32 v200, v138, v139
  v_mfma_f32_16x16x32_bf16 v[222:225], v[174:177], a[188:191], v[222:225]
  s_waitcnt lgkmcnt(1)
  v_cvt_pk_bf16_f32 v201, v140, v141
  v_mfma_f32_16x16x16_bf16 v[138:141], v[230:231], v[162:163], 0
  v_mfma_f32_16x16x16_bf16 v[166:169], v[228:229], v[162:163], v[2:5]
  v_cvt_pk_bf16_f32 v110, v222, v223
  v_cvt_pk_bf16_f32 v111, v224, v225
  v_mfma_f32_16x16x32_bf16 v[138:141], v[186:189], v[150:153], v[138:141]
  s_waitcnt lgkmcnt(0)
  v_mfma_f32_16x16x32_bf16 v[166:169], v[206:209], v[150:153], v[166:169]
  v_mfma_f32_16x16x32_bf16 v[150:153], v[178:181], a[192:195], 0
  v_exp_f32 v138, v138
  v_mfma_f32_16x16x32_bf16 v[150:153], v[142:145], a[196:199], v[150:153]
  v_exp_f32 v139, v139
  v_mfma_f32_16x16x32_bf16 v[150:153], v[190:193], a[200:203], v[150:153]
  ds_read_u16 v108, v20
  v_cvt_pk_bf16_f32 v118, v138, v139
  v_mfma_f32_16x16x32_bf16 v[150:153], v[194:197], a[204:207], v[150:153]
  v_exp_f32 v140, v140
  v_mfma_f32_16x16x32_bf16 v[150:153], v[214:217], a[208:211], v[150:153]
  ds_read_u16 v112, v20 offset:32
  v_mfma_f32_16x16x32_bf16 v[150:153], v[174:177], a[212:215], v[150:153]
  v_exp_f32 v141, v141
  v_mfma_f32_16x16x16_bf16 v[222:225], v[230:231], v[122:123], 0
  ds_read_u16 v116, v20 offset:64
  v_exp_f32 v166, v166
  v_mfma_f32_16x16x16_bf16 v[210:213], v[228:229], v[122:123], v[2:5]
  v_cvt_pk_bf16_f32 v119, v140, v141
  v_cvt_pk_bf16_f32 v120, v166, 0
  v_cvt_pk_bf16_f32 v114, v150, v151
  v_cvt_pk_bf16_f32 v115, v152, v153
  v_mfma_f32_16x16x32_bf16 v[222:225], v[186:189], v[126:129], v[222:225]
  v_mfma_f32_16x16x32_bf16 v[210:213], v[206:209], v[126:129], v[210:213]
  v_mfma_f32_16x16x32_bf16 v[126:129], a[0:3], v[178:181], 0
  v_exp_f32 v222, v222
  v_mfma_f32_16x16x32_bf16 v[126:129], a[4:7], v[142:145], v[126:129]
  v_exp_f32 v223, v223
  v_mfma_f32_16x16x32_bf16 v[126:129], a[8:11], v[190:193], v[126:129]
  v_exp_f32 v224, v224
  v_mfma_f32_16x16x32_bf16 v[126:129], a[12:15], v[194:197], v[126:129]
  v_exp_f32 v225, v225
  v_mfma_f32_16x16x32_bf16 v[126:129], a[16:19], v[214:217], v[126:129]
  v_exp_f32 v210, v210
  v_mfma_f32_16x16x32_bf16 v[126:129], a[20:23], v[174:177], v[126:129]
  v_cvt_pk_bf16_f32 v122, v222, v223
  v_cvt_pk_bf16_f32 v123, v224, v225
  v_mfma_f32_16x16x32_bf16 v[222:225], a[246:249], v[170:173], 0
  v_cvt_pk_bf16_f32 v124, v210, 0
  v_mfma_f32_16x16x32_bf16 v[222:225], a[246:249], v[118:121], v[222:225]
  v_cvt_pk_bf16_f32 v210, v126, v127
  v_cvt_pk_bf16_f32 v211, v128, v129
  v_mfma_f32_16x16x32_bf16 v[126:129], v[158:161], v[170:173], 0
  s_waitcnt lgkmcnt(2)
  v_mfma_f32_16x16x32_bf16 v[126:129], v[106:109], v[118:121], v[126:129]
  v_mul_f32 v222, 0x3ee9a3cd, v222
  v_mfma_f32_16x16x32_bf16 v[150:153], v[202:205], v[170:173], 0
  s_waitcnt lgkmcnt(1)
  v_rcp_f32 v243, v222
  v_mfma_f32_16x16x32_bf16 v[150:153], v[110:113], v[118:121], v[150:153]
  v_mul_f32 v126, v126, v243
  v_mul_f32 v127, v127, v243
  v_mfma_f32_16x16x32_bf16 v[166:169], v[134:137], v[170:173], 0
  s_waitcnt lgkmcnt(0)
  v_cvt_pk_bf16_f32 v170, v126, v127
  v_mul_f32 v128, v128, v243
  v_mfma_f32_16x16x32_bf16 v[166:169], v[114:117], v[118:121], v[166:169]
  v_mul_f32 v129, v129, v243
  v_cvt_pk_bf16_f32 v171, v128, v129
  v_mfma_f32_16x16x32_bf16 v[126:129], a[24:27], v[178:181], 0
  v_mul_f32 v150, v150, v243
  v_mul_f32 v151, v151, v243
  v_mfma_f32_16x16x32_bf16 v[126:129], a[28:31], v[142:145], v[126:129]
  v_cvt_pk_bf16_f32 v172, v150, v151
  v_mul_f32 v152, v152, v243
  v_mfma_f32_16x16x32_bf16 v[126:129], a[32:35], v[190:193], v[126:129]
  v_mul_f32 v153, v153, v243
  v_cvt_pk_bf16_f32 v173, v152, v153
  v_mfma_f32_16x16x32_bf16 v[126:129], a[36:39], v[194:197], v[126:129]
  ds_write_b128 v16, v[170:173] offset:20480
  v_mfma_f32_16x16x32_bf16 v[126:129], a[40:43], v[214:217], v[126:129]
  v_max3_f32 v1, v1, v222, v243
  v_mul_f32 v166, v166, v243
  v_mfma_f32_16x16x32_bf16 v[126:129], a[44:47], v[174:177], v[126:129]
  v_mul_f32 v167, v167, v243
  v_cvt_pk_bf16_f32 v118, v166, v167
  v_mul_f32 v168, v168, v243
  v_mfma_f32_16x16x16_bf16 v[222:225], v[230:231], v[254:255], 0
  v_mul_f32 v169, v169, v243
  v_cvt_pk_bf16_f32 v119, v168, v169
  v_mfma_f32_16x16x16_bf16 v[166:169], v[228:229], v[254:255], v[2:5]
  ds_write_b64 v17, v[118:119] offset:20480
  v_cvt_pk_bf16_f32 v212, v126, v127
  v_mfma_f32_16x16x32_bf16 v[222:225], v[186:189], v[130:133], v[222:225]
  v_cvt_pk_bf16_f32 v213, v128, v129
  v_mfma_f32_16x16x32_bf16 v[166:169], v[206:209], v[130:133], v[166:169]
  v_mfma_f32_16x16x32_bf16 v[130:133], a[246:249], v[218:221], 0
  v_exp_f32 v222, v222
  v_mfma_f32_16x16x32_bf16 v[130:133], a[246:249], v[122:125], v[130:133]
  v_exp_f32 v223, v223
  v_mfma_f32_16x16x32_bf16 v[126:129], v[158:161], v[218:221], 0
  v_exp_f32 v224, v224
  v_mfma_f32_16x16x32_bf16 v[126:129], v[106:109], v[122:125], v[126:129]
  v_exp_f32 v225, v225
  v_mfma_f32_16x16x32_bf16 v[170:173], v[202:205], v[218:221], 0
  v_exp_f32 v166, v166
  v_mfma_f32_16x16x32_bf16 v[170:173], v[110:113], v[122:125], v[170:173]
  v_cvt_pk_bf16_f32 v118, v222, v223
  v_cvt_pk_bf16_f32 v119, v224, v225
  v_mfma_f32_16x16x32_bf16 v[222:225], v[134:137], v[218:221], 0
  v_cvt_pk_bf16_f32 v120, v166, 0
  v_mul_f32 v130, 0x3ee9a3cd, v130
  v_mfma_f32_16x16x32_bf16 v[222:225], v[114:117], v[122:125], v[222:225]
  v_rcp_f32 v124, v130
  v_mfma_f32_16x16x32_bf16 v[166:169], a[48:51], v[178:181], 0
  v_mul_f32 v126, v126, v124
  v_mul_f32 v127, v127, v124
  v_mfma_f32_16x16x32_bf16 v[166:169], a[52:55], v[142:145], v[166:169]
  v_cvt_pk_bf16_f32 v142, v126, v127
  v_mul_f32 v128, v128, v124
  v_mfma_f32_16x16x32_bf16 v[166:169], a[56:59], v[190:193], v[166:169]
  v_mul_f32 v129, v129, v124
  v_cvt_pk_bf16_f32 v143, v128, v129
  v_mfma_f32_16x16x32_bf16 v[166:169], a[60:63], v[194:197], v[166:169]
  v_mul_f32 v170, v170, v124
  v_mul_f32 v171, v171, v124
  v_mfma_f32_16x16x32_bf16 v[166:169], a[64:67], v[214:217], v[166:169]
  ds_read2_b64 v[214:217], v185 offset0:0 offset1:4
  v_cvt_pk_bf16_f32 v144, v170, v171
  v_mfma_f32_16x16x32_bf16 v[166:169], a[68:71], v[174:177], v[166:169]
  ds_read2_b64 v[174:177], v185 offset0:12 offset1:16
  v_mul_f32 v172, v172, v124
  v_mfma_f32_16x16x32_bf16 v[194:197], v[198:201], a[246:249], 0
  v_mul_f32 v173, v173, v124
  v_cvt_pk_bf16_f32 v145, v172, v173
  v_mfma_f32_16x16x32_bf16 v[194:197], v[118:121], a[246:249], v[194:197]
  ds_read_b128 v[170:173], v18
  v_cvt_pk_bf16_f32 v122, v166, v167
  v_mfma_f32_16x16x32_bf16 v[126:129], v[198:201], v[158:161], 0
  ds_read2_b64 v[190:193], v185 offset0:24 offset1:28
  v_cvt_pk_bf16_f32 v123, v168, v169
  v_mfma_f32_16x16x32_bf16 v[126:129], v[118:121], v[106:109], v[126:129]
  v_mul_f32 v194, 0x3ee9a3cd, v194
  v_mul_f32 v222, v222, v124
  v_mfma_f32_16x16x32_bf16 v[166:169], v[198:201], v[202:205], 0
  ds_read_b128 v[178:181], v18 offset:6144
  v_mul_f32 v223, v223, v124
  v_mfma_f32_16x16x32_bf16 v[166:169], v[118:121], v[110:113], v[166:169]
  ds_read2_b64 v[218:221], v185 offset0:36 offset1:40
  v_cvt_pk_bf16_f32 v254, v222, v223
  v_mfma_f32_16x16x32_bf16 v[150:153], v[198:201], v[134:137], 0
  v_rcp_f32 v243, v194
  v_mfma_f32_16x16x32_bf16 v[150:153], v[118:121], v[114:117], v[150:153]
  ds_read_b128 v[198:201], v18 offset:9216
  v_cndmask_b32 v120, v166, v126, s[54:55]
  v_mul_f32 v224, v224, v124
  v_mfma_f32_16x16x16_bf16 v[126:129], v[164:165], v[122:123], 0
  v_mul_f32 v225, v225, v124
  v_cvt_pk_bf16_f32 v255, v224, v225
  v_max3_f32 v1, v1, v130, v124
  v_mfma_f32_16x16x16_bf16 v[130:133], v[226:227], v[122:123], 0
  v_cndmask_b32 v120, v150, v120, s[56:57]
  v_max3_f32 v1, v1, v194, v243
  v_mul_f32 v120, v120, v243
  v_mfma_f32_16x16x16_bf16 v[194:197], v[230:231], v[122:123], 0
  v_cvt_pk_bf16_f32 v120, v120, v120
  v_mfma_f32_16x16x16_bf16 v[150:153], v[228:229], v[122:123], v[2:5]
  ds_read2_b64 v[222:225], v185 offset0:8 offset1:20
  ds_read_b128 v[166:169], v18 offset:3072
  v_mfma_f32_16x16x32_bf16 v[126:129], v[154:157], v[210:213], v[126:129]
  ds_read2_b64 v[154:157], v185 offset0:32 offset1:44
  v_mfma_f32_16x16x32_bf16 v[130:133], v[146:149], v[210:213], v[130:133]
  v_mfma_f32_16x16x32_bf16 v[194:197], v[186:189], v[210:213], v[194:197]
  v_exp_f32 v126, v126
  v_mfma_f32_16x16x32_bf16 v[150:153], v[206:209], v[210:213], v[150:153]
  s_waitcnt vmcnt(9) lgkmcnt(9)
  ds_read_b128 v[206:209], v18 offset:12288
  ds_read_b128 v[210:213], v18 offset:1024
  v_mfma_f32_16x16x32_bf16 v[62:65], a[250:253], v[214:217], v[62:65]
  s_waitcnt lgkmcnt(9)
  v_exp_f32 v127, v127
  v_mfma_f32_16x16x32_bf16 v[62:65], v[170:173], v[174:177], v[62:65]
  s_waitcnt lgkmcnt(7)
  ds_read_b128 v[186:189], v18 offset:7168
  ds_read_b128 v[146:149], v18 offset:10240
  v_mfma_f32_16x16x32_bf16 v[62:65], v[178:181], v[190:193], v[62:65]
  s_waitcnt lgkmcnt(7)
  v_exp_f32 v128, v128
  v_mfma_f32_16x16x32_bf16 v[62:65], v[198:201], v[218:221], v[62:65]
  s_waitcnt lgkmcnt(5)
  ds_read_b128 v[162:165], v18 offset:4096
  ds_read_b128 v[138:141], v18 offset:13312
  v_mfma_f32_16x16x32_bf16 v[62:65], v[166:169], v[222:225], v[62:65]
  s_waitcnt lgkmcnt(6)
  v_exp_f32 v129, v129
  v_exp_f32 v130, v130
  s_waitcnt lgkmcnt(5)
  v_mfma_f32_16x16x32_bf16 v[62:65], v[206:209], v[154:157], v[62:65]
  s_waitcnt vmcnt(8)
  ds_read_b128 v[226:229], v18 offset:2048
  ds_read_b128 v[230:233], v18 offset:8192
  v_mfma_f32_16x16x32_bf16 v[66:69], v[98:101], v[214:217], v[66:69]
  s_waitcnt lgkmcnt(6)
  ds_read_b128 v[234:237], v18 offset:11264
  v_cvt_pk_bf16_f32 v238, v126, v127
  v_mfma_f32_16x16x32_bf16 v[66:69], v[210:213], v[174:177], v[66:69]
  s_waitcnt lgkmcnt(6)
  v_exp_f32 v131, v131
  v_mfma_f32_16x16x32_bf16 v[66:69], v[186:189], v[190:193], v[66:69]
  s_waitcnt lgkmcnt(5)
  v_exp_f32 v132, v132
  v_mfma_f32_16x16x32_bf16 v[66:69], v[146:149], v[218:221], v[66:69]
  s_waitcnt lgkmcnt(4)
  v_exp_f32 v133, v133
  v_mfma_f32_16x16x32_bf16 v[66:69], v[162:165], v[222:225], v[66:69]
  s_waitcnt lgkmcnt(3)
  v_exp_f32 v194, v194
  v_mfma_f32_16x16x32_bf16 v[66:69], v[138:141], v[154:157], v[66:69]
  v_exp_f32 v195, v195
  v_exp_f32 v196, v196
  v_exp_f32 v197, v197
  v_exp_f32 v150, v150
  v_cvt_pk_bf16_f32 v239, v128, v129
  v_cvt_pk_bf16_f32 v240, v130, v131
  v_cvt_pk_bf16_f32 v241, v132, v133
  v_cvt_pk_bf16_f32 v122, v194, v195
  v_cvt_pk_bf16_f32 v123, v196, v197
  v_mfma_f32_16x16x32_bf16 v[194:197], a[246:249], v[238:241], 0
  v_cvt_pk_bf16_f32 v124, v150, 0
  v_cvt_pk_bf16_f32 v150, v62, v63
  v_cvt_pk_bf16_f32 v151, v64, v65
  v_mfma_f32_16x16x32_bf16 v[194:197], a[246:249], v[122:125], v[194:197]
  ds_write_b128 v16, v[142:145] offset:26624
  v_mfma_f32_16x16x32_bf16 v[142:145], v[158:161], v[238:241], 0
  s_nop 3
  v_mul_f32 v194, 0x3ee9a3cd, v194
  v_cvt_pk_bf16_f32 v152, v66, v67
  v_mfma_f32_16x16x32_bf16 v[142:145], v[106:109], v[122:125], v[142:145]
  ds_read_b128 v[158:161], v18 offset:5120
  ds_read_b128 v[130:133], v18 offset:14336
  v_mfma_f32_16x16x32_bf16 v[126:129], v[202:205], v[238:241], 0
  v_rcp_f32 v243, v194
  v_mfma_f32_16x16x32_bf16 v[126:129], v[110:113], v[122:125], v[126:129]
  ds_write_b64 v17, v[254:255] offset:26624
  v_mfma_f32_16x16x32_bf16 v[202:205], v[134:137], v[238:241], 0
  ds_write_b16 v20, v120 offset:384
  v_mfma_f32_16x16x32_bf16 v[202:205], v[114:117], v[122:125], v[202:205]
  s_waitcnt vmcnt(7)
  v_mul_f32 v142, v142, v243
  v_mul_f32 v143, v143, v243
  v_mfma_f32_16x16x32_bf16 v[70:73], v[102:105], v[214:217], v[70:73]
  s_waitcnt lgkmcnt(7)
  v_mul_f32 v144, v144, v243
  v_mul_f32 v145, v145, v243
  v_mfma_f32_16x16x32_bf16 v[70:73], v[226:229], v[174:177], v[70:73]
  s_waitcnt lgkmcnt(6)
  v_mul_f32 v126, v126, v243
  v_mul_f32 v127, v127, v243
  v_mfma_f32_16x16x32_bf16 v[70:73], v[230:233], v[190:193], v[70:73]
  s_waitcnt lgkmcnt(5)
  v_mul_f32 v128, v128, v243
  v_mul_f32 v129, v129, v243
  v_mfma_f32_16x16x32_bf16 v[70:73], v[234:237], v[218:221], v[70:73]
  s_waitcnt lgkmcnt(3)
  v_cvt_pk_bf16_f32 v218, v142, v143
  v_cvt_pk_bf16_f32 v219, v144, v145
  v_mfma_f32_16x16x32_bf16 v[70:73], v[158:161], v[222:225], v[70:73]
  s_waitcnt lgkmcnt(2)
  v_cvt_pk_bf16_f32 v220, v126, v127
  v_cvt_pk_bf16_f32 v221, v128, v129
  v_mfma_f32_16x16x32_bf16 v[70:73], v[130:133], v[154:157], v[70:73]
  s_waitcnt lgkmcnt(0)
  ds_write_b128 v16, v[218:221] offset:32768
  v_mul_f32 v202, v202, v243
  v_mul_f32 v203, v203, v243
  v_mul_f32 v204, v204, v243
  v_mul_f32 v205, v205, v243
  v_cvt_pk_bf16_f32 v114, v202, v203
  v_cvt_pk_bf16_f32 v115, v204, v205
  ds_write_b64 v17, v[114:115] offset:32768
  v_max3_f32 v1, v1, v194, v243
  ds_write_b32 v109, v1
  v_cvt_pk_bf16_f32 v153, v68, v69
  v_cvt_pk_bf16_f32 v194, v70, v71
  v_cvt_pk_bf16_f32 v195, v72, v73
  v_permlane16_swap_b32 v150, v152
  v_permlane16_swap_b32 v151, v153
  v_add_u32 v20, 1160, v20
  buffer_store_dwordx4 v[150:153], v182, s[8:11], 0 offen
  s_waitcnt lgkmcnt(0)
  s_barrier
  ds_read_b128 v[150:153], v15 offset:20480
  ds_read_b128 v[202:205], v15 offset:21504
  ds_read_b128 v[218:221], v15 offset:22528
  ds_read_b128 v[154:157], v15 offset:23552
  ds_read_b128 v[126:129], v15 offset:24576
  ds_read_b128 v[222:225], v15 offset:25600
  ds_read_b128 v[142:145], v242
  s_waitcnt lgkmcnt(6)
  v_mfma_f32_16x16x32_bf16 v[26:29], a[250:253], v[150:153], v[26:29]
  s_waitcnt lgkmcnt(5)
  v_mfma_f32_16x16x32_bf16 v[26:29], v[170:173], v[202:205], v[26:29]
  s_waitcnt lgkmcnt(4)
  v_mfma_f32_16x16x32_bf16 v[26:29], v[178:181], v[218:221], v[26:29]
  s_waitcnt lgkmcnt(3)
  v_mfma_f32_16x16x32_bf16 v[26:29], v[198:201], v[154:157], v[26:29]
  s_waitcnt lgkmcnt(2)
  v_mfma_f32_16x16x32_bf16 v[26:29], v[166:169], v[126:129], v[26:29]
  s_waitcnt lgkmcnt(1)
  v_mfma_f32_16x16x32_bf16 v[26:29], v[206:209], v[222:225], v[26:29]
  ds_read_b128 v[190:193], v15 offset:26624
  v_mfma_f32_16x16x32_bf16 v[30:33], v[98:101], v[150:153], v[30:33]
  s_waitcnt lgkmcnt(1)
  ds_read_b128 v[174:177], v15 offset:27648
  v_max3_f32 v1, v142, v143, v144
  v_mfma_f32_16x16x32_bf16 v[30:33], v[210:213], v[202:205], v[30:33]
  ds_read_b128 v[214:217], v15 offset:28672
  v_cvt_pk_bf16_f32 v134, v26, v27
  v_mfma_f32_16x16x32_bf16 v[30:33], v[186:189], v[218:221], v[30:33]
  ds_read_b128 v[238:241], v15 offset:29696
  v_cvt_pk_bf16_f32 v135, v28, v29
  v_mfma_f32_16x16x32_bf16 v[30:33], v[146:149], v[154:157], v[30:33]
  ds_read_b128 v[242:245], v15 offset:30720
  v_max_f32 v1, v1, v145
  v_mfma_f32_16x16x32_bf16 v[30:33], v[162:165], v[126:129], v[30:33]
  ds_read_b128 v[142:145], v15 offset:31744
  v_mfma_f32_16x16x32_bf16 v[30:33], v[138:141], v[222:225], v[30:33]
  v_mfma_f32_16x16x32_bf16 v[34:37], v[102:105], v[150:153], v[34:37]
  v_mfma_f32_16x16x32_bf16 v[34:37], v[226:229], v[202:205], v[34:37]
  v_cvt_pk_bf16_f32 v136, v30, v31
  v_cvt_pk_bf16_f32 v137, v32, v33
  v_mfma_f32_16x16x32_bf16 v[34:37], v[230:233], v[218:221], v[34:37]
  v_permlane16_swap_b32 v134, v136
  v_mfma_f32_16x16x32_bf16 v[34:37], v[234:237], v[154:157], v[34:37]
  v_permlane16_swap_b32 v135, v137
  v_mfma_f32_16x16x32_bf16 v[34:37], v[158:161], v[126:129], v[34:37]
  buffer_store_dwordx4 v[134:137], v12, s[8:11], s33 offen
  v_mfma_f32_16x16x32_bf16 v[34:37], v[130:133], v[222:225], v[34:37]
  s_waitcnt lgkmcnt(5)
  v_mfma_f32_16x16x32_bf16 v[38:41], a[250:253], v[190:193], v[38:41]
  s_waitcnt lgkmcnt(4)
  v_mfma_f32_16x16x32_bf16 v[38:41], v[170:173], v[174:177], v[38:41]
  s_waitcnt lgkmcnt(3)
  v_cvt_pk_bf16_f32 v222, v34, v35
  v_cvt_pk_bf16_f32 v223, v36, v37
  v_mfma_f32_16x16x32_bf16 v[38:41], v[178:181], v[214:217], v[38:41]
  s_waitcnt lgkmcnt(2)
  v_mfma_f32_16x16x32_bf16 v[38:41], v[198:201], v[238:241], v[38:41]
  s_waitcnt lgkmcnt(1)
  v_mfma_f32_16x16x32_bf16 v[38:41], v[166:169], v[242:245], v[38:41]
  s_waitcnt lgkmcnt(0)
  v_mfma_f32_16x16x32_bf16 v[38:41], v[206:209], v[142:145], v[38:41]
  ds_read_b128 v[134:137], v15 offset:32768
  v_mfma_f32_16x16x32_bf16 v[42:45], v[98:101], v[190:193], v[42:45]
  ds_read_b128 v[126:129], v15 offset:33792
  v_mfma_f32_16x16x32_bf16 v[42:45], v[210:213], v[174:177], v[42:45]
  ds_read_b128 v[154:157], v15 offset:34816
  v_cvt_pk_bf16_f32 v218, v38, v39
  v_mfma_f32_16x16x32_bf16 v[42:45], v[186:189], v[214:217], v[42:45]
  ds_read_b128 v[202:205], v15 offset:35840
  v_cvt_pk_bf16_f32 v219, v40, v41
  v_mfma_f32_16x16x32_bf16 v[42:45], v[146:149], v[238:241], v[42:45]
  ds_read_b128 v[150:153], v15 offset:36864
  v_mfma_f32_16x16x32_bf16 v[42:45], v[162:165], v[242:245], v[42:45]
  ds_read_b128 v[246:249], v15 offset:37888
  v_mfma_f32_16x16x32_bf16 v[42:45], v[138:141], v[142:145], v[42:45]
  v_mfma_f32_16x16x32_bf16 v[46:49], v[102:105], v[190:193], v[46:49]
  v_mfma_f32_16x16x32_bf16 v[46:49], v[226:229], v[174:177], v[46:49]
  v_cvt_pk_bf16_f32 v220, v42, v43
  v_cvt_pk_bf16_f32 v221, v44, v45
  v_mfma_f32_16x16x32_bf16 v[46:49], v[230:233], v[214:217], v[46:49]
  v_permlane16_swap_b32 v218, v220
  v_mfma_f32_16x16x32_bf16 v[46:49], v[234:237], v[238:241], v[46:49]
  v_permlane16_swap_b32 v219, v221
  v_mfma_f32_16x16x32_bf16 v[46:49], v[158:161], v[242:245], v[46:49]
  buffer_store_dwordx4 v[218:221], v13, s[8:11], s33 offen
  v_mfma_f32_16x16x32_bf16 v[46:49], v[130:133], v[142:145], v[46:49]
  s_waitcnt lgkmcnt(5)
  v_mfma_f32_16x16x32_bf16 v[50:53], a[250:253], v[134:137], v[50:53]
  s_waitcnt lgkmcnt(4)
  ds_read2_b64 v[142:145], v250 offset0:0 offset1:4
  v_mfma_f32_16x16x32_bf16 v[50:53], v[170:173], v[126:129], v[50:53]
  s_waitcnt lgkmcnt(4)
  ds_read2_b64 v[218:221], v250 offset0:12 offset1:16
  v_cvt_pk_bf16_f32 v224, v46, v47
  v_mfma_f32_16x16x32_bf16 v[50:53], v[178:181], v[154:157], v[50:53]
  s_waitcnt lgkmcnt(4)
  v_cvt_pk_bf16_f32 v225, v48, v49
  v_mfma_f32_16x16x32_bf16 v[50:53], v[198:201], v[202:205], v[50:53]
  s_waitcnt lgkmcnt(3)
  ds_read2_b64 v[242:245], v250 offset0:24 offset1:28
  v_mfma_f32_16x16x32_bf16 v[50:53], v[166:169], v[150:153], v[50:53]
  s_waitcnt lgkmcnt(3)
  v_permlane16_swap_b32 v222, v224
  v_mfma_f32_16x16x32_bf16 v[50:53], v[206:209], v[246:249], v[50:53]
  ds_read2_b64 v[238:241], v250 offset0:36 offset1:40
  v_mfma_f32_16x16x32_bf16 v[54:57], v[98:101], v[134:137], v[54:57]
  v_permlane16_swap_b32 v223, v225
  v_mfma_f32_16x16x32_bf16 v[54:57], v[210:213], v[126:129], v[54:57]
  ds_read2_b64 v[214:217], v250 offset0:8 offset1:20
  v_cvt_pk_bf16_f32 v174, v50, v51
  v_mfma_f32_16x16x32_bf16 v[54:57], v[186:189], v[154:157], v[54:57]
  v_cvt_pk_bf16_f32 v175, v52, v53
  v_mfma_f32_16x16x32_bf16 v[54:57], v[146:149], v[202:205], v[54:57]
  ds_read2_b64 v[190:193], v250 offset0:32 offset1:44
  v_mfma_f32_16x16x32_bf16 v[54:57], v[162:165], v[150:153], v[54:57]
  v_mfma_f32_16x16x32_bf16 v[54:57], v[138:141], v[246:249], v[54:57]
  v_mfma_f32_16x16x32_bf16 v[58:61], v[102:105], v[134:137], v[58:61]
  v_mfma_f32_16x16x32_bf16 v[58:61], v[226:229], v[126:129], v[58:61]
  v_cvt_pk_bf16_f32 v176, v54, v55
  v_cvt_pk_bf16_f32 v177, v56, v57
  v_mfma_f32_16x16x32_bf16 v[58:61], v[230:233], v[154:157], v[58:61]
  buffer_store_dwordx4 v[222:225], v22, s[8:11], s33 offen
  v_mfma_f32_16x16x32_bf16 v[58:61], v[234:237], v[202:205], v[58:61]
  v_permlane16_swap_b32 v174, v176
  v_mfma_f32_16x16x32_bf16 v[58:61], v[158:161], v[150:153], v[58:61]
  v_permlane16_swap_b32 v175, v177
  v_mfma_f32_16x16x32_bf16 v[58:61], v[130:133], v[246:249], v[58:61]
  s_waitcnt vmcnt(10) lgkmcnt(5)
  v_mfma_f32_16x16x32_bf16 v[74:77], a[250:253], v[142:145], v[74:77]
  s_waitcnt lgkmcnt(4)
  v_mfma_f32_16x16x32_bf16 v[74:77], v[170:173], v[218:221], v[74:77]
  s_waitcnt lgkmcnt(3)
  v_cvt_pk_bf16_f32 v114, v58, v59
  v_cvt_pk_bf16_f32 v115, v60, v61
  v_mfma_f32_16x16x32_bf16 v[74:77], v[178:181], v[242:245], v[74:77]
  s_waitcnt lgkmcnt(2)
  v_mfma_f32_16x16x32_bf16 v[74:77], v[198:201], v[238:241], v[74:77]
  s_waitcnt lgkmcnt(1)
  v_mfma_f32_16x16x32_bf16 v[74:77], v[166:169], v[214:217], v[74:77]
  s_waitcnt lgkmcnt(0)
  v_mfma_f32_16x16x32_bf16 v[74:77], v[206:209], v[190:193], v[74:77]
  s_waitcnt vmcnt(9)
  v_mfma_f32_16x16x32_bf16 v[78:81], v[98:101], v[142:145], v[78:81]
  v_mfma_f32_16x16x32_bf16 v[78:81], v[210:213], v[218:221], v[78:81]
  v_cvt_pk_bf16_f32 v210, v74, v75
  v_cvt_pk_bf16_f32 v211, v76, v77
  v_mfma_f32_16x16x32_bf16 v[78:81], v[186:189], v[242:245], v[78:81]
  v_mfma_f32_16x16x32_bf16 v[78:81], v[146:149], v[238:241], v[78:81]
  v_mfma_f32_16x16x32_bf16 v[78:81], v[162:165], v[214:217], v[78:81]
  v_mfma_f32_16x16x32_bf16 v[78:81], v[138:141], v[190:193], v[78:81]
  s_waitcnt vmcnt(8)
  v_mfma_f32_16x16x32_bf16 v[82:85], v[102:105], v[142:145], v[82:85]
  buffer_store_dwordx4 v[174:177], v14, s[8:11], s33 offen
  s_nop 2
  v_cvt_pk_bf16_f32 v212, v78, v79
  v_mfma_f32_16x16x32_bf16 v[82:85], v[226:229], v[218:221], v[82:85]
  v_cvt_pk_bf16_f32 v213, v80, v81
  v_mfma_f32_16x16x32_bf16 v[82:85], v[230:233], v[242:245], v[82:85]
  v_permlane16_swap_b32 v210, v212
  v_mfma_f32_16x16x32_bf16 v[82:85], v[234:237], v[238:241], v[82:85]
  v_permlane16_swap_b32 v211, v213
  v_mfma_f32_16x16x32_bf16 v[82:85], v[158:161], v[214:217], v[82:85]
  v_mfma_f32_16x16x32_bf16 v[82:85], v[130:133], v[190:193], v[82:85]
  s_nop 7
  v_cvt_pk_bf16_f32 v196, v82, v83
  v_cvt_pk_bf16_f32 v197, v84, v85
  s_nop 0
  v_permlane16_swap_b32 v194, v196
  v_permlane16_swap_b32 v195, v197
  buffer_store_dwordx2 v[114:115], v23, s[8:11], s33 offen
  buffer_store_dwordx4 v[210:213], v183, s[8:11], 0 offen
  buffer_store_dwordx4 v[194:197], v184, s[8:11], 0 offen
  v_cmp_nge_f32 vcc, 0x67800000, v1
  s_nop 4
  s_cmp_eq_u64 vcc, 0
  s_cbranch_scc1 L_exit
L_safe:
  s_waitcnt vmcnt(0)
  s_barrier
  v_mbcnt_lo_u32_b32 v220, -1, 0
  v_mbcnt_hi_u32_b32 v220, -1, v220
  v_lshrrev_b32 v221, 4, v220
  v_and_b32 v222, 15, v220
  s_add_u32 s60, s74, 38912
  v_mul_u32_u24 v223, 24, v221
  v_add_u32 v19, s60, v223
  v_min_u32 v223, 2, v221
  v_lshl_add_u32 v223, v223, 4, v222
  s_add_u32 s60, s60, 384
  v_lshl_add_u32 v20, v223, 1, s60
  v_cmp_gt_u32 vcc, 5, v222
  v_mul_u32_u24 v223, 1160, v222
  v_add_u32 v249, v19, v223
  v_lshl_add_u32 v223, v221, 3, v223
  v_add_u32 v247, s60, v223
  v_mov_b32 v224, 0x30000
  v_add_u32 v225, 18560, v249
  v_cndmask_b32 v250, v224, v225, vcc
  v_add_u32 v225, 18560, v247
  v_cndmask_b32 v248, v224, v225, vcc
  s_mov_b32 s31, 0
  buffer_load_dwordx4 v[126:129], v15, s[12:15], s77 offen offset:3072
  buffer_load_dwordx2 v[106:107], v15, s[12:15], s78 offen
  buffer_load_dwordx4 v[130:133], v15, s[12:15], s78 offen offset:1024
  buffer_load_dwordx2 v[110:111], v15, s[12:15], s78 offen offset:2048
  s_waitcnt vmcnt(3)
  ds_write_b64 v249, v[126:127] offset:768
  ds_write_b64 v249, v[128:129] offset:776
  s_waitcnt vmcnt(2)
  ds_write_b64 v249, v[106:107] offset:784
  s_waitcnt vmcnt(1)
  ds_write_b64 v250, v[130:131] offset:768
  ds_write_b64 v250, v[132:133] offset:776
  s_waitcnt vmcnt(0)
  ds_write_b64 v250, v[110:111] offset:784
  s_waitcnt lgkmcnt(0)
L_safe_loop:
  s_lshl_b32 s60, s31, 5
  s_add_u32 s61, s60, s30
  s_add_u32 s60, s60, s29
  s_mul_i32 s62, s60, 7183
  s_lshr_b32 s62, s62, 22
  s_mul_i32 s63, s62, 584
  s_sub_u32 s63, s60, s63
  s_lshr_b32 s64, s63, 3
  s_and_b32 s65, s63, 7
  s_lshl_b32 s66, s62, 3
  s_add_u32 s65, s65, s66
  s_cmp_ge_u32 s60, 5256
  s_cselect_b32 s64, s63, s64
  s_cselect_b32 s65, 72, s65
  s_mul_i32 s66, s65, 1373568
  s_mul_i32 s67, s64, 2688
  s_add_u32 s35, s66, s67
  s_cmp_ge_u32 s61, 667
  s_cselect_b32 s35, 268435456, s35
  s_cmp_ge_u32 s60, 5329
  s_cselect_b32 s35, 268435456, s35
  s_cmp_eq_u32 s65, 0
  s_cselect_b32 s36, 268435456, s35
  s_add_u32 s37, s35, 195360
  s_add_u32 s38, s35, 390720
  s_add_u32 s39, s35, 586080
  s_add_u32 s40, s35, 781440
  s_add_u32 s41, s35, 981120
  s_add_u32 s42, s35, 1176480
  s_add_u32 s43, s35, 1371840
  s_add_u32 s44, s35, 1567200
  s_cmp_eq_u32 s64, 0
  s_cselect_b64 s[52:53], s[48:49], 0
  s_cmp_eq_u32 s64, 72
  s_cselect_b64 s[52:53], s[50:51], s[52:53]
  s_add_u32 s31, s31, 1
  s_mov_b32 m0, s58
  v_cndmask_b32 v108, v21, 2.0, s[52:53]
  buffer_load_dwordx4 v108, s[4:7], s36 offen lds
  buffer_load_dwordx4 v108, s[4:7], s37 offen offset:864 lds
  buffer_load_dwordx4 v108, s[4:7], s38 offen offset:1728 lds
  buffer_load_dwordx4 v108, s[4:7], s39 offen offset:2592 lds
  buffer_load_dwordx4 v108, s[4:7], s40 offen offset:3456 lds
  s_mov_b32 m0, s59
  s_nop 0
  buffer_load_dwordx4 v108, s[4:7], s41 offen lds
  buffer_load_dwordx4 v108, s[4:7], s42 offen offset:864 lds
  buffer_load_dwordx4 v108, s[4:7], s43 offen offset:1728 lds
  buffer_load_dwordx4 v108, s[4:7], s44 offen offset:2592 lds
  s_waitcnt vmcnt(0)
  ds_read_b64 v[106:107], v9
  ds_read_b64 v[110:111], v9 offset:32
  ds_read_b64 v[114:115], v9 offset:64
  ds_read_b128 v[126:129], v3
  ds_read_b128 v[130:133], v3 offset:864
  ds_read_b128 v[134:137], v3 offset:1728
  ds_read_b128 v[138:141], v6
  s_waitcnt lgkmcnt(6)
  v_mfma_f32_16x16x16_bf16 v[26:29], a[224:225], v[106:107], 0
  ds_read_b128 v[142:145], v3 offset:32
  s_waitcnt lgkmcnt(6)
  v_mfma_f32_16x16x16_bf16 v[30:33], a[234:235], v[110:111], 0
  ds_read_b128 v[146:149], v3 offset:896
  s_waitcnt lgkmcnt(6)
  v_mfma_f32_16x16x16_bf16 v[34:37], a[244:245], v[114:115], 0
  ds_read_b128 v[150:153], v3 offset:1760
  ds_read_b128 v[154:157], v6 offset:32
  s_waitcnt lgkmcnt(6)
  v_smfmac_f32_16x16x64_bf16 v[26:29], a[216:219], v[126:133], v0
  ds_read_b128 v[126:129], v3 offset:64
  ds_read_b128 v[130:133], v3 offset:928
  s_waitcnt lgkmcnt(6)
  v_smfmac_f32_16x16x64_bf16 v[26:29], a[220:223], v[134:141], v0
  ds_read_b128 v[134:137], v3 offset:1792
  ds_read_b128 v[138:141], v6 offset:64
  s_waitcnt lgkmcnt(6)
  v_smfmac_f32_16x16x64_bf16 v[30:33], a[226:229], v[142:149], v0
  ds_read_b64 v[114:115], v10
  ds_read_b64 v[110:111], v10 offset:32
  s_nop 1
  v_mul_f32 v108, v26, v26
  v_add_f32 v112, v26, v27
  s_waitcnt lgkmcnt(6)
  v_smfmac_f32_16x16x64_bf16 v[30:33], a[230:233], v[150:157], v0
  ds_read_b64 v[106:107], v10 offset:64
  ds_read_b128 v[150:153], v4
  v_fmac_f32 v108, v27, v27
  v_add_f32 v112, v112, v28
  s_waitcnt lgkmcnt(6)
  v_smfmac_f32_16x16x64_bf16 v[34:37], a[236:239], v[126:133], v0
  ds_read_b128 v[154:157], v4 offset:864
  ds_read_b128 v[126:129], v4 offset:1728
  v_fmac_f32 v108, v28, v28
  v_add_f32 v112, v112, v29
  s_waitcnt lgkmcnt(6)
  v_smfmac_f32_16x16x64_bf16 v[34:37], a[240:243], v[134:141], v0
  ds_read_b128 v[130:133], v7
  v_fmac_f32 v108, v29, v29
  s_waitcnt lgkmcnt(6)
  v_mfma_f32_16x16x16_bf16 v[38:41], a[224:225], v[114:115], 0
  ds_read_b128 v[134:137], v4 offset:32
  v_add_f32 v112, v112, v30
  s_waitcnt lgkmcnt(6)
  v_mfma_f32_16x16x16_bf16 v[42:45], a[234:235], v[110:111], 0
  ds_read_b128 v[138:141], v4 offset:896
  v_fmac_f32 v108, v30, v30
  s_waitcnt lgkmcnt(6)
  v_mfma_f32_16x16x16_bf16 v[46:49], a[244:245], v[106:107], 0
  ds_read_b128 v[142:145], v4 offset:1760
  ds_read_b128 v[146:149], v7 offset:32
  v_add_f32 v112, v112, v31
  v_fmac_f32 v108, v31, v31
  s_waitcnt lgkmcnt(6)
  v_smfmac_f32_16x16x64_bf16 v[38:41], a[216:219], v[150:157], v0
  ds_read_b128 v[150:153], v4 offset:64
  ds_read_b128 v[154:157], v4 offset:928
  v_add_f32 v112, v112, v32
  v_fmac_f32 v108, v32, v32
  s_waitcnt lgkmcnt(6)
  v_smfmac_f32_16x16x64_bf16 v[38:41], a[220:223], v[126:133], v0
  ds_read_b128 v[126:129], v4 offset:1792
  ds_read_b128 v[130:133], v7 offset:64
  v_add_f32 v112, v112, v33
  v_fmac_f32 v108, v33, v33
  s_waitcnt lgkmcnt(6)
  v_smfmac_f32_16x16x64_bf16 v[42:45], a[226:229], v[134:141], v0
  ds_read_b64 v[106:107], v11
  s_nop 0
  v_mul_f32 v116, v38, v38
  v_add_f32 v120, v38, v39
  v_fmac_f32 v116, v39, v39
  v_add_f32 v120, v120, v40
  s_waitcnt lgkmcnt(5)
  v_smfmac_f32_16x16x64_bf16 v[42:45], a[230:233], v[142:149], v0
  ds_read_b64 v[110:111], v11 offset:32
  v_fmac_f32 v116, v40, v40
  v_add_f32 v120, v120, v41
  v_fmac_f32 v116, v41, v41
  v_add_f32 v112, v112, v34
  s_waitcnt lgkmcnt(4)
  v_smfmac_f32_16x16x64_bf16 v[46:49], a[236:239], v[150:157], v0
  ds_read_b64 v[114:115], v11 offset:64
  v_add_f32 v120, v120, v42
  v_fmac_f32 v116, v42, v42
  v_add_f32 v120, v120, v43
  v_fmac_f32 v116, v43, v43
  s_waitcnt lgkmcnt(3)
  v_smfmac_f32_16x16x64_bf16 v[46:49], a[240:243], v[126:133], v0
  ds_read_b128 v[126:129], v5
  v_add_f32 v120, v120, v44
  s_waitcnt lgkmcnt(3)
  v_mfma_f32_16x16x16_bf16 v[50:53], a[224:225], v[106:107], 0
  v_fmac_f32 v116, v44, v44
  v_add_f32 v120, v120, v45
  s_waitcnt lgkmcnt(2)
  v_mfma_f32_16x16x16_bf16 v[54:57], a[234:235], v[110:111], 0
  v_fmac_f32 v116, v45, v45
  ds_read_b128 v[130:133], v5 offset:864
  v_fmac_f32 v108, v34, v34
  v_add_f32 v120, v120, v46
  s_waitcnt lgkmcnt(2)
  v_mfma_f32_16x16x16_bf16 v[58:61], a[244:245], v[114:115], 0
  v_fmac_f32 v116, v46, v46
  v_add_f32 v112, v112, v35
  v_fmac_f32 v108, v35, v35
  v_add_f32 v120, v120, v47
  v_fmac_f32 v116, v47, v47
  ds_read_b128 v[150:153], v5 offset:1728
  ds_read_b128 v[154:157], v8
  v_add_f32 v112, v112, v36
  v_fmac_f32 v108, v36, v36
  v_add_f32 v120, v120, v48
  v_fmac_f32 v116, v48, v48
  v_add_f32 v112, v112, v37
  v_fmac_f32 v108, v37, v37
  v_add_f32 v120, v120, v49
  v_fmac_f32 v116, v49, v49
  s_waitcnt lgkmcnt(2)
  v_smfmac_f32_16x16x64_bf16 v[50:53], a[216:219], v[126:133], v0
  ds_read_b128 v[126:129], v5 offset:32
  ds_read_b128 v[130:133], v5 offset:896
  v_permlane32_swap_b32 v112, v108
  v_permlane32_swap_b32 v120, v116
  ds_read_b128 v[142:145], v5 offset:1760
  ds_read_b128 v[146:149], v8 offset:32
  v_add_f32 v112, v112, v108
  v_add_f32 v120, v120, v116
  s_waitcnt lgkmcnt(4)
  v_smfmac_f32_16x16x64_bf16 v[50:53], a[220:223], v[150:157], v0
  ds_read_b128 v[150:153], v5 offset:64
  ds_read_b128 v[154:157], v5 offset:928
  v_permlane16_swap_b32 v112, v120
  ds_read_b128 v[134:137], v5 offset:1792
  s_nop 3
  v_mul_f32 v108, v50, v50
  v_add_f32 v116, v50, v51
  v_fmac_f32 v108, v51, v51
  v_add_f32 v116, v116, v52
  s_waitcnt lgkmcnt(5)
  v_smfmac_f32_16x16x64_bf16 v[54:57], a[226:229], v[126:133], v0
  ds_read_b128 v[138:141], v8 offset:64
  v_fmac_f32 v108, v52, v52
  v_add_f32 v116, v116, v53
  v_fmac_f32 v108, v53, v53
  v_add_f32 v112, v112, v120
  s_waitcnt lgkmcnt(4)
  v_smfmac_f32_16x16x64_bf16 v[54:57], a[230:233], v[142:149], v0
  ds_write_b32 v109, v112
  s_waitcnt lgkmcnt(3)
  v_smfmac_f32_16x16x64_bf16 v[58:61], a[236:239], v[150:157], v0
  s_nop 3
  v_add_f32 v116, v116, v54
  v_fmac_f32 v108, v54, v54
  v_add_f32 v116, v116, v55
  v_fmac_f32 v108, v55, v55
  v_add_f32 v116, v116, v56
  v_fmac_f32 v108, v56, v56
  s_waitcnt lgkmcnt(1)
  v_smfmac_f32_16x16x64_bf16 v[58:61], a[240:243], v[134:141], v0
  v_add_f32 v116, v116, v57
  v_fmac_f32 v108, v57, v57
  s_nop 5
  v_add_f32 v116, v116, v58
  v_fmac_f32 v108, v58, v58
  v_add_f32 v116, v116, v59
  v_fmac_f32 v108, v59, v59
  v_add_f32 v116, v116, v60
  v_fmac_f32 v108, v60, v60
  v_add_f32 v116, v116, v61
  v_fmac_f32 v108, v61, v61
  s_nop 1
  v_permlane32_swap_b32 v116, v108
  v_add_f32 v116, v116, v108
  v_mov_b32 v108, v116
  s_nop 1
  v_permlane16_swap_b32 v116, v108
  v_add_f32 v116, v116, v108
  ds_write_b32 v109, v116 offset:512
  s_waitcnt lgkmcnt(0)
  s_barrier
  ds_read_b128 v[134:137], v15
  ds_read_b128 v[138:141], v15 offset:1024
  s_waitcnt lgkmcnt(1)
  v_add_f32 v134, v134, v135
  v_add_f32 v136, v136, v137
  v_add_f32 v134, v134, v136
  s_waitcnt lgkmcnt(0)
  v_add_f32 v138, v138, v139
  v_add_f32 v140, v140, v141
  v_mul_f32 v135, 0x3baaaaab, v134
  v_add_f32 v138, v138, v140
  v_fma_f32 v138, -v135, v134, v138
  v_max_f32 v138, 0, v138
  v_add_f32 v138, 0x3afba882, v138
  v_rsq_f32 v138, v138
  s_nop 0
  v_mul_f32 v138, 0x40ca568a, v138
  v_mul_f32 v139, -v135, v138
  ds_write_b64 v113, v[138:139]
  ds_read_b64 v[106:107], v117 offset:768
  ds_read_b64 v[110:111], v117 offset:896
  ds_read_b64 v[114:115], v117 offset:1792
  s_waitcnt lgkmcnt(2)
  v_fma_f32 v138, v26, v106, v107
  v_fma_f32 v108, v27, v106, v107
  v_cvt_pk_bf16_f32 v138, v138, v108
  v_fma_f32 v139, v28, v106, v107
  v_fma_f32 v108, v29, v106, v107
  v_cvt_pk_bf16_f32 v139, v139, v108
  v_fma_f32 v140, v30, v106, v107
  v_fma_f32 v108, v31, v106, v107
  v_cvt_pk_bf16_f32 v140, v140, v108
  v_fma_f32 v141, v32, v106, v107
  v_fma_f32 v108, v33, v106, v107
  v_cvt_pk_bf16_f32 v141, v141, v108
  s_waitcnt lgkmcnt(1)
  v_fma_f32 v134, v38, v110, v111
  v_fma_f32 v108, v39, v110, v111
  v_cvt_pk_bf16_f32 v134, v134, v108
  v_fma_f32 v135, v40, v110, v111
  v_fma_f32 v108, v41, v110, v111
  v_cvt_pk_bf16_f32 v135, v135, v108
  v_fma_f32 v136, v42, v110, v111
  v_fma_f32 v108, v43, v110, v111
  v_cvt_pk_bf16_f32 v136, v136, v108
  v_fma_f32 v137, v44, v110, v111
  v_fma_f32 v108, v45, v110, v111
  v_cvt_pk_bf16_f32 v137, v137, v108
  s_waitcnt lgkmcnt(0)
  v_fma_f32 v150, v50, v114, v115
  v_fma_f32 v108, v51, v114, v115
  v_cvt_pk_bf16_f32 v150, v150, v108
  v_fma_f32 v151, v52, v114, v115
  v_fma_f32 v108, v53, v114, v115
  v_cvt_pk_bf16_f32 v151, v151, v108
  v_fma_f32 v152, v54, v114, v115
  v_fma_f32 v108, v55, v114, v115
  v_cvt_pk_bf16_f32 v152, v152, v108
  v_fma_f32 v153, v56, v114, v115
  v_fma_f32 v108, v57, v114, v115
  v_cvt_pk_bf16_f32 v153, v153, v108
  ds_write_b128 v16, v[138:141] offset:2048
  v_fma_f32 v118, v34, v106, v107
  ds_write_b128 v16, v[134:137] offset:8192
  v_fma_f32 v108, v35, v106, v107
  v_cvt_pk_bf16_f32 v118, v118, v108
  v_fma_f32 v119, v36, v106, v107
  v_fma_f32 v108, v37, v106, v107
  v_cvt_pk_bf16_f32 v119, v119, v108
  v_fma_f32 v106, v46, v110, v111
  ds_write_b128 v16, v[150:153] offset:14336
  v_fma_f32 v108, v47, v110, v111
  v_cvt_pk_bf16_f32 v106, v106, v108
  v_fma_f32 v107, v48, v110, v111
  v_fma_f32 v108, v49, v110, v111
  v_cvt_pk_bf16_f32 v107, v107, v108
  v_fma_f32 v110, v58, v114, v115
  v_fma_f32 v108, v59, v114, v115
  v_cvt_pk_bf16_f32 v110, v110, v108
  v_fma_f32 v111, v60, v114, v115
  v_fma_f32 v108, v61, v114, v115
  v_cvt_pk_bf16_f32 v111, v111, v108
  ds_write_b64 v17, v[118:119] offset:2048
  ds_write_b64 v17, v[106:107] offset:8192
  ds_write_b64 v17, v[110:111] offset:14336
  s_waitcnt lgkmcnt(0)
  s_barrier
  ds_read_b128 v[150:153], v15 offset:2048
  ds_read_b128 v[134:137], v15 offset:3072
  ds_read_b128 v[138:141], v15 offset:4096
  ds_read_b128 v[154:157], v15 offset:5120
  ds_read_b128 v[142:145], v15 offset:6144
  ds_read_b128 v[146:149], v15 offset:7168
  s_waitcnt lgkmcnt(5)
  v_mfma_f32_16x16x32_bf16 v[126:129], a[0:3], v[150:153], 0
  s_waitcnt lgkmcnt(4)
  v_mfma_f32_16x16x32_bf16 v[126:129], a[4:7], v[134:137], v[126:129]
  s_waitcnt lgkmcnt(3)
  v_mfma_f32_16x16x32_bf16 v[126:129], a[8:11], v[138:141], v[126:129]
  s_waitcnt lgkmcnt(2)
  v_mfma_f32_16x16x32_bf16 v[126:129], a[12:15], v[154:157], v[126:129]
  s_waitcnt lgkmcnt(1)
  v_mfma_f32_16x16x32_bf16 v[126:129], a[16:19], v[142:145], v[126:129]
  s_waitcnt lgkmcnt(0)
  v_mfma_f32_16x16x32_bf16 v[126:129], a[20:23], v[146:149], v[126:129]
  v_mfma_f32_16x16x32_bf16 v[130:133], a[72:75], v[150:153], 0
  v_mfma_f32_16x16x32_bf16 v[130:133], a[76:79], v[134:137], v[130:133]
  v_cvt_pk_bf16_f32 v158, v126, v127
  v_cvt_pk_bf16_f32 v159, v128, v129
  v_mfma_f32_16x16x32_bf16 v[130:133], a[80:83], v[138:141], v[130:133]
  v_mfma_f32_16x16x32_bf16 v[130:133], a[84:87], v[154:157], v[130:133]
  v_mfma_f32_16x16x32_bf16 v[130:133], a[88:91], v[142:145], v[130:133]
  v_mfma_f32_16x16x32_bf16 v[130:133], a[92:95], v[146:149], v[130:133]
  v_mfma_f32_16x16x32_bf16 v[126:129], v[150:153], a[144:147], 0
  v_mfma_f32_16x16x32_bf16 v[126:129], v[134:137], a[148:151], v[126:129]
  v_cvt_pk_bf16_f32 v162, v130, v131
  v_cvt_pk_bf16_f32 v163, v132, v133
  v_mfma_f32_16x16x32_bf16 v[126:129], v[138:141], a[152:155], v[126:129]
  v_mfma_f32_16x16x32_bf16 v[126:129], v[154:157], a[156:159], v[126:129]
  v_mfma_f32_16x16x32_bf16 v[126:129], v[142:145], a[160:163], v[126:129]
  v_mfma_f32_16x16x32_bf16 v[126:129], v[146:149], a[164:167], v[126:129]
  v_mfma_f32_16x16x32_bf16 v[130:133], a[24:27], v[150:153], 0
  v_mfma_f32_16x16x32_bf16 v[130:133], a[28:31], v[134:137], v[130:133]
  v_cvt_pk_bf16_f32 v166, v126, v127
  v_cvt_pk_bf16_f32 v167, v128, v129
  v_mfma_f32_16x16x32_bf16 v[130:133], a[32:35], v[138:141], v[130:133]
  v_mfma_f32_16x16x32_bf16 v[130:133], a[36:39], v[154:157], v[130:133]
  v_mfma_f32_16x16x32_bf16 v[130:133], a[40:43], v[142:145], v[130:133]
  v_mfma_f32_16x16x32_bf16 v[130:133], a[44:47], v[146:149], v[130:133]
  v_mfma_f32_16x16x32_bf16 v[126:129], a[96:99], v[150:153], 0
  v_mfma_f32_16x16x32_bf16 v[126:129], a[100:103], v[134:137], v[126:129]
  v_cvt_pk_bf16_f32 v160, v130, v131
  v_cvt_pk_bf16_f32 v161, v132, v133
  v_mfma_f32_16x16x32_bf16 v[126:129], a[104:107], v[138:141], v[126:129]
  v_mfma_f32_16x16x32_bf16 v[126:129], a[108:111], v[154:157], v[126:129]
  v_mfma_f32_16x16x32_bf16 v[126:129], a[112:115], v[142:145], v[126:129]
  v_mfma_f32_16x16x32_bf16 v[126:129], a[116:119], v[146:149], v[126:129]
  v_mfma_f32_16x16x32_bf16 v[130:133], v[150:153], a[168:171], 0
  v_mfma_f32_16x16x32_bf16 v[130:133], v[134:137], a[172:175], v[130:133]
  v_cvt_pk_bf16_f32 v164, v126, v127
  v_cvt_pk_bf16_f32 v165, v128, v129
  v_mfma_f32_16x16x32_bf16 v[130:133], v[138:141], a[176:179], v[130:133]
  v_mfma_f32_16x16x32_bf16 v[130:133], v[154:157], a[180:183], v[130:133]
  v_mfma_f32_16x16x32_bf16 v[130:133], v[142:145], a[184:187], v[130:133]
  v_mfma_f32_16x16x32_bf16 v[130:133], v[146:149], a[188:191], v[130:133]
  v_mfma_f32_16x16x32_bf16 v[126:129], a[48:51], v[150:153], 0
  v_mfma_f32_16x16x32_bf16 v[126:129], a[52:55], v[134:137], v[126:129]
  v_cvt_pk_bf16_f32 v170, v130, v131
  v_cvt_pk_bf16_f32 v171, v132, v133
  v_mfma_f32_16x16x32_bf16 v[126:129], a[56:59], v[138:141], v[126:129]
  v_mfma_f32_16x16x32_bf16 v[126:129], a[60:63], v[154:157], v[126:129]
  v_mfma_f32_16x16x32_bf16 v[126:129], a[64:67], v[142:145], v[126:129]
  v_mfma_f32_16x16x32_bf16 v[126:129], a[68:71], v[146:149], v[126:129]
  v_mfma_f32_16x16x32_bf16 v[130:133], a[120:123], v[150:153], 0
  v_mfma_f32_16x16x32_bf16 v[130:133], a[124:127], v[134:137], v[130:133]
  ds_read_b128 v[174:177], v15 offset:8192
  v_cvt_pk_bf16_f32 v118, v126, v127
  v_mfma_f32_16x16x32_bf16 v[130:133], a[128:131], v[138:141], v[130:133]
  ds_read_b128 v[178:181], v15 offset:9216
  v_cvt_pk_bf16_f32 v119, v128, v129
  v_mfma_f32_16x16x32_bf16 v[130:133], a[132:135], v[154:157], v[130:133]
  ds_read_b128 v[126:129], v15 offset:10240
  v_mfma_f32_16x16x32_bf16 v[130:133], a[136:139], v[142:145], v[130:133]
  ds_read_b128 v[182:185], v15 offset:11264
  v_mfma_f32_16x16x32_bf16 v[130:133], a[140:143], v[146:149], v[130:133]
  ds_read_b128 v[186:189], v15 offset:12288
  v_mfma_f32_16x16x32_bf16 v[190:193], v[150:153], a[192:195], 0
  ds_read_b128 v[150:153], v15 offset:13312
  v_mfma_f32_16x16x32_bf16 v[190:193], v[134:137], a[196:199], v[190:193]
  v_cvt_pk_bf16_f32 v122, v130, v131
  v_cvt_pk_bf16_f32 v123, v132, v133
  v_mfma_f32_16x16x32_bf16 v[190:193], v[138:141], a[200:203], v[190:193]
  v_mfma_f32_16x16x32_bf16 v[190:193], v[154:157], a[204:207], v[190:193]
  v_mfma_f32_16x16x32_bf16 v[190:193], v[142:145], a[208:211], v[190:193]
  v_mfma_f32_16x16x32_bf16 v[190:193], v[146:149], a[212:215], v[190:193]
  s_waitcnt lgkmcnt(5)
  v_mfma_f32_16x16x32_bf16 v[146:149], a[0:3], v[174:177], 0
  s_waitcnt lgkmcnt(4)
  v_mfma_f32_16x16x32_bf16 v[146:149], a[4:7], v[178:181], v[146:149]
  s_waitcnt lgkmcnt(3)
  v_cvt_pk_bf16_f32 v142, v190, v191
  v_cvt_pk_bf16_f32 v143, v192, v193
  v_mfma_f32_16x16x32_bf16 v[146:149], a[8:11], v[126:129], v[146:149]
  s_waitcnt lgkmcnt(2)
  v_mfma_f32_16x16x32_bf16 v[146:149], a[12:15], v[182:185], v[146:149]
  s_waitcnt lgkmcnt(1)
  v_mfma_f32_16x16x32_bf16 v[146:149], a[16:19], v[186:189], v[146:149]
  s_waitcnt lgkmcnt(0)
  v_mfma_f32_16x16x32_bf16 v[146:149], a[20:23], v[150:153], v[146:149]
  v_mfma_f32_16x16x32_bf16 v[190:193], a[72:75], v[174:177], 0
  v_mfma_f32_16x16x32_bf16 v[190:193], a[76:79], v[178:181], v[190:193]
  v_cvt_pk_bf16_f32 v154, v146, v147
  v_cvt_pk_bf16_f32 v155, v148, v149
  v_mfma_f32_16x16x32_bf16 v[190:193], a[80:83], v[126:129], v[190:193]
  v_mfma_f32_16x16x32_bf16 v[190:193], a[84:87], v[182:185], v[190:193]
  v_mfma_f32_16x16x32_bf16 v[190:193], a[88:91], v[186:189], v[190:193]
  v_mfma_f32_16x16x32_bf16 v[190:193], a[92:95], v[150:153], v[190:193]
  v_mfma_f32_16x16x32_bf16 v[146:149], v[174:177], a[144:147], 0
  v_mfma_f32_16x16x32_bf16 v[146:149], v[178:181], a[148:151], v[146:149]
  v_cvt_pk_bf16_f32 v138, v190, v191
  v_cvt_pk_bf16_f32 v139, v192, v193
  v_mfma_f32_16x16x32_bf16 v[146:149], v[126:129], a[152:155], v[146:149]
  v_mfma_f32_16x16x32_bf16 v[146:149], v[182:185], a[156:159], v[146:149]
  v_mfma_f32_16x16x32_bf16 v[146:149], v[186:189], a[160:163], v[146:149]
  v_mfma_f32_16x16x32_bf16 v[146:149], v[150:153], a[164:167], v[146:149]
  v_mfma_f32_16x16x32_bf16 v[190:193], a[24:27], v[174:177], 0
  v_mfma_f32_16x16x32_bf16 v[190:193], a[28:31], v[178:181], v[190:193]
  v_cvt_pk_bf16_f32 v168, v146, v147
  v_cvt_pk_bf16_f32 v169, v148, v149
  v_mfma_f32_16x16x32_bf16 v[190:193], a[32:35], v[126:129], v[190:193]
  v_mfma_f32_16x16x32_bf16 v[190:193], a[36:39], v[182:185], v[190:193]
  v_mfma_f32_16x16x32_bf16 v[190:193], a[40:43], v[186:189], v[190:193]
  v_mfma_f32_16x16x32_bf16 v[190:193], a[44:47], v[150:153], v[190:193]
  v_mfma_f32_16x16x32_bf16 v[146:149], a[96:99], v[174:177], 0
  v_mfma_f32_16x16x32_bf16 v[146:149], a[100:103], v[178:181], v[146:149]
  v_cvt_pk_bf16_f32 v156, v190, v191
  v_cvt_pk_bf16_f32 v157, v192, v193
  v_mfma_f32_16x16x32_bf16 v[146:149], a[104:107], v[126:129], v[146:149]
  v_mfma_f32_16x16x32_bf16 v[146:149], a[108:111], v[182:185], v[146:149]
  v_mfma_f32_16x16x32_bf16 v[146:149], a[112:115], v[186:189], v[146:149]
  v_mfma_f32_16x16x32_bf16 v[146:149], a[116:119], v[150:153], v[146:149]
  v_mfma_f32_16x16x32_bf16 v[190:193], v[174:177], a[168:171], 0
  v_mfma_f32_16x16x32_bf16 v[190:193], v[178:181], a[172:175], v[190:193]
  v_cvt_pk_bf16_f32 v140, v146, v147
  v_cvt_pk_bf16_f32 v141, v148, v149
  v_mfma_f32_16x16x32_bf16 v[190:193], v[126:129], a[176:179], v[190:193]
  v_mfma_f32_16x16x32_bf16 v[190:193], v[182:185], a[180:183], v[190:193]
  v_mfma_f32_16x16x32_bf16 v[190:193], v[186:189], a[184:187], v[190:193]
  v_mfma_f32_16x16x32_bf16 v[190:193], v[150:153], a[188:191], v[190:193]
  v_mfma_f32_16x16x32_bf16 v[146:149], a[48:51], v[174:177], 0
  v_mfma_f32_16x16x32_bf16 v[146:149], a[52:55], v[178:181], v[146:149]
  v_cvt_pk_bf16_f32 v172, v190, v191
  v_cvt_pk_bf16_f32 v173, v192, v193
  v_mfma_f32_16x16x32_bf16 v[146:149], a[56:59], v[126:129], v[146:149]
  v_mfma_f32_16x16x32_bf16 v[146:149], a[60:63], v[182:185], v[146:149]
  v_mfma_f32_16x16x32_bf16 v[146:149], a[64:67], v[186:189], v[146:149]
  v_mfma_f32_16x16x32_bf16 v[146:149], a[68:71], v[150:153], v[146:149]
  v_mfma_f32_16x16x32_bf16 v[190:193], a[120:123], v[174:177], 0
  v_mfma_f32_16x16x32_bf16 v[190:193], a[124:127], v[178:181], v[190:193]
  ds_read_b128 v[130:133], v15 offset:14336
  v_cvt_pk_bf16_f32 v254, v146, v147
  v_mfma_f32_16x16x32_bf16 v[190:193], a[128:131], v[126:129], v[190:193]
  ds_read_b128 v[134:137], v15 offset:15360
  v_cvt_pk_bf16_f32 v255, v148, v149
  v_mfma_f32_16x16x32_bf16 v[190:193], a[132:135], v[182:185], v[190:193]
  ds_read_b128 v[146:149], v15 offset:16384
  v_mfma_f32_16x16x32_bf16 v[190:193], a[136:139], v[186:189], v[190:193]
  ds_read_b128 v[194:197], v15 offset:17408
  v_mfma_f32_16x16x32_bf16 v[190:193], a[140:143], v[150:153], v[190:193]
  ds_read_b128 v[198:201], v15 offset:18432
  v_mfma_f32_16x16x32_bf16 v[202:205], v[174:177], a[192:195], 0
  ds_read_b128 v[174:177], v15 offset:19456
  v_mfma_f32_16x16x32_bf16 v[202:205], v[178:181], a[196:199], v[202:205]
  v_cvt_pk_bf16_f32 v178, v190, v191
  v_cvt_pk_bf16_f32 v179, v192, v193
  v_mfma_f32_16x16x32_bf16 v[202:205], v[126:129], a[200:203], v[202:205]
  v_mfma_f32_16x16x32_bf16 v[202:205], v[182:185], a[204:207], v[202:205]
  v_mfma_f32_16x16x32_bf16 v[202:205], v[186:189], a[208:211], v[202:205]
  v_mfma_f32_16x16x32_bf16 v[202:205], v[150:153], a[212:215], v[202:205]
  s_waitcnt lgkmcnt(5)
  v_mfma_f32_16x16x32_bf16 v[150:153], a[0:3], v[130:133], 0
  s_waitcnt lgkmcnt(4)
  v_mfma_f32_16x16x32_bf16 v[150:153], a[4:7], v[134:137], v[150:153]
  s_waitcnt lgkmcnt(3)
  v_cvt_pk_bf16_f32 v144, v202, v203
  v_cvt_pk_bf16_f32 v145, v204, v205
  v_mfma_f32_16x16x32_bf16 v[150:153], a[8:11], v[146:149], v[150:153]
  s_waitcnt lgkmcnt(2)
  v_mfma_f32_16x16x32_bf16 v[150:153], a[12:15], v[194:197], v[150:153]
  s_waitcnt lgkmcnt(1)
  v_mfma_f32_16x16x32_bf16 v[150:153], a[16:19], v[198:201], v[150:153]
  s_waitcnt lgkmcnt(0)
  v_mfma_f32_16x16x32_bf16 v[150:153], a[20:23], v[174:177], v[150:153]
  v_mfma_f32_16x16x32_bf16 v[202:205], a[72:75], v[130:133], 0
  v_mfma_f32_16x16x32_bf16 v[202:205], a[76:79], v[134:137], v[202:205]
  v_cvt_pk_bf16_f32 v186, v150, v151
  v_cvt_pk_bf16_f32 v187, v152, v153
  v_mfma_f32_16x16x32_bf16 v[202:205], a[80:83], v[146:149], v[202:205]
  v_mfma_f32_16x16x32_bf16 v[202:205], a[84:87], v[194:197], v[202:205]
  v_mfma_f32_16x16x32_bf16 v[202:205], a[88:91], v[198:201], v[202:205]
  v_mfma_f32_16x16x32_bf16 v[202:205], a[92:95], v[174:177], v[202:205]
  v_mfma_f32_16x16x32_bf16 v[150:153], v[130:133], a[144:147], 0
  v_mfma_f32_16x16x32_bf16 v[150:153], v[134:137], a[148:151], v[150:153]
  v_cvt_pk_bf16_f32 v182, v202, v203
  v_cvt_pk_bf16_f32 v183, v204, v205
  v_mfma_f32_16x16x32_bf16 v[150:153], v[146:149], a[152:155], v[150:153]
  v_mfma_f32_16x16x32_bf16 v[150:153], v[194:197], a[156:159], v[150:153]
  v_mfma_f32_16x16x32_bf16 v[150:153], v[198:201], a[160:163], v[150:153]
  v_mfma_f32_16x16x32_bf16 v[150:153], v[174:177], a[164:167], v[150:153]
  v_mfma_f32_16x16x32_bf16 v[202:205], a[24:27], v[130:133], 0
  v_mfma_f32_16x16x32_bf16 v[202:205], a[28:31], v[134:137], v[202:205]
  v_cvt_pk_bf16_f32 v106, v150, v151
  v_cvt_pk_bf16_f32 v107, v152, v153
  v_mfma_f32_16x16x32_bf16 v[202:205], a[32:35], v[146:149], v[202:205]
  v_mfma_f32_16x16x32_bf16 v[202:205], a[36:39], v[194:197], v[202:205]
  v_mfma_f32_16x16x32_bf16 v[202:205], a[40:43], v[198:201], v[202:205]
  v_mfma_f32_16x16x32_bf16 v[202:205], a[44:47], v[174:177], v[202:205]
  v_mfma_f32_16x16x32_bf16 v[150:153], a[96:99], v[130:133], 0
  v_mfma_f32_16x16x32_bf16 v[150:153], a[100:103], v[134:137], v[150:153]
  v_cvt_pk_bf16_f32 v188, v202, v203
  v_cvt_pk_bf16_f32 v189, v204, v205
  v_mfma_f32_16x16x32_bf16 v[150:153], a[104:107], v[146:149], v[150:153]
  v_mfma_f32_16x16x32_bf16 v[150:153], a[108:111], v[194:197], v[150:153]
  v_mfma_f32_16x16x32_bf16 v[150:153], a[112:115], v[198:201], v[150:153]
  v_mfma_f32_16x16x32_bf16 v[150:153], a[116:119], v[174:177], v[150:153]
  v_mfma_f32_16x16x32_bf16 v[202:205], v[130:133], a[168:171], 0
  v_mfma_f32_16x16x32_bf16 v[202:205], v[134:137], a[172:175], v[202:205]
  v_cvt_pk_bf16_f32 v184, v150, v151
  v_cvt_pk_bf16_f32 v185, v152, v153
  v_mfma_f32_16x16x32_bf16 v[202:205], v[146:149], a[176:179], v[202:205]
  v_mfma_f32_16x16x32_bf16 v[202:205], v[194:197], a[180:183], v[202:205]
  v_mfma_f32_16x16x32_bf16 v[202:205], v[198:201], a[184:187], v[202:205]
  v_mfma_f32_16x16x32_bf16 v[202:205], v[174:177], a[188:191], v[202:205]
  v_mfma_f32_16x16x32_bf16 v[150:153], a[48:51], v[130:133], 0
  v_mfma_f32_16x16x32_bf16 v[150:153], a[52:55], v[134:137], v[150:153]
  v_cvt_pk_bf16_f32 v110, v202, v203
  v_cvt_pk_bf16_f32 v111, v204, v205
  v_mfma_f32_16x16x32_bf16 v[150:153], a[56:59], v[146:149], v[150:153]
  v_mfma_f32_16x16x32_bf16 v[150:153], a[60:63], v[194:197], v[150:153]
  v_mfma_f32_16x16x32_bf16 v[150:153], a[64:67], v[198:201], v[150:153]
  ds_read_b64 v[180:181], v19 offset:16
  v_mfma_f32_16x16x32_bf16 v[150:153], a[68:71], v[174:177], v[150:153]
  v_mfma_f32_16x16x32_bf16 v[202:205], a[120:123], v[130:133], 0
  v_mfma_f32_16x16x32_bf16 v[202:205], a[124:127], v[134:137], v[202:205]
  ds_read2_b64 v[126:129], v19 offset0:0 offset1:1
  v_cvt_pk_bf16_f32 v190, v150, v151
  v_mfma_f32_16x16x32_bf16 v[202:205], a[128:131], v[146:149], v[202:205]
  v_cvt_pk_bf16_f32 v191, v152, v153
  v_mfma_f32_16x16x32_bf16 v[202:205], a[132:135], v[194:197], v[202:205]
  v_mfma_f32_16x16x32_bf16 v[202:205], a[136:139], v[198:201], v[202:205]
  v_mfma_f32_16x16x32_bf16 v[202:205], a[140:143], v[174:177], v[202:205]
  v_mfma_f32_16x16x32_bf16 v[150:153], v[130:133], a[192:195], 0
  ds_read_u16 v108, v20
  v_mfma_f32_16x16x32_bf16 v[150:153], v[134:137], a[196:199], v[150:153]
  v_cvt_pk_bf16_f32 v192, v202, v203
  v_cvt_pk_bf16_f32 v193, v204, v205
  v_mfma_f32_16x16x32_bf16 v[150:153], v[146:149], a[200:203], v[150:153]
  ds_read_u16 v112, v20 offset:32
  v_mfma_f32_16x16x32_bf16 v[150:153], v[194:197], a[204:207], v[150:153]
  v_mfma_f32_16x16x32_bf16 v[150:153], v[198:201], a[208:211], v[150:153]
  ds_read_u16 v116, v20 offset:64
  v_mfma_f32_16x16x32_bf16 v[150:153], v[174:177], a[212:215], v[150:153]
  s_waitcnt lgkmcnt(4)
  v_mfma_f32_16x16x16_bf16 v[174:177], v[122:123], v[118:119], 0
  v_mfma_f32_16x16x16_bf16 v[198:201], v[178:179], v[118:119], 0
  v_cvt_pk_bf16_f32 v114, v150, v151
  v_cvt_pk_bf16_f32 v115, v152, v153
  v_mfma_f32_16x16x16_bf16 v[150:153], v[192:193], v[118:119], 0
  v_mfma_f32_16x16x16_bf16 v[194:197], v[180:181], v[118:119], v[2:5]
  v_mfma_f32_16x16x32_bf16 v[174:177], v[162:165], v[158:161], v[174:177]
  v_mfma_f32_16x16x32_bf16 v[198:201], v[138:141], v[158:161], v[198:201]
  v_mfma_f32_16x16x32_bf16 v[150:153], v[182:185], v[158:161], v[150:153]
  s_waitcnt lgkmcnt(3)
  v_max3_f32 v120, v174, v175, v176
  v_mfma_f32_16x16x32_bf16 v[194:197], v[126:129], v[158:161], v[194:197]
  v_max3_f32 v120, v120, v177, v198
  v_max3_f32 v120, v120, v199, v200
  s_nop 1
  v_max3_f32 v120, v120, v201, v150
  v_max3_f32 v120, v120, v151, v152
  s_nop 1
  v_max3_f32 v120, v120, v153, v194
  v_mov_b32 v118, v120
  s_nop 1
  v_permlane32_swap_b32 v120, v118
  v_max_f32 v120, v120, v118
  v_mov_b32 v118, v120
  s_nop 1
  v_permlane16_swap_b32 v120, v118
  v_max_f32 v120, v120, v118
  v_sub_f32 v174, v174, v120
  v_sub_f32 v175, v175, v120
  v_sub_f32 v176, v176, v120
  v_sub_f32 v177, v177, v120
  v_sub_f32 v198, v198, v120
  v_sub_f32 v199, v199, v120
  v_sub_f32 v200, v200, v120
  v_sub_f32 v201, v201, v120
  v_exp_f32 v174, v174
  v_exp_f32 v175, v175
  v_exp_f32 v176, v176
  v_exp_f32 v177, v177
  v_exp_f32 v198, v198
  v_exp_f32 v199, v199
  v_exp_f32 v200, v200
  v_exp_f32 v201, v201
  v_sub_f32 v150, v150, v120
  v_sub_f32 v151, v151, v120
  v_sub_f32 v152, v152, v120
  v_sub_f32 v153, v153, v120
  v_sub_f32 v194, v194, v120
  v_exp_f32 v150, v150
  v_exp_f32 v151, v151
  v_exp_f32 v152, v152
  v_exp_f32 v153, v153
  v_exp_f32 v194, v194
  v_cvt_pk_bf16_f32 v158, v174, v175
  v_cvt_pk_bf16_f32 v159, v176, v177
  v_cvt_pk_bf16_f32 v160, v198, v199
  v_cvt_pk_bf16_f32 v161, v200, v201
  v_cvt_pk_bf16_f32 v118, v150, v151
  v_cvt_pk_bf16_f32 v119, v152, v153
  v_mfma_f32_16x16x32_bf16 v[150:153], a[246:249], v[158:161], 0
  v_cvt_pk_bf16_f32 v120, v194, 0
  s_nop 1
  v_mfma_f32_16x16x32_bf16 v[150:153], a[246:249], v[118:121], v[150:153]
  v_mfma_f32_16x16x32_bf16 v[194:197], v[166:169], v[158:161], 0
  s_waitcnt lgkmcnt(2)
  v_mfma_f32_16x16x32_bf16 v[194:197], v[106:109], v[118:121], v[194:197]
  v_mul_f32 v150, 0x3ee9a3cd, v150
  v_mfma_f32_16x16x32_bf16 v[198:201], v[170:173], v[158:161], 0
  s_waitcnt lgkmcnt(1)
  v_rcp_f32 v124, v150
  v_mfma_f32_16x16x32_bf16 v[198:201], v[110:113], v[118:121], v[198:201]
  v_mul_f32 v194, v194, v124
  v_mul_f32 v195, v195, v124
  v_mfma_f32_16x16x32_bf16 v[150:153], v[142:145], v[158:161], 0
  s_waitcnt lgkmcnt(0)
  v_cvt_pk_bf16_f32 v158, v194, v195
  v_mul_f32 v196, v196, v124
  v_mfma_f32_16x16x32_bf16 v[150:153], v[114:117], v[118:121], v[150:153]
  v_mul_f32 v197, v197, v124
  v_cvt_pk_bf16_f32 v159, v196, v197
  v_mul_f32 v198, v198, v124
  v_mfma_f32_16x16x16_bf16 v[194:197], v[122:123], v[254:255], 0
  v_mul_f32 v199, v199, v124
  v_cvt_pk_bf16_f32 v160, v198, v199
  v_mul_f32 v200, v200, v124
  v_mfma_f32_16x16x16_bf16 v[174:177], v[178:179], v[254:255], 0
  v_mul_f32 v201, v201, v124
  v_cvt_pk_bf16_f32 v161, v200, v201
  v_mul_f32 v150, v150, v124
  v_mfma_f32_16x16x16_bf16 v[198:201], v[192:193], v[254:255], 0
  v_mul_f32 v151, v151, v124
  v_cvt_pk_bf16_f32 v202, v150, v151
  v_mul_f32 v152, v152, v124
  v_mfma_f32_16x16x16_bf16 v[146:149], v[180:181], v[254:255], v[2:5]
  v_mul_f32 v153, v153, v124
  v_cvt_pk_bf16_f32 v203, v152, v153
  v_mfma_f32_16x16x32_bf16 v[194:197], v[162:165], v[154:157], v[194:197]
  ds_write_b128 v16, v[158:161] offset:20480
  v_mfma_f32_16x16x32_bf16 v[174:177], v[138:141], v[154:157], v[174:177]
  s_nop 3
  v_max3_f32 v124, v194, v195, v196
  v_mfma_f32_16x16x32_bf16 v[198:201], v[182:185], v[154:157], v[198:201]
  ds_write_b64 v17, v[202:203] offset:20480
  v_mfma_f32_16x16x32_bf16 v[146:149], v[126:129], v[154:157], v[146:149]
  v_max3_f32 v124, v124, v197, v174
  v_max3_f32 v124, v124, v175, v176
  s_nop 1
  v_max3_f32 v124, v124, v177, v198
  v_max3_f32 v124, v124, v199, v200
  s_nop 1
  v_max3_f32 v124, v124, v201, v146
  v_mov_b32 v254, v124
  s_nop 1
  v_permlane32_swap_b32 v124, v254
  v_max_f32 v124, v124, v254
  v_mov_b32 v254, v124
  s_nop 1
  v_permlane16_swap_b32 v124, v254
  v_max_f32 v124, v124, v254
  v_sub_f32 v194, v194, v124
  v_sub_f32 v195, v195, v124
  v_sub_f32 v196, v196, v124
  v_sub_f32 v197, v197, v124
  v_sub_f32 v174, v174, v124
  v_sub_f32 v175, v175, v124
  v_sub_f32 v176, v176, v124
  v_sub_f32 v177, v177, v124
  v_exp_f32 v194, v194
  v_exp_f32 v195, v195
  v_exp_f32 v196, v196
  v_exp_f32 v197, v197
  v_exp_f32 v174, v174
  v_exp_f32 v175, v175
  v_exp_f32 v176, v176
  v_exp_f32 v177, v177
  v_sub_f32 v198, v198, v124
  v_sub_f32 v199, v199, v124
  v_sub_f32 v200, v200, v124
  v_sub_f32 v201, v201, v124
  v_sub_f32 v146, v146, v124
  v_exp_f32 v198, v198
  v_exp_f32 v199, v199
  v_exp_f32 v200, v200
  v_exp_f32 v201, v201
  v_exp_f32 v146, v146
  v_cvt_pk_bf16_f32 v154, v194, v195
  v_cvt_pk_bf16_f32 v155, v196, v197
  v_cvt_pk_bf16_f32 v156, v174, v175
  v_cvt_pk_bf16_f32 v157, v176, v177
  v_cvt_pk_bf16_f32 v118, v198, v199
  v_cvt_pk_bf16_f32 v119, v200, v201
  v_mfma_f32_16x16x32_bf16 v[198:201], a[246:249], v[154:157], 0
  v_cvt_pk_bf16_f32 v120, v146, 0
  s_nop 1
  v_mfma_f32_16x16x32_bf16 v[198:201], a[246:249], v[118:121], v[198:201]
  v_mfma_f32_16x16x32_bf16 v[146:149], v[166:169], v[154:157], 0
  v_mfma_f32_16x16x32_bf16 v[146:149], v[106:109], v[118:121], v[146:149]
  v_mul_f32 v198, 0x3ee9a3cd, v198
  v_mfma_f32_16x16x32_bf16 v[174:177], v[170:173], v[154:157], 0
  v_rcp_f32 v124, v198
  v_mfma_f32_16x16x32_bf16 v[174:177], v[110:113], v[118:121], v[174:177]
  v_mul_f32 v146, v146, v124
  v_mul_f32 v147, v147, v124
  v_mfma_f32_16x16x32_bf16 v[198:201], v[142:145], v[154:157], 0
  v_cvt_pk_bf16_f32 v154, v146, v147
  v_mul_f32 v148, v148, v124
  v_mfma_f32_16x16x32_bf16 v[198:201], v[114:117], v[118:121], v[198:201]
  ds_read_b64 v[254:255], v19 offset:784
  v_mul_f32 v149, v149, v124
  v_cvt_pk_bf16_f32 v155, v148, v149
  v_mfma_f32_16x16x16_bf16 v[146:149], v[122:123], v[190:191], 0
  v_mul_f32 v174, v174, v124
  v_mul_f32 v175, v175, v124
  v_cvt_pk_bf16_f32 v156, v174, v175
  v_mfma_f32_16x16x16_bf16 v[194:197], v[178:179], v[190:191], 0
  v_mul_f32 v176, v176, v124
  v_mul_f32 v177, v177, v124
  v_cvt_pk_bf16_f32 v157, v176, v177
  v_mfma_f32_16x16x16_bf16 v[174:177], v[192:193], v[190:191], 0
  v_mul_f32 v198, v198, v124
  v_mul_f32 v199, v199, v124
  v_cvt_pk_bf16_f32 v202, v198, v199
  v_mfma_f32_16x16x16_bf16 v[158:161], v[180:181], v[190:191], v[2:5]
  v_mul_f32 v200, v200, v124
  v_mul_f32 v201, v201, v124
  v_cvt_pk_bf16_f32 v203, v200, v201
  v_mfma_f32_16x16x32_bf16 v[146:149], v[162:165], v[186:189], v[146:149]
  ds_read2_b64 v[198:201], v19 offset0:96 offset1:97
  v_add_u32 v19, 1160, v19
  v_mfma_f32_16x16x32_bf16 v[194:197], v[138:141], v[186:189], v[194:197]
  ds_write_b128 v16, v[154:157] offset:26624
  v_mfma_f32_16x16x32_bf16 v[174:177], v[182:185], v[186:189], v[174:177]
  v_max3_f32 v124, v146, v147, v148
  s_nop 2
  v_max3_f32 v124, v124, v149, v194
  v_mfma_f32_16x16x32_bf16 v[158:161], v[126:129], v[186:189], v[158:161]
  v_max3_f32 v124, v124, v195, v196
  s_nop 0
  v_max3_f32 v124, v124, v197, v174
  v_max3_f32 v124, v124, v175, v176
  s_nop 3
  v_max3_f32 v124, v124, v177, v158
  v_mov_b32 v190, v124
  s_nop 1
  v_permlane32_swap_b32 v124, v190
  v_max_f32 v124, v124, v190
  v_mov_b32 v190, v124
  s_nop 1
  v_permlane16_swap_b32 v124, v190
  v_max_f32 v124, v124, v190
  v_sub_f32 v146, v146, v124
  v_sub_f32 v147, v147, v124
  v_sub_f32 v148, v148, v124
  v_sub_f32 v149, v149, v124
  v_sub_f32 v194, v194, v124
  v_sub_f32 v195, v195, v124
  v_sub_f32 v196, v196, v124
  v_sub_f32 v197, v197, v124
  v_exp_f32 v146, v146
  v_exp_f32 v147, v147
  v_exp_f32 v148, v148
  v_exp_f32 v149, v149
  v_exp_f32 v194, v194
  v_exp_f32 v195, v195
  v_exp_f32 v196, v196
  v_exp_f32 v197, v197
  v_sub_f32 v174, v174, v124
  v_sub_f32 v175, v175, v124
  v_sub_f32 v176, v176, v124
  v_sub_f32 v177, v177, v124
  v_sub_f32 v158, v158, v124
  v_exp_f32 v174, v174
  v_exp_f32 v175, v175
  v_exp_f32 v176, v176
  v_exp_f32 v177, v177
  v_exp_f32 v158, v158
  v_cvt_pk_bf16_f32 v186, v146, v147
  v_cvt_pk_bf16_f32 v187, v148, v149
  v_cvt_pk_bf16_f32 v188, v194, v195
  v_cvt_pk_bf16_f32 v189, v196, v197
  v_cvt_pk_bf16_f32 v118, v174, v175
  v_cvt_pk_bf16_f32 v119, v176, v177
  v_mfma_f32_16x16x32_bf16 v[174:177], a[246:249], v[186:189], 0
  v_cvt_pk_bf16_f32 v120, v158, 0
  s_nop 1
  v_mfma_f32_16x16x32_bf16 v[174:177], a[246:249], v[118:121], v[174:177]
  ds_write_b64 v17, v[202:203] offset:26624
  v_mfma_f32_16x16x32_bf16 v[158:161], v[166:169], v[186:189], 0
  v_mfma_f32_16x16x32_bf16 v[158:161], v[106:109], v[118:121], v[158:161]
  v_mul_f32 v174, 0x3ee9a3cd, v174
  v_mfma_f32_16x16x32_bf16 v[194:197], v[170:173], v[186:189], 0
  v_rcp_f32 v124, v174
  v_mfma_f32_16x16x32_bf16 v[194:197], v[110:113], v[118:121], v[194:197]
  v_mul_f32 v158, v158, v124
  v_mul_f32 v159, v159, v124
  v_mfma_f32_16x16x32_bf16 v[174:177], v[142:145], v[186:189], 0
  v_mul_f32 v160, v160, v124
  v_mul_f32 v161, v161, v124
  v_mfma_f32_16x16x32_bf16 v[174:177], v[114:117], v[118:121], v[174:177]
  s_waitcnt lgkmcnt(2)
  v_mul_f32 v194, v194, v124
  v_mul_f32 v195, v195, v124
  v_mul_f32 v196, v196, v124
  v_mfma_f32_16x16x16_bf16 v[186:189], v[122:123], v[254:255], 0
  v_mul_f32 v197, v197, v124
  v_cvt_pk_bf16_f32 v146, v158, v159
  v_cvt_pk_bf16_f32 v147, v160, v161
  v_mfma_f32_16x16x16_bf16 v[158:161], v[178:179], v[254:255], 0
  v_cvt_pk_bf16_f32 v148, v194, v195
  v_cvt_pk_bf16_f32 v149, v196, v197
  v_mul_f32 v174, v174, v124
  v_mfma_f32_16x16x16_bf16 v[194:197], v[192:193], v[254:255], 0
  v_mul_f32 v175, v175, v124
  v_mul_f32 v176, v176, v124
  v_mul_f32 v177, v177, v124
  v_mfma_f32_16x16x16_bf16 v[154:157], v[180:181], v[254:255], v[2:5]
  v_cvt_pk_bf16_f32 v254, v174, v175
  v_cvt_pk_bf16_f32 v255, v176, v177
  v_mfma_f32_16x16x32_bf16 v[186:189], v[162:165], v[198:201], v[186:189]
  ds_write_b128 v16, v[146:149] offset:32768
  v_mfma_f32_16x16x32_bf16 v[158:161], v[138:141], v[198:201], v[158:161]
  s_nop 3
  v_max3_f32 v124, v186, v187, v188
  v_mfma_f32_16x16x32_bf16 v[194:197], v[182:185], v[198:201], v[194:197]
  ds_write_b64 v17, v[254:255] offset:32768
  v_mfma_f32_16x16x32_bf16 v[154:157], v[126:129], v[198:201], v[154:157]
  v_max3_f32 v124, v124, v189, v158
  v_max3_f32 v124, v124, v159, v160
  s_nop 1
  v_max3_f32 v124, v124, v161, v194
  v_max3_f32 v124, v124, v195, v196
  s_nop 1
  v_max3_f32 v124, v124, v197, v154
  v_mov_b32 v254, v124
  s_nop 1
  v_permlane32_swap_b32 v124, v254
  v_max_f32 v124, v124, v254
  v_mov_b32 v254, v124
  s_nop 1
  v_permlane16_swap_b32 v124, v254
  v_max_f32 v124, v124, v254
  v_sub_f32 v186, v186, v124
  v_sub_f32 v187, v187, v124
  v_sub_f32 v188, v188, v124
  v_sub_f32 v189, v189, v124
  v_sub_f32 v158, v158, v124
  v_sub_f32 v159, v159, v124
  v_sub_f32 v160, v160, v124
  v_sub_f32 v161, v161, v124
  v_exp_f32 v186, v186
  v_exp_f32 v187, v187
  v_exp_f32 v188, v188
  v_exp_f32 v189, v189
  v_exp_f32 v158, v158
  v_exp_f32 v159, v159
  v_exp_f32 v160, v160
  v_exp_f32 v161, v161
  v_sub_f32 v194, v194, v124
  v_sub_f32 v195, v195, v124
  v_sub_f32 v196, v196, v124
  v_sub_f32 v197, v197, v124
  v_sub_f32 v154, v154, v124
  v_exp_f32 v194, v194
  v_exp_f32 v195, v195
  v_exp_f32 v196, v196
  v_exp_f32 v197, v197
  v_exp_f32 v154, v154
  v_cvt_pk_bf16_f32 v126, v186, v187
  v_cvt_pk_bf16_f32 v127, v188, v189
  v_cvt_pk_bf16_f32 v128, v158, v159
  v_cvt_pk_bf16_f32 v129, v160, v161
  v_cvt_pk_bf16_f32 v118, v194, v195
  v_cvt_pk_bf16_f32 v119, v196, v197
  v_mfma_f32_16x16x32_bf16 v[194:197], v[126:129], a[246:249], 0
  v_cvt_pk_bf16_f32 v120, v154, 0
  s_nop 1
  v_mfma_f32_16x16x32_bf16 v[194:197], v[118:121], a[246:249], v[194:197]
  v_mfma_f32_16x16x32_bf16 v[154:157], v[126:129], v[166:169], 0
  v_mfma_f32_16x16x32_bf16 v[154:157], v[118:121], v[106:109], v[154:157]
  v_mul_f32 v194, 0x3ee9a3cd, v194
  v_mfma_f32_16x16x32_bf16 v[166:169], v[126:129], v[170:173], 0
  v_rcp_f32 v108, v194
  v_mfma_f32_16x16x32_bf16 v[166:169], v[118:121], v[110:113], v[166:169]
  ds_read_b128 v[194:197], v18
  ds_read_b128 v[170:173], v18 offset:1024
  v_mfma_f32_16x16x32_bf16 v[158:161], v[126:129], v[142:145], 0
  ds_read_b128 v[126:129], v18 offset:2048
  v_mfma_f32_16x16x32_bf16 v[158:161], v[118:121], v[114:117], v[158:161]
  s_waitcnt lgkmcnt(3)
  v_cndmask_b32 v116, v166, v154, s[54:55]
  s_nop 5
  v_cndmask_b32 v116, v158, v116, s[56:57]
  v_mul_f32 v116, v116, v108
  v_cvt_pk_bf16_f32 v116, v116, v116
  ds_write_b16 v20, v116 offset:384
  v_add_u32 v20, 1160, v20
  s_waitcnt lgkmcnt(0)
  s_barrier
  ds_read_b128 v[158:161], v15 offset:20480
  ds_read_b128 v[154:157], v15 offset:26624
  ds_read_b128 v[166:169], v15 offset:32768
  ds_read_b128 v[142:145], v15 offset:21504
  ds_read_b128 v[186:189], v15 offset:27648
  s_waitcnt lgkmcnt(4)
  v_mfma_f32_16x16x32_bf16 v[26:29], a[250:253], v[158:161], v[26:29]
  v_mfma_f32_16x16x32_bf16 v[30:33], v[98:101], v[158:161], v[30:33]
  v_mfma_f32_16x16x32_bf16 v[34:37], v[102:105], v[158:161], v[34:37]
  s_waitcnt lgkmcnt(3)
  ds_read_b128 v[158:161], v15 offset:33792
  v_mfma_f32_16x16x32_bf16 v[38:41], a[250:253], v[154:157], v[38:41]
  v_mfma_f32_16x16x32_bf16 v[42:45], v[98:101], v[154:157], v[42:45]
  v_mfma_f32_16x16x32_bf16 v[46:49], v[102:105], v[154:157], v[46:49]
  s_waitcnt lgkmcnt(3)
  ds_read_b128 v[154:157], v18 offset:6144
  ds_read_b128 v[198:201], v15 offset:22528
  v_mfma_f32_16x16x32_bf16 v[50:53], a[250:253], v[166:169], v[50:53]
  ds_read_b128 v[182:185], v18 offset:7168
  v_mfma_f32_16x16x32_bf16 v[54:57], v[98:101], v[166:169], v[54:57]
  ds_read_b128 v[138:141], v18 offset:8192
  v_mfma_f32_16x16x32_bf16 v[58:61], v[102:105], v[166:169], v[58:61]
  s_waitcnt lgkmcnt(6)
  ds_read_b128 v[166:169], v15 offset:28672
  v_mfma_f32_16x16x32_bf16 v[26:29], v[194:197], v[142:145], v[26:29]
  v_mfma_f32_16x16x32_bf16 v[30:33], v[170:173], v[142:145], v[30:33]
  v_mfma_f32_16x16x32_bf16 v[34:37], v[126:129], v[142:145], v[34:37]
  s_waitcnt lgkmcnt(6)
  ds_read_b128 v[142:145], v15 offset:34816
  v_mfma_f32_16x16x32_bf16 v[38:41], v[194:197], v[186:189], v[38:41]
  v_mfma_f32_16x16x32_bf16 v[42:45], v[170:173], v[186:189], v[42:45]
  v_mfma_f32_16x16x32_bf16 v[46:49], v[126:129], v[186:189], v[46:49]
  s_waitcnt lgkmcnt(6)
  ds_read_b128 v[186:189], v18 offset:9216
  ds_read_b128 v[146:149], v15 offset:23552
  v_mfma_f32_16x16x32_bf16 v[50:53], v[194:197], v[158:161], v[50:53]
  ds_read_b128 v[194:197], v18 offset:10240
  v_mfma_f32_16x16x32_bf16 v[54:57], v[170:173], v[158:161], v[54:57]
  ds_read_b128 v[170:173], v18 offset:11264
  v_mfma_f32_16x16x32_bf16 v[58:61], v[126:129], v[158:161], v[58:61]
  s_waitcnt lgkmcnt(8)
  ds_read_b128 v[126:129], v15 offset:29696
  v_mfma_f32_16x16x32_bf16 v[26:29], v[154:157], v[198:201], v[26:29]
  s_waitcnt lgkmcnt(8)
  v_mfma_f32_16x16x32_bf16 v[30:33], v[182:185], v[198:201], v[30:33]
  s_waitcnt lgkmcnt(7)
  v_mfma_f32_16x16x32_bf16 v[34:37], v[138:141], v[198:201], v[34:37]
  s_waitcnt lgkmcnt(6)
  ds_read_b128 v[198:201], v15 offset:35840
  v_mfma_f32_16x16x32_bf16 v[38:41], v[154:157], v[166:169], v[38:41]
  v_mfma_f32_16x16x32_bf16 v[42:45], v[182:185], v[166:169], v[42:45]
  v_mfma_f32_16x16x32_bf16 v[46:49], v[138:141], v[166:169], v[46:49]
  s_waitcnt lgkmcnt(6)
  ds_read_b128 v[166:169], v18 offset:3072
  ds_read_b128 v[158:161], v15 offset:24576
  v_mfma_f32_16x16x32_bf16 v[50:53], v[154:157], v[142:145], v[50:53]
  ds_read_b128 v[154:157], v18 offset:4096
  v_mfma_f32_16x16x32_bf16 v[54:57], v[182:185], v[142:145], v[54:57]
  ds_read_b128 v[182:185], v18 offset:5120
  v_mfma_f32_16x16x32_bf16 v[58:61], v[138:141], v[142:145], v[58:61]
  s_waitcnt lgkmcnt(8)
  ds_read_b128 v[138:141], v15 offset:30720
  v_mfma_f32_16x16x32_bf16 v[26:29], v[186:189], v[146:149], v[26:29]
  s_waitcnt lgkmcnt(8)
  v_mfma_f32_16x16x32_bf16 v[30:33], v[194:197], v[146:149], v[30:33]
  s_waitcnt lgkmcnt(7)
  v_mfma_f32_16x16x32_bf16 v[34:37], v[170:173], v[146:149], v[34:37]
  s_waitcnt lgkmcnt(6)
  ds_read_b128 v[146:149], v15 offset:36864
  v_mfma_f32_16x16x32_bf16 v[38:41], v[186:189], v[126:129], v[38:41]
  v_mfma_f32_16x16x32_bf16 v[42:45], v[194:197], v[126:129], v[42:45]
  v_mfma_f32_16x16x32_bf16 v[46:49], v[170:173], v[126:129], v[46:49]
  s_waitcnt lgkmcnt(6)
  ds_read_b128 v[126:129], v18 offset:12288
  ds_read_b128 v[142:145], v15 offset:25600
  v_mfma_f32_16x16x32_bf16 v[50:53], v[186:189], v[198:201], v[50:53]
  ds_read_b128 v[186:189], v18 offset:13312
  v_mfma_f32_16x16x32_bf16 v[54:57], v[194:197], v[198:201], v[54:57]
  ds_read_b128 v[194:197], v18 offset:14336
  v_mfma_f32_16x16x32_bf16 v[58:61], v[170:173], v[198:201], v[58:61]
  s_waitcnt lgkmcnt(8)
  ds_read_b128 v[170:173], v15 offset:31744
  v_mfma_f32_16x16x32_bf16 v[26:29], v[166:169], v[158:161], v[26:29]
  s_waitcnt lgkmcnt(8)
  v_mfma_f32_16x16x32_bf16 v[30:33], v[154:157], v[158:161], v[30:33]
  s_waitcnt lgkmcnt(7)
  v_mfma_f32_16x16x32_bf16 v[34:37], v[182:185], v[158:161], v[34:37]
  s_waitcnt lgkmcnt(6)
  ds_read_b128 v[158:161], v15 offset:37888
  v_mfma_f32_16x16x32_bf16 v[38:41], v[166:169], v[138:141], v[38:41]
  v_mfma_f32_16x16x32_bf16 v[42:45], v[154:157], v[138:141], v[42:45]
  v_mfma_f32_16x16x32_bf16 v[46:49], v[182:185], v[138:141], v[46:49]
  s_waitcnt lgkmcnt(6)
  v_mfma_f32_16x16x32_bf16 v[50:53], v[166:169], v[146:149], v[50:53]
  v_mfma_f32_16x16x32_bf16 v[54:57], v[154:157], v[146:149], v[54:57]
  v_mfma_f32_16x16x32_bf16 v[58:61], v[182:185], v[146:149], v[58:61]
  s_waitcnt lgkmcnt(4)
  v_mfma_f32_16x16x32_bf16 v[26:29], v[126:129], v[142:145], v[26:29]
  s_waitcnt lgkmcnt(3)
  v_mfma_f32_16x16x32_bf16 v[30:33], v[186:189], v[142:145], v[30:33]
  s_waitcnt lgkmcnt(2)
  v_mfma_f32_16x16x32_bf16 v[34:37], v[194:197], v[142:145], v[34:37]
  s_waitcnt lgkmcnt(1)
  v_cvt_pk_bf16_f32 v142, v26, v27
  v_cvt_pk_bf16_f32 v143, v28, v29
  v_mfma_f32_16x16x32_bf16 v[38:41], v[126:129], v[170:173], v[38:41]
  v_cvt_pk_bf16_f32 v144, v30, v31
  v_cvt_pk_bf16_f32 v145, v32, v33
  v_mfma_f32_16x16x32_bf16 v[42:45], v[186:189], v[170:173], v[42:45]
  v_cvt_pk_bf16_f32 v146, v34, v35
  v_cvt_pk_bf16_f32 v147, v36, v37
  v_mfma_f32_16x16x32_bf16 v[46:49], v[194:197], v[170:173], v[46:49]
  s_waitcnt lgkmcnt(0)
  v_cvt_pk_bf16_f32 v170, v38, v39
  v_cvt_pk_bf16_f32 v171, v40, v41
  v_mfma_f32_16x16x32_bf16 v[50:53], v[126:129], v[158:161], v[50:53]
  v_cvt_pk_bf16_f32 v172, v42, v43
  v_cvt_pk_bf16_f32 v173, v44, v45
  v_mfma_f32_16x16x32_bf16 v[54:57], v[186:189], v[158:161], v[54:57]
  v_cvt_pk_bf16_f32 v148, v46, v47
  v_cvt_pk_bf16_f32 v149, v48, v49
  v_mfma_f32_16x16x32_bf16 v[58:61], v[194:197], v[158:161], v[58:61]
  v_cvt_pk_bf16_f32 v158, v50, v51
  v_cvt_pk_bf16_f32 v159, v52, v53
  s_nop 1
  v_cvt_pk_bf16_f32 v160, v54, v55
  v_cvt_pk_bf16_f32 v161, v56, v57
  v_permlane16_swap_b32 v142, v144
  v_permlane16_swap_b32 v143, v145
  v_permlane16_swap_b32 v170, v172
  v_permlane16_swap_b32 v171, v173
  v_permlane16_swap_b32 v146, v148
  v_permlane16_swap_b32 v147, v149
  v_permlane16_swap_b32 v158, v160
  v_permlane16_swap_b32 v159, v161
  v_cvt_pk_bf16_f32 v114, v58, v59
  v_cvt_pk_bf16_f32 v115, v60, v61
  buffer_store_dwordx4 v[142:145], v12, s[8:11], s35 offen
  buffer_store_dwordx4 v[170:173], v13, s[8:11], s35 offen
  buffer_store_dwordx4 v[146:149], v22, s[8:11], s35 offen
  buffer_store_dwordx4 v[158:161], v14, s[8:11], s35 offen
  buffer_store_dwordx2 v[114:115], v23, s[8:11], s35 offen
  s_cmp_lt_u32 s31, 21
  s_cbranch_scc1 L_safe_loop
  buffer_load_dwordx4 v[126:129], v15, s[12:15], s77 offen offset:2048
  buffer_load_dwordx4 v[62:65], v15, s[12:15], s75 offen
  buffer_load_dwordx4 v[66:69], v15, s[12:15], s75 offen offset:1024
  buffer_load_dwordx4 v[70:73], v15, s[12:15], s75 offen offset:2048
  ds_read_b128 v[130:133], v18
  ds_read_b128 v[134:137], v18 offset:6144
  ds_read_b128 v[138:141], v18 offset:9216
  ds_read_b128 v[142:145], v18 offset:3072
  ds_read_b128 v[146:149], v18 offset:12288
  buffer_load_dwordx4 v[74:77], v15, s[12:15], s75 offen offset:3072
  ds_read_b128 v[150:153], v18 offset:1024
  ds_read_b128 v[154:157], v18 offset:7168
  ds_read_b128 v[158:161], v18 offset:10240
  ds_read_b128 v[162:165], v18 offset:4096
  ds_read_b128 v[166:169], v18 offset:13312
  buffer_load_dwordx4 v[78:81], v15, s[12:15], s77 offen
  ds_read_b128 v[170:173], v18 offset:2048
  ds_read_b128 v[174:177], v18 offset:8192
  ds_read_b128 v[178:181], v18 offset:11264
  ds_read_b128 v[182:185], v18 offset:5120
  buffer_load_dwordx4 v[82:85], v15, s[12:15], s77 offen offset:1024
  ds_read_b128 v[186:189], v18 offset:14336
  s_waitcnt vmcnt(6)
  ds_read2_b64 v[190:193], v129 offset0:0 offset1:4
  ds_read2_b64 v[194:197], v129 offset0:12 offset1:16
  v_add_u32 v108, 18560, v129
  ds_read2_b64 v[198:201], v129 offset0:24 offset1:28
  ds_read2_b64 v[202:205], v129 offset0:36 offset1:40
  s_waitcnt vmcnt(5) lgkmcnt(3)
  v_mfma_f32_16x16x32_bf16 v[62:65], a[250:253], v[190:193], v[62:65]
  ds_read2_b64 v[206:209], v129 offset0:8 offset1:20
  s_waitcnt lgkmcnt(3)
  v_mfma_f32_16x16x32_bf16 v[62:65], v[130:133], v[194:197], v[62:65]
  ds_read2_b64 v[210:213], v129 offset0:32 offset1:44
  s_waitcnt lgkmcnt(3)
  v_mfma_f32_16x16x32_bf16 v[62:65], v[134:137], v[198:201], v[62:65]
  ds_read2_b64 v[214:217], v108 offset0:0 offset1:4
  s_waitcnt lgkmcnt(3)
  v_mfma_f32_16x16x32_bf16 v[62:65], v[138:141], v[202:205], v[62:65]
  ds_read2_b64 v[218:221], v108 offset0:12 offset1:16
  s_waitcnt lgkmcnt(3)
  v_mfma_f32_16x16x32_bf16 v[62:65], v[142:145], v[206:209], v[62:65]
  ds_read2_b64 v[222:225], v108 offset0:24 offset1:28
  s_waitcnt lgkmcnt(3)
  v_mfma_f32_16x16x32_bf16 v[62:65], v[146:149], v[210:213], v[62:65]
  s_waitcnt vmcnt(4)
  ds_read2_b64 v[226:229], v108 offset0:36 offset1:40
  v_mfma_f32_16x16x32_bf16 v[66:69], v[98:101], v[190:193], v[66:69]
  v_mfma_f32_16x16x32_bf16 v[66:69], v[150:153], v[194:197], v[66:69]
  ds_read2_b64 v[230:233], v108 offset0:8 offset1:20
  v_cvt_pk_bf16_f32 v234, v62, v63
  v_mfma_f32_16x16x32_bf16 v[66:69], v[154:157], v[198:201], v[66:69]
  v_cvt_pk_bf16_f32 v235, v64, v65
  v_mfma_f32_16x16x32_bf16 v[66:69], v[158:161], v[202:205], v[66:69]
  ds_read2_b64 v[238:241], v108 offset0:32 offset1:44
  v_mfma_f32_16x16x32_bf16 v[66:69], v[162:165], v[206:209], v[66:69]
  v_mfma_f32_16x16x32_bf16 v[66:69], v[166:169], v[210:213], v[66:69]
  s_waitcnt vmcnt(3)
  v_mfma_f32_16x16x32_bf16 v[70:73], v[102:105], v[190:193], v[70:73]
  v_mfma_f32_16x16x32_bf16 v[70:73], v[170:173], v[194:197], v[70:73]
  v_cvt_pk_bf16_f32 v236, v66, v67
  v_cvt_pk_bf16_f32 v237, v68, v69
  v_mfma_f32_16x16x32_bf16 v[70:73], v[174:177], v[198:201], v[70:73]
  v_permlane16_swap_b32 v234, v236
  v_mfma_f32_16x16x32_bf16 v[70:73], v[178:181], v[202:205], v[70:73]
  v_permlane16_swap_b32 v235, v237
  v_mfma_f32_16x16x32_bf16 v[70:73], v[182:185], v[206:209], v[70:73]
  buffer_store_dwordx4 v[234:237], v126, s[8:11], 0 offen
  v_mfma_f32_16x16x32_bf16 v[70:73], v[186:189], v[210:213], v[70:73]
  s_waitcnt vmcnt(3) lgkmcnt(5)
  v_mfma_f32_16x16x32_bf16 v[74:77], a[250:253], v[214:217], v[74:77]
  s_waitcnt lgkmcnt(4)
  v_mfma_f32_16x16x32_bf16 v[74:77], v[130:133], v[218:221], v[74:77]
  s_waitcnt lgkmcnt(3)
  v_cvt_pk_bf16_f32 v130, v70, v71
  v_cvt_pk_bf16_f32 v131, v72, v73
  v_mfma_f32_16x16x32_bf16 v[74:77], v[134:137], v[222:225], v[74:77]
  s_waitcnt lgkmcnt(2)
  v_mfma_f32_16x16x32_bf16 v[74:77], v[138:141], v[226:229], v[74:77]
  s_waitcnt lgkmcnt(1)
  v_mfma_f32_16x16x32_bf16 v[74:77], v[142:145], v[230:233], v[74:77]
  s_waitcnt lgkmcnt(0)
  v_mfma_f32_16x16x32_bf16 v[74:77], v[146:149], v[238:241], v[74:77]
  s_waitcnt vmcnt(2)
  v_mfma_f32_16x16x32_bf16 v[78:81], v[98:101], v[214:217], v[78:81]
  v_mfma_f32_16x16x32_bf16 v[78:81], v[150:153], v[218:221], v[78:81]
  v_cvt_pk_bf16_f32 v150, v74, v75
  v_cvt_pk_bf16_f32 v151, v76, v77
  v_mfma_f32_16x16x32_bf16 v[78:81], v[154:157], v[222:225], v[78:81]
  v_mfma_f32_16x16x32_bf16 v[78:81], v[158:161], v[226:229], v[78:81]
  v_mfma_f32_16x16x32_bf16 v[78:81], v[162:165], v[230:233], v[78:81]
  v_mfma_f32_16x16x32_bf16 v[78:81], v[166:169], v[238:241], v[78:81]
  s_waitcnt vmcnt(1)
  v_mfma_f32_16x16x32_bf16 v[82:85], v[102:105], v[214:217], v[82:85]
  v_mfma_f32_16x16x32_bf16 v[82:85], v[170:173], v[218:221], v[82:85]
  v_cvt_pk_bf16_f32 v152, v78, v79
  v_cvt_pk_bf16_f32 v153, v80, v81
  v_mfma_f32_16x16x32_bf16 v[82:85], v[174:177], v[222:225], v[82:85]
  v_permlane16_swap_b32 v150, v152
  v_mfma_f32_16x16x32_bf16 v[82:85], v[178:181], v[226:229], v[82:85]
  v_permlane16_swap_b32 v151, v153
  v_mfma_f32_16x16x32_bf16 v[82:85], v[182:185], v[230:233], v[82:85]
  buffer_store_dwordx4 v[150:153], v127, s[8:11], 0 offen
  v_mfma_f32_16x16x32_bf16 v[82:85], v[186:189], v[238:241], v[82:85]
  s_nop 7
  v_cvt_pk_bf16_f32 v132, v82, v83
  v_cvt_pk_bf16_f32 v133, v84, v85
  s_nop 0
  v_permlane16_swap_b32 v130, v132
  v_permlane16_swap_b32 v131, v133
  buffer_store_dwordx4 v[130:133], v128, s[8:11], 0 offen
L_exit:
  s_endpgm
.section .rodata,"a"
.p2align 6
.amdhsa_kernel standalone__window_attn_davit__vision_kernel
  .amdhsa_next_free_vgpr 512
  .amdhsa_next_free_sgpr 102
  .amdhsa_accum_offset 256
  .amdhsa_group_segment_fixed_size 0
  .amdhsa_kernarg_size 56
  .amdhsa_user_sgpr_count 2
  .amdhsa_user_sgpr_kernarg_segment_ptr 1
  .amdhsa_system_sgpr_workgroup_id_x 1
.end_amdhsa_kernel
```

```asm
; @launch grid=(256,1,1) block=(256,1,1) lds=163840
.amdgcn_target "amdgcn-amd-amdhsa--gfx950"
.text
.globl standalone__window_attn_davit__vision_kernel
.p2align 8
.type standalone__window_attn_davit__vision_kernel,@function
standalone__window_attn_davit__vision_kernel:
  s_cmp_ge_u32 s2, 256
  s_cbranch_scc1 L_exit
  s_load_dwordx8 s[36:43], s[0:1], 0
  s_load_dwordx2 s[44:45], s[0:1], 32
  s_load_dwordx2 s[46:47], s[0:1], 48
  v_lshrrev_b32 v1, 6, v0
  s_and_b32 s60, s2, 7
  s_lshr_b32 s30, s2, 3
  v_readfirstlane_b32 s28, v1
  v_and_b32 v220, 63, v0
  s_mul_i32 s29, s60, 667
  s_add_u32 s29, s29, s30
  s_mov_b32 s72, 667
  s_mov_b32 s73, 5329
  s_mul_i32 s74, s28, 96
  s_mul_i32 s81, s28, 27648
  s_add_u32 s81, s81, 20992
  s_lshl_b32 s76, s28, 10
  v_add_u32 v223, 0, v220
  v_lshlrev_b32 v223, 5, v223
  v_add_u32 v224, s30, v223
  v_cmp_gt_u32 s[60:61], s72, v224
  v_add_u32 v223, s29, v223
  v_cmp_gt_u32 s[62:63], s73, v223
  v_mul_u32_u24 v224, 7183, v223
  v_lshrrev_b32 v224, 22, v224
  s_and_b64 s[60:61], s[60:61], s[62:63]
  v_mul_u32_u24 v225, 584, v224
  v_sub_u32 v225, v223, v225
  v_cmp_le_u32 vcc, 5256, v223
  v_and_b32 v227, 7, v225
  v_lshl_add_u32 v224, v224, 3, v227
  v_mov_b32 v227, 72
  v_cndmask_b32 v224, v224, v227, vcc
  v_lshrrev_b32 v227, 3, v225
  v_cndmask_b32 v225, v227, v225, vcc
  v_mul_u32_u24 v224, 1373568, v224
  v_mul_u32_u24 v225, 2688, v225
  v_add_u32 v227, v224, v225
  v_cndmask_b32 v227, 2.0, v227, s[60:61]
  v_mul_u32_u24 v223, 43, v220
  v_lshrrev_b32 v223, 8, v223
  v_mul_u32_u24 v224, 6, v223
  v_sub_u32 v224, v220, v224
  v_lshl_add_u32 v224, v224, 4, s74
  v_cmp_gt_u32 vcc, 54, v220
  v_mul_u32_u24 v225, 384, v223
  v_add_u32 v224, v224, v225
  v_cndmask_b32 v21, 2.0, v224, vcc
  v_mul_u32_u24 v223, 11, v223
  v_lshrrev_b32 v223, 5, v223
  v_mul_u32_u24 v223, 195072, v223
  v_add_u32 v224, 589824, v224
  v_add_u32 v224, v224, v223
  v_cndmask_b32 v242, 2.0, v224, vcc
  v_readlane_b32 s60, v227, 0
  v_readlane_b32 s61, v227, 1
  v_readlane_b32 s62, v227, 2
  v_lshlrev_b32 v223, 6, v220
  v_cmp_gt_u32 vcc, 27, v220
  s_lshl_b32 s69, s30, 2
  s_add_u32 s69, s69, s28
  v_cndmask_b32 v224, 2.0, v223, vcc
  v_cmp_gt_u32 vcc, 9, v220
  s_mul_i32 s70, s69, 1728
  s_mul_i32 s71, s69, 576
  v_cndmask_b32 v225, 2.0, v223, vcc
  s_waitcnt lgkmcnt(0)
  s_mov_b32 s16, s40
  s_mov_b32 s17, s41
  s_mov_b32 s18, 221184
  s_mov_b32 s19, 0x20000
  buffer_load_dword v232, v224, s[16:19], s70 offen
  s_mov_b32 s24, s38
  s_mov_b32 s25, s39
  s_mov_b32 s26, 3456
  s_mov_b32 s27, 0x20000
  s_add_u32 m0, s76, 8192
  s_sub_u32 s4, s36, 196608
  s_subb_u32 s5, s37, 0
  s_mov_b32 s6, 100467072
  s_mov_b32 s7, 0x20000
  buffer_load_dwordx4 v21, s[24:27], 0 offen lds
  s_add_u32 m0, s81, 9216
  s_nop 0
  buffer_load_dwordx4 v242, s[4:7], s60 offen lds
  s_add_u32 m0, s81, 10080
  s_nop 0
  buffer_load_dwordx4 v242, s[4:7], s61 offen lds
  s_add_u32 m0, s81, 10944
  s_nop 0
  buffer_load_dwordx4 v242, s[4:7], s62 offen lds
  s_mov_b32 s20, s42
  s_mov_b32 s21, s43
  s_mov_b32 s22, 73728
  s_mov_b32 s23, 0x20000
  buffer_load_dword v233, v225, s[20:23], s71 offen
  s_getpc_b64 s[0:1]
  L_pc:
  s_lshl_b32 s69, s69, 7
  s_add_u32 s62, s0, s69
  s_addc_u32 s63, s1, 0
  v_min_u32 v224, 1, v220
  v_lshlrev_b32 v224, 6, v224
  global_load_dword v234, v224, s[62:63]
  v_readlane_b32 s63, v227, 3
  v_readlane_b32 s64, v227, 4
  v_readlane_b32 s65, v227, 5
  v_readlane_b32 s66, v227, 6
  v_readlane_b32 s67, v227, 7
  v_readlane_b32 s68, v227, 8
  s_mov_b32 s8, s44
  s_mov_b32 s9, s45
  s_mov_b32 s10, 100270464
  s_mov_b32 s11, 0x20000
  s_mov_b32 s12, s46
  s_mov_b32 s13, s47
  s_mov_b32 s14, 16777216
  s_mov_b32 s15, 0x20000
  s_mov_b32 s24, s36
  s_mov_b32 s25, s37
  s_mov_b32 s26, 100270464
  s_add_u32 m0, s81, 11808
  s_nop 0
  buffer_load_dwordx4 v242, s[4:7], s63 offen lds
  s_add_u32 m0, s81, 12672
  s_nop 0
  buffer_load_dwordx4 v242, s[4:7], s64 offen lds
  s_add_u32 m0, s81, 13536
  s_nop 0
  buffer_load_dwordx4 v242, s[4:7], s65 offen lds
  s_add_u32 m0, s81, 14400
  s_nop 0
  buffer_load_dwordx4 v242, s[4:7], s66 offen lds
  s_add_u32 m0, s81, 15264
  s_nop 0
  buffer_load_dwordx4 v242, s[4:7], s67 offen lds
  s_add_u32 m0, s81, 16128
  s_nop 0
  buffer_load_dwordx4 v242, s[4:7], s68 offen lds
  v_readlane_b32 s36, v227, 9
  v_readlane_b32 s37, v227, 10
  v_readlane_b32 s38, v227, 11
  v_readlane_b32 s39, v227, 12
  v_readlane_b32 s40, v227, 13
  v_readlane_b32 s41, v227, 14
  v_readlane_b32 s42, v227, 15
  v_readlane_b32 s43, v227, 16
  v_readlane_b32 s44, v227, 17
  v_readlane_b32 s45, v227, 18
  v_readlane_b32 s46, v227, 19
  v_readlane_b32 s47, v227, 20
  v_add_u32 v223, 0, v220
  v_mul_u32_u24 v224, 171, v223
  v_lshrrev_b32 v224, 10, v224
  v_mul_u32_u24 v225, 6, v224
  v_sub_u32 v225, v223, v225
  v_lshl_add_u32 v225, v225, 4, s74
  v_subrev_u32 v225, 0, v225
  v_mul_u32_u24 v223, 1152, v224
  v_add_u32 v243, v223, v225
  v_mul_u32_u24 v223, 384, v224
  v_add_u32 v251, v223, v225
  v_add_u32 v223, 64, v220
  v_mul_u32_u24 v224, 171, v223
  v_lshrrev_b32 v224, 10, v224
  v_mul_u32_u24 v225, 6, v224
  v_sub_u32 v225, v223, v225
  v_lshl_add_u32 v225, v225, 4, s74
  v_subrev_u32 v225, 1024, v225
  v_mul_u32_u24 v223, 1152, v224
  v_add_u32 v244, v223, v225
  v_mul_u32_u24 v223, 384, v224
  v_add_u32 v252, v223, v225
  v_add_u32 v223, 128, v220
  v_mul_u32_u24 v224, 171, v223
  v_lshrrev_b32 v224, 10, v224
  v_mul_u32_u24 v225, 6, v224
  v_sub_u32 v225, v223, v225
  v_lshl_add_u32 v225, v225, 4, s74
  v_subrev_u32 v225, 2048, v225
  v_mul_u32_u24 v223, 1152, v224
  v_add_u32 v245, v223, v225
  v_mul_u32_u24 v223, 384, v224
  v_add_u32 v253, v223, v225
  s_mov_b64 s[48:49], 0x3f
  s_mov_b32 s50, 0
  s_mov_b32 s51, 0x3f0000
  s_mov_b32 s54, 0xffff
  s_mov_b32 s55, 0
  s_mov_b32 s56, -1
  s_mov_b32 s57, 0
  s_mul_i32 s58, s28, 7936
  s_add_u32 s58, s58, 131968
  s_add_u32 s59, s58, 4320
  s_mul_i32 s75, s2, 65536
  s_mul_i32 s77, s28, 12288
  s_add_u32 s75, s75, s77
  s_add_u32 s77, s75, 4096
  s_add_u32 s78, s75, 8192
  s_mov_b32 s31, 0
  s_mov_b32 s79, 0x4310
  s_mov_b32 s80, 0x5276
  v_lshrrev_b32 v221, 4, v220
  v_and_b32 v222, 15, v220
  v_and_b32 v223, 3, v220
  v_mul_u32_u24 v0, 0x5555, v223
  v_mov_b32 v1, 0
  v_mov_b32 v223, 0xff800000
  v_cndmask_b32 v2, v223, 0, s[54:55]
  v_mov_b32 v123, 0
  v_mov_b32 v127, 0
  v_lshrrev_b32 v219, 1, v221
  v_and_b32 v226, 1, v221
  v_cmp_eq_u32 s[94:95], 1, v226
  v_lshlrev_b32 v226, 4, v226
  v_lshlrev_b32 v218, 4, v219
  v_lshl_add_u32 v218, v226, 1, v218
  v_add_u32 v218, s74, v218
  v_mov_b32 v223, 0x03020100
  v_cmp_le_u32 vcc, 4, v222
  v_mov_b32 v224, 0x13121110
  s_nop 0
  v_cndmask_b32 v223, v223, v224, vcc
  v_cmp_le_u32 vcc, 8, v222
  v_mov_b32 v224, 0x26251514
  s_nop 0
  v_cndmask_b32 v223, v223, v224, vcc
  v_cmp_le_u32 vcc, 12, v222
  v_mov_b32 v224, 0x16060504
  s_nop 0
  v_cndmask_b32 v223, v223, v224, vcc
  v_and_b32 v224, 3, v222
  v_lshlrev_b32 v224, 3, v224
  v_bfe_u32 v223, v223, v224, 8
  s_add_u32 m0, s81, 16992
  s_nop 0
  buffer_load_dwordx4 v242, s[4:7], s36 offen lds
  v_lshrrev_b32 v224, 4, v223
  v_and_b32 v223, 15, v223
  v_mul_u32_u24 v12, 196224, v224
  v_mul_u32_u24 v225, 384, v223
  v_add3_u32 v12, v12, v225, v218
  v_mul_u32_u24 v224, 9, v224
  v_add_u32 v223, v223, v224
  v_mul_u32_u24 v223, 96, v223
  v_add_u32 v223, s58, v223
  v_mul_u32_u24 v224, 96, v219
  v_add3_u32 v3, v223, v224, v226
  v_mul_u32_u24 v224, 864, v219
  v_add3_u32 v6, v223, v224, v226
  v_add_u32 v6, 192, v6
  v_lshl_add_u32 v9, v221, 3, v223
  v_add_u32 v9, 1920, v9
  v_mov_b32 v223, 0x23222120
  v_cmp_le_u32 vcc, 4, v222
  v_mov_b32 v224, 0x42323130
  s_nop 0
  v_cndmask_b32 v223, v223, v224, vcc
  v_cmp_le_u32 vcc, 8, v222
  v_mov_b32 v224, 0x46454443
  s_nop 0
  v_cndmask_b32 v223, v223, v224, vcc
  v_cmp_le_u32 vcc, 12, v222
  v_mov_b32 v224, 0x36353424
  s_nop 0
  v_cndmask_b32 v223, v223, v224, vcc
  v_and_b32 v224, 3, v222
  v_lshlrev_b32 v224, 3, v224
  v_bfe_u32 v223, v223, v224, 8
  v_lshrrev_b32 v224, 4, v223
  s_add_u32 m0, s81, 17856
  s_nop 0
  buffer_load_dwordx4 v242, s[4:7], s37 offen lds
  v_and_b32 v223, 15, v223
  v_mul_u32_u24 v13, 196224, v224
  v_mul_u32_u24 v225, 384, v223
  v_add3_u32 v13, v13, v225, v218
  v_mul_u32_u24 v224, 9, v224
  v_add_u32 v223, v223, v224
  v_mul_u32_u24 v223, 96, v223
  v_add_u32 v223, s58, v223
  v_mul_u32_u24 v224, 96, v219
  v_add3_u32 v4, v223, v224, v226
  v_mul_u32_u24 v224, 864, v219
  v_add3_u32 v7, v223, v224, v226
  v_add_u32 v7, 192, v7
  v_lshl_add_u32 v10, v221, 3, v223
  v_add_u32 v10, 1920, v10
  v_mov_b32 v223, 0x52514140
  v_cmp_le_u32 vcc, 4, v222
  v_mov_b32 v224, 0x62616050
  s_nop 0
  v_cndmask_b32 v223, v223, v224, vcc
  v_cmp_le_u32 vcc, 8, v222
  v_mov_b32 v224, 0x66656463
  s_nop 0
  v_cndmask_b32 v223, v223, v224, vcc
  v_cmp_le_u32 vcc, 12, v222
  v_mov_b32 v224, 0x56555453
  s_nop 0
  v_cndmask_b32 v223, v223, v224, vcc
  v_and_b32 v224, 3, v222
  v_lshlrev_b32 v224, 3, v224
  v_bfe_u32 v223, v223, v224, 8
  s_add_u32 m0, s81, 18720
  s_nop 0
  buffer_load_dwordx4 v242, s[4:7], s38 offen lds
  v_lshrrev_b32 v224, 4, v223
  v_and_b32 v223, 15, v223
  v_mul_u32_u24 v14, 196224, v224
  v_mul_u32_u24 v225, 384, v223
  v_add3_u32 v23, v14, v225, s74
  v_lshl_add_u32 v23, v221, 3, v23
  v_add_u32 v23, 64, v23
  v_add3_u32 v14, v14, v225, v218
  v_mul_u32_u24 v224, 9, v224
  v_add_u32 v223, v223, v224
  v_mul_u32_u24 v223, 96, v223
  v_add_u32 v223, s58, v223
  v_mul_u32_u24 v224, 96, v219
  v_add3_u32 v5, v223, v224, v226
  v_mul_u32_u24 v224, 864, v219
  v_add3_u32 v8, v223, v224, v226
  v_add_u32 v8, 192, v8
  v_lshl_add_u32 v11, v221, 3, v223
  v_add_u32 v11, 1920, v11
  v_add_u32 v223, 64, v12
  v_add_u32 v224, 32, v13
  v_cndmask_b32 v22, v223, v224, s[94:95]
  v_lshlrev_b32 v15, 4, v220
  v_add_u32 v16, s76, v15
  s_lshr_b32 s60, s28, 1
  s_add_u32 s60, s60, 4
  s_lshl_b32 s60, s60, 10
  s_and_b32 s61, s28, 1
  s_lshl_b32 s61, s61, 3
  s_add_u32 m0, s81, 19584
  s_nop 0
  buffer_load_dwordx4 v242, s[4:7], s39 offen lds
  s_add_u32 s60, s60, s61
  v_add_u32 v17, s60, v15
  s_mul_i32 s60, s28, 15360
  s_add_u32 s60, s60, 63280
  v_add_u32 v18, s60, v15
  v_add_u32 v223, v226, v222
  v_lshlrev_b32 v224, 10, v219
  v_lshl_add_u32 v111, v223, 4, v224
  s_lshl_b32 s60, s28, 2
  v_add_u32 v111, s60, v111
  v_lshlrev_b32 v115, 3, v220
  v_add_u32 v115, 125232, v115
  v_lshlrev_b32 v119, 3, v222
  v_add_u32 v119, 125232, v119
  v_and_b32 v224, 3, v222
  v_cmp_eq_u32 vcc, 0, v224
  v_mov_b32 v223, 0x3f803f80
  s_nop 0
  v_cndmask_b32 v223, 0, v223, vcc
  v_accvgpr_write_b32 a246, v223
  v_accvgpr_write_b32 a247, v223
  v_accvgpr_write_b32 a248, v223
  v_accvgpr_write_b32 a249, v223
  s_add_u32 s60, s74, 38912
  v_mul_u32_u24 v223, 24, v221
  v_add_u32 v19, s60, v223
  v_min_u32 v223, 2, v221
  v_lshl_add_u32 v223, v223, 4, v222
  s_add_u32 m0, s81, 20448
  s_nop 0
  buffer_load_dwordx4 v242, s[4:7], s40 offen lds
  s_add_u32 s60, s60, 384
  v_lshl_add_u32 v20, v223, 1, s60
  v_cmp_gt_u32 vcc, 5, v222
  v_mul_u32_u24 v223, 1160, v222
  v_add_u32 v249, v19, v223
  v_lshl_add_u32 v223, v221, 3, v223
  v_add_u32 v247, s60, v223
  v_mov_b32 v224, 0x30000
  v_add_u32 v225, 18560, v249
  v_cndmask_b32 v250, v224, v225, vcc
  v_add_u32 v225, 18560, v247
  v_cndmask_b32 v248, v224, v225, vcc
  s_lshl_b32 s60, s28, 7
  s_add_u32 s60, s60, 124720
  v_lshl_add_u32 v27, v221, 5, s60
  v_lshrrev_b32 v223, 2, v222
  v_lshlrev_b32 v223, 5, v223
  v_lshl_add_u32 v223, v221, 3, v223
  v_and_b32 v224, 3, v222
  v_lshl_add_u32 v223, v224, 1, v223
  s_sub_u32 s60, s60, 8
  v_add_u32 v223, s60, v223
  v_mov_b32 v224, 0x30000
  v_cndmask_b32 v26, v223, v224, s[54:55]
  v_mul_u32_u24 v223, 864, v222
  s_add_u32 s60, s81, 9216
  v_add_u32 v223, s60, v223
  s_add_u32 m0, s81, 21312
  s_nop 0
  buffer_load_dwordx4 v242, s[4:7], s41 offen lds
  v_mul_u32_u24 v224, 96, v219
  v_add3_u32 v239, v223, v224, v226
  v_mul_u32_u24 v224, 288, v219
  v_add3_u32 v240, v223, v224, v226
  v_add_u32 v240, 192, v240
  v_lshl_add_u32 v241, v221, 3, v223
  v_add_u32 v241, 768, v241
  s_add_u32 s60, s76, 8192
  v_lshl_add_u32 v223, v222, 1, s60
  v_lshlrev_b32 v224, 2, v221
  v_lshrrev_b32 v225, v224, s79
  v_and_b32 v225, 15, v225
  v_mul_u32_u24 v225, 96, v225
  v_add_u32 v236, v223, v225
  v_lshrrev_b32 v225, v224, s80
  v_and_b32 v225, 15, v225
  v_mul_u32_u24 v225, 96, v225
  v_add_u32 v237, v223, v225
  v_add_u32 v238, 768, v223
  v_lshrrev_b32 v223, 2, v220
  v_mul_u32_u24 v223, 96, v223
  v_and_b32 v224, 3, v220
  v_lshl_add_u32 v223, v224, 3, v223
  v_add_u32 v246, s81, v223
  s_mul_i32 s70, s28, 15360
  s_add_u32 s70, s70, 63280
  s_add_u32 m0, s81, 22176
  s_nop 0
  buffer_load_dwordx4 v242, s[4:7], s42 offen lds
  v_add_u32 v255, s70, v223
  s_mul_i32 s71, s28, 3072
  s_add_u32 s71, s71, 20480
  v_add_u32 v254, s71, v223
  s_mul_i32 s60, s28, 61
  v_add_u32 v223, s60, v220
  v_mul_u32_u24 v224, 2428, v223
  v_lshrrev_b32 v224, 16, v224
  v_mul_u32_u24 v224, 192768, v224
  v_lshl_add_u32 v224, v223, 7, v224
  v_cmp_gt_u32 vcc, 61, v220
  s_nop 1
  v_cndmask_b32 v224, 2.0, v224, vcc
  v_cmp_gt_u32 vcc, 243, v223
  s_nop 1
  v_cndmask_b32 v24, 2.0, v224, vcc
  v_add_u32 v223, 0, v222
  v_lshlrev_b32 v223, 5, v223
  v_add_u32 v224, s30, v223
  v_cmp_gt_u32 s[60:61], s72, v224
  v_add_u32 v223, s29, v223
  v_cmp_gt_u32 s[62:63], s73, v223
  v_mul_u32_u24 v224, 7183, v223
  v_lshrrev_b32 v224, 22, v224
  s_and_b64 s[60:61], s[60:61], s[62:63]
  v_mul_u32_u24 v225, 584, v224
  v_sub_u32 v225, v223, v225
  v_cmp_le_u32 vcc, 5256, v223
  s_add_u32 m0, s81, 23040
  s_nop 0
  buffer_load_dwordx4 v242, s[4:7], s43 offen lds
  v_and_b32 v228, 7, v225
  v_lshl_add_u32 v224, v224, 3, v228
  v_mov_b32 v228, 72
  v_cndmask_b32 v224, v224, v228, vcc
  v_lshrrev_b32 v228, 3, v225
  v_cndmask_b32 v225, v228, v225, vcc
  v_mul_u32_u24 v224, 1373568, v224
  v_mul_u32_u24 v225, 2688, v225
  v_add_u32 v228, v224, v225
  v_cndmask_b32 v228, 2.0, v228, s[60:61]
  v_add_u32 v228, 589824, v228
  v_add_u32 v228, v218, v228
  v_add_u32 v223, 16, v222
  v_lshlrev_b32 v223, 5, v223
  v_add_u32 v224, s30, v223
  v_cmp_gt_u32 s[60:61], s72, v224
  v_add_u32 v223, s29, v223
  v_cmp_gt_u32 s[62:63], s73, v223
  v_mul_u32_u24 v224, 7183, v223
  v_lshrrev_b32 v224, 22, v224
  s_and_b64 s[60:61], s[60:61], s[62:63]
  v_mul_u32_u24 v225, 584, v224
  v_sub_u32 v225, v223, v225
  v_cmp_le_u32 vcc, 5256, v223
  v_and_b32 v229, 7, v225
  s_add_u32 m0, s81, 23904
  s_nop 0
  buffer_load_dwordx4 v242, s[4:7], s44 offen lds
  v_lshl_add_u32 v224, v224, 3, v229
  v_mov_b32 v229, 72
  v_cndmask_b32 v224, v224, v229, vcc
  v_lshrrev_b32 v229, 3, v225
  v_cndmask_b32 v225, v229, v225, vcc
  v_mul_u32_u24 v224, 1373568, v224
  v_mul_u32_u24 v225, 2688, v225
  v_add_u32 v229, v224, v225
  v_cndmask_b32 v229, 2.0, v229, s[60:61]
  v_add_u32 v229, 589824, v229
  v_add_u32 v229, v218, v229
  v_add_u32 v223, 64, v228
  v_add_u32 v224, 32, v229
  v_cndmask_b32 v230, v223, v224, s[94:95]
  v_mul_u32_u24 v223, 1160, v222
  v_lshl_add_u32 v223, v221, 3, v223
  v_add_u32 v231, 39680, v223
  v_lshrrev_b32 v223, 2, v222
  v_cmp_eq_u32 s[82:83], 0, v223
  v_cmp_eq_u32 s[84:85], 1, v223
  v_cmp_eq_u32 s[86:87], 2, v223
  v_cmp_eq_u32 s[88:89], 3, v223
  v_cmp_eq_u32 s[90:91], 3, v221
  v_cmp_eq_u32 s[92:93], v223, v221
  v_and_b32 v223, 2, v222
  v_cmp_eq_u32 s[96:97], 0, v223
  v_and_b32 v235, 1, v222
  v_lshlrev_b32 v235, 4, v235
  s_add_u32 m0, s81, 24768
  s_nop 0
  buffer_load_dwordx4 v242, s[4:7], s45 offen lds
  s_add_u32 m0, s81, 25632
  s_waitcnt vmcnt(21)
  ds_read_u16 v126, v238
  ds_read_u16 v110, v238 offset:32
  ds_read_u16 v114, v238 offset:64
  ds_read_u16 v108, v236
  ds_read_u16 v109, v237
  ds_read_u16 v113, v236 offset:32
  ds_read_u16 v112, v237 offset:32
  ds_read_u16 v125, v236 offset:64
  ds_read_u16 v236, v237 offset:64
  v_cndmask_b32 v237, 0, 1.0, s[90:91]
  v_subrev_u32 v238, 121136, v115
  v_subrev_u32 v122, 121136, v119
  v_cndmask_b32 v124, 0, 1.0, s[90:91]
  v_cndmask_b32 v117, 0, 1.0, s[90:91]
  v_subrev_u32 v118, 104752, v115
  s_waitcnt lgkmcnt(8)
  v_lshlrev_b32 v126, v235, v126
  v_cndmask_b32 v126, 0, v126, s[92:93]
  v_cndmask_b32 v116, 0, v126, s[96:97]
  v_cndmask_b32 v121, v126, 0, s[96:97]
  s_waitcnt lgkmcnt(7)
  v_lshlrev_b32 v110, v235, v110
  v_accvgpr_write_b32 a224, v116
  v_accvgpr_write_b32 a225, v121
  v_cndmask_b32 v110, 0, v110, s[92:93]
  v_cndmask_b32 v126, 0, v110, s[96:97]
  v_cndmask_b32 v116, v110, 0, s[96:97]
  s_waitcnt lgkmcnt(6)
  v_lshlrev_b32 v114, v235, v114
  v_accvgpr_write_b32 a234, v126
  v_accvgpr_write_b32 a235, v116
  v_cndmask_b32 v114, 0, v114, s[92:93]
  v_cndmask_b32 v126, 0, v114, s[96:97]
  v_cndmask_b32 v235, v114, 0, s[96:97]
  v_accvgpr_write_b32 a244, v126
  v_accvgpr_write_b32 a245, v235
  s_waitcnt lgkmcnt(5)
  v_or_b32 v108, v108, v237
  v_cndmask_b32 v126, 0, v108, s[82:83]
  v_cndmask_b32 v235, 0, v108, s[84:85]
  v_cndmask_b32 v114, 0, v108, s[86:87]
  v_cndmask_b32 v237, 0, v108, s[88:89]
  v_accvgpr_write_b32 a216, v126
  v_accvgpr_write_b32 a217, v235
  v_accvgpr_write_b32 a218, v114
  v_accvgpr_write_b32 a219, v237
  s_waitcnt lgkmcnt(4)
  v_cndmask_b32 v126, 0, v109, s[82:83]
  v_cndmask_b32 v235, 0, v109, s[84:85]
  v_cndmask_b32 v237, 0, v109, s[86:87]
  v_cndmask_b32 v108, 0, v109, s[88:89]
  v_accvgpr_write_b32 a220, v126
  v_accvgpr_write_b32 a221, v235
  v_accvgpr_write_b32 a222, v237
  v_accvgpr_write_b32 a223, v108
  s_waitcnt lgkmcnt(3)
  v_or_b32 v113, v113, v124
  v_cndmask_b32 v126, 0, v113, s[82:83]
  v_cndmask_b32 v235, 0, v113, s[84:85]
  v_cndmask_b32 v124, 0, v113, s[86:87]
  v_cndmask_b32 v114, 0, v113, s[88:89]
  v_accvgpr_write_b32 a226, v126
  v_accvgpr_write_b32 a227, v235
  v_accvgpr_write_b32 a228, v124
  v_accvgpr_write_b32 a229, v114
  s_waitcnt lgkmcnt(2)
  v_cndmask_b32 v126, 0, v112, s[82:83]
  v_cndmask_b32 v235, 0, v112, s[84:85]
  v_cndmask_b32 v124, 0, v112, s[86:87]
  v_cndmask_b32 v113, 0, v112, s[88:89]
  v_accvgpr_write_b32 a230, v126
  buffer_load_dwordx4 v242, s[4:7], s46 offen lds
  s_add_u32 m0, s81, 26496
  v_accvgpr_write_b32 a231, v235
  v_accvgpr_write_b32 a232, v124
  v_accvgpr_write_b32 a233, v113
  s_waitcnt lgkmcnt(1)
  v_or_b32 v125, v125, v117
  v_cndmask_b32 v126, 0, v125, s[82:83]
  v_cndmask_b32 v235, 0, v125, s[84:85]
  v_cndmask_b32 v124, 0, v125, s[86:87]
  v_cndmask_b32 v114, 0, v125, s[88:89]
  v_accvgpr_write_b32 a236, v126
  v_accvgpr_write_b32 a237, v235
  v_accvgpr_write_b32 a238, v124
  v_accvgpr_write_b32 a239, v114
  s_waitcnt lgkmcnt(0)
  v_cndmask_b32 v126, 0, v236, s[82:83]
  v_cndmask_b32 v235, 0, v236, s[84:85]
  v_cndmask_b32 v114, 0, v236, s[86:87]
  v_cndmask_b32 v237, 0, v236, s[88:89]
  v_accvgpr_write_b32 a240, v126
  v_accvgpr_write_b32 a241, v235
  v_accvgpr_write_b32 a242, v114
  v_accvgpr_write_b32 a243, v237
  v_subrev_u32 v126, 104752, v119
  v_and_b32 v169, 64, v15
  buffer_store_dwordx4 v[228:231], v15, s[12:15], s77 offen offset:2048
  s_waitcnt vmcnt(18)
  v_mov_b32 v232, 0
  v_mov_b32 v233, 0
  v_mov_b32 v234, 0
  buffer_load_dwordx4 v242, s[4:7], s47 offen lds
  s_lshl_b32 s60, s31, 5
  s_add_u32 s61, s60, s30
  s_add_u32 s60, s60, s29
  s_mul_i32 s62, s60, 7183
  s_lshr_b32 s62, s62, 22
  s_mul_i32 s63, s62, 584
  s_sub_u32 s63, s60, s63
  s_lshr_b32 s64, s63, 3
  s_and_b32 s65, s63, 7
  s_lshl_b32 s66, s62, 3
  s_add_u32 s65, s65, s66
  s_cmp_ge_u32 s60, 5256
  s_cselect_b32 s64, s63, s64
  s_cselect_b32 s65, 72, s65
  s_mul_i32 s66, s65, 1373568
  s_mul_i32 s67, s64, 2688
  s_add_u32 s35, s66, s67
  s_cmp_ge_u32 s61, 667
  s_cselect_b32 s35, 268435456, s35
  s_cmp_ge_u32 s60, 5329
  s_cselect_b32 s35, 268435456, s35
  s_cmp_eq_u32 s65, 0
  s_cselect_b32 s36, 268435456, s35
  s_add_u32 s37, s35, 195360
  s_add_u32 s38, s35, 390720
  s_add_u32 s39, s35, 586080
  s_add_u32 s40, s35, 781440
  s_add_u32 s41, s35, 981120
  s_add_u32 s42, s35, 1176480
  s_add_u32 s43, s35, 1371840
  s_add_u32 s44, s35, 1567200
  s_cmp_eq_u32 s64, 0
  s_cselect_b64 s[52:53], s[48:49], 0
  s_cmp_eq_u32 s64, 72
  s_cselect_b64 s[52:53], s[50:51], s[52:53]
  s_add_u32 s31, s31, 1
  s_mov_b32 s33, s35
  v_cndmask_b32 v114, v21, 2.0, s[52:53]
  s_mov_b32 m0, s58
  s_nop 0
  buffer_load_dwordx4 v114, s[4:7], s36 offen lds
  s_mov_b32 m0, s58
  s_nop 0
  buffer_load_dwordx4 v114, s[4:7], s37 offen offset:864 lds
  s_mov_b32 m0, s58
  s_nop 0
  buffer_load_dwordx4 v114, s[4:7], s38 offen offset:1728 lds
  s_mov_b32 m0, s58
  s_nop 0
  buffer_load_dwordx4 v114, s[4:7], s39 offen offset:2592 lds
  s_waitcnt vmcnt(10)
  ds_read_b64 v[236:237], v241
  ds_read_b128 v[228:231], v239
  s_mov_b32 m0, s58
  ds_read_b128 v[232:235], v239 offset:288
  ds_read_b128 v[204:207], v239 offset:576
  ds_read_b128 v[208:211], v240
  ds_read_b64 v[124:125], v241 offset:32
  ds_read_b128 v[140:143], v239 offset:32
  s_waitcnt lgkmcnt(6)
  v_mfma_f32_16x16x16_bf16 v[64:67], a[224:225], v[236:237], 0
  ds_read_b128 v[144:147], v239 offset:320
  ds_read_b128 v[220:223], v239 offset:608
  ds_read_b128 v[224:227], v240 offset:32
  ds_read_b64 v[236:237], v241 offset:64
  ds_read_b128 v[172:175], v239 offset:64
  s_waitcnt lgkmcnt(6)
  v_mfma_f32_16x16x16_bf16 v[68:71], a[234:235], v[124:125], 0
  ds_read_b128 v[176:179], v239 offset:352
  ds_read_b128 v[128:131], v239 offset:640
  ds_read_b128 v[132:135], v240 offset:64
  s_waitcnt lgkmcnt(4)
  v_mfma_f32_16x16x16_bf16 v[72:75], a[244:245], v[236:237], 0
  v_smfmac_f32_16x16x64_bf16 v[64:67], a[216:219], v[228:235], v0
  v_smfmac_f32_16x16x64_bf16 v[64:67], a[220:223], v[204:211], v0
  v_smfmac_f32_16x16x64_bf16 v[68:71], a[226:229], v[140:147], v0
  v_smfmac_f32_16x16x64_bf16 v[68:71], a[230:233], v[220:227], v0
  s_waitcnt lgkmcnt(2)
  buffer_load_dwordx4 v114, s[4:7], s40 offen offset:3456 lds
  v_smfmac_f32_16x16x64_bf16 v[72:75], a[236:239], v[172:179], v0
  s_waitcnt lgkmcnt(0)
  v_mul_f32 v242, v64, v64
  v_smfmac_f32_16x16x64_bf16 v[72:75], a[240:243], v[128:135], v0
  s_mov_b32 m0, s59
  v_add_f32 v110, v64, v65
  v_fmac_f32 v242, v65, v65
  v_add_f32 v110, v110, v66
  v_fmac_f32 v242, v66, v66
  v_add_f32 v110, v110, v67
  v_fmac_f32 v242, v67, v67
  v_add_f32 v110, v110, v68
  v_fmac_f32 v242, v68, v68
  v_add_f32 v110, v110, v69
  v_fmac_f32 v242, v69, v69
  v_add_f32 v110, v110, v70
  v_fmac_f32 v242, v70, v70
  v_add_f32 v110, v110, v71
  v_fmac_f32 v242, v71, v71
  v_add_f32 v110, v110, v72
  v_fmac_f32 v242, v72, v72
  v_add_f32 v110, v110, v73
  v_fmac_f32 v242, v73, v73
  v_add_f32 v110, v110, v74
  v_fmac_f32 v242, v74, v74
  v_add_f32 v110, v110, v75
  v_fmac_f32 v242, v75, v75
  s_nop 1
  v_permlane32_swap_b32 v110, v242
  v_add_f32 v110, v110, v242
  buffer_store_dwordx4 v[64:67], v15, s[12:15], s75 offen
  buffer_store_dwordx4 v[68:71], v15, s[12:15], s75 offen offset:1024
  buffer_load_dwordx4 v114, s[4:7], s41 offen lds
  s_mov_b32 m0, s59
  buffer_store_dwordx4 v[72:75], v15, s[12:15], s75 offen offset:2048
  buffer_load_dwordx4 v114, s[4:7], s42 offen offset:864 lds
  s_mov_b32 m0, s59
  s_nop 0
  buffer_load_dwordx4 v114, s[4:7], s43 offen offset:1728 lds
  s_mov_b32 m0, s59
  s_nop 0
  buffer_load_dwordx4 v114, s[4:7], s44 offen offset:2592 lds
  s_waitcnt vmcnt(12)
  ds_read_b64 v[236:237], v241 offset:13824
  ds_read_b64 v[124:125], v241 offset:13856
  s_lshl_b32 s60, s31, 5
  ds_read_b64 v[112:113], v241 offset:13888
  s_add_u32 s61, s60, s30
  s_add_u32 s60, s60, s29
  s_mul_i32 s62, s60, 7183
  ds_read_b128 v[128:131], v239 offset:13824
  s_lshr_b32 s62, s62, 22
  s_mul_i32 s63, s62, 584
  s_sub_u32 s63, s60, s63
  ds_read_b128 v[132:135], v239 offset:14112
  s_lshr_b32 s64, s63, 3
  s_and_b32 s65, s63, 7
  s_lshl_b32 s66, s62, 3
  ds_read_b128 v[140:143], v239 offset:14400
  s_add_u32 s65, s65, s66
  s_cmp_ge_u32 s60, 5256
  s_cselect_b32 s64, s63, s64
  ds_read_b128 v[144:147], v240 offset:13824
  s_cselect_b32 s65, 72, s65
  s_mul_i32 s66, s65, 1373568
  s_waitcnt lgkmcnt(6)
  v_mfma_f32_16x16x16_bf16 v[76:79], a[224:225], v[236:237], 0
  ds_read_b128 v[172:175], v239 offset:13856
  s_mul_i32 s67, s64, 2688
  s_waitcnt lgkmcnt(6)
  v_mfma_f32_16x16x16_bf16 v[80:83], a[234:235], v[124:125], 0
  ds_read_b128 v[176:179], v239 offset:14144
  s_add_u32 s35, s66, s67
  s_waitcnt lgkmcnt(6)
  v_mfma_f32_16x16x16_bf16 v[84:87], a[244:245], v[112:113], 0
  ds_read_b128 v[224:227], v239 offset:14432
  s_cmp_ge_u32 s61, 667
  s_cselect_b32 s35, 268435456, s35
  ds_read_b128 v[228:231], v240 offset:13856
  s_cmp_ge_u32 s60, 5329
  s_cselect_b32 s35, 268435456, s35
  s_waitcnt lgkmcnt(6)
  v_smfmac_f32_16x16x64_bf16 v[76:79], a[216:219], v[128:135], v0
  s_cmp_eq_u32 s65, 0
  ds_read_b128 v[128:131], v239 offset:13888
  s_cselect_b32 s36, 268435456, s35
  ds_read_b128 v[132:135], v239 offset:14176
  s_add_u32 s37, s35, 195360
  s_add_u32 s38, s35, 390720
  s_waitcnt lgkmcnt(6)
  v_smfmac_f32_16x16x64_bf16 v[76:79], a[220:223], v[140:147], v0
  s_add_u32 s39, s35, 586080
  ds_read_b128 v[140:143], v239 offset:14464
  s_add_u32 s40, s35, 781440
  ds_read_b128 v[144:147], v240 offset:13888
  s_add_u32 s41, s35, 981120
  s_add_u32 s42, s35, 1176480
  s_waitcnt lgkmcnt(6)
  v_smfmac_f32_16x16x64_bf16 v[80:83], a[226:229], v[172:179], v0
  s_add_u32 s43, s35, 1371840
  s_add_u32 s44, s35, 1567200
  s_cmp_eq_u32 s64, 0
  s_cselect_b64 s[52:53], s[48:49], 0
  s_cmp_eq_u32 s64, 72
  s_cselect_b64 s[52:53], s[50:51], s[52:53]
  s_waitcnt lgkmcnt(4)
  v_smfmac_f32_16x16x64_bf16 v[80:83], a[230:233], v[224:231], v0
  s_add_u32 s31, s31, 1
  s_mov_b32 s34, s35
  s_mov_b32 s46, 0xffff0000
  s_mov_b32 s47, 0xffff
  s_add_u32 m0, s81, 0
  s_mov_b32 s98, 0
  s_waitcnt lgkmcnt(2)
  v_smfmac_f32_16x16x64_bf16 v[84:87], a[236:239], v[128:135], v0
  buffer_load_dwordx4 v243, s[16:19], s98 offen lds
  v_mul_f32 v114, v76, v76
  v_add_f32 v242, v76, v77
  v_fmac_f32 v114, v77, v77
  s_waitcnt lgkmcnt(0)
  v_smfmac_f32_16x16x64_bf16 v[84:87], a[240:243], v[140:147], v0
  v_add_f32 v242, v242, v78
  v_fmac_f32 v114, v78, v78
  v_add_f32 v242, v242, v79
  v_fmac_f32 v114, v79, v79
  v_add_f32 v242, v242, v80
  v_fmac_f32 v114, v80, v80
  v_add_f32 v242, v242, v81
  v_fmac_f32 v114, v81, v81
  v_add_f32 v242, v242, v82
  v_fmac_f32 v114, v82, v82
  v_add_f32 v242, v242, v83
  v_fmac_f32 v114, v83, v83
  v_add_f32 v242, v242, v84
  v_fmac_f32 v114, v84, v84
  v_add_f32 v242, v242, v85
  v_fmac_f32 v114, v85, v85
  v_add_f32 v242, v242, v86
  v_fmac_f32 v114, v86, v86
  v_add_f32 v242, v242, v87
  v_fmac_f32 v114, v87, v87
  v_cndmask_b32 v239, v21, 2.0, s[52:53]
  s_nop 0
  v_permlane32_swap_b32 v242, v114
  buffer_load_dwordx4 v244, s[16:19], s98 offen offset:1024 lds
  v_add_f32 v242, v242, v114
  s_nop 1
  v_permlane16_swap_b32 v110, v242
  v_add_f32 v110, v110, v242
  ds_write_b32 v111, v110 offset:2048
  buffer_store_dwordx4 v[84:87], v15, s[12:15], s77 offen offset:1024
  s_waitcnt lgkmcnt(0)
  s_barrier
  ds_read_b128 v[128:131], v15 offset:2048
  ds_read_b128 v[140:143], v15 offset:3072
  buffer_store_dwordx4 v[80:83], v15, s[12:15], s77 offen
  s_waitcnt lgkmcnt(1)
  v_add_f32 v128, v128, v129
  v_add_f32 v130, v130, v131
  v_add_f32 v128, v128, v130
  s_waitcnt lgkmcnt(0)
  v_add_f32 v140, v140, v141
  v_add_f32 v142, v142, v143
  v_mul_f32 v129, 0x3baaaaab, v128
  v_add_f32 v140, v140, v142
  v_fma_f32 v140, -v129, v128, v140
  v_max_f32 v140, 0, v140
  v_add_f32 v140, 0x3afba882, v140
  v_rsq_f32 v140, v140
  s_nop 0
  v_mul_f32 v140, 0x40ca568a, v140
  v_mul_f32 v141, -v129, v140
  ds_write_b64 v238, v[140:141]
  ds_read_b64 v[240:241], v122
  ds_read_b64 v[112:113], v122 offset:128
  buffer_store_dwordx4 v[76:79], v15, s[12:15], s75 offen offset:3072
  s_waitcnt lgkmcnt(1)
  v_fma_f32 v128, v64, v240, v241
  v_fma_f32 v122, v65, v240, v241
  v_cvt_pk_bf16_f32 v128, v128, v122
  v_fma_f32 v129, v66, v240, v241
  v_fma_f32 v122, v67, v240, v241
  buffer_load_dwordx4 v245, s[16:19], s98 offen offset:2048 lds
  s_add_u32 m0, s81, 3072
  s_mov_b32 s98, 36864
  v_cvt_pk_bf16_f32 v129, v129, v122
  v_fma_f32 v130, v68, v240, v241
  v_fma_f32 v122, v69, v240, v241
  v_cvt_pk_bf16_f32 v130, v130, v122
  v_fma_f32 v131, v70, v240, v241
  v_fma_f32 v122, v71, v240, v241
  v_cvt_pk_bf16_f32 v131, v131, v122
  s_waitcnt lgkmcnt(0)
  v_fma_f32 v140, v76, v112, v113
  v_fma_f32 v122, v77, v112, v113
  v_cvt_pk_bf16_f32 v140, v140, v122
  v_fma_f32 v141, v78, v112, v113
  v_fma_f32 v122, v79, v112, v113
  v_cvt_pk_bf16_f32 v141, v141, v122
  v_fma_f32 v142, v80, v112, v113
  v_fma_f32 v122, v81, v112, v113
  v_cvt_pk_bf16_f32 v142, v142, v122
  v_fma_f32 v143, v82, v112, v113
  v_fma_f32 v122, v83, v112, v113
  v_cvt_pk_bf16_f32 v143, v143, v122
  ds_write_b128 v16, v[128:131] offset:8192
  v_fma_f32 v236, v72, v240, v241
  ds_write_b128 v16, v[140:143] offset:14336
  v_fma_f32 v122, v73, v240, v241
  v_cvt_pk_bf16_f32 v236, v236, v122
  v_fma_f32 v237, v74, v240, v241
  v_fma_f32 v122, v75, v240, v241
  v_cvt_pk_bf16_f32 v237, v237, v122
  v_fma_f32 v240, v84, v112, v113
  v_fma_f32 v122, v85, v112, v113
  v_cvt_pk_bf16_f32 v240, v240, v122
  v_fma_f32 v241, v86, v112, v113
  v_fma_f32 v122, v87, v112, v113
  v_cvt_pk_bf16_f32 v241, v241, v122
  ds_write_b64 v17, v[236:237] offset:8192
  buffer_load_dwordx4 v243, s[16:19], s98 offen lds
  ds_write_b64 v17, v[240:241] offset:14336
  s_waitcnt vmcnt(14)
  ds_read_b64 v[240:241], v9
  ds_read_b64 v[112:113], v9 offset:32
  ds_read_b64 v[236:237], v9 offset:64
  ds_read_b128 v[128:131], v3
  ds_read_b128 v[132:135], v3 offset:864
  ds_read_b128 v[140:143], v3 offset:1728
  s_waitcnt lgkmcnt(6)
  s_barrier
  ds_read_b128 v[144:147], v6
  s_waitcnt lgkmcnt(6)
  v_mfma_f32_16x16x16_bf16 v[28:31], a[224:225], v[240:241], 0
  ds_read_b128 v[172:175], v3 offset:32
  s_waitcnt lgkmcnt(6)
  v_mfma_f32_16x16x16_bf16 v[32:35], a[234:235], v[112:113], 0
  ds_read_b128 v[176:179], v3 offset:896
  s_waitcnt lgkmcnt(6)
  v_mfma_f32_16x16x16_bf16 v[36:39], a[244:245], v[236:237], 0
  ds_read_b128 v[224:227], v3 offset:1760
  ds_read_b128 v[228:231], v6 offset:32
  s_waitcnt lgkmcnt(6)
  v_smfmac_f32_16x16x64_bf16 v[28:31], a[216:219], v[128:135], v0
  ds_read_b128 v[128:131], v3 offset:64
  ds_read_b128 v[132:135], v3 offset:928
  s_waitcnt lgkmcnt(6)
  v_smfmac_f32_16x16x64_bf16 v[28:31], a[220:223], v[140:147], v0
  ds_read_b128 v[140:143], v3 offset:1792
  ds_read_b128 v[144:147], v6 offset:64
  buffer_load_dwordx4 v244, s[16:19], s98 offen offset:1024 lds
  s_waitcnt lgkmcnt(6)
  v_smfmac_f32_16x16x64_bf16 v[32:35], a[226:229], v[172:179], v0
  s_nop 2
  v_mul_f32 v238, v28, v28
  v_add_f32 v122, v28, v29
  v_fmac_f32 v238, v29, v29
  v_add_f32 v122, v122, v30
  s_waitcnt lgkmcnt(4)
  v_smfmac_f32_16x16x64_bf16 v[32:35], a[230:233], v[224:231], v0
  v_fmac_f32 v238, v30, v30
  v_add_f32 v122, v122, v31
  v_fmac_f32 v238, v31, v31
  s_waitcnt lgkmcnt(2)
  v_smfmac_f32_16x16x64_bf16 v[36:39], a[236:239], v[128:135], v0
  s_nop 2
  v_add_f32 v122, v122, v32
  v_fmac_f32 v238, v32, v32
  v_add_f32 v122, v122, v33
  v_fmac_f32 v238, v33, v33
  v_add_f32 v122, v122, v34
  s_waitcnt lgkmcnt(0)
  v_smfmac_f32_16x16x64_bf16 v[36:39], a[240:243], v[140:147], v0
  v_fmac_f32 v238, v34, v34
  v_add_f32 v122, v122, v35
  v_fmac_f32 v238, v35, v35
  s_nop 4
  v_add_f32 v122, v122, v36
  v_fmac_f32 v238, v36, v36
  v_add_f32 v122, v122, v37
  v_fmac_f32 v238, v37, v37
  v_add_f32 v122, v122, v38
  v_fmac_f32 v238, v38, v38
  v_add_f32 v122, v122, v39
  v_fmac_f32 v238, v39, v39
  buffer_load_dwordx4 v245, s[16:19], s98 offen offset:2048 lds
  s_add_u32 m0, s81, 6144
  s_mov_b32 s98, 73728
  s_waitcnt vmcnt(11)
  ds_read_b64 v[236:237], v10
  ds_read_b64 v[112:113], v10 offset:32
  ds_read_b64 v[240:241], v10 offset:64
  v_permlane32_swap_b32 v122, v238
  ds_read_b128 v[172:175], v4
  ds_read_b128 v[176:179], v4 offset:864
  v_add_f32 v122, v122, v238
  ds_read_b128 v[140:143], v4 offset:1728
  ds_read_b128 v[144:147], v7
  s_waitcnt lgkmcnt(6)
  v_mfma_f32_16x16x16_bf16 v[40:43], a[224:225], v[236:237], 0
  ds_read_b128 v[224:227], v4 offset:32
  s_waitcnt lgkmcnt(6)
  v_mfma_f32_16x16x16_bf16 v[44:47], a[234:235], v[112:113], 0
  ds_read_b128 v[228:231], v4 offset:896
  s_waitcnt lgkmcnt(6)
  v_mfma_f32_16x16x16_bf16 v[48:51], a[244:245], v[240:241], 0
  ds_read_b128 v[128:131], v4 offset:1760
  ds_read_b128 v[132:135], v7 offset:32
  s_waitcnt lgkmcnt(6)
  v_smfmac_f32_16x16x64_bf16 v[40:43], a[216:219], v[172:179], v0
  ds_read_b128 v[172:175], v4 offset:64
  ds_read_b128 v[176:179], v4 offset:928
  s_waitcnt lgkmcnt(6)
  v_smfmac_f32_16x16x64_bf16 v[40:43], a[220:223], v[140:147], v0
  ds_read_b128 v[140:143], v4 offset:1792
  buffer_load_dwordx4 v243, s[16:19], s98 offen lds
  ds_read_b128 v[144:147], v7 offset:64
  s_waitcnt lgkmcnt(6)
  v_smfmac_f32_16x16x64_bf16 v[44:47], a[226:229], v[224:231], v0
  s_nop 2
  v_mul_f32 v238, v40, v40
  v_add_f32 v110, v40, v41
  v_fmac_f32 v238, v41, v41
  v_add_f32 v110, v110, v42
  v_fmac_f32 v238, v42, v42
  s_waitcnt lgkmcnt(4)
  v_smfmac_f32_16x16x64_bf16 v[44:47], a[230:233], v[128:135], v0
  v_add_f32 v110, v110, v43
  v_fmac_f32 v238, v43, v43
  s_waitcnt lgkmcnt(2)
  v_smfmac_f32_16x16x64_bf16 v[48:51], a[236:239], v[172:179], v0
  ds_read_b128 v[96:99], v15 offset:8192
  s_nop 2
  v_add_f32 v110, v110, v44
  v_fmac_f32 v238, v44, v44
  v_add_f32 v110, v110, v45
  v_fmac_f32 v238, v45, v45
  v_add_f32 v110, v110, v46
  s_waitcnt lgkmcnt(1)
  v_smfmac_f32_16x16x64_bf16 v[48:51], a[240:243], v[140:147], v0
  ds_read_b128 v[92:95], v15 offset:9216
  v_fmac_f32 v238, v46, v46
  v_add_f32 v110, v110, v47
  v_fmac_f32 v238, v47, v47
  s_nop 3
  v_add_f32 v110, v110, v48
  v_fmac_f32 v238, v48, v48
  v_add_f32 v110, v110, v49
  v_fmac_f32 v238, v49, v49
  v_add_f32 v110, v110, v50
  v_fmac_f32 v238, v50, v50
  v_add_f32 v110, v110, v51
  v_fmac_f32 v238, v51, v51
  s_nop 1
  v_permlane32_swap_b32 v110, v238
  v_add_f32 v110, v110, v238
  buffer_load_dwordx4 v244, s[16:19], s98 offen offset:1024 lds
  s_waitcnt vmcnt(11)
  ds_read_b64 v[236:237], v11
  ds_read_b64 v[112:113], v11 offset:32
  ds_read_b64 v[240:241], v11 offset:64
  v_permlane16_swap_b32 v122, v110
  ds_read_b128 v[140:143], v5
  ds_read_b128 v[144:147], v5 offset:864
  v_add_f32 v122, v122, v110
  buffer_load_dwordx4 v245, s[16:19], s98 offen offset:2048 lds
  s_add_u32 m0, s81, 9216
  s_mov_b32 s98, 110592
  ds_read_b128 v[172:175], v5 offset:1728
  ds_read_b128 v[176:179], v8
  s_waitcnt lgkmcnt(6)
  v_mfma_f32_16x16x16_bf16 v[52:55], a[224:225], v[236:237], 0
  ds_read_b128 v[224:227], v5 offset:32
  s_waitcnt lgkmcnt(6)
  v_mfma_f32_16x16x16_bf16 v[56:59], a[234:235], v[112:113], 0
  ds_read_b128 v[228:231], v5 offset:896
  s_waitcnt lgkmcnt(6)
  v_mfma_f32_16x16x16_bf16 v[60:63], a[244:245], v[240:241], 0
  ds_read_b128 v[128:131], v5 offset:1760
  buffer_load_dwordx4 v243, s[16:19], s98 offen lds
  ds_read_b128 v[132:135], v8 offset:32
  s_waitcnt lgkmcnt(6)
  v_smfmac_f32_16x16x64_bf16 v[52:55], a[216:219], v[140:147], v0
  ds_read_b128 v[140:143], v5 offset:64
  ds_read_b128 v[144:147], v5 offset:928
  s_waitcnt lgkmcnt(6)
  v_smfmac_f32_16x16x64_bf16 v[52:55], a[220:223], v[172:179], v0
  ds_read_b128 v[172:175], v5 offset:1792
  ds_read_b128 v[176:179], v8 offset:64
  s_waitcnt lgkmcnt(6)
  v_smfmac_f32_16x16x64_bf16 v[56:59], a[226:229], v[224:231], v0
  ds_read_b128 v[88:91], v15 offset:10240
  ds_read_b128 v[84:87], v15 offset:11264
  s_nop 1
  v_mul_f32 v110, v52, v52
  v_add_f32 v238, v52, v53
  s_waitcnt lgkmcnt(6)
  v_smfmac_f32_16x16x64_bf16 v[56:59], a[230:233], v[128:135], v0
  ds_read_b128 v[80:83], v15 offset:12288
  ds_read_b128 v[76:79], v15 offset:13312
  v_fmac_f32 v110, v53, v53
  v_add_f32 v238, v238, v54
  s_waitcnt lgkmcnt(6)
  v_smfmac_f32_16x16x64_bf16 v[60:63], a[236:239], v[140:147], v0
  v_fmac_f32 v110, v54, v54
  v_add_f32 v238, v238, v55
  v_fmac_f32 v110, v55, v55
  v_add_f32 v238, v238, v56
  s_waitcnt lgkmcnt(4)
  v_smfmac_f32_16x16x64_bf16 v[60:63], a[240:243], v[172:179], v0
  v_fmac_f32 v110, v56, v56
  v_add_f32 v238, v238, v57
  v_fmac_f32 v110, v57, v57
  v_add_f32 v238, v238, v58
  v_fmac_f32 v110, v58, v58
  v_add_f32 v238, v238, v59
  v_fmac_f32 v110, v59, v59
  s_nop 0
  v_add_f32 v238, v238, v60
  v_fmac_f32 v110, v60, v60
  v_add_f32 v238, v238, v61
  v_fmac_f32 v110, v61, v61
  v_add_f32 v238, v238, v62
  v_fmac_f32 v110, v62, v62
  v_add_f32 v238, v238, v63
  v_fmac_f32 v110, v63, v63
  s_nop 1
  v_permlane32_swap_b32 v238, v110
  v_add_f32 v238, v238, v110
  v_mov_b32 v110, v238
  s_nop 1
  v_permlane16_swap_b32 v238, v110
  v_add_f32 v238, v238, v110
  ds_write_b32 v111, v122
  ds_write_b32 v111, v238 offset:512
  buffer_load_dwordx4 v244, s[16:19], s98 offen offset:1024 lds
  s_waitcnt vmcnt(8)
  ds_read_b64_tr_b16 a[0:1], v246
  ds_read_b64_tr_b16 a[24:25], v246 offset:32
  ds_read_b64_tr_b16 a[48:49], v246 offset:64
  ds_read_b64_tr_b16 a[2:3], v246 offset:1536
  ds_read_b64_tr_b16 a[26:27], v246 offset:1568
  ds_read_b64_tr_b16 a[50:51], v246 offset:1600
  buffer_load_dwordx4 v245, s[16:19], s98 offen offset:2048 lds
  s_add_u32 m0, s81, 12288
  s_mov_b32 s98, 147456
  s_waitcnt lgkmcnt(2)
  v_mfma_f32_16x16x32_bf16 v[196:199], a[0:3], v[96:99], 0
  buffer_load_dwordx4 v243, s[16:19], s98 offen lds
  buffer_load_dwordx4 v244, s[16:19], s98 offen offset:1024 lds
  s_waitcnt vmcnt(8)
  ds_read_b64_tr_b16 a[16:17], v246 offset:3072
  ds_read_b64_tr_b16 a[40:41], v246 offset:3104
  ds_read_b64_tr_b16 a[64:65], v246 offset:3136
  ds_read_b64_tr_b16 a[4:5], v246 offset:4608
  ds_read_b64_tr_b16 a[28:29], v246 offset:4640
  ds_read_b64_tr_b16 a[52:53], v246 offset:4672
  buffer_load_dwordx4 v245, s[16:19], s98 offen offset:2048 lds
  s_add_u32 m0, s81, 15360
  s_mov_b32 s98, 184320
  buffer_load_dwordx4 v243, s[16:19], s98 offen lds
  buffer_load_dwordx4 v244, s[16:19], s98 offen offset:1024 lds
  s_waitcnt vmcnt(8)
  ds_read_b64_tr_b16 a[6:7], v246 offset:6144
  ds_read_b64_tr_b16 a[30:31], v246 offset:6176
  ds_read_b64_tr_b16 a[54:55], v246 offset:6208
  ds_read_b64_tr_b16 a[18:19], v246 offset:7680
  ds_read_b64_tr_b16 a[42:43], v246 offset:7712
  ds_read_b64_tr_b16 a[66:67], v246 offset:7744
  buffer_load_dwordx4 v245, s[16:19], s98 offen offset:2048 lds
  s_add_u32 m0, s81, 18432
  s_mov_b32 s98, 384
  s_waitcnt lgkmcnt(5)
  v_mfma_f32_16x16x32_bf16 v[196:199], a[4:7], v[92:95], v[196:199]
  buffer_load_dwordx4 v243, s[16:19], s98 offen lds
  buffer_load_dwordx4 v244, s[16:19], s98 offen offset:1024 lds
  s_waitcnt vmcnt(8)
  ds_read_b64_tr_b16 a[8:9], v246 offset:9216
  ds_read_b64_tr_b16 a[10:11], v246 offset:10752
  ds_read_b64_tr_b16 a[32:33], v246 offset:9248
  ds_read_b64_tr_b16 a[34:35], v246 offset:10784
  ds_read_b64_tr_b16 a[56:57], v246 offset:9280
  ds_read_b64_tr_b16 a[58:59], v246 offset:10816
  buffer_load_dwordx4 v245, s[16:19], s98 offen offset:2048 lds
  s_add_u32 m0, s81, 21504
  s_mov_b32 s98, 37248
  s_waitcnt lgkmcnt(4)
  v_mfma_f32_16x16x32_bf16 v[196:199], a[8:11], v[88:91], v[196:199]
  buffer_load_dwordx4 v243, s[16:19], s98 offen lds
  buffer_load_dwordx4 v244, s[16:19], s98 offen offset:1024 lds
  s_waitcnt vmcnt(8)
  ds_read_b64_tr_b16 a[12:13], v246 offset:13824
  ds_read_b64_tr_b16 a[20:21], v246 offset:12288
  ds_read_b64_tr_b16 a[36:37], v246 offset:13856
  ds_read_b64_tr_b16 a[44:45], v246 offset:12320
  ds_read_b64_tr_b16 a[60:61], v246 offset:13888
  ds_read_b64_tr_b16 a[68:69], v246 offset:12352
  buffer_load_dwordx4 v245, s[16:19], s98 offen offset:2048 lds
  s_add_u32 m0, s81, 24576
  s_mov_b32 s98, 74112
  buffer_load_dwordx4 v243, s[16:19], s98 offen lds
  buffer_load_dwordx4 v244, s[16:19], s98 offen offset:1024 lds
  s_waitcnt vmcnt(8)
  ds_read_b64_tr_b16 a[14:15], v246 offset:15360
  ds_read_b64_tr_b16 a[22:23], v246 offset:16896
  ds_read_b64_tr_b16 a[38:39], v246 offset:15392
  ds_read_b64_tr_b16 a[46:47], v246 offset:16928
  ds_read_b64_tr_b16 a[62:63], v246 offset:15424
  ds_read_b64_tr_b16 a[70:71], v246 offset:16960
  buffer_load_dwordx4 v245, s[16:19], s98 offen offset:2048 lds
  s_add_u32 m0, s81, 0
  s_mov_b32 s98, 110976
  s_waitcnt lgkmcnt(5)
  v_mfma_f32_16x16x32_bf16 v[196:199], a[12:15], v[84:87], v[196:199]
  v_mfma_f32_16x16x32_bf16 v[196:199], a[16:19], v[80:83], v[196:199]
  s_waitcnt lgkmcnt(4)
  v_mfma_f32_16x16x32_bf16 v[196:199], a[20:23], v[76:79], v[196:199]
  v_mfma_f32_16x16x32_bf16 v[212:215], a[24:27], v[96:99], 0
  buffer_load_dwordx4 v243, s[16:19], s98 offen lds
  v_mfma_f32_16x16x32_bf16 v[212:215], a[28:31], v[92:95], v[212:215]
  ds_read_b128 v[72:75], v15 offset:14336
  ds_read_b128 v[68:71], v15 offset:15360
  v_mfma_f32_16x16x32_bf16 v[212:215], a[32:35], v[88:91], v[212:215]
  s_waitcnt lgkmcnt(5)
  ds_read_b128 v[64:67], v15 offset:16384
  v_cvt_pk_bf16_f32 v144, v196, v197
  v_mfma_f32_16x16x32_bf16 v[212:215], a[36:39], v[84:87], v[212:215]
  ds_read_b128 v[172:175], v15 offset:17408
  v_cvt_pk_bf16_f32 v145, v198, v199
  v_mfma_f32_16x16x32_bf16 v[212:215], a[40:43], v[80:83], v[212:215]
  s_waitcnt vmcnt(7) lgkmcnt(6)
  buffer_load_dwordx4 v244, s[16:19], s98 offen offset:1024 lds
  v_mfma_f32_16x16x32_bf16 v[212:215], a[44:47], v[76:79], v[212:215]
  ds_read_b64_tr_b16 a[72:73], v246 offset:18432
  ds_read_b64_tr_b16 a[74:75], v246 offset:19968
  v_mfma_f32_16x16x32_bf16 v[140:143], a[48:51], v[96:99], 0
  ds_read_b64_tr_b16 a[96:97], v246 offset:18464
  ds_read_b64_tr_b16 a[98:99], v246 offset:20000
  v_mfma_f32_16x16x32_bf16 v[140:143], a[52:55], v[92:95], v[140:143]
  ds_read_b64_tr_b16 a[120:121], v246 offset:18496
  v_cvt_pk_bf16_f32 v146, v212, v213
  v_mfma_f32_16x16x32_bf16 v[140:143], a[56:59], v[88:91], v[140:143]
  s_waitcnt lgkmcnt(10)
  ds_read_b64_tr_b16 a[122:123], v246 offset:20032
  ds_read_b128 v[160:163], v15 offset:18432
  v_mfma_f32_16x16x32_bf16 v[140:143], a[60:63], v[84:87], v[140:143]
  buffer_load_dwordx4 v245, s[16:19], s98 offen offset:2048 lds
  v_mfma_f32_16x16x32_bf16 v[140:143], a[64:67], v[80:83], v[140:143]
  s_waitcnt lgkmcnt(11)
  ds_read_b128 v[196:199], v15 offset:19456
  v_cvt_pk_bf16_f32 v147, v214, v215
  v_mfma_f32_16x16x32_bf16 v[140:143], a[68:71], v[76:79], v[140:143]
  s_waitcnt lgkmcnt(8)
  s_add_u32 m0, s81, 3072
  s_mov_b32 s98, 147840
  buffer_load_dwordx4 v243, s[16:19], s98 offen lds
  s_nop 3
  v_cvt_pk_bf16_f32 v120, v140, v141
  v_cvt_pk_bf16_f32 v121, v142, v143
  s_waitcnt lgkmcnt(0)
  s_barrier
  v_mfma_f32_16x16x32_bf16 v[140:143], a[0:3], v[72:75], 0
  ds_read_b128 v[176:179], v15
  ds_read_b128 v[132:135], v15 offset:1024
  v_mfma_f32_16x16x32_bf16 v[140:143], a[4:7], v[68:71], v[140:143]
  s_waitcnt vmcnt(7)
  buffer_load_dwordx4 v244, s[16:19], s98 offen offset:1024 lds
  v_mfma_f32_16x16x32_bf16 v[140:143], a[8:11], v[64:67], v[140:143]
  ds_read_b64_tr_b16 a[76:77], v246 offset:23040
  ds_read_b64_tr_b16 a[88:89], v246 offset:21504
  v_mfma_f32_16x16x32_bf16 v[140:143], a[12:15], v[172:175], v[140:143]
  ds_read_b64_tr_b16 a[100:101], v246 offset:23072
  ds_read_b64_tr_b16 a[112:113], v246 offset:21536
  v_mfma_f32_16x16x32_bf16 v[140:143], a[16:19], v[160:163], v[140:143]
  ds_read_b64_tr_b16 a[124:125], v246 offset:23104
  v_mfma_f32_16x16x32_bf16 v[140:143], a[20:23], v[196:199], v[140:143]
  buffer_load_dwordx4 v245, s[16:19], s98 offen offset:2048 lds
  v_mfma_f32_16x16x32_bf16 v[216:219], a[24:27], v[72:75], 0
  s_waitcnt lgkmcnt(6)
  ds_read_b64_tr_b16 a[136:137], v246 offset:21568
  v_add_f32 v176, v176, v177
  v_mfma_f32_16x16x32_bf16 v[216:219], a[28:31], v[68:71], v[216:219]
  s_waitcnt lgkmcnt(6)
  v_add_f32 v178, v178, v179
  v_add_f32 v132, v132, v133
  v_mfma_f32_16x16x32_bf16 v[216:219], a[32:35], v[64:67], v[216:219]
  s_add_u32 m0, s81, 6144
  v_add_f32 v134, v134, v135
  v_add_f32 v176, v176, v178
  v_mfma_f32_16x16x32_bf16 v[216:219], a[36:39], v[172:175], v[216:219]
  s_mov_b32 s98, 184704
  v_add_f32 v132, v132, v134
  v_mul_f32 v177, 0x3baaaaab, v176
  v_mfma_f32_16x16x32_bf16 v[216:219], a[40:43], v[160:163], v[216:219]
  buffer_load_dwordx4 v243, s[16:19], s98 offen lds
  v_mfma_f32_16x16x32_bf16 v[216:219], a[44:47], v[196:199], v[216:219]
  v_fma_f32 v132, -v177, v176, v132
  v_max_f32 v132, 0, v132
  v_mfma_f32_16x16x32_bf16 v[156:159], a[48:51], v[72:75], 0
  v_add_f32 v132, 0x3afba882, v132
  v_cvt_pk_bf16_f32 v212, v140, v141
  v_mfma_f32_16x16x32_bf16 v[156:159], a[52:55], v[68:71], v[156:159]
  v_rsq_f32 v132, v132
  v_mfma_f32_16x16x32_bf16 v[156:159], a[56:59], v[64:67], v[156:159]
  s_waitcnt vmcnt(7)
  buffer_load_dwordx4 v244, s[16:19], s98 offen offset:1024 lds
  v_mfma_f32_16x16x32_bf16 v[156:159], a[60:63], v[172:175], v[156:159]
  ds_read_b64_tr_b16 a[78:79], v246 offset:24576
  ds_read_b64_tr_b16 a[90:91], v246 offset:26112
  v_mfma_f32_16x16x32_bf16 v[156:159], a[64:67], v[160:163], v[156:159]
  ds_read_b64_tr_b16 a[102:103], v246 offset:24608
  ds_read_b64_tr_b16 a[114:115], v246 offset:26144
  v_mfma_f32_16x16x32_bf16 v[156:159], a[68:71], v[196:199], v[156:159]
  ds_read_b64_tr_b16 a[126:127], v246 offset:24640
  v_cvt_pk_bf16_f32 v213, v142, v143
  v_mfma_f32_16x16x32_bf16 v[140:143], a[72:75], v[96:99], 0
  s_waitcnt lgkmcnt(10)
  ds_read_b64_tr_b16 a[138:139], v246 offset:26176
  buffer_load_dwordx4 v245, s[16:19], s98 offen offset:2048 lds
  v_mul_f32 v132, 0x40ca568a, v132
  v_mul_f32 v133, -v177, v132
  v_cvt_pk_bf16_f32 v214, v216, v217
  v_cvt_pk_bf16_f32 v215, v218, v219
  v_cvt_pk_bf16_f32 v236, v156, v157
  v_cvt_pk_bf16_f32 v237, v158, v159
  s_waitcnt lgkmcnt(5)
  v_mfma_f32_16x16x32_bf16 v[140:143], a[76:79], v[92:95], v[140:143]
  s_add_u32 m0, s81, 9216
  ds_write_b64 v118, v[132:133]
  ds_read_b64 v[240:241], v126
  ds_read_b64 v[116:117], v126 offset:128
  s_mov_b32 s98, 768
  ds_read_b64 v[170:171], v126 offset:256
  buffer_load_dwordx4 v243, s[16:19], s98 offen lds
  buffer_load_dwordx4 v244, s[16:19], s98 offen offset:1024 lds
  s_waitcnt vmcnt(8)
  ds_read_b64_tr_b16 a[80:81], v246
  ds_read_b64_tr_b16 a[82:83], v246 offset:1536
  ds_read_b64_tr_b16 a[104:105], v246 offset:32
  ds_read_b64_tr_b16 a[106:107], v246 offset:1568
  ds_read_b64_tr_b16 a[128:129], v246 offset:64
  ds_read_b64_tr_b16 a[130:131], v246 offset:1600
  s_waitcnt lgkmcnt(8)
  v_fma_f32 v156, v28, v240, v241
  buffer_load_dwordx4 v245, s[16:19], s98 offen offset:2048 lds
  v_fma_f32 v118, v29, v240, v241
  v_cvt_pk_bf16_f32 v156, v156, v118
  v_fma_f32 v157, v30, v240, v241
  v_fma_f32 v118, v31, v240, v241
  v_cvt_pk_bf16_f32 v157, v157, v118
  v_fma_f32 v158, v32, v240, v241
  v_fma_f32 v118, v33, v240, v241
  s_waitcnt lgkmcnt(4)
  v_mfma_f32_16x16x32_bf16 v[140:143], a[80:83], v[88:91], v[140:143]
  s_add_u32 m0, s81, 12288
  v_cvt_pk_bf16_f32 v158, v158, v118
  v_fma_f32 v159, v34, v240, v241
  v_fma_f32 v118, v35, v240, v241
  v_cvt_pk_bf16_f32 v159, v159, v118
  v_fma_f32 v216, v40, v116, v117
  v_fma_f32 v118, v41, v116, v117
  v_cvt_pk_bf16_f32 v216, v216, v118
  v_fma_f32 v217, v42, v116, v117
  v_fma_f32 v118, v43, v116, v117
  v_cvt_pk_bf16_f32 v217, v217, v118
  v_fma_f32 v218, v44, v116, v117
  v_fma_f32 v118, v45, v116, v117
  v_cvt_pk_bf16_f32 v218, v218, v118
  v_fma_f32 v219, v46, v116, v117
  v_fma_f32 v118, v47, v116, v117
  v_cvt_pk_bf16_f32 v219, v219, v118
  v_fma_f32 v132, v52, v170, v171
  v_fma_f32 v118, v53, v170, v171
  v_cvt_pk_bf16_f32 v132, v132, v118
  v_fma_f32 v133, v54, v170, v171
  v_fma_f32 v118, v55, v170, v171
  v_cvt_pk_bf16_f32 v133, v133, v118
  s_waitcnt vmcnt(6)
  ds_read_b64_tr_b16 a[84:85], v246 offset:4608
  ds_read_b64_tr_b16 a[92:93], v246 offset:3072
  ds_read_b64_tr_b16 a[108:109], v246 offset:4640
  s_mov_b32 s98, 37632
  buffer_load_dwordx4 v243, s[16:19], s98 offen lds
  buffer_load_dwordx4 v244, s[16:19], s98 offen offset:1024 lds
  ds_read_b64_tr_b16 a[116:117], v246 offset:3104
  ds_read_b64_tr_b16 a[132:133], v246 offset:4672
  ds_read_b64_tr_b16 a[140:141], v246 offset:3136
  v_fma_f32 v134, v56, v170, v171
  v_fma_f32 v118, v57, v170, v171
  v_cvt_pk_bf16_f32 v134, v134, v118
  v_fma_f32 v135, v58, v170, v171
  v_fma_f32 v118, v59, v170, v171
  buffer_load_dwordx4 v245, s[16:19], s98 offen offset:2048 lds
  v_cvt_pk_bf16_f32 v135, v135, v118
  s_add_u32 m0, s81, 15360
  s_mov_b32 s98, 74496
  ds_write_b128 v16, v[156:159] offset:2048
  v_fma_f32 v112, v36, v240, v241
  ds_write_b128 v16, v[216:219] offset:8192
  buffer_load_dwordx4 v243, s[16:19], s98 offen lds
  v_fma_f32 v118, v37, v240, v241
  v_cvt_pk_bf16_f32 v112, v112, v118
  v_fma_f32 v113, v38, v240, v241
  v_fma_f32 v118, v39, v240, v241
  v_cvt_pk_bf16_f32 v113, v113, v118
  ds_write_b128 v16, v[132:135] offset:14336
  v_fma_f32 v240, v48, v116, v117
  v_fma_f32 v118, v49, v116, v117
  buffer_load_dwordx4 v244, s[16:19], s98 offen offset:1024 lds
  s_waitcnt vmcnt(8)
  ds_read_b64_tr_b16 a[86:87], v246 offset:6144
  ds_read_b64_tr_b16 a[94:95], v246 offset:7680
  ds_read_b64_tr_b16 a[110:111], v246 offset:6176
  ds_read_b64_tr_b16 a[118:119], v246 offset:7712
  ds_read_b64_tr_b16 a[134:135], v246 offset:6208
  buffer_load_dwordx4 v245, s[16:19], s98 offen offset:2048 lds
  ds_read_b64_tr_b16 a[142:143], v246 offset:7744
  v_cvt_pk_bf16_f32 v240, v240, v118
  v_fma_f32 v241, v50, v116, v117
  v_fma_f32 v118, v51, v116, v117
  v_cvt_pk_bf16_f32 v241, v241, v118
  v_fma_f32 v116, v60, v170, v171
  v_fma_f32 v118, v61, v170, v171
  v_cvt_pk_bf16_f32 v116, v116, v118
  v_fma_f32 v117, v62, v170, v171
  s_waitcnt lgkmcnt(5)
  v_mfma_f32_16x16x32_bf16 v[140:143], a[84:87], v[84:87], v[140:143]
  s_add_u32 m0, s81, 18432
  ds_write_b64 v17, v[112:113] offset:2048
  v_mfma_f32_16x16x32_bf16 v[140:143], a[88:91], v[80:83], v[140:143]
  s_waitcnt lgkmcnt(5)
  ds_write_b64 v17, v[240:241] offset:8192
  v_mfma_f32_16x16x32_bf16 v[140:143], a[92:95], v[76:79], v[140:143]
  s_mov_b32 s98, 111360
  buffer_load_dwordx4 v243, s[16:19], s98 offen lds
  v_mfma_f32_16x16x32_bf16 v[156:159], a[96:99], v[96:99], 0
  v_fma_f32 v118, v63, v170, v171
  v_cvt_pk_bf16_f32 v117, v117, v118
  v_mfma_f32_16x16x32_bf16 v[156:159], a[100:103], v[92:95], v[156:159]
  ds_write_b64 v17, v[116:117] offset:14336
  v_mfma_f32_16x16x32_bf16 v[156:159], a[104:107], v[88:91], v[156:159]
  s_waitcnt vmcnt(7) lgkmcnt(6)
  buffer_load_dwordx4 v244, s[16:19], s98 offen offset:1024 lds
  v_mfma_f32_16x16x32_bf16 v[156:159], a[108:111], v[84:87], v[156:159]
  ds_read_b64_tr_b16 a[144:145], v246 offset:9216
  ds_read_b64_tr_b16 a[168:169], v246 offset:9248
  v_mfma_f32_16x16x32_bf16 v[156:159], a[112:115], v[80:83], v[156:159]
  s_waitcnt lgkmcnt(7)
  ds_read_b64_tr_b16 a[192:193], v246 offset:9280
  ds_read_b64_tr_b16 a[146:147], v246 offset:10752
  v_mfma_f32_16x16x32_bf16 v[156:159], a[116:119], v[76:79], v[156:159]
  ds_read_b64_tr_b16 a[170:171], v246 offset:10784
  v_cvt_pk_bf16_f32 v132, v140, v141
  v_mfma_f32_16x16x32_bf16 v[216:219], a[120:123], v[96:99], 0
  ds_read_b64_tr_b16 a[194:195], v246 offset:10816
  v_cvt_pk_bf16_f32 v133, v142, v143
  v_mfma_f32_16x16x32_bf16 v[216:219], a[124:127], v[92:95], v[216:219]
  v_cvt_pk_bf16_f32 v134, v156, v157
  v_cvt_pk_bf16_f32 v135, v158, v159
  v_mfma_f32_16x16x32_bf16 v[216:219], a[128:131], v[88:91], v[216:219]
  s_waitcnt lgkmcnt(10)
  v_mfma_f32_16x16x32_bf16 v[216:219], a[132:135], v[84:87], v[216:219]
  buffer_load_dwordx4 v245, s[16:19], s98 offen offset:2048 lds
  v_mfma_f32_16x16x32_bf16 v[216:219], a[136:139], v[80:83], v[216:219]
  s_waitcnt lgkmcnt(9)
  v_mfma_f32_16x16x32_bf16 v[216:219], a[140:143], v[76:79], v[216:219]
  s_waitcnt lgkmcnt(6)
  s_barrier
  v_mfma_f32_16x16x32_bf16 v[140:143], a[72:75], v[72:75], 0
  s_add_u32 m0, s81, 21504
  v_mfma_f32_16x16x32_bf16 v[140:143], a[76:79], v[68:71], v[140:143]
  s_mov_b32 s98, 148224
  buffer_load_dwordx4 v243, s[16:19], s98 offen lds
  v_mfma_f32_16x16x32_bf16 v[140:143], a[80:83], v[64:67], v[140:143]
  v_cvt_pk_bf16_f32 v112, v216, v217
  v_cvt_pk_bf16_f32 v113, v218, v219
  v_mfma_f32_16x16x32_bf16 v[140:143], a[84:87], v[172:175], v[140:143]
  v_mfma_f32_16x16x32_bf16 v[140:143], a[88:91], v[160:163], v[140:143]
  v_mfma_f32_16x16x32_bf16 v[140:143], a[92:95], v[196:199], v[140:143]
  v_mfma_f32_16x16x32_bf16 v[232:235], a[96:99], v[72:75], 0
  s_waitcnt vmcnt(7)
  buffer_load_dwordx4 v244, s[16:19], s98 offen offset:1024 lds
  v_mfma_f32_16x16x32_bf16 v[232:235], a[100:103], v[68:71], v[232:235]
  ds_read_b64_tr_b16 a[160:161], v246 offset:12288
  ds_read_b64_tr_b16 a[184:185], v246 offset:12320
  v_mfma_f32_16x16x32_bf16 v[232:235], a[104:107], v[64:67], v[232:235]
  ds_read_b64_tr_b16 a[208:209], v246 offset:12352
  ds_read_b64_tr_b16 a[148:149], v246 offset:13824
  v_mfma_f32_16x16x32_bf16 v[232:235], a[108:111], v[172:175], v[232:235]
  ds_read_b64_tr_b16 a[172:173], v246 offset:13856
  v_cvt_pk_bf16_f32 v164, v140, v141
  v_mfma_f32_16x16x32_bf16 v[232:235], a[112:115], v[160:163], v[232:235]
  buffer_load_dwordx4 v245, s[16:19], s98 offen offset:2048 lds
  v_mfma_f32_16x16x32_bf16 v[232:235], a[116:119], v[196:199], v[232:235]
  s_add_u32 m0, s81, 24576
  ds_read_b64_tr_b16 a[196:197], v246 offset:13888
  ds_read_b128 v[156:159], v15 offset:2048
  v_mfma_f32_16x16x32_bf16 v[176:179], a[120:123], v[72:75], 0
  s_mov_b32 s98, 185088
  ds_read_b128 v[200:203], v15 offset:3072
  v_cvt_pk_bf16_f32 v165, v142, v143
  v_mfma_f32_16x16x32_bf16 v[176:179], a[124:127], v[68:71], v[176:179]
  ds_read_b128 v[216:219], v15 offset:4096
  v_cvt_pk_bf16_f32 v166, v232, v233
  v_mfma_f32_16x16x32_bf16 v[176:179], a[128:131], v[64:67], v[176:179]
  ds_read_b128 v[208:211], v15 offset:5120
  v_cvt_pk_bf16_f32 v167, v234, v235
  v_mfma_f32_16x16x32_bf16 v[176:179], a[132:135], v[172:175], v[176:179]
  buffer_load_dwordx4 v243, s[16:19], s98 offen lds
  v_mfma_f32_16x16x32_bf16 v[176:179], a[136:139], v[160:163], v[176:179]
  ds_read_b128 v[240:243], v15 offset:6144
  ds_read_b128 v[136:139], v15 offset:7168
  v_mfma_f32_16x16x32_bf16 v[176:179], a[140:143], v[196:199], v[176:179]
  s_waitcnt lgkmcnt(5)
  v_mfma_f32_16x16x32_bf16 v[140:143], a[0:3], v[156:159], 0
  s_waitcnt lgkmcnt(4)
  v_mfma_f32_16x16x32_bf16 v[140:143], a[4:7], v[200:203], v[140:143]
  s_waitcnt vmcnt(7)
  ds_read_b64_tr_b16 a[150:151], v246 offset:15360
  s_waitcnt lgkmcnt(4)
  v_mfma_f32_16x16x32_bf16 v[140:143], a[8:11], v[216:219], v[140:143]
  ds_read_b64_tr_b16 a[174:175], v246 offset:15392
  s_waitcnt lgkmcnt(4)
  v_mfma_f32_16x16x32_bf16 v[140:143], a[12:15], v[208:211], v[140:143]
  buffer_load_dwordx4 v244, s[16:19], s98 offen offset:1024 lds
  s_waitcnt lgkmcnt(3)
  v_mfma_f32_16x16x32_bf16 v[140:143], a[16:19], v[240:243], v[140:143]
  ds_read_b64_tr_b16 a[198:199], v246 offset:15424
  s_waitcnt lgkmcnt(3)
  v_mfma_f32_16x16x32_bf16 v[140:143], a[20:23], v[136:139], v[140:143]
  buffer_load_dwordx4 v245, s[16:19], s98 offen offset:2048 lds
  v_mfma_f32_16x16x32_bf16 v[128:131], a[24:27], v[156:159], 0
  s_lshl_b32 s60, s30, 2
  ds_read_b64_tr_b16 a[162:163], v246 offset:16896
  ds_read_b64_tr_b16 a[186:187], v246 offset:16928
  v_mfma_f32_16x16x32_bf16 v[128:131], a[28:31], v[200:203], v[128:131]
  s_add_u32 s60, s60, s28
  ds_read_b64_tr_b16 a[210:211], v246 offset:16960
  v_cvt_pk_bf16_f32 v244, v176, v177
  v_mfma_f32_16x16x32_bf16 v[128:131], a[32:35], v[216:219], v[128:131]
  s_lshl_b32 s60, s60, 6
  v_cvt_pk_bf16_f32 v245, v178, v179
  v_cvt_pk_bf16_f32 v232, v140, v141
  v_mfma_f32_16x16x32_bf16 v[128:131], a[36:39], v[208:211], v[128:131]
  s_add_u32 s60, s60, L_loop-8192-L_pc
  v_cvt_pk_bf16_f32 v233, v142, v143
  v_mfma_f32_16x16x32_bf16 v[128:131], a[40:43], v[240:243], v[128:131]
  s_add_u32 s60, s0, s60
  v_mfma_f32_16x16x32_bf16 v[128:131], a[44:47], v[136:139], v[128:131]
  s_addc_u32 s61, s1, 0
  global_load_dword v25, v123, s[60:61]
  v_mfma_f32_16x16x32_bf16 v[140:143], a[48:51], v[156:159], 0
  s_mov_b32 m0, s58
  v_mfma_f32_16x16x32_bf16 v[140:143], a[52:55], v[200:203], v[140:143]
  buffer_load_dwordx4 v239, s[4:7], s36 offen lds
  v_mfma_f32_16x16x32_bf16 v[140:143], a[56:59], v[216:219], v[140:143]
  s_waitcnt vmcnt(8)
  buffer_load_dwordx4 v239, s[4:7], s37 offen offset:864 lds
  v_mfma_f32_16x16x32_bf16 v[140:143], a[60:63], v[208:211], v[140:143]
  ds_read_b64_tr_b16 a[152:153], v246 offset:18432
  ds_read_b64_tr_b16 a[176:177], v246 offset:18464
  v_mfma_f32_16x16x32_bf16 v[140:143], a[64:67], v[240:243], v[140:143]
  ds_read_b64_tr_b16 a[200:201], v246 offset:18496
  ds_read_b64_tr_b16 a[154:155], v246 offset:19968
  v_mfma_f32_16x16x32_bf16 v[140:143], a[68:71], v[136:139], v[140:143]
  ds_read_b64_tr_b16 a[178:179], v246 offset:20000
  v_cvt_pk_bf16_f32 v234, v128, v129
  v_mfma_f32_16x16x32_bf16 v[176:179], a[72:75], v[156:159], 0
  ds_read_b64_tr_b16 a[202:203], v246 offset:20032
  v_cvt_pk_bf16_f32 v235, v130, v131
  v_mfma_f32_16x16x32_bf16 v[176:179], a[76:79], v[200:203], v[176:179]
  buffer_load_dwordx4 v239, s[4:7], s38 offen offset:1728 lds
  v_mfma_f32_16x16x32_bf16 v[176:179], a[80:83], v[216:219], v[176:179]
  v_cvt_pk_bf16_f32 v116, v140, v141
  v_cvt_pk_bf16_f32 v117, v142, v143
  v_mfma_f32_16x16x32_bf16 v[176:179], a[84:87], v[208:211], v[176:179]
  v_mfma_f32_16x16x32_bf16 v[176:179], a[88:91], v[240:243], v[176:179]
  v_mfma_f32_16x16x32_bf16 v[176:179], a[92:95], v[136:139], v[176:179]
  buffer_load_dwordx4 v239, s[4:7], s39 offen offset:2592 lds
  v_mfma_f32_16x16x32_bf16 v[128:131], a[96:99], v[156:159], 0
  v_mfma_f32_16x16x32_bf16 v[128:131], a[100:103], v[200:203], v[128:131]
  v_cvt_pk_bf16_f32 v140, v176, v177
  v_cvt_pk_bf16_f32 v141, v178, v179
  v_mfma_f32_16x16x32_bf16 v[128:131], a[104:107], v[216:219], v[128:131]
  v_mfma_f32_16x16x32_bf16 v[128:131], a[108:111], v[208:211], v[128:131]
  v_mfma_f32_16x16x32_bf16 v[128:131], a[112:115], v[240:243], v[128:131]
  s_waitcnt vmcnt(8)
  buffer_load_dwordx4 v239, s[4:7], s40 offen offset:3456 lds
  v_mfma_f32_16x16x32_bf16 v[128:131], a[116:119], v[136:139], v[128:131]
  s_mov_b32 m0, s59
  ds_read_b64_tr_b16 a[164:165], v246 offset:21504
  ds_read_b64_tr_b16 a[188:189], v246 offset:21536
  v_mfma_f32_16x16x32_bf16 v[176:179], a[120:123], v[156:159], 0
  ds_read_b64_tr_b16 a[212:213], v246 offset:21568
  ds_read_b64_tr_b16 a[156:157], v246 offset:23040
  v_mfma_f32_16x16x32_bf16 v[176:179], a[124:127], v[200:203], v[176:179]
  ds_read_b64_tr_b16 a[180:181], v246 offset:23072
  v_cvt_pk_bf16_f32 v142, v128, v129
  v_mfma_f32_16x16x32_bf16 v[176:179], a[128:131], v[216:219], v[176:179]
  buffer_load_dwordx4 v239, s[4:7], s41 offen lds
  v_mfma_f32_16x16x32_bf16 v[176:179], a[132:135], v[208:211], v[176:179]
  buffer_load_dwordx4 v239, s[4:7], s42 offen offset:864 lds
  v_mfma_f32_16x16x32_bf16 v[176:179], a[136:139], v[240:243], v[176:179]
  ds_read_b64_tr_b16 a[204:205], v246 offset:23104
  v_cvt_pk_bf16_f32 v143, v130, v131
  v_mfma_f32_16x16x32_bf16 v[176:179], a[140:143], v[136:139], v[176:179]
  s_waitcnt lgkmcnt(4)
  buffer_load_dwordx4 v239, s[4:7], s43 offen offset:1728 lds
  s_nop 5
  v_cvt_pk_bf16_f32 v170, v176, v177
  v_cvt_pk_bf16_f32 v171, v178, v179
  buffer_load_dwordx4 v239, s[4:7], s44 offen offset:2592 lds
  s_waitcnt vmcnt(10)
  ds_read_b64_tr_b16 a[158:159], v246 offset:24576
  ds_read_b64_tr_b16 a[182:183], v246 offset:24608
  ds_read_b64_tr_b16 a[206:207], v246 offset:24640
  s_mov_b32 m0, s71
  ds_read_b64_tr_b16 a[166:167], v246 offset:26112
  s_mov_b32 s98, 0
  ds_read_b64_tr_b16 a[190:191], v246 offset:26144
  ds_read_b64_tr_b16 a[214:215], v246 offset:26176
  s_waitcnt lgkmcnt(0)
  s_barrier
  v_mfma_f32_16x16x32_bf16 v[128:131], a[144:147], v[96:99], 0
  ds_write_b64 v249, v[144:145] offset:768
  v_mfma_f32_16x16x32_bf16 v[128:131], a[148:151], v[92:95], v[128:131]
  ds_write_b64 v249, v[146:147] offset:776
  v_mfma_f32_16x16x32_bf16 v[128:131], a[152:155], v[88:91], v[128:131]
  ds_write_b64 v249, v[120:121] offset:784
  v_mfma_f32_16x16x32_bf16 v[128:131], a[156:159], v[84:87], v[128:131]
  buffer_store_dwordx4 v[144:147], v15, s[12:15], s77 offen offset:3072
  v_mfma_f32_16x16x32_bf16 v[128:131], a[160:163], v[80:83], v[128:131]
  ds_write_b64 v250, v[212:213] offset:768
  v_mfma_f32_16x16x32_bf16 v[128:131], a[164:167], v[76:79], v[128:131]
  ds_write_b64 v250, v[214:215] offset:776
  v_mfma_f32_16x16x32_bf16 v[144:147], a[168:171], v[96:99], 0
  ds_write_b64 v250, v[236:237] offset:784
  v_mfma_f32_16x16x32_bf16 v[144:147], a[172:175], v[92:95], v[144:147]
  v_cvt_pk_bf16_f32 v176, v128, v129
  v_cvt_pk_bf16_f32 v177, v130, v131
  v_mfma_f32_16x16x32_bf16 v[144:147], a[176:179], v[88:91], v[144:147]
  ds_write_b64 v249, v[132:133]
  v_mfma_f32_16x16x32_bf16 v[144:147], a[180:183], v[84:87], v[144:147]
  ds_write_b64 v249, v[134:135] offset:8
  v_mfma_f32_16x16x32_bf16 v[144:147], a[184:187], v[80:83], v[144:147]
  buffer_store_dwordx2 v[120:121], v15, s[12:15], s78 offen
  v_mfma_f32_16x16x32_bf16 v[144:147], a[188:191], v[76:79], v[144:147]
  ds_write_b64 v249, v[112:113] offset:16
  v_mfma_f32_16x16x32_bf16 v[132:135], a[192:195], v[96:99], 0
  ds_write_b64 v250, v[164:165]
  v_mfma_f32_16x16x32_bf16 v[132:135], a[196:199], v[92:95], v[132:135]
  ds_write_b64 v250, v[166:167] offset:8
  v_mfma_f32_16x16x32_bf16 v[132:135], a[200:203], v[88:91], v[132:135]
  v_cvt_pk_bf16_f32 v178, v144, v145
  v_cvt_pk_bf16_f32 v179, v146, v147
  v_mfma_f32_16x16x32_bf16 v[132:135], a[204:207], v[84:87], v[132:135]
  ds_write_b64 v250, v[244:245] offset:16
  v_mfma_f32_16x16x32_bf16 v[132:135], a[208:211], v[80:83], v[132:135]
  ds_write_b64 v247, v[176:177]
  v_mfma_f32_16x16x32_bf16 v[132:135], a[212:215], v[76:79], v[132:135]
  buffer_store_dwordx4 v[212:215], v15, s[12:15], s78 offen offset:1024
  v_mfma_f32_16x16x32_bf16 v[164:167], a[144:147], v[72:75], 0
  ds_write_b64 v247, v[178:179] offset:32
  v_mfma_f32_16x16x32_bf16 v[164:167], a[148:151], v[68:71], v[164:167]
  v_cvt_pk_bf16_f32 v244, v132, v133
  v_cvt_pk_bf16_f32 v245, v134, v135
  v_mfma_f32_16x16x32_bf16 v[164:167], a[152:155], v[64:67], v[164:167]
  ds_write_b64 v247, v[244:245] offset:64
  v_mfma_f32_16x16x32_bf16 v[164:167], a[156:159], v[172:175], v[164:167]
  v_mfma_f32_16x16x32_bf16 v[164:167], a[160:163], v[160:163], v[164:167]
  buffer_store_dwordx2 v[236:237], v15, s[12:15], s78 offen offset:2048
  v_mfma_f32_16x16x32_bf16 v[164:167], a[164:167], v[196:199], v[164:167]
  v_mfma_f32_16x16x32_bf16 v[144:147], a[168:171], v[72:75], 0
  v_mfma_f32_16x16x32_bf16 v[144:147], a[172:175], v[68:71], v[144:147]
  v_cvt_pk_bf16_f32 v132, v164, v165
  v_cvt_pk_bf16_f32 v133, v166, v167
  v_mfma_f32_16x16x32_bf16 v[144:147], a[176:179], v[64:67], v[144:147]
  ds_write_b64 v248, v[132:133]
  v_mfma_f32_16x16x32_bf16 v[144:147], a[180:183], v[172:175], v[144:147]
  v_mfma_f32_16x16x32_bf16 v[144:147], a[184:187], v[160:163], v[144:147]
  v_mfma_f32_16x16x32_bf16 v[144:147], a[188:191], v[196:199], v[144:147]
  v_mfma_f32_16x16x32_bf16 v[164:167], a[192:195], v[72:75], 0
  v_mfma_f32_16x16x32_bf16 v[164:167], a[196:199], v[68:71], v[164:167]
  v_cvt_pk_bf16_f32 v134, v144, v145
  v_cvt_pk_bf16_f32 v135, v146, v147
  v_mfma_f32_16x16x32_bf16 v[164:167], a[200:203], v[64:67], v[164:167]
  ds_write_b64 v248, v[134:135] offset:32
  v_mfma_f32_16x16x32_bf16 v[164:167], a[204:207], v[172:175], v[164:167]
  v_mfma_f32_16x16x32_bf16 v[164:167], a[208:211], v[160:163], v[164:167]
  v_mfma_f32_16x16x32_bf16 v[164:167], a[212:215], v[196:199], v[164:167]
  v_mfma_f32_16x16x32_bf16 v[144:147], v[156:159], a[144:147], 0
  v_mfma_f32_16x16x32_bf16 v[144:147], v[200:203], a[148:151], v[144:147]
  v_cvt_pk_bf16_f32 v120, v164, v165
  v_cvt_pk_bf16_f32 v121, v166, v167
  v_mfma_f32_16x16x32_bf16 v[144:147], v[216:219], a[152:155], v[144:147]
  ds_write_b64 v248, v[120:121] offset:64
  v_mfma_f32_16x16x32_bf16 v[144:147], v[208:211], a[156:159], v[144:147]
  v_mfma_f32_16x16x32_bf16 v[144:147], v[240:243], a[160:163], v[144:147]
  v_mfma_f32_16x16x32_bf16 v[144:147], v[136:139], a[164:167], v[144:147]
  buffer_load_dwordx4 v251, s[20:23], s98 offen lds
  v_mfma_f32_16x16x32_bf16 v[132:135], v[156:159], a[168:171], 0
  v_mfma_f32_16x16x32_bf16 v[132:135], v[200:203], a[172:175], v[132:135]
  ds_read_b128 v[148:151], v15 offset:8192
  v_cvt_pk_bf16_f32 v172, v144, v145
  v_mfma_f32_16x16x32_bf16 v[132:135], v[216:219], a[176:179], v[132:135]
  ds_read_b128 v[152:155], v15 offset:9216
  v_cvt_pk_bf16_f32 v173, v146, v147
  v_mfma_f32_16x16x32_bf16 v[132:135], v[208:211], a[180:183], v[132:135]
  ds_read_b128 v[204:207], v15 offset:10240
  v_mfma_f32_16x16x32_bf16 v[132:135], v[240:243], a[184:187], v[132:135]
  ds_read_b128 v[228:231], v15 offset:11264
  v_mfma_f32_16x16x32_bf16 v[132:135], v[136:139], a[188:191], v[132:135]
  ds_read_b128 v[180:183], v15 offset:12288
  v_mfma_f32_16x16x32_bf16 v[144:147], v[156:159], a[192:195], 0
  ds_read_b128 v[176:179], v15 offset:13312
  v_mfma_f32_16x16x32_bf16 v[144:147], v[200:203], a[196:199], v[144:147]
  v_cvt_pk_bf16_f32 v164, v132, v133
  v_cvt_pk_bf16_f32 v165, v134, v135
  v_mfma_f32_16x16x32_bf16 v[144:147], v[216:219], a[200:203], v[144:147]
  buffer_load_dwordx4 v252, s[20:23], s98 offen offset:1024 lds
  v_mfma_f32_16x16x32_bf16 v[144:147], v[208:211], a[204:207], v[144:147]
  v_mfma_f32_16x16x32_bf16 v[144:147], v[240:243], a[208:211], v[144:147]
  v_mfma_f32_16x16x32_bf16 v[144:147], v[136:139], a[212:215], v[144:147]
  s_waitcnt lgkmcnt(5)
  v_mfma_f32_16x16x32_bf16 v[132:135], a[72:75], v[148:151], 0
  s_waitcnt lgkmcnt(4)
  v_mfma_f32_16x16x32_bf16 v[132:135], a[76:79], v[152:155], v[132:135]
  s_waitcnt lgkmcnt(3)
  v_cvt_pk_bf16_f32 v208, v144, v145
  v_cvt_pk_bf16_f32 v209, v146, v147
  v_mfma_f32_16x16x32_bf16 v[132:135], a[80:83], v[204:207], v[132:135]
  s_waitcnt lgkmcnt(2)
  v_mfma_f32_16x16x32_bf16 v[132:135], a[84:87], v[228:231], v[132:135]
  s_waitcnt lgkmcnt(1)
  v_mfma_f32_16x16x32_bf16 v[132:135], a[88:91], v[180:183], v[132:135]
  s_waitcnt lgkmcnt(0)
  v_mfma_f32_16x16x32_bf16 v[132:135], a[92:95], v[176:179], v[132:135]
  v_mfma_f32_16x16x32_bf16 v[240:243], a[96:99], v[148:151], 0
  v_mfma_f32_16x16x32_bf16 v[240:243], a[100:103], v[152:155], v[240:243]
  v_cvt_pk_bf16_f32 v144, v132, v133
  v_cvt_pk_bf16_f32 v145, v134, v135
  v_mfma_f32_16x16x32_bf16 v[240:243], a[104:107], v[204:207], v[240:243]
  v_mfma_f32_16x16x32_bf16 v[240:243], a[108:111], v[228:231], v[240:243]
  v_mfma_f32_16x16x32_bf16 v[240:243], a[112:115], v[180:183], v[240:243]
  v_mfma_f32_16x16x32_bf16 v[240:243], a[116:119], v[176:179], v[240:243]
  v_mfma_f32_16x16x32_bf16 v[132:135], a[120:123], v[148:151], 0
  buffer_load_dwordx4 v253, s[20:23], s98 offen offset:2048 lds
  v_mfma_f32_16x16x32_bf16 v[132:135], a[124:127], v[152:155], v[132:135]
  s_add_u32 m0, s70, 0
  v_cvt_pk_bf16_f32 v146, v240, v241
  v_cvt_pk_bf16_f32 v147, v242, v243
  v_mfma_f32_16x16x32_bf16 v[132:135], a[128:131], v[204:207], v[132:135]
  s_mov_b32 s98, 12288
  v_mfma_f32_16x16x32_bf16 v[132:135], a[132:135], v[228:231], v[132:135]
  v_mfma_f32_16x16x32_bf16 v[132:135], a[136:139], v[180:183], v[132:135]
  v_mfma_f32_16x16x32_bf16 v[132:135], a[140:143], v[176:179], v[132:135]
  v_mfma_f32_16x16x32_bf16 v[240:243], a[0:3], v[148:151], 0
  v_mfma_f32_16x16x32_bf16 v[240:243], a[4:7], v[152:155], v[240:243]
  v_cvt_pk_bf16_f32 v220, v132, v133
  v_cvt_pk_bf16_f32 v221, v134, v135
  v_mfma_f32_16x16x32_bf16 v[240:243], a[8:11], v[204:207], v[240:243]
  buffer_load_dwordx4 v251, s[20:23], s98 offen lds
  v_mfma_f32_16x16x32_bf16 v[240:243], a[12:15], v[228:231], v[240:243]
  v_mfma_f32_16x16x32_bf16 v[240:243], a[16:19], v[180:183], v[240:243]
  v_mfma_f32_16x16x32_bf16 v[240:243], a[20:23], v[176:179], v[240:243]
  v_mfma_f32_16x16x32_bf16 v[136:139], a[24:27], v[148:151], 0
  v_mfma_f32_16x16x32_bf16 v[136:139], a[28:31], v[152:155], v[136:139]
  v_cvt_pk_bf16_f32 v132, v240, v241
  v_cvt_pk_bf16_f32 v133, v242, v243
  v_mfma_f32_16x16x32_bf16 v[136:139], a[32:35], v[204:207], v[136:139]
  v_mfma_f32_16x16x32_bf16 v[136:139], a[36:39], v[228:231], v[136:139]
  v_mfma_f32_16x16x32_bf16 v[136:139], a[40:43], v[180:183], v[136:139]
  buffer_load_dwordx4 v252, s[20:23], s98 offen offset:1024 lds
  v_mfma_f32_16x16x32_bf16 v[136:139], a[44:47], v[176:179], v[136:139]
  v_mfma_f32_16x16x32_bf16 v[240:243], a[48:51], v[148:151], 0
  v_mfma_f32_16x16x32_bf16 v[240:243], a[52:55], v[152:155], v[240:243]
  v_cvt_pk_bf16_f32 v134, v136, v137
  v_cvt_pk_bf16_f32 v135, v138, v139
  v_mfma_f32_16x16x32_bf16 v[240:243], a[56:59], v[204:207], v[240:243]
  v_mfma_f32_16x16x32_bf16 v[240:243], a[60:63], v[228:231], v[240:243]
  v_mfma_f32_16x16x32_bf16 v[240:243], a[64:67], v[180:183], v[240:243]
  v_mfma_f32_16x16x32_bf16 v[240:243], a[68:71], v[176:179], v[240:243]
  s_waitcnt vmcnt(13)
  ds_read_b64 v[248:249], v9
  v_mfma_f32_16x16x16_bf16 v[128:131], v[170:171], v[116:117], 0
  buffer_load_dwordx4 v253, s[20:23], s98 offen offset:2048 lds
  ds_read_b64 v[112:113], v9 offset:32
  v_mfma_f32_16x16x16_bf16 v[192:195], v[220:221], v[116:117], 0
  ds_read_b64 v[108:109], v9 offset:64
  v_cvt_pk_bf16_f32 v120, v240, v241
  v_cvt_pk_bf16_f32 v121, v242, v243
  v_mfma_f32_16x16x32_bf16 v[128:131], v[140:143], v[232:235], v[128:131]
  s_add_u32 m0, s70, 3072
  ds_read_b128 v[240:243], v3
  ds_read_b128 v[244:247], v3 offset:864
  v_mfma_f32_16x16x32_bf16 v[192:195], v[144:147], v[232:235], v[192:195]
  s_mov_b32 s98, 24576
  ds_read_b128 v[156:159], v3 offset:1728
  v_mfma_f32_16x16x32_bf16 v[224:227], v[148:151], a[144:147], 0
  ds_read_b128 v[160:163], v6
  v_mfma_f32_16x16x32_bf16 v[224:227], v[152:155], a[148:151], v[224:227]
  v_exp_f32 v128, v128
  v_mfma_f32_16x16x32_bf16 v[224:227], v[204:207], a[152:155], v[224:227]
  v_exp_f32 v129, v129
  v_mfma_f32_16x16x32_bf16 v[224:227], v[228:231], a[156:159], v[224:227]
  ds_read_b128 v[212:215], v3 offset:32
  ds_read_b128 v[216:219], v3 offset:896
  v_mfma_f32_16x16x32_bf16 v[224:227], v[180:183], a[160:163], v[224:227]
  buffer_load_dwordx4 v251, s[20:23], s98 offen lds
  v_mfma_f32_16x16x32_bf16 v[224:227], v[176:179], a[164:167], v[224:227]
  s_waitcnt lgkmcnt(4)
  ds_read_b128 v[196:199], v3 offset:1760
  ds_read_b128 v[200:203], v6 offset:32
  v_cvt_pk_bf16_f32 v136, v128, v129
  v_mfma_f32_16x16x16_bf16 v[64:67], a[224:225], v[248:249], 0
  v_exp_f32 v130, v130
  v_mfma_f32_16x16x16_bf16 v[68:71], a[234:235], v[112:113], 0
  v_exp_f32 v131, v131
  v_cvt_pk_bf16_f32 v174, v224, v225
  v_mfma_f32_16x16x16_bf16 v[72:75], a[244:245], v[108:109], 0
  v_exp_f32 v192, v192
  v_exp_f32 v193, v193
  v_smfmac_f32_16x16x64_bf16 v[64:67], a[216:219], v[240:247], v0
  s_waitcnt lgkmcnt(4)
  ds_read_b128 v[240:243], v3 offset:64
  ds_read_b128 v[244:247], v3 offset:928
  v_smfmac_f32_16x16x64_bf16 v[64:67], a[220:223], v[156:163], v0
  ds_read_b128 v[156:159], v3 offset:1792
  v_cvt_pk_bf16_f32 v175, v226, v227
  v_mfma_f32_16x16x32_bf16 v[224:227], v[148:151], a[168:171], 0
  buffer_load_dwordx4 v252, s[20:23], s98 offen offset:1024 lds
  v_mfma_f32_16x16x32_bf16 v[224:227], v[152:155], a[172:175], v[224:227]
  ds_read_b128 v[160:163], v6 offset:64
  v_cvt_pk_bf16_f32 v137, v130, v131
  v_mfma_f32_16x16x32_bf16 v[224:227], v[204:207], a[176:179], v[224:227]
  s_waitcnt lgkmcnt(6)
  v_exp_f32 v194, v194
  v_smfmac_f32_16x16x64_bf16 v[68:71], a[226:229], v[212:219], v0
  s_waitcnt lgkmcnt(4)
  v_cvt_pk_bf16_f32 v138, v192, v193
  v_smfmac_f32_16x16x64_bf16 v[68:71], a[230:233], v[196:203], v0
  v_mul_f32 v122, v64, v64
  v_mfma_f32_16x16x32_bf16 v[224:227], v[228:231], a[180:183], v[224:227]
  v_exp_f32 v195, v195
  v_mfma_f32_16x16x32_bf16 v[224:227], v[180:183], a[184:187], v[224:227]
  v_cvt_pk_bf16_f32 v139, v194, v195
  v_add_f32 v126, v64, v65
  v_mfma_f32_16x16x32_bf16 v[224:227], v[176:179], a[188:191], v[224:227]
  s_waitcnt lgkmcnt(2)
  v_fmac_f32 v122, v65, v65
  v_add_f32 v126, v126, v66
  v_smfmac_f32_16x16x64_bf16 v[72:75], a[236:239], v[240:247], v0
  s_waitcnt lgkmcnt(0)
  v_fmac_f32 v122, v66, v66
  v_smfmac_f32_16x16x64_bf16 v[72:75], a[240:243], v[156:163], v0
  ds_read_b128 v[128:131], v15 offset:14336
  v_cvt_pk_bf16_f32 v166, v224, v225
  v_mfma_f32_16x16x32_bf16 v[240:243], v[148:151], a[192:195], 0
  ds_read_b128 v[148:151], v15 offset:15360
  v_cvt_pk_bf16_f32 v167, v226, v227
  v_mfma_f32_16x16x32_bf16 v[240:243], v[152:155], a[196:199], v[240:243]
  ds_read_b128 v[152:155], v15 offset:16384
  v_add_f32 v126, v126, v67
  v_mfma_f32_16x16x32_bf16 v[240:243], v[204:207], a[200:203], v[240:243]
  ds_read_b128 v[204:207], v15 offset:17408
  v_fmac_f32 v122, v67, v67
  v_mfma_f32_16x16x32_bf16 v[240:243], v[228:231], a[204:207], v[240:243]
  ds_read_b128 v[192:195], v15 offset:18432
  v_add_f32 v126, v126, v68
  v_mfma_f32_16x16x32_bf16 v[240:243], v[180:183], a[208:211], v[240:243]
  ds_read_b128 v[228:231], v15 offset:19456
  v_fmac_f32 v122, v68, v68
  v_mfma_f32_16x16x32_bf16 v[240:243], v[176:179], a[212:215], v[240:243]
  s_waitcnt vmcnt(14)
  ds_read_b64 v[108:109], v10
  v_add_f32 v126, v126, v69
  v_fmac_f32 v122, v69, v69
  v_mfma_f32_16x16x16_bf16 v[176:179], v[170:171], v[120:121], 0
  v_add_f32 v126, v126, v70
  v_fmac_f32 v122, v70, v70
  v_add_f32 v126, v126, v71
  v_mfma_f32_16x16x16_bf16 v[184:187], v[220:221], v[120:121], 0
  v_cvt_pk_bf16_f32 v210, v240, v241
  v_cvt_pk_bf16_f32 v211, v242, v243
  v_fmac_f32 v122, v71, v71
  v_add_f32 v126, v126, v72
  v_mfma_f32_16x16x32_bf16 v[176:179], v[140:143], v[132:135], v[176:179]
  ds_read_b64 v[248:249], v10 offset:32
  ds_read_b64 v[112:113], v10 offset:64
  v_mfma_f32_16x16x32_bf16 v[184:187], v[144:147], v[132:135], v[184:187]
  s_waitcnt lgkmcnt(8)
  ds_read_b128 v[156:159], v4
  v_fmac_f32 v122, v72, v72
  v_mfma_f32_16x16x32_bf16 v[224:227], a[72:75], v[128:131], 0
  s_waitcnt lgkmcnt(8)
  ds_read_b128 v[160:163], v4 offset:864
  v_add_f32 v126, v126, v73
  v_mfma_f32_16x16x32_bf16 v[224:227], a[76:79], v[148:151], v[224:227]
  s_waitcnt lgkmcnt(8)
  ds_read_b128 v[240:243], v4 offset:1728
  v_fmac_f32 v122, v73, v73
  v_mfma_f32_16x16x32_bf16 v[224:227], a[80:83], v[152:155], v[224:227]
  s_waitcnt lgkmcnt(8)
  ds_read_b128 v[244:247], v7
  v_add_f32 v126, v126, v74
  v_mfma_f32_16x16x32_bf16 v[224:227], a[84:87], v[204:207], v[224:227]
  s_waitcnt lgkmcnt(8)
  ds_read_b128 v[212:215], v4 offset:32
  v_fmac_f32 v122, v74, v74
  v_mfma_f32_16x16x32_bf16 v[224:227], a[88:91], v[192:195], v[224:227]
  s_waitcnt lgkmcnt(8)
  ds_read_b128 v[216:219], v4 offset:896
  v_add_f32 v126, v126, v75
  v_mfma_f32_16x16x32_bf16 v[224:227], a[92:95], v[228:231], v[224:227]
  s_waitcnt lgkmcnt(6)
  ds_read_b128 v[196:199], v4 offset:1760
  v_exp_f32 v176, v176
  v_mfma_f32_16x16x16_bf16 v[76:79], a[224:225], v[108:109], 0
  v_exp_f32 v177, v177
  v_fmac_f32 v122, v75, v75
  v_mfma_f32_16x16x16_bf16 v[80:83], a[234:235], v[248:249], 0
  v_exp_f32 v178, v178
  v_cvt_pk_bf16_f32 v180, v224, v225
  v_mfma_f32_16x16x16_bf16 v[84:87], a[244:245], v[112:113], 0
  buffer_load_dwordx4 v253, s[20:23], s98 offen offset:2048 lds
  s_waitcnt lgkmcnt(5)
  v_smfmac_f32_16x16x64_bf16 v[76:79], a[216:219], v[156:163], v0
  s_waitcnt lgkmcnt(3)
  ds_read_b128 v[200:203], v7 offset:32
  ds_read_b128 v[156:159], v4 offset:64
  v_smfmac_f32_16x16x64_bf16 v[76:79], a[220:223], v[240:247], v0
  s_add_u32 m0, s70, 6144
  ds_read_b128 v[160:163], v4 offset:928
  v_cvt_pk_bf16_f32 v181, v226, v227
  v_mfma_f32_16x16x32_bf16 v[236:239], a[96:99], v[128:131], 0
  s_mov_b32 s98, 36864
  buffer_load_dwordx4 v251, s[20:23], s98 offen lds
  v_mfma_f32_16x16x32_bf16 v[236:239], a[100:103], v[148:151], v[236:239]
  ds_read_b128 v[240:243], v4 offset:1792
  ds_read_b128 v[244:247], v7 offset:64
  v_mfma_f32_16x16x32_bf16 v[236:239], a[104:107], v[152:155], v[236:239]
  s_waitcnt lgkmcnt(6)
  v_exp_f32 v179, v179
  v_smfmac_f32_16x16x64_bf16 v[80:83], a[226:229], v[212:219], v0
  s_waitcnt lgkmcnt(5)
  v_cvt_pk_bf16_f32 v224, v176, v177
  s_waitcnt lgkmcnt(4)
  v_smfmac_f32_16x16x64_bf16 v[80:83], a[230:233], v[196:203], v0
  s_waitcnt vmcnt(7)
  buffer_load_dwordx4 v252, s[20:23], s98 offen offset:1024 lds
  v_mfma_f32_16x16x32_bf16 v[236:239], a[108:111], v[204:207], v[236:239]
  v_exp_f32 v184, v184
  v_mfma_f32_16x16x32_bf16 v[236:239], a[112:115], v[192:195], v[236:239]
  v_exp_f32 v185, v185
  v_mfma_f32_16x16x32_bf16 v[236:239], a[116:119], v[228:231], v[236:239]
  s_waitcnt lgkmcnt(2)
  v_exp_f32 v186, v186
  v_smfmac_f32_16x16x64_bf16 v[84:87], a[236:239], v[156:163], v0
  s_waitcnt lgkmcnt(0)
  ds_read_b64_tr_b16 a[250:251], v254
  ds_read_b64_tr_b16 v[100:101], v254 offset:32
  v_smfmac_f32_16x16x64_bf16 v[84:87], a[240:243], v[240:247], v0
  buffer_load_dwordx4 v253, s[20:23], s98 offen offset:2048 lds
  v_mfma_f32_16x16x32_bf16 v[188:191], a[120:123], v[128:131], 0
  s_add_u32 m0, s70, 9216
  v_exp_f32 v187, v187
  v_mfma_f32_16x16x32_bf16 v[188:191], a[124:127], v[148:151], v[188:191]
  s_mov_b32 s98, 49152
  ds_read_b64 v[248:249], v11
  ds_read_b64_tr_b16 v[104:105], v254 offset:64
  v_mfma_f32_16x16x32_bf16 v[188:191], a[128:131], v[152:155], v[188:191]
  ds_read_b64 v[108:109], v11 offset:32
  v_cvt_pk_bf16_f32 v225, v178, v179
  v_mfma_f32_16x16x32_bf16 v[188:191], a[132:135], v[204:207], v[188:191]
  buffer_load_dwordx4 v251, s[20:23], s98 offen lds
  v_mfma_f32_16x16x32_bf16 v[188:191], a[136:139], v[192:195], v[188:191]
  ds_read_b64 v[112:113], v11 offset:64
  ds_read_b128 v[156:159], v5
  v_mfma_f32_16x16x32_bf16 v[188:191], a[140:143], v[228:231], v[188:191]
  ds_read_b128 v[160:163], v5 offset:864
  v_cvt_pk_bf16_f32 v226, v184, v185
  v_mfma_f32_16x16x32_bf16 v[176:179], v[128:131], a[144:147], 0
  ds_read_b128 v[240:243], v5 offset:1728
  v_cvt_pk_bf16_f32 v182, v236, v237
  v_mfma_f32_16x16x32_bf16 v[176:179], v[148:151], a[148:151], v[176:179]
  ds_read_b128 v[244:247], v8
  v_cvt_pk_bf16_f32 v183, v238, v239
  v_mfma_f32_16x16x32_bf16 v[176:179], v[152:155], a[152:155], v[176:179]
  buffer_load_dwordx4 v252, s[20:23], s98 offen offset:1024 lds
  v_mfma_f32_16x16x32_bf16 v[176:179], v[204:207], a[156:159], v[176:179]
  ds_read_b128 v[212:215], v5 offset:32
  ds_read_b128 v[216:219], v5 offset:896
  v_mfma_f32_16x16x32_bf16 v[176:179], v[192:195], a[160:163], v[176:179]
  ds_read_b64_tr_b16 a[252:253], v254 offset:1536
  v_cvt_pk_bf16_f32 v227, v186, v187
  v_mfma_f32_16x16x32_bf16 v[176:179], v[228:231], a[164:167], v[176:179]
  s_waitcnt lgkmcnt(6)
  ds_read_b128 v[196:199], v5 offset:1760
  v_cvt_pk_bf16_f32 v222, v188, v189
  v_cvt_pk_bf16_f32 v223, v190, v191
  v_mfma_f32_16x16x16_bf16 v[88:91], a[224:225], v[248:249], 0
  v_mul_f32 v168, v76, v76
  v_add_f32 v239, v76, v77
  v_fmac_f32 v168, v77, v77
  v_mfma_f32_16x16x16_bf16 v[92:95], a[234:235], v[108:109], 0
  v_cvt_pk_bf16_f32 v108, v176, v177
  v_cvt_pk_bf16_f32 v109, v178, v179
  v_add_f32 v239, v239, v78
  v_mfma_f32_16x16x16_bf16 v[96:99], a[244:245], v[112:113], 0
  buffer_load_dwordx4 v253, s[20:23], s98 offen offset:2048 lds
  s_waitcnt lgkmcnt(6)
  v_smfmac_f32_16x16x64_bf16 v[88:91], a[216:219], v[156:163], v0
  s_waitcnt lgkmcnt(4)
  ds_read_b128 v[200:203], v8 offset:32
  ds_read_b128 v[156:159], v5 offset:64
  v_smfmac_f32_16x16x64_bf16 v[88:91], a[220:223], v[240:247], v0
  s_add_u32 m0, s70, 12288
  ds_read_b128 v[160:163], v5 offset:928
  v_fmac_f32 v168, v78, v78
  v_mfma_f32_16x16x32_bf16 v[176:179], v[128:131], a[168:171], 0
  s_mov_b32 s98, 61440
  buffer_load_dwordx4 v251, s[20:23], s98 offen lds
  v_mfma_f32_16x16x32_bf16 v[176:179], v[148:151], a[172:175], v[176:179]
  ds_read_b128 v[240:243], v5 offset:1792
  ds_read_b128 v[244:247], v8 offset:64
  v_mfma_f32_16x16x32_bf16 v[176:179], v[152:155], a[176:179], v[176:179]
  s_waitcnt lgkmcnt(7)
  ds_read_b64 v[236:237], v19 offset:16
  ds_read2_b64 v[248:251], v19 offset0:0 offset1:1
  v_smfmac_f32_16x16x64_bf16 v[92:95], a[226:229], v[212:219], v0
  s_waitcnt lgkmcnt(7)
  v_mul_f32 v238, v88, v88
  s_waitcnt lgkmcnt(6)
  v_smfmac_f32_16x16x64_bf16 v[92:95], a[230:233], v[196:203], v0
  buffer_load_dwordx4 v252, s[20:23], s98 offen offset:1024 lds
  v_mfma_f32_16x16x32_bf16 v[176:179], v[204:207], a[180:183], v[176:179]
  ds_read_b64_tr_b16 v[102:103], v254 offset:1568
  ds_read_b64_tr_b16 v[106:107], v254 offset:1600
  v_mfma_f32_16x16x32_bf16 v[176:179], v[192:195], a[184:187], v[176:179]
  v_add_f32 v254, v88, v89
  v_fmac_f32 v238, v89, v89
  v_mfma_f32_16x16x32_bf16 v[176:179], v[228:231], a[188:191], v[176:179]
  s_waitcnt lgkmcnt(6)
  v_add_f32 v254, v254, v90
  v_fmac_f32 v238, v90, v90
  v_smfmac_f32_16x16x64_bf16 v[96:99], a[236:239], v[156:163], v0
  s_waitcnt lgkmcnt(4)
  buffer_load_dwordx4 v253, s[20:23], s98 offen offset:2048 lds
  v_smfmac_f32_16x16x64_bf16 v[96:99], a[240:243], v[240:247], v0
  s_waitcnt lgkmcnt(3)
  v_add_f32 v254, v254, v91
  v_fmac_f32 v238, v91, v91
  v_mfma_f32_16x16x16_bf16 v[156:159], v[222:223], v[116:117], 0
  v_add_f32 v239, v239, v79
  v_fmac_f32 v168, v79, v79
  v_add_f32 v254, v254, v92
  v_mfma_f32_16x16x16_bf16 v[240:243], v[236:237], v[116:117], v[2:5]
  v_fmac_f32 v238, v92, v92
  v_add_f32 v239, v239, v80
  v_fmac_f32 v168, v80, v80
  v_add_f32 v254, v254, v93
  v_mfma_f32_16x16x32_bf16 v[156:159], v[180:183], v[232:235], v[156:159]
  s_waitcnt lgkmcnt(2)
  v_fmac_f32 v238, v93, v93
  v_add_f32 v239, v239, v81
  v_mfma_f32_16x16x32_bf16 v[240:243], v[248:251], v[232:235], v[240:243]
  s_lshl_b32 s60, s31, 5
  v_fmac_f32 v168, v81, v81
  v_add_f32 v254, v254, v94
  v_mfma_f32_16x16x32_bf16 v[232:235], v[128:131], a[192:195], 0
  s_add_u32 s61, s60, s30
  v_fmac_f32 v238, v94, v94
  v_add_f32 v239, v239, v82
  v_mfma_f32_16x16x32_bf16 v[232:235], v[148:151], a[196:199], v[232:235]
  s_add_u32 s60, s60, s29
  v_fmac_f32 v168, v82, v82
  v_add_f32 v254, v254, v95
  v_mfma_f32_16x16x32_bf16 v[232:235], v[152:155], a[200:203], v[232:235]
  s_mul_i32 s62, s60, 7183
  v_fmac_f32 v238, v95, v95
  v_add_f32 v239, v239, v83
  v_mfma_f32_16x16x32_bf16 v[232:235], v[204:207], a[204:207], v[232:235]
  s_lshr_b32 s62, s62, 22
  v_fmac_f32 v168, v83, v83
  v_add_f32 v254, v254, v96
  v_mfma_f32_16x16x32_bf16 v[232:235], v[192:195], a[208:211], v[232:235]
  s_mul_i32 s63, s62, 584
  v_fmac_f32 v238, v96, v96
  v_add_f32 v239, v239, v84
  v_mfma_f32_16x16x32_bf16 v[232:235], v[228:231], a[212:215], v[232:235]
  s_sub_u32 s63, s60, s63
  v_fmac_f32 v168, v84, v84
  v_add_f32 v254, v254, v97
  v_fmac_f32 v238, v97, v97
  v_mfma_f32_16x16x16_bf16 v[160:163], v[222:223], v[120:121], 0
  v_add_f32 v239, v239, v85
  v_fmac_f32 v168, v85, v85
  v_add_f32 v254, v254, v98
  v_mfma_f32_16x16x16_bf16 v[244:247], v[236:237], v[120:121], v[2:5]
  v_fmac_f32 v238, v98, v98
  v_add_f32 v239, v239, v86
  v_fmac_f32 v168, v86, v86
  v_add_f32 v254, v254, v99
  v_mfma_f32_16x16x32_bf16 v[160:163], v[180:183], v[132:135], v[160:163]
  s_lshr_b32 s64, s63, 3
  v_fmac_f32 v238, v99, v99
  v_add_f32 v239, v239, v87
  v_mfma_f32_16x16x32_bf16 v[244:247], v[248:251], v[132:135], v[244:247]
  s_and_b32 s65, s63, 7
  v_fmac_f32 v168, v87, v87
  v_cvt_pk_bf16_f32 v112, v176, v177
  v_mfma_f32_16x16x32_bf16 v[196:199], a[0:3], v[128:131], 0
  s_lshl_b32 s66, s62, 3
  v_cvt_pk_bf16_f32 v113, v178, v179
  v_cvt_pk_bf16_f32 v116, v232, v233
  v_mfma_f32_16x16x32_bf16 v[196:199], a[4:7], v[148:151], v[196:199]
  s_add_u32 s65, s65, s66
  v_permlane32_swap_b32 v254, v238
  v_mfma_f32_16x16x32_bf16 v[196:199], a[8:11], v[152:155], v[196:199]
  s_cmp_ge_u32 s60, 5256
  v_permlane32_swap_b32 v126, v122
  v_mfma_f32_16x16x32_bf16 v[196:199], a[12:15], v[204:207], v[196:199]
  s_cselect_b32 s64, s63, s64
  v_permlane32_swap_b32 v239, v168
  v_mfma_f32_16x16x32_bf16 v[196:199], a[16:19], v[192:195], v[196:199]
  s_cselect_b32 s65, 72, s65
  v_add_f32 v254, v254, v238
  v_add_f32 v126, v126, v122
  v_mfma_f32_16x16x32_bf16 v[196:199], a[20:23], v[228:231], v[196:199]
  s_waitcnt lgkmcnt(0)
  v_add_f32 v239, v239, v168
  v_mov_b32 v122, v254
  v_cvt_pk_bf16_f32 v117, v234, v235
  v_permlane16_swap_b32 v126, v239
  v_permlane16_swap_b32 v254, v122
  v_add_f32 v126, v126, v239
  v_add_f32 v254, v254, v122
  s_mul_i32 s66, s65, 1373568
  s_mul_i32 s67, s64, 2688
  ds_write_b32 v111, v126
  ds_write_b32 v111, v254 offset:512
  v_exp_f32 v156, v156
  v_exp_f32 v157, v157
  v_exp_f32 v158, v158
  v_exp_f32 v159, v159
  v_exp_f32 v240, v240
  v_exp_f32 v160, v160
  v_exp_f32 v161, v161
  v_exp_f32 v162, v162
  v_exp_f32 v163, v163
  v_exp_f32 v244, v244
  v_cvt_pk_bf16_f32 v120, v156, v157
  v_cvt_pk_bf16_f32 v121, v158, v159
  s_waitcnt lgkmcnt(0)
  s_barrier
  v_mfma_f32_16x16x32_bf16 v[232:235], a[24:27], v[128:131], 0
  s_add_u32 s35, s66, s67
  ds_read_u16 v110, v20
  ds_read_u16 v114, v20 offset:32
  v_mfma_f32_16x16x32_bf16 v[232:235], a[28:31], v[148:151], v[232:235]
  s_cmp_ge_u32 s61, 667
  ds_read_u16 v118, v20 offset:64
  ds_read_b64 v[252:253], v19 offset:784
  v_mfma_f32_16x16x32_bf16 v[232:235], a[32:35], v[152:155], v[232:235]
  s_cselect_b32 s35, 268435456, s35
  ds_read2_b64 v[132:135], v19 offset0:96 offset1:97
  v_cvt_pk_bf16_f32 v122, v240, 0
  v_mfma_f32_16x16x32_bf16 v[232:235], a[36:39], v[204:207], v[232:235]
  s_cmp_ge_u32 s60, 5329
  ds_read_b128 v[240:243], v15
  v_cvt_pk_bf16_f32 v176, v196, v197
  v_mfma_f32_16x16x32_bf16 v[232:235], a[40:43], v[192:195], v[232:235]
  s_cselect_b32 s35, 268435456, s35
  ds_read_b128 v[200:203], v15 offset:1024
  v_cvt_pk_bf16_f32 v177, v198, v199
  v_mfma_f32_16x16x32_bf16 v[232:235], a[44:47], v[228:231], v[232:235]
  s_cmp_eq_u32 s65, 0
  v_cvt_pk_bf16_f32 v124, v160, v161
  v_cvt_pk_bf16_f32 v125, v162, v163
  v_mfma_f32_16x16x32_bf16 v[156:159], a[246:249], v[136:139], 0
  s_cselect_b32 s36, 268435456, s35
  v_cvt_pk_bf16_f32 v126, v244, 0
  v_add_u32 v19, 1160, v19
  v_mfma_f32_16x16x32_bf16 v[156:159], a[246:249], v[120:123], v[156:159]
  s_add_u32 s37, s35, 195360
  v_cvt_pk_bf16_f32 v178, v232, v233
  v_cvt_pk_bf16_f32 v179, v234, v235
  v_mfma_f32_16x16x32_bf16 v[244:247], v[172:175], v[136:139], 0
  s_waitcnt lgkmcnt(6)
  v_mfma_f32_16x16x32_bf16 v[244:247], v[108:111], v[120:123], v[244:247]
  s_add_u32 s38, s35, 390720
  v_mul_f32 v156, 0x3ee9a3cd, v156
  v_mfma_f32_16x16x32_bf16 v[212:215], v[164:167], v[136:139], 0
  s_waitcnt lgkmcnt(1)
  v_add_f32 v240, v240, v241
  v_add_f32 v242, v242, v243
  v_mfma_f32_16x16x32_bf16 v[212:215], v[112:115], v[120:123], v[212:215]
  s_waitcnt lgkmcnt(0)
  v_add_f32 v200, v200, v201
  v_add_f32 v202, v202, v203
  v_mfma_f32_16x16x32_bf16 v[232:235], v[208:211], v[136:139], 0
  s_add_u32 s39, s35, 586080
  v_add_f32 v240, v240, v242
  v_add_f32 v200, v200, v202
  v_mfma_f32_16x16x32_bf16 v[232:235], v[116:119], v[120:123], v[232:235]
  s_add_u32 s40, s35, 781440
  v_mul_f32 v241, 0x3baaaaab, v240
  v_fma_f32 v200, -v241, v240, v200
  v_max_f32 v200, 0, v200
  v_mfma_f32_16x16x16_bf16 v[196:199], v[252:253], v[170:171], 0
  v_add_f32 v200, 0x3afba882, v200
  v_rsq_f32 v200, v200
  v_mfma_f32_16x16x16_bf16 v[136:139], v[252:253], v[220:221], 0
  v_mul_f32 v200, 0x40ca568a, v200
  v_mul_f32 v201, -v241, v200
  v_mfma_f32_16x16x16_bf16 v[216:219], v[252:253], v[222:223], 0
  ds_write_b64 v115, v[200:201]
  v_mfma_f32_16x16x16_bf16 v[200:203], v[252:253], v[236:237], 0
  ds_read_b64 v[238:239], v119
  ds_read_b64 v[252:253], v119 offset:128
  v_rcp_f32 v254, v156
  v_mfma_f32_16x16x32_bf16 v[196:199], v[132:135], v[140:143], v[196:199]
  s_add_u32 s41, s35, 981120
  v_mul_f32 v244, v244, v254
  v_mul_f32 v245, v245, v254
  v_mfma_f32_16x16x32_bf16 v[136:139], v[132:135], v[144:147], v[136:139]
  s_add_u32 s42, s35, 1176480
  v_cvt_pk_bf16_f32 v160, v244, v245
  v_mul_f32 v246, v246, v254
  v_mfma_f32_16x16x32_bf16 v[216:219], v[132:135], v[180:183], v[216:219]
  s_add_u32 s43, s35, 1371840
  v_mul_f32 v247, v247, v254
  v_cvt_pk_bf16_f32 v161, v246, v247
  v_mfma_f32_16x16x32_bf16 v[200:203], v[132:135], v[248:251], v[200:203]
  s_add_u32 s44, s35, 1567200
  v_cndmask_b32 v168, v136, v196, s[56:57]
  v_mul_f32 v212, v212, v254
  v_mfma_f32_16x16x32_bf16 v[240:243], a[246:249], v[224:227], 0
  s_cmp_eq_u32 s64, 0
  v_mul_f32 v213, v213, v254
  v_cvt_pk_bf16_f32 v162, v212, v213
  v_mfma_f32_16x16x32_bf16 v[240:243], a[246:249], v[124:127], v[240:243]
  s_waitcnt lgkmcnt(0)
  v_cndmask_b32 v122, v216, v200, s[56:57]
  v_cndmask_b32 v168, v122, v168, s[46:47]
  v_mfma_f32_16x16x32_bf16 v[216:219], v[172:175], v[224:227], 0
  s_cselect_b64 s[52:53], s[48:49], 0
  v_exp_f32 v168, v168
  v_mfma_f32_16x16x32_bf16 v[216:219], v[108:111], v[124:127], v[216:219]
  s_cmp_eq_u32 s64, 72
  v_cvt_pk_bf16_f32 v168, v168, 0
  v_cndmask_b32 v122, 0, v168, s[54:55]
  v_mfma_f32_16x16x32_bf16 v[196:199], v[164:167], v[224:227], 0
  s_cselect_b64 s[52:53], s[50:51], s[52:53]
  ds_write_b16 v26, v168
  v_mfma_f32_16x16x32_bf16 v[196:199], v[112:115], v[124:127], v[196:199]
  s_add_u32 s31, s31, 1
  ds_read_b128 v[136:139], v27
  ds_read_b64 v[120:121], v27 offset:16
  v_mfma_f32_16x16x32_bf16 v[244:247], v[208:211], v[224:227], 0
  s_sub_u32 s68, s35, 196608
  v_fma_f32 v132, v64, v238, v239
  v_fma_f32 v168, v65, v238, v239
  v_mfma_f32_16x16x32_bf16 v[244:247], v[116:119], v[124:127], v[244:247]
  s_waitcnt vmcnt(9)
  ds_read_b64_tr_b16 v[200:201], v255
  ds_read_b64_tr_b16 v[188:189], v255 offset:32
  v_mfma_f32_16x16x32_bf16 v[184:187], a[48:51], v[128:131], 0
  s_cselect_b32 s68, s35, s68
  buffer_load_dword v25, v24, s[24:27], s68 offen
  v_mfma_f32_16x16x32_bf16 v[184:187], a[52:55], v[148:151], v[184:187]
  s_mov_b32 s32, s33
  ds_read_b64_tr_b16 v[128:129], v255 offset:64
  ds_read_b64_tr_b16 v[224:225], v255 offset:1536
  v_mfma_f32_16x16x32_bf16 v[184:187], a[56:59], v[152:155], v[184:187]
  s_mov_b32 s33, s34
  ds_read_b64_tr_b16 v[148:149], v255 offset:1568
  ds_read_b64_tr_b16 v[152:153], v255 offset:1600
  v_mfma_f32_16x16x32_bf16 v[184:187], a[60:63], v[204:207], v[184:187]
  s_mov_b32 s34, s35
  ds_read_b64_tr_b16 v[226:227], v255 offset:3072
  v_cvt_pk_bf16_f32 v132, v132, v168
  v_mfma_f32_16x16x32_bf16 v[184:187], a[64:67], v[192:195], v[184:187]
  s_lshl_b32 s60, s30, 2
  ds_read_b64_tr_b16 v[150:151], v255 offset:3104
  ds_read_b64_tr_b16 v[154:155], v255 offset:3136
  v_mfma_f32_16x16x32_bf16 v[184:187], a[68:71], v[228:231], v[184:187]
  s_waitcnt lgkmcnt(10)
  ds_read_b64_tr_b16 v[202:203], v255 offset:4608
  v_fma_f32 v133, v66, v238, v239
  v_mfma_f32_16x16x32_bf16 v[228:231], a[246:249], v[136:139], 0
  s_waitcnt lgkmcnt(10)
  ds_read_b64_tr_b16 v[190:191], v255 offset:4640
  v_fma_f32 v126, v67, v238, v239
  v_mfma_f32_16x16x32_bf16 v[228:231], a[246:249], v[120:123], v[228:231]
  s_add_u32 s60, s60, s28
  ds_read_b64_tr_b16 v[130:131], v255 offset:4672
  v_cvt_pk_bf16_f32 v133, v133, v126
  v_mfma_f32_16x16x32_bf16 v[192:195], v[136:139], v[172:175], 0
  s_lshl_b32 s60, s60, 7
  v_fma_f32 v134, v68, v238, v239
  v_fma_f32 v126, v69, v238, v239
  v_mfma_f32_16x16x32_bf16 v[192:195], v[120:123], v[108:111], v[192:195]
  s_add_u32 s60, s60, L_loop-L_pc
  v_cvt_pk_bf16_f32 v134, v134, v126
  v_fma_f32 v135, v70, v238, v239
  v_mfma_f32_16x16x32_bf16 v[204:207], v[136:139], v[164:167], 0
  s_waitcnt lgkmcnt(4)
  ds_write_b128 v18, v[224:227]
  v_mfma_f32_16x16x32_bf16 v[204:207], v[120:123], v[112:115], v[204:207]
  s_waitcnt lgkmcnt(3)
  v_fma_f32 v126, v71, v238, v239
  v_cvt_pk_bf16_f32 v135, v135, v126
  v_mfma_f32_16x16x32_bf16 v[224:227], v[136:139], v[208:211], 0
  s_waitcnt lgkmcnt(2)
  ds_write_b128 v18, v[148:151] offset:1024
  v_mfma_f32_16x16x32_bf16 v[224:227], v[120:123], v[116:119], v[224:227]
  s_waitcnt lgkmcnt(2)
  v_cvt_pk_bf16_f32 v124, v184, v185
  s_add_u32 s60, s0, s60
  s_addc_u32 s61, s1, 0
  global_load_dword v25, v169, s[60:61]
  ds_write_b128 v18, v[152:155] offset:2048
  v_cvt_pk_bf16_f32 v125, v186, v187
  v_fma_f32 v168, v72, v238, v239
  v_fma_f32 v122, v73, v238, v239
  v_mfma_f32_16x16x16_bf16 v[136:139], v[170:171], v[124:125], 0
  v_cvt_pk_bf16_f32 v168, v168, v122
  v_fma_f32 v169, v74, v238, v239
  v_fma_f32 v122, v75, v238, v239
  v_mfma_f32_16x16x16_bf16 v[148:151], v[220:221], v[124:125], 0
  v_cvt_pk_bf16_f32 v169, v169, v122
  v_mul_f32 v240, 0x3ee9a3cd, v240
  v_fma_f32 v184, v76, v252, v253
  v_mfma_f32_16x16x16_bf16 v[152:155], v[222:223], v[124:125], 0
  v_rcp_f32 v122, v240
  v_fma_f32 v126, v77, v252, v253
  v_mfma_f32_16x16x16_bf16 v[220:223], v[236:237], v[124:125], v[2:5]
  v_cvt_pk_bf16_f32 v184, v184, v126
  v_fma_f32 v185, v78, v252, v253
  v_fma_f32 v126, v79, v252, v253
  v_cvt_pk_bf16_f32 v185, v185, v126
  v_mfma_f32_16x16x32_bf16 v[136:139], v[140:143], v[176:179], v[136:139]
  ds_write_b128 v18, v[200:203] offset:3072
  v_mfma_f32_16x16x32_bf16 v[148:151], v[144:147], v[176:179], v[148:151]
  s_nop 3
  v_exp_f32 v136, v136
  v_mfma_f32_16x16x32_bf16 v[152:155], v[180:183], v[176:179], v[152:155]
  ds_write_b128 v18, v[188:191] offset:4096
  v_mfma_f32_16x16x32_bf16 v[220:223], v[248:251], v[176:179], v[220:223]
  v_exp_f32 v137, v137
  ds_write_b128 v18, v[128:131] offset:5120
  v_exp_f32 v138, v138
  v_exp_f32 v139, v139
  v_exp_f32 v148, v148
  ds_write_b128 v16, v[132:135] offset:2048
  v_exp_f32 v149, v149
  v_exp_f32 v150, v150
  v_exp_f32 v151, v151
  ds_write_b64 v17, v[168:169] offset:2048
  v_exp_f32 v152, v152
  v_exp_f32 v153, v153
  v_exp_f32 v154, v154
  v_exp_f32 v155, v155
  v_exp_f32 v220, v220
  v_cvt_pk_bf16_f32 v188, v136, v137
  v_cvt_pk_bf16_f32 v189, v138, v139
  v_cvt_pk_bf16_f32 v190, v148, v149
  v_cvt_pk_bf16_f32 v191, v150, v151
  v_cvt_pk_bf16_f32 v124, v152, v153
  v_cvt_pk_bf16_f32 v125, v154, v155
  v_cvt_pk_bf16_f32 v126, v220, 0
  s_waitcnt vmcnt(8)
  ds_read_b64_tr_b16 v[152:153], v255 offset:6144
  ds_read_b64_tr_b16 v[220:221], v255 offset:6176
  ds_read_b64_tr_b16 v[180:181], v255 offset:6208
  ds_read_b64_tr_b16 v[154:155], v255 offset:7680
  v_fma_f32 v186, v80, v252, v253
  v_fma_f32 v121, v81, v252, v253
  s_waitcnt lgkmcnt(4)
  s_barrier
  ds_read_b128 v[128:131], v15 offset:2048
  ds_read_b128 v[132:135], v15 offset:3072
  ds_read_b128 v[136:139], v15 offset:4096
  v_cvt_pk_bf16_f32 v186, v186, v121
  ds_read_b128 v[140:143], v15 offset:5120
  v_fma_f32 v187, v82, v252, v253
  ds_read_b128 v[144:147], v15 offset:6144
  v_fma_f32 v121, v83, v252, v253
  ds_read_b128 v[148:151], v15 offset:7168
  v_cvt_pk_bf16_f32 v187, v187, v121
  ds_read_b64_tr_b16 v[222:223], v255 offset:7712
  v_mul_f32 v214, v214, v254
  v_mul_f32 v215, v215, v254
  s_waitcnt lgkmcnt(6)
  v_mfma_f32_16x16x32_bf16 v[176:179], a[0:3], v[128:131], 0
  v_cvt_pk_bf16_f32 v163, v214, v215
  s_waitcnt lgkmcnt(5)
  v_mfma_f32_16x16x32_bf16 v[176:179], a[4:7], v[132:135], v[176:179]
  ds_read_b64_tr_b16 v[182:183], v255 offset:7744
  s_waitcnt lgkmcnt(5)
  v_mfma_f32_16x16x32_bf16 v[176:179], a[8:11], v[136:139], v[176:179]
  v_mul_f32 v216, v216, v122
  s_waitcnt lgkmcnt(4)
  v_mfma_f32_16x16x32_bf16 v[176:179], a[12:15], v[140:143], v[176:179]
  v_mul_f32 v217, v217, v122
  s_waitcnt lgkmcnt(3)
  v_mfma_f32_16x16x32_bf16 v[176:179], a[16:19], v[144:147], v[176:179]
  v_cvt_pk_bf16_f32 v212, v216, v217
  s_waitcnt lgkmcnt(2)
  v_mfma_f32_16x16x32_bf16 v[176:179], a[20:23], v[148:151], v[176:179]
  s_waitcnt lgkmcnt(1)
  ds_write_b128 v18, v[152:155] offset:6144
  v_mfma_f32_16x16x32_bf16 v[248:251], a[24:27], v[128:131], 0
  s_waitcnt lgkmcnt(1)
  s_nop 2
  v_cvt_pk_bf16_f32 v152, v176, v177
  v_cvt_pk_bf16_f32 v153, v178, v179
  v_mfma_f32_16x16x32_bf16 v[248:251], a[28:31], v[132:135], v[248:251]
  ds_write_b128 v18, v[220:223] offset:7168
  v_mfma_f32_16x16x32_bf16 v[248:251], a[32:35], v[136:139], v[248:251]
  v_mul_f32 v218, v218, v122
  v_mul_f32 v219, v219, v122
  v_mfma_f32_16x16x32_bf16 v[248:251], a[36:39], v[140:143], v[248:251]
  ds_write_b128 v18, v[180:183] offset:8192
  v_mfma_f32_16x16x32_bf16 v[248:251], a[40:43], v[144:147], v[248:251]
  s_waitcnt vmcnt(2)
  v_cvt_pk_bf16_f32 v213, v218, v219
  v_mul_f32 v196, v196, v122
  v_mfma_f32_16x16x32_bf16 v[248:251], a[44:47], v[148:151], v[248:251]
  v_mul_f32 v197, v197, v122
  v_cvt_pk_bf16_f32 v214, v196, v197
  v_mfma_f32_16x16x32_bf16 v[216:219], a[246:249], v[188:191], 0
  ds_write_b128 v16, v[184:187] offset:8192
  v_mfma_f32_16x16x32_bf16 v[216:219], a[246:249], v[124:127], v[216:219]
  v_cvt_pk_bf16_f32 v154, v248, v249
  v_cvt_pk_bf16_f32 v155, v250, v251
  v_mfma_f32_16x16x32_bf16 v[248:251], v[172:175], v[188:191], 0
  ds_write_b128 v16, v[160:163] offset:20480
  v_mfma_f32_16x16x32_bf16 v[248:251], v[108:111], v[124:127], v[248:251]
  v_mul_f32 v216, 0x3ee9a3cd, v216
  v_mul_f32 v198, v198, v122
  v_mfma_f32_16x16x32_bf16 v[160:163], v[164:167], v[188:191], 0
  v_rcp_f32 v110, v216
  v_mfma_f32_16x16x32_bf16 v[160:163], v[112:115], v[124:127], v[160:163]
  ds_read_b64_tr_b16 v[164:165], v255 offset:9216
  ds_read_b64_tr_b16 v[172:173], v255 offset:9248
  v_mfma_f32_16x16x32_bf16 v[184:187], v[208:211], v[188:191], 0
  ds_read_b64_tr_b16 v[208:209], v255 offset:9280
  v_mul_f32 v199, v199, v122
  v_mfma_f32_16x16x32_bf16 v[184:187], v[116:119], v[124:127], v[184:187]
  ds_read_b64_tr_b16 v[188:189], v255 offset:10752
  ds_read_b64_tr_b16 v[180:181], v255 offset:10784
  v_mfma_f32_16x16x32_bf16 v[176:179], a[48:51], v[128:131], 0
  ds_read_b64_tr_b16 v[220:221], v255 offset:10816
  v_cvt_pk_bf16_f32 v215, v198, v199
  v_mfma_f32_16x16x32_bf16 v[176:179], a[52:55], v[132:135], v[176:179]
  ds_write_b128 v16, v[212:215] offset:26624
  v_mfma_f32_16x16x32_bf16 v[176:179], a[56:59], v[136:139], v[176:179]
  v_mul_f32 v248, v248, v110
  v_mul_f32 v249, v249, v110
  v_mfma_f32_16x16x32_bf16 v[176:179], a[60:63], v[140:143], v[176:179]
  v_mul_f32 v250, v250, v110
  v_mul_f32 v251, v251, v110
  v_mfma_f32_16x16x32_bf16 v[176:179], a[64:67], v[144:147], v[176:179]
  ds_read_b64_tr_b16 v[190:191], v255 offset:12288
  ds_read_b64_tr_b16 v[182:183], v255 offset:12320
  v_mfma_f32_16x16x32_bf16 v[176:179], a[68:71], v[148:151], v[176:179]
  ds_read_b64_tr_b16 v[222:223], v255 offset:12352
  v_mul_f32 v160, v160, v110
  v_mfma_f32_16x16x32_bf16 v[212:215], a[72:75], v[128:131], 0
  ds_read_b64_tr_b16 v[166:167], v255 offset:13824
  ds_read_b64_tr_b16 v[174:175], v255 offset:13856
  v_mfma_f32_16x16x32_bf16 v[212:215], a[76:79], v[132:135], v[212:215]
  ds_read_b64_tr_b16 v[210:211], v255 offset:13888
  v_mul_f32 v161, v161, v110
  v_mfma_f32_16x16x32_bf16 v[212:215], a[80:83], v[136:139], v[212:215]
  v_mul_f32 v162, v162, v110
  v_mul_f32 v163, v163, v110
  v_mfma_f32_16x16x32_bf16 v[212:215], a[84:87], v[140:143], v[212:215]
  v_mul_f32 v228, 0x3ee9a3cd, v228
  v_cvt_pk_bf16_f32 v196, v248, v249
  v_mfma_f32_16x16x32_bf16 v[212:215], a[88:91], v[144:147], v[212:215]
  s_waitcnt lgkmcnt(5)
  ds_write_b128 v18, v[188:191] offset:9216
  v_mfma_f32_16x16x32_bf16 v[212:215], a[92:95], v[148:151], v[212:215]
  s_waitcnt lgkmcnt(4)
  v_cvt_pk_bf16_f32 v197, v250, v251
  v_cvt_pk_bf16_f32 v198, v160, v161
  v_mfma_f32_16x16x32_bf16 v[248:251], a[96:99], v[128:131], 0
  s_waitcnt lgkmcnt(2)
  ds_write_b128 v18, v[180:183] offset:10240
  v_mfma_f32_16x16x32_bf16 v[248:251], a[100:103], v[132:135], v[248:251]
  s_waitcnt lgkmcnt(2)
  v_cvt_pk_bf16_f32 v199, v162, v163
  v_cndmask_b32 v255, v204, v192, s[54:55]
  v_mfma_f32_16x16x32_bf16 v[248:251], a[104:107], v[136:139], v[248:251]
  ds_write_b128 v18, v[220:223] offset:11264
  v_mfma_f32_16x16x32_bf16 v[248:251], a[108:111], v[140:143], v[248:251]
  v_rcp_f32 v126, v228
  v_mfma_f32_16x16x32_bf16 v[248:251], a[112:115], v[144:147], v[248:251]
  v_fma_f32 v124, v84, v252, v253
  v_fma_f32 v118, v85, v252, v253
  v_mfma_f32_16x16x32_bf16 v[248:251], a[116:119], v[148:151], v[248:251]
  ds_write_b128 v18, v[164:167] offset:12288
  v_mfma_f32_16x16x32_bf16 v[160:163], a[120:123], v[128:131], 0
  v_cvt_pk_bf16_f32 v124, v124, v118
  v_fma_f32 v125, v86, v252, v253
  v_mfma_f32_16x16x32_bf16 v[160:163], a[124:127], v[132:135], v[160:163]
  ds_write_b128 v18, v[172:175] offset:13312
  v_mfma_f32_16x16x32_bf16 v[160:163], a[128:131], v[136:139], v[160:163]
  v_fma_f32 v118, v87, v252, v253
  v_cvt_pk_bf16_f32 v125, v125, v118
  v_mfma_f32_16x16x32_bf16 v[160:163], a[132:135], v[140:143], v[160:163]
  v_mul_f32 v232, v232, v254
  v_mul_f32 v233, v233, v254
  v_mfma_f32_16x16x32_bf16 v[160:163], a[136:139], v[144:147], v[160:163]
  ds_write_b128 v18, v[208:211] offset:14336
  v_mfma_f32_16x16x32_bf16 v[160:163], a[140:143], v[148:151], v[160:163]
  v_mul_f32 v234, v234, v254
  ds_write_b128 v16, v[196:199] offset:32768
  v_mul_f32 v235, v235, v254
  v_mul_f32 v244, v244, v122
  v_mul_f32 v245, v245, v122
  v_mul_f32 v246, v246, v122
  v_mul_f32 v247, v247, v122
  v_mul_f32 v184, v184, v110
  v_mul_f32 v185, v185, v110
  v_mul_f32 v186, v186, v110
  v_mul_f32 v187, v187, v110
  v_cndmask_b32 v255, v224, v255, s[56:57]
  v_cvt_pk_bf16_f32 v252, v232, v233
  v_cvt_pk_bf16_f32 v253, v234, v235
  v_cvt_pk_bf16_f32 v112, v244, v245
  v_cvt_pk_bf16_f32 v113, v246, v247
  v_cvt_pk_bf16_f32 v166, v184, v185
  v_cvt_pk_bf16_f32 v167, v186, v187
  v_mul_f32 v255, v255, v126
  ds_write_b64 v17, v[124:125] offset:8192
  ds_write_b64 v17, v[252:253] offset:20480
  v_cvt_pk_bf16_f32 v255, v255, v255
  ds_write_b64 v17, v[112:113] offset:26624
  v_cvt_pk_bf16_f32 v164, v176, v177
  v_cvt_pk_bf16_f32 v165, v178, v179
  ds_write_b64 v17, v[166:167] offset:32768
  v_max3_f32 v1, v1, v156, v254
  v_max3_f32 v1, v1, v240, v122
  ds_write_b16 v20, v255 offset:384
  v_cvt_pk_bf16_f32 v156, v212, v213
  v_cvt_pk_bf16_f32 v157, v214, v215
  v_max3_f32 v1, v1, v228, v126
  v_cvt_pk_bf16_f32 v158, v248, v249
  v_cvt_pk_bf16_f32 v159, v250, v251
  v_add_u32 v20, 1160, v20
  v_max3_f32 v1, v1, v216, v110
  s_waitcnt lgkmcnt(0)
  s_barrier
  s_mov_b32 s70, 10
.p2align 6
L_loop:
  v_mfma_f32_16x16x32_bf16 v[168:171], v[128:131], a[144:147], 0
  s_mov_b32 m0, s58
  ds_read_b64 v[108:109], v119 offset:256
  v_cndmask_b32 v110, v21, 2.0, s[52:53]
  v_mfma_f32_16x16x32_bf16 v[168:171], v[132:135], a[148:151], v[168:171]
  buffer_load_dwordx4 v110, s[4:7], s36 offen lds
  v_mfma_f32_16x16x32_bf16 v[168:171], v[136:139], a[152:155], v[168:171]
  v_cvt_pk_bf16_f32 v166, v160, v161
  v_cvt_pk_bf16_f32 v167, v162, v163
  v_mfma_f32_16x16x32_bf16 v[168:171], v[140:143], a[156:159], v[168:171]
  buffer_load_dwordx4 v110, s[4:7], s37 offen offset:864 lds
  v_mfma_f32_16x16x32_bf16 v[168:171], v[144:147], a[160:163], v[168:171]
  v_mfma_f32_16x16x32_bf16 v[168:171], v[148:151], a[164:167], v[168:171]
  s_waitcnt lgkmcnt(0)
  ds_read_b128 v[160:163], v15 offset:20480
  v_fma_f32 v184, v88, v108, v109
  v_mfma_f32_16x16x32_bf16 v[172:175], v[128:131], a[168:171], 0
  ds_read_b128 v[176:179], v18
  ds_read_b128 v[180:183], v15 offset:21504
  v_mfma_f32_16x16x32_bf16 v[172:175], v[132:135], a[172:175], v[172:175]
  ds_read_b128 v[188:191], v18 offset:6144
  v_cvt_pk_bf16_f32 v192, v168, v169
  v_mfma_f32_16x16x32_bf16 v[172:175], v[136:139], a[176:179], v[172:175]
  ds_read_b128 v[196:199], v15 offset:22528
  v_cvt_pk_bf16_f32 v193, v170, v171
  v_mfma_f32_16x16x32_bf16 v[172:175], v[140:143], a[180:183], v[172:175]
  ds_read_b128 v[168:171], v18 offset:1024
  v_fma_f32 v114, v89, v108, v109
  v_mfma_f32_16x16x32_bf16 v[172:175], v[144:147], a[184:187], v[172:175]
  ds_read_b128 v[200:203], v18 offset:7168
  v_cvt_pk_bf16_f32 v184, v184, v114
  v_mfma_f32_16x16x32_bf16 v[172:175], v[148:151], a[188:191], v[172:175]
  buffer_load_dwordx4 v110, s[4:7], s38 offen offset:1728 lds
  v_mfma_f32_16x16x32_bf16 v[204:207], v[128:131], a[192:195], 0
  ds_read_b128 v[128:131], v18 offset:2048
  v_fma_f32 v185, v90, v108, v109
  v_mfma_f32_16x16x32_bf16 v[204:207], v[132:135], a[196:199], v[204:207]
  ds_read_b128 v[132:135], v18 offset:8192
  v_cvt_pk_bf16_f32 v208, v172, v173
  v_mfma_f32_16x16x32_bf16 v[204:207], v[136:139], a[200:203], v[204:207]
  ds_read_b128 v[136:139], v15 offset:26624
  v_cvt_pk_bf16_f32 v209, v174, v175
  v_mfma_f32_16x16x32_bf16 v[204:207], v[140:143], a[204:207], v[204:207]
  ds_read_b128 v[140:143], v15 offset:27648
  v_fma_f32 v114, v91, v108, v109
  v_mfma_f32_16x16x32_bf16 v[204:207], v[144:147], a[208:211], v[204:207]
  ds_read_b128 v[144:147], v15 offset:28672
  v_cvt_pk_bf16_f32 v185, v185, v114
  v_mfma_f32_16x16x32_bf16 v[204:207], v[148:151], a[212:215], v[204:207]
  s_waitcnt lgkmcnt(11)
  buffer_load_dwordx4 v110, s[4:7], s39 offen offset:2592 lds
  v_mfma_f32_16x16x32_bf16 v[28:31], a[250:253], v[160:163], v[28:31]
  s_waitcnt lgkmcnt(9)
  v_fma_f32 v186, v92, v108, v109
  v_fma_f32 v114, v93, v108, v109
  v_mfma_f32_16x16x32_bf16 v[28:31], v[176:179], v[180:183], v[28:31]
  s_waitcnt lgkmcnt(7)
  buffer_load_dwordx4 v110, s[4:7], s40 offen offset:3456 lds
  v_mfma_f32_16x16x32_bf16 v[28:31], v[188:191], v[196:199], v[28:31]
  s_mov_b32 m0, s59
  v_cvt_pk_bf16_f32 v212, v204, v205
  v_cvt_pk_bf16_f32 v213, v206, v207
  v_mfma_f32_16x16x32_bf16 v[32:35], v[100:103], v[160:163], v[32:35]
  s_waitcnt lgkmcnt(6)
  buffer_load_dwordx4 v110, s[4:7], s41 offen lds
  v_mfma_f32_16x16x32_bf16 v[32:35], v[168:171], v[180:183], v[32:35]
  s_waitcnt lgkmcnt(5)
  v_cvt_pk_bf16_f32 v186, v186, v114
  v_fma_f32 v187, v94, v108, v109
  v_mfma_f32_16x16x32_bf16 v[32:35], v[200:203], v[196:199], v[32:35]
  ds_read_b128 v[148:151], v15 offset:32768
  v_fma_f32 v114, v95, v108, v109
  v_mfma_f32_16x16x32_bf16 v[36:39], v[104:107], v[160:163], v[36:39]
  s_waitcnt lgkmcnt(5)
  ds_read_b128 v[172:175], v15 offset:33792
  v_cvt_pk_bf16_f32 v187, v187, v114
  v_mfma_f32_16x16x32_bf16 v[36:39], v[128:131], v[180:183], v[36:39]
  s_waitcnt lgkmcnt(5)
  ds_read_b128 v[180:183], v15 offset:34816
  v_fma_f32 v112, v96, v108, v109
  v_mfma_f32_16x16x32_bf16 v[36:39], v[132:135], v[196:199], v[36:39]
  s_waitcnt lgkmcnt(5)
  buffer_load_dwordx4 v110, s[4:7], s42 offen offset:864 lds
  v_mfma_f32_16x16x32_bf16 v[40:43], a[250:253], v[136:139], v[40:43]
  s_waitcnt lgkmcnt(4)
  v_fma_f32 v114, v97, v108, v109
  v_cvt_pk_bf16_f32 v112, v112, v114
  v_mfma_f32_16x16x32_bf16 v[40:43], v[176:179], v[140:143], v[40:43]
  s_waitcnt lgkmcnt(3)
  buffer_load_dwordx4 v110, s[4:7], s43 offen offset:1728 lds
  v_mfma_f32_16x16x32_bf16 v[40:43], v[188:191], v[144:147], v[40:43]
  v_fma_f32 v113, v98, v108, v109
  v_fma_f32 v114, v99, v108, v109
  v_mfma_f32_16x16x32_bf16 v[44:47], v[100:103], v[136:139], v[44:47]
  buffer_load_dwordx4 v110, s[4:7], s44 offen offset:2592 lds
  v_mfma_f32_16x16x32_bf16 v[44:47], v[168:171], v[140:143], v[44:47]
  s_lshl_b32 s60, s31, 5
  v_cvt_pk_bf16_f32 v113, v113, v114
  v_mfma_f32_16x16x32_bf16 v[44:47], v[200:203], v[144:147], v[44:47]
  s_add_u32 s61, s60, s30
  ds_read_b128 v[196:199], v18 offset:9216
  ds_read_b128 v[160:163], v15 offset:23552
  v_mfma_f32_16x16x32_bf16 v[48:51], v[104:107], v[136:139], v[48:51]
  s_add_u32 s60, s60, s29
  ds_read_b128 v[204:207], v18 offset:3072
  v_mfma_f32_16x16x32_bf16 v[48:51], v[128:131], v[140:143], v[48:51]
  s_mul_i32 s62, s60, 7183
  ds_read_b128 v[140:143], v15 offset:24576
  v_mfma_f32_16x16x32_bf16 v[48:51], v[132:135], v[144:147], v[48:51]
  s_waitcnt lgkmcnt(6)
  ds_read_b128 v[216:219], v18 offset:12288
  v_mfma_f32_16x16x32_bf16 v[52:55], a[250:253], v[148:151], v[52:55]
  s_waitcnt lgkmcnt(6)
  ds_read_b128 v[144:147], v15 offset:25600
  v_mfma_f32_16x16x32_bf16 v[52:55], v[176:179], v[172:175], v[52:55]
  s_waitcnt lgkmcnt(6)
  ds_read_b128 v[176:179], v18 offset:10240
  v_mfma_f32_16x16x32_bf16 v[52:55], v[188:191], v[180:183], v[52:55]
  s_lshr_b32 s62, s62, 22
  ds_read_b128 v[188:191], v18 offset:4096
  v_mfma_f32_16x16x32_bf16 v[56:59], v[100:103], v[148:151], v[56:59]
  s_mul_i32 s63, s62, 584
  ds_read_b128 v[220:223], v18 offset:13312
  v_mfma_f32_16x16x32_bf16 v[56:59], v[168:171], v[172:175], v[56:59]
  s_sub_u32 s63, s60, s63
  ds_read_b128 v[224:227], v18 offset:11264
  v_mfma_f32_16x16x32_bf16 v[56:59], v[200:203], v[180:183], v[56:59]
  s_lshr_b32 s64, s63, 3
  ds_read_b128 v[200:203], v18 offset:5120
  v_mfma_f32_16x16x32_bf16 v[60:63], v[104:107], v[148:151], v[60:63]
  s_and_b32 s65, s63, 7
  ds_read_b128 v[228:231], v18 offset:14336
  v_mfma_f32_16x16x32_bf16 v[60:63], v[128:131], v[172:175], v[60:63]
  s_lshl_b32 s66, s62, 3
  ds_read_b128 v[128:131], v15 offset:29696
  v_mfma_f32_16x16x32_bf16 v[60:63], v[132:135], v[180:183], v[60:63]
  s_waitcnt lgkmcnt(11)
  ds_read_b128 v[132:135], v15 offset:30720
  v_mfma_f32_16x16x32_bf16 v[28:31], v[196:199], v[160:163], v[28:31]
  s_waitcnt lgkmcnt(10)
  ds_read_b128 v[172:175], v15 offset:31744
  v_mfma_f32_16x16x32_bf16 v[28:31], v[204:207], v[140:143], v[28:31]
  s_waitcnt lgkmcnt(9)
  v_mfma_f32_16x16x32_bf16 v[28:31], v[216:219], v[144:147], v[28:31]
  s_waitcnt lgkmcnt(8)
  v_mfma_f32_16x16x32_bf16 v[32:35], v[176:179], v[160:163], v[32:35]
  s_waitcnt lgkmcnt(7)
  v_mfma_f32_16x16x32_bf16 v[32:35], v[188:191], v[140:143], v[32:35]
  s_waitcnt lgkmcnt(6)
  v_cvt_pk_bf16_f32 v168, v28, v29
  v_cvt_pk_bf16_f32 v169, v30, v31
  v_mfma_f32_16x16x32_bf16 v[32:35], v[220:223], v[144:147], v[32:35]
  s_waitcnt lgkmcnt(5)
  ds_read_b128 v[180:183], v15 offset:35840
  v_mfma_f32_16x16x32_bf16 v[36:39], v[224:227], v[160:163], v[36:39]
  s_waitcnt lgkmcnt(5)
  ds_read_b128 v[160:163], v15 offset:36864
  v_mfma_f32_16x16x32_bf16 v[36:39], v[200:203], v[140:143], v[36:39]
  s_waitcnt lgkmcnt(5)
  ds_read_b128 v[232:235], v15 offset:37888
  v_cvt_pk_bf16_f32 v170, v32, v33
  v_mfma_f32_16x16x32_bf16 v[36:39], v[228:231], v[144:147], v[36:39]
  s_waitcnt lgkmcnt(5)
  v_cvt_pk_bf16_f32 v171, v34, v35
  v_mfma_f32_16x16x32_bf16 v[40:43], v[196:199], v[128:131], v[40:43]
  s_waitcnt lgkmcnt(4)
  v_permlane16_swap_b32 v168, v170
  v_mfma_f32_16x16x32_bf16 v[40:43], v[204:207], v[132:135], v[40:43]
  s_waitcnt vmcnt(4) lgkmcnt(3)
  ds_read_b64 v[108:109], v9
  v_cvt_pk_bf16_f32 v236, v36, v37
  v_mfma_f32_16x16x32_bf16 v[40:43], v[216:219], v[172:175], v[40:43]
  s_add_u32 s65, s65, s66
  ds_read_b64 v[116:117], v9 offset:32
  v_cvt_pk_bf16_f32 v237, v38, v39
  v_mfma_f32_16x16x32_bf16 v[44:47], v[176:179], v[128:131], v[44:47]
  s_cmp_ge_u32 s60, 5256
  ds_read_b64 v[120:121], v9 offset:64
  v_mfma_f32_16x16x32_bf16 v[44:47], v[188:191], v[132:135], v[44:47]
  s_cselect_b32 s64, s63, s64
  ds_read_b128 v[144:147], v3
  ds_read_b128 v[148:151], v3 offset:864
  v_mfma_f32_16x16x32_bf16 v[44:47], v[220:223], v[172:175], v[44:47]
  s_cselect_b32 s65, 72, s65
  ds_read_b128 v[136:139], v3 offset:1728
  v_cvt_pk_bf16_f32 v240, v40, v41
  v_mfma_f32_16x16x32_bf16 v[48:51], v[224:227], v[128:131], v[48:51]
  s_mul_i32 s66, s65, 1373568
  ds_read_b128 v[140:143], v6
  v_cvt_pk_bf16_f32 v241, v42, v43
  v_mfma_f32_16x16x32_bf16 v[48:51], v[200:203], v[132:135], v[48:51]
  s_mul_i32 s67, s64, 2688
  v_permlane16_swap_b32 v169, v171
  v_mfma_f32_16x16x32_bf16 v[48:51], v[228:231], v[172:175], v[48:51]
  s_waitcnt lgkmcnt(9)
  buffer_store_dwordx4 v[168:171], v12, s[8:11], s32 offen
  v_cvt_pk_bf16_f32 v242, v44, v45
  v_mfma_f32_16x16x32_bf16 v[52:55], v[196:199], v[180:183], v[52:55]
  s_waitcnt lgkmcnt(8)
  ds_read_b128 v[128:131], v3 offset:32
  ds_read_b128 v[132:135], v3 offset:896
  v_mfma_f32_16x16x32_bf16 v[52:55], v[204:207], v[160:163], v[52:55]
  s_waitcnt lgkmcnt(9)
  ds_read_b128 v[168:171], v3 offset:1760
  v_cvt_pk_bf16_f32 v243, v46, v47
  v_mfma_f32_16x16x32_bf16 v[52:55], v[216:219], v[232:235], v[52:55]
  s_waitcnt lgkmcnt(5)
  ds_read_b128 v[172:175], v6 offset:32
  v_permlane16_swap_b32 v240, v242
  v_mfma_f32_16x16x16_bf16 v[28:31], a[224:225], v[108:109], 0
  v_permlane16_swap_b32 v241, v243
  v_cvt_pk_bf16_f32 v238, v48, v49
  v_mfma_f32_16x16x16_bf16 v[32:35], a[234:235], v[116:117], 0
  v_cvt_pk_bf16_f32 v239, v50, v51
  v_permlane16_swap_b32 v236, v238
  v_mfma_f32_16x16x16_bf16 v[36:39], a[244:245], v[120:121], 0
  v_permlane16_swap_b32 v237, v239
  v_cvt_pk_bf16_f32 v216, v52, v53
  v_cvt_pk_bf16_f32 v217, v54, v55
  v_smfmac_f32_16x16x64_bf16 v[28:31], a[216:219], v[144:151], v0
  s_waitcnt lgkmcnt(4)
  ds_read_b128 v[144:147], v3 offset:64
  ds_read_b128 v[148:151], v3 offset:928
  v_smfmac_f32_16x16x64_bf16 v[28:31], a[220:223], v[136:143], v0
  s_add_u32 s35, s66, s67
  ds_read_b128 v[136:139], v3 offset:1792
  v_mfma_f32_16x16x32_bf16 v[56:59], v[176:179], v[180:183], v[56:59]
  s_cmp_ge_u32 s61, 667
  ds_read_b128 v[140:143], v6 offset:64
  v_mfma_f32_16x16x32_bf16 v[56:59], v[188:191], v[160:163], v[56:59]
  s_cselect_b32 s35, 268435456, s35
  ds_read_b128 v[188:191], v15 offset:8192
  v_mul_f32 v110, v28, v28
  v_mfma_f32_16x16x32_bf16 v[56:59], v[220:223], v[232:235], v[56:59]
  s_waitcnt lgkmcnt(7)
  ds_read_b128 v[220:223], v15 offset:9216
  v_add_f32 v114, v28, v29
  v_smfmac_f32_16x16x64_bf16 v[32:35], a[226:229], v[128:135], v0
  s_waitcnt lgkmcnt(6)
  ds_read_b128 v[204:207], v15 offset:10240
  v_fmac_f32 v110, v29, v29
  v_smfmac_f32_16x16x64_bf16 v[32:35], a[230:233], v[168:175], v0
  s_cmp_ge_u32 s60, 5329
  ds_read_b128 v[196:199], v15 offset:11264
  v_cvt_pk_bf16_f32 v218, v56, v57
  v_mfma_f32_16x16x32_bf16 v[60:63], v[224:227], v[180:183], v[60:63]
  s_waitcnt vmcnt(3)
  ds_read_b128 v[224:227], v15 offset:12288
  v_cvt_pk_bf16_f32 v219, v58, v59
  v_mfma_f32_16x16x32_bf16 v[60:63], v[200:203], v[160:163], v[60:63]
  s_cselect_b32 s35, 268435456, s35
  ds_read_b128 v[160:163], v15 offset:13312
  v_add_f32 v114, v114, v30
  v_mfma_f32_16x16x32_bf16 v[60:63], v[228:231], v[232:235], v[60:63]
  s_waitcnt lgkmcnt(8)
  buffer_store_dwordx4 v[240:243], v13, s[8:11], s32 offen
  ds_read_b64 v[120:121], v10
  v_smfmac_f32_16x16x64_bf16 v[36:39], a[236:239], v[144:151], v0
  s_waitcnt lgkmcnt(7)
  ds_read_b64 v[116:117], v10 offset:32
  ds_read_b64 v[108:109], v10 offset:64
  v_smfmac_f32_16x16x64_bf16 v[36:39], a[240:243], v[136:143], v0
  s_waitcnt lgkmcnt(8)
  ds_read_b128 v[136:139], v4
  v_cvt_pk_bf16_f32 v124, v60, v61
  v_mfma_f32_16x16x32_bf16 v[180:183], a[72:75], v[188:191], 0
  s_waitcnt lgkmcnt(8)
  ds_read_b128 v[140:143], v4 offset:864
  v_cvt_pk_bf16_f32 v125, v62, v63
  v_mfma_f32_16x16x32_bf16 v[180:183], a[76:79], v[220:223], v[180:183]
  s_waitcnt lgkmcnt(8)
  ds_read_b128 v[144:147], v4 offset:1728
  v_fmac_f32 v110, v30, v30
  v_mfma_f32_16x16x32_bf16 v[180:183], a[80:83], v[204:207], v[180:183]
  s_waitcnt lgkmcnt(8)
  ds_read_b128 v[148:151], v7
  v_add_f32 v114, v114, v31
  v_mfma_f32_16x16x32_bf16 v[180:183], a[84:87], v[196:199], v[180:183]
  s_waitcnt lgkmcnt(8)
  ds_read_b128 v[168:171], v4 offset:32
  v_fmac_f32 v110, v31, v31
  v_mfma_f32_16x16x32_bf16 v[180:183], a[88:91], v[224:227], v[180:183]
  s_waitcnt lgkmcnt(8)
  ds_read_b128 v[172:175], v4 offset:896
  v_add_f32 v114, v114, v32
  v_mfma_f32_16x16x32_bf16 v[180:183], a[92:95], v[160:163], v[180:183]
  s_waitcnt lgkmcnt(6)
  ds_read_b128 v[128:131], v4 offset:1760
  v_permlane16_swap_b32 v216, v218
  v_mfma_f32_16x16x16_bf16 v[40:43], a[224:225], v[120:121], 0
  v_permlane16_swap_b32 v217, v219
  v_fmac_f32 v110, v32, v32
  v_mfma_f32_16x16x16_bf16 v[44:47], a[234:235], v[116:117], 0
  v_cvt_pk_bf16_f32 v240, v180, v181
  v_cvt_pk_bf16_f32 v241, v182, v183
  v_add_f32 v114, v114, v33
  v_mfma_f32_16x16x16_bf16 v[48:51], a[244:245], v[108:109], 0
  s_cmp_eq_u32 s65, 0
  ds_read_b128 v[132:135], v7 offset:32
  ds_read_b128 v[176:179], v4 offset:64
  s_waitcnt lgkmcnt(7)
  v_smfmac_f32_16x16x64_bf16 v[40:43], a[216:219], v[136:143], v0
  s_waitcnt lgkmcnt(5)
  ds_read_b128 v[180:183], v4 offset:928
  v_fmac_f32 v110, v33, v33
  v_smfmac_f32_16x16x64_bf16 v[40:43], a[220:223], v[144:151], v0
  s_cselect_b32 s36, 268435456, s35
  ds_read_b128 v[144:147], v4 offset:1792
  v_add_f32 v114, v114, v34
  v_mfma_f32_16x16x32_bf16 v[136:139], a[96:99], v[188:191], 0
  s_add_u32 s37, s35, 195360
  ds_read_b128 v[148:151], v7 offset:64
  v_fmac_f32 v110, v34, v34
  v_mfma_f32_16x16x32_bf16 v[136:139], a[100:103], v[220:223], v[136:139]
  s_add_u32 s38, s35, 390720
  ds_write_b128 v16, v[184:187] offset:14336
  v_mfma_f32_16x16x32_bf16 v[136:139], a[104:107], v[204:207], v[136:139]
  s_waitcnt lgkmcnt(7)
  buffer_store_dwordx4 v[236:239], v22, s[8:11], s32 offen
  v_mul_f32 v122, v40, v40
  v_smfmac_f32_16x16x64_bf16 v[44:47], a[226:229], v[168:175], v0
  s_waitcnt lgkmcnt(5)
  ds_write_b64 v17, v[112:113] offset:14336
  v_smfmac_f32_16x16x64_bf16 v[44:47], a[230:233], v[128:135], v0
  s_add_u32 s39, s35, 586080
  v_add_f32 v126, v40, v41
  v_mfma_f32_16x16x32_bf16 v[136:139], a[108:111], v[196:199], v[136:139]
  s_waitcnt vmcnt(3)
  ds_read_b64 v[108:109], v11
  v_fmac_f32 v122, v41, v41
  v_mfma_f32_16x16x32_bf16 v[136:139], a[112:115], v[224:227], v[136:139]
  s_add_u32 s40, s35, 781440
  ds_read_b64 v[112:113], v11 offset:32
  v_add_f32 v126, v126, v42
  v_mfma_f32_16x16x32_bf16 v[136:139], a[116:119], v[160:163], v[136:139]
  s_waitcnt lgkmcnt(6)
  ds_read_b64 v[120:121], v11 offset:64
  v_fmac_f32 v122, v42, v42
  v_smfmac_f32_16x16x64_bf16 v[48:51], a[236:239], v[176:183], v0
  s_waitcnt lgkmcnt(5)
  ds_read_b128 v[176:179], v5
  ds_read_b128 v[180:183], v5 offset:864
  v_smfmac_f32_16x16x64_bf16 v[48:51], a[240:243], v[144:151], v0
  s_add_u32 s41, s35, 981120
  ds_read_b128 v[144:147], v5 offset:1728
  v_cvt_pk_bf16_f32 v242, v136, v137
  v_mfma_f32_16x16x32_bf16 v[236:239], a[120:123], v[188:191], 0
  s_add_u32 s42, s35, 1176480
  ds_read_b128 v[148:151], v8
  v_cvt_pk_bf16_f32 v243, v138, v139
  v_mfma_f32_16x16x32_bf16 v[236:239], a[124:127], v[220:223], v[236:239]
  s_add_u32 s43, s35, 1371840
  v_add_f32 v126, v126, v43
  v_fmac_f32 v122, v43, v43
  v_mfma_f32_16x16x32_bf16 v[236:239], a[128:131], v[204:207], v[236:239]
  s_add_u32 s44, s35, 1567200
  v_add_f32 v126, v126, v44
  v_fmac_f32 v122, v44, v44
  v_mfma_f32_16x16x32_bf16 v[236:239], a[132:135], v[196:199], v[236:239]
  s_cmp_eq_u32 s64, 0
  ds_read_b128 v[128:131], v5 offset:32
  ds_read_b128 v[132:135], v5 offset:896
  v_mfma_f32_16x16x32_bf16 v[236:239], a[136:139], v[224:227], v[236:239]
  s_cselect_b64 s[52:53], s[48:49], 0
  ds_read_b128 v[168:171], v5 offset:1760
  v_add_f32 v126, v126, v45
  v_mfma_f32_16x16x32_bf16 v[236:239], a[140:143], v[160:163], v[236:239]
  s_waitcnt lgkmcnt(5)
  ds_read_b128 v[172:175], v8 offset:32
  v_fmac_f32 v122, v45, v45
  v_add_f32 v126, v126, v46
  v_mfma_f32_16x16x16_bf16 v[52:55], a[224:225], v[108:109], 0
  v_fmac_f32 v122, v46, v46
  v_add_f32 v114, v114, v35
  v_fmac_f32 v110, v35, v35
  v_mfma_f32_16x16x16_bf16 v[56:59], a[234:235], v[112:113], 0
  v_cvt_pk_bf16_f32 v228, v236, v237
  v_cvt_pk_bf16_f32 v229, v238, v239
  v_add_f32 v126, v126, v47
  v_mfma_f32_16x16x16_bf16 v[60:63], a[244:245], v[120:121], 0
  v_fmac_f32 v122, v47, v47
  v_add_f32 v114, v114, v36
  v_fmac_f32 v110, v36, v36
  v_add_f32 v126, v126, v48
  v_smfmac_f32_16x16x64_bf16 v[52:55], a[216:219], v[176:183], v0
  s_waitcnt lgkmcnt(4)
  buffer_store_dwordx4 v[216:219], v14, s[8:11], s32 offen
  ds_read_b128 v[176:179], v5 offset:64
  v_smfmac_f32_16x16x64_bf16 v[52:55], a[220:223], v[144:151], v0
  s_cmp_eq_u32 s64, 72
  ds_read_b128 v[180:183], v5 offset:928
  ds_read_b128 v[144:147], v5 offset:1792
  v_mfma_f32_16x16x32_bf16 v[216:219], a[0:3], v[188:191], 0
  s_cselect_b64 s[52:53], s[50:51], s[52:53]
  ds_read_b128 v[148:151], v8 offset:64
  v_fmac_f32 v122, v48, v48
  v_mfma_f32_16x16x32_bf16 v[216:219], a[4:7], v[220:223], v[216:219]
  s_add_u32 s31, s31, 1
  v_mul_f32 v118, v52, v52
  v_add_f32 v108, v52, v53
  v_mfma_f32_16x16x32_bf16 v[216:219], a[8:11], v[204:207], v[216:219]
  s_waitcnt lgkmcnt(6)
  v_fmac_f32 v118, v53, v53
  v_add_f32 v108, v108, v54
  v_smfmac_f32_16x16x64_bf16 v[56:59], a[226:229], v[128:135], v0
  s_waitcnt lgkmcnt(4)
  v_fmac_f32 v118, v54, v54
  v_smfmac_f32_16x16x64_bf16 v[56:59], a[230:233], v[168:175], v0
  s_sub_u32 s68, s35, 196608
  v_add_f32 v108, v108, v55
  v_mfma_f32_16x16x32_bf16 v[216:219], a[12:15], v[196:199], v[216:219]
  s_cselect_b32 s68, s35, s68
  v_fmac_f32 v118, v55, v55
  v_add_f32 v114, v114, v37
  v_mfma_f32_16x16x32_bf16 v[216:219], a[16:19], v[224:227], v[216:219]
  v_add_f32 v108, v108, v56
  v_fmac_f32 v118, v56, v56
  v_mfma_f32_16x16x32_bf16 v[216:219], a[20:23], v[160:163], v[216:219]
  s_waitcnt lgkmcnt(2)
  v_add_f32 v108, v108, v57
  v_fmac_f32 v118, v57, v57
  v_smfmac_f32_16x16x64_bf16 v[60:63], a[236:239], v[176:183], v0
  s_waitcnt lgkmcnt(0)
  v_add_f32 v108, v108, v58
  v_smfmac_f32_16x16x64_bf16 v[60:63], a[240:243], v[144:151], v0
  v_cvt_pk_bf16_f32 v128, v216, v217
  v_mfma_f32_16x16x32_bf16 v[144:147], a[24:27], v[188:191], 0
  v_cvt_pk_bf16_f32 v129, v218, v219
  v_fmac_f32 v118, v58, v58
  v_mfma_f32_16x16x32_bf16 v[144:147], a[28:31], v[220:223], v[144:147]
  v_add_f32 v108, v108, v59
  v_fmac_f32 v118, v59, v59
  v_mfma_f32_16x16x32_bf16 v[144:147], a[32:35], v[204:207], v[144:147]
  v_add_f32 v108, v108, v60
  v_fmac_f32 v118, v60, v60
  v_mfma_f32_16x16x32_bf16 v[144:147], a[36:39], v[196:199], v[144:147]
  v_add_f32 v108, v108, v61
  v_fmac_f32 v118, v61, v61
  v_mfma_f32_16x16x32_bf16 v[144:147], a[40:43], v[224:227], v[144:147]
  buffer_store_dwordx2 v[124:125], v23, s[8:11], s32 offen
  v_fmac_f32 v110, v37, v37
  v_mfma_f32_16x16x32_bf16 v[144:147], a[44:47], v[160:163], v[144:147]
  s_mov_b32 s32, s33
  v_add_f32 v126, v126, v49
  v_fmac_f32 v122, v49, v49
  v_mfma_f32_16x16x32_bf16 v[216:219], a[48:51], v[188:191], 0
  s_mov_b32 s33, s34
  v_add_f32 v108, v108, v62
  v_fmac_f32 v118, v62, v62
  v_mfma_f32_16x16x32_bf16 v[216:219], a[52:55], v[220:223], v[216:219]
  s_mov_b32 s34, s35
  ds_read_b64 v[116:117], v19 offset:784
  v_cvt_pk_bf16_f32 v130, v144, v145
  v_mfma_f32_16x16x32_bf16 v[216:219], a[56:59], v[204:207], v[216:219]
  buffer_load_dword v25, v24, s[24:27], s68 offen
  v_mfma_f32_16x16x32_bf16 v[216:219], a[60:63], v[196:199], v[216:219]
  s_cmp_eq_u32 s70, 1
  v_cvt_pk_bf16_f32 v131, v146, v147
  v_add_f32 v114, v114, v38
  v_mfma_f32_16x16x32_bf16 v[216:219], a[64:67], v[224:227], v[216:219]
  s_cbranch_scc1 L_cpf
L_cpf_ret:
  ds_read2_b64 v[144:147], v19 offset0:96 offset1:97
  v_fmac_f32 v110, v38, v38
  v_mfma_f32_16x16x32_bf16 v[216:219], a[68:71], v[160:163], v[216:219]
  v_add_f32 v126, v126, v50
  v_fmac_f32 v122, v50, v50
  v_mfma_f32_16x16x32_bf16 v[148:151], v[188:191], a[144:147], 0
  v_add_f32 v108, v108, v63
  v_fmac_f32 v118, v63, v63
  v_mfma_f32_16x16x32_bf16 v[148:151], v[220:223], a[148:151], v[148:151]
  v_add_f32 v114, v114, v39
  v_fmac_f32 v110, v39, v39
  v_mfma_f32_16x16x32_bf16 v[148:151], v[204:207], a[152:155], v[148:151]
  v_add_f32 v126, v126, v51
  v_fmac_f32 v122, v51, v51
  v_mfma_f32_16x16x32_bf16 v[148:151], v[196:199], a[156:159], v[148:151]
  v_permlane32_swap_b32 v108, v118
  v_mfma_f32_16x16x32_bf16 v[148:151], v[224:227], a[160:163], v[148:151]
  v_permlane32_swap_b32 v114, v110
  v_mfma_f32_16x16x32_bf16 v[148:151], v[160:163], a[164:167], v[148:151]
  v_permlane32_swap_b32 v126, v122
  v_mfma_f32_16x16x32_bf16 v[176:179], v[188:191], a[168:171], 0
  v_add_f32 v108, v108, v118
  v_add_f32 v114, v114, v110
  v_mfma_f32_16x16x32_bf16 v[176:179], v[220:223], a[172:175], v[176:179]
  v_add_f32 v126, v126, v122
  v_mov_b32 v110, v108
  v_mfma_f32_16x16x32_bf16 v[176:179], v[204:207], a[176:179], v[176:179]
  v_cvt_pk_bf16_f32 v124, v216, v217
  v_cvt_pk_bf16_f32 v125, v218, v219
  v_mfma_f32_16x16x32_bf16 v[176:179], v[196:199], a[180:183], v[176:179]
  v_permlane16_swap_b32 v114, v126
  v_mfma_f32_16x16x32_bf16 v[176:179], v[224:227], a[184:187], v[176:179]
  v_permlane16_swap_b32 v108, v110
  v_mfma_f32_16x16x32_bf16 v[176:179], v[160:163], a[188:191], v[176:179]
  s_waitcnt lgkmcnt(0)
  v_add_f32 v114, v114, v126
  v_add_f32 v108, v108, v110
  v_cvt_pk_bf16_f32 v194, v148, v149
  v_mfma_f32_16x16x16_bf16 v[216:219], v[116:117], v[166:167], 0
  v_cvt_pk_bf16_f32 v195, v150, v151
  v_mfma_f32_16x16x16_bf16 v[148:151], v[116:117], v[228:229], 0
  ds_write_b32 v111, v114
  v_cvt_pk_bf16_f32 v210, v176, v177
  v_mfma_f32_16x16x16_bf16 v[132:135], v[166:167], v[164:165], 0
  v_cvt_pk_bf16_f32 v211, v178, v179
  v_mfma_f32_16x16x16_bf16 v[176:179], v[228:229], v[164:165], 0
  ds_write_b32 v111, v108 offset:512
  v_mfma_f32_16x16x32_bf16 v[216:219], v[144:147], v[156:159], v[216:219]
  v_mfma_f32_16x16x32_bf16 v[148:151], v[144:147], v[240:243], v[148:151]
  v_mfma_f32_16x16x32_bf16 v[132:135], v[156:159], v[152:155], v[132:135]
  v_mfma_f32_16x16x32_bf16 v[176:179], v[240:243], v[152:155], v[176:179]
  s_waitcnt lgkmcnt(1)
  v_cndmask_b32 v184, v148, v216, s[56:57]
  s_waitcnt lgkmcnt(0)
  s_barrier
  v_mfma_f32_16x16x32_bf16 v[148:151], v[188:191], a[192:195], 0
  ds_read_b128 v[136:139], v15 offset:14336
  ds_read_b128 v[140:143], v15 offset:15360
  v_mfma_f32_16x16x32_bf16 v[148:151], v[220:223], a[196:199], v[148:151]
  ds_read_b128 v[220:223], v15 offset:16384
  v_mfma_f32_16x16x32_bf16 v[148:151], v[204:207], a[200:203], v[148:151]
  ds_read_b128 v[204:207], v15 offset:17408
  v_mfma_f32_16x16x32_bf16 v[148:151], v[196:199], a[204:207], v[148:151]
  ds_read_b128 v[196:199], v15 offset:18432
  v_mfma_f32_16x16x32_bf16 v[148:151], v[224:227], a[208:211], v[148:151]
  ds_read_b128 v[224:227], v15 offset:19456
  v_mfma_f32_16x16x32_bf16 v[148:151], v[160:163], a[212:215], v[148:151]
  ds_read_b128 v[160:163], v15
  v_exp_f32 v132, v132
  v_mfma_f32_16x16x16_bf16 v[188:191], v[166:167], v[124:125], 0
  v_exp_f32 v133, v133
  v_mfma_f32_16x16x16_bf16 v[216:219], v[228:229], v[124:125], 0
  ds_read_b128 v[180:183], v15 offset:1024
  v_exp_f32 v134, v134
  v_cvt_pk_bf16_f32 v214, v148, v149
  v_mfma_f32_16x16x32_bf16 v[188:191], v[156:159], v[128:131], v[188:191]
  v_exp_f32 v135, v135
  v_mfma_f32_16x16x32_bf16 v[216:219], v[240:243], v[128:131], v[216:219]
  s_waitcnt lgkmcnt(7)
  v_exp_f32 v176, v176
  v_mfma_f32_16x16x32_bf16 v[168:171], a[72:75], v[136:139], 0
  s_waitcnt lgkmcnt(6)
  v_exp_f32 v177, v177
  v_mfma_f32_16x16x32_bf16 v[168:171], a[76:79], v[140:143], v[168:171]
  s_waitcnt lgkmcnt(1)
  v_exp_f32 v178, v178
  v_mfma_f32_16x16x32_bf16 v[168:171], a[80:83], v[220:223], v[168:171]
  s_waitcnt lgkmcnt(0)
  v_exp_f32 v179, v179
  v_mfma_f32_16x16x32_bf16 v[168:171], a[84:87], v[204:207], v[168:171]
  v_cvt_pk_bf16_f32 v215, v150, v151
  v_cvt_pk_bf16_f32 v148, v132, v133
  v_mfma_f32_16x16x32_bf16 v[168:171], a[88:91], v[196:199], v[168:171]
  v_exp_f32 v188, v188
  v_mfma_f32_16x16x32_bf16 v[168:171], a[92:95], v[224:227], v[168:171]
  v_exp_f32 v189, v189
  v_mfma_f32_16x16x32_bf16 v[172:175], a[96:99], v[136:139], 0
  v_exp_f32 v190, v190
  v_mfma_f32_16x16x32_bf16 v[172:175], a[100:103], v[140:143], v[172:175]
  v_exp_f32 v191, v191
  v_mfma_f32_16x16x32_bf16 v[172:175], a[104:107], v[220:223], v[172:175]
  ds_read_b64 v[230:231], v19 offset:16
  v_cvt_pk_bf16_f32 v149, v134, v135
  v_mfma_f32_16x16x32_bf16 v[172:175], a[108:111], v[204:207], v[172:175]
  v_exp_f32 v216, v216
  v_mfma_f32_16x16x32_bf16 v[172:175], a[112:115], v[196:199], v[172:175]
  v_exp_f32 v217, v217
  v_mfma_f32_16x16x32_bf16 v[172:175], a[116:119], v[224:227], v[172:175]
  v_exp_f32 v218, v218
  v_mfma_f32_16x16x32_bf16 v[132:135], a[120:123], v[136:139], 0
  v_exp_f32 v219, v219
  v_mfma_f32_16x16x32_bf16 v[132:135], a[124:127], v[140:143], v[132:135]
  v_cvt_pk_bf16_f32 v150, v176, v177
  v_cvt_pk_bf16_f32 v151, v178, v179
  v_mfma_f32_16x16x32_bf16 v[132:135], a[128:131], v[220:223], v[132:135]
  ds_read2_b64 v[176:179], v19 offset0:0 offset1:1
  v_cvt_pk_bf16_f32 v236, v168, v169
  v_mfma_f32_16x16x32_bf16 v[132:135], a[132:135], v[204:207], v[132:135]
  v_cvt_pk_bf16_f32 v237, v170, v171
  v_cvt_pk_bf16_f32 v168, v188, v189
  v_mfma_f32_16x16x32_bf16 v[132:135], a[136:139], v[196:199], v[132:135]
  v_cvt_pk_bf16_f32 v169, v190, v191
  v_cvt_pk_bf16_f32 v170, v216, v217
  v_mfma_f32_16x16x32_bf16 v[132:135], a[140:143], v[224:227], v[132:135]
  v_cvt_pk_bf16_f32 v238, v172, v173
  v_cvt_pk_bf16_f32 v239, v174, v175
  v_mfma_f32_16x16x32_bf16 v[172:175], v[136:139], a[144:147], 0
  v_cvt_pk_bf16_f32 v171, v218, v219
  v_add_f32 v160, v160, v161
  v_mfma_f32_16x16x32_bf16 v[172:175], v[140:143], a[148:151], v[172:175]
  v_cvt_pk_bf16_f32 v200, v132, v133
  v_cvt_pk_bf16_f32 v201, v134, v135
  v_mfma_f32_16x16x32_bf16 v[172:175], v[220:223], a[152:155], v[172:175]
  v_add_f32 v162, v162, v163
  v_add_f32 v180, v180, v181
  v_mfma_f32_16x16x32_bf16 v[172:175], v[204:207], a[156:159], v[172:175]
  v_add_f32 v182, v182, v183
  v_add_f32 v160, v160, v162
  v_mfma_f32_16x16x32_bf16 v[172:175], v[196:199], a[160:163], v[172:175]
  v_add_f32 v180, v180, v182
  v_mul_f32 v161, 0x3baaaaab, v160
  v_mfma_f32_16x16x32_bf16 v[172:175], v[224:227], a[164:167], v[172:175]
  s_waitcnt lgkmcnt(1)
  v_fma_f32 v180, -v161, v160, v180
  v_max_f32 v180, 0, v180
  v_add_f32 v180, 0x3afba882, v180
  v_mfma_f32_16x16x16_bf16 v[132:135], v[200:201], v[164:165], 0
  v_rsq_f32 v180, v180
  v_add_u32 v19, 1160, v19
  v_mfma_f32_16x16x16_bf16 v[216:219], v[230:231], v[164:165], v[2:5]
  v_cvt_pk_bf16_f32 v108, v172, v173
  v_cvt_pk_bf16_f32 v109, v174, v175
  v_mul_f32 v180, 0x40ca568a, v180
  v_mfma_f32_16x16x16_bf16 v[172:175], v[200:201], v[124:125], 0
  v_mul_f32 v181, -v161, v180
  v_mfma_f32_16x16x16_bf16 v[160:163], v[230:231], v[124:125], v[2:5]
  ds_write_b64 v115, v[180:181]
  ds_read_b64 v[164:165], v119
  v_mfma_f32_16x16x32_bf16 v[132:135], v[236:239], v[152:155], v[132:135]
  s_waitcnt lgkmcnt(2)
  ds_read_b64 v[202:203], v119 offset:128
  v_mfma_f32_16x16x32_bf16 v[216:219], v[176:179], v[152:155], v[216:219]
  v_mfma_f32_16x16x32_bf16 v[172:175], v[236:239], v[128:131], v[172:175]
  v_exp_f32 v132, v132
  v_mfma_f32_16x16x32_bf16 v[160:163], v[176:179], v[128:131], v[160:163]
  v_exp_f32 v133, v133
  v_mfma_f32_16x16x32_bf16 v[128:131], v[136:139], a[168:171], 0
  v_exp_f32 v134, v134
  v_mfma_f32_16x16x32_bf16 v[128:131], v[140:143], a[172:175], v[128:131]
  v_exp_f32 v135, v135
  v_mfma_f32_16x16x32_bf16 v[128:131], v[220:223], a[176:179], v[128:131]
  s_waitcnt lgkmcnt(0)
  v_exp_f32 v216, v216
  v_mfma_f32_16x16x32_bf16 v[128:131], v[204:207], a[180:183], v[128:131]
  v_exp_f32 v172, v172
  v_mfma_f32_16x16x32_bf16 v[128:131], v[196:199], a[184:187], v[128:131]
  v_exp_f32 v173, v173
  v_mfma_f32_16x16x32_bf16 v[128:131], v[224:227], a[188:191], v[128:131]
  v_exp_f32 v174, v174
  v_mfma_f32_16x16x32_bf16 v[152:155], v[136:139], a[192:195], 0
  v_exp_f32 v175, v175
  v_mfma_f32_16x16x32_bf16 v[152:155], v[140:143], a[196:199], v[152:155]
  v_exp_f32 v160, v160
  v_mfma_f32_16x16x32_bf16 v[152:155], v[220:223], a[200:203], v[152:155]
  ds_read_u16 v110, v20
  v_cvt_pk_bf16_f32 v120, v132, v133
  v_mfma_f32_16x16x32_bf16 v[152:155], v[204:207], a[204:207], v[152:155]
  v_cvt_pk_bf16_f32 v121, v134, v135
  v_cvt_pk_bf16_f32 v122, v216, 0
  v_mfma_f32_16x16x32_bf16 v[152:155], v[196:199], a[208:211], v[152:155]
  ds_read_u16 v114, v20 offset:32
  v_cvt_pk_bf16_f32 v124, v172, v173
  v_mfma_f32_16x16x32_bf16 v[152:155], v[224:227], a[212:215], v[152:155]
  v_cvt_pk_bf16_f32 v112, v128, v129
  v_cvt_pk_bf16_f32 v113, v130, v131
  v_cvt_pk_bf16_f32 v125, v174, v175
  v_mfma_f32_16x16x16_bf16 v[128:131], v[116:117], v[200:201], 0
  v_cvt_pk_bf16_f32 v126, v160, 0
  v_fma_f32 v132, v28, v164, v165
  v_fma_f32 v185, v29, v164, v165
  v_mfma_f32_16x16x16_bf16 v[160:163], v[116:117], v[230:231], 0
  v_cvt_pk_bf16_f32 v116, v152, v153
  v_cvt_pk_bf16_f32 v117, v154, v155
  v_cvt_pk_bf16_f32 v132, v132, v185
  v_fma_f32 v133, v30, v164, v165
  v_mfma_f32_16x16x32_bf16 v[128:131], v[144:147], v[236:239], v[128:131]
  ds_read_u16 v118, v20 offset:64
  v_fma_f32 v185, v31, v164, v165
  v_mfma_f32_16x16x32_bf16 v[160:163], v[144:147], v[176:179], v[160:163]
  v_cvt_pk_bf16_f32 v133, v133, v185
  v_fma_f32 v134, v32, v164, v165
  v_mfma_f32_16x16x32_bf16 v[144:147], a[0:3], v[136:139], 0
  v_fma_f32 v185, v33, v164, v165
  v_cvt_pk_bf16_f32 v134, v134, v185
  v_mfma_f32_16x16x32_bf16 v[144:147], a[4:7], v[140:143], v[144:147]
  v_cndmask_b32 v185, v128, v160, s[56:57]
  v_fma_f32 v135, v34, v164, v165
  v_mfma_f32_16x16x32_bf16 v[144:147], a[8:11], v[220:223], v[144:147]
  v_fma_f32 v186, v35, v164, v165
  v_cvt_pk_bf16_f32 v135, v135, v186
  v_mfma_f32_16x16x32_bf16 v[144:147], a[12:15], v[204:207], v[144:147]
  ds_write_b128 v16, v[132:135] offset:2048
  v_mfma_f32_16x16x32_bf16 v[144:147], a[16:19], v[196:199], v[144:147]
  v_cndmask_b32 v184, v185, v184, s[46:47]
  v_fma_f32 v172, v36, v164, v165
  v_mfma_f32_16x16x32_bf16 v[144:147], a[20:23], v[224:227], v[144:147]
  v_fma_f32 v185, v37, v164, v165
  v_cvt_pk_bf16_f32 v172, v172, v185
  v_mfma_f32_16x16x32_bf16 v[160:163], a[246:249], v[148:151], 0
  v_fma_f32 v173, v38, v164, v165
  v_fma_f32 v185, v39, v164, v165
  v_mfma_f32_16x16x32_bf16 v[160:163], a[246:249], v[120:123], v[160:163]
  v_cvt_pk_bf16_f32 v152, v144, v145
  v_cvt_pk_bf16_f32 v153, v146, v147
  v_mfma_f32_16x16x32_bf16 v[132:135], v[192:195], v[148:151], 0
  s_waitcnt lgkmcnt(3)
  v_cvt_pk_bf16_f32 v173, v173, v185
  v_fma_f32 v128, v40, v202, v203
  v_mfma_f32_16x16x32_bf16 v[132:135], v[108:111], v[120:123], v[132:135]
  ds_write_b64 v17, v[172:173] offset:2048
  v_mfma_f32_16x16x32_bf16 v[144:147], v[208:211], v[148:151], 0
  s_waitcnt lgkmcnt(3)
  v_exp_f32 v184, v184
  v_mfma_f32_16x16x32_bf16 v[144:147], v[112:115], v[120:123], v[144:147]
  v_cvt_pk_bf16_f32 v184, v184, 0
  v_mul_f32 v160, 0x3ee9a3cd, v160
  v_mfma_f32_16x16x32_bf16 v[172:175], v[212:215], v[148:151], 0
  s_waitcnt lgkmcnt(2)
  ds_write_b16 v26, v184
  v_mfma_f32_16x16x32_bf16 v[172:175], v[116:119], v[120:123], v[172:175]
  ds_read_b128 v[148:151], v27
  ds_read_b64 v[120:121], v27 offset:16
  v_mfma_f32_16x16x32_bf16 v[216:219], a[24:27], v[136:139], 0
  v_cndmask_b32 v122, 0, v184, s[54:55]
  v_fma_f32 v164, v41, v202, v203
  v_mfma_f32_16x16x32_bf16 v[216:219], a[28:31], v[140:143], v[216:219]
  v_rcp_f32 v232, v160
  v_mfma_f32_16x16x32_bf16 v[216:219], a[32:35], v[220:223], v[216:219]
  v_cvt_pk_bf16_f32 v128, v128, v164
  v_fma_f32 v129, v42, v202, v203
  v_mfma_f32_16x16x32_bf16 v[216:219], a[36:39], v[204:207], v[216:219]
  v_fma_f32 v164, v43, v202, v203
  v_cvt_pk_bf16_f32 v129, v129, v164
  v_mfma_f32_16x16x32_bf16 v[216:219], a[40:43], v[196:199], v[216:219]
  v_fma_f32 v130, v44, v202, v203
  v_fma_f32 v164, v45, v202, v203
  v_mfma_f32_16x16x32_bf16 v[216:219], a[44:47], v[224:227], v[216:219]
  v_cvt_pk_bf16_f32 v130, v130, v164
  v_fma_f32 v131, v46, v202, v203
  v_mfma_f32_16x16x32_bf16 v[180:183], a[246:249], v[168:171], 0
  v_fma_f32 v164, v47, v202, v203
  v_cvt_pk_bf16_f32 v131, v131, v164
  v_mfma_f32_16x16x32_bf16 v[180:183], a[246:249], v[124:127], v[180:183]
  ds_write_b128 v16, v[128:131] offset:8192
  v_mfma_f32_16x16x32_bf16 v[128:131], v[192:195], v[168:171], 0
  v_cvt_pk_bf16_f32 v154, v216, v217
  v_cvt_pk_bf16_f32 v155, v218, v219
  v_mfma_f32_16x16x32_bf16 v[128:131], v[108:111], v[124:127], v[128:131]
  v_mul_f32 v180, 0x3ee9a3cd, v180
  v_mul_f32 v132, v132, v232
  v_mfma_f32_16x16x32_bf16 v[216:219], v[208:211], v[168:171], 0
  v_rcp_f32 v233, v180
  v_mfma_f32_16x16x32_bf16 v[216:219], v[112:115], v[124:127], v[216:219]
  v_mul_f32 v133, v133, v232
  v_cvt_pk_bf16_f32 v188, v132, v133
  v_mfma_f32_16x16x32_bf16 v[184:187], v[212:215], v[168:171], 0
  v_mul_f32 v134, v134, v232
  v_mul_f32 v135, v135, v232
  v_mfma_f32_16x16x32_bf16 v[184:187], v[116:119], v[124:127], v[184:187]
  v_cvt_pk_bf16_f32 v189, v134, v135
  v_mul_f32 v144, v144, v232
  v_mfma_f32_16x16x32_bf16 v[132:135], a[48:51], v[136:139], 0
  v_mul_f32 v145, v145, v232
  v_cvt_pk_bf16_f32 v190, v144, v145
  v_mfma_f32_16x16x32_bf16 v[132:135], a[52:55], v[140:143], v[132:135]
  v_mul_f32 v146, v146, v232
  v_mul_f32 v147, v147, v232
  v_mfma_f32_16x16x32_bf16 v[132:135], a[56:59], v[220:223], v[132:135]
  v_cvt_pk_bf16_f32 v191, v146, v147
  v_mul_f32 v128, v128, v233
  v_mfma_f32_16x16x32_bf16 v[132:135], a[60:63], v[204:207], v[132:135]
  ds_write_b128 v16, v[188:191] offset:20480
  v_mfma_f32_16x16x32_bf16 v[132:135], a[64:67], v[196:199], v[132:135]
  v_mul_f32 v129, v129, v233
  v_cvt_pk_bf16_f32 v196, v128, v129
  v_mfma_f32_16x16x32_bf16 v[132:135], a[68:71], v[224:227], v[132:135]
  s_waitcnt lgkmcnt(3)
  s_barrier
  v_mfma_f32_16x16x32_bf16 v[224:227], a[246:249], v[148:151], 0
  s_waitcnt lgkmcnt(2)
  v_mul_f32 v130, v130, v233
  v_mul_f32 v131, v131, v233
  v_mfma_f32_16x16x32_bf16 v[224:227], a[246:249], v[120:123], v[224:227]
  v_cvt_pk_bf16_f32 v124, v132, v133
  v_cvt_pk_bf16_f32 v125, v134, v135
  v_mfma_f32_16x16x32_bf16 v[144:147], v[148:151], v[192:195], 0
  v_cvt_pk_bf16_f32 v197, v130, v131
  v_mul_f32 v216, v216, v233
  v_mfma_f32_16x16x32_bf16 v[144:147], v[120:123], v[108:111], v[144:147]
  v_mul_f32 v217, v217, v233
  v_cvt_pk_bf16_f32 v198, v216, v217
  v_mfma_f32_16x16x32_bf16 v[140:143], v[148:151], v[208:211], 0
  v_mul_f32 v218, v218, v233
  v_mul_f32 v219, v219, v233
  v_mfma_f32_16x16x32_bf16 v[140:143], v[120:123], v[112:115], v[140:143]
  ds_read_b128 v[128:131], v15 offset:2048
  v_cvt_pk_bf16_f32 v199, v218, v219
  v_mfma_f32_16x16x32_bf16 v[216:219], v[148:151], v[212:215], 0
  ds_read_b128 v[132:135], v15 offset:3072
  v_mul_f32 v224, 0x3ee9a3cd, v224
  v_mfma_f32_16x16x32_bf16 v[216:219], v[120:123], v[116:119], v[216:219]
  ds_read_b128 v[136:139], v15 offset:4096
  v_rcp_f32 v122, v224
  v_mfma_f32_16x16x16_bf16 v[188:191], v[166:167], v[124:125], 0
  v_cndmask_b32 v234, v140, v144, s[54:55]
  v_fma_f32 v120, v48, v202, v203
  v_fma_f32 v126, v49, v202, v203
  v_mfma_f32_16x16x16_bf16 v[164:167], v[228:229], v[124:125], 0
  v_cvt_pk_bf16_f32 v120, v120, v126
  v_fma_f32 v121, v50, v202, v203
  v_fma_f32 v126, v51, v202, v203
  v_mfma_f32_16x16x16_bf16 v[204:207], v[200:201], v[124:125], 0
  v_cvt_pk_bf16_f32 v121, v121, v126
  v_mul_f32 v172, v172, v232
  v_mul_f32 v173, v173, v232
  v_mfma_f32_16x16x16_bf16 v[220:223], v[230:231], v[124:125], v[2:5]
  v_cvt_pk_bf16_f32 v124, v172, v173
  v_mul_f32 v174, v174, v232
  v_mul_f32 v175, v175, v232
  v_cvt_pk_bf16_f32 v125, v174, v175
  v_mfma_f32_16x16x32_bf16 v[188:191], v[156:159], v[152:155], v[188:191]
  ds_read_b128 v[140:143], v15 offset:5120
  ds_read_b128 v[144:147], v15 offset:6144
  v_mfma_f32_16x16x32_bf16 v[164:167], v[240:243], v[152:155], v[164:167]
  ds_read_b128 v[148:151], v15 offset:7168
  v_mul_f32 v184, v184, v233
  v_mfma_f32_16x16x32_bf16 v[204:207], v[236:239], v[152:155], v[204:207]
  ds_write_b128 v16, v[196:199] offset:26624
  v_mfma_f32_16x16x32_bf16 v[220:223], v[176:179], v[152:155], v[220:223]
  s_waitcnt lgkmcnt(6)
  v_exp_f32 v188, v188
  v_mfma_f32_16x16x32_bf16 v[156:159], a[0:3], v[128:131], 0
  s_waitcnt lgkmcnt(5)
  v_exp_f32 v189, v189
  v_mfma_f32_16x16x32_bf16 v[156:159], a[4:7], v[132:135], v[156:159]
  s_waitcnt lgkmcnt(4)
  ds_write_b64 v17, v[120:121] offset:8192
  v_mfma_f32_16x16x32_bf16 v[156:159], a[8:11], v[136:139], v[156:159]
  s_waitcnt lgkmcnt(4)
  ds_write_b64 v17, v[124:125] offset:20480
  v_mfma_f32_16x16x32_bf16 v[156:159], a[12:15], v[140:143], v[156:159]
  s_waitcnt lgkmcnt(4)
  v_exp_f32 v190, v190
  v_mfma_f32_16x16x32_bf16 v[156:159], a[16:19], v[144:147], v[156:159]
  s_waitcnt lgkmcnt(3)
  v_exp_f32 v191, v191
  v_mfma_f32_16x16x32_bf16 v[156:159], a[20:23], v[148:151], v[156:159]
  v_exp_f32 v164, v164
  v_mfma_f32_16x16x32_bf16 v[176:179], a[24:27], v[128:131], 0
  v_exp_f32 v165, v165
  v_mfma_f32_16x16x32_bf16 v[176:179], a[28:31], v[132:135], v[176:179]
  v_exp_f32 v166, v166
  v_mfma_f32_16x16x32_bf16 v[176:179], a[32:35], v[136:139], v[176:179]
  v_exp_f32 v167, v167
  v_mfma_f32_16x16x32_bf16 v[176:179], a[36:39], v[140:143], v[176:179]
  v_exp_f32 v204, v204
  v_mfma_f32_16x16x32_bf16 v[176:179], a[40:43], v[144:147], v[176:179]
  v_exp_f32 v205, v205
  v_mfma_f32_16x16x32_bf16 v[176:179], a[44:47], v[148:151], v[176:179]
  v_exp_f32 v206, v206
  v_mfma_f32_16x16x32_bf16 v[196:199], a[48:51], v[128:131], 0
  v_exp_f32 v207, v207
  v_mfma_f32_16x16x32_bf16 v[196:199], a[52:55], v[132:135], v[196:199]
  v_exp_f32 v220, v220
  v_mfma_f32_16x16x32_bf16 v[196:199], a[56:59], v[136:139], v[196:199]
  v_cvt_pk_bf16_f32 v236, v188, v189
  v_cvt_pk_bf16_f32 v237, v190, v191
  v_mfma_f32_16x16x32_bf16 v[196:199], a[60:63], v[140:143], v[196:199]
  v_cvt_pk_bf16_f32 v238, v164, v165
  v_cvt_pk_bf16_f32 v239, v166, v167
  v_mfma_f32_16x16x32_bf16 v[196:199], a[64:67], v[144:147], v[196:199]
  v_cvt_pk_bf16_f32 v152, v156, v157
  v_cvt_pk_bf16_f32 v153, v158, v159
  v_mfma_f32_16x16x32_bf16 v[196:199], a[68:71], v[148:151], v[196:199]
  v_cvt_pk_bf16_f32 v124, v204, v205
  v_cvt_pk_bf16_f32 v125, v206, v207
  v_mfma_f32_16x16x32_bf16 v[204:207], a[246:249], v[236:239], 0
  v_cvt_pk_bf16_f32 v126, v220, 0
  v_cvt_pk_bf16_f32 v154, v176, v177
  v_cvt_pk_bf16_f32 v155, v178, v179
  v_mfma_f32_16x16x32_bf16 v[204:207], a[246:249], v[124:127], v[204:207]
  v_cvt_pk_bf16_f32 v164, v196, v197
  v_cvt_pk_bf16_f32 v165, v198, v199
  v_mfma_f32_16x16x32_bf16 v[156:159], v[192:195], v[236:239], 0
  v_mul_f32 v185, v185, v233
  v_cvt_pk_bf16_f32 v166, v184, v185
  v_mfma_f32_16x16x32_bf16 v[156:159], v[108:111], v[124:127], v[156:159]
  v_mul_f32 v204, 0x3ee9a3cd, v204
  v_mul_f32 v186, v186, v233
  v_mfma_f32_16x16x32_bf16 v[192:195], v[208:211], v[236:239], 0
  v_rcp_f32 v110, v204
  v_mfma_f32_16x16x32_bf16 v[192:195], v[112:115], v[124:127], v[192:195]
  v_mul_f32 v156, v156, v110
  v_mul_f32 v157, v157, v110
  v_mfma_f32_16x16x32_bf16 v[208:211], v[212:215], v[236:239], 0
  v_mul_f32 v158, v158, v110
  v_mul_f32 v159, v159, v110
  v_mfma_f32_16x16x32_bf16 v[208:211], v[116:119], v[124:127], v[208:211]
  v_mul_f32 v192, v192, v110
  v_mul_f32 v193, v193, v110
  v_mfma_f32_16x16x32_bf16 v[212:215], a[72:75], v[128:131], 0
  v_mul_f32 v194, v194, v110
  v_mul_f32 v195, v195, v110
  v_mfma_f32_16x16x32_bf16 v[212:215], a[76:79], v[132:135], v[212:215]
  v_cvt_pk_bf16_f32 v236, v156, v157
  v_cvt_pk_bf16_f32 v237, v158, v159
  v_mfma_f32_16x16x32_bf16 v[212:215], a[80:83], v[136:139], v[212:215]
  v_cvt_pk_bf16_f32 v238, v192, v193
  v_cvt_pk_bf16_f32 v239, v194, v195
  v_mfma_f32_16x16x32_bf16 v[212:215], a[84:87], v[140:143], v[212:215]
  ds_write_b128 v16, v[236:239] offset:32768
  v_mfma_f32_16x16x32_bf16 v[212:215], a[88:91], v[144:147], v[212:215]
  v_mul_f32 v187, v187, v233
  v_mul_f32 v208, v208, v110
  v_mfma_f32_16x16x32_bf16 v[212:215], a[92:95], v[148:151], v[212:215]
  v_mul_f32 v209, v209, v110
  v_mul_f32 v210, v210, v110
  v_mfma_f32_16x16x32_bf16 v[236:239], a[96:99], v[128:131], 0
  v_mul_f32 v211, v211, v110
  v_cndmask_b32 v234, v216, v234, s[56:57]
  v_mfma_f32_16x16x32_bf16 v[236:239], a[100:103], v[132:135], v[236:239]
  v_cvt_pk_bf16_f32 v167, v186, v187
  v_cvt_pk_bf16_f32 v116, v208, v209
  v_mfma_f32_16x16x32_bf16 v[236:239], a[104:107], v[136:139], v[236:239]
  ds_write_b64 v17, v[166:167] offset:26624
  v_mfma_f32_16x16x32_bf16 v[236:239], a[108:111], v[140:143], v[236:239]
  v_cvt_pk_bf16_f32 v117, v210, v211
  v_mul_f32 v234, v234, v122
  v_mfma_f32_16x16x32_bf16 v[236:239], a[112:115], v[144:147], v[236:239]
  ds_write_b64 v17, v[116:117] offset:32768
  v_mfma_f32_16x16x32_bf16 v[236:239], a[116:119], v[148:151], v[236:239]
  v_cvt_pk_bf16_f32 v234, v234, v234
  v_max3_f32 v1, v1, v160, v232
  v_mfma_f32_16x16x32_bf16 v[160:163], a[120:123], v[128:131], 0
  ds_write_b16 v20, v234 offset:384
  v_mfma_f32_16x16x32_bf16 v[160:163], a[124:127], v[132:135], v[160:163]
  v_max3_f32 v1, v1, v180, v233
  v_cvt_pk_bf16_f32 v156, v212, v213
  v_mfma_f32_16x16x32_bf16 v[160:163], a[128:131], v[136:139], v[160:163]
  v_cvt_pk_bf16_f32 v157, v214, v215
  v_max3_f32 v1, v1, v224, v122
  v_mfma_f32_16x16x32_bf16 v[160:163], a[132:135], v[140:143], v[160:163]
  v_cvt_pk_bf16_f32 v158, v236, v237
  v_cvt_pk_bf16_f32 v159, v238, v239
  v_mfma_f32_16x16x32_bf16 v[160:163], a[136:139], v[144:147], v[160:163]
  v_add_u32 v20, 1160, v20
  v_max3_f32 v1, v1, v204, v110
  v_mfma_f32_16x16x32_bf16 v[160:163], a[140:143], v[148:151], v[160:163]
  s_waitcnt lgkmcnt(1)
  s_waitcnt lgkmcnt(0)
  s_barrier
  s_sub_u32 s70, s70, 1
  s_cmp_eq_u32 s70, 0
  s_cbranch_scc1 L_last
  v_mfma_f32_16x16x32_bf16 v[168:171], v[128:131], a[144:147], 0
  s_mov_b32 m0, s58
  ds_read_b64 v[108:109], v119 offset:256
  v_cndmask_b32 v110, v21, 2.0, s[52:53]
  v_mfma_f32_16x16x32_bf16 v[168:171], v[132:135], a[148:151], v[168:171]
  buffer_load_dwordx4 v110, s[4:7], s36 offen lds
  v_mfma_f32_16x16x32_bf16 v[168:171], v[136:139], a[152:155], v[168:171]
  v_cvt_pk_bf16_f32 v166, v160, v161
  v_cvt_pk_bf16_f32 v167, v162, v163
  v_mfma_f32_16x16x32_bf16 v[168:171], v[140:143], a[156:159], v[168:171]
  buffer_load_dwordx4 v110, s[4:7], s37 offen offset:864 lds
  v_mfma_f32_16x16x32_bf16 v[168:171], v[144:147], a[160:163], v[168:171]
  v_mfma_f32_16x16x32_bf16 v[168:171], v[148:151], a[164:167], v[168:171]
  s_waitcnt lgkmcnt(0)
  ds_read_b128 v[160:163], v15 offset:20480
  v_fma_f32 v184, v52, v108, v109
  v_mfma_f32_16x16x32_bf16 v[172:175], v[128:131], a[168:171], 0
  ds_read_b128 v[176:179], v18
  ds_read_b128 v[180:183], v15 offset:21504
  v_mfma_f32_16x16x32_bf16 v[172:175], v[132:135], a[172:175], v[172:175]
  ds_read_b128 v[188:191], v18 offset:6144
  v_cvt_pk_bf16_f32 v192, v168, v169
  v_mfma_f32_16x16x32_bf16 v[172:175], v[136:139], a[176:179], v[172:175]
  ds_read_b128 v[196:199], v15 offset:22528
  v_cvt_pk_bf16_f32 v193, v170, v171
  v_mfma_f32_16x16x32_bf16 v[172:175], v[140:143], a[180:183], v[172:175]
  ds_read_b128 v[168:171], v18 offset:1024
  v_fma_f32 v114, v53, v108, v109
  v_mfma_f32_16x16x32_bf16 v[172:175], v[144:147], a[184:187], v[172:175]
  ds_read_b128 v[200:203], v18 offset:7168
  v_cvt_pk_bf16_f32 v184, v184, v114
  v_mfma_f32_16x16x32_bf16 v[172:175], v[148:151], a[188:191], v[172:175]
  buffer_load_dwordx4 v110, s[4:7], s38 offen offset:1728 lds
  v_mfma_f32_16x16x32_bf16 v[204:207], v[128:131], a[192:195], 0
  ds_read_b128 v[128:131], v18 offset:2048
  v_fma_f32 v185, v54, v108, v109
  v_mfma_f32_16x16x32_bf16 v[204:207], v[132:135], a[196:199], v[204:207]
  ds_read_b128 v[132:135], v18 offset:8192
  v_cvt_pk_bf16_f32 v208, v172, v173
  v_mfma_f32_16x16x32_bf16 v[204:207], v[136:139], a[200:203], v[204:207]
  ds_read_b128 v[136:139], v15 offset:26624
  v_cvt_pk_bf16_f32 v209, v174, v175
  v_mfma_f32_16x16x32_bf16 v[204:207], v[140:143], a[204:207], v[204:207]
  ds_read_b128 v[140:143], v15 offset:27648
  v_fma_f32 v114, v55, v108, v109
  v_mfma_f32_16x16x32_bf16 v[204:207], v[144:147], a[208:211], v[204:207]
  ds_read_b128 v[144:147], v15 offset:28672
  v_cvt_pk_bf16_f32 v185, v185, v114
  v_mfma_f32_16x16x32_bf16 v[204:207], v[148:151], a[212:215], v[204:207]
  s_waitcnt lgkmcnt(11)
  buffer_load_dwordx4 v110, s[4:7], s39 offen offset:2592 lds
  v_mfma_f32_16x16x32_bf16 v[64:67], a[250:253], v[160:163], v[64:67]
  s_waitcnt lgkmcnt(9)
  v_fma_f32 v186, v56, v108, v109
  v_fma_f32 v114, v57, v108, v109
  v_mfma_f32_16x16x32_bf16 v[64:67], v[176:179], v[180:183], v[64:67]
  s_waitcnt lgkmcnt(7)
  buffer_load_dwordx4 v110, s[4:7], s40 offen offset:3456 lds
  v_mfma_f32_16x16x32_bf16 v[64:67], v[188:191], v[196:199], v[64:67]
  s_mov_b32 m0, s59
  v_cvt_pk_bf16_f32 v212, v204, v205
  v_cvt_pk_bf16_f32 v213, v206, v207
  v_mfma_f32_16x16x32_bf16 v[68:71], v[100:103], v[160:163], v[68:71]
  s_waitcnt lgkmcnt(6)
  buffer_load_dwordx4 v110, s[4:7], s41 offen lds
  v_mfma_f32_16x16x32_bf16 v[68:71], v[168:171], v[180:183], v[68:71]
  s_waitcnt lgkmcnt(5)
  v_cvt_pk_bf16_f32 v186, v186, v114
  v_fma_f32 v187, v58, v108, v109
  v_mfma_f32_16x16x32_bf16 v[68:71], v[200:203], v[196:199], v[68:71]
  ds_read_b128 v[148:151], v15 offset:32768
  v_fma_f32 v114, v59, v108, v109
  v_mfma_f32_16x16x32_bf16 v[72:75], v[104:107], v[160:163], v[72:75]
  s_waitcnt lgkmcnt(5)
  ds_read_b128 v[172:175], v15 offset:33792
  v_cvt_pk_bf16_f32 v187, v187, v114
  v_mfma_f32_16x16x32_bf16 v[72:75], v[128:131], v[180:183], v[72:75]
  s_waitcnt lgkmcnt(5)
  ds_read_b128 v[180:183], v15 offset:34816
  v_fma_f32 v112, v60, v108, v109
  v_mfma_f32_16x16x32_bf16 v[72:75], v[132:135], v[196:199], v[72:75]
  s_waitcnt lgkmcnt(5)
  buffer_load_dwordx4 v110, s[4:7], s42 offen offset:864 lds
  v_mfma_f32_16x16x32_bf16 v[76:79], a[250:253], v[136:139], v[76:79]
  s_waitcnt lgkmcnt(4)
  v_fma_f32 v114, v61, v108, v109
  v_cvt_pk_bf16_f32 v112, v112, v114
  v_mfma_f32_16x16x32_bf16 v[76:79], v[176:179], v[140:143], v[76:79]
  s_waitcnt lgkmcnt(3)
  buffer_load_dwordx4 v110, s[4:7], s43 offen offset:1728 lds
  v_mfma_f32_16x16x32_bf16 v[76:79], v[188:191], v[144:147], v[76:79]
  v_fma_f32 v113, v62, v108, v109
  v_fma_f32 v114, v63, v108, v109
  v_mfma_f32_16x16x32_bf16 v[80:83], v[100:103], v[136:139], v[80:83]
  buffer_load_dwordx4 v110, s[4:7], s44 offen offset:2592 lds
  v_mfma_f32_16x16x32_bf16 v[80:83], v[168:171], v[140:143], v[80:83]
  s_lshl_b32 s60, s31, 5
  v_cvt_pk_bf16_f32 v113, v113, v114
  v_mfma_f32_16x16x32_bf16 v[80:83], v[200:203], v[144:147], v[80:83]
  s_add_u32 s61, s60, s30
  ds_read_b128 v[196:199], v18 offset:9216
  ds_read_b128 v[160:163], v15 offset:23552
  v_mfma_f32_16x16x32_bf16 v[84:87], v[104:107], v[136:139], v[84:87]
  s_add_u32 s60, s60, s29
  ds_read_b128 v[204:207], v18 offset:3072
  v_mfma_f32_16x16x32_bf16 v[84:87], v[128:131], v[140:143], v[84:87]
  s_mul_i32 s62, s60, 7183
  ds_read_b128 v[140:143], v15 offset:24576
  v_mfma_f32_16x16x32_bf16 v[84:87], v[132:135], v[144:147], v[84:87]
  s_waitcnt lgkmcnt(6)
  ds_read_b128 v[216:219], v18 offset:12288
  v_mfma_f32_16x16x32_bf16 v[88:91], a[250:253], v[148:151], v[88:91]
  s_waitcnt lgkmcnt(6)
  ds_read_b128 v[144:147], v15 offset:25600
  v_mfma_f32_16x16x32_bf16 v[88:91], v[176:179], v[172:175], v[88:91]
  s_waitcnt lgkmcnt(6)
  ds_read_b128 v[176:179], v18 offset:10240
  v_mfma_f32_16x16x32_bf16 v[88:91], v[188:191], v[180:183], v[88:91]
  s_lshr_b32 s62, s62, 22
  ds_read_b128 v[188:191], v18 offset:4096
  v_mfma_f32_16x16x32_bf16 v[92:95], v[100:103], v[148:151], v[92:95]
  s_mul_i32 s63, s62, 584
  ds_read_b128 v[220:223], v18 offset:13312
  v_mfma_f32_16x16x32_bf16 v[92:95], v[168:171], v[172:175], v[92:95]
  s_sub_u32 s63, s60, s63
  ds_read_b128 v[224:227], v18 offset:11264
  v_mfma_f32_16x16x32_bf16 v[92:95], v[200:203], v[180:183], v[92:95]
  s_lshr_b32 s64, s63, 3
  ds_read_b128 v[200:203], v18 offset:5120
  v_mfma_f32_16x16x32_bf16 v[96:99], v[104:107], v[148:151], v[96:99]
  s_and_b32 s65, s63, 7
  ds_read_b128 v[228:231], v18 offset:14336
  v_mfma_f32_16x16x32_bf16 v[96:99], v[128:131], v[172:175], v[96:99]
  s_lshl_b32 s66, s62, 3
  ds_read_b128 v[128:131], v15 offset:29696
  v_mfma_f32_16x16x32_bf16 v[96:99], v[132:135], v[180:183], v[96:99]
  s_waitcnt lgkmcnt(11)
  ds_read_b128 v[132:135], v15 offset:30720
  v_mfma_f32_16x16x32_bf16 v[64:67], v[196:199], v[160:163], v[64:67]
  s_waitcnt lgkmcnt(10)
  ds_read_b128 v[172:175], v15 offset:31744
  v_mfma_f32_16x16x32_bf16 v[64:67], v[204:207], v[140:143], v[64:67]
  s_waitcnt lgkmcnt(9)
  v_mfma_f32_16x16x32_bf16 v[64:67], v[216:219], v[144:147], v[64:67]
  s_waitcnt lgkmcnt(8)
  v_mfma_f32_16x16x32_bf16 v[68:71], v[176:179], v[160:163], v[68:71]
  s_waitcnt lgkmcnt(7)
  v_mfma_f32_16x16x32_bf16 v[68:71], v[188:191], v[140:143], v[68:71]
  s_waitcnt lgkmcnt(6)
  v_cvt_pk_bf16_f32 v168, v64, v65
  v_cvt_pk_bf16_f32 v169, v66, v67
  v_mfma_f32_16x16x32_bf16 v[68:71], v[220:223], v[144:147], v[68:71]
  s_waitcnt lgkmcnt(5)
  ds_read_b128 v[180:183], v15 offset:35840
  v_mfma_f32_16x16x32_bf16 v[72:75], v[224:227], v[160:163], v[72:75]
  s_waitcnt lgkmcnt(5)
  ds_read_b128 v[160:163], v15 offset:36864
  v_mfma_f32_16x16x32_bf16 v[72:75], v[200:203], v[140:143], v[72:75]
  s_waitcnt lgkmcnt(5)
  ds_read_b128 v[232:235], v15 offset:37888
  v_cvt_pk_bf16_f32 v170, v68, v69
  v_mfma_f32_16x16x32_bf16 v[72:75], v[228:231], v[144:147], v[72:75]
  s_waitcnt lgkmcnt(5)
  v_cvt_pk_bf16_f32 v171, v70, v71
  v_mfma_f32_16x16x32_bf16 v[76:79], v[196:199], v[128:131], v[76:79]
  s_waitcnt lgkmcnt(4)
  v_permlane16_swap_b32 v168, v170
  v_mfma_f32_16x16x32_bf16 v[76:79], v[204:207], v[132:135], v[76:79]
  s_waitcnt vmcnt(4) lgkmcnt(3)
  ds_read_b64 v[108:109], v9
  v_cvt_pk_bf16_f32 v236, v72, v73
  v_mfma_f32_16x16x32_bf16 v[76:79], v[216:219], v[172:175], v[76:79]
  s_add_u32 s65, s65, s66
  ds_read_b64 v[116:117], v9 offset:32
  v_cvt_pk_bf16_f32 v237, v74, v75
  v_mfma_f32_16x16x32_bf16 v[80:83], v[176:179], v[128:131], v[80:83]
  s_cmp_ge_u32 s60, 5256
  ds_read_b64 v[120:121], v9 offset:64
  v_mfma_f32_16x16x32_bf16 v[80:83], v[188:191], v[132:135], v[80:83]
  s_cselect_b32 s64, s63, s64
  ds_read_b128 v[144:147], v3
  ds_read_b128 v[148:151], v3 offset:864
  v_mfma_f32_16x16x32_bf16 v[80:83], v[220:223], v[172:175], v[80:83]
  s_cselect_b32 s65, 72, s65
  ds_read_b128 v[136:139], v3 offset:1728
  v_cvt_pk_bf16_f32 v240, v76, v77
  v_mfma_f32_16x16x32_bf16 v[84:87], v[224:227], v[128:131], v[84:87]
  s_mul_i32 s66, s65, 1373568
  ds_read_b128 v[140:143], v6
  v_cvt_pk_bf16_f32 v241, v78, v79
  v_mfma_f32_16x16x32_bf16 v[84:87], v[200:203], v[132:135], v[84:87]
  s_mul_i32 s67, s64, 2688
  v_permlane16_swap_b32 v169, v171
  v_mfma_f32_16x16x32_bf16 v[84:87], v[228:231], v[172:175], v[84:87]
  s_waitcnt lgkmcnt(9)
  buffer_store_dwordx4 v[168:171], v12, s[8:11], s32 offen
  v_cvt_pk_bf16_f32 v242, v80, v81
  v_mfma_f32_16x16x32_bf16 v[88:91], v[196:199], v[180:183], v[88:91]
  s_waitcnt lgkmcnt(8)
  ds_read_b128 v[128:131], v3 offset:32
  ds_read_b128 v[132:135], v3 offset:896
  v_mfma_f32_16x16x32_bf16 v[88:91], v[204:207], v[160:163], v[88:91]
  s_waitcnt lgkmcnt(9)
  ds_read_b128 v[168:171], v3 offset:1760
  v_cvt_pk_bf16_f32 v243, v82, v83
  v_mfma_f32_16x16x32_bf16 v[88:91], v[216:219], v[232:235], v[88:91]
  s_waitcnt lgkmcnt(5)
  ds_read_b128 v[172:175], v6 offset:32
  v_permlane16_swap_b32 v240, v242
  v_mfma_f32_16x16x16_bf16 v[64:67], a[224:225], v[108:109], 0
  v_permlane16_swap_b32 v241, v243
  v_cvt_pk_bf16_f32 v238, v84, v85
  v_mfma_f32_16x16x16_bf16 v[68:71], a[234:235], v[116:117], 0
  v_cvt_pk_bf16_f32 v239, v86, v87
  v_permlane16_swap_b32 v236, v238
  v_mfma_f32_16x16x16_bf16 v[72:75], a[244:245], v[120:121], 0
  v_permlane16_swap_b32 v237, v239
  v_cvt_pk_bf16_f32 v216, v88, v89
  v_cvt_pk_bf16_f32 v217, v90, v91
  v_smfmac_f32_16x16x64_bf16 v[64:67], a[216:219], v[144:151], v0
  s_waitcnt lgkmcnt(4)
  ds_read_b128 v[144:147], v3 offset:64
  ds_read_b128 v[148:151], v3 offset:928
  v_smfmac_f32_16x16x64_bf16 v[64:67], a[220:223], v[136:143], v0
  s_add_u32 s35, s66, s67
  ds_read_b128 v[136:139], v3 offset:1792
  v_mfma_f32_16x16x32_bf16 v[92:95], v[176:179], v[180:183], v[92:95]
  s_cmp_ge_u32 s61, 667
  ds_read_b128 v[140:143], v6 offset:64
  v_mfma_f32_16x16x32_bf16 v[92:95], v[188:191], v[160:163], v[92:95]
  s_cselect_b32 s35, 268435456, s35
  ds_read_b128 v[188:191], v15 offset:8192
  v_mul_f32 v110, v64, v64
  v_mfma_f32_16x16x32_bf16 v[92:95], v[220:223], v[232:235], v[92:95]
  s_waitcnt lgkmcnt(7)
  ds_read_b128 v[220:223], v15 offset:9216
  v_add_f32 v114, v64, v65
  v_smfmac_f32_16x16x64_bf16 v[68:71], a[226:229], v[128:135], v0
  s_waitcnt lgkmcnt(6)
  ds_read_b128 v[204:207], v15 offset:10240
  v_fmac_f32 v110, v65, v65
  v_smfmac_f32_16x16x64_bf16 v[68:71], a[230:233], v[168:175], v0
  s_cmp_ge_u32 s60, 5329
  ds_read_b128 v[196:199], v15 offset:11264
  v_cvt_pk_bf16_f32 v218, v92, v93
  v_mfma_f32_16x16x32_bf16 v[96:99], v[224:227], v[180:183], v[96:99]
  s_waitcnt vmcnt(3)
  ds_read_b128 v[224:227], v15 offset:12288
  v_cvt_pk_bf16_f32 v219, v94, v95
  v_mfma_f32_16x16x32_bf16 v[96:99], v[200:203], v[160:163], v[96:99]
  s_cselect_b32 s35, 268435456, s35
  ds_read_b128 v[160:163], v15 offset:13312
  v_add_f32 v114, v114, v66
  v_mfma_f32_16x16x32_bf16 v[96:99], v[228:231], v[232:235], v[96:99]
  s_waitcnt lgkmcnt(8)
  buffer_store_dwordx4 v[240:243], v13, s[8:11], s32 offen
  ds_read_b64 v[120:121], v10
  v_smfmac_f32_16x16x64_bf16 v[72:75], a[236:239], v[144:151], v0
  s_waitcnt lgkmcnt(7)
  ds_read_b64 v[116:117], v10 offset:32
  ds_read_b64 v[108:109], v10 offset:64
  v_smfmac_f32_16x16x64_bf16 v[72:75], a[240:243], v[136:143], v0
  s_waitcnt lgkmcnt(8)
  ds_read_b128 v[136:139], v4
  v_cvt_pk_bf16_f32 v124, v96, v97
  v_mfma_f32_16x16x32_bf16 v[180:183], a[72:75], v[188:191], 0
  s_waitcnt lgkmcnt(8)
  ds_read_b128 v[140:143], v4 offset:864
  v_cvt_pk_bf16_f32 v125, v98, v99
  v_mfma_f32_16x16x32_bf16 v[180:183], a[76:79], v[220:223], v[180:183]
  s_waitcnt lgkmcnt(8)
  ds_read_b128 v[144:147], v4 offset:1728
  v_fmac_f32 v110, v66, v66
  v_mfma_f32_16x16x32_bf16 v[180:183], a[80:83], v[204:207], v[180:183]
  s_waitcnt lgkmcnt(8)
  ds_read_b128 v[148:151], v7
  v_add_f32 v114, v114, v67
  v_mfma_f32_16x16x32_bf16 v[180:183], a[84:87], v[196:199], v[180:183]
  s_waitcnt lgkmcnt(8)
  ds_read_b128 v[168:171], v4 offset:32
  v_fmac_f32 v110, v67, v67
  v_mfma_f32_16x16x32_bf16 v[180:183], a[88:91], v[224:227], v[180:183]
  s_waitcnt lgkmcnt(8)
  ds_read_b128 v[172:175], v4 offset:896
  v_add_f32 v114, v114, v68
  v_mfma_f32_16x16x32_bf16 v[180:183], a[92:95], v[160:163], v[180:183]
  s_waitcnt lgkmcnt(6)
  ds_read_b128 v[128:131], v4 offset:1760
  v_permlane16_swap_b32 v216, v218
  v_mfma_f32_16x16x16_bf16 v[76:79], a[224:225], v[120:121], 0
  v_permlane16_swap_b32 v217, v219
  v_fmac_f32 v110, v68, v68
  v_mfma_f32_16x16x16_bf16 v[80:83], a[234:235], v[116:117], 0
  v_cvt_pk_bf16_f32 v240, v180, v181
  v_cvt_pk_bf16_f32 v241, v182, v183
  v_add_f32 v114, v114, v69
  v_mfma_f32_16x16x16_bf16 v[84:87], a[244:245], v[108:109], 0
  s_cmp_eq_u32 s65, 0
  ds_read_b128 v[132:135], v7 offset:32
  ds_read_b128 v[176:179], v4 offset:64
  s_waitcnt lgkmcnt(7)
  v_smfmac_f32_16x16x64_bf16 v[76:79], a[216:219], v[136:143], v0
  s_waitcnt lgkmcnt(5)
  ds_read_b128 v[180:183], v4 offset:928
  v_fmac_f32 v110, v69, v69
  v_smfmac_f32_16x16x64_bf16 v[76:79], a[220:223], v[144:151], v0
  s_cselect_b32 s36, 268435456, s35
  ds_read_b128 v[144:147], v4 offset:1792
  v_add_f32 v114, v114, v70
  v_mfma_f32_16x16x32_bf16 v[136:139], a[96:99], v[188:191], 0
  s_add_u32 s37, s35, 195360
  ds_read_b128 v[148:151], v7 offset:64
  v_fmac_f32 v110, v70, v70
  v_mfma_f32_16x16x32_bf16 v[136:139], a[100:103], v[220:223], v[136:139]
  s_add_u32 s38, s35, 390720
  ds_write_b128 v16, v[184:187] offset:14336
  v_mfma_f32_16x16x32_bf16 v[136:139], a[104:107], v[204:207], v[136:139]
  s_waitcnt lgkmcnt(7)
  buffer_store_dwordx4 v[236:239], v22, s[8:11], s32 offen
  v_mul_f32 v122, v76, v76
  v_smfmac_f32_16x16x64_bf16 v[80:83], a[226:229], v[168:175], v0
  s_waitcnt lgkmcnt(5)
  ds_write_b64 v17, v[112:113] offset:14336
  v_smfmac_f32_16x16x64_bf16 v[80:83], a[230:233], v[128:135], v0
  s_add_u32 s39, s35, 586080
  v_add_f32 v126, v76, v77
  v_mfma_f32_16x16x32_bf16 v[136:139], a[108:111], v[196:199], v[136:139]
  s_waitcnt vmcnt(3)
  ds_read_b64 v[108:109], v11
  v_fmac_f32 v122, v77, v77
  v_mfma_f32_16x16x32_bf16 v[136:139], a[112:115], v[224:227], v[136:139]
  s_add_u32 s40, s35, 781440
  ds_read_b64 v[112:113], v11 offset:32
  v_add_f32 v126, v126, v78
  v_mfma_f32_16x16x32_bf16 v[136:139], a[116:119], v[160:163], v[136:139]
  s_waitcnt lgkmcnt(6)
  ds_read_b64 v[120:121], v11 offset:64
  v_fmac_f32 v122, v78, v78
  v_smfmac_f32_16x16x64_bf16 v[84:87], a[236:239], v[176:183], v0
  s_waitcnt lgkmcnt(5)
  ds_read_b128 v[176:179], v5
  ds_read_b128 v[180:183], v5 offset:864
  v_smfmac_f32_16x16x64_bf16 v[84:87], a[240:243], v[144:151], v0
  s_add_u32 s41, s35, 981120
  ds_read_b128 v[144:147], v5 offset:1728
  v_cvt_pk_bf16_f32 v242, v136, v137
  v_mfma_f32_16x16x32_bf16 v[236:239], a[120:123], v[188:191], 0
  s_add_u32 s42, s35, 1176480
  ds_read_b128 v[148:151], v8
  v_cvt_pk_bf16_f32 v243, v138, v139
  v_mfma_f32_16x16x32_bf16 v[236:239], a[124:127], v[220:223], v[236:239]
  s_add_u32 s43, s35, 1371840
  v_add_f32 v126, v126, v79
  v_fmac_f32 v122, v79, v79
  v_mfma_f32_16x16x32_bf16 v[236:239], a[128:131], v[204:207], v[236:239]
  s_add_u32 s44, s35, 1567200
  v_add_f32 v126, v126, v80
  v_fmac_f32 v122, v80, v80
  v_mfma_f32_16x16x32_bf16 v[236:239], a[132:135], v[196:199], v[236:239]
  s_cmp_eq_u32 s64, 0
  ds_read_b128 v[128:131], v5 offset:32
  ds_read_b128 v[132:135], v5 offset:896
  v_mfma_f32_16x16x32_bf16 v[236:239], a[136:139], v[224:227], v[236:239]
  s_cselect_b64 s[52:53], s[48:49], 0
  ds_read_b128 v[168:171], v5 offset:1760
  v_add_f32 v126, v126, v81
  v_mfma_f32_16x16x32_bf16 v[236:239], a[140:143], v[160:163], v[236:239]
  s_waitcnt lgkmcnt(5)
  ds_read_b128 v[172:175], v8 offset:32
  v_fmac_f32 v122, v81, v81
  v_add_f32 v126, v126, v82
  v_mfma_f32_16x16x16_bf16 v[88:91], a[224:225], v[108:109], 0
  v_fmac_f32 v122, v82, v82
  v_add_f32 v114, v114, v71
  v_fmac_f32 v110, v71, v71
  v_mfma_f32_16x16x16_bf16 v[92:95], a[234:235], v[112:113], 0
  v_cvt_pk_bf16_f32 v228, v236, v237
  v_cvt_pk_bf16_f32 v229, v238, v239
  v_add_f32 v126, v126, v83
  v_mfma_f32_16x16x16_bf16 v[96:99], a[244:245], v[120:121], 0
  v_fmac_f32 v122, v83, v83
  v_add_f32 v114, v114, v72
  v_fmac_f32 v110, v72, v72
  v_add_f32 v126, v126, v84
  v_smfmac_f32_16x16x64_bf16 v[88:91], a[216:219], v[176:183], v0
  s_waitcnt lgkmcnt(4)
  buffer_store_dwordx4 v[216:219], v14, s[8:11], s32 offen
  ds_read_b128 v[176:179], v5 offset:64
  v_smfmac_f32_16x16x64_bf16 v[88:91], a[220:223], v[144:151], v0
  s_cmp_eq_u32 s64, 72
  ds_read_b128 v[180:183], v5 offset:928
  ds_read_b128 v[144:147], v5 offset:1792
  v_mfma_f32_16x16x32_bf16 v[216:219], a[0:3], v[188:191], 0
  s_cselect_b64 s[52:53], s[50:51], s[52:53]
  ds_read_b128 v[148:151], v8 offset:64
  v_fmac_f32 v122, v84, v84
  v_mfma_f32_16x16x32_bf16 v[216:219], a[4:7], v[220:223], v[216:219]
  s_add_u32 s31, s31, 1
  v_mul_f32 v118, v88, v88
  v_add_f32 v108, v88, v89
  v_mfma_f32_16x16x32_bf16 v[216:219], a[8:11], v[204:207], v[216:219]
  s_waitcnt lgkmcnt(6)
  v_fmac_f32 v118, v89, v89
  v_add_f32 v108, v108, v90
  v_smfmac_f32_16x16x64_bf16 v[92:95], a[226:229], v[128:135], v0
  s_waitcnt lgkmcnt(4)
  v_fmac_f32 v118, v90, v90
  v_smfmac_f32_16x16x64_bf16 v[92:95], a[230:233], v[168:175], v0
  s_sub_u32 s68, s35, 196608
  v_add_f32 v108, v108, v91
  v_mfma_f32_16x16x32_bf16 v[216:219], a[12:15], v[196:199], v[216:219]
  s_cselect_b32 s68, s35, s68
  v_fmac_f32 v118, v91, v91
  v_add_f32 v114, v114, v73
  v_mfma_f32_16x16x32_bf16 v[216:219], a[16:19], v[224:227], v[216:219]
  v_add_f32 v108, v108, v92
  v_fmac_f32 v118, v92, v92
  v_mfma_f32_16x16x32_bf16 v[216:219], a[20:23], v[160:163], v[216:219]
  s_waitcnt lgkmcnt(2)
  v_add_f32 v108, v108, v93
  v_fmac_f32 v118, v93, v93
  v_smfmac_f32_16x16x64_bf16 v[96:99], a[236:239], v[176:183], v0
  s_waitcnt lgkmcnt(0)
  v_add_f32 v108, v108, v94
  v_smfmac_f32_16x16x64_bf16 v[96:99], a[240:243], v[144:151], v0
  v_cvt_pk_bf16_f32 v128, v216, v217
  v_mfma_f32_16x16x32_bf16 v[144:147], a[24:27], v[188:191], 0
  v_cvt_pk_bf16_f32 v129, v218, v219
  v_fmac_f32 v118, v94, v94
  v_mfma_f32_16x16x32_bf16 v[144:147], a[28:31], v[220:223], v[144:147]
  v_add_f32 v108, v108, v95
  v_fmac_f32 v118, v95, v95
  v_mfma_f32_16x16x32_bf16 v[144:147], a[32:35], v[204:207], v[144:147]
  v_add_f32 v108, v108, v96
  v_fmac_f32 v118, v96, v96
  v_mfma_f32_16x16x32_bf16 v[144:147], a[36:39], v[196:199], v[144:147]
  v_add_f32 v108, v108, v97
  v_fmac_f32 v118, v97, v97
  v_mfma_f32_16x16x32_bf16 v[144:147], a[40:43], v[224:227], v[144:147]
  buffer_store_dwordx2 v[124:125], v23, s[8:11], s32 offen
  v_fmac_f32 v110, v73, v73
  v_mfma_f32_16x16x32_bf16 v[144:147], a[44:47], v[160:163], v[144:147]
  s_mov_b32 s32, s33
  v_add_f32 v126, v126, v85
  v_fmac_f32 v122, v85, v85
  v_mfma_f32_16x16x32_bf16 v[216:219], a[48:51], v[188:191], 0
  s_mov_b32 s33, s34
  v_add_f32 v108, v108, v98
  v_fmac_f32 v118, v98, v98
  v_mfma_f32_16x16x32_bf16 v[216:219], a[52:55], v[220:223], v[216:219]
  s_mov_b32 s34, s35
  ds_read_b64 v[116:117], v19 offset:784
  v_cvt_pk_bf16_f32 v130, v144, v145
  v_mfma_f32_16x16x32_bf16 v[216:219], a[56:59], v[204:207], v[216:219]
  buffer_load_dword v25, v24, s[24:27], s68 offen
  v_mfma_f32_16x16x32_bf16 v[216:219], a[60:63], v[196:199], v[216:219]
  v_cvt_pk_bf16_f32 v131, v146, v147
  v_add_f32 v114, v114, v74
  v_mfma_f32_16x16x32_bf16 v[216:219], a[64:67], v[224:227], v[216:219]
  ds_read2_b64 v[144:147], v19 offset0:96 offset1:97
  v_fmac_f32 v110, v74, v74
  v_mfma_f32_16x16x32_bf16 v[216:219], a[68:71], v[160:163], v[216:219]
  v_add_f32 v126, v126, v86
  v_fmac_f32 v122, v86, v86
  v_mfma_f32_16x16x32_bf16 v[148:151], v[188:191], a[144:147], 0
  v_add_f32 v108, v108, v99
  v_fmac_f32 v118, v99, v99
  v_mfma_f32_16x16x32_bf16 v[148:151], v[220:223], a[148:151], v[148:151]
  v_add_f32 v114, v114, v75
  v_fmac_f32 v110, v75, v75
  v_mfma_f32_16x16x32_bf16 v[148:151], v[204:207], a[152:155], v[148:151]
  v_add_f32 v126, v126, v87
  v_fmac_f32 v122, v87, v87
  v_mfma_f32_16x16x32_bf16 v[148:151], v[196:199], a[156:159], v[148:151]
  v_permlane32_swap_b32 v108, v118
  v_mfma_f32_16x16x32_bf16 v[148:151], v[224:227], a[160:163], v[148:151]
  v_permlane32_swap_b32 v114, v110
  v_mfma_f32_16x16x32_bf16 v[148:151], v[160:163], a[164:167], v[148:151]
  v_permlane32_swap_b32 v126, v122
  v_mfma_f32_16x16x32_bf16 v[176:179], v[188:191], a[168:171], 0
  v_add_f32 v108, v108, v118
  v_add_f32 v114, v114, v110
  v_mfma_f32_16x16x32_bf16 v[176:179], v[220:223], a[172:175], v[176:179]
  v_add_f32 v126, v126, v122
  v_mov_b32 v110, v108
  v_mfma_f32_16x16x32_bf16 v[176:179], v[204:207], a[176:179], v[176:179]
  v_cvt_pk_bf16_f32 v124, v216, v217
  v_cvt_pk_bf16_f32 v125, v218, v219
  v_mfma_f32_16x16x32_bf16 v[176:179], v[196:199], a[180:183], v[176:179]
  v_permlane16_swap_b32 v114, v126
  v_mfma_f32_16x16x32_bf16 v[176:179], v[224:227], a[184:187], v[176:179]
  v_permlane16_swap_b32 v108, v110
  v_mfma_f32_16x16x32_bf16 v[176:179], v[160:163], a[188:191], v[176:179]
  s_waitcnt lgkmcnt(0)
  v_add_f32 v114, v114, v126
  v_add_f32 v108, v108, v110
  v_cvt_pk_bf16_f32 v194, v148, v149
  v_mfma_f32_16x16x16_bf16 v[216:219], v[116:117], v[166:167], 0
  v_cvt_pk_bf16_f32 v195, v150, v151
  v_mfma_f32_16x16x16_bf16 v[148:151], v[116:117], v[228:229], 0
  ds_write_b32 v111, v114
  v_cvt_pk_bf16_f32 v210, v176, v177
  v_mfma_f32_16x16x16_bf16 v[132:135], v[166:167], v[164:165], 0
  v_cvt_pk_bf16_f32 v211, v178, v179
  v_mfma_f32_16x16x16_bf16 v[176:179], v[228:229], v[164:165], 0
  ds_write_b32 v111, v108 offset:512
  v_mfma_f32_16x16x32_bf16 v[216:219], v[144:147], v[156:159], v[216:219]
  v_mfma_f32_16x16x32_bf16 v[148:151], v[144:147], v[240:243], v[148:151]
  v_mfma_f32_16x16x32_bf16 v[132:135], v[156:159], v[152:155], v[132:135]
  v_mfma_f32_16x16x32_bf16 v[176:179], v[240:243], v[152:155], v[176:179]
  s_waitcnt lgkmcnt(1)
  v_cndmask_b32 v184, v148, v216, s[56:57]
  s_waitcnt lgkmcnt(0)
  s_barrier
  v_mfma_f32_16x16x32_bf16 v[148:151], v[188:191], a[192:195], 0
  ds_read_b128 v[136:139], v15 offset:14336
  ds_read_b128 v[140:143], v15 offset:15360
  v_mfma_f32_16x16x32_bf16 v[148:151], v[220:223], a[196:199], v[148:151]
  ds_read_b128 v[220:223], v15 offset:16384
  v_mfma_f32_16x16x32_bf16 v[148:151], v[204:207], a[200:203], v[148:151]
  ds_read_b128 v[204:207], v15 offset:17408
  v_mfma_f32_16x16x32_bf16 v[148:151], v[196:199], a[204:207], v[148:151]
  ds_read_b128 v[196:199], v15 offset:18432
  v_mfma_f32_16x16x32_bf16 v[148:151], v[224:227], a[208:211], v[148:151]
  ds_read_b128 v[224:227], v15 offset:19456
  v_mfma_f32_16x16x32_bf16 v[148:151], v[160:163], a[212:215], v[148:151]
  ds_read_b128 v[160:163], v15
  v_exp_f32 v132, v132
  v_mfma_f32_16x16x16_bf16 v[188:191], v[166:167], v[124:125], 0
  v_exp_f32 v133, v133
  v_mfma_f32_16x16x16_bf16 v[216:219], v[228:229], v[124:125], 0
  ds_read_b128 v[180:183], v15 offset:1024
  v_exp_f32 v134, v134
  v_cvt_pk_bf16_f32 v214, v148, v149
  v_mfma_f32_16x16x32_bf16 v[188:191], v[156:159], v[128:131], v[188:191]
  v_exp_f32 v135, v135
  v_mfma_f32_16x16x32_bf16 v[216:219], v[240:243], v[128:131], v[216:219]
  s_waitcnt lgkmcnt(7)
  v_exp_f32 v176, v176
  v_mfma_f32_16x16x32_bf16 v[168:171], a[72:75], v[136:139], 0
  s_waitcnt lgkmcnt(6)
  v_exp_f32 v177, v177
  v_mfma_f32_16x16x32_bf16 v[168:171], a[76:79], v[140:143], v[168:171]
  s_waitcnt lgkmcnt(1)
  v_exp_f32 v178, v178
  v_mfma_f32_16x16x32_bf16 v[168:171], a[80:83], v[220:223], v[168:171]
  s_waitcnt lgkmcnt(0)
  v_exp_f32 v179, v179
  v_mfma_f32_16x16x32_bf16 v[168:171], a[84:87], v[204:207], v[168:171]
  v_cvt_pk_bf16_f32 v215, v150, v151
  v_cvt_pk_bf16_f32 v148, v132, v133
  v_mfma_f32_16x16x32_bf16 v[168:171], a[88:91], v[196:199], v[168:171]
  v_exp_f32 v188, v188
  v_mfma_f32_16x16x32_bf16 v[168:171], a[92:95], v[224:227], v[168:171]
  v_exp_f32 v189, v189
  v_mfma_f32_16x16x32_bf16 v[172:175], a[96:99], v[136:139], 0
  v_exp_f32 v190, v190
  v_mfma_f32_16x16x32_bf16 v[172:175], a[100:103], v[140:143], v[172:175]
  v_exp_f32 v191, v191
  v_mfma_f32_16x16x32_bf16 v[172:175], a[104:107], v[220:223], v[172:175]
  ds_read_b64 v[230:231], v19 offset:16
  v_cvt_pk_bf16_f32 v149, v134, v135
  v_mfma_f32_16x16x32_bf16 v[172:175], a[108:111], v[204:207], v[172:175]
  v_exp_f32 v216, v216
  v_mfma_f32_16x16x32_bf16 v[172:175], a[112:115], v[196:199], v[172:175]
  v_exp_f32 v217, v217
  v_mfma_f32_16x16x32_bf16 v[172:175], a[116:119], v[224:227], v[172:175]
  v_exp_f32 v218, v218
  v_mfma_f32_16x16x32_bf16 v[132:135], a[120:123], v[136:139], 0
  v_exp_f32 v219, v219
  v_mfma_f32_16x16x32_bf16 v[132:135], a[124:127], v[140:143], v[132:135]
  v_cvt_pk_bf16_f32 v150, v176, v177
  v_cvt_pk_bf16_f32 v151, v178, v179
  v_mfma_f32_16x16x32_bf16 v[132:135], a[128:131], v[220:223], v[132:135]
  ds_read2_b64 v[176:179], v19 offset0:0 offset1:1
  v_cvt_pk_bf16_f32 v236, v168, v169
  v_mfma_f32_16x16x32_bf16 v[132:135], a[132:135], v[204:207], v[132:135]
  v_cvt_pk_bf16_f32 v237, v170, v171
  v_cvt_pk_bf16_f32 v168, v188, v189
  v_mfma_f32_16x16x32_bf16 v[132:135], a[136:139], v[196:199], v[132:135]
  v_cvt_pk_bf16_f32 v169, v190, v191
  v_cvt_pk_bf16_f32 v170, v216, v217
  v_mfma_f32_16x16x32_bf16 v[132:135], a[140:143], v[224:227], v[132:135]
  v_cvt_pk_bf16_f32 v238, v172, v173
  v_cvt_pk_bf16_f32 v239, v174, v175
  v_mfma_f32_16x16x32_bf16 v[172:175], v[136:139], a[144:147], 0
  v_cvt_pk_bf16_f32 v171, v218, v219
  v_add_f32 v160, v160, v161
  v_mfma_f32_16x16x32_bf16 v[172:175], v[140:143], a[148:151], v[172:175]
  v_cvt_pk_bf16_f32 v200, v132, v133
  v_cvt_pk_bf16_f32 v201, v134, v135
  v_mfma_f32_16x16x32_bf16 v[172:175], v[220:223], a[152:155], v[172:175]
  v_add_f32 v162, v162, v163
  v_add_f32 v180, v180, v181
  v_mfma_f32_16x16x32_bf16 v[172:175], v[204:207], a[156:159], v[172:175]
  v_add_f32 v182, v182, v183
  v_add_f32 v160, v160, v162
  v_mfma_f32_16x16x32_bf16 v[172:175], v[196:199], a[160:163], v[172:175]
  v_add_f32 v180, v180, v182
  v_mul_f32 v161, 0x3baaaaab, v160
  v_mfma_f32_16x16x32_bf16 v[172:175], v[224:227], a[164:167], v[172:175]
  s_waitcnt lgkmcnt(1)
  v_fma_f32 v180, -v161, v160, v180
  v_max_f32 v180, 0, v180
  v_add_f32 v180, 0x3afba882, v180
  v_mfma_f32_16x16x16_bf16 v[132:135], v[200:201], v[164:165], 0
  v_rsq_f32 v180, v180
  v_add_u32 v19, 1160, v19
  v_mfma_f32_16x16x16_bf16 v[216:219], v[230:231], v[164:165], v[2:5]
  v_cvt_pk_bf16_f32 v108, v172, v173
  v_cvt_pk_bf16_f32 v109, v174, v175
  v_mul_f32 v180, 0x40ca568a, v180
  v_mfma_f32_16x16x16_bf16 v[172:175], v[200:201], v[124:125], 0
  v_mul_f32 v181, -v161, v180
  v_mfma_f32_16x16x16_bf16 v[160:163], v[230:231], v[124:125], v[2:5]
  ds_write_b64 v115, v[180:181]
  ds_read_b64 v[164:165], v119
  v_mfma_f32_16x16x32_bf16 v[132:135], v[236:239], v[152:155], v[132:135]
  s_waitcnt lgkmcnt(2)
  ds_read_b64 v[202:203], v119 offset:128
  v_mfma_f32_16x16x32_bf16 v[216:219], v[176:179], v[152:155], v[216:219]
  v_mfma_f32_16x16x32_bf16 v[172:175], v[236:239], v[128:131], v[172:175]
  v_exp_f32 v132, v132
  v_mfma_f32_16x16x32_bf16 v[160:163], v[176:179], v[128:131], v[160:163]
  v_exp_f32 v133, v133
  v_mfma_f32_16x16x32_bf16 v[128:131], v[136:139], a[168:171], 0
  v_exp_f32 v134, v134
  v_mfma_f32_16x16x32_bf16 v[128:131], v[140:143], a[172:175], v[128:131]
  v_exp_f32 v135, v135
  v_mfma_f32_16x16x32_bf16 v[128:131], v[220:223], a[176:179], v[128:131]
  s_waitcnt lgkmcnt(0)
  v_exp_f32 v216, v216
  v_mfma_f32_16x16x32_bf16 v[128:131], v[204:207], a[180:183], v[128:131]
  v_exp_f32 v172, v172
  v_mfma_f32_16x16x32_bf16 v[128:131], v[196:199], a[184:187], v[128:131]
  v_exp_f32 v173, v173
  v_mfma_f32_16x16x32_bf16 v[128:131], v[224:227], a[188:191], v[128:131]
  v_exp_f32 v174, v174
  v_mfma_f32_16x16x32_bf16 v[152:155], v[136:139], a[192:195], 0
  v_exp_f32 v175, v175
  v_mfma_f32_16x16x32_bf16 v[152:155], v[140:143], a[196:199], v[152:155]
  v_exp_f32 v160, v160
  v_mfma_f32_16x16x32_bf16 v[152:155], v[220:223], a[200:203], v[152:155]
  ds_read_u16 v110, v20
  v_cvt_pk_bf16_f32 v120, v132, v133
  v_mfma_f32_16x16x32_bf16 v[152:155], v[204:207], a[204:207], v[152:155]
  v_cvt_pk_bf16_f32 v121, v134, v135
  v_cvt_pk_bf16_f32 v122, v216, 0
  v_mfma_f32_16x16x32_bf16 v[152:155], v[196:199], a[208:211], v[152:155]
  ds_read_u16 v114, v20 offset:32
  v_cvt_pk_bf16_f32 v124, v172, v173
  v_mfma_f32_16x16x32_bf16 v[152:155], v[224:227], a[212:215], v[152:155]
  v_cvt_pk_bf16_f32 v112, v128, v129
  v_cvt_pk_bf16_f32 v113, v130, v131
  v_cvt_pk_bf16_f32 v125, v174, v175
  v_mfma_f32_16x16x16_bf16 v[128:131], v[116:117], v[200:201], 0
  v_cvt_pk_bf16_f32 v126, v160, 0
  v_fma_f32 v132, v64, v164, v165
  v_fma_f32 v185, v65, v164, v165
  v_mfma_f32_16x16x16_bf16 v[160:163], v[116:117], v[230:231], 0
  v_cvt_pk_bf16_f32 v116, v152, v153
  v_cvt_pk_bf16_f32 v117, v154, v155
  v_cvt_pk_bf16_f32 v132, v132, v185
  v_fma_f32 v133, v66, v164, v165
  v_mfma_f32_16x16x32_bf16 v[128:131], v[144:147], v[236:239], v[128:131]
  ds_read_u16 v118, v20 offset:64
  v_fma_f32 v185, v67, v164, v165
  v_mfma_f32_16x16x32_bf16 v[160:163], v[144:147], v[176:179], v[160:163]
  v_cvt_pk_bf16_f32 v133, v133, v185
  v_fma_f32 v134, v68, v164, v165
  v_mfma_f32_16x16x32_bf16 v[144:147], a[0:3], v[136:139], 0
  v_fma_f32 v185, v69, v164, v165
  v_cvt_pk_bf16_f32 v134, v134, v185
  v_mfma_f32_16x16x32_bf16 v[144:147], a[4:7], v[140:143], v[144:147]
  v_cndmask_b32 v185, v128, v160, s[56:57]
  v_fma_f32 v135, v70, v164, v165
  v_mfma_f32_16x16x32_bf16 v[144:147], a[8:11], v[220:223], v[144:147]
  v_fma_f32 v186, v71, v164, v165
  v_cvt_pk_bf16_f32 v135, v135, v186
  v_mfma_f32_16x16x32_bf16 v[144:147], a[12:15], v[204:207], v[144:147]
  ds_write_b128 v16, v[132:135] offset:2048
  v_mfma_f32_16x16x32_bf16 v[144:147], a[16:19], v[196:199], v[144:147]
  v_cndmask_b32 v184, v185, v184, s[46:47]
  v_fma_f32 v172, v72, v164, v165
  v_mfma_f32_16x16x32_bf16 v[144:147], a[20:23], v[224:227], v[144:147]
  v_fma_f32 v185, v73, v164, v165
  v_cvt_pk_bf16_f32 v172, v172, v185
  v_mfma_f32_16x16x32_bf16 v[160:163], a[246:249], v[148:151], 0
  v_fma_f32 v173, v74, v164, v165
  v_fma_f32 v185, v75, v164, v165
  v_mfma_f32_16x16x32_bf16 v[160:163], a[246:249], v[120:123], v[160:163]
  v_cvt_pk_bf16_f32 v152, v144, v145
  v_cvt_pk_bf16_f32 v153, v146, v147
  v_mfma_f32_16x16x32_bf16 v[132:135], v[192:195], v[148:151], 0
  s_waitcnt lgkmcnt(3)
  v_cvt_pk_bf16_f32 v173, v173, v185
  v_fma_f32 v128, v76, v202, v203
  v_mfma_f32_16x16x32_bf16 v[132:135], v[108:111], v[120:123], v[132:135]
  ds_write_b64 v17, v[172:173] offset:2048
  v_mfma_f32_16x16x32_bf16 v[144:147], v[208:211], v[148:151], 0
  s_waitcnt lgkmcnt(3)
  v_exp_f32 v184, v184
  v_mfma_f32_16x16x32_bf16 v[144:147], v[112:115], v[120:123], v[144:147]
  v_cvt_pk_bf16_f32 v184, v184, 0
  v_mul_f32 v160, 0x3ee9a3cd, v160
  v_mfma_f32_16x16x32_bf16 v[172:175], v[212:215], v[148:151], 0
  s_waitcnt lgkmcnt(2)
  ds_write_b16 v26, v184
  v_mfma_f32_16x16x32_bf16 v[172:175], v[116:119], v[120:123], v[172:175]
  ds_read_b128 v[148:151], v27
  ds_read_b64 v[120:121], v27 offset:16
  v_mfma_f32_16x16x32_bf16 v[216:219], a[24:27], v[136:139], 0
  v_cndmask_b32 v122, 0, v184, s[54:55]
  v_fma_f32 v164, v77, v202, v203
  v_mfma_f32_16x16x32_bf16 v[216:219], a[28:31], v[140:143], v[216:219]
  v_rcp_f32 v232, v160
  v_mfma_f32_16x16x32_bf16 v[216:219], a[32:35], v[220:223], v[216:219]
  v_cvt_pk_bf16_f32 v128, v128, v164
  v_fma_f32 v129, v78, v202, v203
  v_mfma_f32_16x16x32_bf16 v[216:219], a[36:39], v[204:207], v[216:219]
  v_fma_f32 v164, v79, v202, v203
  v_cvt_pk_bf16_f32 v129, v129, v164
  v_mfma_f32_16x16x32_bf16 v[216:219], a[40:43], v[196:199], v[216:219]
  v_fma_f32 v130, v80, v202, v203
  v_fma_f32 v164, v81, v202, v203
  v_mfma_f32_16x16x32_bf16 v[216:219], a[44:47], v[224:227], v[216:219]
  v_cvt_pk_bf16_f32 v130, v130, v164
  v_fma_f32 v131, v82, v202, v203
  v_mfma_f32_16x16x32_bf16 v[180:183], a[246:249], v[168:171], 0
  v_fma_f32 v164, v83, v202, v203
  v_cvt_pk_bf16_f32 v131, v131, v164
  v_mfma_f32_16x16x32_bf16 v[180:183], a[246:249], v[124:127], v[180:183]
  ds_write_b128 v16, v[128:131] offset:8192
  v_mfma_f32_16x16x32_bf16 v[128:131], v[192:195], v[168:171], 0
  v_cvt_pk_bf16_f32 v154, v216, v217
  v_cvt_pk_bf16_f32 v155, v218, v219
  v_mfma_f32_16x16x32_bf16 v[128:131], v[108:111], v[124:127], v[128:131]
  v_mul_f32 v180, 0x3ee9a3cd, v180
  v_mul_f32 v132, v132, v232
  v_mfma_f32_16x16x32_bf16 v[216:219], v[208:211], v[168:171], 0
  v_rcp_f32 v233, v180
  v_mfma_f32_16x16x32_bf16 v[216:219], v[112:115], v[124:127], v[216:219]
  v_mul_f32 v133, v133, v232
  v_cvt_pk_bf16_f32 v188, v132, v133
  v_mfma_f32_16x16x32_bf16 v[184:187], v[212:215], v[168:171], 0
  v_mul_f32 v134, v134, v232
  v_mul_f32 v135, v135, v232
  v_mfma_f32_16x16x32_bf16 v[184:187], v[116:119], v[124:127], v[184:187]
  v_cvt_pk_bf16_f32 v189, v134, v135
  v_mul_f32 v144, v144, v232
  v_mfma_f32_16x16x32_bf16 v[132:135], a[48:51], v[136:139], 0
  v_mul_f32 v145, v145, v232
  v_cvt_pk_bf16_f32 v190, v144, v145
  v_mfma_f32_16x16x32_bf16 v[132:135], a[52:55], v[140:143], v[132:135]
  v_mul_f32 v146, v146, v232
  v_mul_f32 v147, v147, v232
  v_mfma_f32_16x16x32_bf16 v[132:135], a[56:59], v[220:223], v[132:135]
  v_cvt_pk_bf16_f32 v191, v146, v147
  v_mul_f32 v128, v128, v233
  v_mfma_f32_16x16x32_bf16 v[132:135], a[60:63], v[204:207], v[132:135]
  ds_write_b128 v16, v[188:191] offset:20480
  v_mfma_f32_16x16x32_bf16 v[132:135], a[64:67], v[196:199], v[132:135]
  v_mul_f32 v129, v129, v233
  v_cvt_pk_bf16_f32 v196, v128, v129
  v_mfma_f32_16x16x32_bf16 v[132:135], a[68:71], v[224:227], v[132:135]
  s_waitcnt lgkmcnt(3)
  s_barrier
  v_mfma_f32_16x16x32_bf16 v[224:227], a[246:249], v[148:151], 0
  s_waitcnt lgkmcnt(2)
  v_mul_f32 v130, v130, v233
  v_mul_f32 v131, v131, v233
  v_mfma_f32_16x16x32_bf16 v[224:227], a[246:249], v[120:123], v[224:227]
  v_cvt_pk_bf16_f32 v124, v132, v133
  v_cvt_pk_bf16_f32 v125, v134, v135
  v_mfma_f32_16x16x32_bf16 v[144:147], v[148:151], v[192:195], 0
  v_cvt_pk_bf16_f32 v197, v130, v131
  v_mul_f32 v216, v216, v233
  v_mfma_f32_16x16x32_bf16 v[144:147], v[120:123], v[108:111], v[144:147]
  v_mul_f32 v217, v217, v233
  v_cvt_pk_bf16_f32 v198, v216, v217
  v_mfma_f32_16x16x32_bf16 v[140:143], v[148:151], v[208:211], 0
  v_mul_f32 v218, v218, v233
  v_mul_f32 v219, v219, v233
  v_mfma_f32_16x16x32_bf16 v[140:143], v[120:123], v[112:115], v[140:143]
  ds_read_b128 v[128:131], v15 offset:2048
  v_cvt_pk_bf16_f32 v199, v218, v219
  v_mfma_f32_16x16x32_bf16 v[216:219], v[148:151], v[212:215], 0
  ds_read_b128 v[132:135], v15 offset:3072
  v_mul_f32 v224, 0x3ee9a3cd, v224
  v_mfma_f32_16x16x32_bf16 v[216:219], v[120:123], v[116:119], v[216:219]
  ds_read_b128 v[136:139], v15 offset:4096
  v_rcp_f32 v122, v224
  v_mfma_f32_16x16x16_bf16 v[188:191], v[166:167], v[124:125], 0
  v_cndmask_b32 v234, v140, v144, s[54:55]
  v_fma_f32 v120, v84, v202, v203
  v_fma_f32 v126, v85, v202, v203
  v_mfma_f32_16x16x16_bf16 v[164:167], v[228:229], v[124:125], 0
  v_cvt_pk_bf16_f32 v120, v120, v126
  v_fma_f32 v121, v86, v202, v203
  v_fma_f32 v126, v87, v202, v203
  v_mfma_f32_16x16x16_bf16 v[204:207], v[200:201], v[124:125], 0
  v_cvt_pk_bf16_f32 v121, v121, v126
  v_mul_f32 v172, v172, v232
  v_mul_f32 v173, v173, v232
  v_mfma_f32_16x16x16_bf16 v[220:223], v[230:231], v[124:125], v[2:5]
  v_cvt_pk_bf16_f32 v124, v172, v173
  v_mul_f32 v174, v174, v232
  v_mul_f32 v175, v175, v232
  v_cvt_pk_bf16_f32 v125, v174, v175
  v_mfma_f32_16x16x32_bf16 v[188:191], v[156:159], v[152:155], v[188:191]
  ds_read_b128 v[140:143], v15 offset:5120
  ds_read_b128 v[144:147], v15 offset:6144
  v_mfma_f32_16x16x32_bf16 v[164:167], v[240:243], v[152:155], v[164:167]
  ds_read_b128 v[148:151], v15 offset:7168
  v_mul_f32 v184, v184, v233
  v_mfma_f32_16x16x32_bf16 v[204:207], v[236:239], v[152:155], v[204:207]
  ds_write_b128 v16, v[196:199] offset:26624
  v_mfma_f32_16x16x32_bf16 v[220:223], v[176:179], v[152:155], v[220:223]
  s_waitcnt lgkmcnt(6)
  v_exp_f32 v188, v188
  v_mfma_f32_16x16x32_bf16 v[156:159], a[0:3], v[128:131], 0
  s_waitcnt lgkmcnt(5)
  v_exp_f32 v189, v189
  v_mfma_f32_16x16x32_bf16 v[156:159], a[4:7], v[132:135], v[156:159]
  s_waitcnt lgkmcnt(4)
  ds_write_b64 v17, v[120:121] offset:8192
  v_mfma_f32_16x16x32_bf16 v[156:159], a[8:11], v[136:139], v[156:159]
  s_waitcnt lgkmcnt(4)
  ds_write_b64 v17, v[124:125] offset:20480
  v_mfma_f32_16x16x32_bf16 v[156:159], a[12:15], v[140:143], v[156:159]
  s_waitcnt lgkmcnt(4)
  v_exp_f32 v190, v190
  v_mfma_f32_16x16x32_bf16 v[156:159], a[16:19], v[144:147], v[156:159]
  s_waitcnt lgkmcnt(3)
  v_exp_f32 v191, v191
  v_mfma_f32_16x16x32_bf16 v[156:159], a[20:23], v[148:151], v[156:159]
  v_exp_f32 v164, v164
  v_mfma_f32_16x16x32_bf16 v[176:179], a[24:27], v[128:131], 0
  v_exp_f32 v165, v165
  v_mfma_f32_16x16x32_bf16 v[176:179], a[28:31], v[132:135], v[176:179]
  v_exp_f32 v166, v166
  v_mfma_f32_16x16x32_bf16 v[176:179], a[32:35], v[136:139], v[176:179]
  v_exp_f32 v167, v167
  v_mfma_f32_16x16x32_bf16 v[176:179], a[36:39], v[140:143], v[176:179]
  v_exp_f32 v204, v204
  v_mfma_f32_16x16x32_bf16 v[176:179], a[40:43], v[144:147], v[176:179]
  v_exp_f32 v205, v205
  v_mfma_f32_16x16x32_bf16 v[176:179], a[44:47], v[148:151], v[176:179]
  v_exp_f32 v206, v206
  v_mfma_f32_16x16x32_bf16 v[196:199], a[48:51], v[128:131], 0
  v_exp_f32 v207, v207
  v_mfma_f32_16x16x32_bf16 v[196:199], a[52:55], v[132:135], v[196:199]
  v_exp_f32 v220, v220
  v_mfma_f32_16x16x32_bf16 v[196:199], a[56:59], v[136:139], v[196:199]
  v_cvt_pk_bf16_f32 v236, v188, v189
  v_cvt_pk_bf16_f32 v237, v190, v191
  v_mfma_f32_16x16x32_bf16 v[196:199], a[60:63], v[140:143], v[196:199]
  v_cvt_pk_bf16_f32 v238, v164, v165
  v_cvt_pk_bf16_f32 v239, v166, v167
  v_mfma_f32_16x16x32_bf16 v[196:199], a[64:67], v[144:147], v[196:199]
  v_cvt_pk_bf16_f32 v152, v156, v157
  v_cvt_pk_bf16_f32 v153, v158, v159
  v_mfma_f32_16x16x32_bf16 v[196:199], a[68:71], v[148:151], v[196:199]
  v_cvt_pk_bf16_f32 v124, v204, v205
  v_cvt_pk_bf16_f32 v125, v206, v207
  v_mfma_f32_16x16x32_bf16 v[204:207], a[246:249], v[236:239], 0
  v_cvt_pk_bf16_f32 v126, v220, 0
  v_cvt_pk_bf16_f32 v154, v176, v177
  v_cvt_pk_bf16_f32 v155, v178, v179
  v_mfma_f32_16x16x32_bf16 v[204:207], a[246:249], v[124:127], v[204:207]
  v_cvt_pk_bf16_f32 v164, v196, v197
  v_cvt_pk_bf16_f32 v165, v198, v199
  v_mfma_f32_16x16x32_bf16 v[156:159], v[192:195], v[236:239], 0
  v_mul_f32 v185, v185, v233
  v_cvt_pk_bf16_f32 v166, v184, v185
  v_mfma_f32_16x16x32_bf16 v[156:159], v[108:111], v[124:127], v[156:159]
  v_mul_f32 v204, 0x3ee9a3cd, v204
  v_mul_f32 v186, v186, v233
  v_mfma_f32_16x16x32_bf16 v[192:195], v[208:211], v[236:239], 0
  v_rcp_f32 v110, v204
  v_mfma_f32_16x16x32_bf16 v[192:195], v[112:115], v[124:127], v[192:195]
  v_mul_f32 v156, v156, v110
  v_mul_f32 v157, v157, v110
  v_mfma_f32_16x16x32_bf16 v[208:211], v[212:215], v[236:239], 0
  v_mul_f32 v158, v158, v110
  v_mul_f32 v159, v159, v110
  v_mfma_f32_16x16x32_bf16 v[208:211], v[116:119], v[124:127], v[208:211]
  v_mul_f32 v192, v192, v110
  v_mul_f32 v193, v193, v110
  v_mfma_f32_16x16x32_bf16 v[212:215], a[72:75], v[128:131], 0
  v_mul_f32 v194, v194, v110
  v_mul_f32 v195, v195, v110
  v_mfma_f32_16x16x32_bf16 v[212:215], a[76:79], v[132:135], v[212:215]
  v_cvt_pk_bf16_f32 v236, v156, v157
  v_cvt_pk_bf16_f32 v237, v158, v159
  v_mfma_f32_16x16x32_bf16 v[212:215], a[80:83], v[136:139], v[212:215]
  v_cvt_pk_bf16_f32 v238, v192, v193
  v_cvt_pk_bf16_f32 v239, v194, v195
  v_mfma_f32_16x16x32_bf16 v[212:215], a[84:87], v[140:143], v[212:215]
  ds_write_b128 v16, v[236:239] offset:32768
  v_mfma_f32_16x16x32_bf16 v[212:215], a[88:91], v[144:147], v[212:215]
  v_mul_f32 v187, v187, v233
  v_mul_f32 v208, v208, v110
  v_mfma_f32_16x16x32_bf16 v[212:215], a[92:95], v[148:151], v[212:215]
  v_mul_f32 v209, v209, v110
  v_mul_f32 v210, v210, v110
  v_mfma_f32_16x16x32_bf16 v[236:239], a[96:99], v[128:131], 0
  v_mul_f32 v211, v211, v110
  v_cndmask_b32 v234, v216, v234, s[56:57]
  v_mfma_f32_16x16x32_bf16 v[236:239], a[100:103], v[132:135], v[236:239]
  v_cvt_pk_bf16_f32 v167, v186, v187
  v_cvt_pk_bf16_f32 v116, v208, v209
  v_mfma_f32_16x16x32_bf16 v[236:239], a[104:107], v[136:139], v[236:239]
  ds_write_b64 v17, v[166:167] offset:26624
  v_mfma_f32_16x16x32_bf16 v[236:239], a[108:111], v[140:143], v[236:239]
  v_cvt_pk_bf16_f32 v117, v210, v211
  v_mul_f32 v234, v234, v122
  v_mfma_f32_16x16x32_bf16 v[236:239], a[112:115], v[144:147], v[236:239]
  ds_write_b64 v17, v[116:117] offset:32768
  v_mfma_f32_16x16x32_bf16 v[236:239], a[116:119], v[148:151], v[236:239]
  v_cvt_pk_bf16_f32 v234, v234, v234
  v_max3_f32 v1, v1, v160, v232
  v_mfma_f32_16x16x32_bf16 v[160:163], a[120:123], v[128:131], 0
  ds_write_b16 v20, v234 offset:384
  v_mfma_f32_16x16x32_bf16 v[160:163], a[124:127], v[132:135], v[160:163]
  v_max3_f32 v1, v1, v180, v233
  v_cvt_pk_bf16_f32 v156, v212, v213
  v_mfma_f32_16x16x32_bf16 v[160:163], a[128:131], v[136:139], v[160:163]
  v_cvt_pk_bf16_f32 v157, v214, v215
  v_max3_f32 v1, v1, v224, v122
  v_mfma_f32_16x16x32_bf16 v[160:163], a[132:135], v[140:143], v[160:163]
  v_cvt_pk_bf16_f32 v158, v236, v237
  v_cvt_pk_bf16_f32 v159, v238, v239
  v_mfma_f32_16x16x32_bf16 v[160:163], a[136:139], v[144:147], v[160:163]
  v_add_u32 v20, 1160, v20
  v_max3_f32 v1, v1, v204, v110
  v_mfma_f32_16x16x32_bf16 v[160:163], a[140:143], v[148:151], v[160:163]
  s_waitcnt lgkmcnt(1)
  s_waitcnt lgkmcnt(0)
  s_barrier
  s_branch L_loop
L_cpf:
  s_lshl_b32 s60, s30, 2
  s_add_u32 s60, s60, s28
  s_lshl_b32 s60, s60, 6
  s_add_u32 s60, s60, L_last-L_pc
  s_add_u32 s60, s0, s60
  s_addc_u32 s61, s1, 0
  global_load_dword v25, v123, s[60:61]
  s_branch L_cpf_ret
L_last:
  v_mfma_f32_16x16x32_bf16 v[168:171], v[128:131], a[144:147], 0
  ds_read_b64 v[108:109], v119 offset:256
  v_and_b32 v250, -16, v111
  v_mfma_f32_16x16x32_bf16 v[168:171], v[132:135], a[148:151], v[168:171]
  v_cvt_pk_bf16_f32 v166, v160, v161
  v_cvt_pk_bf16_f32 v167, v162, v163
  v_mfma_f32_16x16x32_bf16 v[168:171], v[136:139], a[152:155], v[168:171]
  v_mfma_f32_16x16x32_bf16 v[168:171], v[140:143], a[156:159], v[168:171]
  v_mfma_f32_16x16x32_bf16 v[168:171], v[144:147], a[160:163], v[168:171]
  v_mfma_f32_16x16x32_bf16 v[168:171], v[148:151], a[164:167], v[168:171]
  s_waitcnt lgkmcnt(0)
  ds_read_b128 v[160:163], v15 offset:20480
  v_fma_f32 v172, v52, v108, v109
  v_mfma_f32_16x16x32_bf16 v[176:179], v[128:131], a[168:171], 0
  ds_read_b128 v[180:183], v18
  ds_read_b128 v[184:187], v15 offset:21504
  v_mfma_f32_16x16x32_bf16 v[176:179], v[132:135], a[172:175], v[176:179]
  ds_read_b128 v[188:191], v18 offset:6144
  v_cvt_pk_bf16_f32 v192, v168, v169
  v_mfma_f32_16x16x32_bf16 v[176:179], v[136:139], a[176:179], v[176:179]
  ds_read_b128 v[196:199], v15 offset:22528
  v_cvt_pk_bf16_f32 v193, v170, v171
  v_mfma_f32_16x16x32_bf16 v[176:179], v[140:143], a[180:183], v[176:179]
  ds_read_b128 v[168:171], v18 offset:1024
  v_fma_f32 v110, v53, v108, v109
  v_mfma_f32_16x16x32_bf16 v[176:179], v[144:147], a[184:187], v[176:179]
  ds_read_b128 v[200:203], v18 offset:7168
  v_cvt_pk_bf16_f32 v172, v172, v110
  v_mfma_f32_16x16x32_bf16 v[176:179], v[148:151], a[188:191], v[176:179]
  v_fma_f32 v173, v54, v108, v109
  v_fma_f32 v110, v55, v108, v109
  v_mfma_f32_16x16x32_bf16 v[204:207], v[128:131], a[192:195], 0
  ds_read_b128 v[128:131], v18 offset:2048
  v_cvt_pk_bf16_f32 v173, v173, v110
  v_mfma_f32_16x16x32_bf16 v[204:207], v[132:135], a[196:199], v[204:207]
  ds_read_b128 v[132:135], v18 offset:8192
  v_cvt_pk_bf16_f32 v208, v176, v177
  v_mfma_f32_16x16x32_bf16 v[204:207], v[136:139], a[200:203], v[204:207]
  ds_read_b128 v[136:139], v15 offset:26624
  v_cvt_pk_bf16_f32 v209, v178, v179
  v_mfma_f32_16x16x32_bf16 v[204:207], v[140:143], a[204:207], v[204:207]
  ds_read_b128 v[140:143], v15 offset:27648
  v_fma_f32 v174, v56, v108, v109
  v_mfma_f32_16x16x32_bf16 v[204:207], v[144:147], a[208:211], v[204:207]
  ds_read_b128 v[144:147], v15 offset:28672
  v_fma_f32 v110, v57, v108, v109
  v_mfma_f32_16x16x32_bf16 v[204:207], v[148:151], a[212:215], v[204:207]
  s_waitcnt lgkmcnt(11)
  v_cvt_pk_bf16_f32 v174, v174, v110
  v_fma_f32 v175, v58, v108, v109
  v_mfma_f32_16x16x32_bf16 v[64:67], a[250:253], v[160:163], v[64:67]
  s_waitcnt lgkmcnt(9)
  v_fma_f32 v110, v59, v108, v109
  v_cvt_pk_bf16_f32 v175, v175, v110
  v_mfma_f32_16x16x32_bf16 v[64:67], v[180:183], v[184:187], v[64:67]
  s_waitcnt lgkmcnt(7)
  ds_write_b128 v16, v[172:175] offset:14336
  v_mfma_f32_16x16x32_bf16 v[64:67], v[188:191], v[196:199], v[64:67]
  v_cvt_pk_bf16_f32 v172, v204, v205
  v_cvt_pk_bf16_f32 v173, v206, v207
  v_mfma_f32_16x16x32_bf16 v[68:71], v[100:103], v[160:163], v[68:71]
  s_waitcnt lgkmcnt(7)
  v_fma_f32 v112, v60, v108, v109
  v_fma_f32 v110, v61, v108, v109
  v_mfma_f32_16x16x32_bf16 v[68:71], v[168:171], v[184:187], v[68:71]
  s_waitcnt lgkmcnt(6)
  v_cvt_pk_bf16_f32 v112, v112, v110
  v_fma_f32 v113, v62, v108, v109
  v_mfma_f32_16x16x32_bf16 v[68:71], v[200:203], v[196:199], v[68:71]
  ds_read_b128 v[204:207], v15 offset:32768
  v_fma_f32 v110, v63, v108, v109
  v_mfma_f32_16x16x32_bf16 v[72:75], v[104:107], v[160:163], v[72:75]
  s_waitcnt lgkmcnt(6)
  ds_read_b128 v[160:163], v15 offset:33792
  v_cvt_pk_bf16_f32 v113, v113, v110
  v_mfma_f32_16x16x32_bf16 v[72:75], v[128:131], v[184:187], v[72:75]
  s_waitcnt lgkmcnt(6)
  ds_read_b128 v[184:187], v15 offset:34816
  v_mfma_f32_16x16x32_bf16 v[72:75], v[132:135], v[196:199], v[72:75]
  s_waitcnt lgkmcnt(6)
  ds_write_b64 v17, v[112:113] offset:14336
  v_mfma_f32_16x16x32_bf16 v[76:79], a[250:253], v[136:139], v[76:79]
  s_waitcnt lgkmcnt(6)
  v_mfma_f32_16x16x32_bf16 v[76:79], v[180:183], v[140:143], v[76:79]
  s_waitcnt lgkmcnt(5)
  v_mfma_f32_16x16x32_bf16 v[76:79], v[188:191], v[144:147], v[76:79]
  v_mfma_f32_16x16x32_bf16 v[80:83], v[100:103], v[136:139], v[80:83]
  v_mfma_f32_16x16x32_bf16 v[80:83], v[168:171], v[140:143], v[80:83]
  v_mfma_f32_16x16x32_bf16 v[80:83], v[200:203], v[144:147], v[80:83]
  ds_read_b128 v[196:199], v18 offset:9216
  ds_read_b128 v[148:151], v15 offset:23552
  v_mfma_f32_16x16x32_bf16 v[84:87], v[104:107], v[136:139], v[84:87]
  ds_read_b128 v[136:139], v18 offset:3072
  v_mfma_f32_16x16x32_bf16 v[84:87], v[128:131], v[140:143], v[84:87]
  ds_read_b128 v[140:143], v15 offset:24576
  v_mfma_f32_16x16x32_bf16 v[84:87], v[132:135], v[144:147], v[84:87]
  s_waitcnt lgkmcnt(7)
  ds_read_b128 v[144:147], v18 offset:12288
  v_mfma_f32_16x16x32_bf16 v[88:91], a[250:253], v[204:207], v[88:91]
  s_waitcnt lgkmcnt(7)
  ds_read_b128 v[176:179], v15 offset:25600
  v_mfma_f32_16x16x32_bf16 v[88:91], v[180:183], v[160:163], v[88:91]
  s_waitcnt lgkmcnt(7)
  ds_read_b128 v[180:183], v18 offset:10240
  v_mfma_f32_16x16x32_bf16 v[88:91], v[188:191], v[184:187], v[88:91]
  ds_read_b128 v[188:191], v18 offset:4096
  v_mfma_f32_16x16x32_bf16 v[92:95], v[100:103], v[204:207], v[92:95]
  ds_read_b128 v[212:215], v18 offset:13312
  v_mfma_f32_16x16x32_bf16 v[92:95], v[168:171], v[160:163], v[92:95]
  ds_read_b128 v[168:171], v18 offset:11264
  v_mfma_f32_16x16x32_bf16 v[92:95], v[200:203], v[184:187], v[92:95]
  ds_read_b128 v[200:203], v18 offset:5120
  v_mfma_f32_16x16x32_bf16 v[96:99], v[104:107], v[204:207], v[96:99]
  ds_read_b128 v[204:207], v18 offset:14336
  v_mfma_f32_16x16x32_bf16 v[96:99], v[128:131], v[160:163], v[96:99]
  ds_read_b128 v[128:131], v15 offset:29696
  v_mfma_f32_16x16x32_bf16 v[96:99], v[132:135], v[184:187], v[96:99]
  s_waitcnt lgkmcnt(11)
  ds_read_b128 v[132:135], v15 offset:30720
  v_mfma_f32_16x16x32_bf16 v[64:67], v[196:199], v[148:151], v[64:67]
  s_waitcnt lgkmcnt(10)
  ds_read_b128 v[184:187], v15 offset:31744
  v_mfma_f32_16x16x32_bf16 v[64:67], v[136:139], v[140:143], v[64:67]
  s_waitcnt lgkmcnt(9)
  v_mfma_f32_16x16x32_bf16 v[64:67], v[144:147], v[176:179], v[64:67]
  s_waitcnt lgkmcnt(8)
  v_mfma_f32_16x16x32_bf16 v[68:71], v[180:183], v[148:151], v[68:71]
  s_waitcnt lgkmcnt(7)
  v_mfma_f32_16x16x32_bf16 v[68:71], v[188:191], v[140:143], v[68:71]
  s_waitcnt lgkmcnt(6)
  v_cvt_pk_bf16_f32 v160, v64, v65
  v_cvt_pk_bf16_f32 v161, v66, v67
  v_mfma_f32_16x16x32_bf16 v[68:71], v[212:215], v[176:179], v[68:71]
  s_waitcnt lgkmcnt(5)
  ds_read_b128 v[216:219], v15 offset:35840
  v_mfma_f32_16x16x32_bf16 v[72:75], v[168:171], v[148:151], v[72:75]
  s_waitcnt lgkmcnt(5)
  ds_read_b128 v[148:151], v15 offset:36864
  v_mfma_f32_16x16x32_bf16 v[72:75], v[200:203], v[140:143], v[72:75]
  s_waitcnt lgkmcnt(5)
  v_cvt_pk_bf16_f32 v162, v68, v69
  v_cvt_pk_bf16_f32 v163, v70, v71
  v_mfma_f32_16x16x32_bf16 v[72:75], v[204:207], v[176:179], v[72:75]
  s_waitcnt lgkmcnt(4)
  v_permlane16_swap_b32 v160, v162
  v_mfma_f32_16x16x32_bf16 v[76:79], v[196:199], v[128:131], v[76:79]
  s_waitcnt lgkmcnt(3)
  v_permlane16_swap_b32 v161, v163
  v_mfma_f32_16x16x32_bf16 v[76:79], v[136:139], v[132:135], v[76:79]
  s_waitcnt lgkmcnt(2)
  buffer_store_dwordx4 v[160:163], v12, s[8:11], s32 offen
  s_nop 1
  ds_read_b128 v[160:163], v15 offset:37888
  v_mfma_f32_16x16x32_bf16 v[76:79], v[144:147], v[184:187], v[76:79]
  v_cvt_pk_bf16_f32 v176, v72, v73
  v_cvt_pk_bf16_f32 v177, v74, v75
  v_mfma_f32_16x16x32_bf16 v[80:83], v[180:183], v[128:131], v[80:83]
  v_mfma_f32_16x16x32_bf16 v[80:83], v[188:191], v[132:135], v[80:83]
  v_cvt_pk_bf16_f32 v140, v76, v77
  v_cvt_pk_bf16_f32 v141, v78, v79
  v_mfma_f32_16x16x32_bf16 v[80:83], v[212:215], v[184:187], v[80:83]
  v_mfma_f32_16x16x32_bf16 v[84:87], v[168:171], v[128:131], v[84:87]
  v_mfma_f32_16x16x32_bf16 v[84:87], v[200:203], v[132:135], v[84:87]
  ds_read_b128 v[132:135], v15 offset:8192
  v_cvt_pk_bf16_f32 v142, v80, v81
  v_mfma_f32_16x16x32_bf16 v[84:87], v[204:207], v[184:187], v[84:87]
  s_waitcnt lgkmcnt(3)
  ds_read_b128 v[184:187], v15 offset:9216
  v_cvt_pk_bf16_f32 v143, v82, v83
  v_mfma_f32_16x16x32_bf16 v[88:91], v[196:199], v[216:219], v[88:91]
  s_waitcnt lgkmcnt(3)
  ds_read_b128 v[196:199], v15 offset:10240
  v_mfma_f32_16x16x32_bf16 v[88:91], v[136:139], v[148:151], v[88:91]
  s_waitcnt lgkmcnt(3)
  ds_read_b128 v[136:139], v15 offset:11264
  v_cvt_pk_bf16_f32 v178, v84, v85
  v_mfma_f32_16x16x32_bf16 v[88:91], v[144:147], v[160:163], v[88:91]
  ds_read_b128 v[144:147], v15 offset:12288
  v_cvt_pk_bf16_f32 v179, v86, v87
  v_mfma_f32_16x16x32_bf16 v[92:95], v[180:183], v[216:219], v[92:95]
  ds_read_b128 v[180:183], v15 offset:13312
  v_mfma_f32_16x16x32_bf16 v[92:95], v[188:191], v[148:151], v[92:95]
  v_permlane16_swap_b32 v140, v142
  v_mfma_f32_16x16x32_bf16 v[92:95], v[212:215], v[160:163], v[92:95]
  v_permlane16_swap_b32 v141, v143
  v_mfma_f32_16x16x32_bf16 v[96:99], v[168:171], v[216:219], v[96:99]
  v_permlane16_swap_b32 v176, v178
  v_mfma_f32_16x16x32_bf16 v[96:99], v[200:203], v[148:151], v[96:99]
  v_permlane16_swap_b32 v177, v179
  v_mfma_f32_16x16x32_bf16 v[96:99], v[204:207], v[160:163], v[96:99]
  s_waitcnt lgkmcnt(5)
  buffer_store_dwordx4 v[140:143], v13, s[8:11], s32 offen
  s_nop 1
  v_cvt_pk_bf16_f32 v140, v88, v89
  v_mfma_f32_16x16x32_bf16 v[160:163], a[72:75], v[132:135], 0
  s_waitcnt lgkmcnt(4)
  v_cvt_pk_bf16_f32 v141, v90, v91
  v_cvt_pk_bf16_f32 v142, v92, v93
  v_mfma_f32_16x16x32_bf16 v[160:163], a[76:79], v[184:187], v[160:163]
  s_waitcnt lgkmcnt(3)
  v_cvt_pk_bf16_f32 v143, v94, v95
  v_cvt_pk_bf16_f32 v108, v96, v97
  v_mfma_f32_16x16x32_bf16 v[160:163], a[80:83], v[196:199], v[160:163]
  s_waitcnt lgkmcnt(2)
  v_permlane16_swap_b32 v140, v142
  v_mfma_f32_16x16x32_bf16 v[160:163], a[84:87], v[136:139], v[160:163]
  s_waitcnt lgkmcnt(1)
  v_permlane16_swap_b32 v141, v143
  v_mfma_f32_16x16x32_bf16 v[160:163], a[88:91], v[144:147], v[160:163]
  s_waitcnt lgkmcnt(0)
  v_cvt_pk_bf16_f32 v109, v98, v99
  v_mfma_f32_16x16x32_bf16 v[160:163], a[92:95], v[180:183], v[160:163]
  v_mfma_f32_16x16x32_bf16 v[204:207], a[96:99], v[132:135], 0
  v_mfma_f32_16x16x32_bf16 v[204:207], a[100:103], v[184:187], v[204:207]
  v_cvt_pk_bf16_f32 v148, v160, v161
  v_cvt_pk_bf16_f32 v149, v162, v163
  v_mfma_f32_16x16x32_bf16 v[204:207], a[104:107], v[196:199], v[204:207]
  v_mfma_f32_16x16x32_bf16 v[204:207], a[108:111], v[136:139], v[204:207]
  v_mfma_f32_16x16x32_bf16 v[204:207], a[112:115], v[144:147], v[204:207]
  v_mfma_f32_16x16x32_bf16 v[204:207], a[116:119], v[180:183], v[204:207]
  v_mfma_f32_16x16x32_bf16 v[160:163], a[120:123], v[132:135], 0
  v_mfma_f32_16x16x32_bf16 v[160:163], a[124:127], v[184:187], v[160:163]
  v_cvt_pk_bf16_f32 v150, v204, v205
  v_cvt_pk_bf16_f32 v151, v206, v207
  v_mfma_f32_16x16x32_bf16 v[160:163], a[128:131], v[196:199], v[160:163]
  v_mfma_f32_16x16x32_bf16 v[160:163], a[132:135], v[136:139], v[160:163]
  buffer_store_dwordx4 v[176:179], v22, s[8:11], s32 offen
  v_mfma_f32_16x16x32_bf16 v[160:163], a[136:139], v[144:147], v[160:163]
  v_mfma_f32_16x16x32_bf16 v[160:163], a[140:143], v[180:183], v[160:163]
  v_mfma_f32_16x16x32_bf16 v[176:179], a[0:3], v[132:135], 0
  v_mfma_f32_16x16x32_bf16 v[176:179], a[4:7], v[184:187], v[176:179]
  buffer_load_dwordx4 v[204:207], v15, s[12:15], s77 offen offset:2048
  v_mfma_f32_16x16x32_bf16 v[176:179], a[8:11], v[196:199], v[176:179]
  v_cvt_pk_bf16_f32 v224, v160, v161
  v_cvt_pk_bf16_f32 v225, v162, v163
  v_mfma_f32_16x16x32_bf16 v[176:179], a[12:15], v[136:139], v[176:179]
  v_mfma_f32_16x16x32_bf16 v[176:179], a[16:19], v[144:147], v[176:179]
  v_mfma_f32_16x16x32_bf16 v[176:179], a[20:23], v[180:183], v[176:179]
  buffer_load_dwordx4 v[64:67], v15, s[12:15], s75 offen
  v_mfma_f32_16x16x32_bf16 v[160:163], a[24:27], v[132:135], 0
  v_mfma_f32_16x16x32_bf16 v[160:163], a[28:31], v[184:187], v[160:163]
  v_cvt_pk_bf16_f32 v200, v176, v177
  v_cvt_pk_bf16_f32 v201, v178, v179
  v_mfma_f32_16x16x32_bf16 v[160:163], a[32:35], v[196:199], v[160:163]
  v_mfma_f32_16x16x32_bf16 v[160:163], a[36:39], v[136:139], v[160:163]
  v_mfma_f32_16x16x32_bf16 v[160:163], a[40:43], v[144:147], v[160:163]
  buffer_load_dwordx4 v[68:71], v15, s[12:15], s75 offen offset:1024
  v_mfma_f32_16x16x32_bf16 v[160:163], a[44:47], v[180:183], v[160:163]
  v_mfma_f32_16x16x32_bf16 v[176:179], a[48:51], v[132:135], 0
  v_mfma_f32_16x16x32_bf16 v[176:179], a[52:55], v[184:187], v[176:179]
  ds_read_b64 v[116:117], v19 offset:784
  v_cvt_pk_bf16_f32 v202, v160, v161
  v_mfma_f32_16x16x32_bf16 v[176:179], a[56:59], v[196:199], v[176:179]
  buffer_load_dwordx4 v[72:75], v15, s[12:15], s75 offen offset:2048
  v_mfma_f32_16x16x32_bf16 v[176:179], a[60:63], v[136:139], v[176:179]
  v_cvt_pk_bf16_f32 v203, v162, v163
  v_mfma_f32_16x16x32_bf16 v[176:179], a[64:67], v[144:147], v[176:179]
  ds_read2_b64 v[160:163], v19 offset0:96 offset1:97
  v_mfma_f32_16x16x32_bf16 v[176:179], a[68:71], v[180:183], v[176:179]
  v_mfma_f32_16x16x32_bf16 v[168:171], v[132:135], a[144:147], 0
  v_mfma_f32_16x16x32_bf16 v[168:171], v[184:187], a[148:151], v[168:171]
  buffer_load_dwordx4 v[76:79], v15, s[12:15], s75 offen offset:3072
  v_mfma_f32_16x16x32_bf16 v[168:171], v[196:199], a[152:155], v[168:171]
  v_cvt_pk_bf16_f32 v112, v176, v177
  v_cvt_pk_bf16_f32 v113, v178, v179
  v_mfma_f32_16x16x32_bf16 v[168:171], v[136:139], a[156:159], v[168:171]
  v_mfma_f32_16x16x32_bf16 v[168:171], v[144:147], a[160:163], v[168:171]
  v_mfma_f32_16x16x32_bf16 v[168:171], v[180:183], a[164:167], v[168:171]
  buffer_load_dwordx4 v[80:83], v15, s[12:15], s77 offen
  v_mfma_f32_16x16x32_bf16 v[176:179], v[132:135], a[168:171], 0
  v_mfma_f32_16x16x32_bf16 v[176:179], v[184:187], a[172:175], v[176:179]
  v_cvt_pk_bf16_f32 v194, v168, v169
  v_cvt_pk_bf16_f32 v195, v170, v171
  v_mfma_f32_16x16x32_bf16 v[176:179], v[196:199], a[176:179], v[176:179]
  v_mfma_f32_16x16x32_bf16 v[176:179], v[136:139], a[180:183], v[176:179]
  v_mfma_f32_16x16x32_bf16 v[176:179], v[144:147], a[184:187], v[176:179]
  buffer_load_dwordx4 v[84:87], v15, s[12:15], s77 offen offset:1024
  v_mfma_f32_16x16x32_bf16 v[176:179], v[180:183], a[188:191], v[176:179]
  s_waitcnt lgkmcnt(0)
  v_mfma_f32_16x16x16_bf16 v[168:171], v[116:117], v[166:167], 0
  v_mfma_f32_16x16x16_bf16 v[216:219], v[116:117], v[224:225], 0
  v_cvt_pk_bf16_f32 v210, v176, v177
  v_cvt_pk_bf16_f32 v211, v178, v179
  v_mfma_f32_16x16x16_bf16 v[176:179], v[166:167], v[164:165], 0
  v_mfma_f32_16x16x16_bf16 v[212:215], v[224:225], v[164:165], 0
  v_mfma_f32_16x16x32_bf16 v[168:171], v[160:163], v[156:159], v[168:171]
  v_mfma_f32_16x16x32_bf16 v[216:219], v[160:163], v[148:151], v[216:219]
  v_mfma_f32_16x16x32_bf16 v[176:179], v[156:159], v[152:155], v[176:179]
  v_mfma_f32_16x16x32_bf16 v[212:215], v[148:151], v[152:155], v[212:215]
  s_barrier
  v_mfma_f32_16x16x32_bf16 v[188:191], v[132:135], a[192:195], 0
  ds_read_b128 v[132:135], v15 offset:14336
  ds_read_b128 v[128:131], v15 offset:15360
  v_mfma_f32_16x16x32_bf16 v[188:191], v[184:187], a[196:199], v[188:191]
  ds_read_b128 v[184:187], v15 offset:16384
  v_cndmask_b32 v251, v216, v168, s[56:57]
  v_mfma_f32_16x16x32_bf16 v[188:191], v[196:199], a[200:203], v[188:191]
  ds_read_b128 v[196:199], v15 offset:17408
  v_mfma_f32_16x16x32_bf16 v[188:191], v[136:139], a[204:207], v[188:191]
  ds_read_b128 v[136:139], v15 offset:18432
  v_mfma_f32_16x16x32_bf16 v[188:191], v[144:147], a[208:211], v[188:191]
  ds_read_b128 v[144:147], v15 offset:19456
  v_mfma_f32_16x16x32_bf16 v[188:191], v[180:183], a[212:215], v[188:191]
  v_exp_f32 v176, v176
  v_mfma_f32_16x16x16_bf16 v[180:183], v[166:167], v[112:113], 0
  buffer_store_dwordx4 v[140:143], v14, s[8:11], s32 offen
  s_nop 2
  v_cvt_pk_bf16_f32 v174, v188, v189
  v_mfma_f32_16x16x16_bf16 v[140:143], v[224:225], v[112:113], 0
  v_exp_f32 v177, v177
  v_exp_f32 v178, v178
  v_mfma_f32_16x16x32_bf16 v[180:183], v[156:159], v[200:203], v[180:183]
  v_exp_f32 v179, v179
  v_mfma_f32_16x16x32_bf16 v[140:143], v[148:151], v[200:203], v[140:143]
  s_waitcnt lgkmcnt(5)
  v_exp_f32 v212, v212
  v_mfma_f32_16x16x32_bf16 v[168:171], a[72:75], v[132:135], 0
  s_waitcnt lgkmcnt(4)
  v_exp_f32 v213, v213
  v_mfma_f32_16x16x32_bf16 v[168:171], a[76:79], v[128:131], v[168:171]
  s_waitcnt lgkmcnt(3)
  v_exp_f32 v214, v214
  v_mfma_f32_16x16x32_bf16 v[168:171], a[80:83], v[184:187], v[168:171]
  s_waitcnt lgkmcnt(2)
  v_exp_f32 v215, v215
  v_mfma_f32_16x16x32_bf16 v[168:171], a[84:87], v[196:199], v[168:171]
  s_waitcnt lgkmcnt(1)
  v_cvt_pk_bf16_f32 v175, v190, v191
  v_cvt_pk_bf16_f32 v188, v176, v177
  v_mfma_f32_16x16x32_bf16 v[168:171], a[88:91], v[136:139], v[168:171]
  s_waitcnt lgkmcnt(0)
  v_exp_f32 v180, v180
  v_mfma_f32_16x16x32_bf16 v[168:171], a[92:95], v[144:147], v[168:171]
  v_exp_f32 v181, v181
  v_mfma_f32_16x16x32_bf16 v[216:219], a[96:99], v[132:135], 0
  v_exp_f32 v182, v182
  v_mfma_f32_16x16x32_bf16 v[216:219], a[100:103], v[128:131], v[216:219]
  v_exp_f32 v183, v183
  v_mfma_f32_16x16x32_bf16 v[216:219], a[104:107], v[184:187], v[216:219]
  ds_read_b64 v[226:227], v19 offset:16
  v_cvt_pk_bf16_f32 v189, v178, v179
  v_mfma_f32_16x16x32_bf16 v[216:219], a[108:111], v[196:199], v[216:219]
  v_exp_f32 v140, v140
  v_mfma_f32_16x16x32_bf16 v[216:219], a[112:115], v[136:139], v[216:219]
  v_exp_f32 v141, v141
  v_mfma_f32_16x16x32_bf16 v[216:219], a[116:119], v[144:147], v[216:219]
  v_exp_f32 v142, v142
  v_mfma_f32_16x16x32_bf16 v[176:179], a[120:123], v[132:135], 0
  s_waitcnt vmcnt(7)
  buffer_store_dwordx2 v[108:109], v23, s[8:11], s32 offen
  v_cvt_pk_bf16_f32 v190, v212, v213
  v_mfma_f32_16x16x32_bf16 v[176:179], a[124:127], v[128:131], v[176:179]
  v_exp_f32 v143, v143
  v_mfma_f32_16x16x32_bf16 v[176:179], a[128:131], v[184:187], v[176:179]
  v_cvt_pk_bf16_f32 v191, v214, v215
  v_cvt_pk_bf16_f32 v212, v168, v169
  v_mfma_f32_16x16x32_bf16 v[176:179], a[132:135], v[196:199], v[176:179]
  ds_read2_b64 v[220:223], v19 offset0:0 offset1:1
  v_cvt_pk_bf16_f32 v213, v170, v171
  v_mfma_f32_16x16x32_bf16 v[176:179], a[136:139], v[136:139], v[176:179]
  v_cvt_pk_bf16_f32 v168, v180, v181
  v_cvt_pk_bf16_f32 v169, v182, v183
  v_mfma_f32_16x16x32_bf16 v[176:179], a[140:143], v[144:147], v[176:179]
  v_cvt_pk_bf16_f32 v170, v140, v141
  v_cvt_pk_bf16_f32 v214, v216, v217
  v_mfma_f32_16x16x32_bf16 v[180:183], v[132:135], a[144:147], 0
  v_cvt_pk_bf16_f32 v215, v218, v219
  v_cvt_pk_bf16_f32 v171, v142, v143
  v_mfma_f32_16x16x32_bf16 v[180:183], v[128:131], a[148:151], v[180:183]
  v_cvt_pk_bf16_f32 v228, v176, v177
  v_cvt_pk_bf16_f32 v229, v178, v179
  v_mfma_f32_16x16x32_bf16 v[180:183], v[184:187], a[152:155], v[180:183]
  v_add_u32 v252, 18560, v207
  v_add_u32 v19, 1160, v19
  v_mfma_f32_16x16x32_bf16 v[180:183], v[196:199], a[156:159], v[180:183]
  v_mfma_f32_16x16x32_bf16 v[180:183], v[136:139], a[160:163], v[180:183]
  v_mfma_f32_16x16x32_bf16 v[180:183], v[144:147], a[164:167], v[180:183]
  s_waitcnt lgkmcnt(1)
  v_mfma_f32_16x16x16_bf16 v[176:179], v[228:229], v[164:165], 0
  v_mfma_f32_16x16x16_bf16 v[140:143], v[226:227], v[164:165], v[2:5]
  v_cvt_pk_bf16_f32 v108, v180, v181
  v_cvt_pk_bf16_f32 v109, v182, v183
  v_mfma_f32_16x16x16_bf16 v[180:183], v[228:229], v[112:113], 0
  v_mfma_f32_16x16x16_bf16 v[216:219], v[226:227], v[112:113], v[2:5]
  v_mfma_f32_16x16x32_bf16 v[176:179], v[212:215], v[152:155], v[176:179]
  s_waitcnt lgkmcnt(0)
  v_mfma_f32_16x16x32_bf16 v[140:143], v[220:223], v[152:155], v[140:143]
  v_mfma_f32_16x16x32_bf16 v[180:183], v[212:215], v[200:203], v[180:183]
  v_exp_f32 v176, v176
  v_mfma_f32_16x16x32_bf16 v[216:219], v[220:223], v[200:203], v[216:219]
  v_exp_f32 v177, v177
  v_mfma_f32_16x16x32_bf16 v[200:203], v[132:135], a[168:171], 0
  v_exp_f32 v178, v178
  v_mfma_f32_16x16x32_bf16 v[200:203], v[128:131], a[172:175], v[200:203]
  v_exp_f32 v179, v179
  v_mfma_f32_16x16x32_bf16 v[200:203], v[184:187], a[176:179], v[200:203]
  v_exp_f32 v140, v140
  v_mfma_f32_16x16x32_bf16 v[200:203], v[196:199], a[180:183], v[200:203]
  v_exp_f32 v180, v180
  v_mfma_f32_16x16x32_bf16 v[200:203], v[136:139], a[184:187], v[200:203]
  v_exp_f32 v181, v181
  v_mfma_f32_16x16x32_bf16 v[200:203], v[144:147], a[188:191], v[200:203]
  v_exp_f32 v182, v182
  v_mfma_f32_16x16x32_bf16 v[152:155], v[132:135], a[192:195], 0
  v_exp_f32 v183, v183
  v_mfma_f32_16x16x32_bf16 v[152:155], v[128:131], a[196:199], v[152:155]
  v_exp_f32 v216, v216
  v_mfma_f32_16x16x32_bf16 v[152:155], v[184:187], a[200:203], v[152:155]
  ds_read_u16 v110, v20
  v_cvt_pk_bf16_f32 v120, v176, v177
  v_mfma_f32_16x16x32_bf16 v[152:155], v[196:199], a[204:207], v[152:155]
  v_cvt_pk_bf16_f32 v121, v178, v179
  v_cvt_pk_bf16_f32 v122, v140, 0
  v_mfma_f32_16x16x32_bf16 v[152:155], v[136:139], a[208:211], v[152:155]
  ds_read_u16 v114, v20 offset:32
  v_cvt_pk_bf16_f32 v124, v180, v181
  v_mfma_f32_16x16x32_bf16 v[152:155], v[144:147], a[212:215], v[152:155]
  v_cvt_pk_bf16_f32 v112, v200, v201
  v_cvt_pk_bf16_f32 v113, v202, v203
  v_cvt_pk_bf16_f32 v125, v182, v183
  v_mfma_f32_16x16x16_bf16 v[180:183], v[116:117], v[228:229], 0
  v_cvt_pk_bf16_f32 v126, v216, 0
  v_mfma_f32_16x16x16_bf16 v[216:219], v[116:117], v[226:227], 0
  ds_read_u16 v118, v20 offset:64
  v_cvt_pk_bf16_f32 v116, v152, v153
  v_cvt_pk_bf16_f32 v117, v154, v155
  v_mfma_f32_16x16x32_bf16 v[180:183], v[160:163], v[212:215], v[180:183]
  v_mfma_f32_16x16x32_bf16 v[216:219], v[160:163], v[220:223], v[216:219]
  v_mfma_f32_16x16x32_bf16 v[160:163], a[0:3], v[132:135], 0
  v_mfma_f32_16x16x32_bf16 v[160:163], a[4:7], v[128:131], v[160:163]
  v_cndmask_b32 v164, v180, v216, s[56:57]
  v_cndmask_b32 v251, v164, v251, s[46:47]
  v_mfma_f32_16x16x32_bf16 v[160:163], a[8:11], v[184:187], v[160:163]
  v_exp_f32 v251, v251
  v_mfma_f32_16x16x32_bf16 v[160:163], a[12:15], v[196:199], v[160:163]
  v_cvt_pk_bf16_f32 v251, v251, 0
  v_mfma_f32_16x16x32_bf16 v[160:163], a[16:19], v[136:139], v[160:163]
  ds_write_b16 v26, v251
  v_mfma_f32_16x16x32_bf16 v[160:163], a[20:23], v[144:147], v[160:163]
  ds_read_b128 v[180:183], v27
  v_mfma_f32_16x16x32_bf16 v[216:219], a[246:249], v[188:191], 0
  v_mfma_f32_16x16x32_bf16 v[216:219], a[246:249], v[120:123], v[216:219]
  v_cvt_pk_bf16_f32 v152, v160, v161
  v_cvt_pk_bf16_f32 v153, v162, v163
  v_mfma_f32_16x16x32_bf16 v[160:163], v[192:195], v[188:191], 0
  s_waitcnt lgkmcnt(4)
  v_mfma_f32_16x16x32_bf16 v[160:163], v[108:111], v[120:123], v[160:163]
  v_mul_f32 v216, 0x3ee9a3cd, v216
  v_mfma_f32_16x16x32_bf16 v[200:203], v[208:211], v[188:191], 0
  s_waitcnt lgkmcnt(3)
  v_rcp_f32 v253, v216
  v_mfma_f32_16x16x32_bf16 v[200:203], v[112:115], v[120:123], v[200:203]
  v_mul_f32 v160, v160, v253
  v_mul_f32 v161, v161, v253
  v_mfma_f32_16x16x32_bf16 v[140:143], v[172:175], v[188:191], 0
  s_waitcnt lgkmcnt(2)
  v_cvt_pk_bf16_f32 v188, v160, v161
  v_mul_f32 v162, v162, v253
  v_mfma_f32_16x16x32_bf16 v[140:143], v[116:119], v[120:123], v[140:143]
  ds_read_b64 v[120:121], v27 offset:16
  v_cndmask_b32 v122, 0, v251, s[54:55]
  v_mfma_f32_16x16x32_bf16 v[176:179], a[24:27], v[132:135], 0
  v_mul_f32 v163, v163, v253
  v_cvt_pk_bf16_f32 v189, v162, v163
  v_mfma_f32_16x16x32_bf16 v[176:179], a[28:31], v[128:131], v[176:179]
  v_mul_f32 v200, v200, v253
  v_mul_f32 v201, v201, v253
  v_mfma_f32_16x16x32_bf16 v[176:179], a[32:35], v[184:187], v[176:179]
  v_cvt_pk_bf16_f32 v190, v200, v201
  v_mul_f32 v202, v202, v253
  v_mfma_f32_16x16x32_bf16 v[176:179], a[36:39], v[196:199], v[176:179]
  v_mul_f32 v203, v203, v253
  v_cvt_pk_bf16_f32 v191, v202, v203
  v_mfma_f32_16x16x32_bf16 v[176:179], a[40:43], v[136:139], v[176:179]
  ds_write_b128 v16, v[188:191] offset:20480
  v_mfma_f32_16x16x32_bf16 v[176:179], a[44:47], v[144:147], v[176:179]
  v_max3_f32 v1, v1, v216, v253
  v_mul_f32 v140, v140, v253
  v_mfma_f32_16x16x32_bf16 v[216:219], a[246:249], v[168:171], 0
  v_mul_f32 v141, v141, v253
  v_cvt_pk_bf16_f32 v164, v140, v141
  v_mfma_f32_16x16x32_bf16 v[216:219], a[246:249], v[124:127], v[216:219]
  v_cvt_pk_bf16_f32 v154, v176, v177
  v_cvt_pk_bf16_f32 v155, v178, v179
  v_mfma_f32_16x16x32_bf16 v[176:179], v[192:195], v[168:171], 0
  v_mul_f32 v142, v142, v253
  v_mul_f32 v143, v143, v253
  v_mfma_f32_16x16x32_bf16 v[176:179], v[108:111], v[124:127], v[176:179]
  v_cvt_pk_bf16_f32 v165, v142, v143
  v_mul_f32 v216, 0x3ee9a3cd, v216
  v_mfma_f32_16x16x32_bf16 v[140:143], v[208:211], v[168:171], 0
  ds_write_b64 v17, v[164:165] offset:20480
  v_mfma_f32_16x16x32_bf16 v[140:143], v[112:115], v[124:127], v[140:143]
  v_rcp_f32 v251, v216
  v_mfma_f32_16x16x32_bf16 v[188:191], v[172:175], v[168:171], 0
  v_mul_f32 v176, v176, v251
  v_mul_f32 v177, v177, v251
  v_mfma_f32_16x16x32_bf16 v[188:191], v[116:119], v[124:127], v[188:191]
  v_cvt_pk_bf16_f32 v168, v176, v177
  v_mul_f32 v178, v178, v251
  v_mfma_f32_16x16x32_bf16 v[200:203], a[48:51], v[132:135], 0
  v_mul_f32 v179, v179, v251
  v_cvt_pk_bf16_f32 v169, v178, v179
  v_mfma_f32_16x16x32_bf16 v[200:203], a[52:55], v[128:131], v[200:203]
  v_mul_f32 v140, v140, v251
  v_mul_f32 v141, v141, v251
  v_mfma_f32_16x16x32_bf16 v[200:203], a[56:59], v[184:187], v[200:203]
  v_cvt_pk_bf16_f32 v170, v140, v141
  v_mul_f32 v142, v142, v251
  v_mfma_f32_16x16x32_bf16 v[200:203], a[60:63], v[196:199], v[200:203]
  v_mul_f32 v143, v143, v251
  v_cvt_pk_bf16_f32 v171, v142, v143
  v_mfma_f32_16x16x32_bf16 v[200:203], a[64:67], v[136:139], v[200:203]
  ds_read2_b64 v[136:139], v207 offset0:0 offset1:4
  v_mul_f32 v188, v188, v251
  v_mfma_f32_16x16x32_bf16 v[200:203], a[68:71], v[144:147], v[200:203]
  s_waitcnt lgkmcnt(4)
  ds_read2_b64 v[144:147], v207 offset0:12 offset1:16
  v_mul_f32 v189, v189, v251
  v_mfma_f32_16x16x32_bf16 v[140:143], a[246:249], v[180:183], 0
  s_waitcnt lgkmcnt(4)
  v_cvt_pk_bf16_f32 v248, v188, v189
  v_mul_f32 v190, v190, v251
  v_mfma_f32_16x16x32_bf16 v[140:143], a[246:249], v[120:123], v[140:143]
  ds_read_b128 v[196:199], v18
  v_cvt_pk_bf16_f32 v164, v200, v201
  v_mfma_f32_16x16x32_bf16 v[184:187], v[180:183], v[192:195], 0
  ds_read2_b64 v[128:131], v207 offset0:24 offset1:28
  v_cvt_pk_bf16_f32 v165, v202, v203
  v_mfma_f32_16x16x32_bf16 v[184:187], v[120:123], v[108:111], v[184:187]
  v_mul_f32 v140, 0x3ee9a3cd, v140
  v_mul_f32 v191, v191, v251
  v_mfma_f32_16x16x32_bf16 v[200:203], v[180:183], v[208:211], 0
  ds_read_b128 v[176:179], v18 offset:6144
  v_cvt_pk_bf16_f32 v249, v190, v191
  v_mfma_f32_16x16x32_bf16 v[200:203], v[120:123], v[112:115], v[200:203]
  ds_read2_b64 v[188:191], v207 offset0:36 offset1:40
  v_max3_f32 v1, v1, v216, v251
  v_mfma_f32_16x16x32_bf16 v[216:219], v[180:183], v[172:175], 0
  v_rcp_f32 v126, v140
  v_mfma_f32_16x16x32_bf16 v[216:219], v[120:123], v[116:119], v[216:219]
  ds_read_b128 v[180:183], v18 offset:9216
  v_cndmask_b32 v251, v200, v184, s[54:55]
  v_max3_f32 v1, v1, v140, v126
  v_mfma_f32_16x16x16_bf16 v[140:143], v[166:167], v[164:165], 0
  ds_read2_b64 v[184:187], v207 offset0:8 offset1:20
  v_mfma_f32_16x16x16_bf16 v[200:203], v[224:225], v[164:165], 0
  v_cndmask_b32 v251, v216, v251, s[56:57]
  v_mul_f32 v251, v251, v126
  v_cvt_pk_bf16_f32 v251, v251, v251
  v_mfma_f32_16x16x16_bf16 v[216:219], v[228:229], v[164:165], 0
  ds_read_b128 v[132:135], v18 offset:3072
  v_mfma_f32_16x16x16_bf16 v[160:163], v[226:227], v[164:165], v[2:5]
  ds_read2_b64 v[164:167], v207 offset0:32 offset1:44
  v_mfma_f32_16x16x32_bf16 v[140:143], v[156:159], v[152:155], v[140:143]
  ds_read_b128 v[156:159], v18 offset:12288
  v_mfma_f32_16x16x32_bf16 v[200:203], v[148:151], v[152:155], v[200:203]
  ds_read_b128 v[148:151], v18 offset:1024
  v_mfma_f32_16x16x32_bf16 v[216:219], v[212:215], v[152:155], v[216:219]
  v_exp_f32 v140, v140
  v_mfma_f32_16x16x32_bf16 v[160:163], v[220:223], v[152:155], v[160:163]
  s_waitcnt vmcnt(7) lgkmcnt(11)
  ds_read_b128 v[152:155], v18 offset:7168
  ds_read_b128 v[220:223], v18 offset:10240
  v_mfma_f32_16x16x32_bf16 v[64:67], a[250:253], v[136:139], v[64:67]
  s_waitcnt lgkmcnt(11)
  v_exp_f32 v141, v141
  v_mfma_f32_16x16x32_bf16 v[64:67], v[196:199], v[144:147], v[64:67]
  s_waitcnt lgkmcnt(9)
  ds_read_b128 v[212:215], v18 offset:4096
  ds_read_b128 v[224:227], v18 offset:13312
  v_mfma_f32_16x16x32_bf16 v[64:67], v[176:179], v[128:131], v[64:67]
  s_waitcnt lgkmcnt(9)
  v_exp_f32 v142, v142
  v_mfma_f32_16x16x32_bf16 v[64:67], v[180:183], v[188:191], v[64:67]
  s_waitcnt lgkmcnt(7)
  ds_read_b128 v[228:231], v18 offset:2048
  ds_read_b128 v[232:235], v18 offset:8192
  v_mfma_f32_16x16x32_bf16 v[64:67], v[132:135], v[184:187], v[64:67]
  s_waitcnt lgkmcnt(7)
  v_exp_f32 v143, v143
  v_mfma_f32_16x16x32_bf16 v[64:67], v[156:159], v[164:167], v[64:67]
  s_waitcnt vmcnt(6)
  ds_read_b128 v[236:239], v18 offset:11264
  ds_read_b128 v[240:243], v18 offset:5120
  v_mfma_f32_16x16x32_bf16 v[68:71], v[100:103], v[136:139], v[68:71]
  s_waitcnt lgkmcnt(8)
  v_exp_f32 v200, v200
  v_mfma_f32_16x16x32_bf16 v[68:71], v[148:151], v[144:147], v[68:71]
  s_waitcnt lgkmcnt(7)
  v_exp_f32 v201, v201
  v_mfma_f32_16x16x32_bf16 v[68:71], v[152:155], v[128:131], v[68:71]
  s_waitcnt lgkmcnt(6)
  v_exp_f32 v202, v202
  v_mfma_f32_16x16x32_bf16 v[68:71], v[220:223], v[188:191], v[68:71]
  s_waitcnt lgkmcnt(5)
  v_exp_f32 v203, v203
  v_mfma_f32_16x16x32_bf16 v[68:71], v[212:215], v[184:187], v[68:71]
  s_waitcnt lgkmcnt(4)
  v_exp_f32 v216, v216
  v_mfma_f32_16x16x32_bf16 v[68:71], v[224:227], v[164:167], v[68:71]
  v_exp_f32 v217, v217
  v_exp_f32 v218, v218
  v_exp_f32 v219, v219
  v_exp_f32 v160, v160
  v_cvt_pk_bf16_f32 v244, v140, v141
  v_cvt_pk_bf16_f32 v245, v142, v143
  v_cvt_pk_bf16_f32 v246, v200, v201
  v_cvt_pk_bf16_f32 v247, v202, v203
  v_cvt_pk_bf16_f32 v124, v216, v217
  v_cvt_pk_bf16_f32 v125, v218, v219
  v_mfma_f32_16x16x32_bf16 v[216:219], a[246:249], v[244:247], 0
  v_cvt_pk_bf16_f32 v126, v160, 0
  v_cvt_pk_bf16_f32 v160, v64, v65
  v_cvt_pk_bf16_f32 v161, v66, v67
  v_mfma_f32_16x16x32_bf16 v[216:219], a[246:249], v[124:127], v[216:219]
  ds_write_b128 v16, v[168:171] offset:26624
  v_mfma_f32_16x16x32_bf16 v[168:171], v[192:195], v[244:247], 0
  s_nop 3
  v_mul_f32 v216, 0x3ee9a3cd, v216
  v_cvt_pk_bf16_f32 v162, v68, v69
  v_mfma_f32_16x16x32_bf16 v[168:171], v[108:111], v[124:127], v[168:171]
  ds_read_b128 v[192:195], v18 offset:14336
  v_cvt_pk_bf16_f32 v163, v70, v71
  v_mfma_f32_16x16x32_bf16 v[200:203], v[208:211], v[244:247], 0
  ds_write_b64 v17, v[248:249] offset:26624
  v_mfma_f32_16x16x32_bf16 v[200:203], v[112:115], v[124:127], v[200:203]
  v_rcp_f32 v114, v216
  v_mfma_f32_16x16x32_bf16 v[208:211], v[172:175], v[244:247], 0
  ds_write_b16 v20, v251 offset:384
  v_mfma_f32_16x16x32_bf16 v[208:211], v[116:119], v[124:127], v[208:211]
  s_waitcnt vmcnt(5)
  v_mul_f32 v168, v168, v114
  v_mul_f32 v169, v169, v114
  v_mfma_f32_16x16x32_bf16 v[72:75], v[104:107], v[136:139], v[72:75]
  s_waitcnt lgkmcnt(7)
  v_mul_f32 v170, v170, v114
  v_mul_f32 v171, v171, v114
  v_mfma_f32_16x16x32_bf16 v[72:75], v[228:231], v[144:147], v[72:75]
  s_waitcnt lgkmcnt(6)
  v_mul_f32 v200, v200, v114
  v_mul_f32 v201, v201, v114
  v_mfma_f32_16x16x32_bf16 v[72:75], v[232:235], v[128:131], v[72:75]
  s_waitcnt lgkmcnt(5)
  v_mul_f32 v202, v202, v114
  v_mul_f32 v203, v203, v114
  v_mfma_f32_16x16x32_bf16 v[72:75], v[236:239], v[188:191], v[72:75]
  s_waitcnt lgkmcnt(4)
  v_cvt_pk_bf16_f32 v188, v168, v169
  v_cvt_pk_bf16_f32 v189, v170, v171
  v_mfma_f32_16x16x32_bf16 v[72:75], v[240:243], v[184:187], v[72:75]
  s_waitcnt lgkmcnt(2)
  v_cvt_pk_bf16_f32 v190, v200, v201
  v_cvt_pk_bf16_f32 v191, v202, v203
  v_mfma_f32_16x16x32_bf16 v[72:75], v[192:195], v[164:167], v[72:75]
  s_waitcnt lgkmcnt(0)
  ds_write_b128 v16, v[188:191] offset:32768
  v_mul_f32 v208, v208, v114
  v_mul_f32 v209, v209, v114
  v_mul_f32 v210, v210, v114
  v_mul_f32 v211, v211, v114
  v_cvt_pk_bf16_f32 v116, v208, v209
  v_cvt_pk_bf16_f32 v117, v210, v211
  ds_write_b64 v17, v[116:117] offset:32768
  v_max3_f32 v1, v1, v216, v114
  ds_write_b32 v111, v1
  v_cvt_pk_bf16_f32 v216, v72, v73
  v_cvt_pk_bf16_f32 v217, v74, v75
  v_permlane16_swap_b32 v160, v162
  v_permlane16_swap_b32 v161, v163
  v_add_u32 v20, 1160, v20
  buffer_store_dwordx4 v[160:163], v204, s[8:11], 0 offen
  s_waitcnt lgkmcnt(0)
  s_barrier
  ds_read_b128 v[160:163], v15 offset:20480
  ds_read_b128 v[208:211], v15 offset:21504
  ds_read_b128 v[188:191], v15 offset:22528
  ds_read_b128 v[164:167], v15 offset:23552
  ds_read_b128 v[200:203], v15 offset:24576
  ds_read_b128 v[184:187], v15 offset:25600
  ds_read_b128 v[168:171], v250
  s_waitcnt lgkmcnt(6)
  v_mfma_f32_16x16x32_bf16 v[28:31], a[250:253], v[160:163], v[28:31]
  s_waitcnt lgkmcnt(5)
  v_mfma_f32_16x16x32_bf16 v[28:31], v[196:199], v[208:211], v[28:31]
  s_waitcnt lgkmcnt(4)
  v_mfma_f32_16x16x32_bf16 v[28:31], v[176:179], v[188:191], v[28:31]
  s_waitcnt lgkmcnt(3)
  v_mfma_f32_16x16x32_bf16 v[28:31], v[180:183], v[164:167], v[28:31]
  s_waitcnt lgkmcnt(2)
  v_mfma_f32_16x16x32_bf16 v[28:31], v[132:135], v[200:203], v[28:31]
  s_waitcnt lgkmcnt(1)
  v_mfma_f32_16x16x32_bf16 v[28:31], v[156:159], v[184:187], v[28:31]
  ds_read_b128 v[128:131], v15 offset:26624
  v_mfma_f32_16x16x32_bf16 v[32:35], v[100:103], v[160:163], v[32:35]
  s_waitcnt lgkmcnt(1)
  ds_read_b128 v[144:147], v15 offset:27648
  v_max3_f32 v1, v168, v169, v170
  v_mfma_f32_16x16x32_bf16 v[32:35], v[148:151], v[208:211], v[32:35]
  ds_read_b128 v[136:139], v15 offset:28672
  v_cvt_pk_bf16_f32 v172, v28, v29
  v_mfma_f32_16x16x32_bf16 v[32:35], v[152:155], v[188:191], v[32:35]
  ds_read_b128 v[244:247], v15 offset:29696
  v_cvt_pk_bf16_f32 v173, v30, v31
  v_mfma_f32_16x16x32_bf16 v[32:35], v[220:223], v[164:167], v[32:35]
  ds_read_b128 v[140:143], v15 offset:30720
  v_max_f32 v1, v1, v171
  v_mfma_f32_16x16x32_bf16 v[32:35], v[212:215], v[200:203], v[32:35]
  ds_read_b128 v[168:171], v15 offset:31744
  v_mfma_f32_16x16x32_bf16 v[32:35], v[224:227], v[184:187], v[32:35]
  v_mfma_f32_16x16x32_bf16 v[36:39], v[104:107], v[160:163], v[36:39]
  v_mfma_f32_16x16x32_bf16 v[36:39], v[228:231], v[208:211], v[36:39]
  v_cvt_pk_bf16_f32 v174, v32, v33
  v_cvt_pk_bf16_f32 v175, v34, v35
  v_mfma_f32_16x16x32_bf16 v[36:39], v[232:235], v[188:191], v[36:39]
  v_permlane16_swap_b32 v172, v174
  v_mfma_f32_16x16x32_bf16 v[36:39], v[236:239], v[164:167], v[36:39]
  v_permlane16_swap_b32 v173, v175
  v_mfma_f32_16x16x32_bf16 v[36:39], v[240:243], v[200:203], v[36:39]
  buffer_store_dwordx4 v[172:175], v12, s[8:11], s33 offen
  v_mfma_f32_16x16x32_bf16 v[36:39], v[192:195], v[184:187], v[36:39]
  s_waitcnt lgkmcnt(5)
  v_mfma_f32_16x16x32_bf16 v[40:43], a[250:253], v[128:131], v[40:43]
  s_waitcnt lgkmcnt(4)
  v_mfma_f32_16x16x32_bf16 v[40:43], v[196:199], v[144:147], v[40:43]
  s_waitcnt lgkmcnt(3)
  v_cvt_pk_bf16_f32 v184, v36, v37
  v_cvt_pk_bf16_f32 v185, v38, v39
  v_mfma_f32_16x16x32_bf16 v[40:43], v[176:179], v[136:139], v[40:43]
  s_waitcnt lgkmcnt(2)
  v_mfma_f32_16x16x32_bf16 v[40:43], v[180:183], v[244:247], v[40:43]
  s_waitcnt lgkmcnt(1)
  v_mfma_f32_16x16x32_bf16 v[40:43], v[132:135], v[140:143], v[40:43]
  s_waitcnt lgkmcnt(0)
  v_mfma_f32_16x16x32_bf16 v[40:43], v[156:159], v[168:171], v[40:43]
  ds_read_b128 v[172:175], v15 offset:32768
  v_mfma_f32_16x16x32_bf16 v[44:47], v[100:103], v[128:131], v[44:47]
  ds_read_b128 v[200:203], v15 offset:33792
  v_mfma_f32_16x16x32_bf16 v[44:47], v[148:151], v[144:147], v[44:47]
  ds_read_b128 v[164:167], v15 offset:34816
  v_cvt_pk_bf16_f32 v188, v40, v41
  v_mfma_f32_16x16x32_bf16 v[44:47], v[152:155], v[136:139], v[44:47]
  ds_read_b128 v[208:211], v15 offset:35840
  v_cvt_pk_bf16_f32 v189, v42, v43
  v_mfma_f32_16x16x32_bf16 v[44:47], v[220:223], v[244:247], v[44:47]
  ds_read_b128 v[160:163], v15 offset:36864
  v_mfma_f32_16x16x32_bf16 v[44:47], v[212:215], v[140:143], v[44:47]
  ds_read_b128 v[248:251], v15 offset:37888
  v_mfma_f32_16x16x32_bf16 v[44:47], v[224:227], v[168:171], v[44:47]
  v_mfma_f32_16x16x32_bf16 v[48:51], v[104:107], v[128:131], v[48:51]
  v_mfma_f32_16x16x32_bf16 v[48:51], v[228:231], v[144:147], v[48:51]
  v_cvt_pk_bf16_f32 v190, v44, v45
  v_cvt_pk_bf16_f32 v191, v46, v47
  v_mfma_f32_16x16x32_bf16 v[48:51], v[232:235], v[136:139], v[48:51]
  v_permlane16_swap_b32 v188, v190
  v_mfma_f32_16x16x32_bf16 v[48:51], v[236:239], v[244:247], v[48:51]
  v_permlane16_swap_b32 v189, v191
  v_mfma_f32_16x16x32_bf16 v[48:51], v[240:243], v[140:143], v[48:51]
  buffer_store_dwordx4 v[188:191], v13, s[8:11], s33 offen
  v_mfma_f32_16x16x32_bf16 v[48:51], v[192:195], v[168:171], v[48:51]
  s_waitcnt lgkmcnt(5)
  v_mfma_f32_16x16x32_bf16 v[52:55], a[250:253], v[172:175], v[52:55]
  s_waitcnt lgkmcnt(4)
  ds_read2_b64 v[168:171], v252 offset0:0 offset1:4
  v_mfma_f32_16x16x32_bf16 v[52:55], v[196:199], v[200:203], v[52:55]
  s_waitcnt lgkmcnt(4)
  ds_read2_b64 v[188:191], v252 offset0:12 offset1:16
  v_cvt_pk_bf16_f32 v186, v48, v49
  v_mfma_f32_16x16x32_bf16 v[52:55], v[176:179], v[164:167], v[52:55]
  s_waitcnt lgkmcnt(4)
  v_cvt_pk_bf16_f32 v187, v50, v51
  v_mfma_f32_16x16x32_bf16 v[52:55], v[180:183], v[208:211], v[52:55]
  s_waitcnt lgkmcnt(3)
  ds_read2_b64 v[140:143], v252 offset0:24 offset1:28
  v_mfma_f32_16x16x32_bf16 v[52:55], v[132:135], v[160:163], v[52:55]
  s_waitcnt lgkmcnt(3)
  v_permlane16_swap_b32 v184, v186
  v_mfma_f32_16x16x32_bf16 v[52:55], v[156:159], v[248:251], v[52:55]
  ds_read2_b64 v[244:247], v252 offset0:36 offset1:40
  v_mfma_f32_16x16x32_bf16 v[56:59], v[100:103], v[172:175], v[56:59]
  v_permlane16_swap_b32 v185, v187
  v_mfma_f32_16x16x32_bf16 v[56:59], v[148:151], v[200:203], v[56:59]
  ds_read2_b64 v[136:139], v252 offset0:8 offset1:20
  v_cvt_pk_bf16_f32 v144, v52, v53
  v_mfma_f32_16x16x32_bf16 v[56:59], v[152:155], v[164:167], v[56:59]
  v_cvt_pk_bf16_f32 v145, v54, v55
  v_mfma_f32_16x16x32_bf16 v[56:59], v[220:223], v[208:211], v[56:59]
  ds_read2_b64 v[128:131], v252 offset0:32 offset1:44
  v_mfma_f32_16x16x32_bf16 v[56:59], v[212:215], v[160:163], v[56:59]
  v_mfma_f32_16x16x32_bf16 v[56:59], v[224:227], v[248:251], v[56:59]
  v_mfma_f32_16x16x32_bf16 v[60:63], v[104:107], v[172:175], v[60:63]
  v_mfma_f32_16x16x32_bf16 v[60:63], v[228:231], v[200:203], v[60:63]
  v_cvt_pk_bf16_f32 v146, v56, v57
  v_cvt_pk_bf16_f32 v147, v58, v59
  v_mfma_f32_16x16x32_bf16 v[60:63], v[232:235], v[164:167], v[60:63]
  buffer_store_dwordx4 v[184:187], v22, s[8:11], s33 offen
  v_mfma_f32_16x16x32_bf16 v[60:63], v[236:239], v[208:211], v[60:63]
  v_permlane16_swap_b32 v144, v146
  v_mfma_f32_16x16x32_bf16 v[60:63], v[240:243], v[160:163], v[60:63]
  v_permlane16_swap_b32 v145, v147
  v_mfma_f32_16x16x32_bf16 v[60:63], v[192:195], v[248:251], v[60:63]
  s_waitcnt vmcnt(8) lgkmcnt(5)
  v_mfma_f32_16x16x32_bf16 v[76:79], a[250:253], v[168:171], v[76:79]
  s_waitcnt lgkmcnt(4)
  v_mfma_f32_16x16x32_bf16 v[76:79], v[196:199], v[188:191], v[76:79]
  s_waitcnt lgkmcnt(3)
  v_cvt_pk_bf16_f32 v116, v60, v61
  v_cvt_pk_bf16_f32 v117, v62, v63
  v_mfma_f32_16x16x32_bf16 v[76:79], v[176:179], v[140:143], v[76:79]
  s_waitcnt lgkmcnt(2)
  v_mfma_f32_16x16x32_bf16 v[76:79], v[180:183], v[244:247], v[76:79]
  s_waitcnt lgkmcnt(1)
  v_mfma_f32_16x16x32_bf16 v[76:79], v[132:135], v[136:139], v[76:79]
  s_waitcnt lgkmcnt(0)
  v_mfma_f32_16x16x32_bf16 v[76:79], v[156:159], v[128:131], v[76:79]
  s_waitcnt vmcnt(7)
  v_mfma_f32_16x16x32_bf16 v[80:83], v[100:103], v[168:171], v[80:83]
  v_mfma_f32_16x16x32_bf16 v[80:83], v[148:151], v[188:191], v[80:83]
  v_cvt_pk_bf16_f32 v148, v76, v77
  v_cvt_pk_bf16_f32 v149, v78, v79
  v_mfma_f32_16x16x32_bf16 v[80:83], v[152:155], v[140:143], v[80:83]
  v_mfma_f32_16x16x32_bf16 v[80:83], v[220:223], v[244:247], v[80:83]
  v_mfma_f32_16x16x32_bf16 v[80:83], v[212:215], v[136:139], v[80:83]
  v_mfma_f32_16x16x32_bf16 v[80:83], v[224:227], v[128:131], v[80:83]
  s_waitcnt vmcnt(6)
  v_mfma_f32_16x16x32_bf16 v[84:87], v[104:107], v[168:171], v[84:87]
  buffer_store_dwordx4 v[144:147], v14, s[8:11], s33 offen
  s_nop 2
  v_cvt_pk_bf16_f32 v150, v80, v81
  v_mfma_f32_16x16x32_bf16 v[84:87], v[228:231], v[188:191], v[84:87]
  v_cvt_pk_bf16_f32 v151, v82, v83
  v_mfma_f32_16x16x32_bf16 v[84:87], v[232:235], v[140:143], v[84:87]
  v_permlane16_swap_b32 v148, v150
  v_mfma_f32_16x16x32_bf16 v[84:87], v[236:239], v[244:247], v[84:87]
  v_permlane16_swap_b32 v149, v151
  v_mfma_f32_16x16x32_bf16 v[84:87], v[240:243], v[136:139], v[84:87]
  v_mfma_f32_16x16x32_bf16 v[84:87], v[192:195], v[128:131], v[84:87]
  s_nop 7
  v_cvt_pk_bf16_f32 v218, v84, v85
  v_cvt_pk_bf16_f32 v219, v86, v87
  s_nop 0
  v_permlane16_swap_b32 v216, v218
  v_permlane16_swap_b32 v217, v219
  buffer_store_dwordx2 v[116:117], v23, s[8:11], s33 offen
  buffer_store_dwordx4 v[148:151], v205, s[8:11], 0 offen
  buffer_store_dwordx4 v[216:219], v206, s[8:11], 0 offen
  v_cmp_nge_f32 vcc, 0x67800000, v1
  s_nop 4
  s_cmp_eq_u64 vcc, 0
  s_cbranch_scc1 L_exit
L_safe:
  s_waitcnt vmcnt(0)
  s_barrier
  v_mbcnt_lo_u32_b32 v220, -1, 0
  v_mbcnt_hi_u32_b32 v220, -1, v220
  v_lshrrev_b32 v221, 4, v220
  v_and_b32 v222, 15, v220
  s_add_u32 s60, s74, 38912
  v_mul_u32_u24 v223, 24, v221
  v_add_u32 v19, s60, v223
  v_min_u32 v223, 2, v221
  v_lshl_add_u32 v223, v223, 4, v222
  s_add_u32 s60, s60, 384
  v_lshl_add_u32 v20, v223, 1, s60
  v_cmp_gt_u32 vcc, 5, v222
  v_mul_u32_u24 v223, 1160, v222
  v_add_u32 v249, v19, v223
  v_lshl_add_u32 v223, v221, 3, v223
  v_add_u32 v247, s60, v223
  v_mov_b32 v224, 0x30000
  v_add_u32 v225, 18560, v249
  v_cndmask_b32 v250, v224, v225, vcc
  v_add_u32 v225, 18560, v247
  v_cndmask_b32 v248, v224, v225, vcc
  s_mov_b32 s31, 0
  buffer_load_dwordx4 v[128:131], v15, s[12:15], s77 offen offset:3072
  buffer_load_dwordx2 v[108:109], v15, s[12:15], s78 offen
  buffer_load_dwordx4 v[132:135], v15, s[12:15], s78 offen offset:1024
  buffer_load_dwordx2 v[112:113], v15, s[12:15], s78 offen offset:2048
  s_waitcnt vmcnt(3)
  ds_write_b64 v249, v[128:129] offset:768
  ds_write_b64 v249, v[130:131] offset:776
  s_waitcnt vmcnt(2)
  ds_write_b64 v249, v[108:109] offset:784
  s_waitcnt vmcnt(1)
  ds_write_b64 v250, v[132:133] offset:768
  ds_write_b64 v250, v[134:135] offset:776
  s_waitcnt vmcnt(0)
  ds_write_b64 v250, v[112:113] offset:784
  s_waitcnt lgkmcnt(0)
L_safe_loop:
  s_lshl_b32 s60, s31, 5
  s_add_u32 s61, s60, s30
  s_add_u32 s60, s60, s29
  s_mul_i32 s62, s60, 7183
  s_lshr_b32 s62, s62, 22
  s_mul_i32 s63, s62, 584
  s_sub_u32 s63, s60, s63
  s_lshr_b32 s64, s63, 3
  s_and_b32 s65, s63, 7
  s_lshl_b32 s66, s62, 3
  s_add_u32 s65, s65, s66
  s_cmp_ge_u32 s60, 5256
  s_cselect_b32 s64, s63, s64
  s_cselect_b32 s65, 72, s65
  s_mul_i32 s66, s65, 1373568
  s_mul_i32 s67, s64, 2688
  s_add_u32 s35, s66, s67
  s_cmp_ge_u32 s61, 667
  s_cselect_b32 s35, 268435456, s35
  s_cmp_ge_u32 s60, 5329
  s_cselect_b32 s35, 268435456, s35
  s_cmp_eq_u32 s65, 0
  s_cselect_b32 s36, 268435456, s35
  s_add_u32 s37, s35, 195360
  s_add_u32 s38, s35, 390720
  s_add_u32 s39, s35, 586080
  s_add_u32 s40, s35, 781440
  s_add_u32 s41, s35, 981120
  s_add_u32 s42, s35, 1176480
  s_add_u32 s43, s35, 1371840
  s_add_u32 s44, s35, 1567200
  s_cmp_eq_u32 s64, 0
  s_cselect_b64 s[52:53], s[48:49], 0
  s_cmp_eq_u32 s64, 72
  s_cselect_b64 s[52:53], s[50:51], s[52:53]
  s_add_u32 s31, s31, 1
  s_mov_b32 m0, s58
  v_cndmask_b32 v110, v21, 2.0, s[52:53]
  buffer_load_dwordx4 v110, s[4:7], s36 offen lds
  buffer_load_dwordx4 v110, s[4:7], s37 offen offset:864 lds
  buffer_load_dwordx4 v110, s[4:7], s38 offen offset:1728 lds
  buffer_load_dwordx4 v110, s[4:7], s39 offen offset:2592 lds
  buffer_load_dwordx4 v110, s[4:7], s40 offen offset:3456 lds
  s_mov_b32 m0, s59
  s_nop 0
  buffer_load_dwordx4 v110, s[4:7], s41 offen lds
  buffer_load_dwordx4 v110, s[4:7], s42 offen offset:864 lds
  buffer_load_dwordx4 v110, s[4:7], s43 offen offset:1728 lds
  buffer_load_dwordx4 v110, s[4:7], s44 offen offset:2592 lds
  s_waitcnt vmcnt(0)
  ds_read_b64 v[108:109], v9
  ds_read_b64 v[112:113], v9 offset:32
  ds_read_b64 v[116:117], v9 offset:64
  ds_read_b128 v[128:131], v3
  ds_read_b128 v[132:135], v3 offset:864
  ds_read_b128 v[136:139], v3 offset:1728
  ds_read_b128 v[140:143], v6
  s_waitcnt lgkmcnt(6)
  v_mfma_f32_16x16x16_bf16 v[28:31], a[224:225], v[108:109], 0
  ds_read_b128 v[144:147], v3 offset:32
  s_waitcnt lgkmcnt(6)
  v_mfma_f32_16x16x16_bf16 v[32:35], a[234:235], v[112:113], 0
  ds_read_b128 v[148:151], v3 offset:896
  s_waitcnt lgkmcnt(6)
  v_mfma_f32_16x16x16_bf16 v[36:39], a[244:245], v[116:117], 0
  ds_read_b128 v[152:155], v3 offset:1760
  ds_read_b128 v[156:159], v6 offset:32
  s_waitcnt lgkmcnt(6)
  v_smfmac_f32_16x16x64_bf16 v[28:31], a[216:219], v[128:135], v0
  ds_read_b128 v[128:131], v3 offset:64
  ds_read_b128 v[132:135], v3 offset:928
  s_waitcnt lgkmcnt(6)
  v_smfmac_f32_16x16x64_bf16 v[28:31], a[220:223], v[136:143], v0
  ds_read_b128 v[136:139], v3 offset:1792
  ds_read_b128 v[140:143], v6 offset:64
  s_waitcnt lgkmcnt(6)
  v_smfmac_f32_16x16x64_bf16 v[32:35], a[226:229], v[144:151], v0
  ds_read_b64 v[116:117], v10
  ds_read_b64 v[112:113], v10 offset:32
  s_nop 1
  v_mul_f32 v110, v28, v28
  v_add_f32 v114, v28, v29
  s_waitcnt lgkmcnt(6)
  v_smfmac_f32_16x16x64_bf16 v[32:35], a[230:233], v[152:159], v0
  ds_read_b64 v[108:109], v10 offset:64
  ds_read_b128 v[152:155], v4
  v_fmac_f32 v110, v29, v29
  v_add_f32 v114, v114, v30
  s_waitcnt lgkmcnt(6)
  v_smfmac_f32_16x16x64_bf16 v[36:39], a[236:239], v[128:135], v0
  ds_read_b128 v[156:159], v4 offset:864
  ds_read_b128 v[128:131], v4 offset:1728
  v_fmac_f32 v110, v30, v30
  v_add_f32 v114, v114, v31
  s_waitcnt lgkmcnt(6)
  v_smfmac_f32_16x16x64_bf16 v[36:39], a[240:243], v[136:143], v0
  ds_read_b128 v[132:135], v7
  v_fmac_f32 v110, v31, v31
  s_waitcnt lgkmcnt(6)
  v_mfma_f32_16x16x16_bf16 v[40:43], a[224:225], v[116:117], 0
  ds_read_b128 v[136:139], v4 offset:32
  v_add_f32 v114, v114, v32
  s_waitcnt lgkmcnt(6)
  v_mfma_f32_16x16x16_bf16 v[44:47], a[234:235], v[112:113], 0
  ds_read_b128 v[140:143], v4 offset:896
  v_fmac_f32 v110, v32, v32
  s_waitcnt lgkmcnt(6)
  v_mfma_f32_16x16x16_bf16 v[48:51], a[244:245], v[108:109], 0
  ds_read_b128 v[144:147], v4 offset:1760
  ds_read_b128 v[148:151], v7 offset:32
  v_add_f32 v114, v114, v33
  v_fmac_f32 v110, v33, v33
  s_waitcnt lgkmcnt(6)
  v_smfmac_f32_16x16x64_bf16 v[40:43], a[216:219], v[152:159], v0
  ds_read_b128 v[152:155], v4 offset:64
  ds_read_b128 v[156:159], v4 offset:928
  v_add_f32 v114, v114, v34
  v_fmac_f32 v110, v34, v34
  s_waitcnt lgkmcnt(6)
  v_smfmac_f32_16x16x64_bf16 v[40:43], a[220:223], v[128:135], v0
  ds_read_b128 v[128:131], v4 offset:1792
  ds_read_b128 v[132:135], v7 offset:64
  v_add_f32 v114, v114, v35
  v_fmac_f32 v110, v35, v35
  s_waitcnt lgkmcnt(6)
  v_smfmac_f32_16x16x64_bf16 v[44:47], a[226:229], v[136:143], v0
  ds_read_b64 v[108:109], v11
  s_nop 0
  v_mul_f32 v118, v40, v40
  v_add_f32 v122, v40, v41
  v_fmac_f32 v118, v41, v41
  v_add_f32 v122, v122, v42
  s_waitcnt lgkmcnt(5)
  v_smfmac_f32_16x16x64_bf16 v[44:47], a[230:233], v[144:151], v0
  ds_read_b64 v[112:113], v11 offset:32
  v_fmac_f32 v118, v42, v42
  v_add_f32 v122, v122, v43
  v_fmac_f32 v118, v43, v43
  v_add_f32 v114, v114, v36
  s_waitcnt lgkmcnt(4)
  v_smfmac_f32_16x16x64_bf16 v[48:51], a[236:239], v[152:159], v0
  ds_read_b64 v[116:117], v11 offset:64
  v_add_f32 v122, v122, v44
  v_fmac_f32 v118, v44, v44
  v_add_f32 v122, v122, v45
  v_fmac_f32 v118, v45, v45
  s_waitcnt lgkmcnt(3)
  v_smfmac_f32_16x16x64_bf16 v[48:51], a[240:243], v[128:135], v0
  ds_read_b128 v[128:131], v5
  v_add_f32 v122, v122, v46
  s_waitcnt lgkmcnt(3)
  v_mfma_f32_16x16x16_bf16 v[52:55], a[224:225], v[108:109], 0
  v_fmac_f32 v118, v46, v46
  v_add_f32 v122, v122, v47
  s_waitcnt lgkmcnt(2)
  v_mfma_f32_16x16x16_bf16 v[56:59], a[234:235], v[112:113], 0
  v_fmac_f32 v118, v47, v47
  ds_read_b128 v[132:135], v5 offset:864
  v_fmac_f32 v110, v36, v36
  v_add_f32 v122, v122, v48
  s_waitcnt lgkmcnt(2)
  v_mfma_f32_16x16x16_bf16 v[60:63], a[244:245], v[116:117], 0
  v_fmac_f32 v118, v48, v48
  v_add_f32 v114, v114, v37
  v_fmac_f32 v110, v37, v37
  v_add_f32 v122, v122, v49
  v_fmac_f32 v118, v49, v49
  ds_read_b128 v[152:155], v5 offset:1728
  ds_read_b128 v[156:159], v8
  v_add_f32 v114, v114, v38
  v_fmac_f32 v110, v38, v38
  v_add_f32 v122, v122, v50
  v_fmac_f32 v118, v50, v50
  v_add_f32 v114, v114, v39
  v_fmac_f32 v110, v39, v39
  v_add_f32 v122, v122, v51
  v_fmac_f32 v118, v51, v51
  s_waitcnt lgkmcnt(2)
  v_smfmac_f32_16x16x64_bf16 v[52:55], a[216:219], v[128:135], v0
  ds_read_b128 v[128:131], v5 offset:32
  ds_read_b128 v[132:135], v5 offset:896
  v_permlane32_swap_b32 v114, v110
  v_permlane32_swap_b32 v122, v118
  ds_read_b128 v[144:147], v5 offset:1760
  ds_read_b128 v[148:151], v8 offset:32
  v_add_f32 v114, v114, v110
  v_add_f32 v122, v122, v118
  s_waitcnt lgkmcnt(4)
  v_smfmac_f32_16x16x64_bf16 v[52:55], a[220:223], v[152:159], v0
  ds_read_b128 v[152:155], v5 offset:64
  ds_read_b128 v[156:159], v5 offset:928
  v_permlane16_swap_b32 v114, v122
  ds_read_b128 v[136:139], v5 offset:1792
  s_nop 3
  v_mul_f32 v110, v52, v52
  v_add_f32 v118, v52, v53
  v_fmac_f32 v110, v53, v53
  v_add_f32 v118, v118, v54
  s_waitcnt lgkmcnt(5)
  v_smfmac_f32_16x16x64_bf16 v[56:59], a[226:229], v[128:135], v0
  ds_read_b128 v[140:143], v8 offset:64
  v_fmac_f32 v110, v54, v54
  v_add_f32 v118, v118, v55
  v_fmac_f32 v110, v55, v55
  v_add_f32 v114, v114, v122
  s_waitcnt lgkmcnt(4)
  v_smfmac_f32_16x16x64_bf16 v[56:59], a[230:233], v[144:151], v0
  ds_write_b32 v111, v114
  s_waitcnt lgkmcnt(3)
  v_smfmac_f32_16x16x64_bf16 v[60:63], a[236:239], v[152:159], v0
  s_nop 3
  v_add_f32 v118, v118, v56
  v_fmac_f32 v110, v56, v56
  v_add_f32 v118, v118, v57
  v_fmac_f32 v110, v57, v57
  v_add_f32 v118, v118, v58
  v_fmac_f32 v110, v58, v58
  s_waitcnt lgkmcnt(1)
  v_smfmac_f32_16x16x64_bf16 v[60:63], a[240:243], v[136:143], v0
  v_add_f32 v118, v118, v59
  v_fmac_f32 v110, v59, v59
  s_nop 5
  v_add_f32 v118, v118, v60
  v_fmac_f32 v110, v60, v60
  v_add_f32 v118, v118, v61
  v_fmac_f32 v110, v61, v61
  v_add_f32 v118, v118, v62
  v_fmac_f32 v110, v62, v62
  v_add_f32 v118, v118, v63
  v_fmac_f32 v110, v63, v63
  s_nop 1
  v_permlane32_swap_b32 v118, v110
  v_add_f32 v118, v118, v110
  v_mov_b32 v110, v118
  s_nop 1
  v_permlane16_swap_b32 v118, v110
  v_add_f32 v118, v118, v110
  ds_write_b32 v111, v118 offset:512
  s_waitcnt lgkmcnt(0)
  s_barrier
  ds_read_b128 v[136:139], v15
  ds_read_b128 v[140:143], v15 offset:1024
  s_waitcnt lgkmcnt(1)
  v_add_f32 v136, v136, v137
  v_add_f32 v138, v138, v139
  v_add_f32 v136, v136, v138
  s_waitcnt lgkmcnt(0)
  v_add_f32 v140, v140, v141
  v_add_f32 v142, v142, v143
  v_mul_f32 v137, 0x3baaaaab, v136
  v_add_f32 v140, v140, v142
  v_fma_f32 v140, -v137, v136, v140
  v_max_f32 v140, 0, v140
  v_add_f32 v140, 0x3afba882, v140
  v_rsq_f32 v140, v140
  s_nop 0
  v_mul_f32 v140, 0x40ca568a, v140
  v_mul_f32 v141, -v137, v140
  ds_write_b64 v115, v[140:141]
  ds_read_b64 v[108:109], v119
  ds_read_b64 v[112:113], v119 offset:128
  ds_read_b64 v[116:117], v119 offset:256
  s_waitcnt lgkmcnt(2)
  v_fma_f32 v140, v28, v108, v109
  v_fma_f32 v110, v29, v108, v109
  v_cvt_pk_bf16_f32 v140, v140, v110
  v_fma_f32 v141, v30, v108, v109
  v_fma_f32 v110, v31, v108, v109
  v_cvt_pk_bf16_f32 v141, v141, v110
  v_fma_f32 v142, v32, v108, v109
  v_fma_f32 v110, v33, v108, v109
  v_cvt_pk_bf16_f32 v142, v142, v110
  v_fma_f32 v143, v34, v108, v109
  v_fma_f32 v110, v35, v108, v109
  v_cvt_pk_bf16_f32 v143, v143, v110
  s_waitcnt lgkmcnt(1)
  v_fma_f32 v136, v40, v112, v113
  v_fma_f32 v110, v41, v112, v113
  v_cvt_pk_bf16_f32 v136, v136, v110
  v_fma_f32 v137, v42, v112, v113
  v_fma_f32 v110, v43, v112, v113
  v_cvt_pk_bf16_f32 v137, v137, v110
  v_fma_f32 v138, v44, v112, v113
  v_fma_f32 v110, v45, v112, v113
  v_cvt_pk_bf16_f32 v138, v138, v110
  v_fma_f32 v139, v46, v112, v113
  v_fma_f32 v110, v47, v112, v113
  v_cvt_pk_bf16_f32 v139, v139, v110
  s_waitcnt lgkmcnt(0)
  v_fma_f32 v152, v52, v116, v117
  v_fma_f32 v110, v53, v116, v117
  v_cvt_pk_bf16_f32 v152, v152, v110
  v_fma_f32 v153, v54, v116, v117
  v_fma_f32 v110, v55, v116, v117
  v_cvt_pk_bf16_f32 v153, v153, v110
  v_fma_f32 v154, v56, v116, v117
  v_fma_f32 v110, v57, v116, v117
  v_cvt_pk_bf16_f32 v154, v154, v110
  v_fma_f32 v155, v58, v116, v117
  v_fma_f32 v110, v59, v116, v117
  v_cvt_pk_bf16_f32 v155, v155, v110
  ds_write_b128 v16, v[140:143] offset:2048
  v_fma_f32 v120, v36, v108, v109
  ds_write_b128 v16, v[136:139] offset:8192
  v_fma_f32 v110, v37, v108, v109
  v_cvt_pk_bf16_f32 v120, v120, v110
  v_fma_f32 v121, v38, v108, v109
  v_fma_f32 v110, v39, v108, v109
  v_cvt_pk_bf16_f32 v121, v121, v110
  v_fma_f32 v108, v48, v112, v113
  ds_write_b128 v16, v[152:155] offset:14336
  v_fma_f32 v110, v49, v112, v113
  v_cvt_pk_bf16_f32 v108, v108, v110
  v_fma_f32 v109, v50, v112, v113
  v_fma_f32 v110, v51, v112, v113
  v_cvt_pk_bf16_f32 v109, v109, v110
  v_fma_f32 v112, v60, v116, v117
  v_fma_f32 v110, v61, v116, v117
  v_cvt_pk_bf16_f32 v112, v112, v110
  v_fma_f32 v113, v62, v116, v117
  v_fma_f32 v110, v63, v116, v117
  v_cvt_pk_bf16_f32 v113, v113, v110
  ds_write_b64 v17, v[120:121] offset:2048
  ds_write_b64 v17, v[108:109] offset:8192
  ds_write_b64 v17, v[112:113] offset:14336
  s_waitcnt lgkmcnt(0)
  s_barrier
  ds_read_b128 v[152:155], v15 offset:2048
  ds_read_b128 v[136:139], v15 offset:3072
  ds_read_b128 v[140:143], v15 offset:4096
  ds_read_b128 v[156:159], v15 offset:5120
  ds_read_b128 v[144:147], v15 offset:6144
  ds_read_b128 v[148:151], v15 offset:7168
  s_waitcnt lgkmcnt(5)
  v_mfma_f32_16x16x32_bf16 v[128:131], a[0:3], v[152:155], 0
  s_waitcnt lgkmcnt(4)
  v_mfma_f32_16x16x32_bf16 v[128:131], a[4:7], v[136:139], v[128:131]
  s_waitcnt lgkmcnt(3)
  v_mfma_f32_16x16x32_bf16 v[128:131], a[8:11], v[140:143], v[128:131]
  s_waitcnt lgkmcnt(2)
  v_mfma_f32_16x16x32_bf16 v[128:131], a[12:15], v[156:159], v[128:131]
  s_waitcnt lgkmcnt(1)
  v_mfma_f32_16x16x32_bf16 v[128:131], a[16:19], v[144:147], v[128:131]
  s_waitcnt lgkmcnt(0)
  v_mfma_f32_16x16x32_bf16 v[128:131], a[20:23], v[148:151], v[128:131]
  v_mfma_f32_16x16x32_bf16 v[132:135], a[72:75], v[152:155], 0
  v_mfma_f32_16x16x32_bf16 v[132:135], a[76:79], v[136:139], v[132:135]
  v_cvt_pk_bf16_f32 v160, v128, v129
  v_cvt_pk_bf16_f32 v161, v130, v131
  v_mfma_f32_16x16x32_bf16 v[132:135], a[80:83], v[140:143], v[132:135]
  v_mfma_f32_16x16x32_bf16 v[132:135], a[84:87], v[156:159], v[132:135]
  v_mfma_f32_16x16x32_bf16 v[132:135], a[88:91], v[144:147], v[132:135]
  v_mfma_f32_16x16x32_bf16 v[132:135], a[92:95], v[148:151], v[132:135]
  v_mfma_f32_16x16x32_bf16 v[128:131], v[152:155], a[144:147], 0
  v_mfma_f32_16x16x32_bf16 v[128:131], v[136:139], a[148:151], v[128:131]
  v_cvt_pk_bf16_f32 v164, v132, v133
  v_cvt_pk_bf16_f32 v165, v134, v135
  v_mfma_f32_16x16x32_bf16 v[128:131], v[140:143], a[152:155], v[128:131]
  v_mfma_f32_16x16x32_bf16 v[128:131], v[156:159], a[156:159], v[128:131]
  v_mfma_f32_16x16x32_bf16 v[128:131], v[144:147], a[160:163], v[128:131]
  v_mfma_f32_16x16x32_bf16 v[128:131], v[148:151], a[164:167], v[128:131]
  v_mfma_f32_16x16x32_bf16 v[132:135], a[24:27], v[152:155], 0
  v_mfma_f32_16x16x32_bf16 v[132:135], a[28:31], v[136:139], v[132:135]
  v_cvt_pk_bf16_f32 v168, v128, v129
  v_cvt_pk_bf16_f32 v169, v130, v131
  v_mfma_f32_16x16x32_bf16 v[132:135], a[32:35], v[140:143], v[132:135]
  v_mfma_f32_16x16x32_bf16 v[132:135], a[36:39], v[156:159], v[132:135]
  v_mfma_f32_16x16x32_bf16 v[132:135], a[40:43], v[144:147], v[132:135]
  v_mfma_f32_16x16x32_bf16 v[132:135], a[44:47], v[148:151], v[132:135]
  v_mfma_f32_16x16x32_bf16 v[128:131], a[96:99], v[152:155], 0
  v_mfma_f32_16x16x32_bf16 v[128:131], a[100:103], v[136:139], v[128:131]
  v_cvt_pk_bf16_f32 v162, v132, v133
  v_cvt_pk_bf16_f32 v163, v134, v135
  v_mfma_f32_16x16x32_bf16 v[128:131], a[104:107], v[140:143], v[128:131]
  v_mfma_f32_16x16x32_bf16 v[128:131], a[108:111], v[156:159], v[128:131]
  v_mfma_f32_16x16x32_bf16 v[128:131], a[112:115], v[144:147], v[128:131]
  v_mfma_f32_16x16x32_bf16 v[128:131], a[116:119], v[148:151], v[128:131]
  v_mfma_f32_16x16x32_bf16 v[132:135], v[152:155], a[168:171], 0
  v_mfma_f32_16x16x32_bf16 v[132:135], v[136:139], a[172:175], v[132:135]
  v_cvt_pk_bf16_f32 v166, v128, v129
  v_cvt_pk_bf16_f32 v167, v130, v131
  v_mfma_f32_16x16x32_bf16 v[132:135], v[140:143], a[176:179], v[132:135]
  v_mfma_f32_16x16x32_bf16 v[132:135], v[156:159], a[180:183], v[132:135]
  v_mfma_f32_16x16x32_bf16 v[132:135], v[144:147], a[184:187], v[132:135]
  v_mfma_f32_16x16x32_bf16 v[132:135], v[148:151], a[188:191], v[132:135]
  v_mfma_f32_16x16x32_bf16 v[128:131], a[48:51], v[152:155], 0
  v_mfma_f32_16x16x32_bf16 v[128:131], a[52:55], v[136:139], v[128:131]
  v_cvt_pk_bf16_f32 v172, v132, v133
  v_cvt_pk_bf16_f32 v173, v134, v135
  v_mfma_f32_16x16x32_bf16 v[128:131], a[56:59], v[140:143], v[128:131]
  v_mfma_f32_16x16x32_bf16 v[128:131], a[60:63], v[156:159], v[128:131]
  v_mfma_f32_16x16x32_bf16 v[128:131], a[64:67], v[144:147], v[128:131]
  v_mfma_f32_16x16x32_bf16 v[128:131], a[68:71], v[148:151], v[128:131]
  v_mfma_f32_16x16x32_bf16 v[132:135], a[120:123], v[152:155], 0
  v_mfma_f32_16x16x32_bf16 v[132:135], a[124:127], v[136:139], v[132:135]
  ds_read_b128 v[176:179], v15 offset:8192
  v_cvt_pk_bf16_f32 v120, v128, v129
  v_mfma_f32_16x16x32_bf16 v[132:135], a[128:131], v[140:143], v[132:135]
  ds_read_b128 v[180:183], v15 offset:9216
  v_cvt_pk_bf16_f32 v121, v130, v131
  v_mfma_f32_16x16x32_bf16 v[132:135], a[132:135], v[156:159], v[132:135]
  ds_read_b128 v[128:131], v15 offset:10240
  v_mfma_f32_16x16x32_bf16 v[132:135], a[136:139], v[144:147], v[132:135]
  ds_read_b128 v[184:187], v15 offset:11264
  v_mfma_f32_16x16x32_bf16 v[132:135], a[140:143], v[148:151], v[132:135]
  ds_read_b128 v[188:191], v15 offset:12288
  v_mfma_f32_16x16x32_bf16 v[192:195], v[152:155], a[192:195], 0
  ds_read_b128 v[152:155], v15 offset:13312
  v_mfma_f32_16x16x32_bf16 v[192:195], v[136:139], a[196:199], v[192:195]
  v_cvt_pk_bf16_f32 v124, v132, v133
  v_cvt_pk_bf16_f32 v125, v134, v135
  v_mfma_f32_16x16x32_bf16 v[192:195], v[140:143], a[200:203], v[192:195]
  v_mfma_f32_16x16x32_bf16 v[192:195], v[156:159], a[204:207], v[192:195]
  v_mfma_f32_16x16x32_bf16 v[192:195], v[144:147], a[208:211], v[192:195]
  v_mfma_f32_16x16x32_bf16 v[192:195], v[148:151], a[212:215], v[192:195]
  s_waitcnt lgkmcnt(5)
  v_mfma_f32_16x16x32_bf16 v[148:151], a[0:3], v[176:179], 0
  s_waitcnt lgkmcnt(4)
  v_mfma_f32_16x16x32_bf16 v[148:151], a[4:7], v[180:183], v[148:151]
  s_waitcnt lgkmcnt(3)
  v_cvt_pk_bf16_f32 v144, v192, v193
  v_cvt_pk_bf16_f32 v145, v194, v195
  v_mfma_f32_16x16x32_bf16 v[148:151], a[8:11], v[128:131], v[148:151]
  s_waitcnt lgkmcnt(2)
  v_mfma_f32_16x16x32_bf16 v[148:151], a[12:15], v[184:187], v[148:151]
  s_waitcnt lgkmcnt(1)
  v_mfma_f32_16x16x32_bf16 v[148:151], a[16:19], v[188:191], v[148:151]
  s_waitcnt lgkmcnt(0)
  v_mfma_f32_16x16x32_bf16 v[148:151], a[20:23], v[152:155], v[148:151]
  v_mfma_f32_16x16x32_bf16 v[192:195], a[72:75], v[176:179], 0
  v_mfma_f32_16x16x32_bf16 v[192:195], a[76:79], v[180:183], v[192:195]
  v_cvt_pk_bf16_f32 v156, v148, v149
  v_cvt_pk_bf16_f32 v157, v150, v151
  v_mfma_f32_16x16x32_bf16 v[192:195], a[80:83], v[128:131], v[192:195]
  v_mfma_f32_16x16x32_bf16 v[192:195], a[84:87], v[184:187], v[192:195]
  v_mfma_f32_16x16x32_bf16 v[192:195], a[88:91], v[188:191], v[192:195]
  v_mfma_f32_16x16x32_bf16 v[192:195], a[92:95], v[152:155], v[192:195]
  v_mfma_f32_16x16x32_bf16 v[148:151], v[176:179], a[144:147], 0
  v_mfma_f32_16x16x32_bf16 v[148:151], v[180:183], a[148:151], v[148:151]
  v_cvt_pk_bf16_f32 v140, v192, v193
  v_cvt_pk_bf16_f32 v141, v194, v195
  v_mfma_f32_16x16x32_bf16 v[148:151], v[128:131], a[152:155], v[148:151]
  v_mfma_f32_16x16x32_bf16 v[148:151], v[184:187], a[156:159], v[148:151]
  v_mfma_f32_16x16x32_bf16 v[148:151], v[188:191], a[160:163], v[148:151]
  v_mfma_f32_16x16x32_bf16 v[148:151], v[152:155], a[164:167], v[148:151]
  v_mfma_f32_16x16x32_bf16 v[192:195], a[24:27], v[176:179], 0
  v_mfma_f32_16x16x32_bf16 v[192:195], a[28:31], v[180:183], v[192:195]
  v_cvt_pk_bf16_f32 v170, v148, v149
  v_cvt_pk_bf16_f32 v171, v150, v151
  v_mfma_f32_16x16x32_bf16 v[192:195], a[32:35], v[128:131], v[192:195]
  v_mfma_f32_16x16x32_bf16 v[192:195], a[36:39], v[184:187], v[192:195]
  v_mfma_f32_16x16x32_bf16 v[192:195], a[40:43], v[188:191], v[192:195]
  v_mfma_f32_16x16x32_bf16 v[192:195], a[44:47], v[152:155], v[192:195]
  v_mfma_f32_16x16x32_bf16 v[148:151], a[96:99], v[176:179], 0
  v_mfma_f32_16x16x32_bf16 v[148:151], a[100:103], v[180:183], v[148:151]
  v_cvt_pk_bf16_f32 v158, v192, v193
  v_cvt_pk_bf16_f32 v159, v194, v195
  v_mfma_f32_16x16x32_bf16 v[148:151], a[104:107], v[128:131], v[148:151]
  v_mfma_f32_16x16x32_bf16 v[148:151], a[108:111], v[184:187], v[148:151]
  v_mfma_f32_16x16x32_bf16 v[148:151], a[112:115], v[188:191], v[148:151]
  v_mfma_f32_16x16x32_bf16 v[148:151], a[116:119], v[152:155], v[148:151]
  v_mfma_f32_16x16x32_bf16 v[192:195], v[176:179], a[168:171], 0
  v_mfma_f32_16x16x32_bf16 v[192:195], v[180:183], a[172:175], v[192:195]
  v_cvt_pk_bf16_f32 v142, v148, v149
  v_cvt_pk_bf16_f32 v143, v150, v151
  v_mfma_f32_16x16x32_bf16 v[192:195], v[128:131], a[176:179], v[192:195]
  v_mfma_f32_16x16x32_bf16 v[192:195], v[184:187], a[180:183], v[192:195]
  v_mfma_f32_16x16x32_bf16 v[192:195], v[188:191], a[184:187], v[192:195]
  v_mfma_f32_16x16x32_bf16 v[192:195], v[152:155], a[188:191], v[192:195]
  v_mfma_f32_16x16x32_bf16 v[148:151], a[48:51], v[176:179], 0
  v_mfma_f32_16x16x32_bf16 v[148:151], a[52:55], v[180:183], v[148:151]
  v_cvt_pk_bf16_f32 v174, v192, v193
  v_cvt_pk_bf16_f32 v175, v194, v195
  v_mfma_f32_16x16x32_bf16 v[148:151], a[56:59], v[128:131], v[148:151]
  v_mfma_f32_16x16x32_bf16 v[148:151], a[60:63], v[184:187], v[148:151]
  v_mfma_f32_16x16x32_bf16 v[148:151], a[64:67], v[188:191], v[148:151]
  v_mfma_f32_16x16x32_bf16 v[148:151], a[68:71], v[152:155], v[148:151]
  v_mfma_f32_16x16x32_bf16 v[192:195], a[120:123], v[176:179], 0
  v_mfma_f32_16x16x32_bf16 v[192:195], a[124:127], v[180:183], v[192:195]
  ds_read_b128 v[132:135], v15 offset:14336
  v_cvt_pk_bf16_f32 v208, v148, v149
  v_mfma_f32_16x16x32_bf16 v[192:195], a[128:131], v[128:131], v[192:195]
  ds_read_b128 v[136:139], v15 offset:15360
  v_cvt_pk_bf16_f32 v209, v150, v151
  v_mfma_f32_16x16x32_bf16 v[192:195], a[132:135], v[184:187], v[192:195]
  ds_read_b128 v[148:151], v15 offset:16384
  v_mfma_f32_16x16x32_bf16 v[192:195], a[136:139], v[188:191], v[192:195]
  ds_read_b128 v[196:199], v15 offset:17408
  v_mfma_f32_16x16x32_bf16 v[192:195], a[140:143], v[152:155], v[192:195]
  ds_read_b128 v[200:203], v15 offset:18432
  v_mfma_f32_16x16x32_bf16 v[204:207], v[176:179], a[192:195], 0
  ds_read_b128 v[176:179], v15 offset:19456
  v_mfma_f32_16x16x32_bf16 v[204:207], v[180:183], a[196:199], v[204:207]
  v_cvt_pk_bf16_f32 v210, v192, v193
  v_cvt_pk_bf16_f32 v211, v194, v195
  v_mfma_f32_16x16x32_bf16 v[204:207], v[128:131], a[200:203], v[204:207]
  v_mfma_f32_16x16x32_bf16 v[204:207], v[184:187], a[204:207], v[204:207]
  v_mfma_f32_16x16x32_bf16 v[204:207], v[188:191], a[208:211], v[204:207]
  v_mfma_f32_16x16x32_bf16 v[204:207], v[152:155], a[212:215], v[204:207]
  s_waitcnt lgkmcnt(5)
  v_mfma_f32_16x16x32_bf16 v[152:155], a[0:3], v[132:135], 0
  s_waitcnt lgkmcnt(4)
  v_mfma_f32_16x16x32_bf16 v[152:155], a[4:7], v[136:139], v[152:155]
  s_waitcnt lgkmcnt(3)
  v_cvt_pk_bf16_f32 v146, v204, v205
  v_cvt_pk_bf16_f32 v147, v206, v207
  v_mfma_f32_16x16x32_bf16 v[152:155], a[8:11], v[148:151], v[152:155]
  s_waitcnt lgkmcnt(2)
  v_mfma_f32_16x16x32_bf16 v[152:155], a[12:15], v[196:199], v[152:155]
  s_waitcnt lgkmcnt(1)
  v_mfma_f32_16x16x32_bf16 v[152:155], a[16:19], v[200:203], v[152:155]
  s_waitcnt lgkmcnt(0)
  v_mfma_f32_16x16x32_bf16 v[152:155], a[20:23], v[176:179], v[152:155]
  v_mfma_f32_16x16x32_bf16 v[204:207], a[72:75], v[132:135], 0
  v_mfma_f32_16x16x32_bf16 v[204:207], a[76:79], v[136:139], v[204:207]
  v_cvt_pk_bf16_f32 v188, v152, v153
  v_cvt_pk_bf16_f32 v189, v154, v155
  v_mfma_f32_16x16x32_bf16 v[204:207], a[80:83], v[148:151], v[204:207]
  v_mfma_f32_16x16x32_bf16 v[204:207], a[84:87], v[196:199], v[204:207]
  v_mfma_f32_16x16x32_bf16 v[204:207], a[88:91], v[200:203], v[204:207]
  v_mfma_f32_16x16x32_bf16 v[204:207], a[92:95], v[176:179], v[204:207]
  v_mfma_f32_16x16x32_bf16 v[152:155], v[132:135], a[144:147], 0
  v_mfma_f32_16x16x32_bf16 v[152:155], v[136:139], a[148:151], v[152:155]
  v_cvt_pk_bf16_f32 v184, v204, v205
  v_cvt_pk_bf16_f32 v185, v206, v207
  v_mfma_f32_16x16x32_bf16 v[152:155], v[148:151], a[152:155], v[152:155]
  v_mfma_f32_16x16x32_bf16 v[152:155], v[196:199], a[156:159], v[152:155]
  v_mfma_f32_16x16x32_bf16 v[152:155], v[200:203], a[160:163], v[152:155]
  v_mfma_f32_16x16x32_bf16 v[152:155], v[176:179], a[164:167], v[152:155]
  v_mfma_f32_16x16x32_bf16 v[204:207], a[24:27], v[132:135], 0
  v_mfma_f32_16x16x32_bf16 v[204:207], a[28:31], v[136:139], v[204:207]
  v_cvt_pk_bf16_f32 v108, v152, v153
  v_cvt_pk_bf16_f32 v109, v154, v155
  v_mfma_f32_16x16x32_bf16 v[204:207], a[32:35], v[148:151], v[204:207]
  v_mfma_f32_16x16x32_bf16 v[204:207], a[36:39], v[196:199], v[204:207]
  v_mfma_f32_16x16x32_bf16 v[204:207], a[40:43], v[200:203], v[204:207]
  v_mfma_f32_16x16x32_bf16 v[204:207], a[44:47], v[176:179], v[204:207]
  v_mfma_f32_16x16x32_bf16 v[152:155], a[96:99], v[132:135], 0
  v_mfma_f32_16x16x32_bf16 v[152:155], a[100:103], v[136:139], v[152:155]
  v_cvt_pk_bf16_f32 v190, v204, v205
  v_cvt_pk_bf16_f32 v191, v206, v207
  v_mfma_f32_16x16x32_bf16 v[152:155], a[104:107], v[148:151], v[152:155]
  v_mfma_f32_16x16x32_bf16 v[152:155], a[108:111], v[196:199], v[152:155]
  v_mfma_f32_16x16x32_bf16 v[152:155], a[112:115], v[200:203], v[152:155]
  v_mfma_f32_16x16x32_bf16 v[152:155], a[116:119], v[176:179], v[152:155]
  v_mfma_f32_16x16x32_bf16 v[204:207], v[132:135], a[168:171], 0
  v_mfma_f32_16x16x32_bf16 v[204:207], v[136:139], a[172:175], v[204:207]
  v_cvt_pk_bf16_f32 v186, v152, v153
  v_cvt_pk_bf16_f32 v187, v154, v155
  v_mfma_f32_16x16x32_bf16 v[204:207], v[148:151], a[176:179], v[204:207]
  v_mfma_f32_16x16x32_bf16 v[204:207], v[196:199], a[180:183], v[204:207]
  v_mfma_f32_16x16x32_bf16 v[204:207], v[200:203], a[184:187], v[204:207]
  v_mfma_f32_16x16x32_bf16 v[204:207], v[176:179], a[188:191], v[204:207]
  v_mfma_f32_16x16x32_bf16 v[152:155], a[48:51], v[132:135], 0
  v_mfma_f32_16x16x32_bf16 v[152:155], a[52:55], v[136:139], v[152:155]
  v_cvt_pk_bf16_f32 v112, v204, v205
  v_cvt_pk_bf16_f32 v113, v206, v207
  v_mfma_f32_16x16x32_bf16 v[152:155], a[56:59], v[148:151], v[152:155]
  v_mfma_f32_16x16x32_bf16 v[152:155], a[60:63], v[196:199], v[152:155]
  v_mfma_f32_16x16x32_bf16 v[152:155], a[64:67], v[200:203], v[152:155]
  ds_read_b64 v[192:193], v19 offset:16
  v_mfma_f32_16x16x32_bf16 v[152:155], a[68:71], v[176:179], v[152:155]
  v_mfma_f32_16x16x32_bf16 v[204:207], a[120:123], v[132:135], 0
  v_mfma_f32_16x16x32_bf16 v[204:207], a[124:127], v[136:139], v[204:207]
  ds_read2_b64 v[128:131], v19 offset0:0 offset1:1
  v_cvt_pk_bf16_f32 v194, v152, v153
  v_mfma_f32_16x16x32_bf16 v[204:207], a[128:131], v[148:151], v[204:207]
  v_cvt_pk_bf16_f32 v195, v154, v155
  v_mfma_f32_16x16x32_bf16 v[204:207], a[132:135], v[196:199], v[204:207]
  v_mfma_f32_16x16x32_bf16 v[204:207], a[136:139], v[200:203], v[204:207]
  v_mfma_f32_16x16x32_bf16 v[204:207], a[140:143], v[176:179], v[204:207]
  v_mfma_f32_16x16x32_bf16 v[152:155], v[132:135], a[192:195], 0
  ds_read_u16 v110, v20
  v_mfma_f32_16x16x32_bf16 v[152:155], v[136:139], a[196:199], v[152:155]
  v_cvt_pk_bf16_f32 v132, v204, v205
  v_cvt_pk_bf16_f32 v133, v206, v207
  v_mfma_f32_16x16x32_bf16 v[152:155], v[148:151], a[200:203], v[152:155]
  ds_read_u16 v114, v20 offset:32
  v_mfma_f32_16x16x32_bf16 v[152:155], v[196:199], a[204:207], v[152:155]
  v_mfma_f32_16x16x32_bf16 v[152:155], v[200:203], a[208:211], v[152:155]
  ds_read_u16 v118, v20 offset:64
  v_mfma_f32_16x16x32_bf16 v[152:155], v[176:179], a[212:215], v[152:155]
  s_waitcnt lgkmcnt(4)
  v_mfma_f32_16x16x16_bf16 v[176:179], v[124:125], v[120:121], 0
  v_mfma_f32_16x16x16_bf16 v[200:203], v[210:211], v[120:121], 0
  v_cvt_pk_bf16_f32 v116, v152, v153
  v_cvt_pk_bf16_f32 v117, v154, v155
  v_mfma_f32_16x16x16_bf16 v[152:155], v[132:133], v[120:121], 0
  v_mfma_f32_16x16x16_bf16 v[196:199], v[192:193], v[120:121], v[2:5]
  v_mfma_f32_16x16x32_bf16 v[176:179], v[164:167], v[160:163], v[176:179]
  v_mfma_f32_16x16x32_bf16 v[200:203], v[140:143], v[160:163], v[200:203]
  v_mfma_f32_16x16x32_bf16 v[152:155], v[184:187], v[160:163], v[152:155]
  s_waitcnt lgkmcnt(3)
  v_max3_f32 v122, v176, v177, v178
  v_mfma_f32_16x16x32_bf16 v[196:199], v[128:131], v[160:163], v[196:199]
  v_max3_f32 v122, v122, v179, v200
  v_max3_f32 v122, v122, v201, v202
  s_nop 1
  v_max3_f32 v122, v122, v203, v152
  v_max3_f32 v122, v122, v153, v154
  s_nop 1
  v_max3_f32 v122, v122, v155, v196
  v_mov_b32 v120, v122
  s_nop 1
  v_permlane32_swap_b32 v122, v120
  v_max_f32 v122, v122, v120
  v_mov_b32 v120, v122
  s_nop 1
  v_permlane16_swap_b32 v122, v120
  v_max_f32 v122, v122, v120
  v_sub_f32 v176, v176, v122
  v_sub_f32 v177, v177, v122
  v_sub_f32 v178, v178, v122
  v_sub_f32 v179, v179, v122
  v_sub_f32 v200, v200, v122
  v_sub_f32 v201, v201, v122
  v_sub_f32 v202, v202, v122
  v_sub_f32 v203, v203, v122
  v_exp_f32 v176, v176
  v_exp_f32 v177, v177
  v_exp_f32 v178, v178
  v_exp_f32 v179, v179
  v_exp_f32 v200, v200
  v_exp_f32 v201, v201
  v_exp_f32 v202, v202
  v_exp_f32 v203, v203
  v_sub_f32 v152, v152, v122
  v_sub_f32 v153, v153, v122
  v_sub_f32 v154, v154, v122
  v_sub_f32 v155, v155, v122
  v_sub_f32 v196, v196, v122
  v_exp_f32 v152, v152
  v_exp_f32 v153, v153
  v_exp_f32 v154, v154
  v_exp_f32 v155, v155
  v_exp_f32 v196, v196
  v_cvt_pk_bf16_f32 v160, v176, v177
  v_cvt_pk_bf16_f32 v161, v178, v179
  v_cvt_pk_bf16_f32 v162, v200, v201
  v_cvt_pk_bf16_f32 v163, v202, v203
  v_cvt_pk_bf16_f32 v120, v152, v153
  v_cvt_pk_bf16_f32 v121, v154, v155
  v_mfma_f32_16x16x32_bf16 v[152:155], a[246:249], v[160:163], 0
  v_cvt_pk_bf16_f32 v122, v196, 0
  s_nop 1
  v_mfma_f32_16x16x32_bf16 v[152:155], a[246:249], v[120:123], v[152:155]
  v_mfma_f32_16x16x32_bf16 v[196:199], v[168:171], v[160:163], 0
  s_waitcnt lgkmcnt(2)
  v_mfma_f32_16x16x32_bf16 v[196:199], v[108:111], v[120:123], v[196:199]
  v_mul_f32 v152, 0x3ee9a3cd, v152
  v_mfma_f32_16x16x32_bf16 v[200:203], v[172:175], v[160:163], 0
  s_waitcnt lgkmcnt(1)
  v_rcp_f32 v126, v152
  v_mfma_f32_16x16x32_bf16 v[200:203], v[112:115], v[120:123], v[200:203]
  v_mul_f32 v196, v196, v126
  v_mul_f32 v197, v197, v126
  v_mfma_f32_16x16x32_bf16 v[152:155], v[144:147], v[160:163], 0
  s_waitcnt lgkmcnt(0)
  v_cvt_pk_bf16_f32 v160, v196, v197
  v_mul_f32 v198, v198, v126
  v_mfma_f32_16x16x32_bf16 v[152:155], v[116:119], v[120:123], v[152:155]
  v_mul_f32 v199, v199, v126
  v_cvt_pk_bf16_f32 v161, v198, v199
  v_mul_f32 v200, v200, v126
  v_mfma_f32_16x16x16_bf16 v[196:199], v[124:125], v[208:209], 0
  v_mul_f32 v201, v201, v126
  v_cvt_pk_bf16_f32 v162, v200, v201
  v_mul_f32 v202, v202, v126
  v_mfma_f32_16x16x16_bf16 v[176:179], v[210:211], v[208:209], 0
  v_mul_f32 v203, v203, v126
  v_cvt_pk_bf16_f32 v163, v202, v203
  v_mul_f32 v152, v152, v126
  v_mfma_f32_16x16x16_bf16 v[200:203], v[132:133], v[208:209], 0
  v_mul_f32 v153, v153, v126
  v_cvt_pk_bf16_f32 v134, v152, v153
  v_mul_f32 v154, v154, v126
  v_mfma_f32_16x16x16_bf16 v[148:151], v[192:193], v[208:209], v[2:5]
  v_mul_f32 v155, v155, v126
  v_cvt_pk_bf16_f32 v135, v154, v155
  v_mfma_f32_16x16x32_bf16 v[196:199], v[164:167], v[156:159], v[196:199]
  ds_write_b128 v16, v[160:163] offset:20480
  v_mfma_f32_16x16x32_bf16 v[176:179], v[140:143], v[156:159], v[176:179]
  s_nop 3
  v_max3_f32 v126, v196, v197, v198
  v_mfma_f32_16x16x32_bf16 v[200:203], v[184:187], v[156:159], v[200:203]
  ds_write_b64 v17, v[134:135] offset:20480
  v_mfma_f32_16x16x32_bf16 v[148:151], v[128:131], v[156:159], v[148:151]
  v_max3_f32 v126, v126, v199, v176
  v_max3_f32 v126, v126, v177, v178
  s_nop 1
  v_max3_f32 v126, v126, v179, v200
  v_max3_f32 v126, v126, v201, v202
  s_nop 1
  v_max3_f32 v126, v126, v203, v148
  v_mov_b32 v134, v126
  s_nop 1
  v_permlane32_swap_b32 v126, v134
  v_max_f32 v126, v126, v134
  v_mov_b32 v134, v126
  s_nop 1
  v_permlane16_swap_b32 v126, v134
  v_max_f32 v126, v126, v134
  v_sub_f32 v196, v196, v126
  v_sub_f32 v197, v197, v126
  v_sub_f32 v198, v198, v126
  v_sub_f32 v199, v199, v126
  v_sub_f32 v176, v176, v126
  v_sub_f32 v177, v177, v126
  v_sub_f32 v178, v178, v126
  v_sub_f32 v179, v179, v126
  v_exp_f32 v196, v196
  v_exp_f32 v197, v197
  v_exp_f32 v198, v198
  v_exp_f32 v199, v199
  v_exp_f32 v176, v176
  v_exp_f32 v177, v177
  v_exp_f32 v178, v178
  v_exp_f32 v179, v179
  v_sub_f32 v200, v200, v126
  v_sub_f32 v201, v201, v126
  v_sub_f32 v202, v202, v126
  v_sub_f32 v203, v203, v126
  v_sub_f32 v148, v148, v126
  v_exp_f32 v200, v200
  v_exp_f32 v201, v201
  v_exp_f32 v202, v202
  v_exp_f32 v203, v203
  v_exp_f32 v148, v148
  v_cvt_pk_bf16_f32 v156, v196, v197
  v_cvt_pk_bf16_f32 v157, v198, v199
  v_cvt_pk_bf16_f32 v158, v176, v177
  v_cvt_pk_bf16_f32 v159, v178, v179
  v_cvt_pk_bf16_f32 v120, v200, v201
  v_cvt_pk_bf16_f32 v121, v202, v203
  v_mfma_f32_16x16x32_bf16 v[200:203], a[246:249], v[156:159], 0
  v_cvt_pk_bf16_f32 v122, v148, 0
  s_nop 1
  v_mfma_f32_16x16x32_bf16 v[200:203], a[246:249], v[120:123], v[200:203]
  v_mfma_f32_16x16x32_bf16 v[148:151], v[168:171], v[156:159], 0
  v_mfma_f32_16x16x32_bf16 v[148:151], v[108:111], v[120:123], v[148:151]
  v_mul_f32 v200, 0x3ee9a3cd, v200
  v_mfma_f32_16x16x32_bf16 v[176:179], v[172:175], v[156:159], 0
  v_rcp_f32 v126, v200
  v_mfma_f32_16x16x32_bf16 v[176:179], v[112:115], v[120:123], v[176:179]
  v_mul_f32 v148, v148, v126
  v_mul_f32 v149, v149, v126
  v_mfma_f32_16x16x32_bf16 v[200:203], v[144:147], v[156:159], 0
  v_cvt_pk_bf16_f32 v156, v148, v149
  v_mul_f32 v150, v150, v126
  v_mfma_f32_16x16x32_bf16 v[200:203], v[116:119], v[120:123], v[200:203]
  ds_read_b64 v[134:135], v19 offset:784
  v_mul_f32 v151, v151, v126
  v_cvt_pk_bf16_f32 v157, v150, v151
  v_mfma_f32_16x16x16_bf16 v[148:151], v[124:125], v[194:195], 0
  v_mul_f32 v176, v176, v126
  v_mul_f32 v177, v177, v126
  v_cvt_pk_bf16_f32 v158, v176, v177
  v_mfma_f32_16x16x16_bf16 v[196:199], v[210:211], v[194:195], 0
  v_mul_f32 v178, v178, v126
  v_mul_f32 v179, v179, v126
  v_cvt_pk_bf16_f32 v159, v178, v179
  v_mfma_f32_16x16x16_bf16 v[176:179], v[132:133], v[194:195], 0
  v_mul_f32 v200, v200, v126
  v_mul_f32 v201, v201, v126
  v_cvt_pk_bf16_f32 v208, v200, v201
  v_mfma_f32_16x16x16_bf16 v[160:163], v[192:193], v[194:195], v[2:5]
  v_mul_f32 v202, v202, v126
  v_mul_f32 v203, v203, v126
  v_cvt_pk_bf16_f32 v209, v202, v203
  v_mfma_f32_16x16x32_bf16 v[148:151], v[164:167], v[188:191], v[148:151]
  ds_read2_b64 v[200:203], v19 offset0:96 offset1:97
  v_add_u32 v19, 1160, v19
  v_mfma_f32_16x16x32_bf16 v[196:199], v[140:143], v[188:191], v[196:199]
  ds_write_b128 v16, v[156:159] offset:26624
  v_mfma_f32_16x16x32_bf16 v[176:179], v[184:187], v[188:191], v[176:179]
  v_max3_f32 v126, v148, v149, v150
  s_nop 2
  v_max3_f32 v126, v126, v151, v196
  v_mfma_f32_16x16x32_bf16 v[160:163], v[128:131], v[188:191], v[160:163]
  v_max3_f32 v126, v126, v197, v198
  s_nop 0
  v_max3_f32 v126, v126, v199, v176
  v_max3_f32 v126, v126, v177, v178
  s_nop 3
  v_max3_f32 v126, v126, v179, v160
  v_mov_b32 v194, v126
  s_nop 1
  v_permlane32_swap_b32 v126, v194
  v_max_f32 v126, v126, v194
  v_mov_b32 v194, v126
  s_nop 1
  v_permlane16_swap_b32 v126, v194
  v_max_f32 v126, v126, v194
  v_sub_f32 v148, v148, v126
  v_sub_f32 v149, v149, v126
  v_sub_f32 v150, v150, v126
  v_sub_f32 v151, v151, v126
  v_sub_f32 v196, v196, v126
  v_sub_f32 v197, v197, v126
  v_sub_f32 v198, v198, v126
  v_sub_f32 v199, v199, v126
  v_exp_f32 v148, v148
  v_exp_f32 v149, v149
  v_exp_f32 v150, v150
  v_exp_f32 v151, v151
  v_exp_f32 v196, v196
  v_exp_f32 v197, v197
  v_exp_f32 v198, v198
  v_exp_f32 v199, v199
  v_sub_f32 v176, v176, v126
  v_sub_f32 v177, v177, v126
  v_sub_f32 v178, v178, v126
  v_sub_f32 v179, v179, v126
  v_sub_f32 v160, v160, v126
  v_exp_f32 v176, v176
  v_exp_f32 v177, v177
  v_exp_f32 v178, v178
  v_exp_f32 v179, v179
  v_exp_f32 v160, v160
  v_cvt_pk_bf16_f32 v188, v148, v149
  v_cvt_pk_bf16_f32 v189, v150, v151
  v_cvt_pk_bf16_f32 v190, v196, v197
  v_cvt_pk_bf16_f32 v191, v198, v199
  v_cvt_pk_bf16_f32 v120, v176, v177
  v_cvt_pk_bf16_f32 v121, v178, v179
  v_mfma_f32_16x16x32_bf16 v[176:179], a[246:249], v[188:191], 0
  v_cvt_pk_bf16_f32 v122, v160, 0
  s_nop 1
  v_mfma_f32_16x16x32_bf16 v[176:179], a[246:249], v[120:123], v[176:179]
  ds_write_b64 v17, v[208:209] offset:26624
  v_mfma_f32_16x16x32_bf16 v[160:163], v[168:171], v[188:191], 0
  v_mfma_f32_16x16x32_bf16 v[160:163], v[108:111], v[120:123], v[160:163]
  v_mul_f32 v176, 0x3ee9a3cd, v176
  v_mfma_f32_16x16x32_bf16 v[196:199], v[172:175], v[188:191], 0
  v_rcp_f32 v126, v176
  v_mfma_f32_16x16x32_bf16 v[196:199], v[112:115], v[120:123], v[196:199]
  v_mul_f32 v160, v160, v126
  v_mul_f32 v161, v161, v126
  v_mfma_f32_16x16x32_bf16 v[176:179], v[144:147], v[188:191], 0
  v_mul_f32 v162, v162, v126
  v_mul_f32 v163, v163, v126
  v_mfma_f32_16x16x32_bf16 v[176:179], v[116:119], v[120:123], v[176:179]
  s_waitcnt lgkmcnt(2)
  v_mul_f32 v196, v196, v126
  v_mul_f32 v197, v197, v126
  v_mul_f32 v198, v198, v126
  v_mfma_f32_16x16x16_bf16 v[188:191], v[124:125], v[134:135], 0
  v_mul_f32 v199, v199, v126
  v_cvt_pk_bf16_f32 v148, v160, v161
  v_cvt_pk_bf16_f32 v149, v162, v163
  v_mfma_f32_16x16x16_bf16 v[160:163], v[210:211], v[134:135], 0
  v_cvt_pk_bf16_f32 v150, v196, v197
  v_cvt_pk_bf16_f32 v151, v198, v199
  v_mul_f32 v176, v176, v126
  v_mfma_f32_16x16x16_bf16 v[196:199], v[132:133], v[134:135], 0
  v_mul_f32 v177, v177, v126
  v_mul_f32 v178, v178, v126
  v_mul_f32 v179, v179, v126
  v_mfma_f32_16x16x16_bf16 v[156:159], v[192:193], v[134:135], v[2:5]
  v_cvt_pk_bf16_f32 v124, v176, v177
  v_cvt_pk_bf16_f32 v125, v178, v179
  v_mfma_f32_16x16x32_bf16 v[188:191], v[164:167], v[200:203], v[188:191]
  ds_write_b128 v16, v[148:151] offset:32768
  v_mfma_f32_16x16x32_bf16 v[160:163], v[140:143], v[200:203], v[160:163]
  s_nop 3
  v_max3_f32 v126, v188, v189, v190
  v_mfma_f32_16x16x32_bf16 v[196:199], v[184:187], v[200:203], v[196:199]
  ds_write_b64 v17, v[124:125] offset:32768
  v_mfma_f32_16x16x32_bf16 v[156:159], v[128:131], v[200:203], v[156:159]
  v_max3_f32 v126, v126, v191, v160
  v_max3_f32 v126, v126, v161, v162
  s_nop 1
  v_max3_f32 v126, v126, v163, v196
  v_max3_f32 v126, v126, v197, v198
  ds_read_b128 v[128:131], v18
  s_nop 0
  v_max3_f32 v126, v126, v199, v156
  v_mov_b32 v124, v126
  s_nop 1
  v_permlane32_swap_b32 v126, v124
  v_max_f32 v126, v126, v124
  v_mov_b32 v124, v126
  s_nop 1
  v_permlane16_swap_b32 v126, v124
  v_max_f32 v126, v126, v124
  v_sub_f32 v188, v188, v126
  v_sub_f32 v189, v189, v126
  v_sub_f32 v190, v190, v126
  v_sub_f32 v191, v191, v126
  v_sub_f32 v160, v160, v126
  v_sub_f32 v161, v161, v126
  v_sub_f32 v162, v162, v126
  v_sub_f32 v163, v163, v126
  v_exp_f32 v188, v188
  v_exp_f32 v189, v189
  v_exp_f32 v190, v190
  v_exp_f32 v191, v191
  v_exp_f32 v160, v160
  v_exp_f32 v161, v161
  v_exp_f32 v162, v162
  v_exp_f32 v163, v163
  v_sub_f32 v196, v196, v126
  v_sub_f32 v197, v197, v126
  v_sub_f32 v198, v198, v126
  v_sub_f32 v199, v199, v126
  v_sub_f32 v156, v156, v126
  v_exp_f32 v196, v196
  v_exp_f32 v197, v197
  v_exp_f32 v198, v198
  v_exp_f32 v199, v199
  v_exp_f32 v156, v156
  v_cvt_pk_bf16_f32 v200, v188, v189
  v_cvt_pk_bf16_f32 v201, v190, v191
  v_cvt_pk_bf16_f32 v202, v160, v161
  v_cvt_pk_bf16_f32 v203, v162, v163
  v_cvt_pk_bf16_f32 v120, v196, v197
  v_cvt_pk_bf16_f32 v121, v198, v199
  v_mfma_f32_16x16x32_bf16 v[196:199], a[246:249], v[200:203], 0
  v_cvt_pk_bf16_f32 v122, v156, 0
  s_nop 1
  v_mfma_f32_16x16x32_bf16 v[196:199], a[246:249], v[120:123], v[196:199]
  ds_read_b128 v[156:159], v18 offset:6144
  ds_read_b128 v[160:163], v18 offset:1024
  v_mfma_f32_16x16x32_bf16 v[188:191], v[200:203], v[168:171], 0
  ds_read_b128 v[168:171], v18 offset:7168
  v_mfma_f32_16x16x32_bf16 v[188:191], v[120:123], v[108:111], v[188:191]
  v_mul_f32 v196, 0x3ee9a3cd, v196
  v_mfma_f32_16x16x32_bf16 v[184:187], v[200:203], v[172:175], 0
  v_rcp_f32 v110, v196
  v_mfma_f32_16x16x32_bf16 v[184:187], v[120:123], v[112:115], v[184:187]
  ds_read_b128 v[196:199], v18 offset:2048
  ds_read_b128 v[172:175], v18 offset:8192
  v_mfma_f32_16x16x32_bf16 v[140:143], v[200:203], v[144:147], 0
  v_mfma_f32_16x16x32_bf16 v[140:143], v[120:123], v[116:119], v[140:143]
  s_waitcnt lgkmcnt(6)
  v_cndmask_b32 v118, v184, v188, s[54:55]
  s_nop 5
  v_cndmask_b32 v118, v140, v118, s[56:57]
  v_mul_f32 v118, v118, v110
  v_cvt_pk_bf16_f32 v118, v118, v118
  ds_write_b16 v20, v118 offset:384
  v_add_u32 v20, 1160, v20
  s_waitcnt lgkmcnt(0)
  s_barrier
  ds_read_b128 v[140:143], v15 offset:20480
  ds_read_b128 v[184:187], v15 offset:21504
  ds_read_b128 v[188:191], v15 offset:22528
  ds_read_b128 v[144:147], v15 offset:26624
  ds_read_b128 v[200:203], v15 offset:27648
  ds_read_b128 v[148:151], v15 offset:28672
  s_waitcnt lgkmcnt(5)
  v_mfma_f32_16x16x32_bf16 v[28:31], a[250:253], v[140:143], v[28:31]
  s_waitcnt lgkmcnt(4)
  v_mfma_f32_16x16x32_bf16 v[28:31], v[128:131], v[184:187], v[28:31]
  s_waitcnt lgkmcnt(3)
  v_mfma_f32_16x16x32_bf16 v[28:31], v[156:159], v[188:191], v[28:31]
  v_mfma_f32_16x16x32_bf16 v[32:35], v[100:103], v[140:143], v[32:35]
  v_mfma_f32_16x16x32_bf16 v[32:35], v[160:163], v[184:187], v[32:35]
  v_mfma_f32_16x16x32_bf16 v[32:35], v[168:171], v[188:191], v[32:35]
  ds_read_b128 v[164:167], v15 offset:32768
  v_mfma_f32_16x16x32_bf16 v[36:39], v[104:107], v[140:143], v[36:39]
  ds_read_b128 v[140:143], v15 offset:33792
  v_mfma_f32_16x16x32_bf16 v[36:39], v[196:199], v[184:187], v[36:39]
  ds_read_b128 v[184:187], v15 offset:34816
  v_mfma_f32_16x16x32_bf16 v[36:39], v[172:175], v[188:191], v[36:39]
  s_waitcnt lgkmcnt(5)
  v_mfma_f32_16x16x32_bf16 v[40:43], a[250:253], v[144:147], v[40:43]
  s_waitcnt lgkmcnt(4)
  v_mfma_f32_16x16x32_bf16 v[40:43], v[128:131], v[200:203], v[40:43]
  s_waitcnt lgkmcnt(3)
  v_mfma_f32_16x16x32_bf16 v[40:43], v[156:159], v[148:151], v[40:43]
  v_mfma_f32_16x16x32_bf16 v[44:47], v[100:103], v[144:147], v[44:47]
  v_mfma_f32_16x16x32_bf16 v[44:47], v[160:163], v[200:203], v[44:47]
  v_mfma_f32_16x16x32_bf16 v[44:47], v[168:171], v[148:151], v[44:47]
  ds_read_b128 v[188:191], v18 offset:9216
  ds_read_b128 v[176:179], v15 offset:23552
  v_mfma_f32_16x16x32_bf16 v[48:51], v[104:107], v[144:147], v[48:51]
  ds_read_b128 v[144:147], v18 offset:3072
  v_mfma_f32_16x16x32_bf16 v[48:51], v[196:199], v[200:203], v[48:51]
  ds_read_b128 v[200:203], v15 offset:24576
  v_mfma_f32_16x16x32_bf16 v[48:51], v[172:175], v[148:151], v[48:51]
  s_waitcnt lgkmcnt(6)
  ds_read_b128 v[148:151], v18 offset:12288
  v_mfma_f32_16x16x32_bf16 v[52:55], a[250:253], v[164:167], v[52:55]
  s_waitcnt lgkmcnt(6)
  ds_read_b128 v[152:155], v15 offset:25600
  v_mfma_f32_16x16x32_bf16 v[52:55], v[128:131], v[140:143], v[52:55]
  s_waitcnt lgkmcnt(6)
  ds_read_b128 v[128:131], v18 offset:10240
  v_mfma_f32_16x16x32_bf16 v[52:55], v[156:159], v[184:187], v[52:55]
  ds_read_b128 v[156:159], v18 offset:4096
  v_mfma_f32_16x16x32_bf16 v[56:59], v[100:103], v[164:167], v[56:59]
  ds_read_b128 v[132:135], v18 offset:13312
  v_mfma_f32_16x16x32_bf16 v[56:59], v[160:163], v[140:143], v[56:59]
  ds_read_b128 v[160:163], v18 offset:11264
  v_mfma_f32_16x16x32_bf16 v[56:59], v[168:171], v[184:187], v[56:59]
  ds_read_b128 v[168:171], v18 offset:5120
  v_mfma_f32_16x16x32_bf16 v[60:63], v[104:107], v[164:167], v[60:63]
  ds_read_b128 v[164:167], v18 offset:14336
  v_mfma_f32_16x16x32_bf16 v[60:63], v[196:199], v[140:143], v[60:63]
  ds_read_b128 v[140:143], v15 offset:29696
  v_mfma_f32_16x16x32_bf16 v[60:63], v[172:175], v[184:187], v[60:63]
  s_waitcnt lgkmcnt(11)
  ds_read_b128 v[172:175], v15 offset:30720
  v_mfma_f32_16x16x32_bf16 v[28:31], v[188:191], v[176:179], v[28:31]
  s_waitcnt lgkmcnt(10)
  ds_read_b128 v[184:187], v15 offset:31744
  v_mfma_f32_16x16x32_bf16 v[28:31], v[144:147], v[200:203], v[28:31]
  s_waitcnt lgkmcnt(9)
  v_mfma_f32_16x16x32_bf16 v[28:31], v[148:151], v[152:155], v[28:31]
  s_waitcnt lgkmcnt(8)
  v_mfma_f32_16x16x32_bf16 v[32:35], v[128:131], v[176:179], v[32:35]
  s_waitcnt lgkmcnt(7)
  v_mfma_f32_16x16x32_bf16 v[32:35], v[156:159], v[200:203], v[32:35]
  s_waitcnt lgkmcnt(6)
  v_cvt_pk_bf16_f32 v196, v28, v29
  v_cvt_pk_bf16_f32 v197, v30, v31
  v_mfma_f32_16x16x32_bf16 v[32:35], v[132:135], v[152:155], v[32:35]
  s_waitcnt lgkmcnt(5)
  ds_read_b128 v[136:139], v15 offset:35840
  v_mfma_f32_16x16x32_bf16 v[36:39], v[160:163], v[176:179], v[36:39]
  s_waitcnt lgkmcnt(5)
  ds_read_b128 v[176:179], v15 offset:36864
  v_mfma_f32_16x16x32_bf16 v[36:39], v[168:171], v[200:203], v[36:39]
  s_waitcnt lgkmcnt(5)
  ds_read_b128 v[200:203], v15 offset:37888
  v_cvt_pk_bf16_f32 v198, v32, v33
  v_mfma_f32_16x16x32_bf16 v[36:39], v[164:167], v[152:155], v[36:39]
  s_waitcnt lgkmcnt(5)
  v_cvt_pk_bf16_f32 v199, v34, v35
  v_mfma_f32_16x16x32_bf16 v[40:43], v[188:191], v[140:143], v[40:43]
  s_waitcnt lgkmcnt(4)
  v_permlane16_swap_b32 v196, v198
  v_mfma_f32_16x16x32_bf16 v[40:43], v[144:147], v[172:175], v[40:43]
  s_waitcnt lgkmcnt(3)
  v_cvt_pk_bf16_f32 v152, v36, v37
  v_cvt_pk_bf16_f32 v153, v38, v39
  v_mfma_f32_16x16x32_bf16 v[40:43], v[148:151], v[184:187], v[40:43]
  v_permlane16_swap_b32 v197, v199
  v_mfma_f32_16x16x32_bf16 v[44:47], v[128:131], v[140:143], v[44:47]
  buffer_store_dwordx4 v[196:199], v12, s[8:11], s35 offen
  s_nop 1
  s_nop 0
  v_cvt_pk_bf16_f32 v196, v40, v41
  v_mfma_f32_16x16x32_bf16 v[44:47], v[156:159], v[172:175], v[44:47]
  v_cvt_pk_bf16_f32 v197, v42, v43
  v_mfma_f32_16x16x32_bf16 v[44:47], v[132:135], v[184:187], v[44:47]
  v_mfma_f32_16x16x32_bf16 v[48:51], v[160:163], v[140:143], v[48:51]
  v_mfma_f32_16x16x32_bf16 v[48:51], v[168:171], v[172:175], v[48:51]
  v_cvt_pk_bf16_f32 v198, v44, v45
  v_cvt_pk_bf16_f32 v199, v46, v47
  v_mfma_f32_16x16x32_bf16 v[48:51], v[164:167], v[184:187], v[48:51]
  s_waitcnt lgkmcnt(2)
  v_permlane16_swap_b32 v196, v198
  v_mfma_f32_16x16x32_bf16 v[52:55], v[188:191], v[136:139], v[52:55]
  s_waitcnt lgkmcnt(1)
  v_permlane16_swap_b32 v197, v199
  v_mfma_f32_16x16x32_bf16 v[52:55], v[144:147], v[176:179], v[52:55]
  s_waitcnt lgkmcnt(0)
  v_cvt_pk_bf16_f32 v154, v48, v49
  v_cvt_pk_bf16_f32 v155, v50, v51
  v_mfma_f32_16x16x32_bf16 v[52:55], v[148:151], v[200:203], v[52:55]
  v_permlane16_swap_b32 v152, v154
  v_mfma_f32_16x16x32_bf16 v[56:59], v[128:131], v[136:139], v[56:59]
  v_permlane16_swap_b32 v153, v155
  v_mfma_f32_16x16x32_bf16 v[56:59], v[156:159], v[176:179], v[56:59]
  v_cvt_pk_bf16_f32 v156, v52, v53
  v_cvt_pk_bf16_f32 v157, v54, v55
  v_mfma_f32_16x16x32_bf16 v[56:59], v[132:135], v[200:203], v[56:59]
  v_mfma_f32_16x16x32_bf16 v[60:63], v[160:163], v[136:139], v[60:63]
  v_mfma_f32_16x16x32_bf16 v[60:63], v[168:171], v[176:179], v[60:63]
  v_cvt_pk_bf16_f32 v158, v56, v57
  v_cvt_pk_bf16_f32 v159, v58, v59
  v_mfma_f32_16x16x32_bf16 v[60:63], v[164:167], v[200:203], v[60:63]
  v_permlane16_swap_b32 v156, v158
  v_permlane16_swap_b32 v157, v159
  s_nop 5
  v_cvt_pk_bf16_f32 v116, v60, v61
  v_cvt_pk_bf16_f32 v117, v62, v63
  buffer_store_dwordx4 v[196:199], v13, s[8:11], s35 offen
  buffer_store_dwordx4 v[152:155], v22, s[8:11], s35 offen
  buffer_store_dwordx4 v[156:159], v14, s[8:11], s35 offen
  buffer_store_dwordx2 v[116:117], v23, s[8:11], s35 offen
  s_cmp_lt_u32 s31, 21
  s_cbranch_scc1 L_safe_loop
  buffer_load_dwordx4 v[128:131], v15, s[12:15], s77 offen offset:2048
  buffer_load_dwordx4 v[64:67], v15, s[12:15], s75 offen
  buffer_load_dwordx4 v[68:71], v15, s[12:15], s75 offen offset:1024
  buffer_load_dwordx4 v[72:75], v15, s[12:15], s75 offen offset:2048
  ds_read_b128 v[132:135], v18
  ds_read_b128 v[136:139], v18 offset:6144
  ds_read_b128 v[140:143], v18 offset:9216
  ds_read_b128 v[144:147], v18 offset:3072
  ds_read_b128 v[148:151], v18 offset:12288
  buffer_load_dwordx4 v[76:79], v15, s[12:15], s75 offen offset:3072
  ds_read_b128 v[152:155], v18 offset:1024
  ds_read_b128 v[156:159], v18 offset:7168
  ds_read_b128 v[160:163], v18 offset:10240
  ds_read_b128 v[164:167], v18 offset:4096
  ds_read_b128 v[168:171], v18 offset:13312
  buffer_load_dwordx4 v[80:83], v15, s[12:15], s77 offen
  ds_read_b128 v[172:175], v18 offset:2048
  ds_read_b128 v[176:179], v18 offset:8192
  ds_read_b128 v[180:183], v18 offset:11264
  ds_read_b128 v[184:187], v18 offset:5120
  buffer_load_dwordx4 v[84:87], v15, s[12:15], s77 offen offset:1024
  ds_read_b128 v[188:191], v18 offset:14336
  s_waitcnt vmcnt(6)
  ds_read2_b64 v[192:195], v131 offset0:0 offset1:4
  ds_read2_b64 v[196:199], v131 offset0:12 offset1:16
  v_add_u32 v110, 18560, v131
  ds_read2_b64 v[200:203], v131 offset0:24 offset1:28
  ds_read2_b64 v[204:207], v131 offset0:36 offset1:40
  s_waitcnt vmcnt(5) lgkmcnt(3)
  v_mfma_f32_16x16x32_bf16 v[64:67], a[250:253], v[192:195], v[64:67]
  ds_read2_b64 v[208:211], v131 offset0:8 offset1:20
  s_waitcnt lgkmcnt(3)
  v_mfma_f32_16x16x32_bf16 v[64:67], v[132:135], v[196:199], v[64:67]
  ds_read2_b64 v[212:215], v131 offset0:32 offset1:44
  s_waitcnt lgkmcnt(3)
  v_mfma_f32_16x16x32_bf16 v[64:67], v[136:139], v[200:203], v[64:67]
  ds_read2_b64 v[216:219], v110 offset0:0 offset1:4
  s_waitcnt lgkmcnt(3)
  v_mfma_f32_16x16x32_bf16 v[64:67], v[140:143], v[204:207], v[64:67]
  ds_read2_b64 v[220:223], v110 offset0:12 offset1:16
  s_waitcnt lgkmcnt(3)
  v_mfma_f32_16x16x32_bf16 v[64:67], v[144:147], v[208:211], v[64:67]
  ds_read2_b64 v[224:227], v110 offset0:24 offset1:28
  s_waitcnt lgkmcnt(3)
  v_mfma_f32_16x16x32_bf16 v[64:67], v[148:151], v[212:215], v[64:67]
  s_waitcnt vmcnt(4)
  ds_read2_b64 v[228:231], v110 offset0:36 offset1:40
  v_mfma_f32_16x16x32_bf16 v[68:71], v[100:103], v[192:195], v[68:71]
  v_mfma_f32_16x16x32_bf16 v[68:71], v[152:155], v[196:199], v[68:71]
  ds_read2_b64 v[232:235], v110 offset0:8 offset1:20
  v_cvt_pk_bf16_f32 v236, v64, v65
  v_mfma_f32_16x16x32_bf16 v[68:71], v[156:159], v[200:203], v[68:71]
  v_cvt_pk_bf16_f32 v237, v66, v67
  v_mfma_f32_16x16x32_bf16 v[68:71], v[160:163], v[204:207], v[68:71]
  ds_read2_b64 v[240:243], v110 offset0:32 offset1:44
  v_mfma_f32_16x16x32_bf16 v[68:71], v[164:167], v[208:211], v[68:71]
  v_mfma_f32_16x16x32_bf16 v[68:71], v[168:171], v[212:215], v[68:71]
  s_waitcnt vmcnt(3)
  v_mfma_f32_16x16x32_bf16 v[72:75], v[104:107], v[192:195], v[72:75]
  v_mfma_f32_16x16x32_bf16 v[72:75], v[172:175], v[196:199], v[72:75]
  v_cvt_pk_bf16_f32 v238, v68, v69
  v_cvt_pk_bf16_f32 v239, v70, v71
  v_mfma_f32_16x16x32_bf16 v[72:75], v[176:179], v[200:203], v[72:75]
  v_permlane16_swap_b32 v236, v238
  v_mfma_f32_16x16x32_bf16 v[72:75], v[180:183], v[204:207], v[72:75]
  v_permlane16_swap_b32 v237, v239
  v_mfma_f32_16x16x32_bf16 v[72:75], v[184:187], v[208:211], v[72:75]
  buffer_store_dwordx4 v[236:239], v128, s[8:11], 0 offen
  v_mfma_f32_16x16x32_bf16 v[72:75], v[188:191], v[212:215], v[72:75]
  s_waitcnt vmcnt(3) lgkmcnt(5)
  v_mfma_f32_16x16x32_bf16 v[76:79], a[250:253], v[216:219], v[76:79]
  s_waitcnt lgkmcnt(4)
  v_mfma_f32_16x16x32_bf16 v[76:79], v[132:135], v[220:223], v[76:79]
  s_waitcnt lgkmcnt(3)
  v_cvt_pk_bf16_f32 v132, v72, v73
  v_cvt_pk_bf16_f32 v133, v74, v75
  v_mfma_f32_16x16x32_bf16 v[76:79], v[136:139], v[224:227], v[76:79]
  s_waitcnt lgkmcnt(2)
  v_mfma_f32_16x16x32_bf16 v[76:79], v[140:143], v[228:231], v[76:79]
  s_waitcnt lgkmcnt(1)
  v_mfma_f32_16x16x32_bf16 v[76:79], v[144:147], v[232:235], v[76:79]
  s_waitcnt lgkmcnt(0)
  v_mfma_f32_16x16x32_bf16 v[76:79], v[148:151], v[240:243], v[76:79]
  s_waitcnt vmcnt(2)
  v_mfma_f32_16x16x32_bf16 v[80:83], v[100:103], v[216:219], v[80:83]
  v_mfma_f32_16x16x32_bf16 v[80:83], v[152:155], v[220:223], v[80:83]
  v_cvt_pk_bf16_f32 v152, v76, v77
  v_cvt_pk_bf16_f32 v153, v78, v79
  v_mfma_f32_16x16x32_bf16 v[80:83], v[156:159], v[224:227], v[80:83]
  v_mfma_f32_16x16x32_bf16 v[80:83], v[160:163], v[228:231], v[80:83]
  v_mfma_f32_16x16x32_bf16 v[80:83], v[164:167], v[232:235], v[80:83]
  v_mfma_f32_16x16x32_bf16 v[80:83], v[168:171], v[240:243], v[80:83]
  s_waitcnt vmcnt(1)
  v_mfma_f32_16x16x32_bf16 v[84:87], v[104:107], v[216:219], v[84:87]
  v_mfma_f32_16x16x32_bf16 v[84:87], v[172:175], v[220:223], v[84:87]
  v_cvt_pk_bf16_f32 v154, v80, v81
  v_cvt_pk_bf16_f32 v155, v82, v83
  v_mfma_f32_16x16x32_bf16 v[84:87], v[176:179], v[224:227], v[84:87]
  v_permlane16_swap_b32 v152, v154
  v_mfma_f32_16x16x32_bf16 v[84:87], v[180:183], v[228:231], v[84:87]
  v_permlane16_swap_b32 v153, v155
  v_mfma_f32_16x16x32_bf16 v[84:87], v[184:187], v[232:235], v[84:87]
  buffer_store_dwordx4 v[152:155], v129, s[8:11], 0 offen
  v_mfma_f32_16x16x32_bf16 v[84:87], v[188:191], v[240:243], v[84:87]
  s_nop 7
  v_cvt_pk_bf16_f32 v134, v84, v85
  v_cvt_pk_bf16_f32 v135, v86, v87
  s_nop 0
  v_permlane16_swap_b32 v132, v134
  v_permlane16_swap_b32 v133, v135
  buffer_store_dwordx4 v[132:135], v130, s[8:11], 0 offen
L_exit:
  s_endpgm
.section .rodata,"a"
.p2align 6
.amdhsa_kernel standalone__window_attn_davit__vision_kernel
  .amdhsa_next_free_vgpr 512
  .amdhsa_next_free_sgpr 102
  .amdhsa_accum_offset 256
  .amdhsa_group_segment_fixed_size 0
  .amdhsa_kernarg_size 56
  .amdhsa_user_sgpr_count 2
  .amdhsa_user_sgpr_kernarg_segment_ptr 1
  .amdhsa_system_sgpr_workgroup_id_x 1
.end_amdhsa_kernel
```

```asm
; @launch grid=(256,1,1) block=(256,1,1) lds=163840
.amdgcn_target "amdgcn-amd-amdhsa--gfx950"
.text
.globl standalone__window_attn_davit__vision_kernel
.p2align 8
.type standalone__window_attn_davit__vision_kernel,@function
standalone__window_attn_davit__vision_kernel:
  s_cmp_ge_u32 s2, 256
  s_cbranch_scc1 L_exit
  s_load_dwordx8 s[84:91], s[0:1], 0
  s_load_dwordx2 s[92:93], s[0:1], 32
  s_load_dwordx2 s[94:95], s[0:1], 48
  v_lshrrev_b32 v1, 6, v0
  s_and_b32 s60, s2, 7
  s_lshr_b32 s30, s2, 3
  v_readfirstlane_b32 s28, v1
  v_and_b32 v220, 63, v0
  s_mul_i32 s29, s60, 667
  s_add_u32 s29, s29, s30
  s_lshl_b32 s69, s30, 2
  s_add_u32 s69, s69, s28
  s_getpc_b64 s[96:97]
  L_pc:
  s_lshl_b32 s70, s69, 7
  s_add_u32 s70, s96, s70
  s_addc_u32 s71, s97, 0
  v_min_u32 v224, 1, v220
  v_lshlrev_b32 v224, 6, v224
  global_load_dword v25, v224, s[70:71]
  s_mul_i32 s74, s28, 96
  s_lshl_b32 s76, s28, 10
  s_mov_b64 s[48:49], 0x3f
  s_mov_b32 s50, 0
  s_mov_b32 s51, 0x3f0000
  s_mul_i32 s58, s28, 7936
  s_add_u32 s58, s58, 132096
  s_add_u32 s59, s58, 4320
  s_mov_b32 s31, 0
  s_mul_i32 s82, s28, 15360
  s_add_u32 s82, s82, 78080
  s_add_u32 s83, s82, 4320
  s_sub_u32 s32, s58, s82
  v_mul_u32_u24 v223, 43, v220
  v_lshrrev_b32 v223, 8, v223
  v_mul_u32_u24 v224, 6, v223
  v_sub_u32 v224, v220, v224
  v_lshl_add_u32 v224, v224, 4, s74
  v_cmp_gt_u32 vcc, 54, v220
  v_mul_u32_u24 v225, 384, v223
  v_add_u32 v224, v224, v225
  v_cndmask_b32 v21, 2.0, v224, vcc
  s_lshl_b32 s60, s31, 5
  s_add_u32 s61, s60, s30
  s_add_u32 s60, s60, s29
  s_mul_i32 s62, s60, 7183
  s_lshr_b32 s62, s62, 22
  s_mul_i32 s63, s62, 584
  s_sub_u32 s63, s60, s63
  s_lshr_b32 s64, s63, 3
  s_and_b32 s65, s63, 7
  s_lshl_b32 s66, s62, 3
  s_add_u32 s65, s65, s66
  s_cmp_ge_u32 s60, 5256
  s_cselect_b32 s64, s63, s64
  s_cselect_b32 s65, 72, s65
  s_mul_i32 s66, s65, 1373568
  s_mul_i32 s67, s64, 2688
  s_add_u32 s35, s66, s67
  s_cmp_ge_u32 s61, 667
  s_cselect_b32 s35, 268435456, s35
  s_cmp_ge_u32 s60, 5329
  s_cselect_b32 s35, 268435456, s35
  s_cmp_eq_u32 s65, 0
  s_cselect_b32 s36, 268435456, s35
  s_add_u32 s37, s35, 195360
  s_add_u32 s38, s35, 390720
  s_add_u32 s39, s35, 586080
  s_add_u32 s40, s35, 781440
  s_add_u32 s41, s35, 981120
  s_add_u32 s42, s35, 1176480
  s_add_u32 s43, s35, 1371840
  s_add_u32 s44, s35, 1567200
  s_cmp_eq_u32 s64, 0
  s_cselect_b64 s[52:53], s[48:49], 0
  s_cmp_eq_u32 s64, 72
  s_cselect_b64 s[52:53], s[50:51], s[52:53]
  s_add_u32 s31, s31, 1
  v_cndmask_b32 v226, v21, 2.0, s[52:53]
  s_mov_b32 s33, s35
  s_mov_b32 s26, 3456
  s_mov_b32 s27, 0x20000
  s_add_u32 m0, s76, 8192
  s_mov_b32 s6, 100467072
  s_mov_b32 s7, 0x20000
  s_waitcnt lgkmcnt(0)
  s_mov_b32 s24, s86
  s_mov_b32 s25, s87
  s_sub_u32 s4, s84, 196608
  s_subb_u32 s5, s85, 0
  buffer_load_dwordx4 v21, s[24:27], 0 offen lds
  s_mov_b32 m0, s82
  s_nop 0
  buffer_load_dwordx4 v226, s[4:7], s36 offen lds
  buffer_load_dwordx4 v226, s[4:7], s37 offen offset:864 lds
  buffer_load_dwordx4 v226, s[4:7], s38 offen offset:1728 lds
  buffer_load_dwordx4 v226, s[4:7], s39 offen offset:2592 lds
  buffer_load_dwordx4 v226, s[4:7], s40 offen offset:3456 lds
  s_mov_b32 m0, s83
  s_nop 0
  buffer_load_dwordx4 v226, s[4:7], s41 offen lds
  buffer_load_dwordx4 v226, s[4:7], s42 offen offset:864 lds
  buffer_load_dwordx4 v226, s[4:7], s43 offen offset:1728 lds
  buffer_load_dwordx4 v226, s[4:7], s44 offen offset:2592 lds
  v_mul_u32_u24 v223, 11, v223
  v_lshrrev_b32 v223, 5, v223
  v_mul_u32_u24 v223, 195072, v223
  v_add_u32 v224, 589824, v224
  v_add_u32 v224, v224, v223
  v_cndmask_b32 v242, 2.0, v224, vcc
  s_mov_b32 s16, s88
  s_mov_b32 s17, s89
  s_mov_b32 s18, 221184
  s_mov_b32 s19, 0x20000
  s_mov_b32 s20, s90
  s_mov_b32 s21, s91
  s_mov_b32 s22, 73728
  s_mov_b32 s23, 0x20000
  s_mov_b32 s8, s92
  s_mov_b32 s9, s93
  s_mov_b32 s10, 100270464
  s_mov_b32 s11, 0x20000
  s_mov_b32 s12, s94
  s_mov_b32 s13, s95
  s_mov_b32 s14, 16777216
  s_mov_b32 s15, 0x20000
  s_mov_b32 s24, s84
  s_mov_b32 s25, s85
  s_mov_b32 s26, 100270464
  s_mov_b64 s[0:1], s[96:97]
  s_mov_b32 s72, 667
  s_mov_b32 s73, 5329
  s_mul_i32 s81, s28, 3072
  s_add_u32 s81, s81, 20480
  s_mul_i32 s3, s28, 4608
  s_add_u32 s3, s3, 38912
  v_lshlrev_b32 v223, 6, v220
  v_cmp_gt_u32 vcc, 27, v220
  s_mul_i32 s70, s69, 1728
  s_mul_i32 s71, s69, 576
  v_add_u32 v224, s70, v223
  v_cndmask_b32 v232, 2.0, v224, vcc
  v_cmp_gt_u32 vcc, 9, v220
  v_add_u32 v224, s71, v223
  buffer_load_dword v25, v232, s[16:19], 0 offen
  v_cndmask_b32 v233, 2.0, v224, vcc
  s_mul_i32 s70, s28, 15360
  s_add_u32 s70, s70, 70656
  v_add_u32 v223, 0, v220
  v_lshlrev_b32 v223, 5, v223
  v_add_u32 v224, s30, v223
  v_cmp_gt_u32 s[60:61], s72, v224
  v_add_u32 v223, s29, v223
  v_cmp_gt_u32 s[62:63], s73, v223
  v_mul_u32_u24 v224, 7183, v223
  v_lshrrev_b32 v224, 22, v224
  s_and_b64 s[60:61], s[60:61], s[62:63]
  v_mul_u32_u24 v225, 584, v224
  v_sub_u32 v225, v223, v225
  v_cmp_le_u32 vcc, 5256, v223
  v_and_b32 v254, 7, v225
  v_lshl_add_u32 v224, v224, 3, v254
  v_mov_b32 v254, 72
  v_cndmask_b32 v224, v224, v254, vcc
  v_lshrrev_b32 v254, 3, v225
  v_cndmask_b32 v225, v254, v225, vcc
  v_mul_u32_u24 v224, 1373568, v224
  v_mul_u32_u24 v225, 2688, v225
  v_add_u32 v254, v224, v225
  v_cndmask_b32 v254, 2.0, v254, s[60:61]
  s_lshl_b32 s60, s31, 5
  s_add_u32 s61, s60, s30
  s_add_u32 s60, s60, s29
  s_mul_i32 s62, s60, 7183
  s_lshr_b32 s62, s62, 22
  s_mul_i32 s63, s62, 584
  s_sub_u32 s63, s60, s63
  s_lshr_b32 s64, s63, 3
  s_and_b32 s65, s63, 7
  s_lshl_b32 s66, s62, 3
  s_add_u32 s65, s65, s66
  s_cmp_ge_u32 s60, 5256
  s_cselect_b32 s64, s63, s64
  s_cselect_b32 s65, 72, s65
  s_mul_i32 s66, s65, 1373568
  s_mul_i32 s67, s64, 2688
  s_add_u32 s35, s66, s67
  s_cmp_ge_u32 s61, 667
  s_cselect_b32 s35, 268435456, s35
  s_cmp_ge_u32 s60, 5329
  s_cselect_b32 s35, 268435456, s35
  s_cmp_eq_u32 s65, 0
  s_cselect_b32 s36, 268435456, s35
  s_add_u32 s37, s35, 195360
  s_add_u32 s38, s35, 390720
  s_add_u32 s39, s35, 586080
  s_add_u32 s40, s35, 781440
  s_add_u32 s41, s35, 981120
  s_add_u32 s42, s35, 1176480
  s_add_u32 s43, s35, 1371840
  s_add_u32 s44, s35, 1567200
  s_cmp_eq_u32 s64, 0
  s_cselect_b64 s[52:53], s[48:49], 0
  s_cmp_eq_u32 s64, 72
  s_cselect_b64 s[52:53], s[50:51], s[52:53]
  s_add_u32 s31, s31, 1
  s_mov_b32 s34, s35
  s_mov_b32 s46, 0xffff0000
  s_mov_b32 s47, 0xffff
  v_cndmask_b32 v234, v21, 2.0, s[52:53]
  v_readlane_b32 s98, v254, 0
  v_add_u32 v223, 0, v220
  v_mul_u32_u24 v224, 171, v223
  v_lshrrev_b32 v224, 10, v224
  v_mul_u32_u24 v225, 6, v224
  v_sub_u32 v225, v223, v225
  v_lshl_add_u32 v225, v225, 4, s74
  s_add_u32 m0, s3, 0
  s_nop 0
  buffer_load_dwordx4 v242, s[4:7], s98 offen lds
  v_subrev_u32 v225, 0, v225
  v_mul_u32_u24 v223, 1152, v224
  v_add_u32 v243, v223, v225
  v_mul_u32_u24 v223, 384, v224
  v_add_u32 v251, v223, v225
  v_add_u32 v223, 64, v220
  v_mul_u32_u24 v224, 171, v223
  v_lshrrev_b32 v224, 10, v224
  v_mul_u32_u24 v225, 6, v224
  v_sub_u32 v225, v223, v225
  v_lshl_add_u32 v225, v225, 4, s74
  v_readlane_b32 s98, v254, 1
  v_subrev_u32 v225, 1024, v225
  v_mul_u32_u24 v223, 1152, v224
  v_add_u32 v244, v223, v225
  v_mul_u32_u24 v223, 384, v224
  v_add_u32 v252, v223, v225
  v_add_u32 v223, 128, v220
  s_add_u32 m0, s3, 864
  s_nop 0
  buffer_load_dwordx4 v242, s[4:7], s98 offen lds
  v_mul_u32_u24 v224, 171, v223
  v_lshrrev_b32 v224, 10, v224
  v_mul_u32_u24 v225, 6, v224
  v_sub_u32 v225, v223, v225
  v_lshl_add_u32 v225, v225, 4, s74
  v_subrev_u32 v225, 2048, v225
  v_mul_u32_u24 v223, 1152, v224
  v_add_u32 v245, v223, v225
  v_mul_u32_u24 v223, 384, v224
  v_add_u32 v253, v223, v225
  s_mov_b32 s54, 0xffff
  v_readlane_b32 s98, v254, 2
  s_mov_b32 s55, 0
  s_mov_b32 s56, -1
  s_mov_b32 s57, 0
  s_mul_i32 s75, s2, 65536
  s_mul_i32 s77, s28, 12288
  s_add_u32 s75, s75, s77
  s_add_u32 m0, s3, 1728
  s_nop 0
  buffer_load_dwordx4 v242, s[4:7], s98 offen lds
  s_add_u32 s77, s75, 4096
  s_add_u32 s78, s75, 8192
  s_mov_b32 s79, 0x4310
  s_mov_b32 s80, 0x5276
  v_lshrrev_b32 v221, 4, v220
  v_and_b32 v222, 15, v220
  v_and_b32 v223, 3, v220
  v_mul_u32_u24 v0, 0x5555, v223
  v_mov_b32 v1, 0
  v_mov_b32 v223, 0xff800000
  v_readlane_b32 s98, v254, 3
  v_cndmask_b32 v2, v223, 0, s[54:55]
  v_mov_b32 v123, 0
  v_mov_b32 v127, 0
  v_lshrrev_b32 v219, 1, v221
  v_and_b32 v226, 1, v221
  v_cmp_eq_u32 s[94:95], 1, v226
  s_add_u32 m0, s3, 2592
  s_nop 0
  buffer_load_dwordx4 v242, s[4:7], s98 offen lds
  v_lshlrev_b32 v226, 4, v226
  v_lshlrev_b32 v218, 4, v219
  v_lshl_add_u32 v218, v226, 1, v218
  v_add_u32 v218, s74, v218
  v_mov_b32 v223, 0x03020100
  v_cmp_le_u32 vcc, 4, v222
  v_mov_b32 v224, 0x13121110
  s_nop 0
  v_cndmask_b32 v223, v223, v224, vcc
  v_cmp_le_u32 vcc, 8, v222
  v_readlane_b32 s98, v254, 4
  v_mov_b32 v224, 0x26251514
  v_cndmask_b32 v223, v223, v224, vcc
  v_cmp_le_u32 vcc, 12, v222
  v_mov_b32 v224, 0x16060504
  s_nop 0
  v_cndmask_b32 v223, v223, v224, vcc
  v_and_b32 v224, 3, v222
  s_add_u32 m0, s3, 3456
  s_nop 0
  buffer_load_dwordx4 v242, s[4:7], s98 offen lds
  v_lshlrev_b32 v224, 3, v224
  v_bfe_u32 v223, v223, v224, 8
  v_lshrrev_b32 v224, 4, v223
  v_and_b32 v223, 15, v223
  v_mul_u32_u24 v12, 196224, v224
  v_mul_u32_u24 v225, 384, v223
  v_add3_u32 v12, v12, v225, v218
  v_mul_u32_u24 v224, 9, v224
  v_add_u32 v223, v223, v224
  v_mul_u32_u24 v223, 96, v223
  v_add_u32 v223, s82, v223
  v_mul_u32_u24 v224, 96, v219
  v_add3_u32 v3, v223, v224, v226
  v_mul_u32_u24 v224, 864, v219
  v_add3_u32 v6, v223, v224, v226
  v_add_u32 v6, 192, v6
  v_lshl_add_u32 v9, v221, 3, v223
  v_add_u32 v9, 1920, v9
  v_mov_b32 v223, 0x23222120
  v_cmp_le_u32 vcc, 4, v222
  v_mov_b32 v224, 0x42323130
  s_nop 0
  v_cndmask_b32 v223, v223, v224, vcc
  v_cmp_le_u32 vcc, 8, v222
  v_mov_b32 v224, 0x46454443
  s_nop 0
  v_cndmask_b32 v223, v223, v224, vcc
  v_cmp_le_u32 vcc, 12, v222
  v_mov_b32 v224, 0x36353424
  s_nop 0
  v_cndmask_b32 v223, v223, v224, vcc
  v_and_b32 v224, 3, v222
  v_lshlrev_b32 v224, 3, v224
  v_bfe_u32 v223, v223, v224, 8
  v_lshrrev_b32 v224, 4, v223
  v_and_b32 v223, 15, v223
  v_mul_u32_u24 v13, 196224, v224
  v_mul_u32_u24 v225, 384, v223
  v_add3_u32 v13, v13, v225, v218
  v_mul_u32_u24 v224, 9, v224
  v_add_u32 v223, v223, v224
  v_mul_u32_u24 v223, 96, v223
  v_add_u32 v223, s82, v223
  v_mul_u32_u24 v224, 96, v219
  v_add3_u32 v4, v223, v224, v226
  v_mul_u32_u24 v224, 864, v219
  v_add3_u32 v7, v223, v224, v226
  v_add_u32 v7, 192, v7
  v_lshl_add_u32 v10, v221, 3, v223
  v_add_u32 v10, 1920, v10
  v_mov_b32 v223, 0x52514140
  v_cmp_le_u32 vcc, 4, v222
  v_mov_b32 v224, 0x62616050
  s_nop 0
  v_cndmask_b32 v223, v223, v224, vcc
  v_cmp_le_u32 vcc, 8, v222
  v_mov_b32 v224, 0x66656463
  s_nop 0
  v_cndmask_b32 v223, v223, v224, vcc
  v_cmp_le_u32 vcc, 12, v222
  v_mov_b32 v224, 0x56555453
  s_nop 0
  v_cndmask_b32 v223, v223, v224, vcc
  v_and_b32 v224, 3, v222
  v_lshlrev_b32 v224, 3, v224
  v_bfe_u32 v223, v223, v224, 8
  v_lshrrev_b32 v224, 4, v223
  v_and_b32 v223, 15, v223
  v_mul_u32_u24 v14, 196224, v224
  v_mul_u32_u24 v225, 384, v223
  v_add3_u32 v23, v14, v225, s74
  v_lshl_add_u32 v23, v221, 3, v23
  v_add_u32 v23, 64, v23
  v_add3_u32 v14, v14, v225, v218
  v_mul_u32_u24 v224, 9, v224
  v_add_u32 v223, v223, v224
  v_mul_u32_u24 v223, 96, v223
  v_add_u32 v223, s82, v223
  v_mul_u32_u24 v224, 96, v219
  v_add3_u32 v5, v223, v224, v226
  v_mul_u32_u24 v224, 864, v219
  v_add3_u32 v8, v223, v224, v226
  v_add_u32 v8, 192, v8
  v_lshl_add_u32 v11, v221, 3, v223
  v_add_u32 v11, 1920, v11
  v_add_u32 v223, 64, v12
  v_add_u32 v224, 32, v13
  v_cndmask_b32 v22, v223, v224, s[94:95]
  v_lshlrev_b32 v15, 4, v220
  v_add_u32 v16, s76, v15
  s_lshr_b32 s60, s28, 1
  s_add_u32 s60, s60, 4
  s_lshl_b32 s60, s60, 10
  s_and_b32 s61, s28, 1
  s_lshl_b32 s61, s61, 3
  s_add_u32 s60, s60, s61
  v_add_u32 v17, s60, v15
  s_mul_i32 s60, s28, 15360
  s_add_u32 s60, s60, 70656
  v_add_u32 v18, s60, v15
  v_add_u32 v223, v226, v222
  v_lshlrev_b32 v224, 10, v219
  v_lshl_add_u32 v111, v223, 4, v224
  s_lshl_b32 s60, s28, 2
  v_add_u32 v111, s60, v111
  v_lshlrev_b32 v115, 3, v220
  v_add_u32 v115, 69632, v115
  v_lshlrev_b32 v119, 3, v222
  v_add_u32 v119, 69632, v119
  v_mul_u32_u24 v223, 864, v222
  v_add_u32 v223, s3, v223
  s_sub_u32 s71, s70, s3
  v_mul_u32_u24 v224, 96, v219
  v_add3_u32 v239, v223, v224, v226
  v_mul_u32_u24 v224, 288, v219
  v_add3_u32 v240, v223, v224, v226
  v_add_u32 v240, 192, v240
  v_lshl_add_u32 v241, v221, 3, v223
  v_add_u32 v241, 768, v241
  s_add_u32 s60, s76, 8192
  v_lshl_add_u32 v223, v222, 1, s60
  v_lshlrev_b32 v224, 2, v221
  v_lshrrev_b32 v225, v224, s79
  v_and_b32 v225, 15, v225
  v_mul_u32_u24 v225, 96, v225
  v_add_u32 v236, v223, v225
  v_lshrrev_b32 v225, v224, s80
  v_and_b32 v225, 15, v225
  v_mul_u32_u24 v225, 96, v225
  v_add_u32 v237, v223, v225
  v_add_u32 v238, 768, v223
  v_lshrrev_b32 v223, 2, v220
  v_mul_u32_u24 v223, 96, v223
  v_and_b32 v224, 3, v220
  v_lshl_add_u32 v223, v224, 3, v223
  v_add_u32 v246, s81, v223
  v_add_u32 v255, s70, v223
  v_lshrrev_b32 v223, 2, v222
  v_cmp_eq_u32 s[82:83], 0, v223
  v_cmp_eq_u32 s[84:85], 1, v223
  v_cmp_eq_u32 s[86:87], 2, v223
  v_cmp_eq_u32 s[88:89], 3, v223
  v_cmp_eq_u32 s[90:91], 3, v221
  v_cmp_eq_u32 s[92:93], v223, v221
  v_and_b32 v223, 2, v222
  v_cmp_eq_u32 s[96:97], 0, v223
  v_and_b32 v235, 1, v222
  v_lshlrev_b32 v235, 4, v235
  s_waitcnt vmcnt(15)
  ds_read_u16 v232, v238
  ds_read_u16 v110, v238 offset:32
  ds_read_u16 v114, v238 offset:64
  s_waitcnt vmcnt(10)
  ds_read_b64 v[108:109], v9
  ds_read_b64 v[112:113], v9 offset:32
  s_waitcnt vmcnt(8)
  s_mov_b32 m0, s58
  ds_read_u16 v238, v236
  ds_read_b64 v[116:117], v9 offset:64
  buffer_load_dwordx4 v234, s[4:7], s36 offen lds
  s_mov_b32 m0, s58
  ds_read_u16 v118, v237
  ds_read_b128 v[128:131], v3
  s_waitcnt lgkmcnt(8)
  ds_read_b128 v[132:135], v3 offset:864
  v_lshlrev_b32 v232, v235, v232
  ds_read_u16 v122, v236 offset:32
  ds_read_b128 v[136:139], v3 offset:1728
  v_cndmask_b32 v232, 0, v232, s[92:93]
  ds_read_b128 v[140:143], v6
  v_cndmask_b32 v126, 0, v232, s[96:97]
  ds_read_u16 v219, v237 offset:32
  ds_read_b128 v[144:147], v3 offset:32
  buffer_load_dwordx4 v234, s[4:7], s37 offen offset:864 lds
  s_mov_b32 m0, s58
  ds_read_b128 v[148:151], v3 offset:896
  v_cndmask_b32 v223, v232, 0, s[96:97]
  ds_read_u16 v232, v236 offset:64
  ds_read_b128 v[152:155], v3 offset:1760
  s_waitcnt lgkmcnt(15)
  ds_read_b128 v[156:159], v6 offset:32
  v_lshlrev_b32 v110, v235, v110
  ds_read_u16 v247, v237 offset:64
  ds_read_b128 v[160:163], v3 offset:64
  v_accvgpr_write_b32 a224, v126
  ds_read_b128 v[164:167], v3 offset:928
  buffer_load_dwordx4 v234, s[4:7], s38 offen offset:1728 lds
  ds_read_b128 v[168:171], v3 offset:1792
  s_mov_b32 m0, s58
  ds_read_b128 v[172:175], v6 offset:64
  v_accvgpr_write_b32 a225, v223
  v_cndmask_b32 v110, 0, v110, s[92:93]
  s_waitcnt lgkmcnt(15)
  v_mfma_f32_16x16x16_bf16 v[28:31], a[224:225], v[108:109], 0
  ds_read_b64 v[108:109], v10
  ds_read_b64 v[236:237], v10 offset:32
  v_lshlrev_b32 v114, v235, v114
  ds_read_b64 v[120:121], v10 offset:64
  v_cndmask_b32 v235, 0, v110, s[96:97]
  v_cndmask_b32 v223, v110, 0, s[96:97]
  v_cndmask_b32 v114, 0, v114, s[92:93]
  v_accvgpr_write_b32 a234, v235
  buffer_load_dwordx4 v234, s[4:7], s39 offen offset:2592 lds
  s_mov_b32 m0, s58
  v_accvgpr_write_b32 a235, v223
  v_cndmask_b32 v223, 0, 1.0, s[90:91]
  v_cndmask_b32 v235, 0, v114, s[96:97]
  v_mfma_f32_16x16x16_bf16 v[32:35], a[234:235], v[112:113], 0
  ds_read_b128 v[176:179], v4
  ds_read_b128 v[180:183], v4 offset:864
  v_cndmask_b32 v110, v114, 0, s[96:97]
  v_or_b32 v238, v238, v223
  v_accvgpr_write_b32 a244, v235
  v_accvgpr_write_b32 a245, v110
  v_cndmask_b32 v110, 0, v238, s[82:83]
  v_cndmask_b32 v235, 0, v238, s[84:85]
  v_mfma_f32_16x16x16_bf16 v[36:39], a[244:245], v[116:117], 0
  ds_read_b128 v[184:187], v4 offset:1728
  ds_read_b128 v[188:191], v7
  v_cndmask_b32 v223, 0, v238, s[86:87]
  v_cndmask_b32 v114, 0, v238, s[88:89]
  v_accvgpr_write_b32 a216, v110
  buffer_load_dwordx4 v234, s[4:7], s40 offen offset:3456 lds
  s_mov_b32 m0, s59
  v_accvgpr_write_b32 a217, v235
  v_accvgpr_write_b32 a218, v223
  v_accvgpr_write_b32 a219, v114
  v_cndmask_b32 v114, 0, 1.0, s[90:91]
  s_waitcnt lgkmcnt(15)
  v_smfmac_f32_16x16x64_bf16 v[28:31], a[216:219], v[128:135], v0
  s_waitcnt lgkmcnt(11)
  ds_read_b128 v[128:131], v4 offset:32
  ds_read_b128 v[132:135], v4 offset:896
  v_cndmask_b32 v223, 0, v118, s[82:83]
  v_cndmask_b32 v235, 0, v118, s[84:85]
  v_cndmask_b32 v110, 0, v118, s[86:87]
  v_cndmask_b32 v238, 0, v118, s[88:89]
  v_or_b32 v122, v122, v114
  v_accvgpr_write_b32 a220, v223
  v_accvgpr_write_b32 a221, v235
  v_accvgpr_write_b32 a222, v110
  v_accvgpr_write_b32 a223, v238
  v_cndmask_b32 v238, 0, v122, s[82:83]
  v_cndmask_b32 v110, 0, v122, s[84:85]
  v_smfmac_f32_16x16x64_bf16 v[28:31], a[220:223], v[136:143], v0
  ds_read_b128 v[136:139], v4 offset:1760
  ds_read_b128 v[140:143], v7 offset:32
  buffer_load_dwordx4 v234, s[4:7], s41 offen lds
  s_mov_b32 m0, s59
  v_cndmask_b32 v235, 0, v122, s[86:87]
  v_cndmask_b32 v223, 0, v122, s[88:89]
  v_accvgpr_write_b32 a226, v238
  v_accvgpr_write_b32 a227, v110
  v_accvgpr_write_b32 a228, v235
  v_accvgpr_write_b32 a229, v223
  v_cndmask_b32 v223, 0, 1.0, s[90:91]
  v_cndmask_b32 v235, 0, v219, s[82:83]
  v_smfmac_f32_16x16x64_bf16 v[32:35], a[226:229], v[144:151], v0
  ds_read_b128 v[144:147], v4 offset:64
  ds_read_b128 v[148:151], v4 offset:928
  v_cndmask_b32 v110, 0, v219, s[84:85]
  v_cndmask_b32 v238, 0, v219, s[86:87]
  v_cndmask_b32 v122, 0, v219, s[88:89]
  v_or_b32 v232, v232, v223
  v_accvgpr_write_b32 a230, v235
  v_accvgpr_write_b32 a231, v110
  v_accvgpr_write_b32 a232, v238
  v_accvgpr_write_b32 a233, v122
  v_cndmask_b32 v122, 0, v232, s[82:83]
  v_cndmask_b32 v238, 0, v232, s[84:85]
  v_smfmac_f32_16x16x64_bf16 v[32:35], a[230:233], v[152:159], v0
  s_waitcnt lgkmcnt(15)
  ds_read_b128 v[152:155], v4 offset:1792
  ds_read_b128 v[156:159], v7 offset:64
  buffer_load_dwordx4 v234, s[4:7], s42 offen offset:864 lds
  s_mov_b32 m0, s59
  v_cndmask_b32 v110, 0, v232, s[86:87]
  v_cndmask_b32 v235, 0, v232, s[88:89]
  v_accvgpr_write_b32 a236, v122
  v_accvgpr_write_b32 a237, v238
  v_accvgpr_write_b32 a238, v110
  v_accvgpr_write_b32 a239, v235
  v_cndmask_b32 v235, 0, v247, s[82:83]
  v_cndmask_b32 v110, 0, v247, s[84:85]
  v_smfmac_f32_16x16x64_bf16 v[36:39], a[236:239], v[160:167], v0
  s_waitcnt vmcnt(13) lgkmcnt(15)
  ds_read_b64 v[116:117], v11
  v_cndmask_b32 v238, 0, v247, s[86:87]
  v_cndmask_b32 v122, 0, v247, s[88:89]
  v_accvgpr_write_b32 a240, v235
  v_accvgpr_write_b32 a241, v110
  v_accvgpr_write_b32 a242, v238
  v_accvgpr_write_b32 a243, v122
  v_mul_f32 v247, v28, v28
  v_add_f32 v223, v28, v29
  v_smfmac_f32_16x16x64_bf16 v[36:39], a[240:243], v[168:175], v0
  s_waitcnt lgkmcnt(11)
  ds_read_b64 v[112:113], v11 offset:32
  buffer_load_dwordx4 v234, s[4:7], s43 offen offset:1728 lds
  v_mfma_f32_16x16x16_bf16 v[40:43], a[224:225], v[108:109], 0
  ds_read_b64 v[108:109], v11 offset:64
  v_fmac_f32 v247, v29, v29
  v_add_f32 v223, v223, v30
  v_mfma_f32_16x16x16_bf16 v[44:47], a[234:235], v[236:237], 0
  v_fmac_f32 v247, v30, v30
  v_add_f32 v223, v223, v31
  v_fmac_f32 v247, v31, v31
  v_mfma_f32_16x16x16_bf16 v[48:51], a[244:245], v[120:121], 0
  v_add_f32 v223, v223, v32
  v_fmac_f32 v247, v32, v32
  v_add_f32 v223, v223, v33
  v_fmac_f32 v247, v33, v33
  v_smfmac_f32_16x16x64_bf16 v[40:43], a[216:219], v[176:183], v0
  s_waitcnt lgkmcnt(11)
  ds_read_b128 v[176:179], v5
  ds_read_b128 v[180:183], v5 offset:864
  v_smfmac_f32_16x16x64_bf16 v[40:43], a[220:223], v[184:191], v0
  s_waitcnt lgkmcnt(11)
  ds_read_b128 v[184:187], v5 offset:1728
  v_add_f32 v223, v223, v34
  v_smfmac_f32_16x16x64_bf16 v[44:47], a[226:229], v[128:135], v0
  s_waitcnt lgkmcnt(10)
  ds_read_b128 v[188:191], v8
  v_fmac_f32 v247, v34, v34
  v_smfmac_f32_16x16x64_bf16 v[44:47], a[230:233], v[136:143], v0
  s_waitcnt lgkmcnt(9)
  ds_read_b128 v[136:139], v5 offset:32
  v_mul_f32 v122, v40, v40
  v_smfmac_f32_16x16x64_bf16 v[48:51], a[236:239], v[144:151], v0
  s_waitcnt lgkmcnt(8)
  ds_read_b128 v[140:143], v5 offset:896
  v_add_f32 v238, v40, v41
  v_smfmac_f32_16x16x64_bf16 v[48:51], a[240:243], v[152:159], v0
  s_waitcnt vmcnt(8) lgkmcnt(6)
  ds_read_b128 v[152:155], v5 offset:1760
  v_fmac_f32 v122, v41, v41
  v_add_f32 v238, v238, v42
  v_mfma_f32_16x16x16_bf16 v[52:55], a[224:225], v[116:117], 0
  v_fmac_f32 v122, v42, v42
  v_add_f32 v238, v238, v43
  v_fmac_f32 v122, v43, v43
  v_mfma_f32_16x16x16_bf16 v[56:59], a[234:235], v[112:113], 0
  v_add_f32 v238, v238, v44
  v_fmac_f32 v122, v44, v44
  v_add_f32 v238, v238, v45
  v_mfma_f32_16x16x16_bf16 v[60:63], a[244:245], v[108:109], 0
  s_mov_b32 m0, s59
  ds_read_b128 v[156:159], v8 offset:32
  ds_read_b128 v[144:147], v5 offset:64
  s_waitcnt lgkmcnt(7)
  v_smfmac_f32_16x16x64_bf16 v[52:55], a[216:219], v[176:183], v0
  s_waitcnt lgkmcnt(5)
  ds_read_b128 v[148:151], v5 offset:928
  v_fmac_f32 v122, v45, v45
  v_smfmac_f32_16x16x64_bf16 v[52:55], a[220:223], v[184:191], v0
  s_waitcnt lgkmcnt(4)
  ds_read_b128 v[184:187], v5 offset:1792
  v_add_f32 v238, v238, v46
  v_smfmac_f32_16x16x64_bf16 v[56:59], a[226:229], v[136:143], v0
  s_waitcnt lgkmcnt(4)
  ds_read_b128 v[188:191], v8 offset:64
  ds_read_b64 v[108:109], v241
  buffer_load_dwordx4 v234, s[4:7], s44 offen offset:2592 lds
  ds_read_b64 v[112:113], v241 offset:32
  buffer_load_dword v25, v233, s[20:23], 0 offen
  s_waitcnt lgkmcnt(6)
  v_smfmac_f32_16x16x64_bf16 v[56:59], a[230:233], v[152:159], v0
  s_add_u32 m0, s81, 0
  ds_read_b64 v[116:117], v241 offset:64
  s_mov_b32 s98, 0
  ds_read_b128 v[152:155], v239
  v_mul_f32 v110, v52, v52
  v_add_f32 v219, v52, v53
  s_waitcnt lgkmcnt(6)
  v_smfmac_f32_16x16x64_bf16 v[60:63], a[236:239], v[144:151], v0
  ds_read_b128 v[156:159], v239 offset:288
  ds_read_b128 v[144:147], v239 offset:576
  v_fmac_f32 v110, v53, v53
  v_add_f32 v219, v219, v54
  s_waitcnt lgkmcnt(6)
  v_smfmac_f32_16x16x64_bf16 v[60:63], a[240:243], v[184:191], v0
  ds_read_b128 v[148:151], v240
  v_fmac_f32 v110, v54, v54
  s_waitcnt lgkmcnt(6)
  v_mfma_f32_16x16x16_bf16 v[64:67], a[224:225], v[108:109], 0
  ds_read_b128 v[184:187], v239 offset:32
  v_add_f32 v219, v219, v55
  s_waitcnt lgkmcnt(6)
  v_mfma_f32_16x16x16_bf16 v[68:71], a[234:235], v[112:113], 0
  ds_read_b128 v[188:191], v239 offset:320
  v_fmac_f32 v110, v55, v55
  s_waitcnt lgkmcnt(6)
  v_mfma_f32_16x16x16_bf16 v[72:75], a[244:245], v[116:117], 0
  ds_read_b128 v[136:139], v239 offset:608
  ds_read_b128 v[140:143], v240 offset:32
  v_add_f32 v219, v219, v56
  v_fmac_f32 v110, v56, v56
  s_waitcnt lgkmcnt(6)
  v_smfmac_f32_16x16x64_bf16 v[64:67], a[216:219], v[152:159], v0
  ds_read_b128 v[152:155], v239 offset:64
  ds_read_b128 v[156:159], v239 offset:352
  v_add_f32 v219, v219, v57
  v_fmac_f32 v110, v57, v57
  s_waitcnt lgkmcnt(6)
  v_smfmac_f32_16x16x64_bf16 v[64:67], a[220:223], v[144:151], v0
  ds_read_b128 v[144:147], v239 offset:640
  ds_read_b128 v[148:151], v240 offset:64
  v_fmac_f32 v122, v46, v46
  v_add_f32 v219, v219, v58
  s_waitcnt lgkmcnt(6)
  v_smfmac_f32_16x16x64_bf16 v[68:71], a[226:229], v[184:191], v0
  s_nop 1
  v_mul_f32 v250, v64, v64
  v_add_f32 v114, v64, v65
  v_fmac_f32 v250, v65, v65
  v_add_f32 v114, v114, v66
  s_waitcnt lgkmcnt(4)
  v_smfmac_f32_16x16x64_bf16 v[68:71], a[230:233], v[136:143], v0
  v_fmac_f32 v250, v66, v66
  v_add_f32 v114, v114, v67
  v_fmac_f32 v250, v67, v67
  v_fmac_f32 v110, v58, v58
  s_waitcnt lgkmcnt(2)
  v_smfmac_f32_16x16x64_bf16 v[72:75], a[236:239], v[152:159], v0
  s_nop 1
  v_add_f32 v114, v114, v68
  v_fmac_f32 v250, v68, v68
  v_add_f32 v114, v114, v69
  v_fmac_f32 v250, v69, v69
  s_waitcnt lgkmcnt(0)
  v_smfmac_f32_16x16x64_bf16 v[72:75], a[240:243], v[144:151], v0
  v_add_f32 v114, v114, v70
  v_fmac_f32 v250, v70, v70
  v_add_f32 v223, v223, v35
  v_fmac_f32 v247, v35, v35
  v_add_f32 v238, v238, v47
  v_fmac_f32 v122, v47, v47
  v_add_f32 v219, v219, v59
  v_fmac_f32 v110, v59, v59
  v_add_f32 v114, v114, v71
  v_fmac_f32 v250, v71, v71
  v_add_f32 v223, v223, v36
  v_fmac_f32 v247, v36, v36
  v_add_f32 v238, v238, v48
  v_fmac_f32 v122, v48, v48
  v_add_f32 v219, v219, v60
  v_fmac_f32 v110, v60, v60
  v_add_f32 v114, v114, v72
  v_fmac_f32 v250, v72, v72
  v_add_f32 v223, v223, v37
  v_fmac_f32 v247, v37, v37
  v_add_f32 v238, v238, v49
  v_fmac_f32 v122, v49, v49
  v_add_f32 v219, v219, v61
  v_fmac_f32 v110, v61, v61
  v_add_f32 v114, v114, v73
  v_fmac_f32 v250, v73, v73
  v_add_f32 v223, v223, v38
  v_fmac_f32 v247, v38, v38
  v_add_f32 v238, v238, v50
  v_fmac_f32 v122, v50, v50
  v_add_f32 v219, v219, v62
  v_fmac_f32 v110, v62, v62
  v_add_f32 v114, v114, v74
  v_fmac_f32 v250, v74, v74
  v_add_f32 v223, v223, v39
  v_fmac_f32 v247, v39, v39
  v_add_f32 v238, v238, v51
  v_fmac_f32 v122, v51, v51
  v_add_f32 v219, v219, v63
  v_fmac_f32 v110, v63, v63
  v_add_f32 v114, v114, v75
  v_fmac_f32 v250, v75, v75
  v_permlane32_swap_b32 v223, v247
  v_permlane32_swap_b32 v238, v122
  v_permlane32_swap_b32 v219, v110
  v_permlane32_swap_b32 v114, v250
  v_add_f32 v223, v223, v247
  v_add_f32 v238, v238, v122
  v_add_f32 v219, v219, v110
  v_add_f32 v114, v114, v250
  v_permlane16_swap_b32 v223, v238
  s_nop 0
  v_permlane16_swap_b32 v219, v114
  v_add_f32 v223, v223, v238
  v_add_f32 v219, v219, v114
  v_add_u32 v9, s32, v9
  ds_write_b32 v111, v223
  ds_write_b32 v111, v219 offset:512
  v_add_u32 v3, s32, v3
  v_add_u32 v6, s32, v6
  v_add_u32 v10, s32, v10
  v_add_u32 v4, s32, v4
  v_add_u32 v7, s32, v7
  v_add_u32 v11, s32, v11
  v_add_u32 v5, s32, v5
  v_add_u32 v8, s32, v8
  buffer_store_dwordx4 v[64:67], v15, s[12:15], s75 offen
  v_add_u32 v241, s71, v241
  v_add_u32 v239, s71, v239
  v_add_u32 v240, s71, v240
  v_and_b32 v238, 64, v15
  s_waitcnt lgkmcnt(0)
  s_barrier
  ds_read_b128 v[144:147], v15
  ds_read_b128 v[148:151], v15 offset:1024
  buffer_store_dwordx4 v[68:71], v15, s[12:15], s75 offen offset:1024
  s_waitcnt lgkmcnt(1)
  v_add_f32 v144, v144, v145
  v_add_f32 v146, v146, v147
  v_add_f32 v144, v144, v146
  s_waitcnt lgkmcnt(0)
  v_add_f32 v148, v148, v149
  v_add_f32 v150, v150, v151
  v_mul_f32 v145, 0x3baaaaab, v144
  v_add_f32 v148, v148, v150
  v_fma_f32 v148, -v145, v144, v148
  v_max_f32 v148, 0, v148
  v_add_f32 v148, 0x3afba882, v148
  v_rsq_f32 v148, v148
  s_nop 0
  v_mul_f32 v148, 0x40ca568a, v148
  v_mul_f32 v149, -v145, v148
  ds_write_b64 v115, v[148:149]
  ds_read_b64 v[248:249], v119
  ds_read_b64 v[116:117], v119 offset:128
  ds_read_b64 v[112:113], v119 offset:256
  ds_read_b64 v[108:109], v119 offset:384
  buffer_store_dwordx4 v[72:75], v15, s[12:15], s75 offen offset:2048
  s_waitcnt lgkmcnt(3)
  v_fma_f32 v148, v28, v248, v249
  v_fma_f32 v223, v29, v248, v249
  v_cvt_pk_bf16_f32 v148, v148, v223
  v_fma_f32 v149, v30, v248, v249
  v_fma_f32 v223, v31, v248, v249
  v_cvt_pk_bf16_f32 v149, v149, v223
  v_fma_f32 v150, v32, v248, v249
  v_fma_f32 v223, v33, v248, v249
  v_cvt_pk_bf16_f32 v150, v150, v223
  v_fma_f32 v151, v34, v248, v249
  v_fma_f32 v223, v35, v248, v249
  v_cvt_pk_bf16_f32 v151, v151, v223
  v_fma_f32 v120, v36, v248, v249
  v_fma_f32 v223, v37, v248, v249
  v_cvt_pk_bf16_f32 v120, v120, v223
  v_fma_f32 v121, v38, v248, v249
  v_fma_f32 v223, v39, v248, v249
  v_cvt_pk_bf16_f32 v121, v121, v223
  ds_write_b128 v16, v[148:151] offset:2048
  ds_write_b64 v17, v[120:121] offset:2048
  buffer_load_dwordx4 v243, s[16:19], s98 offen lds
  buffer_load_dwordx4 v244, s[16:19], s98 offen offset:1024 lds
  buffer_load_dwordx4 v245, s[16:19], s98 offen offset:2048 lds
  s_add_u32 m0, s70, 0
  s_mov_b32 s98, 36864
  buffer_load_dwordx4 v243, s[16:19], s98 offen lds
  s_waitcnt lgkmcnt(4)
  v_fma_f32 v148, v40, v116, v117
  v_fma_f32 v223, v41, v116, v117
  v_cvt_pk_bf16_f32 v148, v148, v223
  v_fma_f32 v149, v42, v116, v117
  v_fma_f32 v223, v43, v116, v117
  v_cvt_pk_bf16_f32 v149, v149, v223
  v_fma_f32 v150, v44, v116, v117
  v_fma_f32 v223, v45, v116, v117
  v_cvt_pk_bf16_f32 v150, v150, v223
  buffer_load_dwordx4 v244, s[16:19], s98 offen offset:1024 lds
  v_fma_f32 v151, v46, v116, v117
  v_fma_f32 v223, v47, v116, v117
  v_cvt_pk_bf16_f32 v151, v151, v223
  s_waitcnt lgkmcnt(3)
  v_fma_f32 v144, v52, v112, v113
  v_fma_f32 v223, v53, v112, v113
  v_cvt_pk_bf16_f32 v144, v144, v223
  v_fma_f32 v145, v54, v112, v113
  v_fma_f32 v223, v55, v112, v113
  v_cvt_pk_bf16_f32 v145, v145, v223
  v_fma_f32 v146, v56, v112, v113
  v_fma_f32 v223, v57, v112, v113
  v_cvt_pk_bf16_f32 v146, v146, v223
  v_fma_f32 v147, v58, v112, v113
  buffer_load_dwordx4 v245, s[16:19], s98 offen offset:2048 lds
  s_add_u32 m0, s70, 3072
  s_mov_b32 s98, 73728
  v_fma_f32 v223, v59, v112, v113
  v_cvt_pk_bf16_f32 v147, v147, v223
  s_waitcnt lgkmcnt(2)
  v_fma_f32 v152, v64, v108, v109
  v_fma_f32 v223, v65, v108, v109
  v_cvt_pk_bf16_f32 v152, v152, v223
  v_fma_f32 v153, v66, v108, v109
  v_fma_f32 v223, v67, v108, v109
  v_cvt_pk_bf16_f32 v153, v153, v223
  v_fma_f32 v154, v68, v108, v109
  v_fma_f32 v223, v69, v108, v109
  v_cvt_pk_bf16_f32 v154, v154, v223
  buffer_load_dwordx4 v243, s[16:19], s98 offen lds
  v_fma_f32 v155, v70, v108, v109
  v_fma_f32 v223, v71, v108, v109
  v_cvt_pk_bf16_f32 v155, v155, v223
  ds_write_b128 v16, v[148:151] offset:8192
  v_fma_f32 v248, v48, v116, v117
  v_fma_f32 v223, v49, v116, v117
  v_cvt_pk_bf16_f32 v248, v248, v223
  v_fma_f32 v249, v50, v116, v117
  buffer_load_dwordx4 v244, s[16:19], s98 offen offset:1024 lds
  ds_write_b128 v16, v[144:147] offset:14336
  v_fma_f32 v223, v51, v116, v117
  v_cvt_pk_bf16_f32 v249, v249, v223
  v_fma_f32 v116, v60, v112, v113
  v_fma_f32 v223, v61, v112, v113
  v_cvt_pk_bf16_f32 v116, v116, v223
  ds_write_b128 v16, v[152:155] offset:32768
  buffer_load_dwordx4 v245, s[16:19], s98 offen offset:2048 lds
  s_add_u32 m0, s70, 6144
  s_mov_b32 s98, 110592
  v_fma_f32 v117, v62, v112, v113
  v_fma_f32 v223, v63, v112, v113
  v_cvt_pk_bf16_f32 v117, v117, v223
  v_fma_f32 v112, v72, v108, v109
  v_fma_f32 v223, v73, v108, v109
  v_cvt_pk_bf16_f32 v112, v112, v223
  v_fma_f32 v113, v74, v108, v109
  v_fma_f32 v223, v75, v108, v109
  v_cvt_pk_bf16_f32 v113, v113, v223
  ds_write_b64 v17, v[248:249] offset:8192
  s_waitcnt vmcnt(17)
  ds_write_b64 v17, v[116:117] offset:14336
  s_waitcnt vmcnt(15)
  ds_write_b64 v17, v[112:113] offset:32768
  v_and_b32 v224, 3, v222
  v_cmp_eq_u32 vcc, 0, v224
  ds_read_b64 v[112:113], v9
  v_mov_b32 v223, 0x3f803f80
  ds_read_b64 v[116:117], v9 offset:32
  v_cndmask_b32 v223, 0, v223, vcc
  ds_read_b64 v[108:109], v9 offset:64
  v_accvgpr_write_b32 a246, v223
  ds_read_b128 v[144:147], v3
  v_accvgpr_write_b32 a247, v223
  ds_read_b128 v[148:151], v3 offset:864
  v_accvgpr_write_b32 a248, v223
  ds_read_b128 v[152:155], v3 offset:1728
  v_accvgpr_write_b32 a249, v223
  s_add_u32 s60, s74, 38912
  s_waitcnt lgkmcnt(6)
  s_barrier
  s_waitcnt lgkmcnt(5)
  v_mfma_f32_16x16x16_bf16 v[64:67], a[224:225], v[112:113], 0
  v_readlane_b32 s83, v254, 5
  s_waitcnt lgkmcnt(4)
  v_mfma_f32_16x16x16_bf16 v[68:71], a[234:235], v[116:117], 0
  v_readlane_b32 s84, v254, 6
  s_waitcnt lgkmcnt(3)
  v_mfma_f32_16x16x16_bf16 v[72:75], a[244:245], v[108:109], 0
  v_readlane_b32 s85, v254, 7
  v_readlane_b32 s82, v254, 8
  v_mul_u32_u24 v223, 24, v221
  v_add_u32 v19, s60, v223
  s_waitcnt lgkmcnt(1)
  v_smfmac_f32_16x16x64_bf16 v[64:67], a[216:219], v[144:151], v0
  ds_read_b128 v[156:159], v6
  ds_read_b128 v[144:147], v3 offset:32
  ds_read_b128 v[148:151], v3 offset:896
  v_min_u32 v223, 2, v221
  ds_read_b128 v[136:139], v3 offset:1760
  v_lshl_add_u32 v223, v223, 4, v222
  s_add_u32 s60, s60, 384
  ds_read_b128 v[140:143], v6 offset:32
  v_lshl_add_u32 v20, v223, 1, s60
  ds_read_b128 v[184:187], v3 offset:64
  v_cmp_gt_u32 vcc, 5, v222
  ds_read_b128 v[188:191], v3 offset:928
  v_mul_u32_u24 v223, 1160, v222
  v_add_u32 v249, v19, v223
  s_waitcnt lgkmcnt(6)
  v_smfmac_f32_16x16x64_bf16 v[64:67], a[220:223], v[152:159], v0
  ds_read_b128 v[152:155], v3 offset:1792
  ds_read_b128 v[156:159], v6 offset:64
  v_lshl_add_u32 v223, v221, 3, v223
  v_add_u32 v247, s60, v223
  s_waitcnt lgkmcnt(6)
  v_smfmac_f32_16x16x64_bf16 v[68:71], a[226:229], v[144:151], v0
  ds_read_b64 v[108:109], v10
  ds_read_b64 v[116:117], v10 offset:32
  v_mov_b32 v224, 0x30000
  v_add_u32 v250, 5800, v249
  s_waitcnt lgkmcnt(6)
  v_smfmac_f32_16x16x64_bf16 v[68:71], a[230:233], v[136:143], v0
  ds_read_b64 v[112:113], v10 offset:64
  ds_read_b128 v[136:139], v4
  v_cndmask_b32 v249, v224, v249, vcc
  v_add_u32 v248, 5800, v247
  s_waitcnt lgkmcnt(6)
  v_smfmac_f32_16x16x64_bf16 v[72:75], a[236:239], v[184:191], v0
  s_waitcnt vmcnt(13)
  ds_read_b128 v[140:143], v4 offset:864
  ds_read_b128 v[184:187], v4 offset:1728
  v_cndmask_b32 v247, v224, v247, vcc
  s_lshl_b32 s60, s28, 7
  s_waitcnt lgkmcnt(6)
  v_smfmac_f32_16x16x64_bf16 v[72:75], a[240:243], v[152:159], v0
  s_add_u32 s60, s60, 70144
  ds_read_b128 v[188:191], v7
  v_lshl_add_u32 v27, v221, 5, s60
  s_waitcnt lgkmcnt(6)
  v_mfma_f32_16x16x16_bf16 v[76:79], a[224:225], v[108:109], 0
  ds_read_b128 v[152:155], v4 offset:32
  v_lshrrev_b32 v223, 2, v222
  s_waitcnt lgkmcnt(6)
  v_mfma_f32_16x16x16_bf16 v[80:83], a[234:235], v[116:117], 0
  ds_read_b128 v[156:159], v4 offset:896
  v_lshlrev_b32 v223, 5, v223
  s_waitcnt lgkmcnt(6)
  v_mfma_f32_16x16x16_bf16 v[84:87], a[244:245], v[112:113], 0
  ds_read_b128 v[144:147], v4 offset:1760
  ds_read_b128 v[148:151], v7 offset:32
  buffer_load_dwordx4 v243, s[16:19], s98 offen lds
  s_waitcnt lgkmcnt(6)
  v_smfmac_f32_16x16x64_bf16 v[76:79], a[216:219], v[136:143], v0
  ds_read_b128 v[136:139], v4 offset:64
  ds_read_b128 v[140:143], v4 offset:928
  v_lshl_add_u32 v223, v221, 3, v223
  v_and_b32 v224, 3, v222
  s_waitcnt lgkmcnt(6)
  v_smfmac_f32_16x16x64_bf16 v[76:79], a[220:223], v[184:191], v0
  ds_read_b128 v[184:187], v4 offset:1792
  ds_read_b128 v[188:191], v7 offset:64
  v_lshl_add_u32 v223, v224, 1, v223
  s_sub_u32 s60, s60, 8
  s_waitcnt lgkmcnt(6)
  v_smfmac_f32_16x16x64_bf16 v[80:83], a[226:229], v[152:159], v0
  buffer_load_dwordx4 v244, s[16:19], s98 offen offset:1024 lds
  ds_read_b64 v[112:113], v11
  ds_read_b64 v[116:117], v11 offset:32
  v_add_u32 v223, s60, v223
  s_waitcnt lgkmcnt(6)
  v_smfmac_f32_16x16x64_bf16 v[80:83], a[230:233], v[144:151], v0
  ds_read_b64 v[108:109], v11 offset:64
  ds_read_b128 v[144:147], v5
  v_mov_b32 v224, 0x30000
  v_cndmask_b32 v26, v223, v224, s[54:55]
  s_waitcnt lgkmcnt(6)
  v_smfmac_f32_16x16x64_bf16 v[84:87], a[236:239], v[136:143], v0
  s_waitcnt vmcnt(8)
  buffer_load_dwordx4 v245, s[16:19], s98 offen offset:2048 lds
  ds_read_b64_tr_b16 a[0:1], v246
  ds_read_b64_tr_b16 a[2:3], v246 offset:1536
  ds_read_b64_tr_b16 a[24:25], v246 offset:32
  s_waitcnt lgkmcnt(7)
  v_smfmac_f32_16x16x64_bf16 v[84:87], a[240:243], v[184:191], v0
  s_add_u32 m0, s70, 9216
  ds_read_b64_tr_b16 a[26:27], v246 offset:1568
  s_mov_b32 s98, 147456
  s_waitcnt lgkmcnt(7)
  v_mfma_f32_16x16x16_bf16 v[88:91], a[224:225], v[112:113], 0
  ds_read_b64_tr_b16 a[48:49], v246 offset:64
  ds_read_b64_tr_b16 a[50:51], v246 offset:1600
  s_waitcnt lgkmcnt(8)
  v_mfma_f32_16x16x16_bf16 v[92:95], a[234:235], v[116:117], 0
  ds_read_b128 v[148:151], v5 offset:864
  s_mul_i32 s60, s28, 61
  s_waitcnt lgkmcnt(8)
  v_mfma_f32_16x16x16_bf16 v[96:99], a[244:245], v[108:109], 0
  buffer_load_dwordx4 v243, s[16:19], s98 offen lds
  ds_read_b128 v[184:187], v5 offset:1728
  ds_read_b128 v[188:191], v8
  v_add_u32 v223, s60, v220
  ds_read_b128 v[136:139], v5 offset:32
  v_mul_u32_u24 v224, 2428, v223
  ds_read_b128 v[140:143], v5 offset:896
  buffer_load_dwordx4 v244, s[16:19], s98 offen offset:1024 lds
  ds_read_b128 v[152:155], v5 offset:1760
  ds_read_b128 v[156:159], v8 offset:32
  v_lshrrev_b32 v224, 16, v224
  v_mul_u32_u24 v224, 192768, v224
  s_waitcnt lgkmcnt(6)
  v_smfmac_f32_16x16x64_bf16 v[88:91], a[216:219], v[144:151], v0
  ds_read_b128 v[144:147], v5 offset:64
  ds_read_b128 v[148:151], v5 offset:928
  v_lshl_add_u32 v224, v223, 7, v224
  v_cmp_gt_u32 vcc, 61, v220
  s_waitcnt lgkmcnt(6)
  v_smfmac_f32_16x16x64_bf16 v[88:91], a[220:223], v[184:191], v0
  s_waitcnt vmcnt(8)
  buffer_load_dwordx4 v245, s[16:19], s98 offen offset:2048 lds
  ds_read_b64_tr_b16 a[4:5], v255 offset:1536
  ds_read_b64_tr_b16 a[16:17], v255
  ds_read_b64_tr_b16 a[28:29], v255 offset:1568
  s_waitcnt lgkmcnt(7)
  v_smfmac_f32_16x16x64_bf16 v[92:95], a[226:229], v[136:143], v0
  s_add_u32 m0, s70, 12288
  ds_read_b64_tr_b16 a[40:41], v255 offset:32
  s_mov_b32 s98, 184320
  ds_read_b64_tr_b16 a[52:53], v255 offset:1600
  v_cndmask_b32 v224, 2.0, v224, vcc
  v_cmp_gt_u32 vcc, 243, v223
  s_waitcnt lgkmcnt(7)
  v_smfmac_f32_16x16x64_bf16 v[92:95], a[230:233], v[152:159], v0
  ds_read_b64_tr_b16 a[64:65], v255 offset:64
  buffer_load_dwordx4 v243, s[16:19], s98 offen lds
  ds_read_b128 v[152:155], v5 offset:1792
  ds_read_b128 v[156:159], v8 offset:64
  s_waitcnt lgkmcnt(8)
  v_smfmac_f32_16x16x64_bf16 v[96:99], a[236:239], v[144:151], v0
  ds_read_b128 v[144:147], v15 offset:2048
  v_cndmask_b32 v24, 2.0, v224, vcc
  ds_read_b128 v[148:151], v15 offset:3072
  v_add_u32 v223, 0, v222
  ds_read_b128 v[136:139], v15 offset:4096
  buffer_load_dwordx4 v244, s[16:19], s98 offen offset:1024 lds
  ds_read_b128 v[140:143], v15 offset:5120
  ds_read_b128 v[184:187], v15 offset:6144
  v_lshlrev_b32 v223, 5, v223
  ds_read_b128 v[188:191], v15 offset:7168
  v_add_u32 v224, s30, v223
  v_cmp_gt_u32 s[60:61], s72, v224
  s_waitcnt lgkmcnt(6)
  v_smfmac_f32_16x16x64_bf16 v[96:99], a[240:243], v[152:159], v0
  s_waitcnt lgkmcnt(5)
  v_add_u32 v223, s29, v223
  v_mfma_f32_16x16x32_bf16 v[152:155], a[0:3], v[144:147], 0
  s_waitcnt vmcnt(8)
  buffer_load_dwordx4 v245, s[16:19], s98 offen offset:2048 lds
  ds_read_b64_tr_b16 a[6:7], v255 offset:3072
  ds_read_b64_tr_b16 a[18:19], v255 offset:4608
  ds_read_b64_tr_b16 a[30:31], v255 offset:3104
  s_add_u32 m0, s81, 0
  ds_read_b64_tr_b16 a[42:43], v255 offset:4640
  s_mov_b32 s98, 384
  ds_read_b64_tr_b16 a[54:55], v255 offset:3136
  ds_read_b64_tr_b16 a[66:67], v255 offset:4672
  v_cmp_gt_u32 s[62:63], s73, v223
  v_mul_f32 v110, v88, v88
  buffer_load_dwordx4 v243, s[16:19], s98 offen lds
  v_mul_u32_u24 v224, 7183, v223
  v_lshrrev_b32 v224, 22, v224
  s_and_b64 s[60:61], s[60:61], s[62:63]
  v_mul_u32_u24 v225, 584, v224
  s_waitcnt lgkmcnt(5)
  v_mfma_f32_16x16x32_bf16 v[152:155], a[4:7], v[148:151], v[152:155]
  v_sub_u32 v225, v223, v225
  v_cmp_le_u32 vcc, 5256, v223
  v_mul_f32 v114, v64, v64
  v_mul_f32 v118, v76, v76
  v_and_b32 v228, 7, v225
  v_lshl_add_u32 v224, v224, 3, v228
  v_mov_b32 v228, 72
  buffer_load_dwordx4 v244, s[16:19], s98 offen offset:1024 lds
  v_cndmask_b32 v224, v224, v228, vcc
  v_lshrrev_b32 v228, 3, v225
  v_cndmask_b32 v225, v228, v225, vcc
  v_mul_u32_u24 v224, 1373568, v224
  v_mul_u32_u24 v225, 2688, v225
  v_add_u32 v228, v224, v225
  v_cndmask_b32 v228, 2.0, v228, s[60:61]
  v_cmp_gt_u32 vcc, 5, v222
  v_add_f32 v122, v88, v89
  v_fmac_f32 v110, v89, v89
  v_cndmask_b32 v228, 2.0, v228, vcc
  v_add_u32 v228, 589824, v228
  v_add_u32 v228, v218, v228
  v_add_u32 v223, 5, v222
  buffer_load_dwordx4 v245, s[16:19], s98 offen offset:2048 lds
  s_waitcnt vmcnt(9)
  ds_read_b64_tr_b16 a[8:9], v255 offset:6144
  ds_read_b64_tr_b16 a[10:11], v255 offset:7680
  ds_read_b64_tr_b16 a[32:33], v255 offset:6176
  s_add_u32 m0, s70, 0
  ds_read_b64_tr_b16 a[34:35], v255 offset:7712
  s_mov_b32 s98, 37248
  ds_read_b64_tr_b16 a[56:57], v255 offset:6208
  ds_read_b64_tr_b16 a[58:59], v255 offset:7744
  v_lshlrev_b32 v223, 5, v223
  v_add_u32 v224, s30, v223
  buffer_load_dwordx4 v243, s[16:19], s98 offen lds
  v_cmp_gt_u32 s[60:61], s72, v224
  v_add_f32 v126, v64, v65
  v_add_f32 v112, v76, v77
  v_add_u32 v223, s29, v223
  v_cmp_gt_u32 s[62:63], s73, v223
  v_fmac_f32 v114, v65, v65
  v_fmac_f32 v118, v77, v77
  s_waitcnt lgkmcnt(4)
  v_mfma_f32_16x16x32_bf16 v[152:155], a[8:11], v[136:139], v[152:155]
  v_mul_u32_u24 v224, 7183, v223
  v_lshrrev_b32 v224, 22, v224
  s_and_b64 s[60:61], s[60:61], s[62:63]
  v_mul_u32_u24 v225, 584, v224
  buffer_load_dwordx4 v244, s[16:19], s98 offen offset:1024 lds
  v_sub_u32 v225, v223, v225
  v_cmp_le_u32 vcc, 5256, v223
  v_add_f32 v122, v122, v90
  v_fmac_f32 v110, v90, v90
  v_and_b32 v229, 7, v225
  v_lshl_add_u32 v224, v224, 3, v229
  v_mov_b32 v229, 72
  v_cndmask_b32 v224, v224, v229, vcc
  v_lshrrev_b32 v229, 3, v225
  v_cndmask_b32 v225, v229, v225, vcc
  v_mul_u32_u24 v224, 1373568, v224
  v_mul_u32_u24 v225, 2688, v225
  v_add_u32 v229, v224, v225
  v_cndmask_b32 v229, 2.0, v229, s[60:61]
  buffer_load_dwordx4 v245, s[16:19], s98 offen offset:2048 lds
  s_waitcnt vmcnt(9)
  ds_read_b64_tr_b16 a[12:13], v255 offset:10752
  ds_read_b64_tr_b16 a[20:21], v255 offset:9216
  ds_read_b64_tr_b16 a[36:37], v255 offset:10784
  s_add_u32 m0, s70, 3072
  ds_read_b64_tr_b16 a[44:45], v255 offset:9248
  s_mov_b32 s98, 74112
  ds_read_b64_tr_b16 a[60:61], v255 offset:10816
  ds_read_b64_tr_b16 a[68:69], v255 offset:9280
  v_add_u32 v229, 589824, v229
  v_add_u32 v229, v218, v229
  buffer_load_dwordx4 v243, s[16:19], s98 offen lds
  v_add_u32 v223, 64, v228
  v_add_u32 v224, 32, v229
  v_cndmask_b32 v230, v223, v224, s[94:95]
  v_mul_u32_u24 v223, 1160, v222
  v_lshl_add_u32 v223, v221, 3, v223
  v_add_u32 v231, 39680, v223
  v_add_f32 v126, v126, v66
  v_add_f32 v112, v112, v78
  v_fmac_f32 v114, v66, v66
  v_fmac_f32 v118, v78, v78
  v_add_f32 v122, v122, v91
  v_fmac_f32 v110, v91, v91
  v_add_f32 v126, v126, v67
  v_add_f32 v112, v112, v79
  buffer_load_dwordx4 v244, s[16:19], s98 offen offset:1024 lds
  v_fmac_f32 v114, v67, v67
  v_fmac_f32 v118, v79, v79
  v_add_f32 v122, v122, v92
  v_fmac_f32 v110, v92, v92
  v_add_f32 v126, v126, v68
  v_add_f32 v112, v112, v80
  v_fmac_f32 v114, v68, v68
  v_fmac_f32 v118, v80, v80
  v_add_f32 v122, v122, v93
  v_fmac_f32 v110, v93, v93
  v_add_f32 v126, v126, v69
  v_add_f32 v112, v112, v81
  v_fmac_f32 v114, v69, v69
  v_fmac_f32 v118, v81, v81
  buffer_load_dwordx4 v245, s[16:19], s98 offen offset:2048 lds
  s_waitcnt vmcnt(9)
  ds_read_b64_tr_b16 a[14:15], v255 offset:12288
  ds_read_b64_tr_b16 a[22:23], v255 offset:13824
  ds_read_b64_tr_b16 a[38:39], v255 offset:12320
  s_add_u32 m0, s70, 6144
  ds_read_b64_tr_b16 a[46:47], v255 offset:13856
  s_mov_b32 s98, 110976
  s_waitcnt lgkmcnt(10)
  ds_read_b64_tr_b16 a[62:63], v255 offset:12352
  ds_read_b64_tr_b16 a[70:71], v255 offset:13888
  v_add_f32 v122, v122, v94
  v_fmac_f32 v110, v94, v94
  buffer_load_dwordx4 v243, s[16:19], s98 offen lds
  v_add_f32 v126, v126, v70
  v_add_f32 v112, v112, v82
  v_fmac_f32 v114, v70, v70
  v_fmac_f32 v118, v82, v82
  s_waitcnt lgkmcnt(5)
  v_mfma_f32_16x16x32_bf16 v[152:155], a[12:15], v[140:143], v[152:155]
  v_add_f32 v122, v122, v95
  v_fmac_f32 v110, v95, v95
  v_mfma_f32_16x16x32_bf16 v[152:155], a[16:19], v[184:187], v[152:155]
  s_waitcnt lgkmcnt(4)
  v_add_f32 v126, v126, v71
  v_add_f32 v112, v112, v83
  v_mfma_f32_16x16x32_bf16 v[152:155], a[20:23], v[188:191], v[152:155]
  v_fmac_f32 v114, v71, v71
  v_fmac_f32 v118, v83, v83
  v_mfma_f32_16x16x32_bf16 v[220:223], a[24:27], v[144:147], 0
  buffer_load_dwordx4 v244, s[16:19], s98 offen offset:1024 lds
  v_mfma_f32_16x16x32_bf16 v[220:223], a[28:31], v[148:151], v[220:223]
  ds_read_b128 v[156:159], v15 offset:8192
  v_cvt_pk_bf16_f32 v224, v152, v153
  v_mfma_f32_16x16x32_bf16 v[220:223], a[32:35], v[136:139], v[220:223]
  s_waitcnt lgkmcnt(4)
  ds_read_b128 v[216:219], v15 offset:9216
  v_cvt_pk_bf16_f32 v225, v154, v155
  v_mfma_f32_16x16x32_bf16 v[220:223], a[36:39], v[140:143], v[220:223]
  ds_read_b128 v[152:155], v15 offset:10240
  v_add_f32 v122, v122, v96
  v_mfma_f32_16x16x32_bf16 v[220:223], a[40:43], v[184:187], v[220:223]
  s_waitcnt vmcnt(8) lgkmcnt(5)
  buffer_load_dwordx4 v245, s[16:19], s98 offen offset:2048 lds
  v_mfma_f32_16x16x32_bf16 v[220:223], a[44:47], v[188:191], v[220:223]
  s_add_u32 m0, s70, 9216
  ds_read_b64_tr_b16 a[72:73], v246
  ds_read_b64_tr_b16 a[74:75], v246 offset:1536
  v_mfma_f32_16x16x32_bf16 v[128:131], a[48:51], v[144:147], 0
  s_mov_b32 s98, 147840
  ds_read_b64_tr_b16 a[96:97], v246 offset:32
  ds_read_b64_tr_b16 a[98:99], v246 offset:1568
  v_mfma_f32_16x16x32_bf16 v[128:131], a[52:55], v[148:151], v[128:131]
  ds_read_b64_tr_b16 a[120:121], v246 offset:64
  v_cvt_pk_bf16_f32 v226, v220, v221
  v_mfma_f32_16x16x32_bf16 v[128:131], a[56:59], v[136:139], v[128:131]
  s_waitcnt lgkmcnt(9)
  ds_read_b64_tr_b16 a[122:123], v246 offset:1600
  ds_read_b128 v[136:139], v15 offset:11264
  v_mfma_f32_16x16x32_bf16 v[128:131], a[60:63], v[140:143], v[128:131]
  buffer_load_dwordx4 v243, s[16:19], s98 offen lds
  v_mfma_f32_16x16x32_bf16 v[128:131], a[64:67], v[184:187], v[128:131]
  s_waitcnt lgkmcnt(10)
  ds_read_b128 v[184:187], v15 offset:12288
  ds_read_b128 v[140:143], v15 offset:13312
  v_mfma_f32_16x16x32_bf16 v[128:131], a[68:71], v[188:191], v[128:131]
  s_waitcnt lgkmcnt(11)
  v_cvt_pk_bf16_f32 v227, v222, v223
  v_fmac_f32 v110, v96, v96
  v_mfma_f32_16x16x32_bf16 v[220:223], a[0:3], v[156:159], 0
  s_waitcnt lgkmcnt(10)
  v_add_f32 v126, v126, v72
  v_add_f32 v112, v112, v84
  v_mfma_f32_16x16x32_bf16 v[220:223], a[4:7], v[216:219], v[220:223]
  s_waitcnt lgkmcnt(9)
  buffer_load_dwordx4 v244, s[16:19], s98 offen offset:1024 lds
  v_mfma_f32_16x16x32_bf16 v[220:223], a[8:11], v[152:155], v[220:223]
  v_cvt_pk_bf16_f32 v120, v128, v129
  v_cvt_pk_bf16_f32 v121, v130, v131
  v_fmac_f32 v114, v72, v72
  v_fmac_f32 v118, v84, v84
  s_waitcnt lgkmcnt(2)
  v_mfma_f32_16x16x32_bf16 v[220:223], a[12:15], v[136:139], v[220:223]
  v_add_f32 v122, v122, v97
  s_waitcnt lgkmcnt(1)
  v_mfma_f32_16x16x32_bf16 v[220:223], a[16:19], v[184:187], v[220:223]
  v_fmac_f32 v110, v97, v97
  s_waitcnt lgkmcnt(0)
  v_mfma_f32_16x16x32_bf16 v[220:223], a[20:23], v[140:143], v[220:223]
  s_waitcnt vmcnt(8)
  buffer_load_dwordx4 v245, s[16:19], s98 offen offset:2048 lds
  v_mfma_f32_16x16x32_bf16 v[128:131], a[24:27], v[156:159], 0
  s_add_u32 m0, s70, 12288
  ds_read_b64_tr_b16 a[76:77], v255 offset:1536
  ds_read_b64_tr_b16 a[88:89], v255
  v_mfma_f32_16x16x32_bf16 v[128:131], a[28:31], v[216:219], v[128:131]
  s_mov_b32 s98, 184704
  ds_read_b64_tr_b16 a[100:101], v255 offset:1568
  ds_read_b64_tr_b16 a[112:113], v255 offset:32
  v_mfma_f32_16x16x32_bf16 v[128:131], a[32:35], v[152:155], v[128:131]
  ds_read_b64_tr_b16 a[124:125], v255 offset:1600
  v_cvt_pk_bf16_f32 v188, v220, v221
  v_mfma_f32_16x16x32_bf16 v[128:131], a[36:39], v[136:139], v[128:131]
  buffer_load_dwordx4 v243, s[16:19], s98 offen lds
  v_mfma_f32_16x16x32_bf16 v[128:131], a[40:43], v[184:187], v[128:131]
  ds_read_b64_tr_b16 a[136:137], v255 offset:64
  ds_read_b128 v[148:151], v15 offset:14336
  v_mfma_f32_16x16x32_bf16 v[128:131], a[44:47], v[140:143], v[128:131]
  ds_read_b128 v[144:147], v15 offset:15360
  v_cvt_pk_bf16_f32 v189, v222, v223
  v_mfma_f32_16x16x32_bf16 v[220:223], a[48:51], v[156:159], 0
  ds_read_b128 v[156:159], v15 offset:16384
  v_add_f32 v126, v126, v73
  v_mfma_f32_16x16x32_bf16 v[220:223], a[52:55], v[216:219], v[220:223]
  ds_read_b128 v[216:219], v15 offset:17408
  v_cvt_pk_bf16_f32 v190, v128, v129
  v_mfma_f32_16x16x32_bf16 v[220:223], a[56:59], v[152:155], v[220:223]
  buffer_load_dwordx4 v244, s[16:19], s98 offen offset:1024 lds
  v_mfma_f32_16x16x32_bf16 v[220:223], a[60:63], v[136:139], v[220:223]
  ds_read_b128 v[136:139], v15 offset:18432
  ds_read_b128 v[152:155], v15 offset:19456
  v_mfma_f32_16x16x32_bf16 v[220:223], a[64:67], v[184:187], v[220:223]
  v_cvt_pk_bf16_f32 v191, v130, v131
  v_add_f32 v112, v112, v85
  v_mfma_f32_16x16x32_bf16 v[220:223], a[68:71], v[140:143], v[220:223]
  s_waitcnt lgkmcnt(5)
  v_fmac_f32 v114, v73, v73
  v_fmac_f32 v118, v85, v85
  v_mfma_f32_16x16x32_bf16 v[140:143], a[0:3], v[148:151], 0
  s_waitcnt vmcnt(8) lgkmcnt(4)
  buffer_load_dwordx4 v245, s[16:19], s98 offen offset:2048 lds
  v_mfma_f32_16x16x32_bf16 v[140:143], a[4:7], v[144:147], v[140:143]
  s_waitcnt lgkmcnt(3)
  ds_read_b64_tr_b16 a[78:79], v255 offset:3072
  ds_read_b64_tr_b16 a[90:91], v255 offset:4608
  v_mfma_f32_16x16x32_bf16 v[140:143], a[8:11], v[156:159], v[140:143]
  s_waitcnt lgkmcnt(4)
  ds_read_b64_tr_b16 a[102:103], v255 offset:3104
  ds_read_b64_tr_b16 a[114:115], v255 offset:4640
  v_mfma_f32_16x16x32_bf16 v[140:143], a[12:15], v[216:219], v[140:143]
  s_waitcnt lgkmcnt(5)
  ds_read_b64_tr_b16 a[126:127], v255 offset:3136
  v_cvt_pk_bf16_f32 v124, v220, v221
  v_mfma_f32_16x16x32_bf16 v[140:143], a[16:19], v[136:139], v[140:143]
  s_waitcnt lgkmcnt(5)
  ds_read_b64_tr_b16 a[138:139], v255 offset:4672
  v_cvt_pk_bf16_f32 v125, v222, v223
  v_mfma_f32_16x16x32_bf16 v[140:143], a[20:23], v[152:155], v[140:143]
  s_add_u32 m0, s81, 0
  v_add_f32 v122, v122, v98
  v_fmac_f32 v110, v98, v98
  v_mfma_f32_16x16x32_bf16 v[220:223], a[24:27], v[148:151], 0
  s_mov_b32 s98, 768
  buffer_load_dwordx4 v243, s[16:19], s98 offen lds
  v_mfma_f32_16x16x32_bf16 v[220:223], a[28:31], v[144:147], v[220:223]
  ds_read_b128 v[128:131], v15 offset:32768
  v_cvt_pk_bf16_f32 v184, v140, v141
  v_mfma_f32_16x16x32_bf16 v[220:223], a[32:35], v[156:159], v[220:223]
  ds_read_b128 v[132:135], v15 offset:33792
  v_cvt_pk_bf16_f32 v185, v142, v143
  v_mfma_f32_16x16x32_bf16 v[220:223], a[36:39], v[216:219], v[220:223]
  buffer_load_dwordx4 v244, s[16:19], s98 offen offset:1024 lds
  v_mfma_f32_16x16x32_bf16 v[220:223], a[40:43], v[136:139], v[220:223]
  ds_read_b128 v[140:143], v15 offset:34816
  ds_read_b128 v[160:163], v15 offset:35840
  v_mfma_f32_16x16x32_bf16 v[220:223], a[44:47], v[152:155], v[220:223]
  ds_read_b128 v[164:167], v15 offset:36864
  v_add_f32 v126, v126, v74
  v_mfma_f32_16x16x32_bf16 v[168:171], a[48:51], v[148:151], 0
  ds_read_b128 v[148:151], v15 offset:37888
  v_add_f32 v112, v112, v86
  v_mfma_f32_16x16x32_bf16 v[168:171], a[52:55], v[144:147], v[168:171]
  v_cvt_pk_bf16_f32 v186, v220, v221
  v_cvt_pk_bf16_f32 v187, v222, v223
  v_mfma_f32_16x16x32_bf16 v[168:171], a[56:59], v[156:159], v[168:171]
  s_waitcnt vmcnt(8)
  buffer_load_dwordx4 v245, s[16:19], s98 offen offset:2048 lds
  v_mfma_f32_16x16x32_bf16 v[168:171], a[60:63], v[216:219], v[168:171]
  s_add_u32 m0, s70, 0
  ds_read_b64_tr_b16 a[80:81], v255 offset:6144
  ds_read_b64_tr_b16 a[82:83], v255 offset:7680
  v_mfma_f32_16x16x32_bf16 v[168:171], a[64:67], v[136:139], v[168:171]
  s_mov_b32 s98, 37632
  ds_read_b64_tr_b16 a[104:105], v255 offset:6176
  ds_read_b64_tr_b16 a[106:107], v255 offset:7712
  v_mfma_f32_16x16x32_bf16 v[168:171], a[68:71], v[152:155], v[168:171]
  s_waitcnt lgkmcnt(9)
  ds_read_b64_tr_b16 a[128:129], v255 offset:6208
  v_fmac_f32 v114, v74, v74
  v_mfma_f32_16x16x32_bf16 v[152:155], a[0:3], v[128:131], 0
  s_waitcnt lgkmcnt(9)
  buffer_load_dwordx4 v243, s[16:19], s98 offen lds
  v_mfma_f32_16x16x32_bf16 v[152:155], a[4:7], v[132:135], v[152:155]
  s_waitcnt lgkmcnt(8)
  ds_read_b64_tr_b16 a[130:131], v255 offset:7744
  v_cvt_pk_bf16_f32 v236, v168, v169
  v_mfma_f32_16x16x32_bf16 v[152:155], a[8:11], v[140:143], v[152:155]
  s_waitcnt lgkmcnt(8)
  v_cvt_pk_bf16_f32 v237, v170, v171
  v_fmac_f32 v118, v86, v86
  v_mfma_f32_16x16x32_bf16 v[152:155], a[12:15], v[160:163], v[152:155]
  s_waitcnt lgkmcnt(7)
  v_add_f32 v122, v122, v99
  v_fmac_f32 v110, v99, v99
  v_mfma_f32_16x16x32_bf16 v[152:155], a[16:19], v[164:167], v[152:155]
  s_waitcnt lgkmcnt(6)
  v_add_f32 v126, v126, v75
  v_add_f32 v112, v112, v87
  v_mfma_f32_16x16x32_bf16 v[152:155], a[20:23], v[148:151], v[152:155]
  buffer_load_dwordx4 v244, s[16:19], s98 offen offset:1024 lds
  v_mfma_f32_16x16x32_bf16 v[168:171], a[24:27], v[128:131], 0
  v_fmac_f32 v114, v75, v75
  v_fmac_f32 v118, v87, v87
  v_mfma_f32_16x16x32_bf16 v[168:171], a[28:31], v[132:135], v[168:171]
  ds_read_b128 v[136:139], v15 offset:32768
  v_cvt_pk_bf16_f32 v216, v152, v153
  v_mfma_f32_16x16x32_bf16 v[168:171], a[32:35], v[140:143], v[168:171]
  ds_read_b128 v[156:159], v15 offset:33792
  v_cvt_pk_bf16_f32 v217, v154, v155
  v_mfma_f32_16x16x32_bf16 v[168:171], a[36:39], v[160:163], v[168:171]
  s_waitcnt vmcnt(8)
  buffer_load_dwordx4 v245, s[16:19], s98 offen offset:2048 lds
  v_mfma_f32_16x16x32_bf16 v[168:171], a[40:43], v[164:167], v[168:171]
  s_add_u32 m0, s70, 3072
  ds_read_b64_tr_b16 a[84:85], v255 offset:10752
  ds_read_b64_tr_b16 a[92:93], v255 offset:9216
  v_mfma_f32_16x16x32_bf16 v[168:171], a[44:47], v[148:151], v[168:171]
  s_mov_b32 s98, 74496
  ds_read_b64_tr_b16 a[108:109], v255 offset:10784
  ds_read_b64_tr_b16 a[116:117], v255 offset:9248
  v_mfma_f32_16x16x32_bf16 v[152:155], a[48:51], v[128:131], 0
  ds_read_b64_tr_b16 a[132:133], v255 offset:10816
  v_mfma_f32_16x16x32_bf16 v[152:155], a[52:55], v[132:135], v[152:155]
  ds_read_b64_tr_b16 a[140:141], v255 offset:9280
  ds_read_b128 v[132:135], v15 offset:34816
  v_mfma_f32_16x16x32_bf16 v[152:155], a[56:59], v[140:143], v[152:155]
  buffer_load_dwordx4 v243, s[16:19], s98 offen lds
  v_mfma_f32_16x16x32_bf16 v[152:155], a[60:63], v[160:163], v[152:155]
  ds_read_b128 v[160:163], v15 offset:35840
  ds_read_b128 v[140:143], v15 offset:36864
  v_mfma_f32_16x16x32_bf16 v[152:155], a[64:67], v[164:167], v[152:155]
  v_cvt_pk_bf16_f32 v218, v168, v169
  v_cvt_pk_bf16_f32 v219, v170, v171
  v_mfma_f32_16x16x32_bf16 v[152:155], a[68:71], v[148:151], v[152:155]
  s_waitcnt lgkmcnt(10)
  ds_read_b128 v[148:151], v15 offset:37888
  v_mfma_f32_16x16x32_bf16 v[168:171], a[72:75], v[136:139], 0
  s_waitcnt lgkmcnt(10)
  buffer_load_dwordx4 v244, s[16:19], s98 offen offset:1024 lds
  v_mfma_f32_16x16x32_bf16 v[168:171], a[76:79], v[156:159], v[168:171]
  v_cvt_pk_bf16_f32 v108, v152, v153
  v_cvt_pk_bf16_f32 v109, v154, v155
  v_permlane32_swap_b32 v122, v110
  s_waitcnt lgkmcnt(3)
  v_mfma_f32_16x16x32_bf16 v[168:171], a[80:83], v[132:135], v[168:171]
  v_permlane32_swap_b32 v126, v114
  v_permlane32_swap_b32 v112, v118
  v_add_f32 v122, v122, v110
  buffer_load_dwordx4 v245, s[16:19], s98 offen offset:2048 lds
  s_waitcnt vmcnt(9)
  ds_read_b64_tr_b16 a[86:87], v255 offset:12288
  ds_read_b64_tr_b16 a[94:95], v255 offset:13824
  ds_read_b64_tr_b16 a[110:111], v255 offset:12320
  s_add_u32 m0, s70, 6144
  ds_read_b64_tr_b16 a[118:119], v255 offset:13856
  s_mov_b32 s98, 111360
  ds_read_b64_tr_b16 a[134:135], v255 offset:12352
  ds_read_b64_tr_b16 a[142:143], v255 offset:13888
  v_add_f32 v126, v126, v114
  v_add_f32 v112, v112, v118
  buffer_load_dwordx4 v243, s[16:19], s98 offen lds
  v_mov_b32 v118, v122
  v_permlane16_swap_b32 v126, v112
  v_add_f32 v126, v126, v112
  s_waitcnt lgkmcnt(5)
  v_mfma_f32_16x16x32_bf16 v[168:171], a[84:87], v[160:163], v[168:171]
  v_permlane16_swap_b32 v122, v118
  v_mfma_f32_16x16x32_bf16 v[168:171], a[88:91], v[140:143], v[168:171]
  s_waitcnt lgkmcnt(4)
  v_add_f32 v122, v122, v118
  v_mfma_f32_16x16x32_bf16 v[168:171], a[92:95], v[148:151], v[168:171]
  v_mfma_f32_16x16x32_bf16 v[152:155], a[96:99], v[136:139], 0
  buffer_load_dwordx4 v244, s[16:19], s98 offen offset:1024 lds
  v_mfma_f32_16x16x32_bf16 v[152:155], a[100:103], v[156:159], v[152:155]
  ds_read_b128 v[164:167], v15 offset:2048
  v_cvt_pk_bf16_f32 v128, v168, v169
  v_mfma_f32_16x16x32_bf16 v[152:155], a[104:107], v[132:135], v[152:155]
  s_waitcnt lgkmcnt(4)
  ds_read_b128 v[220:223], v15 offset:3072
  v_cvt_pk_bf16_f32 v129, v170, v171
  v_mfma_f32_16x16x32_bf16 v[152:155], a[108:111], v[160:163], v[152:155]
  ds_read_b128 v[168:171], v15 offset:4096
  v_mfma_f32_16x16x32_bf16 v[152:155], a[112:115], v[140:143], v[152:155]
  s_waitcnt vmcnt(8) lgkmcnt(5)
  buffer_load_dwordx4 v245, s[16:19], s98 offen offset:2048 lds
  v_mfma_f32_16x16x32_bf16 v[152:155], a[116:119], v[148:151], v[152:155]
  s_add_u32 m0, s70, 9216
  ds_read_b64_tr_b16 a[144:145], v246
  ds_read_b64_tr_b16 a[146:147], v246 offset:1536
  v_mfma_f32_16x16x32_bf16 v[144:147], a[120:123], v[136:139], 0
  s_mov_b32 s98, 148224
  ds_read_b64_tr_b16 a[168:169], v246 offset:32
  ds_read_b64_tr_b16 a[170:171], v246 offset:1568
  v_mfma_f32_16x16x32_bf16 v[144:147], a[124:127], v[156:159], v[144:147]
  ds_read_b64_tr_b16 a[192:193], v246 offset:64
  v_cvt_pk_bf16_f32 v130, v152, v153
  v_mfma_f32_16x16x32_bf16 v[144:147], a[128:131], v[132:135], v[144:147]
  s_waitcnt lgkmcnt(9)
  ds_read_b64_tr_b16 a[194:195], v246 offset:1600
  ds_read_b128 v[132:135], v15 offset:5120
  v_mfma_f32_16x16x32_bf16 v[144:147], a[132:135], v[160:163], v[144:147]
  buffer_load_dwordx4 v243, s[16:19], s98 offen lds
  v_mfma_f32_16x16x32_bf16 v[144:147], a[136:139], v[140:143], v[144:147]
  s_waitcnt lgkmcnt(10)
  ds_read_b128 v[140:143], v15 offset:6144
  ds_read_b128 v[160:163], v15 offset:7168
  v_mfma_f32_16x16x32_bf16 v[144:147], a[140:143], v[148:151], v[144:147]
  s_waitcnt lgkmcnt(11)
  v_cvt_pk_bf16_f32 v131, v154, v155
  v_mfma_f32_16x16x32_bf16 v[152:155], a[72:75], v[164:167], 0
  s_waitcnt lgkmcnt(10)
  v_mfma_f32_16x16x32_bf16 v[152:155], a[76:79], v[220:223], v[152:155]
  s_waitcnt lgkmcnt(9)
  buffer_load_dwordx4 v244, s[16:19], s98 offen offset:1024 lds
  v_mfma_f32_16x16x32_bf16 v[152:155], a[80:83], v[168:171], v[152:155]
  v_cvt_pk_bf16_f32 v112, v144, v145
  v_cvt_pk_bf16_f32 v113, v146, v147
  s_waitcnt lgkmcnt(2)
  v_mfma_f32_16x16x32_bf16 v[152:155], a[84:87], v[132:135], v[152:155]
  s_waitcnt lgkmcnt(1)
  v_mfma_f32_16x16x32_bf16 v[152:155], a[88:91], v[140:143], v[152:155]
  s_waitcnt lgkmcnt(0)
  v_mfma_f32_16x16x32_bf16 v[152:155], a[92:95], v[160:163], v[152:155]
  s_waitcnt vmcnt(8)
  buffer_load_dwordx4 v245, s[16:19], s98 offen offset:2048 lds
  v_mfma_f32_16x16x32_bf16 v[144:147], a[96:99], v[164:167], 0
  s_add_u32 m0, s70, 12288
  ds_read_b64_tr_b16 a[148:149], v255 offset:1536
  ds_read_b64_tr_b16 a[160:161], v255
  v_mfma_f32_16x16x32_bf16 v[144:147], a[100:103], v[220:223], v[144:147]
  s_mov_b32 s98, 185088
  ds_read_b64_tr_b16 a[172:173], v255 offset:1568
  ds_read_b64_tr_b16 a[184:185], v255 offset:32
  v_mfma_f32_16x16x32_bf16 v[144:147], a[104:107], v[168:171], v[144:147]
  ds_read_b64_tr_b16 a[196:197], v255 offset:1600
  v_cvt_pk_bf16_f32 v148, v152, v153
  v_mfma_f32_16x16x32_bf16 v[144:147], a[108:111], v[132:135], v[144:147]
  ds_read_b64_tr_b16 a[208:209], v255 offset:64
  ds_read_b128 v[156:159], v15 offset:8192
  v_mfma_f32_16x16x32_bf16 v[144:147], a[112:115], v[140:143], v[144:147]
  buffer_load_dwordx4 v243, s[16:19], s98 offen lds
  v_mfma_f32_16x16x32_bf16 v[144:147], a[116:119], v[160:163], v[144:147]
  ds_read_b128 v[136:139], v15 offset:9216
  ds_read_b128 v[172:175], v15 offset:10240
  v_mfma_f32_16x16x32_bf16 v[176:179], a[120:123], v[164:167], 0
  v_cvt_pk_bf16_f32 v149, v154, v155
  v_mfma_f32_16x16x32_bf16 v[176:179], a[124:127], v[220:223], v[176:179]
  ds_read_b128 v[220:223], v15 offset:11264
  ds_read_b128 v[152:155], v15 offset:12288
  v_mfma_f32_16x16x32_bf16 v[176:179], a[128:131], v[168:171], v[176:179]
  buffer_load_dwordx4 v244, s[16:19], s98 offen offset:1024 lds
  v_mfma_f32_16x16x32_bf16 v[176:179], a[132:135], v[132:135], v[176:179]
  ds_read_b128 v[132:135], v15 offset:13312
  v_cvt_pk_bf16_f32 v150, v144, v145
  v_mfma_f32_16x16x32_bf16 v[176:179], a[136:139], v[140:143], v[176:179]
  v_cvt_pk_bf16_f32 v151, v146, v147
  v_mfma_f32_16x16x32_bf16 v[176:179], a[140:143], v[160:163], v[176:179]
  s_waitcnt lgkmcnt(5)
  v_mfma_f32_16x16x32_bf16 v[160:163], a[72:75], v[156:159], 0
  s_waitcnt lgkmcnt(4)
  v_mfma_f32_16x16x32_bf16 v[160:163], a[76:79], v[136:139], v[160:163]
  s_waitcnt vmcnt(8) lgkmcnt(3)
  buffer_load_dwordx4 v245, s[16:19], s98 offen offset:2048 lds
  v_mfma_f32_16x16x32_bf16 v[160:163], a[80:83], v[172:175], v[160:163]
  s_waitcnt lgkmcnt(2)
  ds_read_b64_tr_b16 a[150:151], v255 offset:3072
  ds_read_b64_tr_b16 a[162:163], v255 offset:4608
  v_mfma_f32_16x16x32_bf16 v[160:163], a[84:87], v[220:223], v[160:163]
  s_waitcnt lgkmcnt(3)
  ds_read_b64_tr_b16 a[174:175], v255 offset:3104
  ds_read_b64_tr_b16 a[186:187], v255 offset:4640
  v_mfma_f32_16x16x32_bf16 v[160:163], a[88:91], v[152:155], v[160:163]
  s_waitcnt lgkmcnt(4)
  ds_read_b64_tr_b16 a[198:199], v255 offset:3136
  v_cvt_pk_bf16_f32 v116, v176, v177
  v_mfma_f32_16x16x32_bf16 v[160:163], a[92:95], v[132:135], v[160:163]
  s_add_u32 m0, s81, 0
  ds_read_b64_tr_b16 a[210:211], v255 offset:4672
  v_cvt_pk_bf16_f32 v117, v178, v179
  v_mfma_f32_16x16x32_bf16 v[176:179], a[96:99], v[156:159], 0
  s_mov_b32 s98, 0
  buffer_load_dwordx4 v251, s[20:23], s98 offen lds
  v_mfma_f32_16x16x32_bf16 v[176:179], a[100:103], v[136:139], v[176:179]
  v_cvt_pk_bf16_f32 v140, v160, v161
  v_cvt_pk_bf16_f32 v141, v162, v163
  v_mfma_f32_16x16x32_bf16 v[176:179], a[104:107], v[172:175], v[176:179]
  v_mfma_f32_16x16x32_bf16 v[176:179], a[108:111], v[220:223], v[176:179]
  v_mfma_f32_16x16x32_bf16 v[176:179], a[112:115], v[152:155], v[176:179]
  buffer_load_dwordx4 v252, s[20:23], s98 offen offset:1024 lds
  v_mfma_f32_16x16x32_bf16 v[176:179], a[116:119], v[132:135], v[176:179]
  v_mfma_f32_16x16x32_bf16 v[160:163], a[120:123], v[156:159], 0
  v_mfma_f32_16x16x32_bf16 v[160:163], a[124:127], v[136:139], v[160:163]
  v_cvt_pk_bf16_f32 v142, v176, v177
  v_cvt_pk_bf16_f32 v143, v178, v179
  v_mfma_f32_16x16x32_bf16 v[160:163], a[128:131], v[172:175], v[160:163]
  s_waitcnt vmcnt(8)
  buffer_load_dwordx4 v253, s[20:23], s98 offen offset:2048 lds
  v_mfma_f32_16x16x32_bf16 v[160:163], a[132:135], v[220:223], v[160:163]
  s_lshl_b32 s60, s30, 2
  ds_read_b64_tr_b16 a[152:153], v255 offset:6144
  ds_read_b64_tr_b16 a[154:155], v255 offset:7680
  v_mfma_f32_16x16x32_bf16 v[160:163], a[136:139], v[152:155], v[160:163]
  s_add_u32 s60, s60, s28
  ds_read_b64_tr_b16 a[176:177], v255 offset:6176
  ds_read_b64_tr_b16 a[178:179], v255 offset:7712
  v_mfma_f32_16x16x32_bf16 v[160:163], a[140:143], v[132:135], v[160:163]
  s_lshl_b32 s60, s60, 6
  ds_read_b64_tr_b16 a[200:201], v255 offset:6208
  ds_read_b64_tr_b16 a[202:203], v255 offset:7744
  v_mfma_f32_16x16x16_bf16 v[132:135], v[116:117], v[120:121], 0
  s_add_u32 s60, s60, L_loop-8192-L_pc
  ds_read_b128 v[152:155], v15 offset:14336
  s_add_u32 s60, s0, s60
  s_nop 0
  v_cvt_pk_bf16_f32 v212, v160, v161
  v_cvt_pk_bf16_f32 v213, v162, v163
  s_nop 1
  v_mfma_f32_16x16x16_bf16 v[160:163], v[212:213], v[120:121], 0
  ds_read_b128 v[220:223], v15 offset:15360
  ds_read_b128 v[172:175], v15 offset:16384
  v_mfma_f32_16x16x16_bf16 v[176:179], v[116:117], v[124:125], 0
  buffer_store_dwordx4 v[228:231], v15, s[12:15], s77 offen offset:2048
  s_nop 1
  ds_read_b128 v[228:231], v15 offset:17408
  v_mfma_f32_16x16x16_bf16 v[136:139], v[212:213], v[124:125], 0
  ds_read_b128 v[156:159], v15 offset:18432
  ds_read_b128 v[144:147], v15 offset:19456
  v_mfma_f32_16x16x32_bf16 v[132:135], v[148:151], v[224:227], v[132:135]
  s_addc_u32 s61, s1, 0
  global_load_dword v25, v123, s[60:61]
  v_mfma_f32_16x16x32_bf16 v[160:163], v[140:143], v[224:227], v[160:163]
  s_add_u32 m0, s70, 0
  v_mfma_f32_16x16x32_bf16 v[176:179], v[148:151], v[188:191], v[176:179]
  buffer_load_dwordx4 v242, s[4:7], s83 offen lds
  v_mfma_f32_16x16x32_bf16 v[136:139], v[140:143], v[188:191], v[136:139]
  s_waitcnt lgkmcnt(5)
  v_readlane_b32 s83, v254, 9
  v_mfma_f32_16x16x32_bf16 v[168:171], a[72:75], v[152:155], 0
  s_waitcnt vmcnt(9) lgkmcnt(4)
  ds_read_b64_tr_b16 a[156:157], v255 offset:10752
  ds_read_b64_tr_b16 a[164:165], v255 offset:9216
  v_mfma_f32_16x16x32_bf16 v[168:171], a[76:79], v[220:223], v[168:171]
  s_waitcnt lgkmcnt(5)
  ds_read_b64_tr_b16 a[180:181], v255 offset:10784
  ds_read_b64_tr_b16 a[188:189], v255 offset:9248
  v_mfma_f32_16x16x32_bf16 v[168:171], a[80:83], v[172:175], v[168:171]
  s_waitcnt lgkmcnt(6)
  ds_read_b64_tr_b16 a[204:205], v255 offset:10816
  v_mfma_f32_16x16x32_bf16 v[168:171], a[84:87], v[228:231], v[168:171]
  s_waitcnt lgkmcnt(6)
  ds_read_b64_tr_b16 a[212:213], v255 offset:9280
  v_mfma_f32_16x16x32_bf16 v[168:171], a[88:91], v[156:159], v[168:171]
  s_waitcnt lgkmcnt(6)
  v_exp_f32 v132, v132
  v_mfma_f32_16x16x32_bf16 v[168:171], a[92:95], v[144:147], v[168:171]
  s_add_u32 m0, s70, 864
  v_exp_f32 v133, v133
  v_mfma_f32_16x16x32_bf16 v[164:167], a[96:99], v[152:155], 0
  buffer_load_dwordx4 v242, s[4:7], s84 offen lds
  v_mfma_f32_16x16x32_bf16 v[164:167], a[100:103], v[220:223], v[164:167]
  s_add_u32 m0, s70, 1728
  v_readlane_b32 s84, v254, 10
  v_mfma_f32_16x16x32_bf16 v[164:167], a[104:107], v[172:175], v[164:167]
  buffer_load_dwordx4 v242, s[4:7], s85 offen lds
  v_mfma_f32_16x16x32_bf16 v[164:167], a[108:111], v[228:231], v[164:167]
  s_add_u32 m0, s70, 2592
  v_readlane_b32 s85, v254, 11
  v_mfma_f32_16x16x32_bf16 v[164:167], a[112:115], v[156:159], v[164:167]
  buffer_load_dwordx4 v242, s[4:7], s82 offen lds
  v_mfma_f32_16x16x32_bf16 v[164:167], a[116:119], v[144:147], v[164:167]
  s_add_u32 m0, s70, 3456
  v_readlane_b32 s82, v254, 12
  v_mfma_f32_16x16x32_bf16 v[180:183], a[120:123], v[152:155], 0
  buffer_load_dwordx4 v242, s[4:7], s83 offen lds
  v_mfma_f32_16x16x32_bf16 v[180:183], a[124:127], v[220:223], v[180:183]
  s_waitcnt vmcnt(10)
  v_readlane_b32 s83, v254, 13
  v_mfma_f32_16x16x32_bf16 v[180:183], a[128:131], v[172:175], v[180:183]
  s_add_u32 m0, s70, 4320
  ds_read_b64_tr_b16 a[158:159], v255 offset:12288
  ds_read_b64_tr_b16 a[166:167], v255 offset:13824
  v_mfma_f32_16x16x32_bf16 v[180:183], a[132:135], v[228:231], v[180:183]
  buffer_load_dwordx4 v242, s[4:7], s84 offen lds
  v_mfma_f32_16x16x32_bf16 v[180:183], a[136:139], v[156:159], v[180:183]
  s_add_u32 m0, s70, 5184
  v_readlane_b32 s84, v254, 14
  v_mfma_f32_16x16x32_bf16 v[180:183], a[140:143], v[144:147], v[180:183]
  ds_read_b64_tr_b16 a[182:183], v255 offset:12320
  buffer_load_dwordx4 v242, s[4:7], s85 offen lds
  v_mfma_f32_16x16x16_bf16 v[144:147], v[116:117], v[236:237], 0
  v_readlane_b32 s85, v254, 15
  v_cvt_pk_bf16_f32 v156, v168, v169
  v_mfma_f32_16x16x16_bf16 v[228:231], v[212:213], v[236:237], 0
  v_exp_f32 v134, v134
  v_exp_f32 v135, v135
  v_mfma_f32_16x16x32_bf16 v[144:147], v[148:151], v[184:187], v[144:147]
  s_add_u32 m0, s70, 6048
  ds_read_b64_tr_b16 a[190:191], v255 offset:13856
  ds_read_b64_tr_b16 a[206:207], v255 offset:12352
  v_mfma_f32_16x16x32_bf16 v[228:231], v[140:143], v[184:187], v[228:231]
  ds_read_b64_tr_b16 a[214:215], v255 offset:13888
  buffer_load_dwordx4 v242, s[4:7], s82 offen lds
  v_readlane_b32 s82, v254, 16
  v_exp_f32 v160, v160
  v_exp_f32 v161, v161
  v_exp_f32 v162, v162
  v_exp_f32 v163, v163
  v_exp_f32 v176, v176
  v_exp_f32 v177, v177
  s_waitcnt vmcnt(10)
  ds_read_b64_tr_b16 a[250:251], v246
  ds_read_b64_tr_b16 v[100:101], v246 offset:32
  ds_read_b64_tr_b16 v[104:105], v246 offset:64
  s_add_u32 m0, s70, 6912
  ds_read_b64_tr_b16 a[252:253], v246 offset:1536
  buffer_load_dwordx4 v242, s[4:7], s83 offen lds
  v_readlane_b32 s83, v254, 17
  s_add_u32 m0, s70, 7776
  ds_read_b64_tr_b16 v[102:103], v246 offset:1568
  ds_read_b64_tr_b16 v[106:107], v246 offset:1600
  v_exp_f32 v178, v178
  v_exp_f32 v179, v179
  buffer_load_dwordx4 v242, s[4:7], s84 offen lds
  v_readlane_b32 s84, v254, 18
  v_exp_f32 v136, v136
  v_exp_f32 v137, v137
  v_exp_f32 v138, v138
  v_exp_f32 v139, v139
  s_add_u32 m0, s70, 8640
  s_waitcnt lgkmcnt(12)
  ds_read_b128 v[172:175], v15 offset:32768
  ds_read_b128 v[220:223], v15 offset:33792
  ds_read_b128 v[152:155], v15 offset:34816
  v_cvt_pk_bf16_f32 v157, v170, v171
  ds_read_b128 v[168:171], v15 offset:35840
  v_cvt_pk_bf16_f32 v192, v132, v133
  ds_read_b128 v[196:199], v15 offset:36864
  v_cvt_pk_bf16_f32 v158, v164, v165
  ds_read_b128 v[200:203], v15 offset:37888
  v_cvt_pk_bf16_f32 v159, v166, v167
  v_cvt_pk_bf16_f32 v214, v180, v181
  v_cvt_pk_bf16_f32 v215, v182, v183
  v_cvt_pk_bf16_f32 v193, v134, v135
  v_exp_f32 v144, v144
  s_waitcnt lgkmcnt(5)
  v_mfma_f32_16x16x32_bf16 v[132:135], a[144:147], v[172:175], 0
  v_cvt_pk_bf16_f32 v194, v160, v161
  s_waitcnt lgkmcnt(4)
  v_mfma_f32_16x16x32_bf16 v[132:135], a[148:151], v[220:223], v[132:135]
  v_cvt_pk_bf16_f32 v195, v162, v163
  s_waitcnt lgkmcnt(3)
  v_mfma_f32_16x16x32_bf16 v[132:135], a[152:155], v[152:155], v[132:135]
  v_cvt_pk_bf16_f32 v160, v176, v177
  s_waitcnt lgkmcnt(2)
  v_mfma_f32_16x16x32_bf16 v[132:135], a[156:159], v[168:171], v[132:135]
  v_cvt_pk_bf16_f32 v161, v178, v179
  s_waitcnt lgkmcnt(1)
  v_mfma_f32_16x16x32_bf16 v[132:135], a[160:163], v[196:199], v[132:135]
  v_cvt_pk_bf16_f32 v162, v136, v137
  s_waitcnt lgkmcnt(0)
  v_mfma_f32_16x16x32_bf16 v[132:135], a[164:167], v[200:203], v[132:135]
  ds_write_b64 v249, v[216:217] offset:768
  v_mfma_f32_16x16x32_bf16 v[176:179], a[168:171], v[172:175], 0
  ds_write_b64 v249, v[218:219] offset:776
  v_mfma_f32_16x16x32_bf16 v[176:179], a[172:175], v[220:223], v[176:179]
  ds_read_b128 v[180:183], v15 offset:2048
  v_cvt_pk_bf16_f32 v163, v138, v139
  v_mfma_f32_16x16x32_bf16 v[176:179], a[176:179], v[152:155], v[176:179]
  ds_read_b128 v[136:139], v15 offset:3072
  v_cvt_pk_bf16_f32 v164, v132, v133
  v_mfma_f32_16x16x32_bf16 v[176:179], a[180:183], v[168:171], v[176:179]
  ds_read_b128 v[204:207], v15 offset:4096
  v_cvt_pk_bf16_f32 v165, v134, v135
  v_mfma_f32_16x16x32_bf16 v[176:179], a[184:187], v[196:199], v[176:179]
  ds_read_b128 v[132:135], v15 offset:5120
  v_mfma_f32_16x16x32_bf16 v[176:179], a[188:191], v[200:203], v[176:179]
  v_exp_f32 v145, v145
  v_mfma_f32_16x16x32_bf16 v[208:211], a[192:195], v[172:175], 0
  v_exp_f32 v146, v146
  v_mfma_f32_16x16x32_bf16 v[208:211], a[196:199], v[220:223], v[208:211]
  v_exp_f32 v147, v147
  v_mfma_f32_16x16x32_bf16 v[208:211], a[200:203], v[152:155], v[208:211]
  ds_read_b128 v[152:155], v15 offset:6144
  ds_read_b128 v[220:223], v15 offset:7168
  v_mfma_f32_16x16x32_bf16 v[208:211], a[204:207], v[168:171], v[208:211]
  v_exp_f32 v228, v228
  v_mfma_f32_16x16x32_bf16 v[208:211], a[208:211], v[196:199], v[208:211]
  v_exp_f32 v229, v229
  v_mfma_f32_16x16x32_bf16 v[208:211], a[212:215], v[200:203], v[208:211]
  s_waitcnt lgkmcnt(5)
  v_exp_f32 v230, v230
  v_mfma_f32_16x16x32_bf16 v[200:203], v[180:183], a[144:147], 0
  s_waitcnt lgkmcnt(4)
  v_exp_f32 v231, v231
  v_mfma_f32_16x16x32_bf16 v[200:203], v[136:139], a[148:151], v[200:203]
  s_waitcnt lgkmcnt(3)
  ds_write_b64 v249, v[108:109] offset:784
  v_mfma_f32_16x16x32_bf16 v[200:203], v[204:207], a[152:155], v[200:203]
  s_waitcnt lgkmcnt(3)
  ds_write_b64 v249, v[128:129]
  v_mfma_f32_16x16x32_bf16 v[200:203], v[132:135], a[156:159], v[200:203]
  s_waitcnt lgkmcnt(3)
  v_cvt_pk_bf16_f32 v166, v176, v177
  v_cvt_pk_bf16_f32 v167, v178, v179
  v_mfma_f32_16x16x32_bf16 v[200:203], v[152:155], a[160:163], v[200:203]
  s_waitcnt lgkmcnt(2)
  v_cvt_pk_bf16_f32 v176, v144, v145
  v_cvt_pk_bf16_f32 v177, v146, v147
  v_mfma_f32_16x16x32_bf16 v[200:203], v[220:223], a[164:167], v[200:203]
  ds_write_b64 v249, v[130:131] offset:8
  v_mfma_f32_16x16x32_bf16 v[128:131], v[180:183], a[168:171], 0
  ds_write_b64 v249, v[112:113] offset:16
  v_mfma_f32_16x16x32_bf16 v[128:131], v[136:139], a[172:175], v[128:131]
  ds_read_b128 v[144:147], v15 offset:8192
  v_cvt_pk_bf16_f32 v178, v228, v229
  v_mfma_f32_16x16x32_bf16 v[128:131], v[204:207], a[176:179], v[128:131]
  ds_read_b128 v[196:199], v15 offset:9216
  v_cvt_pk_bf16_f32 v112, v208, v209
  v_mfma_f32_16x16x32_bf16 v[128:131], v[132:135], a[180:183], v[128:131]
  ds_read_b128 v[168:171], v15 offset:10240
  v_cvt_pk_bf16_f32 v113, v210, v211
  v_mfma_f32_16x16x32_bf16 v[128:131], v[152:155], a[184:187], v[128:131]
  ds_read_b128 v[208:211], v15 offset:11264
  v_cvt_pk_bf16_f32 v179, v230, v231
  v_mfma_f32_16x16x32_bf16 v[128:131], v[220:223], a[188:191], v[128:131]
  ds_read_b128 v[228:231], v15 offset:12288
  v_mfma_f32_16x16x32_bf16 v[172:175], v[180:183], a[192:195], 0
  ds_write_b64 v247, v[164:165]
  v_mfma_f32_16x16x32_bf16 v[172:175], v[136:139], a[196:199], v[172:175]
  buffer_store_dwordx4 v[216:219], v15, s[12:15], s77 offen offset:3072
  s_nop 1
  ds_read_b128 v[216:219], v15 offset:13312
  v_mfma_f32_16x16x32_bf16 v[172:175], v[204:207], a[200:203], v[172:175]
  ds_write_b64 v247, v[166:167] offset:32
  v_mfma_f32_16x16x32_bf16 v[172:175], v[132:135], a[204:207], v[172:175]
  ds_write_b64 v247, v[112:113] offset:64
  v_mfma_f32_16x16x32_bf16 v[172:175], v[152:155], a[208:211], v[172:175]
  v_cvt_pk_bf16_f32 v132, v200, v201
  v_cvt_pk_bf16_f32 v133, v202, v203
  v_mfma_f32_16x16x32_bf16 v[172:175], v[220:223], a[212:215], v[172:175]
  s_waitcnt lgkmcnt(8)
  ds_write_b32 v111, v126
  v_mfma_f32_16x16x32_bf16 v[220:223], v[144:147], a[144:147], 0
  s_waitcnt lgkmcnt(8)
  ds_write_b32 v111, v122 offset:512
  v_mfma_f32_16x16x32_bf16 v[220:223], v[196:199], a[148:151], v[220:223]
  s_waitcnt lgkmcnt(8)
  ds_read_b64 v[232:233], v19 offset:16
  ds_read2_b64 v[152:155], v19 offset0:0 offset1:1
  v_mfma_f32_16x16x32_bf16 v[220:223], v[168:171], a[152:155], v[220:223]
  s_waitcnt lgkmcnt(9)
  buffer_store_dwordx2 v[108:109], v15, s[12:15], s78 offen
  v_cvt_pk_bf16_f32 v136, v128, v129
  v_mfma_f32_16x16x32_bf16 v[220:223], v[208:211], a[156:159], v[220:223]
  s_waitcnt lgkmcnt(8)
  v_cvt_pk_bf16_f32 v137, v130, v131
  v_cvt_pk_bf16_f32 v128, v172, v173
  v_mfma_f32_16x16x32_bf16 v[220:223], v[228:231], a[160:163], v[220:223]
  s_waitcnt lgkmcnt(6)
  v_cvt_pk_bf16_f32 v129, v174, v175
  v_mfma_f32_16x16x32_bf16 v[220:223], v[216:219], a[164:167], v[220:223]
  s_waitcnt lgkmcnt(3)
  s_waitcnt lgkmcnt(2)
  s_barrier
  v_mfma_f32_16x16x16_bf16 v[172:175], v[214:215], v[120:121], 0
  s_nop 3
  v_cvt_pk_bf16_f32 v134, v220, v221
  v_cvt_pk_bf16_f32 v135, v222, v223
  s_waitcnt lgkmcnt(1)
  v_mfma_f32_16x16x16_bf16 v[220:223], v[232:233], v[120:121], v[2:5]
  ds_read_b128 v[164:167], v15
  ds_read_b128 v[180:183], v15 offset:1024
  v_mfma_f32_16x16x16_bf16 v[200:203], v[214:215], v[124:125], 0
  buffer_load_dwordx4 v242, s[4:7], s85 offen lds
  v_mfma_f32_16x16x16_bf16 v[204:207], v[232:233], v[124:125], v[2:5]
  v_readlane_b32 s85, v254, 19
  v_mfma_f32_16x16x32_bf16 v[172:175], v[156:159], v[224:227], v[172:175]
  s_waitcnt lgkmcnt(2)
  ds_read_b64 v[108:109], v19 offset:784
  v_mfma_f32_16x16x32_bf16 v[220:223], v[152:155], v[224:227], v[220:223]
  s_add_u32 m0, s70, 9504
  v_mfma_f32_16x16x32_bf16 v[200:203], v[156:159], v[188:191], v[200:203]
  s_waitcnt lgkmcnt(2)
  ds_read2_b64 v[224:227], v19 offset0:96 offset1:97
  v_add_f32 v164, v164, v165
  v_mfma_f32_16x16x32_bf16 v[204:207], v[152:155], v[188:191], v[204:207]
  s_waitcnt lgkmcnt(2)
  v_exp_f32 v172, v172
  v_mfma_f32_16x16x32_bf16 v[188:191], v[144:147], a[168:171], 0
  v_exp_f32 v173, v173
  v_mfma_f32_16x16x32_bf16 v[188:191], v[196:199], a[172:175], v[188:191]
  v_exp_f32 v174, v174
  v_mfma_f32_16x16x32_bf16 v[188:191], v[168:171], a[176:179], v[188:191]
  v_exp_f32 v175, v175
  v_mfma_f32_16x16x32_bf16 v[188:191], v[208:211], a[180:183], v[188:191]
  v_exp_f32 v220, v220
  v_mfma_f32_16x16x32_bf16 v[188:191], v[228:231], a[184:187], v[188:191]
  v_exp_f32 v200, v200
  v_mfma_f32_16x16x32_bf16 v[188:191], v[216:219], a[188:191], v[188:191]
  v_exp_f32 v201, v201
  v_mfma_f32_16x16x32_bf16 v[244:247], v[144:147], a[192:195], 0
  v_exp_f32 v202, v202
  v_mfma_f32_16x16x32_bf16 v[244:247], v[196:199], a[196:199], v[244:247]
  v_exp_f32 v203, v203
  v_mfma_f32_16x16x32_bf16 v[244:247], v[168:171], a[200:203], v[244:247]
  v_exp_f32 v204, v204
  v_mfma_f32_16x16x32_bf16 v[244:247], v[208:211], a[204:207], v[244:247]
  ds_read_b128 v[144:147], v15 offset:14336
  v_cvt_pk_bf16_f32 v120, v172, v173
  v_mfma_f32_16x16x32_bf16 v[244:247], v[228:231], a[208:211], v[244:247]
  ds_read_b128 v[168:171], v15 offset:15360
  v_cvt_pk_bf16_f32 v121, v174, v175
  v_mfma_f32_16x16x32_bf16 v[244:247], v[216:219], a[212:215], v[244:247]
  s_waitcnt lgkmcnt(2)
  buffer_load_dwordx4 v242, s[4:7], s82 offen lds
  ds_read_b128 v[172:175], v15 offset:16384
  v_mfma_f32_16x16x16_bf16 v[216:219], v[108:109], v[116:117], 0
  v_readlane_b32 s82, v254, 20
  v_cvt_pk_bf16_f32 v122, v220, 0
  v_mfma_f32_16x16x16_bf16 v[220:223], v[108:109], v[212:213], 0
  v_cvt_pk_bf16_f32 v138, v188, v189
  v_cvt_pk_bf16_f32 v139, v190, v191
  v_cvt_pk_bf16_f32 v124, v200, v201
  v_mfma_f32_16x16x16_bf16 v[188:191], v[108:109], v[214:215], 0
  v_cvt_pk_bf16_f32 v125, v202, v203
  v_cvt_pk_bf16_f32 v126, v204, 0
  v_cvt_pk_bf16_f32 v130, v244, v245
  v_mfma_f32_16x16x16_bf16 v[204:207], v[108:109], v[232:233], 0
  v_cvt_pk_bf16_f32 v131, v246, v247
  v_add_f32 v166, v166, v167
  v_add_f32 v180, v180, v181
  v_add_f32 v182, v182, v183
  v_mfma_f32_16x16x32_bf16 v[216:219], v[224:227], v[148:151], v[216:219]
  s_add_u32 m0, s70, 10368
  ds_read_b128 v[148:151], v15 offset:17408
  ds_read_b128 v[244:247], v15 offset:18432
  v_mfma_f32_16x16x32_bf16 v[220:223], v[224:227], v[140:143], v[220:223]
  ds_read_b128 v[140:143], v15 offset:19456
  v_add_f32 v164, v164, v166
  v_mfma_f32_16x16x32_bf16 v[188:191], v[224:227], v[156:159], v[188:191]
  v_add_f32 v180, v180, v182
  v_mul_f32 v165, 0x3baaaaab, v164
  v_mfma_f32_16x16x32_bf16 v[204:207], v[224:227], v[152:155], v[204:207]
  s_waitcnt lgkmcnt(5)
  v_cndmask_b32 v254, v220, v216, s[56:57]
  v_fma_f32 v180, -v165, v164, v180
  v_mfma_f32_16x16x32_bf16 v[216:219], v[144:147], a[144:147], 0
  s_waitcnt lgkmcnt(4)
  v_max_f32 v180, 0, v180
  v_add_f32 v180, 0x3afba882, v180
  v_mfma_f32_16x16x32_bf16 v[216:219], v[168:171], a[148:151], v[216:219]
  s_waitcnt lgkmcnt(3)
  v_cndmask_b32 v110, v188, v204, s[56:57]
  v_cndmask_b32 v254, v110, v254, s[46:47]
  v_mfma_f32_16x16x32_bf16 v[216:219], v[172:175], a[152:155], v[216:219]
  s_waitcnt lgkmcnt(2)
  v_rsq_f32 v180, v180
  v_mfma_f32_16x16x32_bf16 v[216:219], v[148:151], a[156:159], v[216:219]
  s_waitcnt lgkmcnt(1)
  v_mul_f32 v180, 0x40ca568a, v180
  v_mul_f32 v181, -v165, v180
  v_mfma_f32_16x16x32_bf16 v[216:219], v[244:247], a[160:163], v[216:219]
  s_waitcnt lgkmcnt(0)
  ds_read_u16 v110, v20
  v_add_u32 v19, 1160, v19
  v_mfma_f32_16x16x32_bf16 v[216:219], v[140:143], a[164:167], v[216:219]
  ds_write_b64 v115, v[180:181]
  v_mfma_f32_16x16x32_bf16 v[164:167], v[144:147], a[168:171], 0
  v_exp_f32 v254, v254
  v_mfma_f32_16x16x32_bf16 v[164:167], v[168:171], a[172:175], v[164:167]
  v_cvt_pk_bf16_f32 v108, v216, v217
  v_cvt_pk_bf16_f32 v109, v218, v219
  v_mfma_f32_16x16x32_bf16 v[164:167], v[172:175], a[176:179], v[164:167]
  buffer_load_dwordx4 v242, s[4:7], s83 offen lds
  v_mfma_f32_16x16x32_bf16 v[164:167], v[148:151], a[180:183], v[164:167]
  s_add_u32 m0, s70, 11232
  ds_read_u16 v114, v20 offset:32
  ds_read_u16 v118, v20 offset:64
  v_mfma_f32_16x16x32_bf16 v[164:167], v[244:247], a[184:187], v[164:167]
  ds_read_b64 v[212:213], v119
  ds_read_b64 v[234:235], v119 offset:128
  v_mfma_f32_16x16x32_bf16 v[164:167], v[140:143], a[188:191], v[164:167]
  v_cvt_pk_bf16_f32 v254, v254, 0
  v_mfma_f32_16x16x32_bf16 v[180:183], v[144:147], a[192:195], 0
  ds_write_b16 v26, v254
  v_mfma_f32_16x16x32_bf16 v[180:183], v[168:171], a[196:199], v[180:183]
  ds_read_b128 v[144:147], v27
  v_cvt_pk_bf16_f32 v112, v164, v165
  v_mfma_f32_16x16x32_bf16 v[180:183], v[172:175], a[200:203], v[180:183]
  v_cvt_pk_bf16_f32 v113, v166, v167
  v_mfma_f32_16x16x32_bf16 v[180:183], v[148:151], a[204:207], v[180:183]
  s_waitcnt lgkmcnt(3)
  v_fma_f32 v148, v64, v212, v213
  v_fma_f32 v243, v65, v212, v213
  v_mfma_f32_16x16x32_bf16 v[180:183], v[244:247], a[208:211], v[180:183]
  s_waitcnt lgkmcnt(2)
  v_cvt_pk_bf16_f32 v148, v148, v243
  v_fma_f32 v149, v66, v212, v213
  v_mfma_f32_16x16x32_bf16 v[180:183], v[140:143], a[212:215], v[180:183]
  v_fma_f32 v243, v67, v212, v213
  v_cvt_pk_bf16_f32 v149, v149, v243
  v_mfma_f32_16x16x32_bf16 v[140:143], a[246:249], v[192:195], 0
  v_fma_f32 v150, v68, v212, v213
  v_fma_f32 v243, v69, v212, v213
  v_mfma_f32_16x16x32_bf16 v[140:143], a[246:249], v[120:123], v[140:143]
  v_cvt_pk_bf16_f32 v116, v180, v181
  v_cvt_pk_bf16_f32 v117, v182, v183
  v_mfma_f32_16x16x32_bf16 v[180:183], v[132:135], v[192:195], 0
  v_cvt_pk_bf16_f32 v150, v150, v243
  v_fma_f32 v151, v70, v212, v213
  v_mfma_f32_16x16x32_bf16 v[180:183], v[108:111], v[120:123], v[180:183]
  v_fma_f32 v243, v71, v212, v213
  v_cvt_pk_bf16_f32 v151, v151, v243
  v_mfma_f32_16x16x32_bf16 v[164:167], v[136:139], v[192:195], 0
  ds_write_b128 v16, v[148:151] offset:2048
  v_mfma_f32_16x16x32_bf16 v[164:167], v[112:115], v[120:123], v[164:167]
  v_fma_f32 v244, v72, v212, v213
  v_fma_f32 v243, v73, v212, v213
  v_mfma_f32_16x16x32_bf16 v[148:151], v[128:131], v[192:195], 0
  buffer_load_dwordx4 v242, s[4:7], s84 offen lds
  v_mfma_f32_16x16x32_bf16 v[148:151], v[116:119], v[120:123], v[148:151]
  s_add_u32 m0, s70, 12096
  v_cvt_pk_bf16_f32 v244, v244, v243
  v_fma_f32 v245, v74, v212, v213
  v_mfma_f32_16x16x32_bf16 v[172:175], a[246:249], v[160:163], 0
  ds_read_b64 v[120:121], v27 offset:16
  v_fma_f32 v243, v75, v212, v213
  v_mfma_f32_16x16x32_bf16 v[172:175], a[246:249], v[124:127], v[172:175]
  v_cvt_pk_bf16_f32 v245, v245, v243
  v_cndmask_b32 v122, 0, v254, s[54:55]
  v_mfma_f32_16x16x32_bf16 v[168:171], v[132:135], v[160:163], 0
  ds_write_b64 v17, v[244:245] offset:2048
  v_mfma_f32_16x16x32_bf16 v[168:171], v[108:111], v[124:127], v[168:171]
  v_mul_f32 v140, 0x3ee9a3cd, v140
  v_mul_f32 v172, 0x3ee9a3cd, v172
  v_mfma_f32_16x16x32_bf16 v[192:195], v[136:139], v[160:163], 0
  v_rcp_f32 v254, v140
  v_mfma_f32_16x16x32_bf16 v[192:195], v[112:115], v[124:127], v[192:195]
  v_rcp_f32 v249, v172
  v_mfma_f32_16x16x32_bf16 v[244:247], v[128:131], v[160:163], 0
  v_fma_f32 v160, v76, v234, v235
  v_fma_f32 v243, v77, v234, v235
  v_mfma_f32_16x16x32_bf16 v[244:247], v[116:119], v[124:127], v[244:247]
  v_cvt_pk_bf16_f32 v160, v160, v243
  v_fma_f32 v161, v78, v234, v235
  v_fma_f32 v126, v79, v234, v235
  v_mfma_f32_16x16x16_bf16 v[216:219], v[214:215], v[236:237], 0
  v_cvt_pk_bf16_f32 v161, v161, v126
  v_fma_f32 v162, v80, v234, v235
  v_fma_f32 v126, v81, v234, v235
  v_mfma_f32_16x16x16_bf16 v[188:191], v[232:233], v[236:237], v[2:5]
  v_cvt_pk_bf16_f32 v162, v162, v126
  v_fma_f32 v163, v82, v234, v235
  v_fma_f32 v126, v83, v234, v235
  v_cvt_pk_bf16_f32 v163, v163, v126
  v_mfma_f32_16x16x32_bf16 v[216:219], v[156:159], v[184:187], v[216:219]
  ds_write_b128 v16, v[160:163] offset:8192
  v_mfma_f32_16x16x32_bf16 v[188:191], v[152:155], v[184:187], v[188:191]
  s_waitcnt lgkmcnt(1)
  s_barrier
  v_mfma_f32_16x16x32_bf16 v[152:155], a[246:249], v[144:147], 0
  v_exp_f32 v216, v216
  v_mfma_f32_16x16x32_bf16 v[152:155], a[246:249], v[120:123], v[152:155]
  v_exp_f32 v217, v217
  v_mfma_f32_16x16x32_bf16 v[156:159], v[144:147], v[132:135], 0
  buffer_load_dwordx4 v242, s[4:7], s85 offen lds
  v_mfma_f32_16x16x32_bf16 v[156:159], v[120:123], v[108:111], v[156:159]
  s_add_u32 m0, s70, 12960
  v_exp_f32 v218, v218
  v_mfma_f32_16x16x32_bf16 v[160:163], v[144:147], v[136:139], 0
  s_lshl_b32 s60, s31, 5
  v_exp_f32 v219, v219
  v_mfma_f32_16x16x32_bf16 v[160:163], v[120:123], v[112:115], v[160:163]
  s_add_u32 s61, s60, s30
  v_exp_f32 v188, v188
  v_mfma_f32_16x16x32_bf16 v[184:187], v[144:147], v[128:131], 0
  s_add_u32 s60, s60, s29
  v_cvt_pk_bf16_f32 v124, v216, v217
  v_cvt_pk_bf16_f32 v125, v218, v219
  v_mfma_f32_16x16x32_bf16 v[184:187], v[120:123], v[116:119], v[184:187]
  s_mul_i32 s62, s60, 7183
  v_cvt_pk_bf16_f32 v126, v188, 0
  v_mul_f32 v180, v180, v254
  v_mfma_f32_16x16x32_bf16 v[144:147], a[246:249], v[176:179], 0
  s_lshr_b32 s62, s62, 22
  v_mul_f32 v181, v181, v254
  v_cvt_pk_bf16_f32 v188, v180, v181
  v_mfma_f32_16x16x32_bf16 v[144:147], a[246:249], v[124:127], v[144:147]
  s_mul_i32 s63, s62, 584
  v_mul_f32 v182, v182, v254
  v_mul_f32 v183, v183, v254
  v_mfma_f32_16x16x32_bf16 v[216:219], v[132:135], v[176:179], 0
  s_sub_u32 s63, s60, s63
  v_cvt_pk_bf16_f32 v189, v182, v183
  v_mul_f32 v164, v164, v254
  v_mfma_f32_16x16x32_bf16 v[216:219], v[108:111], v[124:127], v[216:219]
  s_lshr_b32 s64, s63, 3
  v_mul_f32 v144, 0x3ee9a3cd, v144
  v_mul_f32 v165, v165, v254
  v_mfma_f32_16x16x32_bf16 v[180:183], v[136:139], v[176:179], 0
  s_and_b32 s65, s63, 7
  v_cvt_pk_bf16_f32 v190, v164, v165
  v_mul_f32 v166, v166, v254
  v_mfma_f32_16x16x32_bf16 v[180:183], v[112:115], v[124:127], v[180:183]
  s_lshl_b32 s66, s62, 3
  v_rcp_f32 v114, v144
  v_mfma_f32_16x16x32_bf16 v[136:139], v[128:131], v[176:179], 0
  s_add_u32 s65, s65, s66
  ds_read_b128 v[128:131], v15 offset:2048
  v_mul_f32 v167, v167, v254
  v_mfma_f32_16x16x32_bf16 v[136:139], v[116:119], v[124:127], v[136:139]
  s_cmp_ge_u32 s60, 5256
  s_cselect_b32 s64, s63, s64
  s_cselect_b32 s65, 72, s65
  s_mul_i32 s66, s65, 1373568
  s_mul_i32 s67, s64, 2688
  s_add_u32 s35, s66, s67
  s_cmp_ge_u32 s61, 667
  s_cselect_b32 s35, 268435456, s35
  s_cmp_ge_u32 s60, 5329
  s_cselect_b32 s35, 268435456, s35
  s_cmp_eq_u32 s65, 0
  s_cselect_b32 s36, 268435456, s35
  s_add_u32 s37, s35, 195360
  s_add_u32 s38, s35, 390720
  s_add_u32 s39, s35, 586080
  s_add_u32 s40, s35, 781440
  s_add_u32 s41, s35, 981120
  s_add_u32 s42, s35, 1176480
  buffer_load_dwordx4 v242, s[4:7], s82 offen lds
  s_add_u32 s43, s35, 1371840
  s_add_u32 s44, s35, 1567200
  s_cmp_eq_u32 s64, 0
  s_cselect_b64 s[52:53], s[48:49], 0
  s_cmp_eq_u32 s64, 72
  s_cselect_b64 s[52:53], s[50:51], s[52:53]
  s_add_u32 s31, s31, 1
  s_sub_u32 s68, s35, 196608
  s_cselect_b32 s68, s35, s68
  s_add_u32 m0, s70, 0
  s_mov_b32 s98, 12288
  ds_read_b128 v[132:135], v15 offset:3072
  v_or_b32 v118, 0x100, v111
  v_cvt_pk_bf16_f32 v191, v166, v167
  v_mul_f32 v168, v168, v249
  v_mul_f32 v169, v169, v249
  v_cvt_pk_bf16_f32 v164, v168, v169
  v_mul_f32 v170, v170, v249
  v_mul_f32 v171, v171, v249
  v_cvt_pk_bf16_f32 v165, v170, v171
  v_mul_f32 v192, v192, v249
  v_mul_f32 v193, v193, v249
  v_cvt_pk_bf16_f32 v166, v192, v193
  v_mul_f32 v194, v194, v249
  v_mul_f32 v195, v195, v249
  v_cvt_pk_bf16_f32 v167, v194, v195
  v_mul_f32 v216, v216, v114
  v_mul_f32 v217, v217, v114
  v_cvt_pk_bf16_f32 v168, v216, v217
  v_mul_f32 v218, v218, v114
  v_mul_f32 v219, v219, v114
  v_cvt_pk_bf16_f32 v169, v218, v219
  v_mul_f32 v180, v180, v114
  v_mul_f32 v181, v181, v114
  v_cvt_pk_bf16_f32 v170, v180, v181
  v_mul_f32 v182, v182, v114
  v_mul_f32 v183, v183, v114
  v_cvt_pk_bf16_f32 v171, v182, v183
  v_mul_f32 v152, 0x3ee9a3cd, v152
  v_add_u32 v126, 8192, v16
  ds_write_b128 v16, v[188:191] offset:20480
  v_rcp_f32 v110, v152
  ds_write_b128 v16, v[164:167] offset:26624
  v_cndmask_b32 v122, v160, v156, s[54:55]
  v_fma_f32 v242, v84, v234, v235
  v_fma_f32 v116, v85, v234, v235
  v_cvt_pk_bf16_f32 v242, v242, v116
  v_fma_f32 v243, v86, v234, v235
  v_fma_f32 v116, v87, v234, v235
  v_cvt_pk_bf16_f32 v243, v243, v116
  v_mul_f32 v148, v148, v254
  v_mul_f32 v149, v149, v254
  v_cvt_pk_bf16_f32 v236, v148, v149
  v_mul_f32 v150, v150, v254
  v_mul_f32 v151, v151, v254
  v_cvt_pk_bf16_f32 v237, v150, v151
  v_mul_f32 v244, v244, v249
  v_mul_f32 v245, v245, v249
  v_cvt_pk_bf16_f32 v116, v244, v245
  v_mul_f32 v246, v246, v249
  v_mul_f32 v247, v247, v249
  v_cvt_pk_bf16_f32 v117, v246, v247
  ds_write_b128 v16, v[168:171] offset:32768
  v_mul_f32 v136, v136, v114
  v_mul_f32 v137, v137, v114
  v_cvt_pk_bf16_f32 v124, v136, v137
  v_mul_f32 v138, v138, v114
  v_mul_f32 v139, v139, v114
  v_cvt_pk_bf16_f32 v125, v138, v139
  v_cndmask_b32 v122, v184, v122, s[56:57]
  v_add_u32 v112, 8192, v17
  v_mul_f32 v122, v122, v110
  ds_write_b64 v17, v[242:243] offset:8192
  ds_write_b64 v17, v[236:237] offset:20480
  v_cvt_pk_bf16_f32 v122, v122, v122
  v_add_u32 v113, 8192, v15
  ds_write_b64 v17, v[116:117] offset:26624
  v_max3_f32 v1, v1, v140, v254
  v_max3_f32 v1, v1, v172, v249
  ds_write_b64 v17, v[124:125] offset:32768
  v_max3_f32 v1, v1, v152, v110
  v_max3_f32 v1, v1, v144, v114
  ds_write_b16 v20, v122 offset:384
  v_add_u32 v20, 1160, v20
  s_waitcnt vmcnt(0)
  ds_read_b64 v[242:243], v241
  ds_read_b64 v[236:237], v241 offset:32
  ds_read_b64 v[124:125], v241 offset:64
  ds_read_b128 v[136:139], v239
  ds_read_b128 v[140:143], v239 offset:288
  ds_read_b128 v[144:147], v239 offset:576
  ds_read_b128 v[148:151], v240
  s_waitcnt lgkmcnt(6)
  v_mfma_f32_16x16x16_bf16 v[184:187], a[224:225], v[242:243], 0
  ds_read_b128 v[152:155], v239 offset:32
  s_waitcnt lgkmcnt(6)
  v_mfma_f32_16x16x16_bf16 v[244:247], a[234:235], v[236:237], 0
  ds_read_b128 v[156:159], v239 offset:320
  s_waitcnt lgkmcnt(6)
  v_mfma_f32_16x16x16_bf16 v[188:191], a[244:245], v[124:125], 0
  ds_read_b128 v[160:163], v239 offset:608
  ds_read_b128 v[164:167], v240 offset:32
  s_waitcnt lgkmcnt(6)
  v_smfmac_f32_16x16x64_bf16 v[184:187], a[216:219], v[136:143], v0
  ds_read_b128 v[168:171], v239 offset:64
  ds_read_b128 v[172:175], v239 offset:352
  s_waitcnt lgkmcnt(6)
  v_smfmac_f32_16x16x64_bf16 v[184:187], a[220:223], v[144:151], v0
  ds_read_b128 v[176:179], v239 offset:640
  ds_read_b128 v[180:183], v240 offset:64
  s_waitcnt lgkmcnt(6)
  v_smfmac_f32_16x16x64_bf16 v[244:247], a[226:229], v[152:159], v0
  ds_read_b128 v[136:139], v15 offset:4096
  s_nop 2
  v_mul_f32 v239, v184, v184
  v_add_f32 v122, v184, v185
  v_fmac_f32 v239, v185, v185
  v_add_f32 v122, v122, v186
  v_fmac_f32 v239, v186, v186
  s_waitcnt lgkmcnt(5)
  v_smfmac_f32_16x16x64_bf16 v[244:247], a[230:233], v[160:167], v0
  ds_read_b128 v[140:143], v15 offset:5120
  v_add_f32 v122, v122, v187
  v_fmac_f32 v239, v187, v187
  s_waitcnt lgkmcnt(4)
  v_smfmac_f32_16x16x64_bf16 v[188:191], a[236:239], v[168:175], v0
  ds_read_b128 v[144:147], v15 offset:6144
  s_nop 1
  v_add_f32 v122, v122, v244
  v_fmac_f32 v239, v244, v244
  v_add_f32 v122, v122, v245
  v_fmac_f32 v239, v245, v245
  v_add_f32 v122, v122, v246
  s_waitcnt lgkmcnt(3)
  v_smfmac_f32_16x16x64_bf16 v[188:191], a[240:243], v[176:183], v0
  buffer_load_dwordx4 v251, s[20:23], s98 offen lds
  v_mfma_f32_16x16x32_bf16 v[156:159], a[0:3], v[128:131], 0
  buffer_load_dwordx4 v252, s[20:23], s98 offen offset:1024 lds
  v_mfma_f32_16x16x32_bf16 v[156:159], a[4:7], v[132:135], v[156:159]
  s_waitcnt lgkmcnt(2)
  buffer_load_dwordx4 v253, s[20:23], s98 offen offset:2048 lds
  v_mfma_f32_16x16x32_bf16 v[156:159], a[8:11], v[136:139], v[156:159]
  s_waitcnt lgkmcnt(1)
  v_fmac_f32 v239, v246, v246
  v_add_f32 v122, v122, v247
  v_mfma_f32_16x16x32_bf16 v[156:159], a[12:15], v[140:143], v[156:159]
  s_waitcnt lgkmcnt(0)
  v_fmac_f32 v239, v247, v247
  v_add_f32 v122, v122, v188
  v_mfma_f32_16x16x32_bf16 v[156:159], a[16:19], v[144:147], v[156:159]
  s_add_u32 m0, s70, 3072
  s_mov_b32 s98, 24576
  buffer_load_dwordx4 v251, s[20:23], s98 offen lds
  buffer_load_dwordx4 v252, s[20:23], s98 offen offset:1024 lds
  v_fmac_f32 v239, v188, v188
  v_add_f32 v122, v122, v189
  v_fmac_f32 v239, v189, v189
  v_add_f32 v122, v122, v190
  v_fmac_f32 v239, v190, v190
  v_add_f32 v122, v122, v191
  v_fmac_f32 v239, v191, v191
  s_nop 1
  v_permlane32_swap_b32 v122, v239
  v_add_f32 v122, v122, v239
  v_mov_b32 v239, v122
  buffer_load_dwordx4 v253, s[20:23], s98 offen offset:2048 lds
  s_nop 0
  v_permlane16_swap_b32 v122, v239
  s_add_u32 m0, s70, 6144
  s_mov_b32 s98, 36864
  ds_read_b128 v[148:151], v15 offset:7168
  v_add_f32 v122, v122, v239
  ds_write_b32 v118, v122 offset:512
  buffer_load_dwordx4 v251, s[20:23], s98 offen lds
  s_waitcnt lgkmcnt(1)
  v_mfma_f32_16x16x32_bf16 v[156:159], a[20:23], v[148:151], v[156:159]
  s_waitcnt lgkmcnt(0)
  s_barrier
  v_mfma_f32_16x16x32_bf16 v[164:167], a[24:27], v[128:131], 0
  buffer_load_dwordx4 v252, s[20:23], s98 offen offset:1024 lds
  v_mfma_f32_16x16x32_bf16 v[164:167], a[28:31], v[132:135], v[164:167]
  ds_read_b128 v[160:163], v15
  ds_read_b128 v[176:179], v15 offset:1024
  v_mfma_f32_16x16x32_bf16 v[164:167], a[32:35], v[136:139], v[164:167]
  v_cvt_pk_bf16_f32 v152, v156, v157
  v_cvt_pk_bf16_f32 v153, v158, v159
  v_mfma_f32_16x16x32_bf16 v[164:167], a[36:39], v[140:143], v[164:167]
  v_mfma_f32_16x16x32_bf16 v[164:167], a[40:43], v[144:147], v[164:167]
  v_mfma_f32_16x16x32_bf16 v[164:167], a[44:47], v[148:151], v[164:167]
  buffer_load_dwordx4 v253, s[20:23], s98 offen offset:2048 lds
  v_mfma_f32_16x16x32_bf16 v[156:159], a[48:51], v[128:131], 0
  s_add_u32 m0, s70, 9216
  v_mfma_f32_16x16x32_bf16 v[156:159], a[52:55], v[132:135], v[156:159]
  s_waitcnt lgkmcnt(1)
  v_add_f32 v160, v160, v161
  v_add_f32 v162, v162, v163
  v_mfma_f32_16x16x32_bf16 v[156:159], a[56:59], v[136:139], v[156:159]
  s_waitcnt lgkmcnt(0)
  v_add_f32 v176, v176, v177
  v_add_f32 v178, v178, v179
  v_mfma_f32_16x16x32_bf16 v[156:159], a[60:63], v[140:143], v[156:159]
  s_mov_b32 s98, 49152
  v_add_f32 v160, v160, v162
  v_add_f32 v176, v176, v178
  v_mfma_f32_16x16x32_bf16 v[156:159], a[64:67], v[144:147], v[156:159]
  v_mul_f32 v161, 0x3baaaaab, v160
  v_fma_f32 v176, -v161, v160, v176
  v_mfma_f32_16x16x32_bf16 v[156:159], a[68:71], v[148:151], v[156:159]
  v_max_f32 v176, 0, v176
  v_add_f32 v176, 0x3afba882, v176
  v_mfma_f32_16x16x32_bf16 v[180:183], a[72:75], v[128:131], 0
  v_rsq_f32 v176, v176
  v_mfma_f32_16x16x32_bf16 v[180:183], a[76:79], v[132:135], v[180:183]
  v_mul_f32 v176, 0x40ca568a, v176
  v_mul_f32 v177, -v161, v176
  v_mfma_f32_16x16x32_bf16 v[180:183], a[80:83], v[136:139], v[180:183]
  buffer_load_dwordx4 v251, s[20:23], s98 offen lds
  v_mfma_f32_16x16x32_bf16 v[180:183], a[84:87], v[140:143], v[180:183]
  ds_write_b64 v115, v[176:177]
  v_mfma_f32_16x16x32_bf16 v[180:183], a[88:91], v[144:147], v[180:183]
  v_cvt_pk_bf16_f32 v154, v164, v165
  v_cvt_pk_bf16_f32 v155, v166, v167
  v_mfma_f32_16x16x32_bf16 v[180:183], a[92:95], v[148:151], v[180:183]
  v_cvt_pk_bf16_f32 v164, v156, v157
  buffer_load_dwordx4 v252, s[20:23], s98 offen offset:1024 lds
  v_cvt_pk_bf16_f32 v165, v158, v159
  s_nop 4
  v_cvt_pk_bf16_f32 v156, v180, v181
  v_cvt_pk_bf16_f32 v157, v182, v183
  buffer_load_dwordx4 v253, s[20:23], s98 offen offset:2048 lds
  s_waitcnt vmcnt(9)
  s_add_u32 m0, s70, 12288
  s_mov_b32 s98, 61440
  s_mov_b32 s32, s33
  s_mov_b32 s33, s34
  s_mov_b32 s34, s35
  s_lshl_b32 s60, s30, 2
  s_add_u32 s60, s60, s28
  s_lshl_b32 s60, s60, 7
  s_add_u32 s60, s60, L_loop-L_pc
  s_add_u32 s60, s0, s60
  s_addc_u32 s61, s1, 0
  ds_read_b64 v[166:167], v119 offset:384
  buffer_load_dwordx4 v251, s[20:23], s98 offen lds
  ds_read_b64_tr_b16 v[160:161], v255 offset:1536
  ds_read_b64_tr_b16 v[180:181], v255 offset:1568
  ds_read_b64_tr_b16 v[176:177], v255
  ds_read_b64_tr_b16 v[168:169], v255 offset:32
  ds_read_b64_tr_b16 v[172:173], v255 offset:64
  ds_read_b64_tr_b16 v[240:241], v255 offset:1600
  buffer_load_dwordx4 v252, s[20:23], s98 offen offset:1024 lds
  s_waitcnt lgkmcnt(6)
  v_fma_f32 v216, v184, v166, v167
  v_fma_f32 v252, v185, v166, v167
  v_cvt_pk_bf16_f32 v216, v216, v252
  v_fma_f32 v217, v186, v166, v167
  v_fma_f32 v252, v187, v166, v167
  v_cvt_pk_bf16_f32 v217, v217, v252
  v_fma_f32 v218, v244, v166, v167
  v_fma_f32 v252, v245, v166, v167
  v_cvt_pk_bf16_f32 v218, v218, v252
  v_fma_f32 v219, v246, v166, v167
  v_fma_f32 v252, v247, v166, v167
  buffer_load_dwordx4 v253, s[20:23], s98 offen offset:2048 lds
  v_cvt_pk_bf16_f32 v219, v219, v252
  ds_write_b128 v126, v[216:219] offset:55296
  v_fma_f32 v252, v188, v166, v167
  v_fma_f32 v239, v189, v166, v167
  v_cvt_pk_bf16_f32 v252, v252, v239
  v_fma_f32 v253, v190, v166, v167
  v_fma_f32 v239, v191, v166, v167
  v_cvt_pk_bf16_f32 v253, v253, v239
  s_waitcnt vmcnt(9)
  buffer_store_dwordx4 v[184:187], v15, s[12:15], s75 offen offset:3072
  ds_read_b64_tr_b16 v[162:163], v255 offset:3072
  ds_write_b64 v112, v[252:253] offset:55296
  buffer_store_dwordx4 v[244:247], v15, s[12:15], s77 offen
  buffer_store_dwordx4 v[188:191], v15, s[12:15], s77 offen offset:1024
  ds_read_b64_tr_b16 v[182:183], v255 offset:3104
  ds_read_b64_tr_b16 v[242:243], v255 offset:3136
  ds_read_b64_tr_b16 v[178:179], v255 offset:4608
  ds_read_b64_tr_b16 v[170:171], v255 offset:4640
  ds_read_b64_tr_b16 v[174:175], v255 offset:4672
  s_waitcnt lgkmcnt(6)
  ds_write_b128 v18, v[160:163]
  buffer_load_dword v25, v24, s[24:27], s68 offen
  s_waitcnt lgkmcnt(6)
  s_barrier
  v_mfma_f32_16x16x32_bf16 v[160:163], a[96:99], v[128:131], 0
  s_waitcnt lgkmcnt(5)
  v_mfma_f32_16x16x32_bf16 v[160:163], a[100:103], v[132:135], v[160:163]
  v_mfma_f32_16x16x32_bf16 v[160:163], a[104:107], v[136:139], v[160:163]
  global_load_dword v25, v238, s[60:61]
  v_mfma_f32_16x16x32_bf16 v[160:163], a[108:111], v[140:143], v[160:163]
  v_mfma_f32_16x16x32_bf16 v[160:163], a[112:115], v[144:147], v[160:163]
  ds_read_b128 v[188:191], v113 offset:55296
  v_mfma_f32_16x16x32_bf16 v[160:163], a[116:119], v[148:151], v[160:163]
  ds_read_b128 v[244:247], v113 offset:56320
  ds_read_b128 v[184:187], v113 offset:57344
  ds_read_b128 v[216:219], v113 offset:58368
  s_nop 4
  v_cvt_pk_bf16_f32 v158, v160, v161
  ds_write_b128 v18, v[180:183] offset:1024
  v_cvt_pk_bf16_f32 v159, v162, v163
  s_waitcnt lgkmcnt(4)
  v_mfma_f32_16x16x32_bf16 v[160:163], a[0:3], v[188:191], 0
  ds_read_b128 v[180:183], v113 offset:59392
  s_waitcnt lgkmcnt(4)
  v_mfma_f32_16x16x32_bf16 v[160:163], a[4:7], v[244:247], v[160:163]
  ds_read_b128 v[236:239], v113 offset:60416
  s_waitcnt lgkmcnt(4)
  v_mfma_f32_16x16x32_bf16 v[160:163], a[8:11], v[184:187], v[160:163]
  s_waitcnt lgkmcnt(3)
  v_mfma_f32_16x16x32_bf16 v[160:163], a[12:15], v[216:219], v[160:163]
  ds_write_b128 v18, v[240:243] offset:2048
  s_waitcnt lgkmcnt(2)
  v_mfma_f32_16x16x32_bf16 v[160:163], a[16:19], v[180:183], v[160:163]
  s_waitcnt lgkmcnt(1)
  v_mfma_f32_16x16x32_bf16 v[160:163], a[20:23], v[236:239], v[160:163]
  ds_write_b128 v18, v[176:179] offset:3072
  v_mfma_f32_16x16x32_bf16 v[176:179], a[24:27], v[188:191], 0
  s_nop 3
  v_cvt_pk_bf16_f32 v240, v160, v161
  v_cvt_pk_bf16_f32 v241, v162, v163
  v_mfma_f32_16x16x32_bf16 v[176:179], a[28:31], v[244:247], v[176:179]
  ds_write_b64 v250, v[240:241] offset:768
  v_mfma_f32_16x16x32_bf16 v[176:179], a[32:35], v[184:187], v[176:179]
  ds_write_b128 v18, v[168:171] offset:4096
  v_mfma_f32_16x16x32_bf16 v[176:179], a[36:39], v[216:219], v[176:179]
  v_mfma_f32_16x16x32_bf16 v[176:179], a[40:43], v[180:183], v[176:179]
  v_mfma_f32_16x16x32_bf16 v[176:179], a[44:47], v[236:239], v[176:179]
  ds_write_b128 v18, v[172:175] offset:5120
  v_mfma_f32_16x16x32_bf16 v[160:163], a[48:51], v[188:191], 0
  s_waitcnt vmcnt(11)
  s_nop 2
  v_cvt_pk_bf16_f32 v242, v176, v177
  v_cvt_pk_bf16_f32 v243, v178, v179
  v_mfma_f32_16x16x32_bf16 v[160:163], a[52:55], v[244:247], v[160:163]
  ds_read_b64_tr_b16 v[176:177], v255 offset:6144
  v_mfma_f32_16x16x32_bf16 v[160:163], a[56:59], v[184:187], v[160:163]
  ds_read_b64_tr_b16 v[178:179], v255 offset:7680
  ds_read_b64_tr_b16 v[172:173], v255 offset:6176
  v_mfma_f32_16x16x32_bf16 v[160:163], a[60:63], v[216:219], v[160:163]
  ds_read_b64_tr_b16 v[174:175], v255 offset:7712
  v_mfma_f32_16x16x32_bf16 v[160:163], a[64:67], v[180:183], v[160:163]
  ds_read_b64_tr_b16 v[168:169], v255 offset:6208
  v_mfma_f32_16x16x32_bf16 v[160:163], a[68:71], v[236:239], v[160:163]
  ds_read_b64_tr_b16 v[170:171], v255 offset:7744
  v_mfma_f32_16x16x32_bf16 v[192:195], a[72:75], v[188:191], 0
  ds_write_b64 v250, v[242:243] offset:776
  v_mfma_f32_16x16x32_bf16 v[192:195], a[76:79], v[244:247], v[192:195]
  buffer_store_dwordx4 v[240:243], v15, s[12:15], s78 offen offset:1024
  v_cvt_pk_bf16_f32 v166, v160, v161
  v_mfma_f32_16x16x32_bf16 v[192:195], a[80:83], v[184:187], v[192:195]
  s_waitcnt lgkmcnt(5)
  ds_write_b128 v18, v[176:179] offset:6144
  v_mfma_f32_16x16x32_bf16 v[192:195], a[84:87], v[216:219], v[192:195]
  s_waitcnt lgkmcnt(4)
  v_cvt_pk_bf16_f32 v167, v162, v163
  v_mfma_f32_16x16x32_bf16 v[192:195], a[88:91], v[180:183], v[192:195]
  ds_write_b64 v250, v[166:167] offset:784
  v_mfma_f32_16x16x32_bf16 v[192:195], a[92:95], v[236:239], v[192:195]
  ds_write_b128 v18, v[172:175] offset:7168
  v_mfma_f32_16x16x32_bf16 v[160:163], a[96:99], v[188:191], 0
  s_waitcnt lgkmcnt(4)
  buffer_store_dwordx2 v[166:167], v15, s[12:15], s78 offen offset:2048
  s_nop 1
  v_cvt_pk_bf16_f32 v172, v192, v193
  v_mfma_f32_16x16x32_bf16 v[160:163], a[100:103], v[244:247], v[160:163]
  ds_write_b128 v18, v[168:171] offset:8192
  v_mfma_f32_16x16x32_bf16 v[160:163], a[104:107], v[184:187], v[160:163]
  s_waitcnt vmcnt(7)
  v_cvt_pk_bf16_f32 v173, v194, v195
  v_mfma_f32_16x16x32_bf16 v[160:163], a[108:111], v[216:219], v[160:163]
  v_mfma_f32_16x16x32_bf16 v[160:163], a[112:115], v[180:183], v[160:163]
  ds_read_b64_tr_b16 v[192:193], v255 offset:10752
  ds_read_b64_tr_b16 v[194:195], v255 offset:12288
  v_mfma_f32_16x16x32_bf16 v[160:163], a[116:119], v[236:239], v[160:163]
  ds_read_b64_tr_b16 v[168:169], v255 offset:10784
  v_mfma_f32_16x16x32_bf16 v[176:179], a[120:123], v[188:191], 0
  ds_read_b64_tr_b16 v[170:171], v255 offset:12320
  v_mfma_f32_16x16x32_bf16 v[176:179], a[124:127], v[244:247], v[176:179]
  ds_read_b64_tr_b16 v[240:241], v255 offset:9216
  ds_read_b64_tr_b16 v[196:197], v255 offset:9248
  v_mfma_f32_16x16x32_bf16 v[176:179], a[128:131], v[184:187], v[176:179]
  ds_read_b64_tr_b16 v[200:201], v255 offset:9280
  v_cvt_pk_bf16_f32 v174, v160, v161
  v_mfma_f32_16x16x32_bf16 v[176:179], a[132:135], v[216:219], v[176:179]
  ds_read_b64_tr_b16 v[204:205], v255 offset:10816
  v_cvt_pk_bf16_f32 v175, v162, v163
  v_mfma_f32_16x16x32_bf16 v[176:179], a[136:139], v[180:183], v[176:179]
  ds_read_b64_tr_b16 v[206:207], v255 offset:12352
  ds_read_b64_tr_b16 v[242:243], v255 offset:13824
  v_mfma_f32_16x16x32_bf16 v[176:179], a[140:143], v[236:239], v[176:179]
  ds_read_b64_tr_b16 v[198:199], v255 offset:13856
  v_mfma_f32_16x16x32_bf16 v[160:163], a[144:147], v[188:191], 0
  ds_read_b64_tr_b16 v[202:203], v255 offset:13888
  v_mfma_f32_16x16x32_bf16 v[160:163], a[148:151], v[244:247], v[160:163]
  s_waitcnt lgkmcnt(10)
  ds_write_b128 v18, v[192:195] offset:9216
  v_mfma_f32_16x16x32_bf16 v[160:163], a[152:155], v[184:187], v[160:163]
  s_waitcnt lgkmcnt(9)
  v_cvt_pk_bf16_f32 v166, v176, v177
  v_cvt_pk_bf16_f32 v167, v178, v179
  v_mfma_f32_16x16x32_bf16 v[160:163], a[156:159], v[216:219], v[160:163]
  ds_write_b64 v250, v[172:173]
  v_mfma_f32_16x16x32_bf16 v[160:163], a[160:163], v[180:183], v[160:163]
  v_mfma_f32_16x16x32_bf16 v[160:163], a[164:167], v[236:239], v[160:163]
  ds_write_b128 v18, v[168:171] offset:10240
  v_mfma_f32_16x16x32_bf16 v[168:171], a[168:171], v[188:191], 0
  s_waitcnt lgkmcnt(6)
  s_nop 2
  v_cvt_pk_bf16_f32 v176, v160, v161
  v_cvt_pk_bf16_f32 v177, v162, v163
  v_mfma_f32_16x16x32_bf16 v[168:171], a[172:175], v[244:247], v[168:171]
  ds_write_b64 v250, v[174:175] offset:8
  v_mfma_f32_16x16x32_bf16 v[168:171], a[176:179], v[184:187], v[168:171]
  v_mfma_f32_16x16x32_bf16 v[168:171], a[180:183], v[216:219], v[168:171]
  ds_write_b128 v18, v[204:207] offset:11264
  v_mfma_f32_16x16x32_bf16 v[168:171], a[184:187], v[180:183], v[168:171]
  s_waitcnt lgkmcnt(7)
  v_mfma_f32_16x16x32_bf16 v[168:171], a[188:191], v[236:239], v[168:171]
  ds_write_b64 v250, v[166:167] offset:16
  v_mfma_f32_16x16x32_bf16 v[204:207], a[192:195], v[188:191], 0
  v_mfma_f32_16x16x32_bf16 v[204:207], a[196:199], v[244:247], v[204:207]
  ds_write_b128 v18, v[240:243] offset:12288
  v_mfma_f32_16x16x32_bf16 v[204:207], a[200:203], v[184:187], v[204:207]
  s_waitcnt lgkmcnt(8)
  v_cvt_pk_bf16_f32 v178, v168, v169
  v_cvt_pk_bf16_f32 v179, v170, v171
  v_mfma_f32_16x16x32_bf16 v[204:207], a[204:207], v[216:219], v[204:207]
  ds_write_b64 v248, v[176:177]
  v_mfma_f32_16x16x32_bf16 v[204:207], a[208:211], v[180:183], v[204:207]
  v_mfma_f32_16x16x32_bf16 v[204:207], a[212:215], v[236:239], v[204:207]
  ds_write_b128 v18, v[196:199] offset:13312
  v_mfma_f32_16x16x32_bf16 v[160:163], a[120:123], v[128:131], 0
  s_waitcnt lgkmcnt(9)
  s_nop 2
  v_cvt_pk_bf16_f32 v166, v204, v205
  v_cvt_pk_bf16_f32 v167, v206, v207
  v_mfma_f32_16x16x32_bf16 v[160:163], a[124:127], v[132:135], v[160:163]
  ds_write_b64 v248, v[178:179] offset:32
  v_mfma_f32_16x16x32_bf16 v[160:163], a[128:131], v[136:139], v[160:163]
  v_mfma_f32_16x16x32_bf16 v[160:163], a[132:135], v[140:143], v[160:163]
  ds_write_b128 v18, v[200:203] offset:14336
  v_mfma_f32_16x16x32_bf16 v[160:163], a[136:139], v[144:147], v[160:163]
  v_mfma_f32_16x16x32_bf16 v[160:163], a[140:143], v[148:151], v[160:163]
  ds_write_b64 v248, v[166:167] offset:64
  s_waitcnt lgkmcnt(0)
  s_mov_b32 s70, 10
.p2align 6
L_loop:
  v_mfma_f32_16x16x32_bf16 v[168:171], v[128:131], a[144:147], 0
  s_mov_b32 m0, s58
  ds_read_b64 v[108:109], v119 offset:256
  v_cndmask_b32 v110, v21, 2.0, s[52:53]
  v_mfma_f32_16x16x32_bf16 v[168:171], v[132:135], a[148:151], v[168:171]
  buffer_load_dwordx4 v110, s[4:7], s36 offen lds
  v_mfma_f32_16x16x32_bf16 v[168:171], v[136:139], a[152:155], v[168:171]
  v_cvt_pk_bf16_f32 v166, v160, v161
  v_cvt_pk_bf16_f32 v167, v162, v163
  v_mfma_f32_16x16x32_bf16 v[168:171], v[140:143], a[156:159], v[168:171]
  buffer_load_dwordx4 v110, s[4:7], s37 offen offset:864 lds
  v_mfma_f32_16x16x32_bf16 v[168:171], v[144:147], a[160:163], v[168:171]
  v_mfma_f32_16x16x32_bf16 v[168:171], v[148:151], a[164:167], v[168:171]
  s_waitcnt lgkmcnt(0)
  ds_read_b128 v[160:163], v15 offset:20480
  v_fma_f32 v184, v88, v108, v109
  v_mfma_f32_16x16x32_bf16 v[172:175], v[128:131], a[168:171], 0
  ds_read_b128 v[176:179], v18
  ds_read_b128 v[180:183], v15 offset:21504
  v_mfma_f32_16x16x32_bf16 v[172:175], v[132:135], a[172:175], v[172:175]
  ds_read_b128 v[188:191], v18 offset:6144
  v_cvt_pk_bf16_f32 v192, v168, v169
  v_mfma_f32_16x16x32_bf16 v[172:175], v[136:139], a[176:179], v[172:175]
  ds_read_b128 v[196:199], v15 offset:22528
  v_cvt_pk_bf16_f32 v193, v170, v171
  v_mfma_f32_16x16x32_bf16 v[172:175], v[140:143], a[180:183], v[172:175]
  ds_read_b128 v[168:171], v18 offset:1024
  v_fma_f32 v114, v89, v108, v109
  v_mfma_f32_16x16x32_bf16 v[172:175], v[144:147], a[184:187], v[172:175]
  ds_read_b128 v[200:203], v18 offset:7168
  v_cvt_pk_bf16_f32 v184, v184, v114
  v_mfma_f32_16x16x32_bf16 v[172:175], v[148:151], a[188:191], v[172:175]
  buffer_load_dwordx4 v110, s[4:7], s38 offen offset:1728 lds
  v_mfma_f32_16x16x32_bf16 v[204:207], v[128:131], a[192:195], 0
  ds_read_b128 v[128:131], v18 offset:2048
  v_fma_f32 v185, v90, v108, v109
  v_mfma_f32_16x16x32_bf16 v[204:207], v[132:135], a[196:199], v[204:207]
  ds_read_b128 v[132:135], v18 offset:8192
  v_cvt_pk_bf16_f32 v208, v172, v173
  v_mfma_f32_16x16x32_bf16 v[204:207], v[136:139], a[200:203], v[204:207]
  ds_read_b128 v[136:139], v15 offset:26624
  v_cvt_pk_bf16_f32 v209, v174, v175
  v_mfma_f32_16x16x32_bf16 v[204:207], v[140:143], a[204:207], v[204:207]
  ds_read_b128 v[140:143], v15 offset:27648
  v_fma_f32 v114, v91, v108, v109
  v_mfma_f32_16x16x32_bf16 v[204:207], v[144:147], a[208:211], v[204:207]
  ds_read_b128 v[144:147], v15 offset:28672
  v_cvt_pk_bf16_f32 v185, v185, v114
  v_mfma_f32_16x16x32_bf16 v[204:207], v[148:151], a[212:215], v[204:207]
  s_waitcnt lgkmcnt(11)
  buffer_load_dwordx4 v110, s[4:7], s39 offen offset:2592 lds
  v_mfma_f32_16x16x32_bf16 v[28:31], a[250:253], v[160:163], v[28:31]
  s_waitcnt lgkmcnt(9)
  v_fma_f32 v186, v92, v108, v109
  v_fma_f32 v114, v93, v108, v109
  v_mfma_f32_16x16x32_bf16 v[28:31], v[176:179], v[180:183], v[28:31]
  s_waitcnt lgkmcnt(7)
  buffer_load_dwordx4 v110, s[4:7], s40 offen offset:3456 lds
  v_mfma_f32_16x16x32_bf16 v[28:31], v[188:191], v[196:199], v[28:31]
  s_mov_b32 m0, s59
  v_cvt_pk_bf16_f32 v212, v204, v205
  v_cvt_pk_bf16_f32 v213, v206, v207
  v_mfma_f32_16x16x32_bf16 v[32:35], v[100:103], v[160:163], v[32:35]
  s_waitcnt lgkmcnt(6)
  buffer_load_dwordx4 v110, s[4:7], s41 offen lds
  v_mfma_f32_16x16x32_bf16 v[32:35], v[168:171], v[180:183], v[32:35]
  s_waitcnt lgkmcnt(5)
  v_cvt_pk_bf16_f32 v186, v186, v114
  v_fma_f32 v187, v94, v108, v109
  v_mfma_f32_16x16x32_bf16 v[32:35], v[200:203], v[196:199], v[32:35]
  ds_read_b128 v[148:151], v15 offset:32768
  v_fma_f32 v114, v95, v108, v109
  v_mfma_f32_16x16x32_bf16 v[36:39], v[104:107], v[160:163], v[36:39]
  s_waitcnt lgkmcnt(5)
  ds_read_b128 v[172:175], v15 offset:33792
  v_cvt_pk_bf16_f32 v187, v187, v114
  v_mfma_f32_16x16x32_bf16 v[36:39], v[128:131], v[180:183], v[36:39]
  s_waitcnt lgkmcnt(5)
  ds_read_b128 v[180:183], v15 offset:34816
  v_fma_f32 v112, v96, v108, v109
  v_mfma_f32_16x16x32_bf16 v[36:39], v[132:135], v[196:199], v[36:39]
  s_waitcnt lgkmcnt(5)
  buffer_load_dwordx4 v110, s[4:7], s42 offen offset:864 lds
  v_mfma_f32_16x16x32_bf16 v[40:43], a[250:253], v[136:139], v[40:43]
  s_waitcnt lgkmcnt(4)
  v_fma_f32 v114, v97, v108, v109
  v_cvt_pk_bf16_f32 v112, v112, v114
  v_mfma_f32_16x16x32_bf16 v[40:43], v[176:179], v[140:143], v[40:43]
  s_waitcnt lgkmcnt(3)
  buffer_load_dwordx4 v110, s[4:7], s43 offen offset:1728 lds
  v_mfma_f32_16x16x32_bf16 v[40:43], v[188:191], v[144:147], v[40:43]
  v_fma_f32 v113, v98, v108, v109
  v_fma_f32 v114, v99, v108, v109
  v_mfma_f32_16x16x32_bf16 v[44:47], v[100:103], v[136:139], v[44:47]
  buffer_load_dwordx4 v110, s[4:7], s44 offen offset:2592 lds
  v_mfma_f32_16x16x32_bf16 v[44:47], v[168:171], v[140:143], v[44:47]
  s_lshl_b32 s60, s31, 5
  v_cvt_pk_bf16_f32 v113, v113, v114
  v_mfma_f32_16x16x32_bf16 v[44:47], v[200:203], v[144:147], v[44:47]
  s_add_u32 s61, s60, s30
  ds_read_b128 v[196:199], v18 offset:9216
  ds_read_b128 v[160:163], v15 offset:23552
  v_mfma_f32_16x16x32_bf16 v[48:51], v[104:107], v[136:139], v[48:51]
  s_add_u32 s60, s60, s29
  ds_read_b128 v[204:207], v18 offset:3072
  v_mfma_f32_16x16x32_bf16 v[48:51], v[128:131], v[140:143], v[48:51]
  s_mul_i32 s62, s60, 7183
  ds_read_b128 v[140:143], v15 offset:24576
  v_mfma_f32_16x16x32_bf16 v[48:51], v[132:135], v[144:147], v[48:51]
  s_waitcnt lgkmcnt(6)
  ds_read_b128 v[216:219], v18 offset:12288
  v_mfma_f32_16x16x32_bf16 v[52:55], a[250:253], v[148:151], v[52:55]
  s_waitcnt lgkmcnt(6)
  ds_read_b128 v[144:147], v15 offset:25600
  v_mfma_f32_16x16x32_bf16 v[52:55], v[176:179], v[172:175], v[52:55]
  s_waitcnt lgkmcnt(6)
  ds_read_b128 v[176:179], v18 offset:10240
  v_mfma_f32_16x16x32_bf16 v[52:55], v[188:191], v[180:183], v[52:55]
  s_lshr_b32 s62, s62, 22
  ds_read_b128 v[188:191], v18 offset:4096
  v_mfma_f32_16x16x32_bf16 v[56:59], v[100:103], v[148:151], v[56:59]
  s_mul_i32 s63, s62, 584
  ds_read_b128 v[220:223], v18 offset:13312
  v_mfma_f32_16x16x32_bf16 v[56:59], v[168:171], v[172:175], v[56:59]
  s_sub_u32 s63, s60, s63
  ds_read_b128 v[224:227], v18 offset:11264
  v_mfma_f32_16x16x32_bf16 v[56:59], v[200:203], v[180:183], v[56:59]
  s_lshr_b32 s64, s63, 3
  ds_read_b128 v[200:203], v18 offset:5120
  v_mfma_f32_16x16x32_bf16 v[60:63], v[104:107], v[148:151], v[60:63]
  s_and_b32 s65, s63, 7
  ds_read_b128 v[228:231], v18 offset:14336
  v_mfma_f32_16x16x32_bf16 v[60:63], v[128:131], v[172:175], v[60:63]
  s_lshl_b32 s66, s62, 3
  ds_read_b128 v[128:131], v15 offset:29696
  v_mfma_f32_16x16x32_bf16 v[60:63], v[132:135], v[180:183], v[60:63]
  s_waitcnt lgkmcnt(11)
  ds_read_b128 v[132:135], v15 offset:30720
  v_mfma_f32_16x16x32_bf16 v[28:31], v[196:199], v[160:163], v[28:31]
  s_waitcnt lgkmcnt(10)
  ds_read_b128 v[172:175], v15 offset:31744
  v_mfma_f32_16x16x32_bf16 v[28:31], v[204:207], v[140:143], v[28:31]
  s_waitcnt lgkmcnt(9)
  v_mfma_f32_16x16x32_bf16 v[28:31], v[216:219], v[144:147], v[28:31]
  s_waitcnt lgkmcnt(8)
  v_mfma_f32_16x16x32_bf16 v[32:35], v[176:179], v[160:163], v[32:35]
  s_waitcnt lgkmcnt(7)
  v_mfma_f32_16x16x32_bf16 v[32:35], v[188:191], v[140:143], v[32:35]
  s_waitcnt lgkmcnt(6)
  v_cvt_pk_bf16_f32 v168, v28, v29
  v_cvt_pk_bf16_f32 v169, v30, v31
  v_mfma_f32_16x16x32_bf16 v[32:35], v[220:223], v[144:147], v[32:35]
  s_waitcnt lgkmcnt(5)
  ds_read_b128 v[180:183], v15 offset:35840
  v_mfma_f32_16x16x32_bf16 v[36:39], v[224:227], v[160:163], v[36:39]
  s_waitcnt lgkmcnt(5)
  ds_read_b128 v[160:163], v15 offset:36864
  v_mfma_f32_16x16x32_bf16 v[36:39], v[200:203], v[140:143], v[36:39]
  s_waitcnt lgkmcnt(5)
  ds_read_b128 v[232:235], v15 offset:37888
  v_cvt_pk_bf16_f32 v170, v32, v33
  v_mfma_f32_16x16x32_bf16 v[36:39], v[228:231], v[144:147], v[36:39]
  s_waitcnt lgkmcnt(5)
  v_cvt_pk_bf16_f32 v171, v34, v35
  v_mfma_f32_16x16x32_bf16 v[40:43], v[196:199], v[128:131], v[40:43]
  s_waitcnt lgkmcnt(4)
  v_permlane16_swap_b32 v168, v170
  v_mfma_f32_16x16x32_bf16 v[40:43], v[204:207], v[132:135], v[40:43]
  s_waitcnt vmcnt(4) lgkmcnt(3)
  ds_read_b64 v[108:109], v9
  v_cvt_pk_bf16_f32 v236, v36, v37
  v_mfma_f32_16x16x32_bf16 v[40:43], v[216:219], v[172:175], v[40:43]
  s_add_u32 s65, s65, s66
  ds_read_b64 v[116:117], v9 offset:32
  v_cvt_pk_bf16_f32 v237, v38, v39
  v_mfma_f32_16x16x32_bf16 v[44:47], v[176:179], v[128:131], v[44:47]
  s_cmp_ge_u32 s60, 5256
  ds_read_b64 v[120:121], v9 offset:64
  v_mfma_f32_16x16x32_bf16 v[44:47], v[188:191], v[132:135], v[44:47]
  s_cselect_b32 s64, s63, s64
  ds_read_b128 v[144:147], v3
  ds_read_b128 v[148:151], v3 offset:864
  v_mfma_f32_16x16x32_bf16 v[44:47], v[220:223], v[172:175], v[44:47]
  s_cselect_b32 s65, 72, s65
  ds_read_b128 v[136:139], v3 offset:1728
  v_cvt_pk_bf16_f32 v240, v40, v41
  v_mfma_f32_16x16x32_bf16 v[48:51], v[224:227], v[128:131], v[48:51]
  s_mul_i32 s66, s65, 1373568
  ds_read_b128 v[140:143], v6
  v_cvt_pk_bf16_f32 v241, v42, v43
  v_mfma_f32_16x16x32_bf16 v[48:51], v[200:203], v[132:135], v[48:51]
  s_mul_i32 s67, s64, 2688
  v_permlane16_swap_b32 v169, v171
  v_mfma_f32_16x16x32_bf16 v[48:51], v[228:231], v[172:175], v[48:51]
  s_waitcnt lgkmcnt(9)
  buffer_store_dwordx4 v[168:171], v12, s[8:11], s32 offen
  v_cvt_pk_bf16_f32 v242, v44, v45
  v_mfma_f32_16x16x32_bf16 v[52:55], v[196:199], v[180:183], v[52:55]
  s_waitcnt lgkmcnt(8)
  ds_read_b128 v[128:131], v3 offset:32
  ds_read_b128 v[132:135], v3 offset:896
  v_mfma_f32_16x16x32_bf16 v[52:55], v[204:207], v[160:163], v[52:55]
  s_waitcnt lgkmcnt(9)
  ds_read_b128 v[168:171], v3 offset:1760
  v_cvt_pk_bf16_f32 v243, v46, v47
  v_mfma_f32_16x16x32_bf16 v[52:55], v[216:219], v[232:235], v[52:55]
  s_waitcnt lgkmcnt(5)
  ds_read_b128 v[172:175], v6 offset:32
  v_permlane16_swap_b32 v240, v242
  v_mfma_f32_16x16x16_bf16 v[28:31], a[224:225], v[108:109], 0
  v_permlane16_swap_b32 v241, v243
  v_cvt_pk_bf16_f32 v238, v48, v49
  v_mfma_f32_16x16x16_bf16 v[32:35], a[234:235], v[116:117], 0
  v_cvt_pk_bf16_f32 v239, v50, v51
  v_permlane16_swap_b32 v236, v238
  v_mfma_f32_16x16x16_bf16 v[36:39], a[244:245], v[120:121], 0
  v_permlane16_swap_b32 v237, v239
  v_cvt_pk_bf16_f32 v216, v52, v53
  v_cvt_pk_bf16_f32 v217, v54, v55
  v_smfmac_f32_16x16x64_bf16 v[28:31], a[216:219], v[144:151], v0
  s_waitcnt lgkmcnt(4)
  ds_read_b128 v[144:147], v3 offset:64
  ds_read_b128 v[148:151], v3 offset:928
  v_smfmac_f32_16x16x64_bf16 v[28:31], a[220:223], v[136:143], v0
  s_add_u32 s35, s66, s67
  ds_read_b128 v[136:139], v3 offset:1792
  v_mfma_f32_16x16x32_bf16 v[56:59], v[176:179], v[180:183], v[56:59]
  s_cmp_ge_u32 s61, 667
  ds_read_b128 v[140:143], v6 offset:64
  v_mfma_f32_16x16x32_bf16 v[56:59], v[188:191], v[160:163], v[56:59]
  s_cselect_b32 s35, 268435456, s35
  ds_read_b128 v[188:191], v15 offset:8192
  v_mul_f32 v110, v28, v28
  v_mfma_f32_16x16x32_bf16 v[56:59], v[220:223], v[232:235], v[56:59]
  s_waitcnt lgkmcnt(7)
  ds_read_b128 v[220:223], v15 offset:9216
  v_add_f32 v114, v28, v29
  v_smfmac_f32_16x16x64_bf16 v[32:35], a[226:229], v[128:135], v0
  s_waitcnt lgkmcnt(6)
  ds_read_b128 v[204:207], v15 offset:10240
  v_fmac_f32 v110, v29, v29
  v_smfmac_f32_16x16x64_bf16 v[32:35], a[230:233], v[168:175], v0
  s_cmp_ge_u32 s60, 5329
  ds_read_b128 v[196:199], v15 offset:11264
  v_cvt_pk_bf16_f32 v218, v56, v57
  v_mfma_f32_16x16x32_bf16 v[60:63], v[224:227], v[180:183], v[60:63]
  s_waitcnt vmcnt(3)
  ds_read_b128 v[224:227], v15 offset:12288
  v_cvt_pk_bf16_f32 v219, v58, v59
  v_mfma_f32_16x16x32_bf16 v[60:63], v[200:203], v[160:163], v[60:63]
  s_cselect_b32 s35, 268435456, s35
  ds_read_b128 v[160:163], v15 offset:13312
  v_add_f32 v114, v114, v30
  v_mfma_f32_16x16x32_bf16 v[60:63], v[228:231], v[232:235], v[60:63]
  s_waitcnt lgkmcnt(8)
  buffer_store_dwordx4 v[240:243], v13, s[8:11], s32 offen
  ds_read_b64 v[120:121], v10
  v_smfmac_f32_16x16x64_bf16 v[36:39], a[236:239], v[144:151], v0
  s_waitcnt lgkmcnt(7)
  ds_read_b64 v[116:117], v10 offset:32
  ds_read_b64 v[108:109], v10 offset:64
  v_smfmac_f32_16x16x64_bf16 v[36:39], a[240:243], v[136:143], v0
  s_waitcnt lgkmcnt(8)
  ds_read_b128 v[136:139], v4
  v_cvt_pk_bf16_f32 v124, v60, v61
  v_mfma_f32_16x16x32_bf16 v[180:183], a[72:75], v[188:191], 0
  s_waitcnt lgkmcnt(8)
  ds_read_b128 v[140:143], v4 offset:864
  v_cvt_pk_bf16_f32 v125, v62, v63
  v_mfma_f32_16x16x32_bf16 v[180:183], a[76:79], v[220:223], v[180:183]
  s_waitcnt lgkmcnt(8)
  ds_read_b128 v[144:147], v4 offset:1728
  v_fmac_f32 v110, v30, v30
  v_mfma_f32_16x16x32_bf16 v[180:183], a[80:83], v[204:207], v[180:183]
  s_waitcnt lgkmcnt(8)
  ds_read_b128 v[148:151], v7
  v_add_f32 v114, v114, v31
  v_mfma_f32_16x16x32_bf16 v[180:183], a[84:87], v[196:199], v[180:183]
  s_waitcnt lgkmcnt(8)
  ds_read_b128 v[168:171], v4 offset:32
  v_fmac_f32 v110, v31, v31
  v_mfma_f32_16x16x32_bf16 v[180:183], a[88:91], v[224:227], v[180:183]
  s_waitcnt lgkmcnt(8)
  ds_read_b128 v[172:175], v4 offset:896
  v_add_f32 v114, v114, v32
  v_mfma_f32_16x16x32_bf16 v[180:183], a[92:95], v[160:163], v[180:183]
  s_waitcnt lgkmcnt(6)
  ds_read_b128 v[128:131], v4 offset:1760
  v_permlane16_swap_b32 v216, v218
  v_mfma_f32_16x16x16_bf16 v[40:43], a[224:225], v[120:121], 0
  v_permlane16_swap_b32 v217, v219
  v_fmac_f32 v110, v32, v32
  v_mfma_f32_16x16x16_bf16 v[44:47], a[234:235], v[116:117], 0
  v_cvt_pk_bf16_f32 v240, v180, v181
  v_cvt_pk_bf16_f32 v241, v182, v183
  v_add_f32 v114, v114, v33
  v_mfma_f32_16x16x16_bf16 v[48:51], a[244:245], v[108:109], 0
  s_cmp_eq_u32 s65, 0
  ds_read_b128 v[132:135], v7 offset:32
  ds_read_b128 v[176:179], v4 offset:64
  s_waitcnt lgkmcnt(7)
  v_smfmac_f32_16x16x64_bf16 v[40:43], a[216:219], v[136:143], v0
  s_waitcnt lgkmcnt(5)
  ds_read_b128 v[180:183], v4 offset:928
  v_fmac_f32 v110, v33, v33
  v_smfmac_f32_16x16x64_bf16 v[40:43], a[220:223], v[144:151], v0
  s_cselect_b32 s36, 268435456, s35
  ds_read_b128 v[144:147], v4 offset:1792
  v_add_f32 v114, v114, v34
  v_mfma_f32_16x16x32_bf16 v[136:139], a[96:99], v[188:191], 0
  s_add_u32 s37, s35, 195360
  ds_read_b128 v[148:151], v7 offset:64
  v_fmac_f32 v110, v34, v34
  v_mfma_f32_16x16x32_bf16 v[136:139], a[100:103], v[220:223], v[136:139]
  s_add_u32 s38, s35, 390720
  ds_write_b128 v16, v[184:187] offset:14336
  v_mfma_f32_16x16x32_bf16 v[136:139], a[104:107], v[204:207], v[136:139]
  s_waitcnt lgkmcnt(7)
  buffer_store_dwordx4 v[236:239], v22, s[8:11], s32 offen
  v_mul_f32 v122, v40, v40
  v_smfmac_f32_16x16x64_bf16 v[44:47], a[226:229], v[168:175], v0
  s_waitcnt lgkmcnt(5)
  ds_write_b64 v17, v[112:113] offset:14336
  v_smfmac_f32_16x16x64_bf16 v[44:47], a[230:233], v[128:135], v0
  s_add_u32 s39, s35, 586080
  v_add_f32 v126, v40, v41
  v_mfma_f32_16x16x32_bf16 v[136:139], a[108:111], v[196:199], v[136:139]
  s_waitcnt vmcnt(3)
  ds_read_b64 v[108:109], v11
  v_fmac_f32 v122, v41, v41
  v_mfma_f32_16x16x32_bf16 v[136:139], a[112:115], v[224:227], v[136:139]
  s_add_u32 s40, s35, 781440
  ds_read_b64 v[112:113], v11 offset:32
  v_add_f32 v126, v126, v42
  v_mfma_f32_16x16x32_bf16 v[136:139], a[116:119], v[160:163], v[136:139]
  s_waitcnt lgkmcnt(6)
  ds_read_b64 v[120:121], v11 offset:64
  v_fmac_f32 v122, v42, v42
  v_smfmac_f32_16x16x64_bf16 v[48:51], a[236:239], v[176:183], v0
  s_waitcnt lgkmcnt(5)
  ds_read_b128 v[176:179], v5
  ds_read_b128 v[180:183], v5 offset:864
  v_smfmac_f32_16x16x64_bf16 v[48:51], a[240:243], v[144:151], v0
  s_add_u32 s41, s35, 981120
  ds_read_b128 v[144:147], v5 offset:1728
  v_cvt_pk_bf16_f32 v242, v136, v137
  v_mfma_f32_16x16x32_bf16 v[236:239], a[120:123], v[188:191], 0
  s_add_u32 s42, s35, 1176480
  ds_read_b128 v[148:151], v8
  v_cvt_pk_bf16_f32 v243, v138, v139
  v_mfma_f32_16x16x32_bf16 v[236:239], a[124:127], v[220:223], v[236:239]
  s_add_u32 s43, s35, 1371840
  v_add_f32 v126, v126, v43
  v_fmac_f32 v122, v43, v43
  v_mfma_f32_16x16x32_bf16 v[236:239], a[128:131], v[204:207], v[236:239]
  s_add_u32 s44, s35, 1567200
  v_add_f32 v126, v126, v44
  v_fmac_f32 v122, v44, v44
  v_mfma_f32_16x16x32_bf16 v[236:239], a[132:135], v[196:199], v[236:239]
  s_cmp_eq_u32 s64, 0
  ds_read_b128 v[128:131], v5 offset:32
  ds_read_b128 v[132:135], v5 offset:896
  v_mfma_f32_16x16x32_bf16 v[236:239], a[136:139], v[224:227], v[236:239]
  s_cselect_b64 s[52:53], s[48:49], 0
  ds_read_b128 v[168:171], v5 offset:1760
  v_add_f32 v126, v126, v45
  v_mfma_f32_16x16x32_bf16 v[236:239], a[140:143], v[160:163], v[236:239]
  s_waitcnt lgkmcnt(5)
  ds_read_b128 v[172:175], v8 offset:32
  v_fmac_f32 v122, v45, v45
  v_add_f32 v126, v126, v46
  v_mfma_f32_16x16x16_bf16 v[52:55], a[224:225], v[108:109], 0
  v_fmac_f32 v122, v46, v46
  v_add_f32 v114, v114, v35
  v_fmac_f32 v110, v35, v35
  v_mfma_f32_16x16x16_bf16 v[56:59], a[234:235], v[112:113], 0
  v_cvt_pk_bf16_f32 v228, v236, v237
  v_cvt_pk_bf16_f32 v229, v238, v239
  v_add_f32 v126, v126, v47
  v_mfma_f32_16x16x16_bf16 v[60:63], a[244:245], v[120:121], 0
  v_fmac_f32 v122, v47, v47
  v_add_f32 v114, v114, v36
  v_fmac_f32 v110, v36, v36
  v_add_f32 v126, v126, v48
  v_smfmac_f32_16x16x64_bf16 v[52:55], a[216:219], v[176:183], v0
  s_waitcnt lgkmcnt(4)
  buffer_store_dwordx4 v[216:219], v14, s[8:11], s32 offen
  ds_read_b128 v[176:179], v5 offset:64
  v_smfmac_f32_16x16x64_bf16 v[52:55], a[220:223], v[144:151], v0
  s_cmp_eq_u32 s64, 72
  ds_read_b128 v[180:183], v5 offset:928
  ds_read_b128 v[144:147], v5 offset:1792
  v_mfma_f32_16x16x32_bf16 v[216:219], a[0:3], v[188:191], 0
  s_cselect_b64 s[52:53], s[50:51], s[52:53]
  ds_read_b128 v[148:151], v8 offset:64
  v_fmac_f32 v122, v48, v48
  v_mfma_f32_16x16x32_bf16 v[216:219], a[4:7], v[220:223], v[216:219]
  s_add_u32 s31, s31, 1
  v_mul_f32 v118, v52, v52
  v_add_f32 v108, v52, v53
  v_mfma_f32_16x16x32_bf16 v[216:219], a[8:11], v[204:207], v[216:219]
  s_waitcnt lgkmcnt(6)
  v_fmac_f32 v118, v53, v53
  v_add_f32 v108, v108, v54
  v_smfmac_f32_16x16x64_bf16 v[56:59], a[226:229], v[128:135], v0
  s_waitcnt lgkmcnt(4)
  v_fmac_f32 v118, v54, v54
  v_smfmac_f32_16x16x64_bf16 v[56:59], a[230:233], v[168:175], v0
  s_sub_u32 s68, s35, 196608
  v_add_f32 v108, v108, v55
  v_mfma_f32_16x16x32_bf16 v[216:219], a[12:15], v[196:199], v[216:219]
  s_cselect_b32 s68, s35, s68
  v_fmac_f32 v118, v55, v55
  v_add_f32 v114, v114, v37
  v_mfma_f32_16x16x32_bf16 v[216:219], a[16:19], v[224:227], v[216:219]
  v_add_f32 v108, v108, v56
  v_fmac_f32 v118, v56, v56
  v_mfma_f32_16x16x32_bf16 v[216:219], a[20:23], v[160:163], v[216:219]
  s_waitcnt lgkmcnt(2)
  v_add_f32 v108, v108, v57
  v_fmac_f32 v118, v57, v57
  v_smfmac_f32_16x16x64_bf16 v[60:63], a[236:239], v[176:183], v0
  s_waitcnt lgkmcnt(0)
  v_add_f32 v108, v108, v58
  v_smfmac_f32_16x16x64_bf16 v[60:63], a[240:243], v[144:151], v0
  v_cvt_pk_bf16_f32 v128, v216, v217
  v_mfma_f32_16x16x32_bf16 v[144:147], a[24:27], v[188:191], 0
  v_cvt_pk_bf16_f32 v129, v218, v219
  v_fmac_f32 v118, v58, v58
  v_mfma_f32_16x16x32_bf16 v[144:147], a[28:31], v[220:223], v[144:147]
  v_add_f32 v108, v108, v59
  v_fmac_f32 v118, v59, v59
  v_mfma_f32_16x16x32_bf16 v[144:147], a[32:35], v[204:207], v[144:147]
  v_add_f32 v108, v108, v60
  v_fmac_f32 v118, v60, v60
  v_mfma_f32_16x16x32_bf16 v[144:147], a[36:39], v[196:199], v[144:147]
  v_add_f32 v108, v108, v61
  v_fmac_f32 v118, v61, v61
  v_mfma_f32_16x16x32_bf16 v[144:147], a[40:43], v[224:227], v[144:147]
  buffer_store_dwordx2 v[124:125], v23, s[8:11], s32 offen
  v_fmac_f32 v110, v37, v37
  v_mfma_f32_16x16x32_bf16 v[144:147], a[44:47], v[160:163], v[144:147]
  s_mov_b32 s32, s33
  v_add_f32 v126, v126, v49
  v_fmac_f32 v122, v49, v49
  v_mfma_f32_16x16x32_bf16 v[216:219], a[48:51], v[188:191], 0
  s_mov_b32 s33, s34
  v_add_f32 v108, v108, v62
  v_fmac_f32 v118, v62, v62
  v_mfma_f32_16x16x32_bf16 v[216:219], a[52:55], v[220:223], v[216:219]
  s_mov_b32 s34, s35
  ds_read_b64 v[116:117], v19 offset:784
  v_cvt_pk_bf16_f32 v130, v144, v145
  v_mfma_f32_16x16x32_bf16 v[216:219], a[56:59], v[204:207], v[216:219]
  buffer_load_dword v25, v24, s[24:27], s68 offen
  v_mfma_f32_16x16x32_bf16 v[216:219], a[60:63], v[196:199], v[216:219]
  s_cmp_eq_u32 s70, 1
  v_cvt_pk_bf16_f32 v131, v146, v147
  v_add_f32 v114, v114, v38
  v_mfma_f32_16x16x32_bf16 v[216:219], a[64:67], v[224:227], v[216:219]
  s_cbranch_scc1 L_cpf
L_cpf_ret:
  ds_read2_b64 v[144:147], v19 offset0:96 offset1:97
  v_fmac_f32 v110, v38, v38
  v_mfma_f32_16x16x32_bf16 v[216:219], a[68:71], v[160:163], v[216:219]
  v_add_f32 v126, v126, v50
  v_fmac_f32 v122, v50, v50
  v_mfma_f32_16x16x32_bf16 v[148:151], v[188:191], a[144:147], 0
  v_add_f32 v108, v108, v63
  v_fmac_f32 v118, v63, v63
  v_mfma_f32_16x16x32_bf16 v[148:151], v[220:223], a[148:151], v[148:151]
  v_add_f32 v114, v114, v39
  v_fmac_f32 v110, v39, v39
  v_mfma_f32_16x16x32_bf16 v[148:151], v[204:207], a[152:155], v[148:151]
  v_add_f32 v126, v126, v51
  v_fmac_f32 v122, v51, v51
  v_mfma_f32_16x16x32_bf16 v[148:151], v[196:199], a[156:159], v[148:151]
  v_permlane32_swap_b32 v108, v118
  v_mfma_f32_16x16x32_bf16 v[148:151], v[224:227], a[160:163], v[148:151]
  v_permlane32_swap_b32 v114, v110
  v_mfma_f32_16x16x32_bf16 v[148:151], v[160:163], a[164:167], v[148:151]
  v_permlane32_swap_b32 v126, v122
  v_mfma_f32_16x16x32_bf16 v[176:179], v[188:191], a[168:171], 0
  v_add_f32 v108, v108, v118
  v_add_f32 v114, v114, v110
  v_mfma_f32_16x16x32_bf16 v[176:179], v[220:223], a[172:175], v[176:179]
  v_add_f32 v126, v126, v122
  v_mov_b32 v110, v108
  v_mfma_f32_16x16x32_bf16 v[176:179], v[204:207], a[176:179], v[176:179]
  v_cvt_pk_bf16_f32 v124, v216, v217
  v_cvt_pk_bf16_f32 v125, v218, v219
  v_mfma_f32_16x16x32_bf16 v[176:179], v[196:199], a[180:183], v[176:179]
  v_permlane16_swap_b32 v114, v126
  v_mfma_f32_16x16x32_bf16 v[176:179], v[224:227], a[184:187], v[176:179]
  v_permlane16_swap_b32 v108, v110
  v_mfma_f32_16x16x32_bf16 v[176:179], v[160:163], a[188:191], v[176:179]
  s_waitcnt lgkmcnt(0)
  v_add_f32 v114, v114, v126
  v_add_f32 v108, v108, v110
  v_cvt_pk_bf16_f32 v194, v148, v149
  v_mfma_f32_16x16x16_bf16 v[216:219], v[116:117], v[166:167], 0
  v_cvt_pk_bf16_f32 v195, v150, v151
  v_mfma_f32_16x16x16_bf16 v[148:151], v[116:117], v[228:229], 0
  ds_write_b32 v111, v114
  v_cvt_pk_bf16_f32 v210, v176, v177
  v_mfma_f32_16x16x16_bf16 v[132:135], v[166:167], v[164:165], 0
  v_cvt_pk_bf16_f32 v211, v178, v179
  v_mfma_f32_16x16x16_bf16 v[176:179], v[228:229], v[164:165], 0
  ds_write_b32 v111, v108 offset:512
  v_mfma_f32_16x16x32_bf16 v[216:219], v[144:147], v[156:159], v[216:219]
  v_mfma_f32_16x16x32_bf16 v[148:151], v[144:147], v[240:243], v[148:151]
  v_mfma_f32_16x16x32_bf16 v[132:135], v[156:159], v[152:155], v[132:135]
  v_mfma_f32_16x16x32_bf16 v[176:179], v[240:243], v[152:155], v[176:179]
  s_waitcnt lgkmcnt(1)
  v_cndmask_b32 v184, v148, v216, s[56:57]
  s_waitcnt lgkmcnt(0)
  s_barrier
  v_mfma_f32_16x16x32_bf16 v[148:151], v[188:191], a[192:195], 0
  ds_read_b128 v[136:139], v15 offset:14336
  ds_read_b128 v[140:143], v15 offset:15360
  v_mfma_f32_16x16x32_bf16 v[148:151], v[220:223], a[196:199], v[148:151]
  ds_read_b128 v[220:223], v15 offset:16384
  v_mfma_f32_16x16x32_bf16 v[148:151], v[204:207], a[200:203], v[148:151]
  ds_read_b128 v[204:207], v15 offset:17408
  v_mfma_f32_16x16x32_bf16 v[148:151], v[196:199], a[204:207], v[148:151]
  ds_read_b128 v[196:199], v15 offset:18432
  v_mfma_f32_16x16x32_bf16 v[148:151], v[224:227], a[208:211], v[148:151]
  ds_read_b128 v[224:227], v15 offset:19456
  v_mfma_f32_16x16x32_bf16 v[148:151], v[160:163], a[212:215], v[148:151]
  ds_read_b128 v[160:163], v15
  v_exp_f32 v132, v132
  v_mfma_f32_16x16x16_bf16 v[188:191], v[166:167], v[124:125], 0
  v_exp_f32 v133, v133
  v_mfma_f32_16x16x16_bf16 v[216:219], v[228:229], v[124:125], 0
  ds_read_b128 v[180:183], v15 offset:1024
  v_exp_f32 v134, v134
  v_cvt_pk_bf16_f32 v214, v148, v149
  v_mfma_f32_16x16x32_bf16 v[188:191], v[156:159], v[128:131], v[188:191]
  v_exp_f32 v135, v135
  v_mfma_f32_16x16x32_bf16 v[216:219], v[240:243], v[128:131], v[216:219]
  s_waitcnt lgkmcnt(7)
  v_exp_f32 v176, v176
  v_mfma_f32_16x16x32_bf16 v[168:171], a[72:75], v[136:139], 0
  s_waitcnt lgkmcnt(6)
  v_exp_f32 v177, v177
  v_mfma_f32_16x16x32_bf16 v[168:171], a[76:79], v[140:143], v[168:171]
  s_waitcnt lgkmcnt(1)
  v_exp_f32 v178, v178
  v_mfma_f32_16x16x32_bf16 v[168:171], a[80:83], v[220:223], v[168:171]
  s_waitcnt lgkmcnt(0)
  v_exp_f32 v179, v179
  v_mfma_f32_16x16x32_bf16 v[168:171], a[84:87], v[204:207], v[168:171]
  v_cvt_pk_bf16_f32 v215, v150, v151
  v_cvt_pk_bf16_f32 v148, v132, v133
  v_mfma_f32_16x16x32_bf16 v[168:171], a[88:91], v[196:199], v[168:171]
  v_exp_f32 v188, v188
  v_mfma_f32_16x16x32_bf16 v[168:171], a[92:95], v[224:227], v[168:171]
  v_exp_f32 v189, v189
  v_mfma_f32_16x16x32_bf16 v[172:175], a[96:99], v[136:139], 0
  v_exp_f32 v190, v190
  v_mfma_f32_16x16x32_bf16 v[172:175], a[100:103], v[140:143], v[172:175]
  v_exp_f32 v191, v191
  v_mfma_f32_16x16x32_bf16 v[172:175], a[104:107], v[220:223], v[172:175]
  ds_read_b64 v[230:231], v19 offset:16
  v_cvt_pk_bf16_f32 v149, v134, v135
  v_mfma_f32_16x16x32_bf16 v[172:175], a[108:111], v[204:207], v[172:175]
  v_exp_f32 v216, v216
  v_mfma_f32_16x16x32_bf16 v[172:175], a[112:115], v[196:199], v[172:175]
  v_exp_f32 v217, v217
  v_mfma_f32_16x16x32_bf16 v[172:175], a[116:119], v[224:227], v[172:175]
  v_exp_f32 v218, v218
  v_mfma_f32_16x16x32_bf16 v[132:135], a[120:123], v[136:139], 0
  v_exp_f32 v219, v219
  v_mfma_f32_16x16x32_bf16 v[132:135], a[124:127], v[140:143], v[132:135]
  v_cvt_pk_bf16_f32 v150, v176, v177
  v_cvt_pk_bf16_f32 v151, v178, v179
  v_mfma_f32_16x16x32_bf16 v[132:135], a[128:131], v[220:223], v[132:135]
  ds_read2_b64 v[176:179], v19 offset0:0 offset1:1
  v_cvt_pk_bf16_f32 v236, v168, v169
  v_mfma_f32_16x16x32_bf16 v[132:135], a[132:135], v[204:207], v[132:135]
  v_cvt_pk_bf16_f32 v237, v170, v171
  v_cvt_pk_bf16_f32 v168, v188, v189
  v_mfma_f32_16x16x32_bf16 v[132:135], a[136:139], v[196:199], v[132:135]
  v_cvt_pk_bf16_f32 v169, v190, v191
  v_cvt_pk_bf16_f32 v170, v216, v217
  v_mfma_f32_16x16x32_bf16 v[132:135], a[140:143], v[224:227], v[132:135]
  v_cvt_pk_bf16_f32 v238, v172, v173
  v_cvt_pk_bf16_f32 v239, v174, v175
  v_mfma_f32_16x16x32_bf16 v[172:175], v[136:139], a[144:147], 0
  v_cvt_pk_bf16_f32 v171, v218, v219
  v_add_f32 v160, v160, v161
  v_mfma_f32_16x16x32_bf16 v[172:175], v[140:143], a[148:151], v[172:175]
  v_cvt_pk_bf16_f32 v200, v132, v133
  v_cvt_pk_bf16_f32 v201, v134, v135
  v_mfma_f32_16x16x32_bf16 v[172:175], v[220:223], a[152:155], v[172:175]
  v_add_f32 v162, v162, v163
  v_add_f32 v180, v180, v181
  v_mfma_f32_16x16x32_bf16 v[172:175], v[204:207], a[156:159], v[172:175]
  v_add_f32 v182, v182, v183
  v_add_f32 v160, v160, v162
  v_mfma_f32_16x16x32_bf16 v[172:175], v[196:199], a[160:163], v[172:175]
  v_add_f32 v180, v180, v182
  v_mul_f32 v161, 0x3baaaaab, v160
  v_mfma_f32_16x16x32_bf16 v[172:175], v[224:227], a[164:167], v[172:175]
  s_waitcnt lgkmcnt(1)
  v_fma_f32 v180, -v161, v160, v180
  v_max_f32 v180, 0, v180
  v_add_f32 v180, 0x3afba882, v180
  v_mfma_f32_16x16x16_bf16 v[132:135], v[200:201], v[164:165], 0
  v_rsq_f32 v180, v180
  v_add_u32 v19, 1160, v19
  v_mfma_f32_16x16x16_bf16 v[216:219], v[230:231], v[164:165], v[2:5]
  v_cvt_pk_bf16_f32 v108, v172, v173
  v_cvt_pk_bf16_f32 v109, v174, v175
  v_mul_f32 v180, 0x40ca568a, v180
  v_mfma_f32_16x16x16_bf16 v[172:175], v[200:201], v[124:125], 0
  v_mul_f32 v181, -v161, v180
  v_mfma_f32_16x16x16_bf16 v[160:163], v[230:231], v[124:125], v[2:5]
  ds_write_b64 v115, v[180:181]
  ds_read_b64 v[164:165], v119
  v_mfma_f32_16x16x32_bf16 v[132:135], v[236:239], v[152:155], v[132:135]
  s_waitcnt lgkmcnt(2)
  ds_read_b64 v[202:203], v119 offset:128
  v_mfma_f32_16x16x32_bf16 v[216:219], v[176:179], v[152:155], v[216:219]
  v_mfma_f32_16x16x32_bf16 v[172:175], v[236:239], v[128:131], v[172:175]
  v_exp_f32 v132, v132
  v_mfma_f32_16x16x32_bf16 v[160:163], v[176:179], v[128:131], v[160:163]
  v_exp_f32 v133, v133
  v_mfma_f32_16x16x32_bf16 v[128:131], v[136:139], a[168:171], 0
  v_exp_f32 v134, v134
  v_mfma_f32_16x16x32_bf16 v[128:131], v[140:143], a[172:175], v[128:131]
  v_exp_f32 v135, v135
  v_mfma_f32_16x16x32_bf16 v[128:131], v[220:223], a[176:179], v[128:131]
  s_waitcnt lgkmcnt(0)
  v_exp_f32 v216, v216
  v_mfma_f32_16x16x32_bf16 v[128:131], v[204:207], a[180:183], v[128:131]
  v_exp_f32 v172, v172
  v_mfma_f32_16x16x32_bf16 v[128:131], v[196:199], a[184:187], v[128:131]
  v_exp_f32 v173, v173
  v_mfma_f32_16x16x32_bf16 v[128:131], v[224:227], a[188:191], v[128:131]
  v_exp_f32 v174, v174
  v_mfma_f32_16x16x32_bf16 v[152:155], v[136:139], a[192:195], 0
  v_exp_f32 v175, v175
  v_mfma_f32_16x16x32_bf16 v[152:155], v[140:143], a[196:199], v[152:155]
  v_exp_f32 v160, v160
  v_mfma_f32_16x16x32_bf16 v[152:155], v[220:223], a[200:203], v[152:155]
  ds_read_u16 v110, v20
  v_cvt_pk_bf16_f32 v120, v132, v133
  v_mfma_f32_16x16x32_bf16 v[152:155], v[204:207], a[204:207], v[152:155]
  v_cvt_pk_bf16_f32 v121, v134, v135
  v_cvt_pk_bf16_f32 v122, v216, 0
  v_mfma_f32_16x16x32_bf16 v[152:155], v[196:199], a[208:211], v[152:155]
  ds_read_u16 v114, v20 offset:32
  v_cvt_pk_bf16_f32 v124, v172, v173
  v_mfma_f32_16x16x32_bf16 v[152:155], v[224:227], a[212:215], v[152:155]
  v_cvt_pk_bf16_f32 v112, v128, v129
  v_cvt_pk_bf16_f32 v113, v130, v131
  v_cvt_pk_bf16_f32 v125, v174, v175
  v_mfma_f32_16x16x16_bf16 v[128:131], v[116:117], v[200:201], 0
  v_cvt_pk_bf16_f32 v126, v160, 0
  v_fma_f32 v132, v28, v164, v165
  v_fma_f32 v185, v29, v164, v165
  v_mfma_f32_16x16x16_bf16 v[160:163], v[116:117], v[230:231], 0
  v_cvt_pk_bf16_f32 v116, v152, v153
  v_cvt_pk_bf16_f32 v117, v154, v155
  v_cvt_pk_bf16_f32 v132, v132, v185
  v_fma_f32 v133, v30, v164, v165
  v_mfma_f32_16x16x32_bf16 v[128:131], v[144:147], v[236:239], v[128:131]
  ds_read_u16 v118, v20 offset:64
  v_fma_f32 v185, v31, v164, v165
  v_mfma_f32_16x16x32_bf16 v[160:163], v[144:147], v[176:179], v[160:163]
  v_cvt_pk_bf16_f32 v133, v133, v185
  v_fma_f32 v134, v32, v164, v165
  v_mfma_f32_16x16x32_bf16 v[144:147], a[0:3], v[136:139], 0
  v_fma_f32 v185, v33, v164, v165
  v_cvt_pk_bf16_f32 v134, v134, v185
  v_mfma_f32_16x16x32_bf16 v[144:147], a[4:7], v[140:143], v[144:147]
  v_cndmask_b32 v185, v128, v160, s[56:57]
  v_fma_f32 v135, v34, v164, v165
  v_mfma_f32_16x16x32_bf16 v[144:147], a[8:11], v[220:223], v[144:147]
  v_fma_f32 v186, v35, v164, v165
  v_cvt_pk_bf16_f32 v135, v135, v186
  v_mfma_f32_16x16x32_bf16 v[144:147], a[12:15], v[204:207], v[144:147]
  ds_write_b128 v16, v[132:135] offset:2048
  v_mfma_f32_16x16x32_bf16 v[144:147], a[16:19], v[196:199], v[144:147]
  v_cndmask_b32 v184, v185, v184, s[46:47]
  v_fma_f32 v172, v36, v164, v165
  v_mfma_f32_16x16x32_bf16 v[144:147], a[20:23], v[224:227], v[144:147]
  v_fma_f32 v185, v37, v164, v165
  v_cvt_pk_bf16_f32 v172, v172, v185
  v_mfma_f32_16x16x32_bf16 v[160:163], a[246:249], v[148:151], 0
  v_fma_f32 v173, v38, v164, v165
  v_fma_f32 v185, v39, v164, v165
  v_mfma_f32_16x16x32_bf16 v[160:163], a[246:249], v[120:123], v[160:163]
  v_cvt_pk_bf16_f32 v152, v144, v145
  v_cvt_pk_bf16_f32 v153, v146, v147
  v_mfma_f32_16x16x32_bf16 v[132:135], v[192:195], v[148:151], 0
  s_waitcnt lgkmcnt(3)
  v_cvt_pk_bf16_f32 v173, v173, v185
  v_fma_f32 v128, v40, v202, v203
  v_mfma_f32_16x16x32_bf16 v[132:135], v[108:111], v[120:123], v[132:135]
  ds_write_b64 v17, v[172:173] offset:2048
  v_mfma_f32_16x16x32_bf16 v[144:147], v[208:211], v[148:151], 0
  s_waitcnt lgkmcnt(3)
  v_exp_f32 v184, v184
  v_mfma_f32_16x16x32_bf16 v[144:147], v[112:115], v[120:123], v[144:147]
  v_cvt_pk_bf16_f32 v184, v184, 0
  v_mul_f32 v160, 0x3ee9a3cd, v160
  v_mfma_f32_16x16x32_bf16 v[172:175], v[212:215], v[148:151], 0
  s_waitcnt lgkmcnt(2)
  ds_write_b16 v26, v184
  v_mfma_f32_16x16x32_bf16 v[172:175], v[116:119], v[120:123], v[172:175]
  ds_read_b128 v[148:151], v27
  ds_read_b64 v[120:121], v27 offset:16
  v_mfma_f32_16x16x32_bf16 v[216:219], a[24:27], v[136:139], 0
  v_cndmask_b32 v122, 0, v184, s[54:55]
  v_fma_f32 v164, v41, v202, v203
  v_mfma_f32_16x16x32_bf16 v[216:219], a[28:31], v[140:143], v[216:219]
  v_rcp_f32 v232, v160
  v_mfma_f32_16x16x32_bf16 v[216:219], a[32:35], v[220:223], v[216:219]
  v_cvt_pk_bf16_f32 v128, v128, v164
  v_fma_f32 v129, v42, v202, v203
  v_mfma_f32_16x16x32_bf16 v[216:219], a[36:39], v[204:207], v[216:219]
  v_fma_f32 v164, v43, v202, v203
  v_cvt_pk_bf16_f32 v129, v129, v164
  v_mfma_f32_16x16x32_bf16 v[216:219], a[40:43], v[196:199], v[216:219]
  v_fma_f32 v130, v44, v202, v203
  v_fma_f32 v164, v45, v202, v203
  v_mfma_f32_16x16x32_bf16 v[216:219], a[44:47], v[224:227], v[216:219]
  v_cvt_pk_bf16_f32 v130, v130, v164
  v_fma_f32 v131, v46, v202, v203
  v_mfma_f32_16x16x32_bf16 v[180:183], a[246:249], v[168:171], 0
  v_fma_f32 v164, v47, v202, v203
  v_cvt_pk_bf16_f32 v131, v131, v164
  v_mfma_f32_16x16x32_bf16 v[180:183], a[246:249], v[124:127], v[180:183]
  ds_write_b128 v16, v[128:131] offset:8192
  v_mfma_f32_16x16x32_bf16 v[128:131], v[192:195], v[168:171], 0
  v_cvt_pk_bf16_f32 v154, v216, v217
  v_cvt_pk_bf16_f32 v155, v218, v219
  v_mfma_f32_16x16x32_bf16 v[128:131], v[108:111], v[124:127], v[128:131]
  v_mul_f32 v180, 0x3ee9a3cd, v180
  v_mul_f32 v132, v132, v232
  v_mfma_f32_16x16x32_bf16 v[216:219], v[208:211], v[168:171], 0
  v_rcp_f32 v233, v180
  v_mfma_f32_16x16x32_bf16 v[216:219], v[112:115], v[124:127], v[216:219]
  v_mul_f32 v133, v133, v232
  v_cvt_pk_bf16_f32 v188, v132, v133
  v_mfma_f32_16x16x32_bf16 v[184:187], v[212:215], v[168:171], 0
  v_mul_f32 v134, v134, v232
  v_mul_f32 v135, v135, v232
  v_mfma_f32_16x16x32_bf16 v[184:187], v[116:119], v[124:127], v[184:187]
  v_cvt_pk_bf16_f32 v189, v134, v135
  v_mul_f32 v144, v144, v232
  v_mfma_f32_16x16x32_bf16 v[132:135], a[48:51], v[136:139], 0
  v_mul_f32 v145, v145, v232
  v_cvt_pk_bf16_f32 v190, v144, v145
  v_mfma_f32_16x16x32_bf16 v[132:135], a[52:55], v[140:143], v[132:135]
  v_mul_f32 v146, v146, v232
  v_mul_f32 v147, v147, v232
  v_mfma_f32_16x16x32_bf16 v[132:135], a[56:59], v[220:223], v[132:135]
  v_cvt_pk_bf16_f32 v191, v146, v147
  v_mul_f32 v128, v128, v233
  v_mfma_f32_16x16x32_bf16 v[132:135], a[60:63], v[204:207], v[132:135]
  ds_write_b128 v16, v[188:191] offset:20480
  v_mfma_f32_16x16x32_bf16 v[132:135], a[64:67], v[196:199], v[132:135]
  v_mul_f32 v129, v129, v233
  v_cvt_pk_bf16_f32 v196, v128, v129
  v_mfma_f32_16x16x32_bf16 v[132:135], a[68:71], v[224:227], v[132:135]
  s_waitcnt lgkmcnt(3)
  s_barrier
  v_mfma_f32_16x16x32_bf16 v[224:227], a[246:249], v[148:151], 0
  s_waitcnt lgkmcnt(2)
  v_mul_f32 v130, v130, v233
  v_mul_f32 v131, v131, v233
  v_mfma_f32_16x16x32_bf16 v[224:227], a[246:249], v[120:123], v[224:227]
  v_cvt_pk_bf16_f32 v124, v132, v133
  v_cvt_pk_bf16_f32 v125, v134, v135
  v_mfma_f32_16x16x32_bf16 v[144:147], v[148:151], v[192:195], 0
  v_cvt_pk_bf16_f32 v197, v130, v131
  v_mul_f32 v216, v216, v233
  v_mfma_f32_16x16x32_bf16 v[144:147], v[120:123], v[108:111], v[144:147]
  v_mul_f32 v217, v217, v233
  v_cvt_pk_bf16_f32 v198, v216, v217
  v_mfma_f32_16x16x32_bf16 v[140:143], v[148:151], v[208:211], 0
  v_mul_f32 v218, v218, v233
  v_mul_f32 v219, v219, v233
  v_mfma_f32_16x16x32_bf16 v[140:143], v[120:123], v[112:115], v[140:143]
  ds_read_b128 v[128:131], v15 offset:2048
  v_cvt_pk_bf16_f32 v199, v218, v219
  v_mfma_f32_16x16x32_bf16 v[216:219], v[148:151], v[212:215], 0
  ds_read_b128 v[132:135], v15 offset:3072
  v_mul_f32 v224, 0x3ee9a3cd, v224
  v_mfma_f32_16x16x32_bf16 v[216:219], v[120:123], v[116:119], v[216:219]
  ds_read_b128 v[136:139], v15 offset:4096
  v_rcp_f32 v122, v224
  v_mfma_f32_16x16x16_bf16 v[188:191], v[166:167], v[124:125], 0
  v_cndmask_b32 v234, v140, v144, s[54:55]
  v_fma_f32 v120, v48, v202, v203
  v_fma_f32 v126, v49, v202, v203
  v_mfma_f32_16x16x16_bf16 v[164:167], v[228:229], v[124:125], 0
  v_cvt_pk_bf16_f32 v120, v120, v126
  v_fma_f32 v121, v50, v202, v203
  v_fma_f32 v126, v51, v202, v203
  v_mfma_f32_16x16x16_bf16 v[204:207], v[200:201], v[124:125], 0
  v_cvt_pk_bf16_f32 v121, v121, v126
  v_mul_f32 v172, v172, v232
  v_mul_f32 v173, v173, v232
  v_mfma_f32_16x16x16_bf16 v[220:223], v[230:231], v[124:125], v[2:5]
  v_cvt_pk_bf16_f32 v124, v172, v173
  v_mul_f32 v174, v174, v232
  v_mul_f32 v175, v175, v232
  v_cvt_pk_bf16_f32 v125, v174, v175
  v_mfma_f32_16x16x32_bf16 v[188:191], v[156:159], v[152:155], v[188:191]
  ds_read_b128 v[140:143], v15 offset:5120
  ds_read_b128 v[144:147], v15 offset:6144
  v_mfma_f32_16x16x32_bf16 v[164:167], v[240:243], v[152:155], v[164:167]
  ds_read_b128 v[148:151], v15 offset:7168
  v_mul_f32 v184, v184, v233
  v_mfma_f32_16x16x32_bf16 v[204:207], v[236:239], v[152:155], v[204:207]
  ds_write_b128 v16, v[196:199] offset:26624
  v_mfma_f32_16x16x32_bf16 v[220:223], v[176:179], v[152:155], v[220:223]
  s_waitcnt lgkmcnt(6)
  v_exp_f32 v188, v188
  v_mfma_f32_16x16x32_bf16 v[156:159], a[0:3], v[128:131], 0
  s_waitcnt lgkmcnt(5)
  v_exp_f32 v189, v189
  v_mfma_f32_16x16x32_bf16 v[156:159], a[4:7], v[132:135], v[156:159]
  s_waitcnt lgkmcnt(4)
  ds_write_b64 v17, v[120:121] offset:8192
  v_mfma_f32_16x16x32_bf16 v[156:159], a[8:11], v[136:139], v[156:159]
  s_waitcnt lgkmcnt(4)
  ds_write_b64 v17, v[124:125] offset:20480
  v_mfma_f32_16x16x32_bf16 v[156:159], a[12:15], v[140:143], v[156:159]
  s_waitcnt lgkmcnt(4)
  v_exp_f32 v190, v190
  v_mfma_f32_16x16x32_bf16 v[156:159], a[16:19], v[144:147], v[156:159]
  s_waitcnt lgkmcnt(3)
  v_exp_f32 v191, v191
  v_mfma_f32_16x16x32_bf16 v[156:159], a[20:23], v[148:151], v[156:159]
  v_exp_f32 v164, v164
  v_mfma_f32_16x16x32_bf16 v[176:179], a[24:27], v[128:131], 0
  v_exp_f32 v165, v165
  v_mfma_f32_16x16x32_bf16 v[176:179], a[28:31], v[132:135], v[176:179]
  v_exp_f32 v166, v166
  v_mfma_f32_16x16x32_bf16 v[176:179], a[32:35], v[136:139], v[176:179]
  v_exp_f32 v167, v167
  v_mfma_f32_16x16x32_bf16 v[176:179], a[36:39], v[140:143], v[176:179]
  v_exp_f32 v204, v204
  v_mfma_f32_16x16x32_bf16 v[176:179], a[40:43], v[144:147], v[176:179]
  v_exp_f32 v205, v205
  v_mfma_f32_16x16x32_bf16 v[176:179], a[44:47], v[148:151], v[176:179]
  v_exp_f32 v206, v206
  v_mfma_f32_16x16x32_bf16 v[196:199], a[48:51], v[128:131], 0
  v_exp_f32 v207, v207
  v_mfma_f32_16x16x32_bf16 v[196:199], a[52:55], v[132:135], v[196:199]
  v_exp_f32 v220, v220
  v_mfma_f32_16x16x32_bf16 v[196:199], a[56:59], v[136:139], v[196:199]
  v_cvt_pk_bf16_f32 v236, v188, v189
  v_cvt_pk_bf16_f32 v237, v190, v191
  v_mfma_f32_16x16x32_bf16 v[196:199], a[60:63], v[140:143], v[196:199]
  v_cvt_pk_bf16_f32 v238, v164, v165
  v_cvt_pk_bf16_f32 v239, v166, v167
  v_mfma_f32_16x16x32_bf16 v[196:199], a[64:67], v[144:147], v[196:199]
  v_cvt_pk_bf16_f32 v152, v156, v157
  v_cvt_pk_bf16_f32 v153, v158, v159
  v_mfma_f32_16x16x32_bf16 v[196:199], a[68:71], v[148:151], v[196:199]
  v_cvt_pk_bf16_f32 v124, v204, v205
  v_cvt_pk_bf16_f32 v125, v206, v207
  v_mfma_f32_16x16x32_bf16 v[204:207], a[246:249], v[236:239], 0
  v_cvt_pk_bf16_f32 v126, v220, 0
  v_cvt_pk_bf16_f32 v154, v176, v177
  v_cvt_pk_bf16_f32 v155, v178, v179
  v_mfma_f32_16x16x32_bf16 v[204:207], a[246:249], v[124:127], v[204:207]
  v_cvt_pk_bf16_f32 v164, v196, v197
  v_cvt_pk_bf16_f32 v165, v198, v199
  v_mfma_f32_16x16x32_bf16 v[156:159], v[192:195], v[236:239], 0
  v_mul_f32 v185, v185, v233
  v_cvt_pk_bf16_f32 v166, v184, v185
  v_mfma_f32_16x16x32_bf16 v[156:159], v[108:111], v[124:127], v[156:159]
  v_mul_f32 v204, 0x3ee9a3cd, v204
  v_mul_f32 v186, v186, v233
  v_mfma_f32_16x16x32_bf16 v[192:195], v[208:211], v[236:239], 0
  v_rcp_f32 v110, v204
  v_mfma_f32_16x16x32_bf16 v[192:195], v[112:115], v[124:127], v[192:195]
  v_mul_f32 v156, v156, v110
  v_mul_f32 v157, v157, v110
  v_mfma_f32_16x16x32_bf16 v[208:211], v[212:215], v[236:239], 0
  v_mul_f32 v158, v158, v110
  v_mul_f32 v159, v159, v110
  v_mfma_f32_16x16x32_bf16 v[208:211], v[116:119], v[124:127], v[208:211]
  v_mul_f32 v192, v192, v110
  v_mul_f32 v193, v193, v110
  v_mfma_f32_16x16x32_bf16 v[212:215], a[72:75], v[128:131], 0
  v_mul_f32 v194, v194, v110
  v_mul_f32 v195, v195, v110
  v_mfma_f32_16x16x32_bf16 v[212:215], a[76:79], v[132:135], v[212:215]
  v_cvt_pk_bf16_f32 v236, v156, v157
  v_cvt_pk_bf16_f32 v237, v158, v159
  v_mfma_f32_16x16x32_bf16 v[212:215], a[80:83], v[136:139], v[212:215]
  v_cvt_pk_bf16_f32 v238, v192, v193
  v_cvt_pk_bf16_f32 v239, v194, v195
  v_mfma_f32_16x16x32_bf16 v[212:215], a[84:87], v[140:143], v[212:215]
  ds_write_b128 v16, v[236:239] offset:32768
  v_mfma_f32_16x16x32_bf16 v[212:215], a[88:91], v[144:147], v[212:215]
  v_mul_f32 v187, v187, v233
  v_mul_f32 v208, v208, v110
  v_mfma_f32_16x16x32_bf16 v[212:215], a[92:95], v[148:151], v[212:215]
  v_mul_f32 v209, v209, v110
  v_mul_f32 v210, v210, v110
  v_mfma_f32_16x16x32_bf16 v[236:239], a[96:99], v[128:131], 0
  v_mul_f32 v211, v211, v110
  v_cndmask_b32 v234, v216, v234, s[56:57]
  v_mfma_f32_16x16x32_bf16 v[236:239], a[100:103], v[132:135], v[236:239]
  v_cvt_pk_bf16_f32 v167, v186, v187
  v_cvt_pk_bf16_f32 v116, v208, v209
  v_mfma_f32_16x16x32_bf16 v[236:239], a[104:107], v[136:139], v[236:239]
  ds_write_b64 v17, v[166:167] offset:26624
  v_mfma_f32_16x16x32_bf16 v[236:239], a[108:111], v[140:143], v[236:239]
  v_cvt_pk_bf16_f32 v117, v210, v211
  v_mul_f32 v234, v234, v122
  v_mfma_f32_16x16x32_bf16 v[236:239], a[112:115], v[144:147], v[236:239]
  ds_write_b64 v17, v[116:117] offset:32768
  v_mfma_f32_16x16x32_bf16 v[236:239], a[116:119], v[148:151], v[236:239]
  v_cvt_pk_bf16_f32 v234, v234, v234
  v_max3_f32 v1, v1, v160, v232
  v_mfma_f32_16x16x32_bf16 v[160:163], a[120:123], v[128:131], 0
  ds_write_b16 v20, v234 offset:384
  v_mfma_f32_16x16x32_bf16 v[160:163], a[124:127], v[132:135], v[160:163]
  v_max3_f32 v1, v1, v180, v233
  v_cvt_pk_bf16_f32 v156, v212, v213
  v_mfma_f32_16x16x32_bf16 v[160:163], a[128:131], v[136:139], v[160:163]
  v_cvt_pk_bf16_f32 v157, v214, v215
  v_max3_f32 v1, v1, v224, v122
  v_mfma_f32_16x16x32_bf16 v[160:163], a[132:135], v[140:143], v[160:163]
  v_cvt_pk_bf16_f32 v158, v236, v237
  v_cvt_pk_bf16_f32 v159, v238, v239
  v_mfma_f32_16x16x32_bf16 v[160:163], a[136:139], v[144:147], v[160:163]
  v_add_u32 v20, 1160, v20
  v_max3_f32 v1, v1, v204, v110
  v_mfma_f32_16x16x32_bf16 v[160:163], a[140:143], v[148:151], v[160:163]
  s_waitcnt lgkmcnt(1)
  s_waitcnt lgkmcnt(0)
  s_barrier
  s_sub_u32 s70, s70, 1
  s_cmp_eq_u32 s70, 0
  s_cbranch_scc1 L_last
  v_mfma_f32_16x16x32_bf16 v[168:171], v[128:131], a[144:147], 0
  s_mov_b32 m0, s58
  ds_read_b64 v[108:109], v119 offset:256
  v_cndmask_b32 v110, v21, 2.0, s[52:53]
  v_mfma_f32_16x16x32_bf16 v[168:171], v[132:135], a[148:151], v[168:171]
  buffer_load_dwordx4 v110, s[4:7], s36 offen lds
  v_mfma_f32_16x16x32_bf16 v[168:171], v[136:139], a[152:155], v[168:171]
  v_cvt_pk_bf16_f32 v166, v160, v161
  v_cvt_pk_bf16_f32 v167, v162, v163
  v_mfma_f32_16x16x32_bf16 v[168:171], v[140:143], a[156:159], v[168:171]
  buffer_load_dwordx4 v110, s[4:7], s37 offen offset:864 lds
  v_mfma_f32_16x16x32_bf16 v[168:171], v[144:147], a[160:163], v[168:171]
  v_mfma_f32_16x16x32_bf16 v[168:171], v[148:151], a[164:167], v[168:171]
  s_waitcnt lgkmcnt(0)
  ds_read_b128 v[160:163], v15 offset:20480
  v_fma_f32 v184, v52, v108, v109
  v_mfma_f32_16x16x32_bf16 v[172:175], v[128:131], a[168:171], 0
  ds_read_b128 v[176:179], v18
  ds_read_b128 v[180:183], v15 offset:21504
  v_mfma_f32_16x16x32_bf16 v[172:175], v[132:135], a[172:175], v[172:175]
  ds_read_b128 v[188:191], v18 offset:6144
  v_cvt_pk_bf16_f32 v192, v168, v169
  v_mfma_f32_16x16x32_bf16 v[172:175], v[136:139], a[176:179], v[172:175]
  ds_read_b128 v[196:199], v15 offset:22528
  v_cvt_pk_bf16_f32 v193, v170, v171
  v_mfma_f32_16x16x32_bf16 v[172:175], v[140:143], a[180:183], v[172:175]
  ds_read_b128 v[168:171], v18 offset:1024
  v_fma_f32 v114, v53, v108, v109
  v_mfma_f32_16x16x32_bf16 v[172:175], v[144:147], a[184:187], v[172:175]
  ds_read_b128 v[200:203], v18 offset:7168
  v_cvt_pk_bf16_f32 v184, v184, v114
  v_mfma_f32_16x16x32_bf16 v[172:175], v[148:151], a[188:191], v[172:175]
  buffer_load_dwordx4 v110, s[4:7], s38 offen offset:1728 lds
  v_mfma_f32_16x16x32_bf16 v[204:207], v[128:131], a[192:195], 0
  ds_read_b128 v[128:131], v18 offset:2048
  v_fma_f32 v185, v54, v108, v109
  v_mfma_f32_16x16x32_bf16 v[204:207], v[132:135], a[196:199], v[204:207]
  ds_read_b128 v[132:135], v18 offset:8192
  v_cvt_pk_bf16_f32 v208, v172, v173
  v_mfma_f32_16x16x32_bf16 v[204:207], v[136:139], a[200:203], v[204:207]
  ds_read_b128 v[136:139], v15 offset:26624
  v_cvt_pk_bf16_f32 v209, v174, v175
  v_mfma_f32_16x16x32_bf16 v[204:207], v[140:143], a[204:207], v[204:207]
  ds_read_b128 v[140:143], v15 offset:27648
  v_fma_f32 v114, v55, v108, v109
  v_mfma_f32_16x16x32_bf16 v[204:207], v[144:147], a[208:211], v[204:207]
  ds_read_b128 v[144:147], v15 offset:28672
  v_cvt_pk_bf16_f32 v185, v185, v114
  v_mfma_f32_16x16x32_bf16 v[204:207], v[148:151], a[212:215], v[204:207]
  s_waitcnt lgkmcnt(11)
  buffer_load_dwordx4 v110, s[4:7], s39 offen offset:2592 lds
  v_mfma_f32_16x16x32_bf16 v[64:67], a[250:253], v[160:163], v[64:67]
  s_waitcnt lgkmcnt(9)
  v_fma_f32 v186, v56, v108, v109
  v_fma_f32 v114, v57, v108, v109
  v_mfma_f32_16x16x32_bf16 v[64:67], v[176:179], v[180:183], v[64:67]
  s_waitcnt lgkmcnt(7)
  buffer_load_dwordx4 v110, s[4:7], s40 offen offset:3456 lds
  v_mfma_f32_16x16x32_bf16 v[64:67], v[188:191], v[196:199], v[64:67]
  s_mov_b32 m0, s59
  v_cvt_pk_bf16_f32 v212, v204, v205
  v_cvt_pk_bf16_f32 v213, v206, v207
  v_mfma_f32_16x16x32_bf16 v[68:71], v[100:103], v[160:163], v[68:71]
  s_waitcnt lgkmcnt(6)
  buffer_load_dwordx4 v110, s[4:7], s41 offen lds
  v_mfma_f32_16x16x32_bf16 v[68:71], v[168:171], v[180:183], v[68:71]
  s_waitcnt lgkmcnt(5)
  v_cvt_pk_bf16_f32 v186, v186, v114
  v_fma_f32 v187, v58, v108, v109
  v_mfma_f32_16x16x32_bf16 v[68:71], v[200:203], v[196:199], v[68:71]
  ds_read_b128 v[148:151], v15 offset:32768
  v_fma_f32 v114, v59, v108, v109
  v_mfma_f32_16x16x32_bf16 v[72:75], v[104:107], v[160:163], v[72:75]
  s_waitcnt lgkmcnt(5)
  ds_read_b128 v[172:175], v15 offset:33792
  v_cvt_pk_bf16_f32 v187, v187, v114
  v_mfma_f32_16x16x32_bf16 v[72:75], v[128:131], v[180:183], v[72:75]
  s_waitcnt lgkmcnt(5)
  ds_read_b128 v[180:183], v15 offset:34816
  v_fma_f32 v112, v60, v108, v109
  v_mfma_f32_16x16x32_bf16 v[72:75], v[132:135], v[196:199], v[72:75]
  s_waitcnt lgkmcnt(5)
  buffer_load_dwordx4 v110, s[4:7], s42 offen offset:864 lds
  v_mfma_f32_16x16x32_bf16 v[76:79], a[250:253], v[136:139], v[76:79]
  s_waitcnt lgkmcnt(4)
  v_fma_f32 v114, v61, v108, v109
  v_cvt_pk_bf16_f32 v112, v112, v114
  v_mfma_f32_16x16x32_bf16 v[76:79], v[176:179], v[140:143], v[76:79]
  s_waitcnt lgkmcnt(3)
  buffer_load_dwordx4 v110, s[4:7], s43 offen offset:1728 lds
  v_mfma_f32_16x16x32_bf16 v[76:79], v[188:191], v[144:147], v[76:79]
  v_fma_f32 v113, v62, v108, v109
  v_fma_f32 v114, v63, v108, v109
  v_mfma_f32_16x16x32_bf16 v[80:83], v[100:103], v[136:139], v[80:83]
  buffer_load_dwordx4 v110, s[4:7], s44 offen offset:2592 lds
  v_mfma_f32_16x16x32_bf16 v[80:83], v[168:171], v[140:143], v[80:83]
  s_lshl_b32 s60, s31, 5
  v_cvt_pk_bf16_f32 v113, v113, v114
  v_mfma_f32_16x16x32_bf16 v[80:83], v[200:203], v[144:147], v[80:83]
  s_add_u32 s61, s60, s30
  ds_read_b128 v[196:199], v18 offset:9216
  ds_read_b128 v[160:163], v15 offset:23552
  v_mfma_f32_16x16x32_bf16 v[84:87], v[104:107], v[136:139], v[84:87]
  s_add_u32 s60, s60, s29
  ds_read_b128 v[204:207], v18 offset:3072
  v_mfma_f32_16x16x32_bf16 v[84:87], v[128:131], v[140:143], v[84:87]
  s_mul_i32 s62, s60, 7183
  ds_read_b128 v[140:143], v15 offset:24576
  v_mfma_f32_16x16x32_bf16 v[84:87], v[132:135], v[144:147], v[84:87]
  s_waitcnt lgkmcnt(6)
  ds_read_b128 v[216:219], v18 offset:12288
  v_mfma_f32_16x16x32_bf16 v[88:91], a[250:253], v[148:151], v[88:91]
  s_waitcnt lgkmcnt(6)
  ds_read_b128 v[144:147], v15 offset:25600
  v_mfma_f32_16x16x32_bf16 v[88:91], v[176:179], v[172:175], v[88:91]
  s_waitcnt lgkmcnt(6)
  ds_read_b128 v[176:179], v18 offset:10240
  v_mfma_f32_16x16x32_bf16 v[88:91], v[188:191], v[180:183], v[88:91]
  s_lshr_b32 s62, s62, 22
  ds_read_b128 v[188:191], v18 offset:4096
  v_mfma_f32_16x16x32_bf16 v[92:95], v[100:103], v[148:151], v[92:95]
  s_mul_i32 s63, s62, 584
  ds_read_b128 v[220:223], v18 offset:13312
  v_mfma_f32_16x16x32_bf16 v[92:95], v[168:171], v[172:175], v[92:95]
  s_sub_u32 s63, s60, s63
  ds_read_b128 v[224:227], v18 offset:11264
  v_mfma_f32_16x16x32_bf16 v[92:95], v[200:203], v[180:183], v[92:95]
  s_lshr_b32 s64, s63, 3
  ds_read_b128 v[200:203], v18 offset:5120
  v_mfma_f32_16x16x32_bf16 v[96:99], v[104:107], v[148:151], v[96:99]
  s_and_b32 s65, s63, 7
  ds_read_b128 v[228:231], v18 offset:14336
  v_mfma_f32_16x16x32_bf16 v[96:99], v[128:131], v[172:175], v[96:99]
  s_lshl_b32 s66, s62, 3
  ds_read_b128 v[128:131], v15 offset:29696
  v_mfma_f32_16x16x32_bf16 v[96:99], v[132:135], v[180:183], v[96:99]
  s_waitcnt lgkmcnt(11)
  ds_read_b128 v[132:135], v15 offset:30720
  v_mfma_f32_16x16x32_bf16 v[64:67], v[196:199], v[160:163], v[64:67]
  s_waitcnt lgkmcnt(10)
  ds_read_b128 v[172:175], v15 offset:31744
  v_mfma_f32_16x16x32_bf16 v[64:67], v[204:207], v[140:143], v[64:67]
  s_waitcnt lgkmcnt(9)
  v_mfma_f32_16x16x32_bf16 v[64:67], v[216:219], v[144:147], v[64:67]
  s_waitcnt lgkmcnt(8)
  v_mfma_f32_16x16x32_bf16 v[68:71], v[176:179], v[160:163], v[68:71]
  s_waitcnt lgkmcnt(7)
  v_mfma_f32_16x16x32_bf16 v[68:71], v[188:191], v[140:143], v[68:71]
  s_waitcnt lgkmcnt(6)
  v_cvt_pk_bf16_f32 v168, v64, v65
  v_cvt_pk_bf16_f32 v169, v66, v67
  v_mfma_f32_16x16x32_bf16 v[68:71], v[220:223], v[144:147], v[68:71]
  s_waitcnt lgkmcnt(5)
  ds_read_b128 v[180:183], v15 offset:35840
  v_mfma_f32_16x16x32_bf16 v[72:75], v[224:227], v[160:163], v[72:75]
  s_waitcnt lgkmcnt(5)
  ds_read_b128 v[160:163], v15 offset:36864
  v_mfma_f32_16x16x32_bf16 v[72:75], v[200:203], v[140:143], v[72:75]
  s_waitcnt lgkmcnt(5)
  ds_read_b128 v[232:235], v15 offset:37888
  v_cvt_pk_bf16_f32 v170, v68, v69
  v_mfma_f32_16x16x32_bf16 v[72:75], v[228:231], v[144:147], v[72:75]
  s_waitcnt lgkmcnt(5)
  v_cvt_pk_bf16_f32 v171, v70, v71
  v_mfma_f32_16x16x32_bf16 v[76:79], v[196:199], v[128:131], v[76:79]
  s_waitcnt lgkmcnt(4)
  v_permlane16_swap_b32 v168, v170
  v_mfma_f32_16x16x32_bf16 v[76:79], v[204:207], v[132:135], v[76:79]
  s_waitcnt vmcnt(4) lgkmcnt(3)
  ds_read_b64 v[108:109], v9
  v_cvt_pk_bf16_f32 v236, v72, v73
  v_mfma_f32_16x16x32_bf16 v[76:79], v[216:219], v[172:175], v[76:79]
  s_add_u32 s65, s65, s66
  ds_read_b64 v[116:117], v9 offset:32
  v_cvt_pk_bf16_f32 v237, v74, v75
  v_mfma_f32_16x16x32_bf16 v[80:83], v[176:179], v[128:131], v[80:83]
  s_cmp_ge_u32 s60, 5256
  ds_read_b64 v[120:121], v9 offset:64
  v_mfma_f32_16x16x32_bf16 v[80:83], v[188:191], v[132:135], v[80:83]
  s_cselect_b32 s64, s63, s64
  ds_read_b128 v[144:147], v3
  ds_read_b128 v[148:151], v3 offset:864
  v_mfma_f32_16x16x32_bf16 v[80:83], v[220:223], v[172:175], v[80:83]
  s_cselect_b32 s65, 72, s65
  ds_read_b128 v[136:139], v3 offset:1728
  v_cvt_pk_bf16_f32 v240, v76, v77
  v_mfma_f32_16x16x32_bf16 v[84:87], v[224:227], v[128:131], v[84:87]
  s_mul_i32 s66, s65, 1373568
  ds_read_b128 v[140:143], v6
  v_cvt_pk_bf16_f32 v241, v78, v79
  v_mfma_f32_16x16x32_bf16 v[84:87], v[200:203], v[132:135], v[84:87]
  s_mul_i32 s67, s64, 2688
  v_permlane16_swap_b32 v169, v171
  v_mfma_f32_16x16x32_bf16 v[84:87], v[228:231], v[172:175], v[84:87]
  s_waitcnt lgkmcnt(9)
  buffer_store_dwordx4 v[168:171], v12, s[8:11], s32 offen
  v_cvt_pk_bf16_f32 v242, v80, v81
  v_mfma_f32_16x16x32_bf16 v[88:91], v[196:199], v[180:183], v[88:91]
  s_waitcnt lgkmcnt(8)
  ds_read_b128 v[128:131], v3 offset:32
  ds_read_b128 v[132:135], v3 offset:896
  v_mfma_f32_16x16x32_bf16 v[88:91], v[204:207], v[160:163], v[88:91]
  s_waitcnt lgkmcnt(9)
  ds_read_b128 v[168:171], v3 offset:1760
  v_cvt_pk_bf16_f32 v243, v82, v83
  v_mfma_f32_16x16x32_bf16 v[88:91], v[216:219], v[232:235], v[88:91]
  s_waitcnt lgkmcnt(5)
  ds_read_b128 v[172:175], v6 offset:32
  v_permlane16_swap_b32 v240, v242
  v_mfma_f32_16x16x16_bf16 v[64:67], a[224:225], v[108:109], 0
  v_permlane16_swap_b32 v241, v243
  v_cvt_pk_bf16_f32 v238, v84, v85
  v_mfma_f32_16x16x16_bf16 v[68:71], a[234:235], v[116:117], 0
  v_cvt_pk_bf16_f32 v239, v86, v87
  v_permlane16_swap_b32 v236, v238
  v_mfma_f32_16x16x16_bf16 v[72:75], a[244:245], v[120:121], 0
  v_permlane16_swap_b32 v237, v239
  v_cvt_pk_bf16_f32 v216, v88, v89
  v_cvt_pk_bf16_f32 v217, v90, v91
  v_smfmac_f32_16x16x64_bf16 v[64:67], a[216:219], v[144:151], v0
  s_waitcnt lgkmcnt(4)
  ds_read_b128 v[144:147], v3 offset:64
  ds_read_b128 v[148:151], v3 offset:928
  v_smfmac_f32_16x16x64_bf16 v[64:67], a[220:223], v[136:143], v0
  s_add_u32 s35, s66, s67
  ds_read_b128 v[136:139], v3 offset:1792
  v_mfma_f32_16x16x32_bf16 v[92:95], v[176:179], v[180:183], v[92:95]
  s_cmp_ge_u32 s61, 667
  ds_read_b128 v[140:143], v6 offset:64
  v_mfma_f32_16x16x32_bf16 v[92:95], v[188:191], v[160:163], v[92:95]
  s_cselect_b32 s35, 268435456, s35
  ds_read_b128 v[188:191], v15 offset:8192
  v_mul_f32 v110, v64, v64
  v_mfma_f32_16x16x32_bf16 v[92:95], v[220:223], v[232:235], v[92:95]
  s_waitcnt lgkmcnt(7)
  ds_read_b128 v[220:223], v15 offset:9216
  v_add_f32 v114, v64, v65
  v_smfmac_f32_16x16x64_bf16 v[68:71], a[226:229], v[128:135], v0
  s_waitcnt lgkmcnt(6)
  ds_read_b128 v[204:207], v15 offset:10240
  v_fmac_f32 v110, v65, v65
  v_smfmac_f32_16x16x64_bf16 v[68:71], a[230:233], v[168:175], v0
  s_cmp_ge_u32 s60, 5329
  ds_read_b128 v[196:199], v15 offset:11264
  v_cvt_pk_bf16_f32 v218, v92, v93
  v_mfma_f32_16x16x32_bf16 v[96:99], v[224:227], v[180:183], v[96:99]
  s_waitcnt vmcnt(3)
  ds_read_b128 v[224:227], v15 offset:12288
  v_cvt_pk_bf16_f32 v219, v94, v95
  v_mfma_f32_16x16x32_bf16 v[96:99], v[200:203], v[160:163], v[96:99]
  s_cselect_b32 s35, 268435456, s35
  ds_read_b128 v[160:163], v15 offset:13312
  v_add_f32 v114, v114, v66
  v_mfma_f32_16x16x32_bf16 v[96:99], v[228:231], v[232:235], v[96:99]
  s_waitcnt lgkmcnt(8)
  buffer_store_dwordx4 v[240:243], v13, s[8:11], s32 offen
  ds_read_b64 v[120:121], v10
  v_smfmac_f32_16x16x64_bf16 v[72:75], a[236:239], v[144:151], v0
  s_waitcnt lgkmcnt(7)
  ds_read_b64 v[116:117], v10 offset:32
  ds_read_b64 v[108:109], v10 offset:64
  v_smfmac_f32_16x16x64_bf16 v[72:75], a[240:243], v[136:143], v0
  s_waitcnt lgkmcnt(8)
  ds_read_b128 v[136:139], v4
  v_cvt_pk_bf16_f32 v124, v96, v97
  v_mfma_f32_16x16x32_bf16 v[180:183], a[72:75], v[188:191], 0
  s_waitcnt lgkmcnt(8)
  ds_read_b128 v[140:143], v4 offset:864
  v_cvt_pk_bf16_f32 v125, v98, v99
  v_mfma_f32_16x16x32_bf16 v[180:183], a[76:79], v[220:223], v[180:183]
  s_waitcnt lgkmcnt(8)
  ds_read_b128 v[144:147], v4 offset:1728
  v_fmac_f32 v110, v66, v66
  v_mfma_f32_16x16x32_bf16 v[180:183], a[80:83], v[204:207], v[180:183]
  s_waitcnt lgkmcnt(8)
  ds_read_b128 v[148:151], v7
  v_add_f32 v114, v114, v67
  v_mfma_f32_16x16x32_bf16 v[180:183], a[84:87], v[196:199], v[180:183]
  s_waitcnt lgkmcnt(8)
  ds_read_b128 v[168:171], v4 offset:32
  v_fmac_f32 v110, v67, v67
  v_mfma_f32_16x16x32_bf16 v[180:183], a[88:91], v[224:227], v[180:183]
  s_waitcnt lgkmcnt(8)
  ds_read_b128 v[172:175], v4 offset:896
  v_add_f32 v114, v114, v68
  v_mfma_f32_16x16x32_bf16 v[180:183], a[92:95], v[160:163], v[180:183]
  s_waitcnt lgkmcnt(6)
  ds_read_b128 v[128:131], v4 offset:1760
  v_permlane16_swap_b32 v216, v218
  v_mfma_f32_16x16x16_bf16 v[76:79], a[224:225], v[120:121], 0
  v_permlane16_swap_b32 v217, v219
  v_fmac_f32 v110, v68, v68
  v_mfma_f32_16x16x16_bf16 v[80:83], a[234:235], v[116:117], 0
  v_cvt_pk_bf16_f32 v240, v180, v181
  v_cvt_pk_bf16_f32 v241, v182, v183
  v_add_f32 v114, v114, v69
  v_mfma_f32_16x16x16_bf16 v[84:87], a[244:245], v[108:109], 0
  s_cmp_eq_u32 s65, 0
  ds_read_b128 v[132:135], v7 offset:32
  ds_read_b128 v[176:179], v4 offset:64
  s_waitcnt lgkmcnt(7)
  v_smfmac_f32_16x16x64_bf16 v[76:79], a[216:219], v[136:143], v0
  s_waitcnt lgkmcnt(5)
  ds_read_b128 v[180:183], v4 offset:928
  v_fmac_f32 v110, v69, v69
  v_smfmac_f32_16x16x64_bf16 v[76:79], a[220:223], v[144:151], v0
  s_cselect_b32 s36, 268435456, s35
  ds_read_b128 v[144:147], v4 offset:1792
  v_add_f32 v114, v114, v70
  v_mfma_f32_16x16x32_bf16 v[136:139], a[96:99], v[188:191], 0
  s_add_u32 s37, s35, 195360
  ds_read_b128 v[148:151], v7 offset:64
  v_fmac_f32 v110, v70, v70
  v_mfma_f32_16x16x32_bf16 v[136:139], a[100:103], v[220:223], v[136:139]
  s_add_u32 s38, s35, 390720
  ds_write_b128 v16, v[184:187] offset:14336
  v_mfma_f32_16x16x32_bf16 v[136:139], a[104:107], v[204:207], v[136:139]
  s_waitcnt lgkmcnt(7)
  buffer_store_dwordx4 v[236:239], v22, s[8:11], s32 offen
  v_mul_f32 v122, v76, v76
  v_smfmac_f32_16x16x64_bf16 v[80:83], a[226:229], v[168:175], v0
  s_waitcnt lgkmcnt(5)
  ds_write_b64 v17, v[112:113] offset:14336
  v_smfmac_f32_16x16x64_bf16 v[80:83], a[230:233], v[128:135], v0
  s_add_u32 s39, s35, 586080
  v_add_f32 v126, v76, v77
  v_mfma_f32_16x16x32_bf16 v[136:139], a[108:111], v[196:199], v[136:139]
  s_waitcnt vmcnt(3)
  ds_read_b64 v[108:109], v11
  v_fmac_f32 v122, v77, v77
  v_mfma_f32_16x16x32_bf16 v[136:139], a[112:115], v[224:227], v[136:139]
  s_add_u32 s40, s35, 781440
  ds_read_b64 v[112:113], v11 offset:32
  v_add_f32 v126, v126, v78
  v_mfma_f32_16x16x32_bf16 v[136:139], a[116:119], v[160:163], v[136:139]
  s_waitcnt lgkmcnt(6)
  ds_read_b64 v[120:121], v11 offset:64
  v_fmac_f32 v122, v78, v78
  v_smfmac_f32_16x16x64_bf16 v[84:87], a[236:239], v[176:183], v0
  s_waitcnt lgkmcnt(5)
  ds_read_b128 v[176:179], v5
  ds_read_b128 v[180:183], v5 offset:864
  v_smfmac_f32_16x16x64_bf16 v[84:87], a[240:243], v[144:151], v0
  s_add_u32 s41, s35, 981120
  ds_read_b128 v[144:147], v5 offset:1728
  v_cvt_pk_bf16_f32 v242, v136, v137
  v_mfma_f32_16x16x32_bf16 v[236:239], a[120:123], v[188:191], 0
  s_add_u32 s42, s35, 1176480
  ds_read_b128 v[148:151], v8
  v_cvt_pk_bf16_f32 v243, v138, v139
  v_mfma_f32_16x16x32_bf16 v[236:239], a[124:127], v[220:223], v[236:239]
  s_add_u32 s43, s35, 1371840
  v_add_f32 v126, v126, v79
  v_fmac_f32 v122, v79, v79
  v_mfma_f32_16x16x32_bf16 v[236:239], a[128:131], v[204:207], v[236:239]
  s_add_u32 s44, s35, 1567200
  v_add_f32 v126, v126, v80
  v_fmac_f32 v122, v80, v80
  v_mfma_f32_16x16x32_bf16 v[236:239], a[132:135], v[196:199], v[236:239]
  s_cmp_eq_u32 s64, 0
  ds_read_b128 v[128:131], v5 offset:32
  ds_read_b128 v[132:135], v5 offset:896
  v_mfma_f32_16x16x32_bf16 v[236:239], a[136:139], v[224:227], v[236:239]
  s_cselect_b64 s[52:53], s[48:49], 0
  ds_read_b128 v[168:171], v5 offset:1760
  v_add_f32 v126, v126, v81
  v_mfma_f32_16x16x32_bf16 v[236:239], a[140:143], v[160:163], v[236:239]
  s_waitcnt lgkmcnt(5)
  ds_read_b128 v[172:175], v8 offset:32
  v_fmac_f32 v122, v81, v81
  v_add_f32 v126, v126, v82
  v_mfma_f32_16x16x16_bf16 v[88:91], a[224:225], v[108:109], 0
  v_fmac_f32 v122, v82, v82
  v_add_f32 v114, v114, v71
  v_fmac_f32 v110, v71, v71
  v_mfma_f32_16x16x16_bf16 v[92:95], a[234:235], v[112:113], 0
  v_cvt_pk_bf16_f32 v228, v236, v237
  v_cvt_pk_bf16_f32 v229, v238, v239
  v_add_f32 v126, v126, v83
  v_mfma_f32_16x16x16_bf16 v[96:99], a[244:245], v[120:121], 0
  v_fmac_f32 v122, v83, v83
  v_add_f32 v114, v114, v72
  v_fmac_f32 v110, v72, v72
  v_add_f32 v126, v126, v84
  v_smfmac_f32_16x16x64_bf16 v[88:91], a[216:219], v[176:183], v0
  s_waitcnt lgkmcnt(4)
  buffer_store_dwordx4 v[216:219], v14, s[8:11], s32 offen
  ds_read_b128 v[176:179], v5 offset:64
  v_smfmac_f32_16x16x64_bf16 v[88:91], a[220:223], v[144:151], v0
  s_cmp_eq_u32 s64, 72
  ds_read_b128 v[180:183], v5 offset:928
  ds_read_b128 v[144:147], v5 offset:1792
  v_mfma_f32_16x16x32_bf16 v[216:219], a[0:3], v[188:191], 0
  s_cselect_b64 s[52:53], s[50:51], s[52:53]
  ds_read_b128 v[148:151], v8 offset:64
  v_fmac_f32 v122, v84, v84
  v_mfma_f32_16x16x32_bf16 v[216:219], a[4:7], v[220:223], v[216:219]
  s_add_u32 s31, s31, 1
  v_mul_f32 v118, v88, v88
  v_add_f32 v108, v88, v89
  v_mfma_f32_16x16x32_bf16 v[216:219], a[8:11], v[204:207], v[216:219]
  s_waitcnt lgkmcnt(6)
  v_fmac_f32 v118, v89, v89
  v_add_f32 v108, v108, v90
  v_smfmac_f32_16x16x64_bf16 v[92:95], a[226:229], v[128:135], v0
  s_waitcnt lgkmcnt(4)
  v_fmac_f32 v118, v90, v90
  v_smfmac_f32_16x16x64_bf16 v[92:95], a[230:233], v[168:175], v0
  s_sub_u32 s68, s35, 196608
  v_add_f32 v108, v108, v91
  v_mfma_f32_16x16x32_bf16 v[216:219], a[12:15], v[196:199], v[216:219]
  s_cselect_b32 s68, s35, s68
  v_fmac_f32 v118, v91, v91
  v_add_f32 v114, v114, v73
  v_mfma_f32_16x16x32_bf16 v[216:219], a[16:19], v[224:227], v[216:219]
  v_add_f32 v108, v108, v92
  v_fmac_f32 v118, v92, v92
  v_mfma_f32_16x16x32_bf16 v[216:219], a[20:23], v[160:163], v[216:219]
  s_waitcnt lgkmcnt(2)
  v_add_f32 v108, v108, v93
  v_fmac_f32 v118, v93, v93
  v_smfmac_f32_16x16x64_bf16 v[96:99], a[236:239], v[176:183], v0
  s_waitcnt lgkmcnt(0)
  v_add_f32 v108, v108, v94
  v_smfmac_f32_16x16x64_bf16 v[96:99], a[240:243], v[144:151], v0
  v_cvt_pk_bf16_f32 v128, v216, v217
  v_mfma_f32_16x16x32_bf16 v[144:147], a[24:27], v[188:191], 0
  v_cvt_pk_bf16_f32 v129, v218, v219
  v_fmac_f32 v118, v94, v94
  v_mfma_f32_16x16x32_bf16 v[144:147], a[28:31], v[220:223], v[144:147]
  v_add_f32 v108, v108, v95
  v_fmac_f32 v118, v95, v95
  v_mfma_f32_16x16x32_bf16 v[144:147], a[32:35], v[204:207], v[144:147]
  v_add_f32 v108, v108, v96
  v_fmac_f32 v118, v96, v96
  v_mfma_f32_16x16x32_bf16 v[144:147], a[36:39], v[196:199], v[144:147]
  v_add_f32 v108, v108, v97
  v_fmac_f32 v118, v97, v97
  v_mfma_f32_16x16x32_bf16 v[144:147], a[40:43], v[224:227], v[144:147]
  buffer_store_dwordx2 v[124:125], v23, s[8:11], s32 offen
  v_fmac_f32 v110, v73, v73
  v_mfma_f32_16x16x32_bf16 v[144:147], a[44:47], v[160:163], v[144:147]
  s_mov_b32 s32, s33
  v_add_f32 v126, v126, v85
  v_fmac_f32 v122, v85, v85
  v_mfma_f32_16x16x32_bf16 v[216:219], a[48:51], v[188:191], 0
  s_mov_b32 s33, s34
  v_add_f32 v108, v108, v98
  v_fmac_f32 v118, v98, v98
  v_mfma_f32_16x16x32_bf16 v[216:219], a[52:55], v[220:223], v[216:219]
  s_mov_b32 s34, s35
  ds_read_b64 v[116:117], v19 offset:784
  v_cvt_pk_bf16_f32 v130, v144, v145
  v_mfma_f32_16x16x32_bf16 v[216:219], a[56:59], v[204:207], v[216:219]
  buffer_load_dword v25, v24, s[24:27], s68 offen
  v_mfma_f32_16x16x32_bf16 v[216:219], a[60:63], v[196:199], v[216:219]
  v_cvt_pk_bf16_f32 v131, v146, v147
  v_add_f32 v114, v114, v74
  v_mfma_f32_16x16x32_bf16 v[216:219], a[64:67], v[224:227], v[216:219]
  ds_read2_b64 v[144:147], v19 offset0:96 offset1:97
  v_fmac_f32 v110, v74, v74
  v_mfma_f32_16x16x32_bf16 v[216:219], a[68:71], v[160:163], v[216:219]
  v_add_f32 v126, v126, v86
  v_fmac_f32 v122, v86, v86
  v_mfma_f32_16x16x32_bf16 v[148:151], v[188:191], a[144:147], 0
  v_add_f32 v108, v108, v99
  v_fmac_f32 v118, v99, v99
  v_mfma_f32_16x16x32_bf16 v[148:151], v[220:223], a[148:151], v[148:151]
  v_add_f32 v114, v114, v75
  v_fmac_f32 v110, v75, v75
  v_mfma_f32_16x16x32_bf16 v[148:151], v[204:207], a[152:155], v[148:151]
  v_add_f32 v126, v126, v87
  v_fmac_f32 v122, v87, v87
  v_mfma_f32_16x16x32_bf16 v[148:151], v[196:199], a[156:159], v[148:151]
  v_permlane32_swap_b32 v108, v118
  v_mfma_f32_16x16x32_bf16 v[148:151], v[224:227], a[160:163], v[148:151]
  v_permlane32_swap_b32 v114, v110
  v_mfma_f32_16x16x32_bf16 v[148:151], v[160:163], a[164:167], v[148:151]
  v_permlane32_swap_b32 v126, v122
  v_mfma_f32_16x16x32_bf16 v[176:179], v[188:191], a[168:171], 0
  v_add_f32 v108, v108, v118
  v_add_f32 v114, v114, v110
  v_mfma_f32_16x16x32_bf16 v[176:179], v[220:223], a[172:175], v[176:179]
  v_add_f32 v126, v126, v122
  v_mov_b32 v110, v108
  v_mfma_f32_16x16x32_bf16 v[176:179], v[204:207], a[176:179], v[176:179]
  v_cvt_pk_bf16_f32 v124, v216, v217
  v_cvt_pk_bf16_f32 v125, v218, v219
  v_mfma_f32_16x16x32_bf16 v[176:179], v[196:199], a[180:183], v[176:179]
  v_permlane16_swap_b32 v114, v126
  v_mfma_f32_16x16x32_bf16 v[176:179], v[224:227], a[184:187], v[176:179]
  v_permlane16_swap_b32 v108, v110
  v_mfma_f32_16x16x32_bf16 v[176:179], v[160:163], a[188:191], v[176:179]
  s_waitcnt lgkmcnt(0)
  v_add_f32 v114, v114, v126
  v_add_f32 v108, v108, v110
  v_cvt_pk_bf16_f32 v194, v148, v149
  v_mfma_f32_16x16x16_bf16 v[216:219], v[116:117], v[166:167], 0
  v_cvt_pk_bf16_f32 v195, v150, v151
  v_mfma_f32_16x16x16_bf16 v[148:151], v[116:117], v[228:229], 0
  ds_write_b32 v111, v114
  v_cvt_pk_bf16_f32 v210, v176, v177
  v_mfma_f32_16x16x16_bf16 v[132:135], v[166:167], v[164:165], 0
  v_cvt_pk_bf16_f32 v211, v178, v179
  v_mfma_f32_16x16x16_bf16 v[176:179], v[228:229], v[164:165], 0
  ds_write_b32 v111, v108 offset:512
  v_mfma_f32_16x16x32_bf16 v[216:219], v[144:147], v[156:159], v[216:219]
  v_mfma_f32_16x16x32_bf16 v[148:151], v[144:147], v[240:243], v[148:151]
  v_mfma_f32_16x16x32_bf16 v[132:135], v[156:159], v[152:155], v[132:135]
  v_mfma_f32_16x16x32_bf16 v[176:179], v[240:243], v[152:155], v[176:179]
  s_waitcnt lgkmcnt(1)
  v_cndmask_b32 v184, v148, v216, s[56:57]
  s_waitcnt lgkmcnt(0)
  s_barrier
  v_mfma_f32_16x16x32_bf16 v[148:151], v[188:191], a[192:195], 0
  ds_read_b128 v[136:139], v15 offset:14336
  ds_read_b128 v[140:143], v15 offset:15360
  v_mfma_f32_16x16x32_bf16 v[148:151], v[220:223], a[196:199], v[148:151]
  ds_read_b128 v[220:223], v15 offset:16384
  v_mfma_f32_16x16x32_bf16 v[148:151], v[204:207], a[200:203], v[148:151]
  ds_read_b128 v[204:207], v15 offset:17408
  v_mfma_f32_16x16x32_bf16 v[148:151], v[196:199], a[204:207], v[148:151]
  ds_read_b128 v[196:199], v15 offset:18432
  v_mfma_f32_16x16x32_bf16 v[148:151], v[224:227], a[208:211], v[148:151]
  ds_read_b128 v[224:227], v15 offset:19456
  v_mfma_f32_16x16x32_bf16 v[148:151], v[160:163], a[212:215], v[148:151]
  ds_read_b128 v[160:163], v15
  v_exp_f32 v132, v132
  v_mfma_f32_16x16x16_bf16 v[188:191], v[166:167], v[124:125], 0
  v_exp_f32 v133, v133
  v_mfma_f32_16x16x16_bf16 v[216:219], v[228:229], v[124:125], 0
  ds_read_b128 v[180:183], v15 offset:1024
  v_exp_f32 v134, v134
  v_cvt_pk_bf16_f32 v214, v148, v149
  v_mfma_f32_16x16x32_bf16 v[188:191], v[156:159], v[128:131], v[188:191]
  v_exp_f32 v135, v135
  v_mfma_f32_16x16x32_bf16 v[216:219], v[240:243], v[128:131], v[216:219]
  s_waitcnt lgkmcnt(7)
  v_exp_f32 v176, v176
  v_mfma_f32_16x16x32_bf16 v[168:171], a[72:75], v[136:139], 0
  s_waitcnt lgkmcnt(6)
  v_exp_f32 v177, v177
  v_mfma_f32_16x16x32_bf16 v[168:171], a[76:79], v[140:143], v[168:171]
  s_waitcnt lgkmcnt(1)
  v_exp_f32 v178, v178
  v_mfma_f32_16x16x32_bf16 v[168:171], a[80:83], v[220:223], v[168:171]
  s_waitcnt lgkmcnt(0)
  v_exp_f32 v179, v179
  v_mfma_f32_16x16x32_bf16 v[168:171], a[84:87], v[204:207], v[168:171]
  v_cvt_pk_bf16_f32 v215, v150, v151
  v_cvt_pk_bf16_f32 v148, v132, v133
  v_mfma_f32_16x16x32_bf16 v[168:171], a[88:91], v[196:199], v[168:171]
  v_exp_f32 v188, v188
  v_mfma_f32_16x16x32_bf16 v[168:171], a[92:95], v[224:227], v[168:171]
  v_exp_f32 v189, v189
  v_mfma_f32_16x16x32_bf16 v[172:175], a[96:99], v[136:139], 0
  v_exp_f32 v190, v190
  v_mfma_f32_16x16x32_bf16 v[172:175], a[100:103], v[140:143], v[172:175]
  v_exp_f32 v191, v191
  v_mfma_f32_16x16x32_bf16 v[172:175], a[104:107], v[220:223], v[172:175]
  ds_read_b64 v[230:231], v19 offset:16
  v_cvt_pk_bf16_f32 v149, v134, v135
  v_mfma_f32_16x16x32_bf16 v[172:175], a[108:111], v[204:207], v[172:175]
  v_exp_f32 v216, v216
  v_mfma_f32_16x16x32_bf16 v[172:175], a[112:115], v[196:199], v[172:175]
  v_exp_f32 v217, v217
  v_mfma_f32_16x16x32_bf16 v[172:175], a[116:119], v[224:227], v[172:175]
  v_exp_f32 v218, v218
  v_mfma_f32_16x16x32_bf16 v[132:135], a[120:123], v[136:139], 0
  v_exp_f32 v219, v219
  v_mfma_f32_16x16x32_bf16 v[132:135], a[124:127], v[140:143], v[132:135]
  v_cvt_pk_bf16_f32 v150, v176, v177
  v_cvt_pk_bf16_f32 v151, v178, v179
  v_mfma_f32_16x16x32_bf16 v[132:135], a[128:131], v[220:223], v[132:135]
  ds_read2_b64 v[176:179], v19 offset0:0 offset1:1
  v_cvt_pk_bf16_f32 v236, v168, v169
  v_mfma_f32_16x16x32_bf16 v[132:135], a[132:135], v[204:207], v[132:135]
  v_cvt_pk_bf16_f32 v237, v170, v171
  v_cvt_pk_bf16_f32 v168, v188, v189
  v_mfma_f32_16x16x32_bf16 v[132:135], a[136:139], v[196:199], v[132:135]
  v_cvt_pk_bf16_f32 v169, v190, v191
  v_cvt_pk_bf16_f32 v170, v216, v217
  v_mfma_f32_16x16x32_bf16 v[132:135], a[140:143], v[224:227], v[132:135]
  v_cvt_pk_bf16_f32 v238, v172, v173
  v_cvt_pk_bf16_f32 v239, v174, v175
  v_mfma_f32_16x16x32_bf16 v[172:175], v[136:139], a[144:147], 0
  v_cvt_pk_bf16_f32 v171, v218, v219
  v_add_f32 v160, v160, v161
  v_mfma_f32_16x16x32_bf16 v[172:175], v[140:143], a[148:151], v[172:175]
  v_cvt_pk_bf16_f32 v200, v132, v133
  v_cvt_pk_bf16_f32 v201, v134, v135
  v_mfma_f32_16x16x32_bf16 v[172:175], v[220:223], a[152:155], v[172:175]
  v_add_f32 v162, v162, v163
  v_add_f32 v180, v180, v181
  v_mfma_f32_16x16x32_bf16 v[172:175], v[204:207], a[156:159], v[172:175]
  v_add_f32 v182, v182, v183
  v_add_f32 v160, v160, v162
  v_mfma_f32_16x16x32_bf16 v[172:175], v[196:199], a[160:163], v[172:175]
  v_add_f32 v180, v180, v182
  v_mul_f32 v161, 0x3baaaaab, v160
  v_mfma_f32_16x16x32_bf16 v[172:175], v[224:227], a[164:167], v[172:175]
  s_waitcnt lgkmcnt(1)
  v_fma_f32 v180, -v161, v160, v180
  v_max_f32 v180, 0, v180
  v_add_f32 v180, 0x3afba882, v180
  v_mfma_f32_16x16x16_bf16 v[132:135], v[200:201], v[164:165], 0
  v_rsq_f32 v180, v180
  v_add_u32 v19, 1160, v19
  v_mfma_f32_16x16x16_bf16 v[216:219], v[230:231], v[164:165], v[2:5]
  v_cvt_pk_bf16_f32 v108, v172, v173
  v_cvt_pk_bf16_f32 v109, v174, v175
  v_mul_f32 v180, 0x40ca568a, v180
  v_mfma_f32_16x16x16_bf16 v[172:175], v[200:201], v[124:125], 0
  v_mul_f32 v181, -v161, v180
  v_mfma_f32_16x16x16_bf16 v[160:163], v[230:231], v[124:125], v[2:5]
  ds_write_b64 v115, v[180:181]
  ds_read_b64 v[164:165], v119
  v_mfma_f32_16x16x32_bf16 v[132:135], v[236:239], v[152:155], v[132:135]
  s_waitcnt lgkmcnt(2)
  ds_read_b64 v[202:203], v119 offset:128
  v_mfma_f32_16x16x32_bf16 v[216:219], v[176:179], v[152:155], v[216:219]
  v_mfma_f32_16x16x32_bf16 v[172:175], v[236:239], v[128:131], v[172:175]
  v_exp_f32 v132, v132
  v_mfma_f32_16x16x32_bf16 v[160:163], v[176:179], v[128:131], v[160:163]
  v_exp_f32 v133, v133
  v_mfma_f32_16x16x32_bf16 v[128:131], v[136:139], a[168:171], 0
  v_exp_f32 v134, v134
  v_mfma_f32_16x16x32_bf16 v[128:131], v[140:143], a[172:175], v[128:131]
  v_exp_f32 v135, v135
  v_mfma_f32_16x16x32_bf16 v[128:131], v[220:223], a[176:179], v[128:131]
  s_waitcnt lgkmcnt(0)
  v_exp_f32 v216, v216
  v_mfma_f32_16x16x32_bf16 v[128:131], v[204:207], a[180:183], v[128:131]
  v_exp_f32 v172, v172
  v_mfma_f32_16x16x32_bf16 v[128:131], v[196:199], a[184:187], v[128:131]
  v_exp_f32 v173, v173
  v_mfma_f32_16x16x32_bf16 v[128:131], v[224:227], a[188:191], v[128:131]
  v_exp_f32 v174, v174
  v_mfma_f32_16x16x32_bf16 v[152:155], v[136:139], a[192:195], 0
  v_exp_f32 v175, v175
  v_mfma_f32_16x16x32_bf16 v[152:155], v[140:143], a[196:199], v[152:155]
  v_exp_f32 v160, v160
  v_mfma_f32_16x16x32_bf16 v[152:155], v[220:223], a[200:203], v[152:155]
  ds_read_u16 v110, v20
  v_cvt_pk_bf16_f32 v120, v132, v133
  v_mfma_f32_16x16x32_bf16 v[152:155], v[204:207], a[204:207], v[152:155]
  v_cvt_pk_bf16_f32 v121, v134, v135
  v_cvt_pk_bf16_f32 v122, v216, 0
  v_mfma_f32_16x16x32_bf16 v[152:155], v[196:199], a[208:211], v[152:155]
  ds_read_u16 v114, v20 offset:32
  v_cvt_pk_bf16_f32 v124, v172, v173
  v_mfma_f32_16x16x32_bf16 v[152:155], v[224:227], a[212:215], v[152:155]
  v_cvt_pk_bf16_f32 v112, v128, v129
  v_cvt_pk_bf16_f32 v113, v130, v131
  v_cvt_pk_bf16_f32 v125, v174, v175
  v_mfma_f32_16x16x16_bf16 v[128:131], v[116:117], v[200:201], 0
  v_cvt_pk_bf16_f32 v126, v160, 0
  v_fma_f32 v132, v64, v164, v165
  v_fma_f32 v185, v65, v164, v165
  v_mfma_f32_16x16x16_bf16 v[160:163], v[116:117], v[230:231], 0
  v_cvt_pk_bf16_f32 v116, v152, v153
  v_cvt_pk_bf16_f32 v117, v154, v155
  v_cvt_pk_bf16_f32 v132, v132, v185
  v_fma_f32 v133, v66, v164, v165
  v_mfma_f32_16x16x32_bf16 v[128:131], v[144:147], v[236:239], v[128:131]
  ds_read_u16 v118, v20 offset:64
  v_fma_f32 v185, v67, v164, v165
  v_mfma_f32_16x16x32_bf16 v[160:163], v[144:147], v[176:179], v[160:163]
  v_cvt_pk_bf16_f32 v133, v133, v185
  v_fma_f32 v134, v68, v164, v165
  v_mfma_f32_16x16x32_bf16 v[144:147], a[0:3], v[136:139], 0
  v_fma_f32 v185, v69, v164, v165
  v_cvt_pk_bf16_f32 v134, v134, v185
  v_mfma_f32_16x16x32_bf16 v[144:147], a[4:7], v[140:143], v[144:147]
  v_cndmask_b32 v185, v128, v160, s[56:57]
  v_fma_f32 v135, v70, v164, v165
  v_mfma_f32_16x16x32_bf16 v[144:147], a[8:11], v[220:223], v[144:147]
  v_fma_f32 v186, v71, v164, v165
  v_cvt_pk_bf16_f32 v135, v135, v186
  v_mfma_f32_16x16x32_bf16 v[144:147], a[12:15], v[204:207], v[144:147]
  ds_write_b128 v16, v[132:135] offset:2048
  v_mfma_f32_16x16x32_bf16 v[144:147], a[16:19], v[196:199], v[144:147]
  v_cndmask_b32 v184, v185, v184, s[46:47]
  v_fma_f32 v172, v72, v164, v165
  v_mfma_f32_16x16x32_bf16 v[144:147], a[20:23], v[224:227], v[144:147]
  v_fma_f32 v185, v73, v164, v165
  v_cvt_pk_bf16_f32 v172, v172, v185
  v_mfma_f32_16x16x32_bf16 v[160:163], a[246:249], v[148:151], 0
  v_fma_f32 v173, v74, v164, v165
  v_fma_f32 v185, v75, v164, v165
  v_mfma_f32_16x16x32_bf16 v[160:163], a[246:249], v[120:123], v[160:163]
  v_cvt_pk_bf16_f32 v152, v144, v145
  v_cvt_pk_bf16_f32 v153, v146, v147
  v_mfma_f32_16x16x32_bf16 v[132:135], v[192:195], v[148:151], 0
  s_waitcnt lgkmcnt(3)
  v_cvt_pk_bf16_f32 v173, v173, v185
  v_fma_f32 v128, v76, v202, v203
  v_mfma_f32_16x16x32_bf16 v[132:135], v[108:111], v[120:123], v[132:135]
  ds_write_b64 v17, v[172:173] offset:2048
  v_mfma_f32_16x16x32_bf16 v[144:147], v[208:211], v[148:151], 0
  s_waitcnt lgkmcnt(3)
  v_exp_f32 v184, v184
  v_mfma_f32_16x16x32_bf16 v[144:147], v[112:115], v[120:123], v[144:147]
  v_cvt_pk_bf16_f32 v184, v184, 0
  v_mul_f32 v160, 0x3ee9a3cd, v160
  v_mfma_f32_16x16x32_bf16 v[172:175], v[212:215], v[148:151], 0
  s_waitcnt lgkmcnt(2)
  ds_write_b16 v26, v184
  v_mfma_f32_16x16x32_bf16 v[172:175], v[116:119], v[120:123], v[172:175]
  ds_read_b128 v[148:151], v27
  ds_read_b64 v[120:121], v27 offset:16
  v_mfma_f32_16x16x32_bf16 v[216:219], a[24:27], v[136:139], 0
  v_cndmask_b32 v122, 0, v184, s[54:55]
  v_fma_f32 v164, v77, v202, v203
  v_mfma_f32_16x16x32_bf16 v[216:219], a[28:31], v[140:143], v[216:219]
  v_rcp_f32 v232, v160
  v_mfma_f32_16x16x32_bf16 v[216:219], a[32:35], v[220:223], v[216:219]
  v_cvt_pk_bf16_f32 v128, v128, v164
  v_fma_f32 v129, v78, v202, v203
  v_mfma_f32_16x16x32_bf16 v[216:219], a[36:39], v[204:207], v[216:219]
  v_fma_f32 v164, v79, v202, v203
  v_cvt_pk_bf16_f32 v129, v129, v164
  v_mfma_f32_16x16x32_bf16 v[216:219], a[40:43], v[196:199], v[216:219]
  v_fma_f32 v130, v80, v202, v203
  v_fma_f32 v164, v81, v202, v203
  v_mfma_f32_16x16x32_bf16 v[216:219], a[44:47], v[224:227], v[216:219]
  v_cvt_pk_bf16_f32 v130, v130, v164
  v_fma_f32 v131, v82, v202, v203
  v_mfma_f32_16x16x32_bf16 v[180:183], a[246:249], v[168:171], 0
  v_fma_f32 v164, v83, v202, v203
  v_cvt_pk_bf16_f32 v131, v131, v164
  v_mfma_f32_16x16x32_bf16 v[180:183], a[246:249], v[124:127], v[180:183]
  ds_write_b128 v16, v[128:131] offset:8192
  v_mfma_f32_16x16x32_bf16 v[128:131], v[192:195], v[168:171], 0
  v_cvt_pk_bf16_f32 v154, v216, v217
  v_cvt_pk_bf16_f32 v155, v218, v219
  v_mfma_f32_16x16x32_bf16 v[128:131], v[108:111], v[124:127], v[128:131]
  v_mul_f32 v180, 0x3ee9a3cd, v180
  v_mul_f32 v132, v132, v232
  v_mfma_f32_16x16x32_bf16 v[216:219], v[208:211], v[168:171], 0
  v_rcp_f32 v233, v180
  v_mfma_f32_16x16x32_bf16 v[216:219], v[112:115], v[124:127], v[216:219]
  v_mul_f32 v133, v133, v232
  v_cvt_pk_bf16_f32 v188, v132, v133
  v_mfma_f32_16x16x32_bf16 v[184:187], v[212:215], v[168:171], 0
  v_mul_f32 v134, v134, v232
  v_mul_f32 v135, v135, v232
  v_mfma_f32_16x16x32_bf16 v[184:187], v[116:119], v[124:127], v[184:187]
  v_cvt_pk_bf16_f32 v189, v134, v135
  v_mul_f32 v144, v144, v232
  v_mfma_f32_16x16x32_bf16 v[132:135], a[48:51], v[136:139], 0
  v_mul_f32 v145, v145, v232
  v_cvt_pk_bf16_f32 v190, v144, v145
  v_mfma_f32_16x16x32_bf16 v[132:135], a[52:55], v[140:143], v[132:135]
  v_mul_f32 v146, v146, v232
  v_mul_f32 v147, v147, v232
  v_mfma_f32_16x16x32_bf16 v[132:135], a[56:59], v[220:223], v[132:135]
  v_cvt_pk_bf16_f32 v191, v146, v147
  v_mul_f32 v128, v128, v233
  v_mfma_f32_16x16x32_bf16 v[132:135], a[60:63], v[204:207], v[132:135]
  ds_write_b128 v16, v[188:191] offset:20480
  v_mfma_f32_16x16x32_bf16 v[132:135], a[64:67], v[196:199], v[132:135]
  v_mul_f32 v129, v129, v233
  v_cvt_pk_bf16_f32 v196, v128, v129
  v_mfma_f32_16x16x32_bf16 v[132:135], a[68:71], v[224:227], v[132:135]
  s_waitcnt lgkmcnt(3)
  s_barrier
  v_mfma_f32_16x16x32_bf16 v[224:227], a[246:249], v[148:151], 0
  s_waitcnt lgkmcnt(2)
  v_mul_f32 v130, v130, v233
  v_mul_f32 v131, v131, v233
  v_mfma_f32_16x16x32_bf16 v[224:227], a[246:249], v[120:123], v[224:227]
  v_cvt_pk_bf16_f32 v124, v132, v133
  v_cvt_pk_bf16_f32 v125, v134, v135
  v_mfma_f32_16x16x32_bf16 v[144:147], v[148:151], v[192:195], 0
  v_cvt_pk_bf16_f32 v197, v130, v131
  v_mul_f32 v216, v216, v233
  v_mfma_f32_16x16x32_bf16 v[144:147], v[120:123], v[108:111], v[144:147]
  v_mul_f32 v217, v217, v233
  v_cvt_pk_bf16_f32 v198, v216, v217
  v_mfma_f32_16x16x32_bf16 v[140:143], v[148:151], v[208:211], 0
  v_mul_f32 v218, v218, v233
  v_mul_f32 v219, v219, v233
  v_mfma_f32_16x16x32_bf16 v[140:143], v[120:123], v[112:115], v[140:143]
  ds_read_b128 v[128:131], v15 offset:2048
  v_cvt_pk_bf16_f32 v199, v218, v219
  v_mfma_f32_16x16x32_bf16 v[216:219], v[148:151], v[212:215], 0
  ds_read_b128 v[132:135], v15 offset:3072
  v_mul_f32 v224, 0x3ee9a3cd, v224
  v_mfma_f32_16x16x32_bf16 v[216:219], v[120:123], v[116:119], v[216:219]
  ds_read_b128 v[136:139], v15 offset:4096
  v_rcp_f32 v122, v224
  v_mfma_f32_16x16x16_bf16 v[188:191], v[166:167], v[124:125], 0
  v_cndmask_b32 v234, v140, v144, s[54:55]
  v_fma_f32 v120, v84, v202, v203
  v_fma_f32 v126, v85, v202, v203
  v_mfma_f32_16x16x16_bf16 v[164:167], v[228:229], v[124:125], 0
  v_cvt_pk_bf16_f32 v120, v120, v126
  v_fma_f32 v121, v86, v202, v203
  v_fma_f32 v126, v87, v202, v203
  v_mfma_f32_16x16x16_bf16 v[204:207], v[200:201], v[124:125], 0
  v_cvt_pk_bf16_f32 v121, v121, v126
  v_mul_f32 v172, v172, v232
  v_mul_f32 v173, v173, v232
  v_mfma_f32_16x16x16_bf16 v[220:223], v[230:231], v[124:125], v[2:5]
  v_cvt_pk_bf16_f32 v124, v172, v173
  v_mul_f32 v174, v174, v232
  v_mul_f32 v175, v175, v232
  v_cvt_pk_bf16_f32 v125, v174, v175
  v_mfma_f32_16x16x32_bf16 v[188:191], v[156:159], v[152:155], v[188:191]
  ds_read_b128 v[140:143], v15 offset:5120
  ds_read_b128 v[144:147], v15 offset:6144
  v_mfma_f32_16x16x32_bf16 v[164:167], v[240:243], v[152:155], v[164:167]
  ds_read_b128 v[148:151], v15 offset:7168
  v_mul_f32 v184, v184, v233
  v_mfma_f32_16x16x32_bf16 v[204:207], v[236:239], v[152:155], v[204:207]
  ds_write_b128 v16, v[196:199] offset:26624
  v_mfma_f32_16x16x32_bf16 v[220:223], v[176:179], v[152:155], v[220:223]
  s_waitcnt lgkmcnt(6)
  v_exp_f32 v188, v188
  v_mfma_f32_16x16x32_bf16 v[156:159], a[0:3], v[128:131], 0
  s_waitcnt lgkmcnt(5)
  v_exp_f32 v189, v189
  v_mfma_f32_16x16x32_bf16 v[156:159], a[4:7], v[132:135], v[156:159]
  s_waitcnt lgkmcnt(4)
  ds_write_b64 v17, v[120:121] offset:8192
  v_mfma_f32_16x16x32_bf16 v[156:159], a[8:11], v[136:139], v[156:159]
  s_waitcnt lgkmcnt(4)
  ds_write_b64 v17, v[124:125] offset:20480
  v_mfma_f32_16x16x32_bf16 v[156:159], a[12:15], v[140:143], v[156:159]
  s_waitcnt lgkmcnt(4)
  v_exp_f32 v190, v190
  v_mfma_f32_16x16x32_bf16 v[156:159], a[16:19], v[144:147], v[156:159]
  s_waitcnt lgkmcnt(3)
  v_exp_f32 v191, v191
  v_mfma_f32_16x16x32_bf16 v[156:159], a[20:23], v[148:151], v[156:159]
  v_exp_f32 v164, v164
  v_mfma_f32_16x16x32_bf16 v[176:179], a[24:27], v[128:131], 0
  v_exp_f32 v165, v165
  v_mfma_f32_16x16x32_bf16 v[176:179], a[28:31], v[132:135], v[176:179]
  v_exp_f32 v166, v166
  v_mfma_f32_16x16x32_bf16 v[176:179], a[32:35], v[136:139], v[176:179]
  v_exp_f32 v167, v167
  v_mfma_f32_16x16x32_bf16 v[176:179], a[36:39], v[140:143], v[176:179]
  v_exp_f32 v204, v204
  v_mfma_f32_16x16x32_bf16 v[176:179], a[40:43], v[144:147], v[176:179]
  v_exp_f32 v205, v205
  v_mfma_f32_16x16x32_bf16 v[176:179], a[44:47], v[148:151], v[176:179]
  v_exp_f32 v206, v206
  v_mfma_f32_16x16x32_bf16 v[196:199], a[48:51], v[128:131], 0
  v_exp_f32 v207, v207
  v_mfma_f32_16x16x32_bf16 v[196:199], a[52:55], v[132:135], v[196:199]
  v_exp_f32 v220, v220
  v_mfma_f32_16x16x32_bf16 v[196:199], a[56:59], v[136:139], v[196:199]
  v_cvt_pk_bf16_f32 v236, v188, v189
  v_cvt_pk_bf16_f32 v237, v190, v191
  v_mfma_f32_16x16x32_bf16 v[196:199], a[60:63], v[140:143], v[196:199]
  v_cvt_pk_bf16_f32 v238, v164, v165
  v_cvt_pk_bf16_f32 v239, v166, v167
  v_mfma_f32_16x16x32_bf16 v[196:199], a[64:67], v[144:147], v[196:199]
  v_cvt_pk_bf16_f32 v152, v156, v157
  v_cvt_pk_bf16_f32 v153, v158, v159
  v_mfma_f32_16x16x32_bf16 v[196:199], a[68:71], v[148:151], v[196:199]
  v_cvt_pk_bf16_f32 v124, v204, v205
  v_cvt_pk_bf16_f32 v125, v206, v207
  v_mfma_f32_16x16x32_bf16 v[204:207], a[246:249], v[236:239], 0
  v_cvt_pk_bf16_f32 v126, v220, 0
  v_cvt_pk_bf16_f32 v154, v176, v177
  v_cvt_pk_bf16_f32 v155, v178, v179
  v_mfma_f32_16x16x32_bf16 v[204:207], a[246:249], v[124:127], v[204:207]
  v_cvt_pk_bf16_f32 v164, v196, v197
  v_cvt_pk_bf16_f32 v165, v198, v199
  v_mfma_f32_16x16x32_bf16 v[156:159], v[192:195], v[236:239], 0
  v_mul_f32 v185, v185, v233
  v_cvt_pk_bf16_f32 v166, v184, v185
  v_mfma_f32_16x16x32_bf16 v[156:159], v[108:111], v[124:127], v[156:159]
  v_mul_f32 v204, 0x3ee9a3cd, v204
  v_mul_f32 v186, v186, v233
  v_mfma_f32_16x16x32_bf16 v[192:195], v[208:211], v[236:239], 0
  v_rcp_f32 v110, v204
  v_mfma_f32_16x16x32_bf16 v[192:195], v[112:115], v[124:127], v[192:195]
  v_mul_f32 v156, v156, v110
  v_mul_f32 v157, v157, v110
  v_mfma_f32_16x16x32_bf16 v[208:211], v[212:215], v[236:239], 0
  v_mul_f32 v158, v158, v110
  v_mul_f32 v159, v159, v110
  v_mfma_f32_16x16x32_bf16 v[208:211], v[116:119], v[124:127], v[208:211]
  v_mul_f32 v192, v192, v110
  v_mul_f32 v193, v193, v110
  v_mfma_f32_16x16x32_bf16 v[212:215], a[72:75], v[128:131], 0
  v_mul_f32 v194, v194, v110
  v_mul_f32 v195, v195, v110
  v_mfma_f32_16x16x32_bf16 v[212:215], a[76:79], v[132:135], v[212:215]
  v_cvt_pk_bf16_f32 v236, v156, v157
  v_cvt_pk_bf16_f32 v237, v158, v159
  v_mfma_f32_16x16x32_bf16 v[212:215], a[80:83], v[136:139], v[212:215]
  v_cvt_pk_bf16_f32 v238, v192, v193
  v_cvt_pk_bf16_f32 v239, v194, v195
  v_mfma_f32_16x16x32_bf16 v[212:215], a[84:87], v[140:143], v[212:215]
  ds_write_b128 v16, v[236:239] offset:32768
  v_mfma_f32_16x16x32_bf16 v[212:215], a[88:91], v[144:147], v[212:215]
  v_mul_f32 v187, v187, v233
  v_mul_f32 v208, v208, v110
  v_mfma_f32_16x16x32_bf16 v[212:215], a[92:95], v[148:151], v[212:215]
  v_mul_f32 v209, v209, v110
  v_mul_f32 v210, v210, v110
  v_mfma_f32_16x16x32_bf16 v[236:239], a[96:99], v[128:131], 0
  v_mul_f32 v211, v211, v110
  v_cndmask_b32 v234, v216, v234, s[56:57]
  v_mfma_f32_16x16x32_bf16 v[236:239], a[100:103], v[132:135], v[236:239]
  v_cvt_pk_bf16_f32 v167, v186, v187
  v_cvt_pk_bf16_f32 v116, v208, v209
  v_mfma_f32_16x16x32_bf16 v[236:239], a[104:107], v[136:139], v[236:239]
  ds_write_b64 v17, v[166:167] offset:26624
  v_mfma_f32_16x16x32_bf16 v[236:239], a[108:111], v[140:143], v[236:239]
  v_cvt_pk_bf16_f32 v117, v210, v211
  v_mul_f32 v234, v234, v122
  v_mfma_f32_16x16x32_bf16 v[236:239], a[112:115], v[144:147], v[236:239]
  ds_write_b64 v17, v[116:117] offset:32768
  v_mfma_f32_16x16x32_bf16 v[236:239], a[116:119], v[148:151], v[236:239]
  v_cvt_pk_bf16_f32 v234, v234, v234
  v_max3_f32 v1, v1, v160, v232
  v_mfma_f32_16x16x32_bf16 v[160:163], a[120:123], v[128:131], 0
  ds_write_b16 v20, v234 offset:384
  v_mfma_f32_16x16x32_bf16 v[160:163], a[124:127], v[132:135], v[160:163]
  v_max3_f32 v1, v1, v180, v233
  v_cvt_pk_bf16_f32 v156, v212, v213
  v_mfma_f32_16x16x32_bf16 v[160:163], a[128:131], v[136:139], v[160:163]
  v_cvt_pk_bf16_f32 v157, v214, v215
  v_max3_f32 v1, v1, v224, v122
  v_mfma_f32_16x16x32_bf16 v[160:163], a[132:135], v[140:143], v[160:163]
  v_cvt_pk_bf16_f32 v158, v236, v237
  v_cvt_pk_bf16_f32 v159, v238, v239
  v_mfma_f32_16x16x32_bf16 v[160:163], a[136:139], v[144:147], v[160:163]
  v_add_u32 v20, 1160, v20
  v_max3_f32 v1, v1, v204, v110
  v_mfma_f32_16x16x32_bf16 v[160:163], a[140:143], v[148:151], v[160:163]
  s_waitcnt lgkmcnt(1)
  s_waitcnt lgkmcnt(0)
  s_barrier
  s_branch L_loop
L_cpf:
  s_lshl_b32 s60, s30, 2
  s_add_u32 s60, s60, s28
  s_lshl_b32 s60, s60, 6
  s_add_u32 s60, s60, L_last-L_pc
  s_add_u32 s60, s0, s60
  s_addc_u32 s61, s1, 0
  global_load_dword v25, v123, s[60:61]
  s_branch L_cpf_ret
L_last:
  v_mfma_f32_16x16x32_bf16 v[168:171], v[128:131], a[144:147], 0
  ds_read_b64 v[108:109], v119 offset:256
  v_and_b32 v250, -16, v111
  v_mfma_f32_16x16x32_bf16 v[168:171], v[132:135], a[148:151], v[168:171]
  v_cvt_pk_bf16_f32 v166, v160, v161
  v_cvt_pk_bf16_f32 v167, v162, v163
  v_mfma_f32_16x16x32_bf16 v[168:171], v[136:139], a[152:155], v[168:171]
  v_mfma_f32_16x16x32_bf16 v[168:171], v[140:143], a[156:159], v[168:171]
  v_mfma_f32_16x16x32_bf16 v[168:171], v[144:147], a[160:163], v[168:171]
  v_mfma_f32_16x16x32_bf16 v[168:171], v[148:151], a[164:167], v[168:171]
  s_waitcnt lgkmcnt(0)
  ds_read_b128 v[160:163], v15 offset:20480
  v_fma_f32 v172, v52, v108, v109
  v_mfma_f32_16x16x32_bf16 v[176:179], v[128:131], a[168:171], 0
  ds_read_b128 v[180:183], v18
  ds_read_b128 v[184:187], v15 offset:21504
  v_mfma_f32_16x16x32_bf16 v[176:179], v[132:135], a[172:175], v[176:179]
  ds_read_b128 v[188:191], v18 offset:6144
  v_cvt_pk_bf16_f32 v192, v168, v169
  v_mfma_f32_16x16x32_bf16 v[176:179], v[136:139], a[176:179], v[176:179]
  ds_read_b128 v[196:199], v15 offset:22528
  v_cvt_pk_bf16_f32 v193, v170, v171
  v_mfma_f32_16x16x32_bf16 v[176:179], v[140:143], a[180:183], v[176:179]
  ds_read_b128 v[168:171], v18 offset:1024
  v_fma_f32 v110, v53, v108, v109
  v_mfma_f32_16x16x32_bf16 v[176:179], v[144:147], a[184:187], v[176:179]
  ds_read_b128 v[200:203], v18 offset:7168
  v_cvt_pk_bf16_f32 v172, v172, v110
  v_mfma_f32_16x16x32_bf16 v[176:179], v[148:151], a[188:191], v[176:179]
  v_fma_f32 v173, v54, v108, v109
  v_fma_f32 v110, v55, v108, v109
  v_mfma_f32_16x16x32_bf16 v[204:207], v[128:131], a[192:195], 0
  ds_read_b128 v[128:131], v18 offset:2048
  v_cvt_pk_bf16_f32 v173, v173, v110
  v_mfma_f32_16x16x32_bf16 v[204:207], v[132:135], a[196:199], v[204:207]
  ds_read_b128 v[132:135], v18 offset:8192
  v_cvt_pk_bf16_f32 v208, v176, v177
  v_mfma_f32_16x16x32_bf16 v[204:207], v[136:139], a[200:203], v[204:207]
  ds_read_b128 v[136:139], v15 offset:26624
  v_cvt_pk_bf16_f32 v209, v178, v179
  v_mfma_f32_16x16x32_bf16 v[204:207], v[140:143], a[204:207], v[204:207]
  ds_read_b128 v[140:143], v15 offset:27648
  v_fma_f32 v174, v56, v108, v109
  v_mfma_f32_16x16x32_bf16 v[204:207], v[144:147], a[208:211], v[204:207]
  ds_read_b128 v[144:147], v15 offset:28672
  v_fma_f32 v110, v57, v108, v109
  v_mfma_f32_16x16x32_bf16 v[204:207], v[148:151], a[212:215], v[204:207]
  s_waitcnt lgkmcnt(11)
  v_cvt_pk_bf16_f32 v174, v174, v110
  v_fma_f32 v175, v58, v108, v109
  v_mfma_f32_16x16x32_bf16 v[64:67], a[250:253], v[160:163], v[64:67]
  s_waitcnt lgkmcnt(9)
  v_fma_f32 v110, v59, v108, v109
  v_cvt_pk_bf16_f32 v175, v175, v110
  v_mfma_f32_16x16x32_bf16 v[64:67], v[180:183], v[184:187], v[64:67]
  s_waitcnt lgkmcnt(7)
  ds_write_b128 v16, v[172:175] offset:14336
  v_mfma_f32_16x16x32_bf16 v[64:67], v[188:191], v[196:199], v[64:67]
  v_cvt_pk_bf16_f32 v172, v204, v205
  v_cvt_pk_bf16_f32 v173, v206, v207
  v_mfma_f32_16x16x32_bf16 v[68:71], v[100:103], v[160:163], v[68:71]
  s_waitcnt lgkmcnt(7)
  v_fma_f32 v112, v60, v108, v109
  v_fma_f32 v110, v61, v108, v109
  v_mfma_f32_16x16x32_bf16 v[68:71], v[168:171], v[184:187], v[68:71]
  s_waitcnt lgkmcnt(6)
  v_cvt_pk_bf16_f32 v112, v112, v110
  v_fma_f32 v113, v62, v108, v109
  v_mfma_f32_16x16x32_bf16 v[68:71], v[200:203], v[196:199], v[68:71]
  ds_read_b128 v[204:207], v15 offset:32768
  v_fma_f32 v110, v63, v108, v109
  v_mfma_f32_16x16x32_bf16 v[72:75], v[104:107], v[160:163], v[72:75]
  s_waitcnt lgkmcnt(6)
  ds_read_b128 v[160:163], v15 offset:33792
  v_cvt_pk_bf16_f32 v113, v113, v110
  v_mfma_f32_16x16x32_bf16 v[72:75], v[128:131], v[184:187], v[72:75]
  s_waitcnt lgkmcnt(6)
  ds_read_b128 v[184:187], v15 offset:34816
  v_mfma_f32_16x16x32_bf16 v[72:75], v[132:135], v[196:199], v[72:75]
  s_waitcnt lgkmcnt(6)
  ds_write_b64 v17, v[112:113] offset:14336
  v_mfma_f32_16x16x32_bf16 v[76:79], a[250:253], v[136:139], v[76:79]
  s_waitcnt lgkmcnt(6)
  v_mfma_f32_16x16x32_bf16 v[76:79], v[180:183], v[140:143], v[76:79]
  s_waitcnt lgkmcnt(5)
  v_mfma_f32_16x16x32_bf16 v[76:79], v[188:191], v[144:147], v[76:79]
  v_mfma_f32_16x16x32_bf16 v[80:83], v[100:103], v[136:139], v[80:83]
  v_mfma_f32_16x16x32_bf16 v[80:83], v[168:171], v[140:143], v[80:83]
  v_mfma_f32_16x16x32_bf16 v[80:83], v[200:203], v[144:147], v[80:83]
  ds_read_b128 v[196:199], v18 offset:9216
  ds_read_b128 v[148:151], v15 offset:23552
  v_mfma_f32_16x16x32_bf16 v[84:87], v[104:107], v[136:139], v[84:87]
  ds_read_b128 v[136:139], v18 offset:3072
  v_mfma_f32_16x16x32_bf16 v[84:87], v[128:131], v[140:143], v[84:87]
  ds_read_b128 v[140:143], v15 offset:24576
  v_mfma_f32_16x16x32_bf16 v[84:87], v[132:135], v[144:147], v[84:87]
  s_waitcnt lgkmcnt(7)
  ds_read_b128 v[144:147], v18 offset:12288
  v_mfma_f32_16x16x32_bf16 v[88:91], a[250:253], v[204:207], v[88:91]
  s_waitcnt lgkmcnt(7)
  ds_read_b128 v[176:179], v15 offset:25600
  v_mfma_f32_16x16x32_bf16 v[88:91], v[180:183], v[160:163], v[88:91]
  s_waitcnt lgkmcnt(7)
  ds_read_b128 v[180:183], v18 offset:10240
  v_mfma_f32_16x16x32_bf16 v[88:91], v[188:191], v[184:187], v[88:91]
  ds_read_b128 v[188:191], v18 offset:4096
  v_mfma_f32_16x16x32_bf16 v[92:95], v[100:103], v[204:207], v[92:95]
  ds_read_b128 v[212:215], v18 offset:13312
  v_mfma_f32_16x16x32_bf16 v[92:95], v[168:171], v[160:163], v[92:95]
  ds_read_b128 v[168:171], v18 offset:11264
  v_mfma_f32_16x16x32_bf16 v[92:95], v[200:203], v[184:187], v[92:95]
  ds_read_b128 v[200:203], v18 offset:5120
  v_mfma_f32_16x16x32_bf16 v[96:99], v[104:107], v[204:207], v[96:99]
  ds_read_b128 v[204:207], v18 offset:14336
  v_mfma_f32_16x16x32_bf16 v[96:99], v[128:131], v[160:163], v[96:99]
  ds_read_b128 v[128:131], v15 offset:29696
  v_mfma_f32_16x16x32_bf16 v[96:99], v[132:135], v[184:187], v[96:99]
  s_waitcnt lgkmcnt(11)
  ds_read_b128 v[132:135], v15 offset:30720
  v_mfma_f32_16x16x32_bf16 v[64:67], v[196:199], v[148:151], v[64:67]
  s_waitcnt lgkmcnt(10)
  ds_read_b128 v[184:187], v15 offset:31744
  v_mfma_f32_16x16x32_bf16 v[64:67], v[136:139], v[140:143], v[64:67]
  s_waitcnt lgkmcnt(9)
  v_mfma_f32_16x16x32_bf16 v[64:67], v[144:147], v[176:179], v[64:67]
  s_waitcnt lgkmcnt(8)
  v_mfma_f32_16x16x32_bf16 v[68:71], v[180:183], v[148:151], v[68:71]
  s_waitcnt lgkmcnt(7)
  v_mfma_f32_16x16x32_bf16 v[68:71], v[188:191], v[140:143], v[68:71]
  s_waitcnt lgkmcnt(6)
  v_cvt_pk_bf16_f32 v160, v64, v65
  v_cvt_pk_bf16_f32 v161, v66, v67
  v_mfma_f32_16x16x32_bf16 v[68:71], v[212:215], v[176:179], v[68:71]
  s_waitcnt lgkmcnt(5)
  ds_read_b128 v[216:219], v15 offset:35840
  v_mfma_f32_16x16x32_bf16 v[72:75], v[168:171], v[148:151], v[72:75]
  s_waitcnt lgkmcnt(5)
  ds_read_b128 v[148:151], v15 offset:36864
  v_mfma_f32_16x16x32_bf16 v[72:75], v[200:203], v[140:143], v[72:75]
  s_waitcnt lgkmcnt(5)
  v_cvt_pk_bf16_f32 v162, v68, v69
  v_cvt_pk_bf16_f32 v163, v70, v71
  v_mfma_f32_16x16x32_bf16 v[72:75], v[204:207], v[176:179], v[72:75]
  s_waitcnt lgkmcnt(4)
  v_permlane16_swap_b32 v160, v162
  v_mfma_f32_16x16x32_bf16 v[76:79], v[196:199], v[128:131], v[76:79]
  s_waitcnt lgkmcnt(3)
  v_permlane16_swap_b32 v161, v163
  v_mfma_f32_16x16x32_bf16 v[76:79], v[136:139], v[132:135], v[76:79]
  s_waitcnt lgkmcnt(2)
  buffer_store_dwordx4 v[160:163], v12, s[8:11], s32 offen
  s_nop 1
  ds_read_b128 v[160:163], v15 offset:37888
  v_mfma_f32_16x16x32_bf16 v[76:79], v[144:147], v[184:187], v[76:79]
  v_cvt_pk_bf16_f32 v176, v72, v73
  v_cvt_pk_bf16_f32 v177, v74, v75
  v_mfma_f32_16x16x32_bf16 v[80:83], v[180:183], v[128:131], v[80:83]
  v_mfma_f32_16x16x32_bf16 v[80:83], v[188:191], v[132:135], v[80:83]
  v_cvt_pk_bf16_f32 v140, v76, v77
  v_cvt_pk_bf16_f32 v141, v78, v79
  v_mfma_f32_16x16x32_bf16 v[80:83], v[212:215], v[184:187], v[80:83]
  v_mfma_f32_16x16x32_bf16 v[84:87], v[168:171], v[128:131], v[84:87]
  v_mfma_f32_16x16x32_bf16 v[84:87], v[200:203], v[132:135], v[84:87]
  ds_read_b128 v[132:135], v15 offset:8192
  v_cvt_pk_bf16_f32 v142, v80, v81
  v_mfma_f32_16x16x32_bf16 v[84:87], v[204:207], v[184:187], v[84:87]
  s_waitcnt lgkmcnt(3)
  ds_read_b128 v[184:187], v15 offset:9216
  v_cvt_pk_bf16_f32 v143, v82, v83
  v_mfma_f32_16x16x32_bf16 v[88:91], v[196:199], v[216:219], v[88:91]
  s_waitcnt lgkmcnt(3)
  ds_read_b128 v[196:199], v15 offset:10240
  v_mfma_f32_16x16x32_bf16 v[88:91], v[136:139], v[148:151], v[88:91]
  s_waitcnt lgkmcnt(3)
  ds_read_b128 v[136:139], v15 offset:11264
  v_cvt_pk_bf16_f32 v178, v84, v85
  v_mfma_f32_16x16x32_bf16 v[88:91], v[144:147], v[160:163], v[88:91]
  ds_read_b128 v[144:147], v15 offset:12288
  v_cvt_pk_bf16_f32 v179, v86, v87
  v_mfma_f32_16x16x32_bf16 v[92:95], v[180:183], v[216:219], v[92:95]
  ds_read_b128 v[180:183], v15 offset:13312
  v_mfma_f32_16x16x32_bf16 v[92:95], v[188:191], v[148:151], v[92:95]
  v_permlane16_swap_b32 v140, v142
  v_mfma_f32_16x16x32_bf16 v[92:95], v[212:215], v[160:163], v[92:95]
  v_permlane16_swap_b32 v141, v143
  v_mfma_f32_16x16x32_bf16 v[96:99], v[168:171], v[216:219], v[96:99]
  v_permlane16_swap_b32 v176, v178
  v_mfma_f32_16x16x32_bf16 v[96:99], v[200:203], v[148:151], v[96:99]
  v_permlane16_swap_b32 v177, v179
  v_mfma_f32_16x16x32_bf16 v[96:99], v[204:207], v[160:163], v[96:99]
  s_waitcnt lgkmcnt(5)
  buffer_store_dwordx4 v[140:143], v13, s[8:11], s32 offen
  s_nop 1
  v_cvt_pk_bf16_f32 v140, v88, v89
  v_mfma_f32_16x16x32_bf16 v[160:163], a[72:75], v[132:135], 0
  s_waitcnt lgkmcnt(4)
  v_cvt_pk_bf16_f32 v141, v90, v91
  v_cvt_pk_bf16_f32 v142, v92, v93
  v_mfma_f32_16x16x32_bf16 v[160:163], a[76:79], v[184:187], v[160:163]
  s_waitcnt lgkmcnt(3)
  v_cvt_pk_bf16_f32 v143, v94, v95
  v_cvt_pk_bf16_f32 v108, v96, v97
  v_mfma_f32_16x16x32_bf16 v[160:163], a[80:83], v[196:199], v[160:163]
  s_waitcnt lgkmcnt(2)
  v_permlane16_swap_b32 v140, v142
  v_mfma_f32_16x16x32_bf16 v[160:163], a[84:87], v[136:139], v[160:163]
  s_waitcnt lgkmcnt(1)
  v_permlane16_swap_b32 v141, v143
  v_mfma_f32_16x16x32_bf16 v[160:163], a[88:91], v[144:147], v[160:163]
  s_waitcnt lgkmcnt(0)
  v_cvt_pk_bf16_f32 v109, v98, v99
  v_mfma_f32_16x16x32_bf16 v[160:163], a[92:95], v[180:183], v[160:163]
  v_mfma_f32_16x16x32_bf16 v[204:207], a[96:99], v[132:135], 0
  v_mfma_f32_16x16x32_bf16 v[204:207], a[100:103], v[184:187], v[204:207]
  v_cvt_pk_bf16_f32 v148, v160, v161
  v_cvt_pk_bf16_f32 v149, v162, v163
  v_mfma_f32_16x16x32_bf16 v[204:207], a[104:107], v[196:199], v[204:207]
  v_mfma_f32_16x16x32_bf16 v[204:207], a[108:111], v[136:139], v[204:207]
  v_mfma_f32_16x16x32_bf16 v[204:207], a[112:115], v[144:147], v[204:207]
  v_mfma_f32_16x16x32_bf16 v[204:207], a[116:119], v[180:183], v[204:207]
  v_mfma_f32_16x16x32_bf16 v[160:163], a[120:123], v[132:135], 0
  v_mfma_f32_16x16x32_bf16 v[160:163], a[124:127], v[184:187], v[160:163]
  v_cvt_pk_bf16_f32 v150, v204, v205
  v_cvt_pk_bf16_f32 v151, v206, v207
  v_mfma_f32_16x16x32_bf16 v[160:163], a[128:131], v[196:199], v[160:163]
  v_mfma_f32_16x16x32_bf16 v[160:163], a[132:135], v[136:139], v[160:163]
  buffer_store_dwordx4 v[176:179], v22, s[8:11], s32 offen
  v_mfma_f32_16x16x32_bf16 v[160:163], a[136:139], v[144:147], v[160:163]
  v_mfma_f32_16x16x32_bf16 v[160:163], a[140:143], v[180:183], v[160:163]
  v_mfma_f32_16x16x32_bf16 v[176:179], a[0:3], v[132:135], 0
  v_mfma_f32_16x16x32_bf16 v[176:179], a[4:7], v[184:187], v[176:179]
  buffer_load_dwordx4 v[204:207], v15, s[12:15], s77 offen offset:2048
  v_mfma_f32_16x16x32_bf16 v[176:179], a[8:11], v[196:199], v[176:179]
  v_cvt_pk_bf16_f32 v224, v160, v161
  v_cvt_pk_bf16_f32 v225, v162, v163
  v_mfma_f32_16x16x32_bf16 v[176:179], a[12:15], v[136:139], v[176:179]
  v_mfma_f32_16x16x32_bf16 v[176:179], a[16:19], v[144:147], v[176:179]
  v_mfma_f32_16x16x32_bf16 v[176:179], a[20:23], v[180:183], v[176:179]
  buffer_load_dwordx4 v[64:67], v15, s[12:15], s75 offen
  v_mfma_f32_16x16x32_bf16 v[160:163], a[24:27], v[132:135], 0
  v_mfma_f32_16x16x32_bf16 v[160:163], a[28:31], v[184:187], v[160:163]
  v_cvt_pk_bf16_f32 v200, v176, v177
  v_cvt_pk_bf16_f32 v201, v178, v179
  v_mfma_f32_16x16x32_bf16 v[160:163], a[32:35], v[196:199], v[160:163]
  v_mfma_f32_16x16x32_bf16 v[160:163], a[36:39], v[136:139], v[160:163]
  v_mfma_f32_16x16x32_bf16 v[160:163], a[40:43], v[144:147], v[160:163]
  buffer_load_dwordx4 v[68:71], v15, s[12:15], s75 offen offset:1024
  v_mfma_f32_16x16x32_bf16 v[160:163], a[44:47], v[180:183], v[160:163]
  v_mfma_f32_16x16x32_bf16 v[176:179], a[48:51], v[132:135], 0
  v_mfma_f32_16x16x32_bf16 v[176:179], a[52:55], v[184:187], v[176:179]
  ds_read_b64 v[116:117], v19 offset:784
  v_cvt_pk_bf16_f32 v202, v160, v161
  v_mfma_f32_16x16x32_bf16 v[176:179], a[56:59], v[196:199], v[176:179]
  buffer_load_dwordx4 v[72:75], v15, s[12:15], s75 offen offset:2048
  v_mfma_f32_16x16x32_bf16 v[176:179], a[60:63], v[136:139], v[176:179]
  v_cvt_pk_bf16_f32 v203, v162, v163
  v_mfma_f32_16x16x32_bf16 v[176:179], a[64:67], v[144:147], v[176:179]
  ds_read2_b64 v[160:163], v19 offset0:96 offset1:97
  v_mfma_f32_16x16x32_bf16 v[176:179], a[68:71], v[180:183], v[176:179]
  v_mfma_f32_16x16x32_bf16 v[168:171], v[132:135], a[144:147], 0
  v_mfma_f32_16x16x32_bf16 v[168:171], v[184:187], a[148:151], v[168:171]
  buffer_load_dwordx4 v[76:79], v15, s[12:15], s75 offen offset:3072
  v_mfma_f32_16x16x32_bf16 v[168:171], v[196:199], a[152:155], v[168:171]
  v_cvt_pk_bf16_f32 v112, v176, v177
  v_cvt_pk_bf16_f32 v113, v178, v179
  v_mfma_f32_16x16x32_bf16 v[168:171], v[136:139], a[156:159], v[168:171]
  v_mfma_f32_16x16x32_bf16 v[168:171], v[144:147], a[160:163], v[168:171]
  v_mfma_f32_16x16x32_bf16 v[168:171], v[180:183], a[164:167], v[168:171]
  buffer_load_dwordx4 v[80:83], v15, s[12:15], s77 offen
  v_mfma_f32_16x16x32_bf16 v[176:179], v[132:135], a[168:171], 0
  v_mfma_f32_16x16x32_bf16 v[176:179], v[184:187], a[172:175], v[176:179]
  v_cvt_pk_bf16_f32 v194, v168, v169
  v_cvt_pk_bf16_f32 v195, v170, v171
  v_mfma_f32_16x16x32_bf16 v[176:179], v[196:199], a[176:179], v[176:179]
  v_mfma_f32_16x16x32_bf16 v[176:179], v[136:139], a[180:183], v[176:179]
  v_mfma_f32_16x16x32_bf16 v[176:179], v[144:147], a[184:187], v[176:179]
  buffer_load_dwordx4 v[84:87], v15, s[12:15], s77 offen offset:1024
  v_mfma_f32_16x16x32_bf16 v[176:179], v[180:183], a[188:191], v[176:179]
  s_waitcnt lgkmcnt(0)
  v_mfma_f32_16x16x16_bf16 v[168:171], v[116:117], v[166:167], 0
  v_mfma_f32_16x16x16_bf16 v[216:219], v[116:117], v[224:225], 0
  v_cvt_pk_bf16_f32 v210, v176, v177
  v_cvt_pk_bf16_f32 v211, v178, v179
  v_mfma_f32_16x16x16_bf16 v[176:179], v[166:167], v[164:165], 0
  v_mfma_f32_16x16x16_bf16 v[212:215], v[224:225], v[164:165], 0
  v_mfma_f32_16x16x32_bf16 v[168:171], v[160:163], v[156:159], v[168:171]
  v_mfma_f32_16x16x32_bf16 v[216:219], v[160:163], v[148:151], v[216:219]
  v_mfma_f32_16x16x32_bf16 v[176:179], v[156:159], v[152:155], v[176:179]
  v_mfma_f32_16x16x32_bf16 v[212:215], v[148:151], v[152:155], v[212:215]
  s_barrier
  v_mfma_f32_16x16x32_bf16 v[188:191], v[132:135], a[192:195], 0
  ds_read_b128 v[132:135], v15 offset:14336
  ds_read_b128 v[128:131], v15 offset:15360
  v_mfma_f32_16x16x32_bf16 v[188:191], v[184:187], a[196:199], v[188:191]
  ds_read_b128 v[184:187], v15 offset:16384
  v_cndmask_b32 v251, v216, v168, s[56:57]
  v_mfma_f32_16x16x32_bf16 v[188:191], v[196:199], a[200:203], v[188:191]
  ds_read_b128 v[196:199], v15 offset:17408
  v_mfma_f32_16x16x32_bf16 v[188:191], v[136:139], a[204:207], v[188:191]
  ds_read_b128 v[136:139], v15 offset:18432
  v_mfma_f32_16x16x32_bf16 v[188:191], v[144:147], a[208:211], v[188:191]
  ds_read_b128 v[144:147], v15 offset:19456
  v_mfma_f32_16x16x32_bf16 v[188:191], v[180:183], a[212:215], v[188:191]
  v_exp_f32 v176, v176
  v_mfma_f32_16x16x16_bf16 v[180:183], v[166:167], v[112:113], 0
  buffer_store_dwordx4 v[140:143], v14, s[8:11], s32 offen
  s_nop 2
  v_cvt_pk_bf16_f32 v174, v188, v189
  v_mfma_f32_16x16x16_bf16 v[140:143], v[224:225], v[112:113], 0
  v_exp_f32 v177, v177
  v_exp_f32 v178, v178
  v_mfma_f32_16x16x32_bf16 v[180:183], v[156:159], v[200:203], v[180:183]
  v_exp_f32 v179, v179
  v_mfma_f32_16x16x32_bf16 v[140:143], v[148:151], v[200:203], v[140:143]
  s_waitcnt lgkmcnt(5)
  v_exp_f32 v212, v212
  v_mfma_f32_16x16x32_bf16 v[168:171], a[72:75], v[132:135], 0
  s_waitcnt lgkmcnt(4)
  v_exp_f32 v213, v213
  v_mfma_f32_16x16x32_bf16 v[168:171], a[76:79], v[128:131], v[168:171]
  s_waitcnt lgkmcnt(3)
  v_exp_f32 v214, v214
  v_mfma_f32_16x16x32_bf16 v[168:171], a[80:83], v[184:187], v[168:171]
  s_waitcnt lgkmcnt(2)
  v_exp_f32 v215, v215
  v_mfma_f32_16x16x32_bf16 v[168:171], a[84:87], v[196:199], v[168:171]
  s_waitcnt lgkmcnt(1)
  v_cvt_pk_bf16_f32 v175, v190, v191
  v_cvt_pk_bf16_f32 v188, v176, v177
  v_mfma_f32_16x16x32_bf16 v[168:171], a[88:91], v[136:139], v[168:171]
  s_waitcnt lgkmcnt(0)
  v_exp_f32 v180, v180
  v_mfma_f32_16x16x32_bf16 v[168:171], a[92:95], v[144:147], v[168:171]
  v_exp_f32 v181, v181
  v_mfma_f32_16x16x32_bf16 v[216:219], a[96:99], v[132:135], 0
  v_exp_f32 v182, v182
  v_mfma_f32_16x16x32_bf16 v[216:219], a[100:103], v[128:131], v[216:219]
  v_exp_f32 v183, v183
  v_mfma_f32_16x16x32_bf16 v[216:219], a[104:107], v[184:187], v[216:219]
  ds_read_b64 v[226:227], v19 offset:16
  v_cvt_pk_bf16_f32 v189, v178, v179
  v_mfma_f32_16x16x32_bf16 v[216:219], a[108:111], v[196:199], v[216:219]
  v_exp_f32 v140, v140
  v_mfma_f32_16x16x32_bf16 v[216:219], a[112:115], v[136:139], v[216:219]
  v_exp_f32 v141, v141
  v_mfma_f32_16x16x32_bf16 v[216:219], a[116:119], v[144:147], v[216:219]
  v_exp_f32 v142, v142
  v_mfma_f32_16x16x32_bf16 v[176:179], a[120:123], v[132:135], 0
  s_waitcnt vmcnt(7)
  buffer_store_dwordx2 v[108:109], v23, s[8:11], s32 offen
  v_cvt_pk_bf16_f32 v190, v212, v213
  v_mfma_f32_16x16x32_bf16 v[176:179], a[124:127], v[128:131], v[176:179]
  v_exp_f32 v143, v143
  v_mfma_f32_16x16x32_bf16 v[176:179], a[128:131], v[184:187], v[176:179]
  v_cvt_pk_bf16_f32 v191, v214, v215
  v_cvt_pk_bf16_f32 v212, v168, v169
  v_mfma_f32_16x16x32_bf16 v[176:179], a[132:135], v[196:199], v[176:179]
  ds_read2_b64 v[220:223], v19 offset0:0 offset1:1
  v_cvt_pk_bf16_f32 v213, v170, v171
  v_mfma_f32_16x16x32_bf16 v[176:179], a[136:139], v[136:139], v[176:179]
  v_cvt_pk_bf16_f32 v168, v180, v181
  v_cvt_pk_bf16_f32 v169, v182, v183
  v_mfma_f32_16x16x32_bf16 v[176:179], a[140:143], v[144:147], v[176:179]
  v_cvt_pk_bf16_f32 v170, v140, v141
  v_cvt_pk_bf16_f32 v214, v216, v217
  v_mfma_f32_16x16x32_bf16 v[180:183], v[132:135], a[144:147], 0
  v_cvt_pk_bf16_f32 v215, v218, v219
  v_cvt_pk_bf16_f32 v171, v142, v143
  v_mfma_f32_16x16x32_bf16 v[180:183], v[128:131], a[148:151], v[180:183]
  v_cvt_pk_bf16_f32 v228, v176, v177
  v_cvt_pk_bf16_f32 v229, v178, v179
  v_mfma_f32_16x16x32_bf16 v[180:183], v[184:187], a[152:155], v[180:183]
  v_add_u32 v252, 5800, v207
  v_add_u32 v19, 1160, v19
  v_mfma_f32_16x16x32_bf16 v[180:183], v[196:199], a[156:159], v[180:183]
  v_mfma_f32_16x16x32_bf16 v[180:183], v[136:139], a[160:163], v[180:183]
  v_mfma_f32_16x16x32_bf16 v[180:183], v[144:147], a[164:167], v[180:183]
  s_waitcnt lgkmcnt(1)
  v_mfma_f32_16x16x16_bf16 v[176:179], v[228:229], v[164:165], 0
  v_mfma_f32_16x16x16_bf16 v[140:143], v[226:227], v[164:165], v[2:5]
  v_cvt_pk_bf16_f32 v108, v180, v181
  v_cvt_pk_bf16_f32 v109, v182, v183
  v_mfma_f32_16x16x16_bf16 v[180:183], v[228:229], v[112:113], 0
  v_mfma_f32_16x16x16_bf16 v[216:219], v[226:227], v[112:113], v[2:5]
  v_mfma_f32_16x16x32_bf16 v[176:179], v[212:215], v[152:155], v[176:179]
  s_waitcnt lgkmcnt(0)
  v_mfma_f32_16x16x32_bf16 v[140:143], v[220:223], v[152:155], v[140:143]
  v_mfma_f32_16x16x32_bf16 v[180:183], v[212:215], v[200:203], v[180:183]
  v_exp_f32 v176, v176
  v_mfma_f32_16x16x32_bf16 v[216:219], v[220:223], v[200:203], v[216:219]
  v_exp_f32 v177, v177
  v_mfma_f32_16x16x32_bf16 v[200:203], v[132:135], a[168:171], 0
  v_exp_f32 v178, v178
  v_mfma_f32_16x16x32_bf16 v[200:203], v[128:131], a[172:175], v[200:203]
  v_exp_f32 v179, v179
  v_mfma_f32_16x16x32_bf16 v[200:203], v[184:187], a[176:179], v[200:203]
  v_exp_f32 v140, v140
  v_mfma_f32_16x16x32_bf16 v[200:203], v[196:199], a[180:183], v[200:203]
  v_exp_f32 v180, v180
  v_mfma_f32_16x16x32_bf16 v[200:203], v[136:139], a[184:187], v[200:203]
  v_exp_f32 v181, v181
  v_mfma_f32_16x16x32_bf16 v[200:203], v[144:147], a[188:191], v[200:203]
  v_exp_f32 v182, v182
  v_mfma_f32_16x16x32_bf16 v[152:155], v[132:135], a[192:195], 0
  v_exp_f32 v183, v183
  v_mfma_f32_16x16x32_bf16 v[152:155], v[128:131], a[196:199], v[152:155]
  v_exp_f32 v216, v216
  v_mfma_f32_16x16x32_bf16 v[152:155], v[184:187], a[200:203], v[152:155]
  ds_read_u16 v110, v20
  v_cvt_pk_bf16_f32 v120, v176, v177
  v_mfma_f32_16x16x32_bf16 v[152:155], v[196:199], a[204:207], v[152:155]
  v_cvt_pk_bf16_f32 v121, v178, v179
  v_cvt_pk_bf16_f32 v122, v140, 0
  v_mfma_f32_16x16x32_bf16 v[152:155], v[136:139], a[208:211], v[152:155]
  ds_read_u16 v114, v20 offset:32
  v_cvt_pk_bf16_f32 v124, v180, v181
  v_mfma_f32_16x16x32_bf16 v[152:155], v[144:147], a[212:215], v[152:155]
  v_cvt_pk_bf16_f32 v112, v200, v201
  v_cvt_pk_bf16_f32 v113, v202, v203
  v_cvt_pk_bf16_f32 v125, v182, v183
  v_mfma_f32_16x16x16_bf16 v[180:183], v[116:117], v[228:229], 0
  v_cvt_pk_bf16_f32 v126, v216, 0
  v_mfma_f32_16x16x16_bf16 v[216:219], v[116:117], v[226:227], 0
  ds_read_u16 v118, v20 offset:64
  v_cvt_pk_bf16_f32 v116, v152, v153
  v_cvt_pk_bf16_f32 v117, v154, v155
  v_mfma_f32_16x16x32_bf16 v[180:183], v[160:163], v[212:215], v[180:183]
  v_mfma_f32_16x16x32_bf16 v[216:219], v[160:163], v[220:223], v[216:219]
  v_mfma_f32_16x16x32_bf16 v[160:163], a[0:3], v[132:135], 0
  v_mfma_f32_16x16x32_bf16 v[160:163], a[4:7], v[128:131], v[160:163]
  v_cndmask_b32 v164, v180, v216, s[56:57]
  v_cndmask_b32 v251, v164, v251, s[46:47]
  v_mfma_f32_16x16x32_bf16 v[160:163], a[8:11], v[184:187], v[160:163]
  v_exp_f32 v251, v251
  v_mfma_f32_16x16x32_bf16 v[160:163], a[12:15], v[196:199], v[160:163]
  v_cvt_pk_bf16_f32 v251, v251, 0
  v_mfma_f32_16x16x32_bf16 v[160:163], a[16:19], v[136:139], v[160:163]
  ds_write_b16 v26, v251
  v_mfma_f32_16x16x32_bf16 v[160:163], a[20:23], v[144:147], v[160:163]
  ds_read_b128 v[180:183], v27
  v_mfma_f32_16x16x32_bf16 v[216:219], a[246:249], v[188:191], 0
  v_mfma_f32_16x16x32_bf16 v[216:219], a[246:249], v[120:123], v[216:219]
  v_cvt_pk_bf16_f32 v152, v160, v161
  v_cvt_pk_bf16_f32 v153, v162, v163
  v_mfma_f32_16x16x32_bf16 v[160:163], v[192:195], v[188:191], 0
  s_waitcnt lgkmcnt(4)
  v_mfma_f32_16x16x32_bf16 v[160:163], v[108:111], v[120:123], v[160:163]
  v_mul_f32 v216, 0x3ee9a3cd, v216
  v_mfma_f32_16x16x32_bf16 v[200:203], v[208:211], v[188:191], 0
  s_waitcnt lgkmcnt(3)
  v_rcp_f32 v253, v216
  v_mfma_f32_16x16x32_bf16 v[200:203], v[112:115], v[120:123], v[200:203]
  v_mul_f32 v160, v160, v253
  v_mul_f32 v161, v161, v253
  v_mfma_f32_16x16x32_bf16 v[140:143], v[172:175], v[188:191], 0
  s_waitcnt lgkmcnt(2)
  v_cvt_pk_bf16_f32 v188, v160, v161
  v_mul_f32 v162, v162, v253
  v_mfma_f32_16x16x32_bf16 v[140:143], v[116:119], v[120:123], v[140:143]
  ds_read_b64 v[120:121], v27 offset:16
  v_cndmask_b32 v122, 0, v251, s[54:55]
  v_mfma_f32_16x16x32_bf16 v[176:179], a[24:27], v[132:135], 0
  v_mul_f32 v163, v163, v253
  v_cvt_pk_bf16_f32 v189, v162, v163
  v_mfma_f32_16x16x32_bf16 v[176:179], a[28:31], v[128:131], v[176:179]
  v_mul_f32 v200, v200, v253
  v_mul_f32 v201, v201, v253
  v_mfma_f32_16x16x32_bf16 v[176:179], a[32:35], v[184:187], v[176:179]
  v_cvt_pk_bf16_f32 v190, v200, v201
  v_mul_f32 v202, v202, v253
  v_mfma_f32_16x16x32_bf16 v[176:179], a[36:39], v[196:199], v[176:179]
  v_mul_f32 v203, v203, v253
  v_cvt_pk_bf16_f32 v191, v202, v203
  v_mfma_f32_16x16x32_bf16 v[176:179], a[40:43], v[136:139], v[176:179]
  ds_write_b128 v16, v[188:191] offset:20480
  v_mfma_f32_16x16x32_bf16 v[176:179], a[44:47], v[144:147], v[176:179]
  v_max3_f32 v1, v1, v216, v253
  v_mul_f32 v140, v140, v253
  v_mfma_f32_16x16x32_bf16 v[216:219], a[246:249], v[168:171], 0
  v_mul_f32 v141, v141, v253
  v_cvt_pk_bf16_f32 v164, v140, v141
  v_mfma_f32_16x16x32_bf16 v[216:219], a[246:249], v[124:127], v[216:219]
  v_cvt_pk_bf16_f32 v154, v176, v177
  v_cvt_pk_bf16_f32 v155, v178, v179
  v_mfma_f32_16x16x32_bf16 v[176:179], v[192:195], v[168:171], 0
  v_mul_f32 v142, v142, v253
  v_mul_f32 v143, v143, v253
  v_mfma_f32_16x16x32_bf16 v[176:179], v[108:111], v[124:127], v[176:179]
  v_cvt_pk_bf16_f32 v165, v142, v143
  v_mul_f32 v216, 0x3ee9a3cd, v216
  v_mfma_f32_16x16x32_bf16 v[140:143], v[208:211], v[168:171], 0
  ds_write_b64 v17, v[164:165] offset:20480
  v_mfma_f32_16x16x32_bf16 v[140:143], v[112:115], v[124:127], v[140:143]
  v_rcp_f32 v251, v216
  v_mfma_f32_16x16x32_bf16 v[188:191], v[172:175], v[168:171], 0
  v_mul_f32 v176, v176, v251
  v_mul_f32 v177, v177, v251
  v_mfma_f32_16x16x32_bf16 v[188:191], v[116:119], v[124:127], v[188:191]
  v_cvt_pk_bf16_f32 v168, v176, v177
  v_mul_f32 v178, v178, v251
  v_mfma_f32_16x16x32_bf16 v[200:203], a[48:51], v[132:135], 0
  v_mul_f32 v179, v179, v251
  v_cvt_pk_bf16_f32 v169, v178, v179
  v_mfma_f32_16x16x32_bf16 v[200:203], a[52:55], v[128:131], v[200:203]
  v_mul_f32 v140, v140, v251
  v_mul_f32 v141, v141, v251
  v_mfma_f32_16x16x32_bf16 v[200:203], a[56:59], v[184:187], v[200:203]
  v_cvt_pk_bf16_f32 v170, v140, v141
  v_mul_f32 v142, v142, v251
  v_mfma_f32_16x16x32_bf16 v[200:203], a[60:63], v[196:199], v[200:203]
  v_mul_f32 v143, v143, v251
  v_cvt_pk_bf16_f32 v171, v142, v143
  v_mfma_f32_16x16x32_bf16 v[200:203], a[64:67], v[136:139], v[200:203]
  ds_read2_b64 v[136:139], v207 offset0:0 offset1:4
  v_mul_f32 v188, v188, v251
  v_mfma_f32_16x16x32_bf16 v[200:203], a[68:71], v[144:147], v[200:203]
  s_waitcnt lgkmcnt(4)
  ds_read2_b64 v[144:147], v207 offset0:12 offset1:16
  v_mul_f32 v189, v189, v251
  v_mfma_f32_16x16x32_bf16 v[140:143], a[246:249], v[180:183], 0
  s_waitcnt lgkmcnt(4)
  v_cvt_pk_bf16_f32 v248, v188, v189
  v_mul_f32 v190, v190, v251
  v_mfma_f32_16x16x32_bf16 v[140:143], a[246:249], v[120:123], v[140:143]
  ds_read_b128 v[196:199], v18
  v_cvt_pk_bf16_f32 v164, v200, v201
  v_mfma_f32_16x16x32_bf16 v[184:187], v[180:183], v[192:195], 0
  ds_read2_b64 v[128:131], v207 offset0:24 offset1:28
  v_cvt_pk_bf16_f32 v165, v202, v203
  v_mfma_f32_16x16x32_bf16 v[184:187], v[120:123], v[108:111], v[184:187]
  v_mul_f32 v140, 0x3ee9a3cd, v140
  v_mul_f32 v191, v191, v251
  v_mfma_f32_16x16x32_bf16 v[200:203], v[180:183], v[208:211], 0
  ds_read_b128 v[176:179], v18 offset:6144
  v_cvt_pk_bf16_f32 v249, v190, v191
  v_mfma_f32_16x16x32_bf16 v[200:203], v[120:123], v[112:115], v[200:203]
  ds_read2_b64 v[188:191], v207 offset0:36 offset1:40
  v_max3_f32 v1, v1, v216, v251
  v_mfma_f32_16x16x32_bf16 v[216:219], v[180:183], v[172:175], 0
  v_rcp_f32 v126, v140
  v_mfma_f32_16x16x32_bf16 v[216:219], v[120:123], v[116:119], v[216:219]
  ds_read_b128 v[180:183], v18 offset:9216
  v_cndmask_b32 v251, v200, v184, s[54:55]
  v_max3_f32 v1, v1, v140, v126
  v_mfma_f32_16x16x16_bf16 v[140:143], v[166:167], v[164:165], 0
  ds_read2_b64 v[184:187], v207 offset0:8 offset1:20
  v_mfma_f32_16x16x16_bf16 v[200:203], v[224:225], v[164:165], 0
  v_cndmask_b32 v251, v216, v251, s[56:57]
  v_mul_f32 v251, v251, v126
  v_cvt_pk_bf16_f32 v251, v251, v251
  v_mfma_f32_16x16x16_bf16 v[216:219], v[228:229], v[164:165], 0
  ds_read_b128 v[132:135], v18 offset:3072
  v_mfma_f32_16x16x16_bf16 v[160:163], v[226:227], v[164:165], v[2:5]
  ds_read2_b64 v[164:167], v207 offset0:32 offset1:44
  v_mfma_f32_16x16x32_bf16 v[140:143], v[156:159], v[152:155], v[140:143]
  ds_read_b128 v[156:159], v18 offset:12288
  v_mfma_f32_16x16x32_bf16 v[200:203], v[148:151], v[152:155], v[200:203]
  ds_read_b128 v[148:151], v18 offset:1024
  v_mfma_f32_16x16x32_bf16 v[216:219], v[212:215], v[152:155], v[216:219]
  v_exp_f32 v140, v140
  v_mfma_f32_16x16x32_bf16 v[160:163], v[220:223], v[152:155], v[160:163]
  s_waitcnt vmcnt(7) lgkmcnt(11)
  ds_read_b128 v[152:155], v18 offset:7168
  ds_read_b128 v[220:223], v18 offset:10240
  v_mfma_f32_16x16x32_bf16 v[64:67], a[250:253], v[136:139], v[64:67]
  s_waitcnt lgkmcnt(11)
  v_exp_f32 v141, v141
  v_mfma_f32_16x16x32_bf16 v[64:67], v[196:199], v[144:147], v[64:67]
  s_waitcnt lgkmcnt(9)
  ds_read_b128 v[212:215], v18 offset:4096
  ds_read_b128 v[224:227], v18 offset:13312
  v_mfma_f32_16x16x32_bf16 v[64:67], v[176:179], v[128:131], v[64:67]
  s_waitcnt lgkmcnt(9)
  v_exp_f32 v142, v142
  v_mfma_f32_16x16x32_bf16 v[64:67], v[180:183], v[188:191], v[64:67]
  s_waitcnt lgkmcnt(7)
  ds_read_b128 v[228:231], v18 offset:2048
  ds_read_b128 v[232:235], v18 offset:8192
  v_mfma_f32_16x16x32_bf16 v[64:67], v[132:135], v[184:187], v[64:67]
  s_waitcnt lgkmcnt(7)
  v_exp_f32 v143, v143
  v_mfma_f32_16x16x32_bf16 v[64:67], v[156:159], v[164:167], v[64:67]
  s_waitcnt vmcnt(6)
  ds_read_b128 v[236:239], v18 offset:11264
  ds_read_b128 v[240:243], v18 offset:5120
  v_mfma_f32_16x16x32_bf16 v[68:71], v[100:103], v[136:139], v[68:71]
  s_waitcnt lgkmcnt(8)
  v_exp_f32 v200, v200
  v_mfma_f32_16x16x32_bf16 v[68:71], v[148:151], v[144:147], v[68:71]
  s_waitcnt lgkmcnt(7)
  v_exp_f32 v201, v201
  v_mfma_f32_16x16x32_bf16 v[68:71], v[152:155], v[128:131], v[68:71]
  s_waitcnt lgkmcnt(6)
  v_exp_f32 v202, v202
  v_mfma_f32_16x16x32_bf16 v[68:71], v[220:223], v[188:191], v[68:71]
  s_waitcnt lgkmcnt(5)
  v_exp_f32 v203, v203
  v_mfma_f32_16x16x32_bf16 v[68:71], v[212:215], v[184:187], v[68:71]
  s_waitcnt lgkmcnt(4)
  v_exp_f32 v216, v216
  v_mfma_f32_16x16x32_bf16 v[68:71], v[224:227], v[164:167], v[68:71]
  v_exp_f32 v217, v217
  v_exp_f32 v218, v218
  v_exp_f32 v219, v219
  v_exp_f32 v160, v160
  v_cvt_pk_bf16_f32 v244, v140, v141
  v_cvt_pk_bf16_f32 v245, v142, v143
  v_cvt_pk_bf16_f32 v246, v200, v201
  v_cvt_pk_bf16_f32 v247, v202, v203
  v_cvt_pk_bf16_f32 v124, v216, v217
  v_cvt_pk_bf16_f32 v125, v218, v219
  v_mfma_f32_16x16x32_bf16 v[216:219], a[246:249], v[244:247], 0
  v_cvt_pk_bf16_f32 v126, v160, 0
  v_cvt_pk_bf16_f32 v160, v64, v65
  v_cvt_pk_bf16_f32 v161, v66, v67
  v_mfma_f32_16x16x32_bf16 v[216:219], a[246:249], v[124:127], v[216:219]
  ds_write_b128 v16, v[168:171] offset:26624
  v_mfma_f32_16x16x32_bf16 v[168:171], v[192:195], v[244:247], 0
  s_nop 3
  v_mul_f32 v216, 0x3ee9a3cd, v216
  v_cvt_pk_bf16_f32 v162, v68, v69
  v_mfma_f32_16x16x32_bf16 v[168:171], v[108:111], v[124:127], v[168:171]
  ds_read_b128 v[192:195], v18 offset:14336
  v_cvt_pk_bf16_f32 v163, v70, v71
  v_mfma_f32_16x16x32_bf16 v[200:203], v[208:211], v[244:247], 0
  ds_write_b64 v17, v[248:249] offset:26624
  v_mfma_f32_16x16x32_bf16 v[200:203], v[112:115], v[124:127], v[200:203]
  v_rcp_f32 v114, v216
  v_mfma_f32_16x16x32_bf16 v[208:211], v[172:175], v[244:247], 0
  ds_write_b16 v20, v251 offset:384
  v_mfma_f32_16x16x32_bf16 v[208:211], v[116:119], v[124:127], v[208:211]
  s_waitcnt vmcnt(5)
  v_mul_f32 v168, v168, v114
  v_mul_f32 v169, v169, v114
  v_mfma_f32_16x16x32_bf16 v[72:75], v[104:107], v[136:139], v[72:75]
  s_waitcnt lgkmcnt(7)
  v_mul_f32 v170, v170, v114
  v_mul_f32 v171, v171, v114
  v_mfma_f32_16x16x32_bf16 v[72:75], v[228:231], v[144:147], v[72:75]
  s_waitcnt lgkmcnt(6)
  v_mul_f32 v200, v200, v114
  v_mul_f32 v201, v201, v114
  v_mfma_f32_16x16x32_bf16 v[72:75], v[232:235], v[128:131], v[72:75]
  s_waitcnt lgkmcnt(5)
  v_mul_f32 v202, v202, v114
  v_mul_f32 v203, v203, v114
  v_mfma_f32_16x16x32_bf16 v[72:75], v[236:239], v[188:191], v[72:75]
  s_waitcnt lgkmcnt(4)
  v_cvt_pk_bf16_f32 v188, v168, v169
  v_cvt_pk_bf16_f32 v189, v170, v171
  v_mfma_f32_16x16x32_bf16 v[72:75], v[240:243], v[184:187], v[72:75]
  s_waitcnt lgkmcnt(2)
  v_cvt_pk_bf16_f32 v190, v200, v201
  v_cvt_pk_bf16_f32 v191, v202, v203
  v_mfma_f32_16x16x32_bf16 v[72:75], v[192:195], v[164:167], v[72:75]
  s_waitcnt lgkmcnt(0)
  ds_write_b128 v16, v[188:191] offset:32768
  v_mul_f32 v208, v208, v114
  v_mul_f32 v209, v209, v114
  v_mul_f32 v210, v210, v114
  v_mul_f32 v211, v211, v114
  v_cvt_pk_bf16_f32 v116, v208, v209
  v_cvt_pk_bf16_f32 v117, v210, v211
  ds_write_b64 v17, v[116:117] offset:32768
  v_max3_f32 v1, v1, v216, v114
  ds_write_b32 v111, v1
  v_cvt_pk_bf16_f32 v216, v72, v73
  v_cvt_pk_bf16_f32 v217, v74, v75
  v_permlane16_swap_b32 v160, v162
  v_permlane16_swap_b32 v161, v163
  v_add_u32 v20, 1160, v20
  buffer_store_dwordx4 v[160:163], v204, s[8:11], 0 offen
  s_waitcnt lgkmcnt(0)
  s_barrier
  ds_read_b128 v[160:163], v15 offset:20480
  ds_read_b128 v[208:211], v15 offset:21504
  ds_read_b128 v[188:191], v15 offset:22528
  ds_read_b128 v[164:167], v15 offset:23552
  ds_read_b128 v[200:203], v15 offset:24576
  ds_read_b128 v[184:187], v15 offset:25600
  ds_read_b128 v[168:171], v250
  s_waitcnt lgkmcnt(6)
  v_mfma_f32_16x16x32_bf16 v[28:31], a[250:253], v[160:163], v[28:31]
  s_waitcnt lgkmcnt(5)
  v_mfma_f32_16x16x32_bf16 v[28:31], v[196:199], v[208:211], v[28:31]
  s_waitcnt lgkmcnt(4)
  v_mfma_f32_16x16x32_bf16 v[28:31], v[176:179], v[188:191], v[28:31]
  s_waitcnt lgkmcnt(3)
  v_mfma_f32_16x16x32_bf16 v[28:31], v[180:183], v[164:167], v[28:31]
  s_waitcnt lgkmcnt(2)
  v_mfma_f32_16x16x32_bf16 v[28:31], v[132:135], v[200:203], v[28:31]
  s_waitcnt lgkmcnt(1)
  v_mfma_f32_16x16x32_bf16 v[28:31], v[156:159], v[184:187], v[28:31]
  ds_read_b128 v[128:131], v15 offset:26624
  v_mfma_f32_16x16x32_bf16 v[32:35], v[100:103], v[160:163], v[32:35]
  s_waitcnt lgkmcnt(1)
  ds_read_b128 v[144:147], v15 offset:27648
  v_max3_f32 v1, v168, v169, v170
  v_mfma_f32_16x16x32_bf16 v[32:35], v[148:151], v[208:211], v[32:35]
  ds_read_b128 v[136:139], v15 offset:28672
  v_cvt_pk_bf16_f32 v172, v28, v29
  v_mfma_f32_16x16x32_bf16 v[32:35], v[152:155], v[188:191], v[32:35]
  ds_read_b128 v[244:247], v15 offset:29696
  v_cvt_pk_bf16_f32 v173, v30, v31
  v_mfma_f32_16x16x32_bf16 v[32:35], v[220:223], v[164:167], v[32:35]
  ds_read_b128 v[140:143], v15 offset:30720
  v_max_f32 v1, v1, v171
  v_mfma_f32_16x16x32_bf16 v[32:35], v[212:215], v[200:203], v[32:35]
  ds_read_b128 v[168:171], v15 offset:31744
  v_mfma_f32_16x16x32_bf16 v[32:35], v[224:227], v[184:187], v[32:35]
  v_mfma_f32_16x16x32_bf16 v[36:39], v[104:107], v[160:163], v[36:39]
  v_mfma_f32_16x16x32_bf16 v[36:39], v[228:231], v[208:211], v[36:39]
  v_cvt_pk_bf16_f32 v174, v32, v33
  v_cvt_pk_bf16_f32 v175, v34, v35
  v_mfma_f32_16x16x32_bf16 v[36:39], v[232:235], v[188:191], v[36:39]
  v_permlane16_swap_b32 v172, v174
  v_mfma_f32_16x16x32_bf16 v[36:39], v[236:239], v[164:167], v[36:39]
  v_permlane16_swap_b32 v173, v175
  v_mfma_f32_16x16x32_bf16 v[36:39], v[240:243], v[200:203], v[36:39]
  buffer_store_dwordx4 v[172:175], v12, s[8:11], s33 offen
  v_mfma_f32_16x16x32_bf16 v[36:39], v[192:195], v[184:187], v[36:39]
  s_waitcnt lgkmcnt(5)
  v_mfma_f32_16x16x32_bf16 v[40:43], a[250:253], v[128:131], v[40:43]
  s_waitcnt lgkmcnt(4)
  v_mfma_f32_16x16x32_bf16 v[40:43], v[196:199], v[144:147], v[40:43]
  s_waitcnt lgkmcnt(3)
  v_cvt_pk_bf16_f32 v184, v36, v37
  v_cvt_pk_bf16_f32 v185, v38, v39
  v_mfma_f32_16x16x32_bf16 v[40:43], v[176:179], v[136:139], v[40:43]
  s_waitcnt lgkmcnt(2)
  v_mfma_f32_16x16x32_bf16 v[40:43], v[180:183], v[244:247], v[40:43]
  s_waitcnt lgkmcnt(1)
  v_mfma_f32_16x16x32_bf16 v[40:43], v[132:135], v[140:143], v[40:43]
  s_waitcnt lgkmcnt(0)
  v_mfma_f32_16x16x32_bf16 v[40:43], v[156:159], v[168:171], v[40:43]
  ds_read_b128 v[172:175], v15 offset:32768
  v_mfma_f32_16x16x32_bf16 v[44:47], v[100:103], v[128:131], v[44:47]
  ds_read_b128 v[200:203], v15 offset:33792
  v_mfma_f32_16x16x32_bf16 v[44:47], v[148:151], v[144:147], v[44:47]
  ds_read_b128 v[164:167], v15 offset:34816
  v_cvt_pk_bf16_f32 v188, v40, v41
  v_mfma_f32_16x16x32_bf16 v[44:47], v[152:155], v[136:139], v[44:47]
  ds_read_b128 v[208:211], v15 offset:35840
  v_cvt_pk_bf16_f32 v189, v42, v43
  v_mfma_f32_16x16x32_bf16 v[44:47], v[220:223], v[244:247], v[44:47]
  ds_read_b128 v[160:163], v15 offset:36864
  v_mfma_f32_16x16x32_bf16 v[44:47], v[212:215], v[140:143], v[44:47]
  ds_read_b128 v[248:251], v15 offset:37888
  v_mfma_f32_16x16x32_bf16 v[44:47], v[224:227], v[168:171], v[44:47]
  v_mfma_f32_16x16x32_bf16 v[48:51], v[104:107], v[128:131], v[48:51]
  v_mfma_f32_16x16x32_bf16 v[48:51], v[228:231], v[144:147], v[48:51]
  v_cvt_pk_bf16_f32 v190, v44, v45
  v_cvt_pk_bf16_f32 v191, v46, v47
  v_mfma_f32_16x16x32_bf16 v[48:51], v[232:235], v[136:139], v[48:51]
  v_permlane16_swap_b32 v188, v190
  v_mfma_f32_16x16x32_bf16 v[48:51], v[236:239], v[244:247], v[48:51]
  v_permlane16_swap_b32 v189, v191
  v_mfma_f32_16x16x32_bf16 v[48:51], v[240:243], v[140:143], v[48:51]
  buffer_store_dwordx4 v[188:191], v13, s[8:11], s33 offen
  v_mfma_f32_16x16x32_bf16 v[48:51], v[192:195], v[168:171], v[48:51]
  s_waitcnt lgkmcnt(5)
  v_mfma_f32_16x16x32_bf16 v[52:55], a[250:253], v[172:175], v[52:55]
  s_waitcnt lgkmcnt(4)
  ds_read2_b64 v[168:171], v252 offset0:0 offset1:4
  v_mfma_f32_16x16x32_bf16 v[52:55], v[196:199], v[200:203], v[52:55]
  s_waitcnt lgkmcnt(4)
  ds_read2_b64 v[188:191], v252 offset0:12 offset1:16
  v_cvt_pk_bf16_f32 v186, v48, v49
  v_mfma_f32_16x16x32_bf16 v[52:55], v[176:179], v[164:167], v[52:55]
  s_waitcnt lgkmcnt(4)
  v_cvt_pk_bf16_f32 v187, v50, v51
  v_mfma_f32_16x16x32_bf16 v[52:55], v[180:183], v[208:211], v[52:55]
  s_waitcnt lgkmcnt(3)
  ds_read2_b64 v[140:143], v252 offset0:24 offset1:28
  v_mfma_f32_16x16x32_bf16 v[52:55], v[132:135], v[160:163], v[52:55]
  s_waitcnt lgkmcnt(3)
  v_permlane16_swap_b32 v184, v186
  v_mfma_f32_16x16x32_bf16 v[52:55], v[156:159], v[248:251], v[52:55]
  ds_read2_b64 v[244:247], v252 offset0:36 offset1:40
  v_mfma_f32_16x16x32_bf16 v[56:59], v[100:103], v[172:175], v[56:59]
  v_permlane16_swap_b32 v185, v187
  v_mfma_f32_16x16x32_bf16 v[56:59], v[148:151], v[200:203], v[56:59]
  ds_read2_b64 v[136:139], v252 offset0:8 offset1:20
  v_cvt_pk_bf16_f32 v144, v52, v53
  v_mfma_f32_16x16x32_bf16 v[56:59], v[152:155], v[164:167], v[56:59]
  v_cvt_pk_bf16_f32 v145, v54, v55
  v_mfma_f32_16x16x32_bf16 v[56:59], v[220:223], v[208:211], v[56:59]
  ds_read2_b64 v[128:131], v252 offset0:32 offset1:44
  v_mfma_f32_16x16x32_bf16 v[56:59], v[212:215], v[160:163], v[56:59]
  v_mfma_f32_16x16x32_bf16 v[56:59], v[224:227], v[248:251], v[56:59]
  v_mfma_f32_16x16x32_bf16 v[60:63], v[104:107], v[172:175], v[60:63]
  v_mfma_f32_16x16x32_bf16 v[60:63], v[228:231], v[200:203], v[60:63]
  v_cvt_pk_bf16_f32 v146, v56, v57
  v_cvt_pk_bf16_f32 v147, v58, v59
  v_mfma_f32_16x16x32_bf16 v[60:63], v[232:235], v[164:167], v[60:63]
  buffer_store_dwordx4 v[184:187], v22, s[8:11], s33 offen
  v_mfma_f32_16x16x32_bf16 v[60:63], v[236:239], v[208:211], v[60:63]
  v_permlane16_swap_b32 v144, v146
  v_mfma_f32_16x16x32_bf16 v[60:63], v[240:243], v[160:163], v[60:63]
  v_permlane16_swap_b32 v145, v147
  v_mfma_f32_16x16x32_bf16 v[60:63], v[192:195], v[248:251], v[60:63]
  s_waitcnt vmcnt(8) lgkmcnt(5)
  v_mfma_f32_16x16x32_bf16 v[76:79], a[250:253], v[168:171], v[76:79]
  s_waitcnt lgkmcnt(4)
  v_mfma_f32_16x16x32_bf16 v[76:79], v[196:199], v[188:191], v[76:79]
  s_waitcnt lgkmcnt(3)
  v_cvt_pk_bf16_f32 v116, v60, v61
  v_cvt_pk_bf16_f32 v117, v62, v63
  v_mfma_f32_16x16x32_bf16 v[76:79], v[176:179], v[140:143], v[76:79]
  s_waitcnt lgkmcnt(2)
  v_mfma_f32_16x16x32_bf16 v[76:79], v[180:183], v[244:247], v[76:79]
  s_waitcnt lgkmcnt(1)
  v_mfma_f32_16x16x32_bf16 v[76:79], v[132:135], v[136:139], v[76:79]
  s_waitcnt lgkmcnt(0)
  v_mfma_f32_16x16x32_bf16 v[76:79], v[156:159], v[128:131], v[76:79]
  s_waitcnt vmcnt(7)
  v_mfma_f32_16x16x32_bf16 v[80:83], v[100:103], v[168:171], v[80:83]
  v_mfma_f32_16x16x32_bf16 v[80:83], v[148:151], v[188:191], v[80:83]
  v_cvt_pk_bf16_f32 v148, v76, v77
  v_cvt_pk_bf16_f32 v149, v78, v79
  v_mfma_f32_16x16x32_bf16 v[80:83], v[152:155], v[140:143], v[80:83]
  v_mfma_f32_16x16x32_bf16 v[80:83], v[220:223], v[244:247], v[80:83]
  v_mfma_f32_16x16x32_bf16 v[80:83], v[212:215], v[136:139], v[80:83]
  v_mfma_f32_16x16x32_bf16 v[80:83], v[224:227], v[128:131], v[80:83]
  s_waitcnt vmcnt(6)
  v_mfma_f32_16x16x32_bf16 v[84:87], v[104:107], v[168:171], v[84:87]
  buffer_store_dwordx4 v[144:147], v14, s[8:11], s33 offen
  s_nop 2
  v_cvt_pk_bf16_f32 v150, v80, v81
  v_mfma_f32_16x16x32_bf16 v[84:87], v[228:231], v[188:191], v[84:87]
  v_cvt_pk_bf16_f32 v151, v82, v83
  v_mfma_f32_16x16x32_bf16 v[84:87], v[232:235], v[140:143], v[84:87]
  v_permlane16_swap_b32 v148, v150
  v_mfma_f32_16x16x32_bf16 v[84:87], v[236:239], v[244:247], v[84:87]
  v_permlane16_swap_b32 v149, v151
  v_mfma_f32_16x16x32_bf16 v[84:87], v[240:243], v[136:139], v[84:87]
  v_mfma_f32_16x16x32_bf16 v[84:87], v[192:195], v[128:131], v[84:87]
  s_nop 7
  v_cvt_pk_bf16_f32 v218, v84, v85
  v_cvt_pk_bf16_f32 v219, v86, v87
  s_nop 0
  v_permlane16_swap_b32 v216, v218
  v_permlane16_swap_b32 v217, v219
  buffer_store_dwordx2 v[116:117], v23, s[8:11], s33 offen
  buffer_store_dwordx4 v[148:151], v205, s[8:11], 0 offen
  buffer_store_dwordx4 v[216:219], v206, s[8:11], 0 offen
  v_cmp_nge_f32 vcc, 0x67800000, v1
  s_nop 4
  s_cmp_eq_u64 vcc, 0
  s_cbranch_scc1 L_exit
L_safe:
  s_waitcnt vmcnt(0)
  s_barrier
  v_mbcnt_lo_u32_b32 v220, -1, 0
  v_mbcnt_hi_u32_b32 v220, -1, v220
  v_lshrrev_b32 v221, 4, v220
  v_and_b32 v222, 15, v220
  s_add_u32 s60, s74, 38912
  v_mul_u32_u24 v223, 24, v221
  v_add_u32 v19, s60, v223
  v_min_u32 v223, 2, v221
  v_lshl_add_u32 v223, v223, 4, v222
  s_add_u32 s60, s60, 384
  v_lshl_add_u32 v20, v223, 1, s60
  v_cmp_gt_u32 vcc, 5, v222
  v_mul_u32_u24 v223, 1160, v222
  v_add_u32 v249, v19, v223
  v_lshl_add_u32 v223, v221, 3, v223
  v_add_u32 v247, s60, v223
  v_mov_b32 v224, 0x30000
  v_add_u32 v250, 5800, v249
  v_cndmask_b32 v249, v224, v249, vcc
  v_add_u32 v248, 5800, v247
  v_cndmask_b32 v247, v224, v247, vcc
  s_mov_b32 s31, 0
  buffer_load_dwordx4 v[128:131], v15, s[12:15], s77 offen offset:3072
  buffer_load_dwordx2 v[108:109], v15, s[12:15], s78 offen
  buffer_load_dwordx4 v[132:135], v15, s[12:15], s78 offen offset:1024
  buffer_load_dwordx2 v[112:113], v15, s[12:15], s78 offen offset:2048
  s_waitcnt vmcnt(3)
  ds_write_b64 v249, v[128:129] offset:768
  ds_write_b64 v249, v[130:131] offset:776
  s_waitcnt vmcnt(2)
  ds_write_b64 v249, v[108:109] offset:784
  s_waitcnt vmcnt(1)
  ds_write_b64 v250, v[132:133] offset:768
  ds_write_b64 v250, v[134:135] offset:776
  s_waitcnt vmcnt(0)
  ds_write_b64 v250, v[112:113] offset:784
  s_waitcnt lgkmcnt(0)
L_safe_loop:
  s_lshl_b32 s60, s31, 5
  s_add_u32 s61, s60, s30
  s_add_u32 s60, s60, s29
  s_mul_i32 s62, s60, 7183
  s_lshr_b32 s62, s62, 22
  s_mul_i32 s63, s62, 584
  s_sub_u32 s63, s60, s63
  s_lshr_b32 s64, s63, 3
  s_and_b32 s65, s63, 7
  s_lshl_b32 s66, s62, 3
  s_add_u32 s65, s65, s66
  s_cmp_ge_u32 s60, 5256
  s_cselect_b32 s64, s63, s64
  s_cselect_b32 s65, 72, s65
  s_mul_i32 s66, s65, 1373568
  s_mul_i32 s67, s64, 2688
  s_add_u32 s35, s66, s67
  s_cmp_ge_u32 s61, 667
  s_cselect_b32 s35, 268435456, s35
  s_cmp_ge_u32 s60, 5329
  s_cselect_b32 s35, 268435456, s35
  s_cmp_eq_u32 s65, 0
  s_cselect_b32 s36, 268435456, s35
  s_add_u32 s37, s35, 195360
  s_add_u32 s38, s35, 390720
  s_add_u32 s39, s35, 586080
  s_add_u32 s40, s35, 781440
  s_add_u32 s41, s35, 981120
  s_add_u32 s42, s35, 1176480
  s_add_u32 s43, s35, 1371840
  s_add_u32 s44, s35, 1567200
  s_cmp_eq_u32 s64, 0
  s_cselect_b64 s[52:53], s[48:49], 0
  s_cmp_eq_u32 s64, 72
  s_cselect_b64 s[52:53], s[50:51], s[52:53]
  s_add_u32 s31, s31, 1
  s_mov_b32 m0, s58
  v_cndmask_b32 v110, v21, 2.0, s[52:53]
  buffer_load_dwordx4 v110, s[4:7], s36 offen lds
  buffer_load_dwordx4 v110, s[4:7], s37 offen offset:864 lds
  buffer_load_dwordx4 v110, s[4:7], s38 offen offset:1728 lds
  buffer_load_dwordx4 v110, s[4:7], s39 offen offset:2592 lds
  buffer_load_dwordx4 v110, s[4:7], s40 offen offset:3456 lds
  s_mov_b32 m0, s59
  s_nop 0
  buffer_load_dwordx4 v110, s[4:7], s41 offen lds
  buffer_load_dwordx4 v110, s[4:7], s42 offen offset:864 lds
  buffer_load_dwordx4 v110, s[4:7], s43 offen offset:1728 lds
  buffer_load_dwordx4 v110, s[4:7], s44 offen offset:2592 lds
  s_waitcnt vmcnt(0)
  ds_read_b64 v[108:109], v9
  ds_read_b64 v[112:113], v9 offset:32
  ds_read_b64 v[116:117], v9 offset:64
  ds_read_b128 v[128:131], v3
  ds_read_b128 v[132:135], v3 offset:864
  ds_read_b128 v[136:139], v3 offset:1728
  ds_read_b128 v[140:143], v6
  s_waitcnt lgkmcnt(6)
  v_mfma_f32_16x16x16_bf16 v[28:31], a[224:225], v[108:109], 0
  ds_read_b128 v[144:147], v3 offset:32
  s_waitcnt lgkmcnt(6)
  v_mfma_f32_16x16x16_bf16 v[32:35], a[234:235], v[112:113], 0
  ds_read_b128 v[148:151], v3 offset:896
  s_waitcnt lgkmcnt(6)
  v_mfma_f32_16x16x16_bf16 v[36:39], a[244:245], v[116:117], 0
  ds_read_b128 v[152:155], v3 offset:1760
  ds_read_b128 v[156:159], v6 offset:32
  s_waitcnt lgkmcnt(6)
  v_smfmac_f32_16x16x64_bf16 v[28:31], a[216:219], v[128:135], v0
  ds_read_b128 v[128:131], v3 offset:64
  ds_read_b128 v[132:135], v3 offset:928
  s_waitcnt lgkmcnt(6)
  v_smfmac_f32_16x16x64_bf16 v[28:31], a[220:223], v[136:143], v0
  ds_read_b128 v[136:139], v3 offset:1792
  ds_read_b128 v[140:143], v6 offset:64
  s_waitcnt lgkmcnt(6)
  v_smfmac_f32_16x16x64_bf16 v[32:35], a[226:229], v[144:151], v0
  ds_read_b64 v[116:117], v10
  ds_read_b64 v[112:113], v10 offset:32
  s_nop 1
  v_mul_f32 v110, v28, v28
  v_add_f32 v114, v28, v29
  s_waitcnt lgkmcnt(6)
  v_smfmac_f32_16x16x64_bf16 v[32:35], a[230:233], v[152:159], v0
  ds_read_b64 v[108:109], v10 offset:64
  ds_read_b128 v[152:155], v4
  v_fmac_f32 v110, v29, v29
  v_add_f32 v114, v114, v30
  s_waitcnt lgkmcnt(6)
  v_smfmac_f32_16x16x64_bf16 v[36:39], a[236:239], v[128:135], v0
  ds_read_b128 v[156:159], v4 offset:864
  ds_read_b128 v[128:131], v4 offset:1728
  v_fmac_f32 v110, v30, v30
  v_add_f32 v114, v114, v31
  s_waitcnt lgkmcnt(6)
  v_smfmac_f32_16x16x64_bf16 v[36:39], a[240:243], v[136:143], v0
  ds_read_b128 v[132:135], v7
  v_fmac_f32 v110, v31, v31
  s_waitcnt lgkmcnt(6)
  v_mfma_f32_16x16x16_bf16 v[40:43], a[224:225], v[116:117], 0
  ds_read_b128 v[136:139], v4 offset:32
  v_add_f32 v114, v114, v32
  s_waitcnt lgkmcnt(6)
  v_mfma_f32_16x16x16_bf16 v[44:47], a[234:235], v[112:113], 0
  ds_read_b128 v[140:143], v4 offset:896
  v_fmac_f32 v110, v32, v32
  s_waitcnt lgkmcnt(6)
  v_mfma_f32_16x16x16_bf16 v[48:51], a[244:245], v[108:109], 0
  ds_read_b128 v[144:147], v4 offset:1760
  ds_read_b128 v[148:151], v7 offset:32
  v_add_f32 v114, v114, v33
  v_fmac_f32 v110, v33, v33
  s_waitcnt lgkmcnt(6)
  v_smfmac_f32_16x16x64_bf16 v[40:43], a[216:219], v[152:159], v0
  ds_read_b128 v[152:155], v4 offset:64
  ds_read_b128 v[156:159], v4 offset:928
  v_add_f32 v114, v114, v34
  v_fmac_f32 v110, v34, v34
  s_waitcnt lgkmcnt(6)
  v_smfmac_f32_16x16x64_bf16 v[40:43], a[220:223], v[128:135], v0
  ds_read_b128 v[128:131], v4 offset:1792
  ds_read_b128 v[132:135], v7 offset:64
  v_add_f32 v114, v114, v35
  v_fmac_f32 v110, v35, v35
  s_waitcnt lgkmcnt(6)
  v_smfmac_f32_16x16x64_bf16 v[44:47], a[226:229], v[136:143], v0
  ds_read_b64 v[108:109], v11
  s_nop 0
  v_mul_f32 v118, v40, v40
  v_add_f32 v122, v40, v41
  v_fmac_f32 v118, v41, v41
  v_add_f32 v122, v122, v42
  s_waitcnt lgkmcnt(5)
  v_smfmac_f32_16x16x64_bf16 v[44:47], a[230:233], v[144:151], v0
  ds_read_b64 v[112:113], v11 offset:32
  v_fmac_f32 v118, v42, v42
  v_add_f32 v122, v122, v43
  v_fmac_f32 v118, v43, v43
  v_add_f32 v114, v114, v36
  s_waitcnt lgkmcnt(4)
  v_smfmac_f32_16x16x64_bf16 v[48:51], a[236:239], v[152:159], v0
  ds_read_b64 v[116:117], v11 offset:64
  v_add_f32 v122, v122, v44
  v_fmac_f32 v118, v44, v44
  v_add_f32 v122, v122, v45
  v_fmac_f32 v118, v45, v45
  s_waitcnt lgkmcnt(3)
  v_smfmac_f32_16x16x64_bf16 v[48:51], a[240:243], v[128:135], v0
  ds_read_b128 v[128:131], v5
  v_add_f32 v122, v122, v46
  s_waitcnt lgkmcnt(3)
  v_mfma_f32_16x16x16_bf16 v[52:55], a[224:225], v[108:109], 0
  v_fmac_f32 v118, v46, v46
  v_add_f32 v122, v122, v47
  s_waitcnt lgkmcnt(2)
  v_mfma_f32_16x16x16_bf16 v[56:59], a[234:235], v[112:113], 0
  v_fmac_f32 v118, v47, v47
  ds_read_b128 v[132:135], v5 offset:864
  v_fmac_f32 v110, v36, v36
  v_add_f32 v122, v122, v48
  s_waitcnt lgkmcnt(2)
  v_mfma_f32_16x16x16_bf16 v[60:63], a[244:245], v[116:117], 0
  v_fmac_f32 v118, v48, v48
  v_add_f32 v114, v114, v37
  v_fmac_f32 v110, v37, v37
  v_add_f32 v122, v122, v49
  v_fmac_f32 v118, v49, v49
  ds_read_b128 v[152:155], v5 offset:1728
  ds_read_b128 v[156:159], v8
  v_add_f32 v114, v114, v38
  v_fmac_f32 v110, v38, v38
  v_add_f32 v122, v122, v50
  v_fmac_f32 v118, v50, v50
  v_add_f32 v114, v114, v39
  v_fmac_f32 v110, v39, v39
  v_add_f32 v122, v122, v51
  v_fmac_f32 v118, v51, v51
  s_waitcnt lgkmcnt(2)
  v_smfmac_f32_16x16x64_bf16 v[52:55], a[216:219], v[128:135], v0
  ds_read_b128 v[128:131], v5 offset:32
  ds_read_b128 v[132:135], v5 offset:896
  v_permlane32_swap_b32 v114, v110
  v_permlane32_swap_b32 v122, v118
  ds_read_b128 v[144:147], v5 offset:1760
  ds_read_b128 v[148:151], v8 offset:32
  v_add_f32 v114, v114, v110
  v_add_f32 v122, v122, v118
  s_waitcnt lgkmcnt(4)
  v_smfmac_f32_16x16x64_bf16 v[52:55], a[220:223], v[152:159], v0
  ds_read_b128 v[152:155], v5 offset:64
  ds_read_b128 v[156:159], v5 offset:928
  v_permlane16_swap_b32 v114, v122
  ds_read_b128 v[136:139], v5 offset:1792
  s_nop 3
  v_mul_f32 v110, v52, v52
  v_add_f32 v118, v52, v53
  v_fmac_f32 v110, v53, v53
  v_add_f32 v118, v118, v54
  s_waitcnt lgkmcnt(5)
  v_smfmac_f32_16x16x64_bf16 v[56:59], a[226:229], v[128:135], v0
  ds_read_b128 v[140:143], v8 offset:64
  v_fmac_f32 v110, v54, v54
  v_add_f32 v118, v118, v55
  v_fmac_f32 v110, v55, v55
  v_add_f32 v114, v114, v122
  s_waitcnt lgkmcnt(4)
  v_smfmac_f32_16x16x64_bf16 v[56:59], a[230:233], v[144:151], v0
  ds_write_b32 v111, v114
  s_waitcnt lgkmcnt(3)
  v_smfmac_f32_16x16x64_bf16 v[60:63], a[236:239], v[152:159], v0
  s_nop 3
  v_add_f32 v118, v118, v56
  v_fmac_f32 v110, v56, v56
  v_add_f32 v118, v118, v57
  v_fmac_f32 v110, v57, v57
  v_add_f32 v118, v118, v58
  v_fmac_f32 v110, v58, v58
  s_waitcnt lgkmcnt(1)
  v_smfmac_f32_16x16x64_bf16 v[60:63], a[240:243], v[136:143], v0
  v_add_f32 v118, v118, v59
  v_fmac_f32 v110, v59, v59
  s_nop 5
  v_add_f32 v118, v118, v60
  v_fmac_f32 v110, v60, v60
  v_add_f32 v118, v118, v61
  v_fmac_f32 v110, v61, v61
  v_add_f32 v118, v118, v62
  v_fmac_f32 v110, v62, v62
  v_add_f32 v118, v118, v63
  v_fmac_f32 v110, v63, v63
  s_nop 1
  v_permlane32_swap_b32 v118, v110
  v_add_f32 v118, v118, v110
  v_mov_b32 v110, v118
  s_nop 1
  v_permlane16_swap_b32 v118, v110
  v_add_f32 v118, v118, v110
  ds_write_b32 v111, v118 offset:512
  s_waitcnt lgkmcnt(0)
  s_barrier
  ds_read_b128 v[136:139], v15
  ds_read_b128 v[140:143], v15 offset:1024
  s_waitcnt lgkmcnt(1)
  v_add_f32 v136, v136, v137
  v_add_f32 v138, v138, v139
  v_add_f32 v136, v136, v138
  s_waitcnt lgkmcnt(0)
  v_add_f32 v140, v140, v141
  v_add_f32 v142, v142, v143
  v_mul_f32 v137, 0x3baaaaab, v136
  v_add_f32 v140, v140, v142
  v_fma_f32 v140, -v137, v136, v140
  v_max_f32 v140, 0, v140
  v_add_f32 v140, 0x3afba882, v140
  v_rsq_f32 v140, v140
  s_nop 0
  v_mul_f32 v140, 0x40ca568a, v140
  v_mul_f32 v141, -v137, v140
  ds_write_b64 v115, v[140:141]
  ds_read_b64 v[108:109], v119
  ds_read_b64 v[112:113], v119 offset:128
  ds_read_b64 v[116:117], v119 offset:256
  s_waitcnt lgkmcnt(2)
  v_fma_f32 v140, v28, v108, v109
  v_fma_f32 v110, v29, v108, v109
  v_cvt_pk_bf16_f32 v140, v140, v110
  v_fma_f32 v141, v30, v108, v109
  v_fma_f32 v110, v31, v108, v109
  v_cvt_pk_bf16_f32 v141, v141, v110
  v_fma_f32 v142, v32, v108, v109
  v_fma_f32 v110, v33, v108, v109
  v_cvt_pk_bf16_f32 v142, v142, v110
  v_fma_f32 v143, v34, v108, v109
  v_fma_f32 v110, v35, v108, v109
  v_cvt_pk_bf16_f32 v143, v143, v110
  s_waitcnt lgkmcnt(1)
  v_fma_f32 v136, v40, v112, v113
  v_fma_f32 v110, v41, v112, v113
  v_cvt_pk_bf16_f32 v136, v136, v110
  v_fma_f32 v137, v42, v112, v113
  v_fma_f32 v110, v43, v112, v113
  v_cvt_pk_bf16_f32 v137, v137, v110
  v_fma_f32 v138, v44, v112, v113
  v_fma_f32 v110, v45, v112, v113
  v_cvt_pk_bf16_f32 v138, v138, v110
  v_fma_f32 v139, v46, v112, v113
  v_fma_f32 v110, v47, v112, v113
  v_cvt_pk_bf16_f32 v139, v139, v110
  s_waitcnt lgkmcnt(0)
  v_fma_f32 v152, v52, v116, v117
  v_fma_f32 v110, v53, v116, v117
  v_cvt_pk_bf16_f32 v152, v152, v110
  v_fma_f32 v153, v54, v116, v117
  v_fma_f32 v110, v55, v116, v117
  v_cvt_pk_bf16_f32 v153, v153, v110
  v_fma_f32 v154, v56, v116, v117
  v_fma_f32 v110, v57, v116, v117
  v_cvt_pk_bf16_f32 v154, v154, v110
  v_fma_f32 v155, v58, v116, v117
  v_fma_f32 v110, v59, v116, v117
  v_cvt_pk_bf16_f32 v155, v155, v110
  ds_write_b128 v16, v[140:143] offset:2048
  v_fma_f32 v120, v36, v108, v109
  ds_write_b128 v16, v[136:139] offset:8192
  v_fma_f32 v110, v37, v108, v109
  v_cvt_pk_bf16_f32 v120, v120, v110
  v_fma_f32 v121, v38, v108, v109
  v_fma_f32 v110, v39, v108, v109
  v_cvt_pk_bf16_f32 v121, v121, v110
  v_fma_f32 v108, v48, v112, v113
  ds_write_b128 v16, v[152:155] offset:14336
  v_fma_f32 v110, v49, v112, v113
  v_cvt_pk_bf16_f32 v108, v108, v110
  v_fma_f32 v109, v50, v112, v113
  v_fma_f32 v110, v51, v112, v113
  v_cvt_pk_bf16_f32 v109, v109, v110
  v_fma_f32 v112, v60, v116, v117
  v_fma_f32 v110, v61, v116, v117
  v_cvt_pk_bf16_f32 v112, v112, v110
  v_fma_f32 v113, v62, v116, v117
  v_fma_f32 v110, v63, v116, v117
  v_cvt_pk_bf16_f32 v113, v113, v110
  ds_write_b64 v17, v[120:121] offset:2048
  ds_write_b64 v17, v[108:109] offset:8192
  ds_write_b64 v17, v[112:113] offset:14336
  s_waitcnt lgkmcnt(0)
  s_barrier
  ds_read_b128 v[152:155], v15 offset:2048
  ds_read_b128 v[136:139], v15 offset:3072
  ds_read_b128 v[140:143], v15 offset:4096
  ds_read_b128 v[156:159], v15 offset:5120
  ds_read_b128 v[144:147], v15 offset:6144
  ds_read_b128 v[148:151], v15 offset:7168
  s_waitcnt lgkmcnt(5)
  v_mfma_f32_16x16x32_bf16 v[128:131], a[0:3], v[152:155], 0
  s_waitcnt lgkmcnt(4)
  v_mfma_f32_16x16x32_bf16 v[128:131], a[4:7], v[136:139], v[128:131]
  s_waitcnt lgkmcnt(3)
  v_mfma_f32_16x16x32_bf16 v[128:131], a[8:11], v[140:143], v[128:131]
  s_waitcnt lgkmcnt(2)
  v_mfma_f32_16x16x32_bf16 v[128:131], a[12:15], v[156:159], v[128:131]
  s_waitcnt lgkmcnt(1)
  v_mfma_f32_16x16x32_bf16 v[128:131], a[16:19], v[144:147], v[128:131]
  s_waitcnt lgkmcnt(0)
  v_mfma_f32_16x16x32_bf16 v[128:131], a[20:23], v[148:151], v[128:131]
  v_mfma_f32_16x16x32_bf16 v[132:135], a[72:75], v[152:155], 0
  v_mfma_f32_16x16x32_bf16 v[132:135], a[76:79], v[136:139], v[132:135]
  v_cvt_pk_bf16_f32 v160, v128, v129
  v_cvt_pk_bf16_f32 v161, v130, v131
  v_mfma_f32_16x16x32_bf16 v[132:135], a[80:83], v[140:143], v[132:135]
  v_mfma_f32_16x16x32_bf16 v[132:135], a[84:87], v[156:159], v[132:135]
  v_mfma_f32_16x16x32_bf16 v[132:135], a[88:91], v[144:147], v[132:135]
  v_mfma_f32_16x16x32_bf16 v[132:135], a[92:95], v[148:151], v[132:135]
  v_mfma_f32_16x16x32_bf16 v[128:131], v[152:155], a[144:147], 0
  v_mfma_f32_16x16x32_bf16 v[128:131], v[136:139], a[148:151], v[128:131]
  v_cvt_pk_bf16_f32 v164, v132, v133
  v_cvt_pk_bf16_f32 v165, v134, v135
  v_mfma_f32_16x16x32_bf16 v[128:131], v[140:143], a[152:155], v[128:131]
  v_mfma_f32_16x16x32_bf16 v[128:131], v[156:159], a[156:159], v[128:131]
  v_mfma_f32_16x16x32_bf16 v[128:131], v[144:147], a[160:163], v[128:131]
  v_mfma_f32_16x16x32_bf16 v[128:131], v[148:151], a[164:167], v[128:131]
  v_mfma_f32_16x16x32_bf16 v[132:135], a[24:27], v[152:155], 0
  v_mfma_f32_16x16x32_bf16 v[132:135], a[28:31], v[136:139], v[132:135]
  v_cvt_pk_bf16_f32 v168, v128, v129
  v_cvt_pk_bf16_f32 v169, v130, v131
  v_mfma_f32_16x16x32_bf16 v[132:135], a[32:35], v[140:143], v[132:135]
  v_mfma_f32_16x16x32_bf16 v[132:135], a[36:39], v[156:159], v[132:135]
  v_mfma_f32_16x16x32_bf16 v[132:135], a[40:43], v[144:147], v[132:135]
  v_mfma_f32_16x16x32_bf16 v[132:135], a[44:47], v[148:151], v[132:135]
  v_mfma_f32_16x16x32_bf16 v[128:131], a[96:99], v[152:155], 0
  v_mfma_f32_16x16x32_bf16 v[128:131], a[100:103], v[136:139], v[128:131]
  v_cvt_pk_bf16_f32 v162, v132, v133
  v_cvt_pk_bf16_f32 v163, v134, v135
  v_mfma_f32_16x16x32_bf16 v[128:131], a[104:107], v[140:143], v[128:131]
  v_mfma_f32_16x16x32_bf16 v[128:131], a[108:111], v[156:159], v[128:131]
  v_mfma_f32_16x16x32_bf16 v[128:131], a[112:115], v[144:147], v[128:131]
  v_mfma_f32_16x16x32_bf16 v[128:131], a[116:119], v[148:151], v[128:131]
  v_mfma_f32_16x16x32_bf16 v[132:135], v[152:155], a[168:171], 0
  v_mfma_f32_16x16x32_bf16 v[132:135], v[136:139], a[172:175], v[132:135]
  v_cvt_pk_bf16_f32 v166, v128, v129
  v_cvt_pk_bf16_f32 v167, v130, v131
  v_mfma_f32_16x16x32_bf16 v[132:135], v[140:143], a[176:179], v[132:135]
  v_mfma_f32_16x16x32_bf16 v[132:135], v[156:159], a[180:183], v[132:135]
  v_mfma_f32_16x16x32_bf16 v[132:135], v[144:147], a[184:187], v[132:135]
  v_mfma_f32_16x16x32_bf16 v[132:135], v[148:151], a[188:191], v[132:135]
  v_mfma_f32_16x16x32_bf16 v[128:131], a[48:51], v[152:155], 0
  v_mfma_f32_16x16x32_bf16 v[128:131], a[52:55], v[136:139], v[128:131]
  v_cvt_pk_bf16_f32 v172, v132, v133
  v_cvt_pk_bf16_f32 v173, v134, v135
  v_mfma_f32_16x16x32_bf16 v[128:131], a[56:59], v[140:143], v[128:131]
  v_mfma_f32_16x16x32_bf16 v[128:131], a[60:63], v[156:159], v[128:131]
  v_mfma_f32_16x16x32_bf16 v[128:131], a[64:67], v[144:147], v[128:131]
  v_mfma_f32_16x16x32_bf16 v[128:131], a[68:71], v[148:151], v[128:131]
  v_mfma_f32_16x16x32_bf16 v[132:135], a[120:123], v[152:155], 0
  v_mfma_f32_16x16x32_bf16 v[132:135], a[124:127], v[136:139], v[132:135]
  ds_read_b128 v[176:179], v15 offset:8192
  v_cvt_pk_bf16_f32 v120, v128, v129
  v_mfma_f32_16x16x32_bf16 v[132:135], a[128:131], v[140:143], v[132:135]
  ds_read_b128 v[180:183], v15 offset:9216
  v_cvt_pk_bf16_f32 v121, v130, v131
  v_mfma_f32_16x16x32_bf16 v[132:135], a[132:135], v[156:159], v[132:135]
  ds_read_b128 v[128:131], v15 offset:10240
  v_mfma_f32_16x16x32_bf16 v[132:135], a[136:139], v[144:147], v[132:135]
  ds_read_b128 v[184:187], v15 offset:11264
  v_mfma_f32_16x16x32_bf16 v[132:135], a[140:143], v[148:151], v[132:135]
  ds_read_b128 v[188:191], v15 offset:12288
  v_mfma_f32_16x16x32_bf16 v[192:195], v[152:155], a[192:195], 0
  ds_read_b128 v[152:155], v15 offset:13312
  v_mfma_f32_16x16x32_bf16 v[192:195], v[136:139], a[196:199], v[192:195]
  v_cvt_pk_bf16_f32 v124, v132, v133
  v_cvt_pk_bf16_f32 v125, v134, v135
  v_mfma_f32_16x16x32_bf16 v[192:195], v[140:143], a[200:203], v[192:195]
  v_mfma_f32_16x16x32_bf16 v[192:195], v[156:159], a[204:207], v[192:195]
  v_mfma_f32_16x16x32_bf16 v[192:195], v[144:147], a[208:211], v[192:195]
  v_mfma_f32_16x16x32_bf16 v[192:195], v[148:151], a[212:215], v[192:195]
  s_waitcnt lgkmcnt(5)
  v_mfma_f32_16x16x32_bf16 v[148:151], a[0:3], v[176:179], 0
  s_waitcnt lgkmcnt(4)
  v_mfma_f32_16x16x32_bf16 v[148:151], a[4:7], v[180:183], v[148:151]
  s_waitcnt lgkmcnt(3)
  v_cvt_pk_bf16_f32 v144, v192, v193
  v_cvt_pk_bf16_f32 v145, v194, v195
  v_mfma_f32_16x16x32_bf16 v[148:151], a[8:11], v[128:131], v[148:151]
  s_waitcnt lgkmcnt(2)
  v_mfma_f32_16x16x32_bf16 v[148:151], a[12:15], v[184:187], v[148:151]
  s_waitcnt lgkmcnt(1)
  v_mfma_f32_16x16x32_bf16 v[148:151], a[16:19], v[188:191], v[148:151]
  s_waitcnt lgkmcnt(0)
  v_mfma_f32_16x16x32_bf16 v[148:151], a[20:23], v[152:155], v[148:151]
  v_mfma_f32_16x16x32_bf16 v[192:195], a[72:75], v[176:179], 0
  v_mfma_f32_16x16x32_bf16 v[192:195], a[76:79], v[180:183], v[192:195]
  v_cvt_pk_bf16_f32 v156, v148, v149
  v_cvt_pk_bf16_f32 v157, v150, v151
  v_mfma_f32_16x16x32_bf16 v[192:195], a[80:83], v[128:131], v[192:195]
  v_mfma_f32_16x16x32_bf16 v[192:195], a[84:87], v[184:187], v[192:195]
  v_mfma_f32_16x16x32_bf16 v[192:195], a[88:91], v[188:191], v[192:195]
  v_mfma_f32_16x16x32_bf16 v[192:195], a[92:95], v[152:155], v[192:195]
  v_mfma_f32_16x16x32_bf16 v[148:151], v[176:179], a[144:147], 0
  v_mfma_f32_16x16x32_bf16 v[148:151], v[180:183], a[148:151], v[148:151]
  v_cvt_pk_bf16_f32 v140, v192, v193
  v_cvt_pk_bf16_f32 v141, v194, v195
  v_mfma_f32_16x16x32_bf16 v[148:151], v[128:131], a[152:155], v[148:151]
  v_mfma_f32_16x16x32_bf16 v[148:151], v[184:187], a[156:159], v[148:151]
  v_mfma_f32_16x16x32_bf16 v[148:151], v[188:191], a[160:163], v[148:151]
  v_mfma_f32_16x16x32_bf16 v[148:151], v[152:155], a[164:167], v[148:151]
  v_mfma_f32_16x16x32_bf16 v[192:195], a[24:27], v[176:179], 0
  v_mfma_f32_16x16x32_bf16 v[192:195], a[28:31], v[180:183], v[192:195]
  v_cvt_pk_bf16_f32 v170, v148, v149
  v_cvt_pk_bf16_f32 v171, v150, v151
  v_mfma_f32_16x16x32_bf16 v[192:195], a[32:35], v[128:131], v[192:195]
  v_mfma_f32_16x16x32_bf16 v[192:195], a[36:39], v[184:187], v[192:195]
  v_mfma_f32_16x16x32_bf16 v[192:195], a[40:43], v[188:191], v[192:195]
  v_mfma_f32_16x16x32_bf16 v[192:195], a[44:47], v[152:155], v[192:195]
  v_mfma_f32_16x16x32_bf16 v[148:151], a[96:99], v[176:179], 0
  v_mfma_f32_16x16x32_bf16 v[148:151], a[100:103], v[180:183], v[148:151]
  v_cvt_pk_bf16_f32 v158, v192, v193
  v_cvt_pk_bf16_f32 v159, v194, v195
  v_mfma_f32_16x16x32_bf16 v[148:151], a[104:107], v[128:131], v[148:151]
  v_mfma_f32_16x16x32_bf16 v[148:151], a[108:111], v[184:187], v[148:151]
  v_mfma_f32_16x16x32_bf16 v[148:151], a[112:115], v[188:191], v[148:151]
  v_mfma_f32_16x16x32_bf16 v[148:151], a[116:119], v[152:155], v[148:151]
  v_mfma_f32_16x16x32_bf16 v[192:195], v[176:179], a[168:171], 0
  v_mfma_f32_16x16x32_bf16 v[192:195], v[180:183], a[172:175], v[192:195]
  v_cvt_pk_bf16_f32 v142, v148, v149
  v_cvt_pk_bf16_f32 v143, v150, v151
  v_mfma_f32_16x16x32_bf16 v[192:195], v[128:131], a[176:179], v[192:195]
  v_mfma_f32_16x16x32_bf16 v[192:195], v[184:187], a[180:183], v[192:195]
  v_mfma_f32_16x16x32_bf16 v[192:195], v[188:191], a[184:187], v[192:195]
  v_mfma_f32_16x16x32_bf16 v[192:195], v[152:155], a[188:191], v[192:195]
  v_mfma_f32_16x16x32_bf16 v[148:151], a[48:51], v[176:179], 0
  v_mfma_f32_16x16x32_bf16 v[148:151], a[52:55], v[180:183], v[148:151]
  v_cvt_pk_bf16_f32 v174, v192, v193
  v_cvt_pk_bf16_f32 v175, v194, v195
  v_mfma_f32_16x16x32_bf16 v[148:151], a[56:59], v[128:131], v[148:151]
  v_mfma_f32_16x16x32_bf16 v[148:151], a[60:63], v[184:187], v[148:151]
  v_mfma_f32_16x16x32_bf16 v[148:151], a[64:67], v[188:191], v[148:151]
  v_mfma_f32_16x16x32_bf16 v[148:151], a[68:71], v[152:155], v[148:151]
  v_mfma_f32_16x16x32_bf16 v[192:195], a[120:123], v[176:179], 0
  v_mfma_f32_16x16x32_bf16 v[192:195], a[124:127], v[180:183], v[192:195]
  ds_read_b128 v[132:135], v15 offset:14336
  v_cvt_pk_bf16_f32 v208, v148, v149
  v_mfma_f32_16x16x32_bf16 v[192:195], a[128:131], v[128:131], v[192:195]
  ds_read_b128 v[136:139], v15 offset:15360
  v_cvt_pk_bf16_f32 v209, v150, v151
  v_mfma_f32_16x16x32_bf16 v[192:195], a[132:135], v[184:187], v[192:195]
  ds_read_b128 v[148:151], v15 offset:16384
  v_mfma_f32_16x16x32_bf16 v[192:195], a[136:139], v[188:191], v[192:195]
  ds_read_b128 v[196:199], v15 offset:17408
  v_mfma_f32_16x16x32_bf16 v[192:195], a[140:143], v[152:155], v[192:195]
  ds_read_b128 v[200:203], v15 offset:18432
  v_mfma_f32_16x16x32_bf16 v[204:207], v[176:179], a[192:195], 0
  ds_read_b128 v[176:179], v15 offset:19456
  v_mfma_f32_16x16x32_bf16 v[204:207], v[180:183], a[196:199], v[204:207]
  v_cvt_pk_bf16_f32 v210, v192, v193
  v_cvt_pk_bf16_f32 v211, v194, v195
  v_mfma_f32_16x16x32_bf16 v[204:207], v[128:131], a[200:203], v[204:207]
  v_mfma_f32_16x16x32_bf16 v[204:207], v[184:187], a[204:207], v[204:207]
  v_mfma_f32_16x16x32_bf16 v[204:207], v[188:191], a[208:211], v[204:207]
  v_mfma_f32_16x16x32_bf16 v[204:207], v[152:155], a[212:215], v[204:207]
  s_waitcnt lgkmcnt(5)
  v_mfma_f32_16x16x32_bf16 v[152:155], a[0:3], v[132:135], 0
  s_waitcnt lgkmcnt(4)
  v_mfma_f32_16x16x32_bf16 v[152:155], a[4:7], v[136:139], v[152:155]
  s_waitcnt lgkmcnt(3)
  v_cvt_pk_bf16_f32 v146, v204, v205
  v_cvt_pk_bf16_f32 v147, v206, v207
  v_mfma_f32_16x16x32_bf16 v[152:155], a[8:11], v[148:151], v[152:155]
  s_waitcnt lgkmcnt(2)
  v_mfma_f32_16x16x32_bf16 v[152:155], a[12:15], v[196:199], v[152:155]
  s_waitcnt lgkmcnt(1)
  v_mfma_f32_16x16x32_bf16 v[152:155], a[16:19], v[200:203], v[152:155]
  s_waitcnt lgkmcnt(0)
  v_mfma_f32_16x16x32_bf16 v[152:155], a[20:23], v[176:179], v[152:155]
  v_mfma_f32_16x16x32_bf16 v[204:207], a[72:75], v[132:135], 0
  v_mfma_f32_16x16x32_bf16 v[204:207], a[76:79], v[136:139], v[204:207]
  v_cvt_pk_bf16_f32 v188, v152, v153
  v_cvt_pk_bf16_f32 v189, v154, v155
  v_mfma_f32_16x16x32_bf16 v[204:207], a[80:83], v[148:151], v[204:207]
  v_mfma_f32_16x16x32_bf16 v[204:207], a[84:87], v[196:199], v[204:207]
  v_mfma_f32_16x16x32_bf16 v[204:207], a[88:91], v[200:203], v[204:207]
  v_mfma_f32_16x16x32_bf16 v[204:207], a[92:95], v[176:179], v[204:207]
  v_mfma_f32_16x16x32_bf16 v[152:155], v[132:135], a[144:147], 0
  v_mfma_f32_16x16x32_bf16 v[152:155], v[136:139], a[148:151], v[152:155]
  v_cvt_pk_bf16_f32 v184, v204, v205
  v_cvt_pk_bf16_f32 v185, v206, v207
  v_mfma_f32_16x16x32_bf16 v[152:155], v[148:151], a[152:155], v[152:155]
  v_mfma_f32_16x16x32_bf16 v[152:155], v[196:199], a[156:159], v[152:155]
  v_mfma_f32_16x16x32_bf16 v[152:155], v[200:203], a[160:163], v[152:155]
  v_mfma_f32_16x16x32_bf16 v[152:155], v[176:179], a[164:167], v[152:155]
  v_mfma_f32_16x16x32_bf16 v[204:207], a[24:27], v[132:135], 0
  v_mfma_f32_16x16x32_bf16 v[204:207], a[28:31], v[136:139], v[204:207]
  v_cvt_pk_bf16_f32 v108, v152, v153
  v_cvt_pk_bf16_f32 v109, v154, v155
  v_mfma_f32_16x16x32_bf16 v[204:207], a[32:35], v[148:151], v[204:207]
  v_mfma_f32_16x16x32_bf16 v[204:207], a[36:39], v[196:199], v[204:207]
  v_mfma_f32_16x16x32_bf16 v[204:207], a[40:43], v[200:203], v[204:207]
  v_mfma_f32_16x16x32_bf16 v[204:207], a[44:47], v[176:179], v[204:207]
  v_mfma_f32_16x16x32_bf16 v[152:155], a[96:99], v[132:135], 0
  v_mfma_f32_16x16x32_bf16 v[152:155], a[100:103], v[136:139], v[152:155]
  v_cvt_pk_bf16_f32 v190, v204, v205
  v_cvt_pk_bf16_f32 v191, v206, v207
  v_mfma_f32_16x16x32_bf16 v[152:155], a[104:107], v[148:151], v[152:155]
  v_mfma_f32_16x16x32_bf16 v[152:155], a[108:111], v[196:199], v[152:155]
  v_mfma_f32_16x16x32_bf16 v[152:155], a[112:115], v[200:203], v[152:155]
  v_mfma_f32_16x16x32_bf16 v[152:155], a[116:119], v[176:179], v[152:155]
  v_mfma_f32_16x16x32_bf16 v[204:207], v[132:135], a[168:171], 0
  v_mfma_f32_16x16x32_bf16 v[204:207], v[136:139], a[172:175], v[204:207]
  v_cvt_pk_bf16_f32 v186, v152, v153
  v_cvt_pk_bf16_f32 v187, v154, v155
  v_mfma_f32_16x16x32_bf16 v[204:207], v[148:151], a[176:179], v[204:207]
  v_mfma_f32_16x16x32_bf16 v[204:207], v[196:199], a[180:183], v[204:207]
  v_mfma_f32_16x16x32_bf16 v[204:207], v[200:203], a[184:187], v[204:207]
  v_mfma_f32_16x16x32_bf16 v[204:207], v[176:179], a[188:191], v[204:207]
  v_mfma_f32_16x16x32_bf16 v[152:155], a[48:51], v[132:135], 0
  v_mfma_f32_16x16x32_bf16 v[152:155], a[52:55], v[136:139], v[152:155]
  v_cvt_pk_bf16_f32 v112, v204, v205
  v_cvt_pk_bf16_f32 v113, v206, v207
  v_mfma_f32_16x16x32_bf16 v[152:155], a[56:59], v[148:151], v[152:155]
  v_mfma_f32_16x16x32_bf16 v[152:155], a[60:63], v[196:199], v[152:155]
  v_mfma_f32_16x16x32_bf16 v[152:155], a[64:67], v[200:203], v[152:155]
  ds_read_b64 v[192:193], v19 offset:16
  v_mfma_f32_16x16x32_bf16 v[152:155], a[68:71], v[176:179], v[152:155]
  v_mfma_f32_16x16x32_bf16 v[204:207], a[120:123], v[132:135], 0
  v_mfma_f32_16x16x32_bf16 v[204:207], a[124:127], v[136:139], v[204:207]
  ds_read2_b64 v[128:131], v19 offset0:0 offset1:1
  v_cvt_pk_bf16_f32 v194, v152, v153
  v_mfma_f32_16x16x32_bf16 v[204:207], a[128:131], v[148:151], v[204:207]
  v_cvt_pk_bf16_f32 v195, v154, v155
  v_mfma_f32_16x16x32_bf16 v[204:207], a[132:135], v[196:199], v[204:207]
  v_mfma_f32_16x16x32_bf16 v[204:207], a[136:139], v[200:203], v[204:207]
  v_mfma_f32_16x16x32_bf16 v[204:207], a[140:143], v[176:179], v[204:207]
  v_mfma_f32_16x16x32_bf16 v[152:155], v[132:135], a[192:195], 0
  ds_read_u16 v110, v20
  v_mfma_f32_16x16x32_bf16 v[152:155], v[136:139], a[196:199], v[152:155]
  v_cvt_pk_bf16_f32 v132, v204, v205
  v_cvt_pk_bf16_f32 v133, v206, v207
  v_mfma_f32_16x16x32_bf16 v[152:155], v[148:151], a[200:203], v[152:155]
  ds_read_u16 v114, v20 offset:32
  v_mfma_f32_16x16x32_bf16 v[152:155], v[196:199], a[204:207], v[152:155]
  v_mfma_f32_16x16x32_bf16 v[152:155], v[200:203], a[208:211], v[152:155]
  ds_read_u16 v118, v20 offset:64
  v_mfma_f32_16x16x32_bf16 v[152:155], v[176:179], a[212:215], v[152:155]
  s_waitcnt lgkmcnt(4)
  v_mfma_f32_16x16x16_bf16 v[176:179], v[124:125], v[120:121], 0
  v_mfma_f32_16x16x16_bf16 v[200:203], v[210:211], v[120:121], 0
  v_cvt_pk_bf16_f32 v116, v152, v153
  v_cvt_pk_bf16_f32 v117, v154, v155
  v_mfma_f32_16x16x16_bf16 v[152:155], v[132:133], v[120:121], 0
  v_mfma_f32_16x16x16_bf16 v[196:199], v[192:193], v[120:121], v[2:5]
  v_mfma_f32_16x16x32_bf16 v[176:179], v[164:167], v[160:163], v[176:179]
  v_mfma_f32_16x16x32_bf16 v[200:203], v[140:143], v[160:163], v[200:203]
  v_mfma_f32_16x16x32_bf16 v[152:155], v[184:187], v[160:163], v[152:155]
  s_waitcnt lgkmcnt(3)
  v_max3_f32 v122, v176, v177, v178
  v_mfma_f32_16x16x32_bf16 v[196:199], v[128:131], v[160:163], v[196:199]
  v_max3_f32 v122, v122, v179, v200
  v_max3_f32 v122, v122, v201, v202
  s_nop 1
  v_max3_f32 v122, v122, v203, v152
  v_max3_f32 v122, v122, v153, v154
  s_nop 1
  v_max3_f32 v122, v122, v155, v196
  v_mov_b32 v120, v122
  s_nop 1
  v_permlane32_swap_b32 v122, v120
  v_max_f32 v122, v122, v120
  v_mov_b32 v120, v122
  s_nop 1
  v_permlane16_swap_b32 v122, v120
  v_max_f32 v122, v122, v120
  v_sub_f32 v176, v176, v122
  v_sub_f32 v177, v177, v122
  v_sub_f32 v178, v178, v122
  v_sub_f32 v179, v179, v122
  v_sub_f32 v200, v200, v122
  v_sub_f32 v201, v201, v122
  v_sub_f32 v202, v202, v122
  v_sub_f32 v203, v203, v122
  v_exp_f32 v176, v176
  v_exp_f32 v177, v177
  v_exp_f32 v178, v178
  v_exp_f32 v179, v179
  v_exp_f32 v200, v200
  v_exp_f32 v201, v201
  v_exp_f32 v202, v202
  v_exp_f32 v203, v203
  v_sub_f32 v152, v152, v122
  v_sub_f32 v153, v153, v122
  v_sub_f32 v154, v154, v122
  v_sub_f32 v155, v155, v122
  v_sub_f32 v196, v196, v122
  v_exp_f32 v152, v152
  v_exp_f32 v153, v153
  v_exp_f32 v154, v154
  v_exp_f32 v155, v155
  v_exp_f32 v196, v196
  v_cvt_pk_bf16_f32 v160, v176, v177
  v_cvt_pk_bf16_f32 v161, v178, v179
  v_cvt_pk_bf16_f32 v162, v200, v201
  v_cvt_pk_bf16_f32 v163, v202, v203
  v_cvt_pk_bf16_f32 v120, v152, v153
  v_cvt_pk_bf16_f32 v121, v154, v155
  v_mfma_f32_16x16x32_bf16 v[152:155], a[246:249], v[160:163], 0
  v_cvt_pk_bf16_f32 v122, v196, 0
  s_nop 1
  v_mfma_f32_16x16x32_bf16 v[152:155], a[246:249], v[120:123], v[152:155]
  v_mfma_f32_16x16x32_bf16 v[196:199], v[168:171], v[160:163], 0
  s_waitcnt lgkmcnt(2)
  v_mfma_f32_16x16x32_bf16 v[196:199], v[108:111], v[120:123], v[196:199]
  v_mul_f32 v152, 0x3ee9a3cd, v152
  v_mfma_f32_16x16x32_bf16 v[200:203], v[172:175], v[160:163], 0
  s_waitcnt lgkmcnt(1)
  v_rcp_f32 v126, v152
  v_mfma_f32_16x16x32_bf16 v[200:203], v[112:115], v[120:123], v[200:203]
  v_mul_f32 v196, v196, v126
  v_mul_f32 v197, v197, v126
  v_mfma_f32_16x16x32_bf16 v[152:155], v[144:147], v[160:163], 0
  s_waitcnt lgkmcnt(0)
  v_cvt_pk_bf16_f32 v160, v196, v197
  v_mul_f32 v198, v198, v126
  v_mfma_f32_16x16x32_bf16 v[152:155], v[116:119], v[120:123], v[152:155]
  v_mul_f32 v199, v199, v126
  v_cvt_pk_bf16_f32 v161, v198, v199
  v_mul_f32 v200, v200, v126
  v_mfma_f32_16x16x16_bf16 v[196:199], v[124:125], v[208:209], 0
  v_mul_f32 v201, v201, v126
  v_cvt_pk_bf16_f32 v162, v200, v201
  v_mul_f32 v202, v202, v126
  v_mfma_f32_16x16x16_bf16 v[176:179], v[210:211], v[208:209], 0
  v_mul_f32 v203, v203, v126
  v_cvt_pk_bf16_f32 v163, v202, v203
  v_mul_f32 v152, v152, v126
  v_mfma_f32_16x16x16_bf16 v[200:203], v[132:133], v[208:209], 0
  v_mul_f32 v153, v153, v126
  v_cvt_pk_bf16_f32 v134, v152, v153
  v_mul_f32 v154, v154, v126
  v_mfma_f32_16x16x16_bf16 v[148:151], v[192:193], v[208:209], v[2:5]
  v_mul_f32 v155, v155, v126
  v_cvt_pk_bf16_f32 v135, v154, v155
  v_mfma_f32_16x16x32_bf16 v[196:199], v[164:167], v[156:159], v[196:199]
  ds_write_b128 v16, v[160:163] offset:20480
  v_mfma_f32_16x16x32_bf16 v[176:179], v[140:143], v[156:159], v[176:179]
  s_nop 3
  v_max3_f32 v126, v196, v197, v198
  v_mfma_f32_16x16x32_bf16 v[200:203], v[184:187], v[156:159], v[200:203]
  ds_write_b64 v17, v[134:135] offset:20480
  v_mfma_f32_16x16x32_bf16 v[148:151], v[128:131], v[156:159], v[148:151]
  v_max3_f32 v126, v126, v199, v176
  v_max3_f32 v126, v126, v177, v178
  s_nop 1
  v_max3_f32 v126, v126, v179, v200
  v_max3_f32 v126, v126, v201, v202
  s_nop 1
  v_max3_f32 v126, v126, v203, v148
  v_mov_b32 v134, v126
  s_nop 1
  v_permlane32_swap_b32 v126, v134
  v_max_f32 v126, v126, v134
  v_mov_b32 v134, v126
  s_nop 1
  v_permlane16_swap_b32 v126, v134
  v_max_f32 v126, v126, v134
  v_sub_f32 v196, v196, v126
  v_sub_f32 v197, v197, v126
  v_sub_f32 v198, v198, v126
  v_sub_f32 v199, v199, v126
  v_sub_f32 v176, v176, v126
  v_sub_f32 v177, v177, v126
  v_sub_f32 v178, v178, v126
  v_sub_f32 v179, v179, v126
  v_exp_f32 v196, v196
  v_exp_f32 v197, v197
  v_exp_f32 v198, v198
  v_exp_f32 v199, v199
  v_exp_f32 v176, v176
  v_exp_f32 v177, v177
  v_exp_f32 v178, v178
  v_exp_f32 v179, v179
  v_sub_f32 v200, v200, v126
  v_sub_f32 v201, v201, v126
  v_sub_f32 v202, v202, v126
  v_sub_f32 v203, v203, v126
  v_sub_f32 v148, v148, v126
  v_exp_f32 v200, v200
  v_exp_f32 v201, v201
  v_exp_f32 v202, v202
  v_exp_f32 v203, v203
  v_exp_f32 v148, v148
  v_cvt_pk_bf16_f32 v156, v196, v197
  v_cvt_pk_bf16_f32 v157, v198, v199
  v_cvt_pk_bf16_f32 v158, v176, v177
  v_cvt_pk_bf16_f32 v159, v178, v179
  v_cvt_pk_bf16_f32 v120, v200, v201
  v_cvt_pk_bf16_f32 v121, v202, v203
  v_mfma_f32_16x16x32_bf16 v[200:203], a[246:249], v[156:159], 0
  v_cvt_pk_bf16_f32 v122, v148, 0
  s_nop 1
  v_mfma_f32_16x16x32_bf16 v[200:203], a[246:249], v[120:123], v[200:203]
  v_mfma_f32_16x16x32_bf16 v[148:151], v[168:171], v[156:159], 0
  v_mfma_f32_16x16x32_bf16 v[148:151], v[108:111], v[120:123], v[148:151]
  v_mul_f32 v200, 0x3ee9a3cd, v200
  v_mfma_f32_16x16x32_bf16 v[176:179], v[172:175], v[156:159], 0
  v_rcp_f32 v126, v200
  v_mfma_f32_16x16x32_bf16 v[176:179], v[112:115], v[120:123], v[176:179]
  v_mul_f32 v148, v148, v126
  v_mul_f32 v149, v149, v126
  v_mfma_f32_16x16x32_bf16 v[200:203], v[144:147], v[156:159], 0
  v_cvt_pk_bf16_f32 v156, v148, v149
  v_mul_f32 v150, v150, v126
  v_mfma_f32_16x16x32_bf16 v[200:203], v[116:119], v[120:123], v[200:203]
  ds_read_b64 v[134:135], v19 offset:784
  v_mul_f32 v151, v151, v126
  v_cvt_pk_bf16_f32 v157, v150, v151
  v_mfma_f32_16x16x16_bf16 v[148:151], v[124:125], v[194:195], 0
  v_mul_f32 v176, v176, v126
  v_mul_f32 v177, v177, v126
  v_cvt_pk_bf16_f32 v158, v176, v177
  v_mfma_f32_16x16x16_bf16 v[196:199], v[210:211], v[194:195], 0
  v_mul_f32 v178, v178, v126
  v_mul_f32 v179, v179, v126
  v_cvt_pk_bf16_f32 v159, v178, v179
  v_mfma_f32_16x16x16_bf16 v[176:179], v[132:133], v[194:195], 0
  v_mul_f32 v200, v200, v126
  v_mul_f32 v201, v201, v126
  v_cvt_pk_bf16_f32 v208, v200, v201
  v_mfma_f32_16x16x16_bf16 v[160:163], v[192:193], v[194:195], v[2:5]
  v_mul_f32 v202, v202, v126
  v_mul_f32 v203, v203, v126
  v_cvt_pk_bf16_f32 v209, v202, v203
  v_mfma_f32_16x16x32_bf16 v[148:151], v[164:167], v[188:191], v[148:151]
  ds_read2_b64 v[200:203], v19 offset0:96 offset1:97
  v_add_u32 v19, 1160, v19
  v_mfma_f32_16x16x32_bf16 v[196:199], v[140:143], v[188:191], v[196:199]
  ds_write_b128 v16, v[156:159] offset:26624
  v_mfma_f32_16x16x32_bf16 v[176:179], v[184:187], v[188:191], v[176:179]
  v_max3_f32 v126, v148, v149, v150
  s_nop 2
  v_max3_f32 v126, v126, v151, v196
  v_mfma_f32_16x16x32_bf16 v[160:163], v[128:131], v[188:191], v[160:163]
  v_max3_f32 v126, v126, v197, v198
  s_nop 0
  v_max3_f32 v126, v126, v199, v176
  v_max3_f32 v126, v126, v177, v178
  s_nop 3
  v_max3_f32 v126, v126, v179, v160
  v_mov_b32 v194, v126
  s_nop 1
  v_permlane32_swap_b32 v126, v194
  v_max_f32 v126, v126, v194
  v_mov_b32 v194, v126
  s_nop 1
  v_permlane16_swap_b32 v126, v194
  v_max_f32 v126, v126, v194
  v_sub_f32 v148, v148, v126
  v_sub_f32 v149, v149, v126
  v_sub_f32 v150, v150, v126
  v_sub_f32 v151, v151, v126
  v_sub_f32 v196, v196, v126
  v_sub_f32 v197, v197, v126
  v_sub_f32 v198, v198, v126
  v_sub_f32 v199, v199, v126
  v_exp_f32 v148, v148
  v_exp_f32 v149, v149
  v_exp_f32 v150, v150
  v_exp_f32 v151, v151
  v_exp_f32 v196, v196
  v_exp_f32 v197, v197
  v_exp_f32 v198, v198
  v_exp_f32 v199, v199
  v_sub_f32 v176, v176, v126
  v_sub_f32 v177, v177, v126
  v_sub_f32 v178, v178, v126
  v_sub_f32 v179, v179, v126
  v_sub_f32 v160, v160, v126
  v_exp_f32 v176, v176
  v_exp_f32 v177, v177
  v_exp_f32 v178, v178
  v_exp_f32 v179, v179
  v_exp_f32 v160, v160
  v_cvt_pk_bf16_f32 v188, v148, v149
  v_cvt_pk_bf16_f32 v189, v150, v151
  v_cvt_pk_bf16_f32 v190, v196, v197
  v_cvt_pk_bf16_f32 v191, v198, v199
  v_cvt_pk_bf16_f32 v120, v176, v177
  v_cvt_pk_bf16_f32 v121, v178, v179
  v_mfma_f32_16x16x32_bf16 v[176:179], a[246:249], v[188:191], 0
  v_cvt_pk_bf16_f32 v122, v160, 0
  s_nop 1
  v_mfma_f32_16x16x32_bf16 v[176:179], a[246:249], v[120:123], v[176:179]
  ds_write_b64 v17, v[208:209] offset:26624
  v_mfma_f32_16x16x32_bf16 v[160:163], v[168:171], v[188:191], 0
  v_mfma_f32_16x16x32_bf16 v[160:163], v[108:111], v[120:123], v[160:163]
  v_mul_f32 v176, 0x3ee9a3cd, v176
  v_mfma_f32_16x16x32_bf16 v[196:199], v[172:175], v[188:191], 0
  v_rcp_f32 v126, v176
  v_mfma_f32_16x16x32_bf16 v[196:199], v[112:115], v[120:123], v[196:199]
  v_mul_f32 v160, v160, v126
  v_mul_f32 v161, v161, v126
  v_mfma_f32_16x16x32_bf16 v[176:179], v[144:147], v[188:191], 0
  v_mul_f32 v162, v162, v126
  v_mul_f32 v163, v163, v126
  v_mfma_f32_16x16x32_bf16 v[176:179], v[116:119], v[120:123], v[176:179]
  s_waitcnt lgkmcnt(2)
  v_mul_f32 v196, v196, v126
  v_mul_f32 v197, v197, v126
  v_mul_f32 v198, v198, v126
  v_mfma_f32_16x16x16_bf16 v[188:191], v[124:125], v[134:135], 0
  v_mul_f32 v199, v199, v126
  v_cvt_pk_bf16_f32 v148, v160, v161
  v_cvt_pk_bf16_f32 v149, v162, v163
  v_mfma_f32_16x16x16_bf16 v[160:163], v[210:211], v[134:135], 0
  v_cvt_pk_bf16_f32 v150, v196, v197
  v_cvt_pk_bf16_f32 v151, v198, v199
  v_mul_f32 v176, v176, v126
  v_mfma_f32_16x16x16_bf16 v[196:199], v[132:133], v[134:135], 0
  v_mul_f32 v177, v177, v126
  v_mul_f32 v178, v178, v126
  v_mul_f32 v179, v179, v126
  v_mfma_f32_16x16x16_bf16 v[156:159], v[192:193], v[134:135], v[2:5]
  v_cvt_pk_bf16_f32 v124, v176, v177
  v_cvt_pk_bf16_f32 v125, v178, v179
  v_mfma_f32_16x16x32_bf16 v[188:191], v[164:167], v[200:203], v[188:191]
  ds_write_b128 v16, v[148:151] offset:32768
  v_mfma_f32_16x16x32_bf16 v[160:163], v[140:143], v[200:203], v[160:163]
  s_nop 3
  v_max3_f32 v126, v188, v189, v190
  v_mfma_f32_16x16x32_bf16 v[196:199], v[184:187], v[200:203], v[196:199]
  ds_write_b64 v17, v[124:125] offset:32768
  v_mfma_f32_16x16x32_bf16 v[156:159], v[128:131], v[200:203], v[156:159]
  v_max3_f32 v126, v126, v191, v160
  v_max3_f32 v126, v126, v161, v162
  s_nop 1
  v_max3_f32 v126, v126, v163, v196
  v_max3_f32 v126, v126, v197, v198
  ds_read_b128 v[128:131], v18
  s_nop 0
  v_max3_f32 v126, v126, v199, v156
  v_mov_b32 v124, v126
  s_nop 1
  v_permlane32_swap_b32 v126, v124
  v_max_f32 v126, v126, v124
  v_mov_b32 v124, v126
  s_nop 1
  v_permlane16_swap_b32 v126, v124
  v_max_f32 v126, v126, v124
  v_sub_f32 v188, v188, v126
  v_sub_f32 v189, v189, v126
  v_sub_f32 v190, v190, v126
  v_sub_f32 v191, v191, v126
  v_sub_f32 v160, v160, v126
  v_sub_f32 v161, v161, v126
  v_sub_f32 v162, v162, v126
  v_sub_f32 v163, v163, v126
  v_exp_f32 v188, v188
  v_exp_f32 v189, v189
  v_exp_f32 v190, v190
  v_exp_f32 v191, v191
  v_exp_f32 v160, v160
  v_exp_f32 v161, v161
  v_exp_f32 v162, v162
  v_exp_f32 v163, v163
  v_sub_f32 v196, v196, v126
  v_sub_f32 v197, v197, v126
  v_sub_f32 v198, v198, v126
  v_sub_f32 v199, v199, v126
  v_sub_f32 v156, v156, v126
  v_exp_f32 v196, v196
  v_exp_f32 v197, v197
  v_exp_f32 v198, v198
  v_exp_f32 v199, v199
  v_exp_f32 v156, v156
  v_cvt_pk_bf16_f32 v200, v188, v189
  v_cvt_pk_bf16_f32 v201, v190, v191
  v_cvt_pk_bf16_f32 v202, v160, v161
  v_cvt_pk_bf16_f32 v203, v162, v163
  v_cvt_pk_bf16_f32 v120, v196, v197
  v_cvt_pk_bf16_f32 v121, v198, v199
  v_mfma_f32_16x16x32_bf16 v[196:199], a[246:249], v[200:203], 0
  v_cvt_pk_bf16_f32 v122, v156, 0
  s_nop 1
  v_mfma_f32_16x16x32_bf16 v[196:199], a[246:249], v[120:123], v[196:199]
  ds_read_b128 v[156:159], v18 offset:6144
  ds_read_b128 v[160:163], v18 offset:1024
  v_mfma_f32_16x16x32_bf16 v[188:191], v[200:203], v[168:171], 0
  ds_read_b128 v[168:171], v18 offset:7168
  v_mfma_f32_16x16x32_bf16 v[188:191], v[120:123], v[108:111], v[188:191]
  v_mul_f32 v196, 0x3ee9a3cd, v196
  v_mfma_f32_16x16x32_bf16 v[184:187], v[200:203], v[172:175], 0
  v_rcp_f32 v110, v196
  v_mfma_f32_16x16x32_bf16 v[184:187], v[120:123], v[112:115], v[184:187]
  ds_read_b128 v[196:199], v18 offset:2048
  ds_read_b128 v[172:175], v18 offset:8192
  v_mfma_f32_16x16x32_bf16 v[140:143], v[200:203], v[144:147], 0
  v_mfma_f32_16x16x32_bf16 v[140:143], v[120:123], v[116:119], v[140:143]
  s_waitcnt lgkmcnt(6)
  v_cndmask_b32 v118, v184, v188, s[54:55]
  s_nop 5
  v_cndmask_b32 v118, v140, v118, s[56:57]
  v_mul_f32 v118, v118, v110
  v_cvt_pk_bf16_f32 v118, v118, v118
  ds_write_b16 v20, v118 offset:384
  v_add_u32 v20, 1160, v20
  s_waitcnt lgkmcnt(0)
  s_barrier
  ds_read_b128 v[140:143], v15 offset:20480
  ds_read_b128 v[184:187], v15 offset:21504
  ds_read_b128 v[188:191], v15 offset:22528
  ds_read_b128 v[144:147], v15 offset:26624
  ds_read_b128 v[200:203], v15 offset:27648
  ds_read_b128 v[148:151], v15 offset:28672
  s_waitcnt lgkmcnt(5)
  v_mfma_f32_16x16x32_bf16 v[28:31], a[250:253], v[140:143], v[28:31]
  s_waitcnt lgkmcnt(4)
  v_mfma_f32_16x16x32_bf16 v[28:31], v[128:131], v[184:187], v[28:31]
  s_waitcnt lgkmcnt(3)
  v_mfma_f32_16x16x32_bf16 v[28:31], v[156:159], v[188:191], v[28:31]
  v_mfma_f32_16x16x32_bf16 v[32:35], v[100:103], v[140:143], v[32:35]
  v_mfma_f32_16x16x32_bf16 v[32:35], v[160:163], v[184:187], v[32:35]
  v_mfma_f32_16x16x32_bf16 v[32:35], v[168:171], v[188:191], v[32:35]
  ds_read_b128 v[164:167], v15 offset:32768
  v_mfma_f32_16x16x32_bf16 v[36:39], v[104:107], v[140:143], v[36:39]
  ds_read_b128 v[140:143], v15 offset:33792
  v_mfma_f32_16x16x32_bf16 v[36:39], v[196:199], v[184:187], v[36:39]
  ds_read_b128 v[184:187], v15 offset:34816
  v_mfma_f32_16x16x32_bf16 v[36:39], v[172:175], v[188:191], v[36:39]
  s_waitcnt lgkmcnt(5)
  v_mfma_f32_16x16x32_bf16 v[40:43], a[250:253], v[144:147], v[40:43]
  s_waitcnt lgkmcnt(4)
  v_mfma_f32_16x16x32_bf16 v[40:43], v[128:131], v[200:203], v[40:43]
  s_waitcnt lgkmcnt(3)
  v_mfma_f32_16x16x32_bf16 v[40:43], v[156:159], v[148:151], v[40:43]
  v_mfma_f32_16x16x32_bf16 v[44:47], v[100:103], v[144:147], v[44:47]
  v_mfma_f32_16x16x32_bf16 v[44:47], v[160:163], v[200:203], v[44:47]
  v_mfma_f32_16x16x32_bf16 v[44:47], v[168:171], v[148:151], v[44:47]
  ds_read_b128 v[188:191], v18 offset:9216
  ds_read_b128 v[176:179], v15 offset:23552
  v_mfma_f32_16x16x32_bf16 v[48:51], v[104:107], v[144:147], v[48:51]
  ds_read_b128 v[144:147], v18 offset:3072
  v_mfma_f32_16x16x32_bf16 v[48:51], v[196:199], v[200:203], v[48:51]
  ds_read_b128 v[200:203], v15 offset:24576
  v_mfma_f32_16x16x32_bf16 v[48:51], v[172:175], v[148:151], v[48:51]
  s_waitcnt lgkmcnt(6)
  ds_read_b128 v[148:151], v18 offset:12288
  v_mfma_f32_16x16x32_bf16 v[52:55], a[250:253], v[164:167], v[52:55]
  s_waitcnt lgkmcnt(6)
  ds_read_b128 v[152:155], v15 offset:25600
  v_mfma_f32_16x16x32_bf16 v[52:55], v[128:131], v[140:143], v[52:55]
  s_waitcnt lgkmcnt(6)
  ds_read_b128 v[128:131], v18 offset:10240
  v_mfma_f32_16x16x32_bf16 v[52:55], v[156:159], v[184:187], v[52:55]
  ds_read_b128 v[156:159], v18 offset:4096
  v_mfma_f32_16x16x32_bf16 v[56:59], v[100:103], v[164:167], v[56:59]
  ds_read_b128 v[132:135], v18 offset:13312
  v_mfma_f32_16x16x32_bf16 v[56:59], v[160:163], v[140:143], v[56:59]
  ds_read_b128 v[160:163], v18 offset:11264
  v_mfma_f32_16x16x32_bf16 v[56:59], v[168:171], v[184:187], v[56:59]
  ds_read_b128 v[168:171], v18 offset:5120
  v_mfma_f32_16x16x32_bf16 v[60:63], v[104:107], v[164:167], v[60:63]
  ds_read_b128 v[164:167], v18 offset:14336
  v_mfma_f32_16x16x32_bf16 v[60:63], v[196:199], v[140:143], v[60:63]
  ds_read_b128 v[140:143], v15 offset:29696
  v_mfma_f32_16x16x32_bf16 v[60:63], v[172:175], v[184:187], v[60:63]
  s_waitcnt lgkmcnt(11)
  ds_read_b128 v[172:175], v15 offset:30720
  v_mfma_f32_16x16x32_bf16 v[28:31], v[188:191], v[176:179], v[28:31]
  s_waitcnt lgkmcnt(10)
  ds_read_b128 v[184:187], v15 offset:31744
  v_mfma_f32_16x16x32_bf16 v[28:31], v[144:147], v[200:203], v[28:31]
  s_waitcnt lgkmcnt(9)
  v_mfma_f32_16x16x32_bf16 v[28:31], v[148:151], v[152:155], v[28:31]
  s_waitcnt lgkmcnt(8)
  v_mfma_f32_16x16x32_bf16 v[32:35], v[128:131], v[176:179], v[32:35]
  s_waitcnt lgkmcnt(7)
  v_mfma_f32_16x16x32_bf16 v[32:35], v[156:159], v[200:203], v[32:35]
  s_waitcnt lgkmcnt(6)
  v_cvt_pk_bf16_f32 v196, v28, v29
  v_cvt_pk_bf16_f32 v197, v30, v31
  v_mfma_f32_16x16x32_bf16 v[32:35], v[132:135], v[152:155], v[32:35]
  s_waitcnt lgkmcnt(5)
  ds_read_b128 v[136:139], v15 offset:35840
  v_mfma_f32_16x16x32_bf16 v[36:39], v[160:163], v[176:179], v[36:39]
  s_waitcnt lgkmcnt(5)
  ds_read_b128 v[176:179], v15 offset:36864
  v_mfma_f32_16x16x32_bf16 v[36:39], v[168:171], v[200:203], v[36:39]
  s_waitcnt lgkmcnt(5)
  ds_read_b128 v[200:203], v15 offset:37888
  v_cvt_pk_bf16_f32 v198, v32, v33
  v_mfma_f32_16x16x32_bf16 v[36:39], v[164:167], v[152:155], v[36:39]
  s_waitcnt lgkmcnt(5)
  v_cvt_pk_bf16_f32 v199, v34, v35
  v_mfma_f32_16x16x32_bf16 v[40:43], v[188:191], v[140:143], v[40:43]
  s_waitcnt lgkmcnt(4)
  v_permlane16_swap_b32 v196, v198
  v_mfma_f32_16x16x32_bf16 v[40:43], v[144:147], v[172:175], v[40:43]
  s_waitcnt lgkmcnt(3)
  v_cvt_pk_bf16_f32 v152, v36, v37
  v_cvt_pk_bf16_f32 v153, v38, v39
  v_mfma_f32_16x16x32_bf16 v[40:43], v[148:151], v[184:187], v[40:43]
  v_permlane16_swap_b32 v197, v199
  v_mfma_f32_16x16x32_bf16 v[44:47], v[128:131], v[140:143], v[44:47]
  buffer_store_dwordx4 v[196:199], v12, s[8:11], s35 offen
  s_nop 1
  s_nop 0
  v_cvt_pk_bf16_f32 v196, v40, v41
  v_mfma_f32_16x16x32_bf16 v[44:47], v[156:159], v[172:175], v[44:47]
  v_cvt_pk_bf16_f32 v197, v42, v43
  v_mfma_f32_16x16x32_bf16 v[44:47], v[132:135], v[184:187], v[44:47]
  v_mfma_f32_16x16x32_bf16 v[48:51], v[160:163], v[140:143], v[48:51]
  v_mfma_f32_16x16x32_bf16 v[48:51], v[168:171], v[172:175], v[48:51]
  v_cvt_pk_bf16_f32 v198, v44, v45
  v_cvt_pk_bf16_f32 v199, v46, v47
  v_mfma_f32_16x16x32_bf16 v[48:51], v[164:167], v[184:187], v[48:51]
  s_waitcnt lgkmcnt(2)
  v_permlane16_swap_b32 v196, v198
  v_mfma_f32_16x16x32_bf16 v[52:55], v[188:191], v[136:139], v[52:55]
  s_waitcnt lgkmcnt(1)
  v_permlane16_swap_b32 v197, v199
  v_mfma_f32_16x16x32_bf16 v[52:55], v[144:147], v[176:179], v[52:55]
  s_waitcnt lgkmcnt(0)
  v_cvt_pk_bf16_f32 v154, v48, v49
  v_cvt_pk_bf16_f32 v155, v50, v51
  v_mfma_f32_16x16x32_bf16 v[52:55], v[148:151], v[200:203], v[52:55]
  v_permlane16_swap_b32 v152, v154
  v_mfma_f32_16x16x32_bf16 v[56:59], v[128:131], v[136:139], v[56:59]
  v_permlane16_swap_b32 v153, v155
  v_mfma_f32_16x16x32_bf16 v[56:59], v[156:159], v[176:179], v[56:59]
  v_cvt_pk_bf16_f32 v156, v52, v53
  v_cvt_pk_bf16_f32 v157, v54, v55
  v_mfma_f32_16x16x32_bf16 v[56:59], v[132:135], v[200:203], v[56:59]
  v_mfma_f32_16x16x32_bf16 v[60:63], v[160:163], v[136:139], v[60:63]
  v_mfma_f32_16x16x32_bf16 v[60:63], v[168:171], v[176:179], v[60:63]
  v_cvt_pk_bf16_f32 v158, v56, v57
  v_cvt_pk_bf16_f32 v159, v58, v59
  v_mfma_f32_16x16x32_bf16 v[60:63], v[164:167], v[200:203], v[60:63]
  v_permlane16_swap_b32 v156, v158
  v_permlane16_swap_b32 v157, v159
  s_nop 5
  v_cvt_pk_bf16_f32 v116, v60, v61
  v_cvt_pk_bf16_f32 v117, v62, v63
  buffer_store_dwordx4 v[196:199], v13, s[8:11], s35 offen
  buffer_store_dwordx4 v[152:155], v22, s[8:11], s35 offen
  buffer_store_dwordx4 v[156:159], v14, s[8:11], s35 offen
  buffer_store_dwordx2 v[116:117], v23, s[8:11], s35 offen
  s_cmp_lt_u32 s31, 21
  s_cbranch_scc1 L_safe_loop
  buffer_load_dwordx4 v[128:131], v15, s[12:15], s77 offen offset:2048
  buffer_load_dwordx4 v[64:67], v15, s[12:15], s75 offen
  buffer_load_dwordx4 v[68:71], v15, s[12:15], s75 offen offset:1024
  buffer_load_dwordx4 v[72:75], v15, s[12:15], s75 offen offset:2048
  ds_read_b128 v[132:135], v18
  ds_read_b128 v[136:139], v18 offset:6144
  ds_read_b128 v[140:143], v18 offset:9216
  ds_read_b128 v[144:147], v18 offset:3072
  ds_read_b128 v[148:151], v18 offset:12288
  buffer_load_dwordx4 v[76:79], v15, s[12:15], s75 offen offset:3072
  ds_read_b128 v[152:155], v18 offset:1024
  ds_read_b128 v[156:159], v18 offset:7168
  ds_read_b128 v[160:163], v18 offset:10240
  ds_read_b128 v[164:167], v18 offset:4096
  ds_read_b128 v[168:171], v18 offset:13312
  buffer_load_dwordx4 v[80:83], v15, s[12:15], s77 offen
  ds_read_b128 v[172:175], v18 offset:2048
  ds_read_b128 v[176:179], v18 offset:8192
  ds_read_b128 v[180:183], v18 offset:11264
  ds_read_b128 v[184:187], v18 offset:5120
  buffer_load_dwordx4 v[84:87], v15, s[12:15], s77 offen offset:1024
  ds_read_b128 v[188:191], v18 offset:14336
  s_waitcnt vmcnt(6)
  ds_read2_b64 v[192:195], v131 offset0:0 offset1:4
  ds_read2_b64 v[196:199], v131 offset0:12 offset1:16
  v_add_u32 v110, 5800, v131
  ds_read2_b64 v[200:203], v131 offset0:24 offset1:28
  ds_read2_b64 v[204:207], v131 offset0:36 offset1:40
  s_waitcnt vmcnt(5) lgkmcnt(3)
  v_mfma_f32_16x16x32_bf16 v[64:67], a[250:253], v[192:195], v[64:67]
  ds_read2_b64 v[208:211], v131 offset0:8 offset1:20
  s_waitcnt lgkmcnt(3)
  v_mfma_f32_16x16x32_bf16 v[64:67], v[132:135], v[196:199], v[64:67]
  ds_read2_b64 v[212:215], v131 offset0:32 offset1:44
  s_waitcnt lgkmcnt(3)
  v_mfma_f32_16x16x32_bf16 v[64:67], v[136:139], v[200:203], v[64:67]
  ds_read2_b64 v[216:219], v110 offset0:0 offset1:4
  s_waitcnt lgkmcnt(3)
  v_mfma_f32_16x16x32_bf16 v[64:67], v[140:143], v[204:207], v[64:67]
  ds_read2_b64 v[220:223], v110 offset0:12 offset1:16
  s_waitcnt lgkmcnt(3)
  v_mfma_f32_16x16x32_bf16 v[64:67], v[144:147], v[208:211], v[64:67]
  ds_read2_b64 v[224:227], v110 offset0:24 offset1:28
  s_waitcnt lgkmcnt(3)
  v_mfma_f32_16x16x32_bf16 v[64:67], v[148:151], v[212:215], v[64:67]
  s_waitcnt vmcnt(4)
  ds_read2_b64 v[228:231], v110 offset0:36 offset1:40
  v_mfma_f32_16x16x32_bf16 v[68:71], v[100:103], v[192:195], v[68:71]
  v_mfma_f32_16x16x32_bf16 v[68:71], v[152:155], v[196:199], v[68:71]
  ds_read2_b64 v[232:235], v110 offset0:8 offset1:20
  v_cvt_pk_bf16_f32 v236, v64, v65
  v_mfma_f32_16x16x32_bf16 v[68:71], v[156:159], v[200:203], v[68:71]
  v_cvt_pk_bf16_f32 v237, v66, v67
  v_mfma_f32_16x16x32_bf16 v[68:71], v[160:163], v[204:207], v[68:71]
  ds_read2_b64 v[240:243], v110 offset0:32 offset1:44
  v_mfma_f32_16x16x32_bf16 v[68:71], v[164:167], v[208:211], v[68:71]
  v_mfma_f32_16x16x32_bf16 v[68:71], v[168:171], v[212:215], v[68:71]
  s_waitcnt vmcnt(3)
  v_mfma_f32_16x16x32_bf16 v[72:75], v[104:107], v[192:195], v[72:75]
  v_mfma_f32_16x16x32_bf16 v[72:75], v[172:175], v[196:199], v[72:75]
  v_cvt_pk_bf16_f32 v238, v68, v69
  v_cvt_pk_bf16_f32 v239, v70, v71
  v_mfma_f32_16x16x32_bf16 v[72:75], v[176:179], v[200:203], v[72:75]
  v_permlane16_swap_b32 v236, v238
  v_mfma_f32_16x16x32_bf16 v[72:75], v[180:183], v[204:207], v[72:75]
  v_permlane16_swap_b32 v237, v239
  v_mfma_f32_16x16x32_bf16 v[72:75], v[184:187], v[208:211], v[72:75]
  buffer_store_dwordx4 v[236:239], v128, s[8:11], 0 offen
  v_mfma_f32_16x16x32_bf16 v[72:75], v[188:191], v[212:215], v[72:75]
  s_waitcnt vmcnt(3) lgkmcnt(5)
  v_mfma_f32_16x16x32_bf16 v[76:79], a[250:253], v[216:219], v[76:79]
  s_waitcnt lgkmcnt(4)
  v_mfma_f32_16x16x32_bf16 v[76:79], v[132:135], v[220:223], v[76:79]
  s_waitcnt lgkmcnt(3)
  v_cvt_pk_bf16_f32 v132, v72, v73
  v_cvt_pk_bf16_f32 v133, v74, v75
  v_mfma_f32_16x16x32_bf16 v[76:79], v[136:139], v[224:227], v[76:79]
  s_waitcnt lgkmcnt(2)
  v_mfma_f32_16x16x32_bf16 v[76:79], v[140:143], v[228:231], v[76:79]
  s_waitcnt lgkmcnt(1)
  v_mfma_f32_16x16x32_bf16 v[76:79], v[144:147], v[232:235], v[76:79]
  s_waitcnt lgkmcnt(0)
  v_mfma_f32_16x16x32_bf16 v[76:79], v[148:151], v[240:243], v[76:79]
  s_waitcnt vmcnt(2)
  v_mfma_f32_16x16x32_bf16 v[80:83], v[100:103], v[216:219], v[80:83]
  v_mfma_f32_16x16x32_bf16 v[80:83], v[152:155], v[220:223], v[80:83]
  v_cvt_pk_bf16_f32 v152, v76, v77
  v_cvt_pk_bf16_f32 v153, v78, v79
  v_mfma_f32_16x16x32_bf16 v[80:83], v[156:159], v[224:227], v[80:83]
  v_mfma_f32_16x16x32_bf16 v[80:83], v[160:163], v[228:231], v[80:83]
  v_mfma_f32_16x16x32_bf16 v[80:83], v[164:167], v[232:235], v[80:83]
  v_mfma_f32_16x16x32_bf16 v[80:83], v[168:171], v[240:243], v[80:83]
  s_waitcnt vmcnt(1)
  v_mfma_f32_16x16x32_bf16 v[84:87], v[104:107], v[216:219], v[84:87]
  v_mfma_f32_16x16x32_bf16 v[84:87], v[172:175], v[220:223], v[84:87]
  v_cvt_pk_bf16_f32 v154, v80, v81
  v_cvt_pk_bf16_f32 v155, v82, v83
  v_mfma_f32_16x16x32_bf16 v[84:87], v[176:179], v[224:227], v[84:87]
  v_permlane16_swap_b32 v152, v154
  v_mfma_f32_16x16x32_bf16 v[84:87], v[180:183], v[228:231], v[84:87]
  v_permlane16_swap_b32 v153, v155
  v_mfma_f32_16x16x32_bf16 v[84:87], v[184:187], v[232:235], v[84:87]
  buffer_store_dwordx4 v[152:155], v129, s[8:11], 0 offen
  v_mfma_f32_16x16x32_bf16 v[84:87], v[188:191], v[240:243], v[84:87]
  s_nop 7
  v_cvt_pk_bf16_f32 v134, v84, v85
  v_cvt_pk_bf16_f32 v135, v86, v87
  s_nop 0
  v_permlane16_swap_b32 v132, v134
  v_permlane16_swap_b32 v133, v135
  buffer_store_dwordx4 v[132:135], v130, s[8:11], 0 offen
L_exit:
  s_endpgm
.section .rodata,"a"
.p2align 6
.amdhsa_kernel standalone__window_attn_davit__vision_kernel
  .amdhsa_next_free_vgpr 512
  .amdhsa_next_free_sgpr 102
  .amdhsa_accum_offset 256
  .amdhsa_group_segment_fixed_size 0
  .amdhsa_kernarg_size 56
  .amdhsa_user_sgpr_count 2
  .amdhsa_user_sgpr_kernarg_segment_ptr 1
  .amdhsa_system_sgpr_workgroup_id_x 1
.end_amdhsa_kernel
```
